```python
import torch

def _softmax(x, axis=-1):
    return torch.softmax(x, dim=axis)
def _gelu(x):
    return torch.nn.functional.gelu(x, approximate="tanh")
def _silu(x):
    return torch.nn.functional.silu(x)
def _sigmoid(x):
    return torch.sigmoid(x)
def _layernorm(x, axis=-1, eps=1e-5):
    m = x.mean(dim=axis, keepdim=True)
    v = x.var(dim=axis, keepdim=True, unbiased=False)
    return (x - m) / torch.sqrt(v + eps)
def _scatter_add(tgt, idx, src, axis=0):
    return tgt.clone().index_add_(axis, idx, src)
def _segment_sum(src, seg, n):
    out = torch.zeros((n,) + src.shape[1:], dtype=src.dtype)
    return out.index_add_(0, seg, src)
def _pad(x, pw):
    flat = tuple(v for pair in reversed(pw) for v in pair)
    return torch.nn.functional.pad(x, flat)

kernel_name = 'recurrent_scan__gqa_block_cached__glu_gated_bilinear__prompt'

def setup_inputs():

    _w = (lambda a: (lambda t: t.to(torch.bfloat16) if t.is_floating_point() else t)(torch.as_tensor(a)))
    def _A_setup():
        B, Sq, D = 1, 2048, 640
        Hq, Hkv, Sk, Dh = 32, 32, 2048, 128
        assert Hq % Hkv == 0, (Hq, Hkv)
        return {
            "x": _w((lambda *s: torch.randn(*s, dtype=torch.bfloat16) * 0.05)(B, Sq, D)),
            "k_cache": _w((lambda *s: torch.randn(*s, dtype=torch.bfloat16) * 1.6)(B, Hkv, Sk, Dh)),
            "v_cache": _w((lambda *s: torch.randn(*s, dtype=torch.bfloat16) * 1.6)(B, Hkv, Sk, Dh)),
            "wq": _w((lambda *s: torch.randn(*s, dtype=torch.bfloat16) * 1.6)(D, Hq * Dh) * (D ** -0.5)),
            "wo": _w((lambda *s: torch.randn(*s, dtype=torch.bfloat16) * 1.6)(Hq * Dh, D) * ((Hq * Dh) ** -0.5)),
        }
    _A_in = _A_setup()

    def _B_setup():
        B, S, D, F = 1, 2048, 640, 1728
        return {
            "x": _w((lambda *s: torch.randn(*s, dtype=torch.bfloat16) * 0.05)(B, S, D)),
            "w_gate": _w((lambda *s: torch.randn(*s, dtype=torch.bfloat16) * 0.2)(D, F) * (D ** -0.5)),
            "w_up": _w((lambda *s: torch.randn(*s, dtype=torch.bfloat16) * 0.2)(D, F) * (D ** -0.5)),
            "w_down": _w((lambda *s: torch.randn(*s, dtype=torch.bfloat16) * 0.2)(F, D) * (F ** -0.5)),
        }
    _B_in = _B_setup()

    return {
        "A_x": _A_in["x"],
        "A_k_cache": _A_in["k_cache"],
        "A_v_cache": _A_in["v_cache"],
        "A_wq": _A_in["wq"],
        "A_wo": _A_in["wo"],
        "B_x": _B_in["x"],
        "B_w_gate": _B_in["w_gate"],
        "B_w_up": _B_in["w_up"],
        "B_w_down": _B_in["w_down"],
    }

def reference(A_x, A_k_cache, A_v_cache, A_wq, A_wo, B_x, B_w_gate, B_w_up, B_w_down):
    def _A_ref(x, k_cache, v_cache, wq, wo):
        B, Sq, D = x.shape
        Hq, Dh = 32, 128
        Hkv = k_cache.shape[1]
        rep = Hq // Hkv
        q = (lambda x, *d: x.permute(*d))((x @ wq).reshape(B, Sq, Hq, Dh), 0, 2, 1, 3)
        k = (lambda x, n, axis: torch.repeat_interleave(x, n, dim=axis))(k_cache, rep, axis=1)
        v = (lambda x, n, axis: torch.repeat_interleave(x, n, dim=axis))(v_cache, rep, axis=1)
        scores = torch.einsum("bhqd,bhkd->bhqk", q, k) * (Dh ** -0.5)
        p = _softmax(scores, axis=-1)
        o = torch.einsum("bhqk,bhkd->bhqd", p, v)
        return (lambda x, *d: x.permute(*d))(o, 0, 2, 1, 3).reshape(B, Sq, Hq * Dh) @ wo

    def _B_ref(x, w_gate, w_up, w_down):
        g = torch.einsum("bsd,df->bsf", x, w_gate)
        u = torch.einsum("bsd,df->bsf", x, w_up)
        h = g * u
        return torch.einsum("bsf,fd->bsd", h, w_down)

    x = A_x
    xn = _layernorm(x, axis=-1)
    s = _A_ref(xn, A_k_cache, A_v_cache, A_wq, A_wo)
    g = _silu(_B_ref(xn, B_w_gate, B_w_up, B_w_down))
    return x + s * g
```

```asm
; @launch grid=(256,1,1) block=(256,1,1) lds=163840
.amdgcn_target "amdgcn-amd-amdhsa--gfx950"
.text
.globl recurrent_scan__gqa_block_cached__glu_gated_bilinear__prompt_kernel
.p2align 8
.type recurrent_scan__gqa_block_cached__glu_gated_bilinear__prompt_kernel,@function
recurrent_scan__gqa_block_cached__glu_gated_bilinear__prompt_kernel:
  s_cmp_ge_u32 s2, 256
  s_cbranch_scc1 L_out
  s_load_dwordx2 s[4:5], s[0:1], 0
  s_load_dwordx2 s[32:33], s[0:1], 88
  s_load_dwordx2 s[20:21], s[0:1], 24
  s_load_dwordx2 s[24:25], s[0:1], 48
  s_load_dwordx2 s[28:29], s[0:1], 56
  s_load_dwordx2 s[48:49], s[0:1], 80
  s_load_dwordx2 s[8:9], s[0:1], 8
  s_load_dwordx2 s[12:13], s[0:1], 16
  s_load_dwordx2 s[88:89], s[0:1], 0
  s_load_dwordx2 s[90:91], s[0:1], 72
  s_load_dwordx2 s[100:101], s[0:1], 32
  s_load_dwordx2 s[98:99], s[0:1], 64
  v_lshrrev_b32 v2, 6, v0
  s_getpc_b64 s[36:37]
L_pc:
  s_lshr_b32 s3, s2, 3
  v_readfirstlane_b32 s43, v2
  v_bfe_u32 v1, v0, 1, 5
  v_lshlrev_b32 v1, 12, v1
  s_lshl_b32 s3, s3, 7
  s_mov_b32 s59, L_post1-L_pc
  s_cmp_eq_u32 s43, 3
  s_cselect_b32 s3, L_proj0-L_pc, s3
  s_cselect_b32 s59, L_slow-L_pc, s59
  v_add_u32 v1, s3, v1
  v_min_u32 v1, s59, v1
  v_mov_b32 v127, s37
  v_add_co_u32 v126, vcc, s36, v1
  s_cmp_lt_u32 s43, 2
  s_cselect_b32 s6, 2621440, 0
  v_addc_co_u32 v127, vcc, 0, v127, vcc
  s_cmp_lt_u32 s43, 2
  s_cbranch_scc1 L_nopf
  global_load_dword v117, v[126:127], off
L_nopf:
  s_mov_b32 s7, 0x20000
  s_lshl_b32 s44, s2, 2
  s_lshr_b32 s44, 0x75643120, s44
  s_and_b32 s44, s44, 7
  s_bfe_u32 s45, s2, 0x20003
  s_lshl2_add_u32 s44, s44, s45
  s_lshr_b32 s45, s2, 5
  v_lshrrev_b32 v10, 4, v0
  v_and_b32 v11, 15, v0
  v_mul_u32_u24 v12, 1280, v10
  v_lshl_add_u32 v12, v11, 4, v12
  s_lshl_b32 s3, s45, 5
  s_add_u32 s3, s3, s44
  s_mul_i32 s59, s3, 10240
  s_lshl_b32 s85, s45, 16
  s_add_u32 s85, s85, 3211264
  s_mov_b32 s34, 67108864
  s_mov_b32 s35, 0x20000
  s_waitcnt lgkmcnt(0)
  buffer_load_dwordx2 v[20:21], off, s[32:35], s85 sc1
  buffer_load_dwordx4 v[128:131], v12, s[4:7], s59 offen offset:0
  buffer_load_dwordx4 v[132:135], v12, s[4:7], s59 offen offset:256
  buffer_load_dwordx4 v[136:139], v12, s[4:7], s59 offen offset:512
  buffer_load_dwordx4 v[140:143], v12, s[4:7], s59 offen offset:768
  buffer_load_dwordx4 v[144:147], v12, s[4:7], s59 offen offset:1024
  v_and_b32 v1, 63, v0
  v_lshlrev_b32 v3, 4, v1
  v_lshrrev_b32 v96, 4, v1
  v_lshlrev_b32 v99, 2, v96
  v_xor_b32 v99, v99, v1
  v_and_b32 v99, 15, v99
  v_lshlrev_b32 v99, 4, v99
  v_lshl_add_u32 v112, v96, 13, v99
  s_bitcmp1_b32 s44, 3
  s_cselect_b32 s3, 6, 8
  s_lshl_b32 s3, s3, 4
  v_mov_b32 v97, 0x10000000
  v_and_b32 v99, 1, v96
  v_or_b32 v99, 0, v99
  v_lshlrev_b32 v99, 1, v99
  v_xor_b32 v99, v99, v1
  v_and_b32 v99, 7, v99
  v_lshlrev_b32 v99, 4, v99
  v_cmp_gt_u32 vcc, s3, v99
  v_lshrrev_b32 v113, 3, v1
  v_mul_u32_u24 v113, 3456, v113
  v_cndmask_b32 v99, v97, v99, vcc
  v_add_u32 v113, v113, v99
  v_and_b32 v99, 1, v96
  v_or_b32 v99, 2, v99
  v_lshlrev_b32 v99, 1, v99
  v_xor_b32 v99, v99, v1
  v_and_b32 v99, 7, v99
  v_lshlrev_b32 v99, 4, v99
  v_cmp_gt_u32 vcc, s3, v99
  v_lshrrev_b32 v114, 3, v1
  v_mul_u32_u24 v114, 3456, v114
  v_cndmask_b32 v99, v97, v99, vcc
  v_add_u32 v114, v114, v99
  v_add_u32 v114, 26624, v114
  s_lshl_b32 s18, s43, 12
  s_lshl_b32 s80, s43, 17
  s_lshl_b32 s3, s44, 8
  s_add_u32 s80, s80, s3
  s_lshr_b32 s3, s44, 1
  s_and_b32 s3, s3, 8
  s_and_b32 s19, s44, 7
  s_add_u32 s19, s19, s3
  s_bitcmp1_b32 s44, 3
  s_cselect_b32 s3, 3, 4
  s_mul_i32 s19, s19, s3
  s_cselect_b32 s3, 64, 0
  s_add_u32 s19, s19, s3
  s_mul_i32 s81, s43, 55296
  s_lshl_b32 s3, s19, 5
  s_add_u32 s81, s81, s3
  s_lshl_b32 s3, s45, 2
  s_add_u32 s3, s3, s43
  s_mul_i32 s82, s3, 81920
  s_lshl_b32 s47, s3, 13
  s_mov_b32 s40, s80
  s_mov_b32 s41, s81
  s_mov_b32 s42, s82
  s_add_u32 s46, s47, 12582912
  s_add_u32 s59, s19, 1
  s_lshr_b32 s3, s59, 2
  s_lshl_b32 s3, s3, 18
  s_add_u32 s47, s47, s3
  s_and_b32 s3, s59, 2
  s_lshl_b32 s3, s3, 9
  s_add_u32 s47, s47, s3
  s_lshl_b32 s3, s44, 19
  s_add_u32 s46, s46, s3
  s_add_u32 s16, s3, s18
  s_mov_b32 s17, s16
  v_mov_b32 v124, 0
  v_cmp_eq_u32 vcc, 0, v0
  v_mov_b32 v2, 0x10000000
  v_mov_b32 v118, 1
  v_cndmask_b32 v94, v2, v124, vcc
  v_cmp_eq_u32 vcc, 0, v1
  s_mov_b32 s58, -1
  s_cmp_lt_u32 s19, 108
  v_cndmask_b32 v125, v2, v124, vcc
  s_cselect_b32 s26, 2211840, 0
  s_mov_b32 s30, s26
  s_mov_b32 s27, 0x20000
  s_mov_b32 s31, 0x20000
  s_mov_b32 s22, 5242880
  s_mov_b32 s23, 0x20000
  s_mov_b32 s50, 256
  s_mov_b32 s51, 0x20000
  s_add_u32 s36, s32, 4194304
  s_addc_u32 s37, s33, 0
  s_mov_b32 s38, 7077888
  s_mov_b32 s39, 0x20000
  s_add_u32 s52, s32, 33554432
  s_addc_u32 s53, s33, 0
  s_mov_b32 s54, 7454720
  s_mov_b32 s55, 0x20000
  s_mov_b32 s10, 16777216
  s_mov_b32 s11, 0x20000
  s_mov_b32 s14, 16777216
  s_mov_b32 s15, 0x20000
  s_lshr_b32 s59, s44, 3
  s_and_b32 s19, s44, 7
  s_lshl_b32 s3, s45, 2
  s_add_u32 s3, s3, s59
  s_lshl_b32 s3, s3, 3
  s_add_u32 s3, s3, s43
  s_lshl_b32 s3, s3, 3
  s_add_u32 s3, s3, s19
  s_lshl_b32 s3, s3, 2
  s_add_u32 s96, s3, 3145728
  s_lshl_b32 s3, s45, 3
  s_add_u32 s3, s3, s19
  s_lshl_b32 s3, s3, 2
  s_add_u32 s3, s3, s43
  s_lshl_b32 s3, s3, 2
  s_add_u32 s3, s3, s59
  s_lshl_b32 s3, s3, 14
  s_add_u32 s97, s3, 46137344
  s_mov_b32 s86, s97
  s_lshl_b32 s3, s44, 3
  s_add_u32 s3, s3, s85
  s_add_u32 s84, s3, 128
  v_cmp_gt_u32 vcc, 8, v0
  v_lshlrev_b32 v2, 8, v0
  s_nop 0
  v_cndmask_b32 v24, v94, v2, vcc
  s_lshr_b32 s3, s44, 2
  s_lshl_b32 s3, s3, 8
  v_and_b32 v2, 31, v1
  v_lshl_add_u32 v123, v2, 3, s3
  s_cmp_lt_u32 s43, 2
  s_cbranch_scc1 L_ln
  s_and_b32 s3, s43, 2
  s_lshl_b32 s19, s3, 12
  s_sub_u32 s19, s18, s19
  s_lshl_b32 s56, s3, 17
  s_sub_u32 s56, s40, s56
  s_mul_i32 s57, s3, 55296
  s_sub_u32 s57, s41, s57
  s_add_u32 m0, s19, 32768
  s_nop 0
  buffer_load_dwordx4 v112, s[20:23], s56 offen offset:0 lds
  s_add_u32 s56, s56, 31744
  buffer_load_dwordx4 v112, s[20:23], s56 offen offset:1024 lds
  s_add_u32 s56, s56, 31744
  buffer_load_dwordx4 v112, s[20:23], s56 offen offset:2048 lds
  s_add_u32 s56, s56, 31744
  buffer_load_dwordx4 v112, s[20:23], s56 offen offset:3072 lds
  s_add_u32 m0, s19, 81920
  s_nop 0
  buffer_load_dwordx4 v113, s[24:27], s57 offen offset:0 lds
  buffer_load_dwordx4 v114, s[24:27], s57 offen offset:1024 lds
  s_add_u32 m0, s19, 83968
  s_nop 0
  buffer_load_dwordx4 v113, s[28:31], s57 offen offset:0 lds
  buffer_load_dwordx4 v114, s[28:31], s57 offen offset:1024 lds
  s_add_u32 s19, s19, 8192
  s_add_u32 m0, s19, 32768
  s_add_u32 s56, s56, 166912
  buffer_load_dwordx4 v112, s[20:23], s56 offen offset:0 lds
  s_add_u32 s56, s56, 31744
  buffer_load_dwordx4 v112, s[20:23], s56 offen offset:1024 lds
  s_add_u32 s56, s56, 31744
  buffer_load_dwordx4 v112, s[20:23], s56 offen offset:2048 lds
  s_add_u32 s56, s56, 31744
  buffer_load_dwordx4 v112, s[20:23], s56 offen offset:3072 lds
  s_add_u32 m0, s19, 81920
  s_add_u32 s57, s57, 110592
  buffer_load_dwordx4 v113, s[24:27], s57 offen offset:0 lds
  buffer_load_dwordx4 v114, s[24:27], s57 offen offset:1024 lds
  s_add_u32 m0, s19, 83968
  s_nop 0
  buffer_load_dwordx4 v113, s[28:31], s57 offen offset:0 lds
  buffer_load_dwordx4 v114, s[28:31], s57 offen offset:1024 lds
  s_branch L_com
L_ln:
  v_lshlrev_b32 v13, 6, v11
  v_and_b32 v10, 3, v10
  v_lshl_add_u32 v13, v10, 4, v13
  s_lshl_b32 s3, s45, 5
  s_add_u32 s3, s3, s44
  s_lshl1_add_u32 s3, s3, s43
  s_mul_i32 s59, s3, 5120
  s_waitcnt vmcnt(4)
  v_lshlrev_b32 v160, 16, v128
  v_and_b32 v161, 0xffff0000, v128
  v_lshlrev_b32 v162, 16, v129
  v_and_b32 v163, 0xffff0000, v129
  v_lshlrev_b32 v164, 16, v130
  v_and_b32 v165, 0xffff0000, v130
  v_lshlrev_b32 v166, 16, v131
  v_and_b32 v167, 0xffff0000, v131
  v_pk_add_f32 v[14:15], v[160:161], v[164:165]
  v_pk_add_f32 v[16:17], v[162:163], v[166:167]
  s_waitcnt vmcnt(3)
  v_lshlrev_b32 v168, 16, v132
  v_and_b32 v169, 0xffff0000, v132
  v_lshlrev_b32 v170, 16, v133
  v_and_b32 v171, 0xffff0000, v133
  v_lshlrev_b32 v172, 16, v134
  v_and_b32 v173, 0xffff0000, v134
  v_lshlrev_b32 v174, 16, v135
  v_and_b32 v175, 0xffff0000, v135
  v_pk_add_f32 v[14:15], v[14:15], v[168:169]
  v_pk_add_f32 v[16:17], v[16:17], v[170:171]
  v_pk_add_f32 v[14:15], v[14:15], v[172:173]
  v_pk_add_f32 v[16:17], v[16:17], v[174:175]
  s_waitcnt vmcnt(2)
  v_lshlrev_b32 v176, 16, v136
  v_and_b32 v177, 0xffff0000, v136
  v_lshlrev_b32 v178, 16, v137
  v_and_b32 v179, 0xffff0000, v137
  v_lshlrev_b32 v180, 16, v138
  v_and_b32 v181, 0xffff0000, v138
  v_lshlrev_b32 v182, 16, v139
  v_and_b32 v183, 0xffff0000, v139
  v_pk_add_f32 v[14:15], v[14:15], v[176:177]
  v_pk_add_f32 v[16:17], v[16:17], v[178:179]
  v_pk_add_f32 v[14:15], v[14:15], v[180:181]
  v_pk_add_f32 v[16:17], v[16:17], v[182:183]
  s_waitcnt vmcnt(1)
  v_lshlrev_b32 v184, 16, v140
  v_and_b32 v185, 0xffff0000, v140
  v_lshlrev_b32 v186, 16, v141
  v_and_b32 v187, 0xffff0000, v141
  v_lshlrev_b32 v188, 16, v142
  v_and_b32 v189, 0xffff0000, v142
  v_lshlrev_b32 v190, 16, v143
  v_and_b32 v191, 0xffff0000, v143
  v_pk_add_f32 v[14:15], v[14:15], v[184:185]
  v_pk_add_f32 v[16:17], v[16:17], v[186:187]
  v_pk_add_f32 v[14:15], v[14:15], v[188:189]
  v_pk_add_f32 v[16:17], v[16:17], v[190:191]
  s_waitcnt vmcnt(0)
  v_lshlrev_b32 v192, 16, v144
  v_and_b32 v193, 0xffff0000, v144
  v_lshlrev_b32 v194, 16, v145
  v_and_b32 v195, 0xffff0000, v145
  v_lshlrev_b32 v196, 16, v146
  v_and_b32 v197, 0xffff0000, v146
  v_lshlrev_b32 v198, 16, v147
  v_and_b32 v199, 0xffff0000, v147
  v_pk_add_f32 v[14:15], v[14:15], v[192:193]
  v_pk_add_f32 v[16:17], v[16:17], v[194:195]
  v_pk_add_f32 v[14:15], v[14:15], v[196:197]
  v_pk_add_f32 v[16:17], v[16:17], v[198:199]
  v_pk_add_f32 v[18:19], v[14:15], v[16:17]
  v_add_f32 v18, v18, v19
  s_nop 1
  v_add_f32 v18, v18, v18 quad_perm:[1,0,3,2] row_mask:0xf bank_mask:0xf
  s_nop 1
  v_add_f32 v18, v18, v18 quad_perm:[2,3,0,1] row_mask:0xf bank_mask:0xf
  s_nop 1
  v_add_f32 v18, v18, v18 row_half_mirror row_mask:0xf bank_mask:0xf
  s_nop 1
  v_add_f32 v18, v18, v18 row_mirror row_mask:0xf bank_mask:0xf
  v_mul_f32 v18, 0xbacccccd, v18
  v_pk_add_f32 v[160:161], v[160:161], v[18:19] op_sel_hi:[1,0]
  v_pk_add_f32 v[162:163], v[162:163], v[18:19] op_sel_hi:[1,0]
  v_pk_add_f32 v[164:165], v[164:165], v[18:19] op_sel_hi:[1,0]
  v_pk_add_f32 v[166:167], v[166:167], v[18:19] op_sel_hi:[1,0]
  v_pk_add_f32 v[168:169], v[168:169], v[18:19] op_sel_hi:[1,0]
  v_pk_add_f32 v[170:171], v[170:171], v[18:19] op_sel_hi:[1,0]
  v_pk_add_f32 v[172:173], v[172:173], v[18:19] op_sel_hi:[1,0]
  v_pk_add_f32 v[174:175], v[174:175], v[18:19] op_sel_hi:[1,0]
  v_pk_add_f32 v[176:177], v[176:177], v[18:19] op_sel_hi:[1,0]
  v_pk_add_f32 v[178:179], v[178:179], v[18:19] op_sel_hi:[1,0]
  v_pk_add_f32 v[180:181], v[180:181], v[18:19] op_sel_hi:[1,0]
  v_pk_add_f32 v[182:183], v[182:183], v[18:19] op_sel_hi:[1,0]
  v_pk_add_f32 v[184:185], v[184:185], v[18:19] op_sel_hi:[1,0]
  v_pk_add_f32 v[186:187], v[186:187], v[18:19] op_sel_hi:[1,0]
  v_pk_add_f32 v[188:189], v[188:189], v[18:19] op_sel_hi:[1,0]
  v_pk_add_f32 v[190:191], v[190:191], v[18:19] op_sel_hi:[1,0]
  v_pk_add_f32 v[192:193], v[192:193], v[18:19] op_sel_hi:[1,0]
  v_pk_add_f32 v[194:195], v[194:195], v[18:19] op_sel_hi:[1,0]
  v_pk_add_f32 v[196:197], v[196:197], v[18:19] op_sel_hi:[1,0]
  v_pk_add_f32 v[198:199], v[198:199], v[18:19] op_sel_hi:[1,0]
  v_pk_mul_f32 v[14:15], v[160:161], v[160:161]
  v_pk_mul_f32 v[16:17], v[162:163], v[162:163]
  v_pk_fma_f32 v[14:15], v[164:165], v[164:165], v[14:15]
  v_pk_fma_f32 v[16:17], v[166:167], v[166:167], v[16:17]
  v_pk_fma_f32 v[14:15], v[168:169], v[168:169], v[14:15]
  v_pk_fma_f32 v[16:17], v[170:171], v[170:171], v[16:17]
  v_pk_fma_f32 v[14:15], v[172:173], v[172:173], v[14:15]
  v_pk_fma_f32 v[16:17], v[174:175], v[174:175], v[16:17]
  v_pk_fma_f32 v[14:15], v[176:177], v[176:177], v[14:15]
  v_pk_fma_f32 v[16:17], v[178:179], v[178:179], v[16:17]
  v_pk_fma_f32 v[14:15], v[180:181], v[180:181], v[14:15]
  v_pk_fma_f32 v[16:17], v[182:183], v[182:183], v[16:17]
  v_pk_fma_f32 v[14:15], v[184:185], v[184:185], v[14:15]
  v_pk_fma_f32 v[16:17], v[186:187], v[186:187], v[16:17]
  v_pk_fma_f32 v[14:15], v[188:189], v[188:189], v[14:15]
  v_pk_fma_f32 v[16:17], v[190:191], v[190:191], v[16:17]
  v_pk_fma_f32 v[14:15], v[192:193], v[192:193], v[14:15]
  v_pk_fma_f32 v[16:17], v[194:195], v[194:195], v[16:17]
  v_pk_fma_f32 v[14:15], v[196:197], v[196:197], v[14:15]
  v_pk_fma_f32 v[16:17], v[198:199], v[198:199], v[16:17]
  v_pk_add_f32 v[18:19], v[14:15], v[16:17]
  v_add_f32 v18, v18, v19
  s_nop 1
  v_add_f32 v18, v18, v18 quad_perm:[1,0,3,2] row_mask:0xf bank_mask:0xf
  s_nop 1
  v_add_f32 v18, v18, v18 quad_perm:[2,3,0,1] row_mask:0xf bank_mask:0xf
  s_nop 1
  v_add_f32 v18, v18, v18 row_half_mirror row_mask:0xf bank_mask:0xf
  s_nop 1
  v_add_f32 v18, v18, v18 row_mirror row_mask:0xf bank_mask:0xf
  v_mov_b32 v14, 0x3727c5ac
  v_fmac_f32 v14, 0x3acccccd, v18
  v_rsq_f32 v14, v14
  s_nop 0
  v_mul_f32 v14, 0x3e0293ee, v14
  v_pk_mul_f32 v[160:161], v[160:161], v[14:15] op_sel_hi:[1,0]
  v_pk_mul_f32 v[162:163], v[162:163], v[14:15] op_sel_hi:[1,0]
  v_pk_mul_f32 v[164:165], v[164:165], v[14:15] op_sel_hi:[1,0]
  v_pk_mul_f32 v[166:167], v[166:167], v[14:15] op_sel_hi:[1,0]
  v_cvt_pk_bf16_f32 v128, v160, v161
  v_cvt_pk_bf16_f32 v129, v162, v163
  v_cvt_pk_bf16_f32 v130, v164, v165
  v_cvt_pk_bf16_f32 v131, v166, v167
  buffer_store_dwordx4 v[128:131], v13, s[32:35], s59 offen sc1
  s_add_u32 s59, s59, 1024
  v_pk_mul_f32 v[168:169], v[168:169], v[14:15] op_sel_hi:[1,0]
  v_pk_mul_f32 v[170:171], v[170:171], v[14:15] op_sel_hi:[1,0]
  v_pk_mul_f32 v[172:173], v[172:173], v[14:15] op_sel_hi:[1,0]
  v_pk_mul_f32 v[174:175], v[174:175], v[14:15] op_sel_hi:[1,0]
  v_cvt_pk_bf16_f32 v132, v168, v169
  v_cvt_pk_bf16_f32 v133, v170, v171
  v_cvt_pk_bf16_f32 v134, v172, v173
  v_cvt_pk_bf16_f32 v135, v174, v175
  buffer_store_dwordx4 v[132:135], v13, s[32:35], s59 offen sc1
  s_add_u32 s59, s59, 1024
  v_pk_mul_f32 v[176:177], v[176:177], v[14:15] op_sel_hi:[1,0]
  v_pk_mul_f32 v[178:179], v[178:179], v[14:15] op_sel_hi:[1,0]
  v_pk_mul_f32 v[180:181], v[180:181], v[14:15] op_sel_hi:[1,0]
  v_pk_mul_f32 v[182:183], v[182:183], v[14:15] op_sel_hi:[1,0]
  v_cvt_pk_bf16_f32 v136, v176, v177
  v_cvt_pk_bf16_f32 v137, v178, v179
  v_cvt_pk_bf16_f32 v138, v180, v181
  v_cvt_pk_bf16_f32 v139, v182, v183
  buffer_store_dwordx4 v[136:139], v13, s[32:35], s59 offen sc1
  s_add_u32 s59, s59, 1024
  v_pk_mul_f32 v[184:185], v[184:185], v[14:15] op_sel_hi:[1,0]
  v_pk_mul_f32 v[186:187], v[186:187], v[14:15] op_sel_hi:[1,0]
  v_pk_mul_f32 v[188:189], v[188:189], v[14:15] op_sel_hi:[1,0]
  v_pk_mul_f32 v[190:191], v[190:191], v[14:15] op_sel_hi:[1,0]
  v_cvt_pk_bf16_f32 v140, v184, v185
  v_cvt_pk_bf16_f32 v141, v186, v187
  v_cvt_pk_bf16_f32 v142, v188, v189
  v_cvt_pk_bf16_f32 v143, v190, v191
  buffer_store_dwordx4 v[140:143], v13, s[32:35], s59 offen sc1
  s_add_u32 s59, s59, 1024
  v_pk_mul_f32 v[192:193], v[192:193], v[14:15] op_sel_hi:[1,0]
  v_pk_mul_f32 v[194:195], v[194:195], v[14:15] op_sel_hi:[1,0]
  v_pk_mul_f32 v[196:197], v[196:197], v[14:15] op_sel_hi:[1,0]
  v_pk_mul_f32 v[198:199], v[198:199], v[14:15] op_sel_hi:[1,0]
  v_cvt_pk_bf16_f32 v144, v192, v193
  v_cvt_pk_bf16_f32 v145, v194, v195
  v_cvt_pk_bf16_f32 v146, v196, v197
  v_cvt_pk_bf16_f32 v147, v198, v199
  buffer_store_dwordx4 v[144:147], v13, s[32:35], s59 offen sc1
L_com:
  v_lshrrev_b32 v96, 4, v1
  v_bfe_u32 v97, v1, 2, 2
  v_and_b32 v98, 3, v1
  v_lshl_add_u32 v99, v96, 3, v97
  v_lshlrev_b32 v99, 8, v99
  v_lshl_add_u32 v99, v98, 4, v99
  v_xor_b32 v104, 0, v97
  v_lshl_add_u32 v104, v104, 6, v99
  v_xor_b32 v105, 1, v97
  v_lshl_add_u32 v105, v105, 6, v99
  v_xor_b32 v106, 2, v97
  v_lshl_add_u32 v106, v106, 6, v99
  v_xor_b32 v107, 3, v97
  v_lshl_add_u32 v107, v107, 6, v99
  v_and_b32 v100, 1, v96
  v_lshl_add_u32 v99, v100, 3, v97
  v_lshlrev_b32 v99, 7, v99
  v_lshl_add_u32 v99, v98, 3, v99
  v_lshrrev_b32 v96, 1, v96
  v_lshl_add_u32 v99, v96, 12, v99
  v_add_u32 v99, 65536, v99
  v_lshrrev_b32 v97, 1, v97
  v_lshl_add_u32 v100, v100, 1, v97
  s_and_b32 s3, s44, 9
  s_cmp_eq_u32 s3, 9
  s_cselect_b32 s3, 1, 0
  v_xor_b32 v108, s3, v100
  v_lshl_add_u32 v108, v108, 5, v99
  s_cselect_b32 s3, 2, 1
  v_xor_b32 v109, s3, v100
  v_lshl_add_u32 v109, v109, 5, v99
  s_cselect_b32 s3, 0, 2
  v_xor_b32 v110, s3, v100
  v_lshl_add_u32 v110, v110, 5, v99
  s_cselect_b32 s3, 1, 3
  v_xor_b32 v111, s3, v100
  v_lshl_add_u32 v111, v111, 5, v99
  v_and_b32 v96, 15, v1
  v_lshrrev_b32 v97, 4, v1
  v_xor_b32 v98, v96, v97
  v_xor_b32 v99, 0, v98
  v_lshlrev_b32 v99, 4, v99
  v_lshl_add_u32 v76, v96, 8, v99
  v_lshl_add_u32 v88, v97, 8, v99
  v_xor_b32 v99, 4, v98
  v_lshlrev_b32 v99, 4, v99
  v_lshl_add_u32 v77, v96, 8, v99
  v_lshl_add_u32 v89, v97, 8, v99
  v_xor_b32 v99, 8, v98
  v_lshlrev_b32 v99, 4, v99
  v_lshl_add_u32 v78, v96, 8, v99
  v_lshl_add_u32 v90, v97, 8, v99
  v_xor_b32 v99, 12, v98
  v_lshlrev_b32 v99, 4, v99
  v_lshl_add_u32 v79, v96, 8, v99
  v_lshl_add_u32 v91, v97, 8, v99
  v_lshrrev_b32 v99, 2, v1
  v_and_b32 v100, 3, v1
  v_lshlrev_b32 v100, 3, v100
  v_lshl_add_u32 v100, v99, 8, v100
  v_add_u32 v100, 65536, v100
  v_and_b32 v99, 7, v99
  v_xor_b32 v80, 0, v99
  v_lshl_add_u32 v80, v80, 5, v100
  v_xor_b32 v81, 1, v99
  v_lshl_add_u32 v81, v81, 5, v100
  v_xor_b32 v82, 2, v99
  v_lshl_add_u32 v82, v82, 5, v100
  v_xor_b32 v83, 3, v99
  v_lshl_add_u32 v83, v83, 5, v100
  v_xor_b32 v84, 4, v99
  v_lshl_add_u32 v84, v84, 5, v100
  v_xor_b32 v85, 5, v99
  v_lshl_add_u32 v85, v85, 5, v100
  v_xor_b32 v86, 6, v99
  v_lshl_add_u32 v86, v86, 5, v100
  v_xor_b32 v87, 7, v99
  v_lshl_add_u32 v87, v87, 5, v100
  v_add_u32 v99, 0, v97
  v_lshlrev_b32 v99, 1, v99
  v_xor_b32 v99, v99, v96
  v_lshlrev_b32 v99, 4, v99
  v_lshl_add_u32 v92, v97, 8, v99
  v_mul_u32_u24 v100, 1280, v97
  v_add_u32 v72, v100, v99
  v_add_u32 v99, 4, v97
  v_lshlrev_b32 v99, 1, v99
  v_xor_b32 v99, v99, v96
  v_lshlrev_b32 v99, 4, v99
  v_lshl_add_u32 v93, v97, 8, v99
  v_mul_u32_u24 v100, 1280, v97
  v_add_u32 v73, v100, v99
  v_and_b32 v99, 2, v1
  v_cmp_eq_u32 vcc, 0, v99
  v_mov_b32 v100, 0x3f803f80
  s_nop 0
  v_cndmask_b32 v4, 0, v100, vcc
  v_cndmask_b32 v5, 0, v100, vcc
  v_cndmask_b32 v6, 0, v100, vcc
  v_cndmask_b32 v7, 0, v100, vcc
  v_mov_b32 v119, v3
  v_add_u32 v120, 61440, v3
  v_add_u32 v121, 122880, v3
  v_and_b32 v122, 3, v1
  v_lshlrev_b32 v122, 2, v122
  s_getpc_b64 s[4:5]
L_pc2:
  s_lshr_b32 s3, s2, 3
  v_lshrrev_b32 v2, 5, v0
  v_lshlrev_b32 v2, 12, v2
  v_lshl_add_u32 v2, s3, 7, v2
  s_bitcmp1_b32 s44, 3
  s_cselect_b32 s3, 0, L_post0-L_post1
  v_add_u32 v2, L_post1-L_pc2, v2
  v_add_u32 v2, s3, v2
  v_min_u32 v2, L_slow-L_pc2, v2
  v_mov_b32 v127, s5
  v_add_co_u32 v126, vcc, s4, v2
  s_nop 1
  v_addc_co_u32 v127, vcc, 0, v127, vcc
  s_add_u32 s40, s40, 524288
  s_add_u32 s41, s41, 221184
  v_mov_b32 v96, -1
  v_accvgpr_write_b32 a32, v96
  v_accvgpr_write_b32 a33, v96
  v_accvgpr_write_b32 a34, v96
  v_accvgpr_write_b32 a35, v96
  s_and_b32 s3, s44, 8
  s_add_u32 s3, s3, s43
  s_mov_b64 exec, 0
  s_cmp_eq_u32 s3, 2
  s_cbranch_scc1 L_pad_proj02_0
  s_cmp_eq_u32 s3, 10
  s_cbranch_scc1 L_pad_proj12_0
  s_cmp_eq_u32 s43, 3
  s_cbranch_scc1 L_pad_fm3_0
L_back0:
  s_mov_b64 exec, -1
  s_cmp_eq_u32 s43, 2
  s_cbranch_scc1 L_bar1
  s_waitcnt vmcnt(16)
  v_add_u32 v20, 0x9e3779b9, v20
  v_add_u32 v21, 0x7f4a7c15, v21
  s_cmp_eq_u32 s43, 3
  s_cbranch_scc1 L_bar1
  s_waitcnt vmcnt(0)
L_bar1:
  s_barrier
  s_cbranch_scc1 L_w1
  buffer_store_dwordx2 v[20:21], v24, s[32:35], s84 offen sc1
  s_and_b32 s3, s43, 2
  s_lshl_b32 s19, s3, 12
  s_sub_u32 s19, s18, s19
  s_lshl_b32 s56, s3, 17
  s_sub_u32 s56, s40, s56
  s_mul_i32 s57, s3, 55296
  s_sub_u32 s57, s41, s57
  s_add_u32 m0, s19, 49152
  s_nop 0
  buffer_load_dwordx4 v112, s[20:23], s56 offen offset:0 lds
  s_add_u32 s56, s56, 31744
  buffer_load_dwordx4 v112, s[20:23], s56 offen offset:1024 lds
  s_add_u32 s56, s56, 31744
  buffer_load_dwordx4 v112, s[20:23], s56 offen offset:2048 lds
  s_add_u32 s56, s56, 31744
  buffer_load_dwordx4 v112, s[20:23], s56 offen offset:3072 lds
  s_add_u32 m0, s19, 65536
  s_nop 0
  buffer_load_dwordx4 v113, s[24:27], s57 offen offset:0 lds
  buffer_load_dwordx4 v114, s[24:27], s57 offen offset:1024 lds
  s_add_u32 m0, s19, 67584
  s_nop 0
  buffer_load_dwordx4 v113, s[28:31], s57 offen offset:0 lds
  buffer_load_dwordx4 v114, s[28:31], s57 offen offset:1024 lds
  s_add_u32 s19, s19, 8192
  s_add_u32 m0, s19, 49152
  s_add_u32 s56, s56, 166912
  buffer_load_dwordx4 v112, s[20:23], s56 offen offset:0 lds
  s_add_u32 s56, s56, 31744
  buffer_load_dwordx4 v112, s[20:23], s56 offen offset:1024 lds
  s_add_u32 s56, s56, 31744
  buffer_load_dwordx4 v112, s[20:23], s56 offen offset:2048 lds
  s_add_u32 s56, s56, 31744
  buffer_load_dwordx4 v112, s[20:23], s56 offen offset:3072 lds
  s_add_u32 m0, s19, 65536
  s_add_u32 s57, s57, 110592
  buffer_load_dwordx4 v113, s[24:27], s57 offen offset:0 lds
  buffer_load_dwordx4 v114, s[24:27], s57 offen offset:1024 lds
  s_add_u32 m0, s19, 67584
  s_nop 0
  buffer_load_dwordx4 v113, s[28:31], s57 offen offset:0 lds
  buffer_load_dwordx4 v114, s[28:31], s57 offen offset:1024 lds
L_w1:
  s_and_b32 s3, s45, 4
  s_sub_u32 s83, 10, s3
  s_mul_i32 s87, s3, 512
  s_add_u32 s87, s87, 512
  s_add_u32 s82, s82, 1024
  s_add_u32 s80, s80, 1048576
  s_add_u32 s81, s81, 442368
  s_lshl_b32 s59, s3, 19
  s_add_u32 s40, s40, s59
  s_mul_i32 s59, s3, 221184
  s_add_u32 s41, s41, s59
  s_add_u32 s40, s40, 95232
  s_lshl_b32 s57, s2, 2
  s_add_u32 s57, s57, s43
  s_mul_hi_u32 s19, s57, 858993460
  s_mul_i32 s59, s19, 5
  s_sub_u32 s59, s57, s59
  s_lshl_b32 s57, s57, 13
  s_lshl_b32 s59, s59, 8
  s_mov_b32 s6, 2211840
  s_cmp_ge_u32 s19, 54
  s_cselect_b32 s4, s100, s98
  s_cselect_b32 s5, s101, s99
  s_cselect_b32 s6, 5242880, s6
  s_cselect_b32 s56, 54, 0
  s_sub_u32 s19, s19, s56
  s_mul_i32 s56, s19, 40960
  s_add_u32 s56, s56, s59
  s_lshl_b32 s100, s43, 13
  s_add_u32 s101, s100, 65536
  s_bfe_u32 s98, s44, 0x10002
  s_lshr_b32 s3, s44, 4
  s_lshl1_add_u32 s98, s98, s3
  v_bfe_u32 v96, v1, 2, 2
  v_mul_u32_u24 v96, 5120, v96
  v_lshrrev_b32 v74, 4, v1
  v_lshl_add_u32 v96, v74, 6, v96
  v_and_b32 v74, 3, v1
  v_lshl_add_u32 v96, v74, 4, v96
  s_xor_b32 s3, s98, 0
  s_mul_i32 s3, s3, 20480
  v_add_u32 v100, s3, v96
  s_xor_b32 s3, s98, 1
  s_mul_i32 s3, s3, 20480
  v_add_u32 v101, s3, v96
  s_xor_b32 s3, s98, 2
  s_mul_i32 s3, s3, 20480
  v_add_u32 v102, s3, v96
  s_xor_b32 s3, s98, 3
  s_mul_i32 s3, s3, 20480
  v_add_u32 v103, s3, v96
  s_cmp_lt_u32 s43, 2
  s_cbranch_scc1 L_walk
  s_cmp_lg_u32 s43, 3
  s_cbranch_scc1 L_lw3
  s_mov_b32 s59, 65536
L_lw2:
  buffer_load_dwordx2 v[22:23], v123, s[32:35], s85 offen offset:128 sc1
  s_sub_u32 s59, s59, 1
  s_waitcnt vmcnt(0)
  v_cmp_ne_u64 vcc, v[20:21], v[22:23]
  s_cmp_eq_u32 s59, 0
  s_cbranch_scc1 L_lw2_ok
  s_cbranch_vccnz L_lw2
L_lw2_ok:
  s_cmp_lg_u32 s44, 0
  s_cbranch_scc1 L_bar2
  buffer_store_dwordx2 v[20:21], v125, s[32:35], s85 offen sc1
  s_branch L_bar2
L_lw3:
  s_waitcnt vmcnt(0)
L_walk:
  s_and_b32 s3, s44, 8
  s_add_u32 s3, s3, s43
  s_mov_b64 exec, 0
  s_cmp_eq_u32 s3, 8
  s_cbranch_scc1 L_pad_post10_0
  s_cmp_eq_u32 s3, 9
  s_cbranch_scc1 L_pad_post11_0
  s_cmp_eq_u32 s3, 10
  s_cbranch_scc1 L_pad_post12_0
  s_cmp_eq_u32 s3, 0
  s_cbranch_scc1 L_pad_post00_0
  s_cmp_eq_u32 s3, 1
  s_cbranch_scc1 L_pad_post01_0
  s_cmp_eq_u32 s3, 2
  s_cbranch_scc1 L_pad_post02_0
L_back1:
  s_mov_b64 exec, -1
L_bar2:
  s_barrier
  buffer_load_dwordx4 a[128:131], v100, s[32:35], s42 offen offset:0 sc1
  buffer_load_dwordx4 a[132:135], v100, s[32:35], s42 offen offset:256 sc1
  buffer_load_dwordx4 a[136:139], v101, s[32:35], s42 offen offset:0 sc1
  buffer_load_dwordx4 a[140:143], v101, s[32:35], s42 offen offset:256 sc1
  buffer_load_dwordx4 a[144:147], v102, s[32:35], s42 offen offset:0 sc1
  buffer_load_dwordx4 a[148:151], v102, s[32:35], s42 offen offset:256 sc1
  buffer_load_dwordx4 a[152:155], v103, s[32:35], s42 offen offset:0 sc1
  buffer_load_dwordx4 a[156:159], v103, s[32:35], s42 offen offset:256 sc1
  ds_read_b64_tr_b16 a[192:193], v108 offset:16384
  ds_read_b64_tr_b16 a[194:195], v108 offset:16896
  ds_read_b64_tr_b16 a[196:197], v108 offset:24576
  ds_read_b64_tr_b16 a[198:199], v108 offset:25088
  ds_read_b64_tr_b16 a[200:201], v108 offset:18432
  ds_read_b64_tr_b16 a[202:203], v108 offset:18944
  ds_read_b64_tr_b16 a[204:205], v108 offset:26624
  ds_read_b64_tr_b16 a[206:207], v108 offset:27136
  buffer_store_dword v124, v125, s[32:35], s96 offen offset:0 sc1
  s_bitcmp1_b32 s44, 3
  s_cbranch_scc1 L_proj1
  s_branch L_proj0
L_out:
  s_endpgm
.p2align 12
L_proj0:
  s_waitcnt vmcnt(7)
  s_waitcnt lgkmcnt(4)
  v_mfma_f32_16x16x32_bf16 v[8:11], a[192:195], a[128:131], 0
L_pad_proj02_0:
  s_cbranch_execz L_pad_proj02_1
  ds_read_b64_tr_b16 a[208:209], v109 offset:16384
  v_mfma_f32_16x16x32_bf16 v[8:11], a[196:199], a[132:135], v[8:11]
  s_waitcnt vmcnt(5)
  v_mfma_f32_16x16x32_bf16 v[16:19], a[196:199], a[140:143], 0
  ds_read_b64_tr_b16 a[210:211], v109 offset:16896
  v_mfma_f32_16x16x32_bf16 v[16:19], a[192:195], a[136:139], v[16:19]
  s_waitcnt vmcnt(3)
  v_mfma_f32_16x16x32_bf16 v[24:27], a[192:195], a[144:147], 0
  ds_read_b64_tr_b16 a[212:213], v109 offset:24576
  v_mfma_f32_16x16x32_bf16 v[24:27], a[196:199], a[148:151], v[24:27]
  s_waitcnt vmcnt(1)
  s_add_u32 s42, s42, 512
  v_mfma_f32_16x16x32_bf16 v[32:35], a[196:199], a[156:159], 0
  ds_read_b64_tr_b16 a[214:215], v109 offset:25088
  v_mfma_f32_16x16x32_bf16 v[32:35], a[192:195], a[152:155], v[32:35]
  s_waitcnt lgkmcnt(4)
  buffer_load_dwordx4 a[160:163], v100, s[32:35], s42 offen offset:0 sc1
  v_mfma_f32_16x16x32_bf16 a[88:91], a[200:203], a[152:155], 0
  ds_read_b64_tr_b16 a[216:217], v109 offset:18432
  v_mfma_f32_16x16x32_bf16 a[88:91], a[204:207], a[156:159], a[88:91]
  v_mfma_f32_16x16x32_bf16 a[80:83], a[204:207], a[148:151], 0
  ds_read_b64_tr_b16 a[218:219], v109 offset:18944
  v_mfma_f32_16x16x32_bf16 a[80:83], a[200:203], a[144:147], a[80:83]
  buffer_load_dwordx4 a[164:167], v100, s[32:35], s42 offen offset:256 sc1
  v_mfma_f32_16x16x32_bf16 a[72:75], a[200:203], a[136:139], 0
  ds_read_b64_tr_b16 a[220:221], v109 offset:26624
  v_mfma_f32_16x16x32_bf16 a[72:75], a[204:207], a[140:143], a[72:75]
  v_mfma_f32_16x16x32_bf16 a[64:67], a[204:207], a[132:135], 0
  ds_read_b64_tr_b16 a[222:223], v109 offset:27136
  v_mfma_f32_16x16x32_bf16 a[64:67], a[200:203], a[128:131], a[64:67]
  s_waitcnt lgkmcnt(4)
  v_mfma_f32_16x16x32_bf16 v[12:15], a[208:211], a[128:131], 0
  ds_read_b64_tr_b16 a[192:193], v110 offset:16384
  v_mfma_f32_16x16x32_bf16 v[12:15], a[212:215], a[132:135], v[12:15]
  buffer_load_dwordx4 a[168:171], v101, s[32:35], s42 offen offset:0 sc1
  v_mfma_f32_16x16x32_bf16 v[20:23], a[212:215], a[140:143], 0
  ds_read_b64_tr_b16 a[194:195], v110 offset:16896
  v_mfma_f32_16x16x32_bf16 v[20:23], a[208:211], a[136:139], v[20:23]
  v_mfma_f32_16x16x32_bf16 v[28:31], a[208:211], a[144:147], 0
  ds_read_b64_tr_b16 a[196:197], v110 offset:24576
  v_mfma_f32_16x16x32_bf16 v[28:31], a[212:215], a[148:151], v[28:31]
  v_mfma_f32_16x16x32_bf16 v[36:39], a[212:215], a[156:159], 0
  ds_read_b64_tr_b16 a[198:199], v110 offset:25088
  v_mfma_f32_16x16x32_bf16 v[36:39], a[208:211], a[152:155], v[36:39]
  s_waitcnt lgkmcnt(4)
  buffer_load_dwordx4 a[172:175], v101, s[32:35], s42 offen offset:256 sc1
  v_mfma_f32_16x16x32_bf16 a[92:95], a[216:219], a[152:155], 0
  ds_read_b64_tr_b16 a[200:201], v110 offset:18432
  v_mfma_f32_16x16x32_bf16 a[92:95], a[220:223], a[156:159], a[92:95]
  v_mfma_f32_16x16x32_bf16 a[84:87], a[220:223], a[148:151], 0
  ds_read_b64_tr_b16 a[202:203], v110 offset:18944
  v_mfma_f32_16x16x32_bf16 a[84:87], a[216:219], a[144:147], a[84:87]
  v_mfma_f32_16x16x32_bf16 a[76:79], a[216:219], a[136:139], 0
  ds_read_b64_tr_b16 a[204:205], v110 offset:26624
  v_mfma_f32_16x16x32_bf16 a[76:79], a[220:223], a[140:143], a[76:79]
  buffer_load_dwordx4 a[176:179], v102, s[32:35], s42 offen offset:0 sc1
  v_mfma_f32_16x16x32_bf16 a[68:71], a[220:223], a[132:135], 0
  ds_read_b64_tr_b16 a[206:207], v110 offset:27136
  v_mfma_f32_16x16x32_bf16 a[68:71], a[216:219], a[128:131], a[68:71]
  s_waitcnt lgkmcnt(4)
  v_mfma_f32_16x16x32_bf16 v[40:43], a[192:195], a[128:131], 0
  ds_read_b64_tr_b16 a[208:209], v111 offset:16384
  v_mfma_f32_16x16x32_bf16 v[40:43], a[196:199], a[132:135], v[40:43]
  v_mfma_f32_16x16x32_bf16 v[48:51], a[196:199], a[140:143], 0
  ds_read_b64_tr_b16 a[210:211], v111 offset:16896
  v_mfma_f32_16x16x32_bf16 v[48:51], a[192:195], a[136:139], v[48:51]
  buffer_load_dwordx4 a[180:183], v102, s[32:35], s42 offen offset:256 sc1
  v_mfma_f32_16x16x32_bf16 v[56:59], a[192:195], a[144:147], 0
  ds_read_b64_tr_b16 a[212:213], v111 offset:24576
  v_mfma_f32_16x16x32_bf16 v[56:59], a[196:199], a[148:151], v[56:59]
  v_mfma_f32_16x16x32_bf16 v[64:67], a[196:199], a[156:159], 0
  ds_read_b64_tr_b16 a[214:215], v111 offset:25088
  v_mfma_f32_16x16x32_bf16 v[64:67], a[192:195], a[152:155], v[64:67]
  s_waitcnt lgkmcnt(4)
  v_mfma_f32_16x16x32_bf16 a[120:123], a[200:203], a[152:155], 0
  ds_read_b64_tr_b16 a[216:217], v111 offset:18432
  v_mfma_f32_16x16x32_bf16 a[120:123], a[204:207], a[156:159], a[120:123]
  buffer_load_dwordx4 a[184:187], v103, s[32:35], s42 offen offset:0 sc1
  v_mfma_f32_16x16x32_bf16 a[112:115], a[204:207], a[148:151], 0
  ds_read_b64_tr_b16 a[218:219], v111 offset:18944
  v_mfma_f32_16x16x32_bf16 a[112:115], a[200:203], a[144:147], a[112:115]
  v_mfma_f32_16x16x32_bf16 a[104:107], a[200:203], a[136:139], 0
  ds_read_b64_tr_b16 a[220:221], v111 offset:26624
  v_mfma_f32_16x16x32_bf16 a[104:107], a[204:207], a[140:143], a[104:107]
  v_mfma_f32_16x16x32_bf16 a[96:99], a[204:207], a[132:135], 0
  ds_read_b64_tr_b16 a[222:223], v111 offset:27136
  v_mfma_f32_16x16x32_bf16 a[96:99], a[200:203], a[128:131], a[96:99]
  s_waitcnt lgkmcnt(4)
  buffer_load_dwordx4 a[188:191], v103, s[32:35], s42 offen offset:256 sc1
  v_mfma_f32_16x16x32_bf16 v[44:47], a[208:211], a[128:131], 0
  ds_read_b64_tr_b16 a[192:193], v107 offset:32768
  v_mfma_f32_16x16x32_bf16 v[44:47], a[212:215], a[132:135], v[44:47]
  v_mfma_f32_16x16x32_bf16 v[52:55], a[212:215], a[140:143], 0
  s_add_u32 m0, s18, 0
  ds_read_b64_tr_b16 a[194:195], v107 offset:33792
  v_mfma_f32_16x16x32_bf16 v[52:55], a[208:211], a[136:139], v[52:55]
  s_add_u32 s40, s40, 429056
  v_mfma_f32_16x16x32_bf16 v[60:63], a[208:211], a[144:147], 0
  ds_read_b64_tr_b16 a[196:197], v107 offset:40960
  v_mfma_f32_16x16x32_bf16 v[60:63], a[212:215], a[148:151], v[60:63]
  buffer_load_dwordx4 v112, s[20:23], s40 offen offset:0 lds
  v_mfma_f32_16x16x32_bf16 v[68:71], a[212:215], a[156:159], 0
  ds_read_b64_tr_b16 a[198:199], v107 offset:41984
  v_mfma_f32_16x16x32_bf16 v[68:71], a[208:211], a[152:155], v[68:71]
  s_waitcnt lgkmcnt(4)
  v_mfma_f32_16x16x32_bf16 a[124:127], a[216:219], a[152:155], 0
  ds_read_b64_tr_b16 a[200:201], v107 offset:32776
  v_mfma_f32_16x16x32_bf16 a[124:127], a[220:223], a[156:159], a[124:127]
  s_add_u32 s40, s40, 31744
  v_mfma_f32_16x16x32_bf16 a[116:119], a[220:223], a[148:151], 0
  ds_read_b64_tr_b16 a[202:203], v107 offset:33800
  v_mfma_f32_16x16x32_bf16 a[116:119], a[216:219], a[144:147], a[116:119]
  buffer_load_dwordx4 v112, s[20:23], s40 offen offset:1024 lds
  v_mfma_f32_16x16x32_bf16 a[108:111], a[216:219], a[136:139], 0
  ds_read_b64_tr_b16 a[204:205], v107 offset:40968
  v_mfma_f32_16x16x32_bf16 a[108:111], a[220:223], a[140:143], a[108:111]
  v_mfma_f32_16x16x32_bf16 a[100:103], a[220:223], a[132:135], 0
  ds_read_b64_tr_b16 a[206:207], v107 offset:41992
  v_mfma_f32_16x16x32_bf16 a[100:103], a[216:219], a[128:131], a[100:103]
  s_waitcnt lgkmcnt(4)
  s_add_u32 s40, s40, 31744
  v_mfma_f32_16x16x32_bf16 v[224:227], a[192:195], a[128:131], 0
  ds_read_b64_tr_b16 a[208:209], v106 offset:32768
  v_mfma_f32_16x16x32_bf16 v[224:227], a[196:199], a[132:135], v[224:227]
  buffer_load_dwordx4 v112, s[20:23], s40 offen offset:2048 lds
  v_mfma_f32_16x16x32_bf16 v[232:235], a[196:199], a[140:143], 0
  ds_read_b64_tr_b16 a[210:211], v106 offset:33792
  v_mfma_f32_16x16x32_bf16 v[232:235], a[192:195], a[136:139], v[232:235]
  s_add_u32 s40, s40, 31744
  v_mfma_f32_16x16x32_bf16 v[240:243], a[192:195], a[144:147], 0
  ds_read_b64_tr_b16 a[212:213], v106 offset:40960
  v_mfma_f32_16x16x32_bf16 v[240:243], a[196:199], a[148:151], v[240:243]
  buffer_load_dwordx4 v112, s[20:23], s40 offen offset:3072 lds
  v_mfma_f32_16x16x32_bf16 v[248:251], a[196:199], a[156:159], 0
  ds_read_b64_tr_b16 a[214:215], v106 offset:41984
  v_mfma_f32_16x16x32_bf16 v[248:251], a[192:195], a[152:155], v[248:251]
  s_waitcnt lgkmcnt(4)
  v_mfma_f32_16x16x32_bf16 v[252:255], a[200:203], a[152:155], 0
  s_add_u32 m0, s18, 114688
  ds_read_b64_tr_b16 a[216:217], v106 offset:32776
  v_mfma_f32_16x16x32_bf16 v[252:255], a[204:207], a[156:159], v[252:255]
  s_add_u32 s41, s41, 221184
  v_mfma_f32_16x16x32_bf16 v[244:247], a[204:207], a[148:151], 0
  ds_read_b64_tr_b16 a[218:219], v106 offset:33800
  v_mfma_f32_16x16x32_bf16 v[244:247], a[200:203], a[144:147], v[244:247]
  buffer_load_dwordx4 v113, s[24:27], s41 offen offset:0 lds
  v_mfma_f32_16x16x32_bf16 v[236:239], a[200:203], a[136:139], 0
  ds_read_b64_tr_b16 a[220:221], v106 offset:40968
  v_mfma_f32_16x16x32_bf16 v[236:239], a[204:207], a[140:143], v[236:239]
  v_mfma_f32_16x16x32_bf16 v[228:231], a[204:207], a[132:135], 0
  ds_read_b64_tr_b16 a[222:223], v106 offset:41992
  v_mfma_f32_16x16x32_bf16 v[228:231], a[200:203], a[128:131], v[228:231]
  s_waitcnt lgkmcnt(4)
  v_mfma_f32_16x16x32_bf16 v[192:195], a[208:211], a[128:131], 0
  ds_read_b64_tr_b16 a[192:193], v105 offset:32768
  v_mfma_f32_16x16x32_bf16 v[192:195], a[212:215], a[132:135], v[192:195]
  buffer_load_dwordx4 v114, s[24:27], s41 offen offset:1024 lds
  v_mfma_f32_16x16x32_bf16 v[200:203], a[212:215], a[140:143], 0
  ds_read_b64_tr_b16 a[194:195], v105 offset:33792
  v_mfma_f32_16x16x32_bf16 v[200:203], a[208:211], a[136:139], v[200:203]
  v_mfma_f32_16x16x32_bf16 v[208:211], a[208:211], a[144:147], 0
  ds_read_b64_tr_b16 a[196:197], v105 offset:40960
  v_mfma_f32_16x16x32_bf16 v[208:211], a[212:215], a[148:151], v[208:211]
  s_add_u32 m0, s18, 116736
  v_mfma_f32_16x16x32_bf16 v[216:219], a[212:215], a[156:159], 0
  ds_read_b64_tr_b16 a[198:199], v105 offset:41984
  v_mfma_f32_16x16x32_bf16 v[216:219], a[208:211], a[152:155], v[216:219]
  s_waitcnt lgkmcnt(4)
  buffer_load_dwordx4 v113, s[28:31], s41 offen offset:0 lds
  v_mfma_f32_16x16x32_bf16 v[220:223], a[216:219], a[152:155], 0
  ds_read_b64_tr_b16 a[200:201], v105 offset:32776
  v_mfma_f32_16x16x32_bf16 v[220:223], a[220:223], a[156:159], v[220:223]
  v_mfma_f32_16x16x32_bf16 v[212:215], a[220:223], a[148:151], 0
  ds_read_b64_tr_b16 a[202:203], v105 offset:33800
  v_mfma_f32_16x16x32_bf16 v[212:215], a[216:219], a[144:147], v[212:215]
  v_mfma_f32_16x16x32_bf16 v[204:207], a[216:219], a[136:139], 0
  ds_read_b64_tr_b16 a[204:205], v105 offset:40968
  v_mfma_f32_16x16x32_bf16 v[204:207], a[220:223], a[140:143], v[204:207]
  buffer_load_dwordx4 v114, s[28:31], s41 offen offset:1024 lds
  v_mfma_f32_16x16x32_bf16 v[196:199], a[220:223], a[132:135], 0
  ds_read_b64_tr_b16 a[206:207], v105 offset:41992
  v_mfma_f32_16x16x32_bf16 v[196:199], a[216:219], a[128:131], v[196:199]
  s_waitcnt lgkmcnt(4)
  v_mfma_f32_16x16x32_bf16 v[160:163], a[192:195], a[128:131], 0
  ds_read_b64_tr_b16 a[208:209], v104 offset:32768
  v_mfma_f32_16x16x32_bf16 v[160:163], a[196:199], a[132:135], v[160:163]
  v_mfma_f32_16x16x32_bf16 v[168:171], a[196:199], a[140:143], 0
  ds_read_b64_tr_b16 a[210:211], v104 offset:33792
  v_mfma_f32_16x16x32_bf16 v[168:171], a[192:195], a[136:139], v[168:171]
  v_mfma_f32_16x16x32_bf16 v[176:179], a[192:195], a[144:147], 0
  ds_read_b64_tr_b16 a[212:213], v104 offset:40960
  v_mfma_f32_16x16x32_bf16 v[176:179], a[196:199], a[148:151], v[176:179]
  v_mfma_f32_16x16x32_bf16 v[184:187], a[196:199], a[156:159], 0
  ds_read_b64_tr_b16 a[214:215], v104 offset:41984
  v_mfma_f32_16x16x32_bf16 v[184:187], a[192:195], a[152:155], v[184:187]
  s_waitcnt lgkmcnt(4)
  v_mfma_f32_16x16x32_bf16 v[188:191], a[200:203], a[152:155], 0
  ds_read_b64_tr_b16 a[216:217], v104 offset:32776
  v_mfma_f32_16x16x32_bf16 v[188:191], a[204:207], a[156:159], v[188:191]
  v_mfma_f32_16x16x32_bf16 v[180:183], a[204:207], a[148:151], 0
  ds_read_b64_tr_b16 a[218:219], v104 offset:33800
  v_mfma_f32_16x16x32_bf16 v[180:183], a[200:203], a[144:147], v[180:183]
  v_mfma_f32_16x16x32_bf16 v[172:175], a[200:203], a[136:139], 0
  ds_read_b64_tr_b16 a[220:221], v104 offset:40968
  v_mfma_f32_16x16x32_bf16 v[172:175], a[204:207], a[140:143], v[172:175]
  v_mfma_f32_16x16x32_bf16 v[164:167], a[204:207], a[132:135], 0
  ds_read_b64_tr_b16 a[222:223], v104 offset:41992
  v_mfma_f32_16x16x32_bf16 v[164:167], a[200:203], a[128:131], v[164:167]
  s_waitcnt lgkmcnt(4)
  s_barrier
  v_mfma_f32_16x16x32_bf16 v[128:131], a[208:211], a[128:131], 0
  ds_read_b64_tr_b16 a[192:193], v108 offset:0
  v_mfma_f32_16x16x32_bf16 v[128:131], a[212:215], a[132:135], v[128:131]
  v_mfma_f32_16x16x32_bf16 v[136:139], a[212:215], a[140:143], 0
  ds_read_b64_tr_b16 a[194:195], v108 offset:512
  v_mfma_f32_16x16x32_bf16 v[136:139], a[208:211], a[136:139], v[136:139]
  v_mfma_f32_16x16x32_bf16 v[144:147], a[208:211], a[144:147], 0
  ds_read_b64_tr_b16 a[196:197], v108 offset:8192
  v_mfma_f32_16x16x32_bf16 v[144:147], a[212:215], a[148:151], v[144:147]
  v_mfma_f32_16x16x32_bf16 v[152:155], a[212:215], a[156:159], 0
  ds_read_b64_tr_b16 a[198:199], v108 offset:8704
  v_mfma_f32_16x16x32_bf16 v[152:155], a[208:211], a[152:155], v[152:155]
  s_waitcnt lgkmcnt(4)
  v_mfma_f32_16x16x32_bf16 v[156:159], a[216:219], a[152:155], 0
  ds_read_b64_tr_b16 a[200:201], v108 offset:2048
  v_mfma_f32_16x16x32_bf16 v[156:159], a[220:223], a[156:159], v[156:159]
  v_mfma_f32_16x16x32_bf16 v[148:151], a[220:223], a[148:151], 0
  ds_read_b64_tr_b16 a[202:203], v108 offset:2560
  v_mfma_f32_16x16x32_bf16 v[148:151], a[216:219], a[144:147], v[148:151]
  v_mfma_f32_16x16x32_bf16 v[140:143], a[216:219], a[136:139], 0
  ds_read_b64_tr_b16 a[204:205], v108 offset:10240
  v_mfma_f32_16x16x32_bf16 v[140:143], a[220:223], a[140:143], v[140:143]
  s_waitcnt vmcnt(8)
  v_mfma_f32_16x16x32_bf16 v[132:135], a[220:223], a[132:135], 0
  ds_read_b64_tr_b16 a[206:207], v108 offset:10752
  v_mfma_f32_16x16x32_bf16 v[132:135], a[216:219], a[128:131], v[132:135]
  s_waitcnt lgkmcnt(4)
  v_mfma_f32_16x16x32_bf16 v[8:11], a[192:195], a[160:163], v[8:11]
  ds_read_b64_tr_b16 a[208:209], v109 offset:0
  v_mfma_f32_16x16x32_bf16 v[8:11], a[196:199], a[164:167], v[8:11]
  v_mfma_f32_16x16x32_bf16 v[16:19], a[196:199], a[172:175], v[16:19]
  ds_read_b64_tr_b16 a[210:211], v109 offset:512
  v_mfma_f32_16x16x32_bf16 v[16:19], a[192:195], a[168:171], v[16:19]
  v_mfma_f32_16x16x32_bf16 v[24:27], a[192:195], a[176:179], v[24:27]
  ds_read_b64_tr_b16 a[212:213], v109 offset:8192
  v_mfma_f32_16x16x32_bf16 v[24:27], a[196:199], a[180:183], v[24:27]
  s_add_u32 s42, s42, s87
  v_mfma_f32_16x16x32_bf16 v[32:35], a[196:199], a[188:191], v[32:35]
  ds_read_b64_tr_b16 a[214:215], v109 offset:8704
  v_mfma_f32_16x16x32_bf16 v[32:35], a[192:195], a[184:187], v[32:35]
  s_waitcnt lgkmcnt(4)
  buffer_load_dwordx4 a[128:131], v100, s[32:35], s42 offen offset:0 sc1
  v_mfma_f32_16x16x32_bf16 a[88:91], a[200:203], a[184:187], a[88:91]
  ds_read_b64_tr_b16 a[216:217], v109 offset:2048
  v_mfma_f32_16x16x32_bf16 a[88:91], a[204:207], a[188:191], a[88:91]
  v_mfma_f32_16x16x32_bf16 a[80:83], a[204:207], a[180:183], a[80:83]
  ds_read_b64_tr_b16 a[218:219], v109 offset:2560
  v_mfma_f32_16x16x32_bf16 a[80:83], a[200:203], a[176:179], a[80:83]
  buffer_load_dwordx4 a[132:135], v100, s[32:35], s42 offen offset:256 sc1
  v_mfma_f32_16x16x32_bf16 a[72:75], a[200:203], a[168:171], a[72:75]
  ds_read_b64_tr_b16 a[220:221], v109 offset:10240
  v_mfma_f32_16x16x32_bf16 a[72:75], a[204:207], a[172:175], a[72:75]
  v_mfma_f32_16x16x32_bf16 a[64:67], a[204:207], a[164:167], a[64:67]
  ds_read_b64_tr_b16 a[222:223], v109 offset:10752
  v_mfma_f32_16x16x32_bf16 a[64:67], a[200:203], a[160:163], a[64:67]
  s_waitcnt lgkmcnt(4)
  v_mfma_f32_16x16x32_bf16 v[12:15], a[208:211], a[160:163], v[12:15]
  ds_read_b64_tr_b16 a[192:193], v110 offset:0
  v_mfma_f32_16x16x32_bf16 v[12:15], a[212:215], a[164:167], v[12:15]
  buffer_load_dwordx4 a[136:139], v101, s[32:35], s42 offen offset:0 sc1
  v_mfma_f32_16x16x32_bf16 v[20:23], a[212:215], a[172:175], v[20:23]
  ds_read_b64_tr_b16 a[194:195], v110 offset:512
  v_mfma_f32_16x16x32_bf16 v[20:23], a[208:211], a[168:171], v[20:23]
  v_mfma_f32_16x16x32_bf16 v[28:31], a[208:211], a[176:179], v[28:31]
  ds_read_b64_tr_b16 a[196:197], v110 offset:8192
  v_mfma_f32_16x16x32_bf16 v[28:31], a[212:215], a[180:183], v[28:31]
  v_mfma_f32_16x16x32_bf16 v[36:39], a[212:215], a[188:191], v[36:39]
  ds_read_b64_tr_b16 a[198:199], v110 offset:8704
  v_mfma_f32_16x16x32_bf16 v[36:39], a[208:211], a[184:187], v[36:39]
  s_waitcnt lgkmcnt(4)
  buffer_load_dwordx4 a[140:143], v101, s[32:35], s42 offen offset:256 sc1
  v_mfma_f32_16x16x32_bf16 a[92:95], a[216:219], a[184:187], a[92:95]
  ds_read_b64_tr_b16 a[200:201], v110 offset:2048
  v_mfma_f32_16x16x32_bf16 a[92:95], a[220:223], a[188:191], a[92:95]
  v_mfma_f32_16x16x32_bf16 a[84:87], a[220:223], a[180:183], a[84:87]
  ds_read_b64_tr_b16 a[202:203], v110 offset:2560
  v_mfma_f32_16x16x32_bf16 a[84:87], a[216:219], a[176:179], a[84:87]
  v_mfma_f32_16x16x32_bf16 a[76:79], a[216:219], a[168:171], a[76:79]
  ds_read_b64_tr_b16 a[204:205], v110 offset:10240
  v_mfma_f32_16x16x32_bf16 a[76:79], a[220:223], a[172:175], a[76:79]
  buffer_load_dwordx4 a[144:147], v102, s[32:35], s42 offen offset:0 sc1
  v_mfma_f32_16x16x32_bf16 a[68:71], a[220:223], a[164:167], a[68:71]
  ds_read_b64_tr_b16 a[206:207], v110 offset:10752
  v_mfma_f32_16x16x32_bf16 a[68:71], a[216:219], a[160:163], a[68:71]
  s_waitcnt lgkmcnt(4)
  v_mfma_f32_16x16x32_bf16 v[40:43], a[192:195], a[160:163], v[40:43]
  ds_read_b64_tr_b16 a[208:209], v111 offset:0
  v_mfma_f32_16x16x32_bf16 v[40:43], a[196:199], a[164:167], v[40:43]
  v_mfma_f32_16x16x32_bf16 v[48:51], a[196:199], a[172:175], v[48:51]
  ds_read_b64_tr_b16 a[210:211], v111 offset:512
  v_mfma_f32_16x16x32_bf16 v[48:51], a[192:195], a[168:171], v[48:51]
  buffer_load_dwordx4 a[148:151], v102, s[32:35], s42 offen offset:256 sc1
  v_mfma_f32_16x16x32_bf16 v[56:59], a[192:195], a[176:179], v[56:59]
  ds_read_b64_tr_b16 a[212:213], v111 offset:8192
  v_mfma_f32_16x16x32_bf16 v[56:59], a[196:199], a[180:183], v[56:59]
  v_mfma_f32_16x16x32_bf16 v[64:67], a[196:199], a[188:191], v[64:67]
  ds_read_b64_tr_b16 a[214:215], v111 offset:8704
  v_mfma_f32_16x16x32_bf16 v[64:67], a[192:195], a[184:187], v[64:67]
  s_waitcnt lgkmcnt(4)
  v_mfma_f32_16x16x32_bf16 a[120:123], a[200:203], a[184:187], a[120:123]
  ds_read_b64_tr_b16 a[216:217], v111 offset:2048
  v_mfma_f32_16x16x32_bf16 a[120:123], a[204:207], a[188:191], a[120:123]
  buffer_load_dwordx4 a[152:155], v103, s[32:35], s42 offen offset:0 sc1
  v_mfma_f32_16x16x32_bf16 a[112:115], a[204:207], a[180:183], a[112:115]
  ds_read_b64_tr_b16 a[218:219], v111 offset:2560
  v_mfma_f32_16x16x32_bf16 a[112:115], a[200:203], a[176:179], a[112:115]
  v_mfma_f32_16x16x32_bf16 a[104:107], a[200:203], a[168:171], a[104:107]
  ds_read_b64_tr_b16 a[220:221], v111 offset:10240
  v_mfma_f32_16x16x32_bf16 a[104:107], a[204:207], a[172:175], a[104:107]
  v_mfma_f32_16x16x32_bf16 a[96:99], a[204:207], a[164:167], a[96:99]
  ds_read_b64_tr_b16 a[222:223], v111 offset:10752
  v_mfma_f32_16x16x32_bf16 a[96:99], a[200:203], a[160:163], a[96:99]
  s_waitcnt lgkmcnt(4)
  buffer_load_dwordx4 a[156:159], v103, s[32:35], s42 offen offset:256 sc1
  v_mfma_f32_16x16x32_bf16 v[44:47], a[208:211], a[160:163], v[44:47]
  ds_read_b64_tr_b16 a[192:193], v107 offset:49152
  v_mfma_f32_16x16x32_bf16 v[44:47], a[212:215], a[164:167], v[44:47]
  v_mfma_f32_16x16x32_bf16 v[52:55], a[212:215], a[172:175], v[52:55]
  s_add_u32 m0, s18, 16384
  ds_read_b64_tr_b16 a[194:195], v107 offset:50176
  v_mfma_f32_16x16x32_bf16 v[52:55], a[208:211], a[168:171], v[52:55]
  s_add_u32 s40, s40, 429056
  v_mfma_f32_16x16x32_bf16 v[60:63], a[208:211], a[176:179], v[60:63]
  ds_read_b64_tr_b16 a[196:197], v107 offset:57344
  v_mfma_f32_16x16x32_bf16 v[60:63], a[212:215], a[180:183], v[60:63]
  buffer_load_dwordx4 v112, s[20:23], s40 offen offset:0 lds
  v_mfma_f32_16x16x32_bf16 v[68:71], a[212:215], a[188:191], v[68:71]
  ds_read_b64_tr_b16 a[198:199], v107 offset:58368
  v_mfma_f32_16x16x32_bf16 v[68:71], a[208:211], a[184:187], v[68:71]
  s_waitcnt lgkmcnt(4)
  v_mfma_f32_16x16x32_bf16 a[124:127], a[216:219], a[184:187], a[124:127]
  ds_read_b64_tr_b16 a[200:201], v107 offset:49160
  v_mfma_f32_16x16x32_bf16 a[124:127], a[220:223], a[188:191], a[124:127]
  s_add_u32 s40, s40, 31744
  v_mfma_f32_16x16x32_bf16 a[116:119], a[220:223], a[180:183], a[116:119]
  ds_read_b64_tr_b16 a[202:203], v107 offset:50184
  v_mfma_f32_16x16x32_bf16 a[116:119], a[216:219], a[176:179], a[116:119]
  buffer_load_dwordx4 v112, s[20:23], s40 offen offset:1024 lds
  v_mfma_f32_16x16x32_bf16 a[108:111], a[216:219], a[168:171], a[108:111]
  ds_read_b64_tr_b16 a[204:205], v107 offset:57352
  v_mfma_f32_16x16x32_bf16 a[108:111], a[220:223], a[172:175], a[108:111]
  v_mfma_f32_16x16x32_bf16 a[100:103], a[220:223], a[164:167], a[100:103]
  ds_read_b64_tr_b16 a[206:207], v107 offset:58376
  v_mfma_f32_16x16x32_bf16 a[100:103], a[216:219], a[160:163], a[100:103]
  s_waitcnt lgkmcnt(4)
  s_add_u32 s40, s40, 31744
  v_mfma_f32_16x16x32_bf16 v[224:227], a[192:195], a[160:163], v[224:227]
  ds_read_b64_tr_b16 a[208:209], v106 offset:49152
  v_mfma_f32_16x16x32_bf16 v[224:227], a[196:199], a[164:167], v[224:227]
  buffer_load_dwordx4 v112, s[20:23], s40 offen offset:2048 lds
  v_mfma_f32_16x16x32_bf16 v[232:235], a[196:199], a[172:175], v[232:235]
  ds_read_b64_tr_b16 a[210:211], v106 offset:50176
  v_mfma_f32_16x16x32_bf16 v[232:235], a[192:195], a[168:171], v[232:235]
  s_add_u32 s40, s40, 31744
  v_mfma_f32_16x16x32_bf16 v[240:243], a[192:195], a[176:179], v[240:243]
  ds_read_b64_tr_b16 a[212:213], v106 offset:57344
  v_mfma_f32_16x16x32_bf16 v[240:243], a[196:199], a[180:183], v[240:243]
  buffer_load_dwordx4 v112, s[20:23], s40 offen offset:3072 lds
  v_mfma_f32_16x16x32_bf16 v[248:251], a[196:199], a[188:191], v[248:251]
  ds_read_b64_tr_b16 a[214:215], v106 offset:58368
  v_mfma_f32_16x16x32_bf16 v[248:251], a[192:195], a[184:187], v[248:251]
  s_waitcnt lgkmcnt(4)
  v_mfma_f32_16x16x32_bf16 v[252:255], a[200:203], a[184:187], v[252:255]
  s_add_u32 m0, s18, 98304
  ds_read_b64_tr_b16 a[216:217], v106 offset:49160
  v_mfma_f32_16x16x32_bf16 v[252:255], a[204:207], a[188:191], v[252:255]
  s_add_u32 s41, s41, 221184
  v_mfma_f32_16x16x32_bf16 v[244:247], a[204:207], a[180:183], v[244:247]
  ds_read_b64_tr_b16 a[218:219], v106 offset:50184
  v_mfma_f32_16x16x32_bf16 v[244:247], a[200:203], a[176:179], v[244:247]
  buffer_load_dwordx4 v113, s[24:27], s41 offen offset:0 lds
  v_mfma_f32_16x16x32_bf16 v[236:239], a[200:203], a[168:171], v[236:239]
  ds_read_b64_tr_b16 a[220:221], v106 offset:57352
  v_mfma_f32_16x16x32_bf16 v[236:239], a[204:207], a[172:175], v[236:239]
  v_mfma_f32_16x16x32_bf16 v[228:231], a[204:207], a[164:167], v[228:231]
  ds_read_b64_tr_b16 a[222:223], v106 offset:58376
  v_mfma_f32_16x16x32_bf16 v[228:231], a[200:203], a[160:163], v[228:231]
  s_waitcnt lgkmcnt(4)
  v_mfma_f32_16x16x32_bf16 v[192:195], a[208:211], a[160:163], v[192:195]
  ds_read_b64_tr_b16 a[192:193], v105 offset:49152
  v_mfma_f32_16x16x32_bf16 v[192:195], a[212:215], a[164:167], v[192:195]
  buffer_load_dwordx4 v114, s[24:27], s41 offen offset:1024 lds
  v_mfma_f32_16x16x32_bf16 v[200:203], a[212:215], a[172:175], v[200:203]
  ds_read_b64_tr_b16 a[194:195], v105 offset:50176
  v_mfma_f32_16x16x32_bf16 v[200:203], a[208:211], a[168:171], v[200:203]
  v_mfma_f32_16x16x32_bf16 v[208:211], a[208:211], a[176:179], v[208:211]
  ds_read_b64_tr_b16 a[196:197], v105 offset:57344
  v_mfma_f32_16x16x32_bf16 v[208:211], a[212:215], a[180:183], v[208:211]
  s_add_u32 m0, s18, 100352
  v_mfma_f32_16x16x32_bf16 v[216:219], a[212:215], a[188:191], v[216:219]
  ds_read_b64_tr_b16 a[198:199], v105 offset:58368
  v_mfma_f32_16x16x32_bf16 v[216:219], a[208:211], a[184:187], v[216:219]
  s_waitcnt lgkmcnt(4)
  buffer_load_dwordx4 v113, s[28:31], s41 offen offset:0 lds
  v_mfma_f32_16x16x32_bf16 v[220:223], a[216:219], a[184:187], v[220:223]
  ds_read_b64_tr_b16 a[200:201], v105 offset:49160
  v_mfma_f32_16x16x32_bf16 v[220:223], a[220:223], a[188:191], v[220:223]
  v_mfma_f32_16x16x32_bf16 v[212:215], a[220:223], a[180:183], v[212:215]
  ds_read_b64_tr_b16 a[202:203], v105 offset:50184
  v_mfma_f32_16x16x32_bf16 v[212:215], a[216:219], a[176:179], v[212:215]
  v_mfma_f32_16x16x32_bf16 v[204:207], a[216:219], a[168:171], v[204:207]
  ds_read_b64_tr_b16 a[204:205], v105 offset:57352
  v_mfma_f32_16x16x32_bf16 v[204:207], a[220:223], a[172:175], v[204:207]
  buffer_load_dwordx4 v114, s[28:31], s41 offen offset:1024 lds
  v_mfma_f32_16x16x32_bf16 v[196:199], a[220:223], a[164:167], v[196:199]
  ds_read_b64_tr_b16 a[206:207], v105 offset:58376
  v_mfma_f32_16x16x32_bf16 v[196:199], a[216:219], a[160:163], v[196:199]
  s_waitcnt lgkmcnt(4)
  v_mfma_f32_16x16x32_bf16 v[160:163], a[192:195], a[160:163], v[160:163]
  ds_read_b64_tr_b16 a[208:209], v104 offset:49152
  v_mfma_f32_16x16x32_bf16 v[160:163], a[196:199], a[164:167], v[160:163]
  v_mfma_f32_16x16x32_bf16 v[168:171], a[196:199], a[172:175], v[168:171]
  ds_read_b64_tr_b16 a[210:211], v104 offset:50176
  v_mfma_f32_16x16x32_bf16 v[168:171], a[192:195], a[168:171], v[168:171]
  v_mfma_f32_16x16x32_bf16 v[176:179], a[192:195], a[176:179], v[176:179]
  ds_read_b64_tr_b16 a[212:213], v104 offset:57344
  v_mfma_f32_16x16x32_bf16 v[176:179], a[196:199], a[180:183], v[176:179]
  v_mfma_f32_16x16x32_bf16 v[184:187], a[196:199], a[188:191], v[184:187]
  ds_read_b64_tr_b16 a[214:215], v104 offset:58368
  v_mfma_f32_16x16x32_bf16 v[184:187], a[192:195], a[184:187], v[184:187]
  s_waitcnt lgkmcnt(4)
  v_mfma_f32_16x16x32_bf16 v[188:191], a[200:203], a[184:187], v[188:191]
  ds_read_b64_tr_b16 a[216:217], v104 offset:49160
  v_mfma_f32_16x16x32_bf16 v[188:191], a[204:207], a[188:191], v[188:191]
  v_mfma_f32_16x16x32_bf16 v[180:183], a[204:207], a[180:183], v[180:183]
  ds_read_b64_tr_b16 a[218:219], v104 offset:50184
  v_mfma_f32_16x16x32_bf16 v[180:183], a[200:203], a[176:179], v[180:183]
  v_mfma_f32_16x16x32_bf16 v[172:175], a[200:203], a[168:171], v[172:175]
  ds_read_b64_tr_b16 a[220:221], v104 offset:57352
  v_mfma_f32_16x16x32_bf16 v[172:175], a[204:207], a[172:175], v[172:175]
  v_mfma_f32_16x16x32_bf16 v[164:167], a[204:207], a[164:167], v[164:167]
  ds_read_b64_tr_b16 a[222:223], v104 offset:58376
  v_mfma_f32_16x16x32_bf16 v[164:167], a[200:203], a[160:163], v[164:167]
  s_waitcnt lgkmcnt(4)
  s_waitcnt vmcnt(16)
  s_barrier
  v_mfma_f32_16x16x32_bf16 v[128:131], a[208:211], a[160:163], v[128:131]
  ds_read_b64_tr_b16 a[192:193], v108 offset:49152
  v_mfma_f32_16x16x32_bf16 v[128:131], a[212:215], a[164:167], v[128:131]
  v_mfma_f32_16x16x32_bf16 v[136:139], a[212:215], a[172:175], v[136:139]
  ds_read_b64_tr_b16 a[194:195], v108 offset:49664
  v_mfma_f32_16x16x32_bf16 v[136:139], a[208:211], a[168:171], v[136:139]
  v_mfma_f32_16x16x32_bf16 v[144:147], a[208:211], a[176:179], v[144:147]
  ds_read_b64_tr_b16 a[196:197], v108 offset:57344
  v_mfma_f32_16x16x32_bf16 v[144:147], a[212:215], a[180:183], v[144:147]
  v_mfma_f32_16x16x32_bf16 v[152:155], a[212:215], a[188:191], v[152:155]
  ds_read_b64_tr_b16 a[198:199], v108 offset:57856
  v_mfma_f32_16x16x32_bf16 v[152:155], a[208:211], a[184:187], v[152:155]
  s_waitcnt lgkmcnt(4)
  v_mfma_f32_16x16x32_bf16 v[156:159], a[216:219], a[184:187], v[156:159]
  ds_read_b64_tr_b16 a[200:201], v108 offset:51200
  v_mfma_f32_16x16x32_bf16 v[156:159], a[220:223], a[188:191], v[156:159]
  v_mfma_f32_16x16x32_bf16 v[148:151], a[220:223], a[180:183], v[148:151]
  ds_read_b64_tr_b16 a[202:203], v108 offset:51712
  v_mfma_f32_16x16x32_bf16 v[148:151], a[216:219], a[176:179], v[148:151]
  v_mfma_f32_16x16x32_bf16 v[140:143], a[216:219], a[168:171], v[140:143]
  ds_read_b64_tr_b16 a[204:205], v108 offset:59392
  v_mfma_f32_16x16x32_bf16 v[140:143], a[220:223], a[172:175], v[140:143]
  s_waitcnt vmcnt(8)
  v_mfma_f32_16x16x32_bf16 v[132:135], a[220:223], a[164:167], v[132:135]
  ds_read_b64_tr_b16 a[206:207], v108 offset:59904
  v_mfma_f32_16x16x32_bf16 v[132:135], a[216:219], a[160:163], v[132:135]
  s_waitcnt lgkmcnt(4)
  v_mfma_f32_16x16x32_bf16 v[8:11], a[192:195], a[128:131], v[8:11]
  ds_read_b64_tr_b16 a[208:209], v109 offset:49152
  v_mfma_f32_16x16x32_bf16 v[8:11], a[196:199], a[132:135], v[8:11]
  v_mfma_f32_16x16x32_bf16 v[16:19], a[196:199], a[140:143], v[16:19]
  ds_read_b64_tr_b16 a[210:211], v109 offset:49664
  v_mfma_f32_16x16x32_bf16 v[16:19], a[192:195], a[136:139], v[16:19]
  v_mfma_f32_16x16x32_bf16 v[24:27], a[192:195], a[144:147], v[24:27]
  ds_read_b64_tr_b16 a[212:213], v109 offset:57344
  v_mfma_f32_16x16x32_bf16 v[24:27], a[196:199], a[148:151], v[24:27]
  s_add_u32 s42, s42, 512
  v_mfma_f32_16x16x32_bf16 v[32:35], a[196:199], a[156:159], v[32:35]
  ds_read_b64_tr_b16 a[214:215], v109 offset:57856
  v_mfma_f32_16x16x32_bf16 v[32:35], a[192:195], a[152:155], v[32:35]
  s_waitcnt lgkmcnt(4)
  buffer_load_dwordx4 a[160:163], v100, s[32:35], s42 offen offset:0 sc1
  v_mfma_f32_16x16x32_bf16 a[88:91], a[200:203], a[152:155], a[88:91]
  ds_read_b64_tr_b16 a[216:217], v109 offset:51200
  v_mfma_f32_16x16x32_bf16 a[88:91], a[204:207], a[156:159], a[88:91]
  v_mfma_f32_16x16x32_bf16 a[80:83], a[204:207], a[148:151], a[80:83]
  ds_read_b64_tr_b16 a[218:219], v109 offset:51712
  v_mfma_f32_16x16x32_bf16 a[80:83], a[200:203], a[144:147], a[80:83]
  buffer_load_dwordx4 a[164:167], v100, s[32:35], s42 offen offset:256 sc1
  v_mfma_f32_16x16x32_bf16 a[72:75], a[200:203], a[136:139], a[72:75]
  ds_read_b64_tr_b16 a[220:221], v109 offset:59392
  v_mfma_f32_16x16x32_bf16 a[72:75], a[204:207], a[140:143], a[72:75]
  v_mfma_f32_16x16x32_bf16 a[64:67], a[204:207], a[132:135], a[64:67]
  ds_read_b64_tr_b16 a[222:223], v109 offset:59904
  v_mfma_f32_16x16x32_bf16 a[64:67], a[200:203], a[128:131], a[64:67]
  s_waitcnt lgkmcnt(4)
  v_mfma_f32_16x16x32_bf16 v[12:15], a[208:211], a[128:131], v[12:15]
  ds_read_b64_tr_b16 a[192:193], v110 offset:49152
  v_mfma_f32_16x16x32_bf16 v[12:15], a[212:215], a[132:135], v[12:15]
  buffer_load_dwordx4 a[168:171], v101, s[32:35], s42 offen offset:0 sc1
  v_mfma_f32_16x16x32_bf16 v[20:23], a[212:215], a[140:143], v[20:23]
  ds_read_b64_tr_b16 a[194:195], v110 offset:49664
  v_mfma_f32_16x16x32_bf16 v[20:23], a[208:211], a[136:139], v[20:23]
  v_mfma_f32_16x16x32_bf16 v[28:31], a[208:211], a[144:147], v[28:31]
  ds_read_b64_tr_b16 a[196:197], v110 offset:57344
  v_mfma_f32_16x16x32_bf16 v[28:31], a[212:215], a[148:151], v[28:31]
  v_mfma_f32_16x16x32_bf16 v[36:39], a[212:215], a[156:159], v[36:39]
  ds_read_b64_tr_b16 a[198:199], v110 offset:57856
  v_mfma_f32_16x16x32_bf16 v[36:39], a[208:211], a[152:155], v[36:39]
  s_waitcnt lgkmcnt(4)
  buffer_load_dwordx4 a[172:175], v101, s[32:35], s42 offen offset:256 sc1
  v_mfma_f32_16x16x32_bf16 a[92:95], a[216:219], a[152:155], a[92:95]
  ds_read_b64_tr_b16 a[200:201], v110 offset:51200
  v_mfma_f32_16x16x32_bf16 a[92:95], a[220:223], a[156:159], a[92:95]
  v_mfma_f32_16x16x32_bf16 a[84:87], a[220:223], a[148:151], a[84:87]
  ds_read_b64_tr_b16 a[202:203], v110 offset:51712
  v_mfma_f32_16x16x32_bf16 a[84:87], a[216:219], a[144:147], a[84:87]
  v_mfma_f32_16x16x32_bf16 a[76:79], a[216:219], a[136:139], a[76:79]
  ds_read_b64_tr_b16 a[204:205], v110 offset:59392
  v_mfma_f32_16x16x32_bf16 a[76:79], a[220:223], a[140:143], a[76:79]
  buffer_load_dwordx4 a[176:179], v102, s[32:35], s42 offen offset:0 sc1
  v_mfma_f32_16x16x32_bf16 a[68:71], a[220:223], a[132:135], a[68:71]
  ds_read_b64_tr_b16 a[206:207], v110 offset:59904
  v_mfma_f32_16x16x32_bf16 a[68:71], a[216:219], a[128:131], a[68:71]
  s_waitcnt lgkmcnt(4)
  v_mfma_f32_16x16x32_bf16 v[40:43], a[192:195], a[128:131], v[40:43]
  ds_read_b64_tr_b16 a[208:209], v111 offset:49152
  v_mfma_f32_16x16x32_bf16 v[40:43], a[196:199], a[132:135], v[40:43]
L_pad_proj02_1:
  s_cbranch_execz L_pad_proj02_2
  v_mfma_f32_16x16x32_bf16 v[48:51], a[196:199], a[140:143], v[48:51]
  ds_read_b64_tr_b16 a[210:211], v111 offset:49664
  v_mfma_f32_16x16x32_bf16 v[48:51], a[192:195], a[136:139], v[48:51]
  buffer_load_dwordx4 a[180:183], v102, s[32:35], s42 offen offset:256 sc1
  v_mfma_f32_16x16x32_bf16 v[56:59], a[192:195], a[144:147], v[56:59]
  ds_read_b64_tr_b16 a[212:213], v111 offset:57344
  v_mfma_f32_16x16x32_bf16 v[56:59], a[196:199], a[148:151], v[56:59]
  v_mfma_f32_16x16x32_bf16 v[64:67], a[196:199], a[156:159], v[64:67]
  ds_read_b64_tr_b16 a[214:215], v111 offset:57856
  v_mfma_f32_16x16x32_bf16 v[64:67], a[192:195], a[152:155], v[64:67]
  s_waitcnt lgkmcnt(4)
  v_mfma_f32_16x16x32_bf16 a[120:123], a[200:203], a[152:155], a[120:123]
  ds_read_b64_tr_b16 a[216:217], v111 offset:51200
  v_mfma_f32_16x16x32_bf16 a[120:123], a[204:207], a[156:159], a[120:123]
  buffer_load_dwordx4 a[184:187], v103, s[32:35], s42 offen offset:0 sc1
  v_mfma_f32_16x16x32_bf16 a[112:115], a[204:207], a[148:151], a[112:115]
  ds_read_b64_tr_b16 a[218:219], v111 offset:51712
  v_mfma_f32_16x16x32_bf16 a[112:115], a[200:203], a[144:147], a[112:115]
  v_mfma_f32_16x16x32_bf16 a[104:107], a[200:203], a[136:139], a[104:107]
  ds_read_b64_tr_b16 a[220:221], v111 offset:59392
  v_mfma_f32_16x16x32_bf16 a[104:107], a[204:207], a[140:143], a[104:107]
  v_mfma_f32_16x16x32_bf16 a[96:99], a[204:207], a[132:135], a[96:99]
  ds_read_b64_tr_b16 a[222:223], v111 offset:59904
  v_mfma_f32_16x16x32_bf16 a[96:99], a[200:203], a[128:131], a[96:99]
  s_waitcnt lgkmcnt(4)
  buffer_load_dwordx4 a[188:191], v103, s[32:35], s42 offen offset:256 sc1
  v_mfma_f32_16x16x32_bf16 v[44:47], a[208:211], a[128:131], v[44:47]
  ds_read_b64_tr_b16 a[192:193], v107 offset:0
  v_mfma_f32_16x16x32_bf16 v[44:47], a[212:215], a[132:135], v[44:47]
  v_mfma_f32_16x16x32_bf16 v[52:55], a[212:215], a[140:143], v[52:55]
  s_add_u32 m0, s18, 32768
  ds_read_b64_tr_b16 a[194:195], v107 offset:1024
  v_mfma_f32_16x16x32_bf16 v[52:55], a[208:211], a[136:139], v[52:55]
  s_add_u32 s40, s40, 429056
  v_mfma_f32_16x16x32_bf16 v[60:63], a[208:211], a[144:147], v[60:63]
  ds_read_b64_tr_b16 a[196:197], v107 offset:8192
  v_mfma_f32_16x16x32_bf16 v[60:63], a[212:215], a[148:151], v[60:63]
  buffer_load_dwordx4 v112, s[20:23], s40 offen offset:0 lds
  v_mfma_f32_16x16x32_bf16 v[68:71], a[212:215], a[156:159], v[68:71]
  ds_read_b64_tr_b16 a[198:199], v107 offset:9216
  v_mfma_f32_16x16x32_bf16 v[68:71], a[208:211], a[152:155], v[68:71]
  s_waitcnt lgkmcnt(4)
  v_mfma_f32_16x16x32_bf16 a[124:127], a[216:219], a[152:155], a[124:127]
  ds_read_b64_tr_b16 a[200:201], v107 offset:8
  v_mfma_f32_16x16x32_bf16 a[124:127], a[220:223], a[156:159], a[124:127]
  s_add_u32 s40, s40, 31744
  v_mfma_f32_16x16x32_bf16 a[116:119], a[220:223], a[148:151], a[116:119]
  ds_read_b64_tr_b16 a[202:203], v107 offset:1032
  v_mfma_f32_16x16x32_bf16 a[116:119], a[216:219], a[144:147], a[116:119]
  buffer_load_dwordx4 v112, s[20:23], s40 offen offset:1024 lds
  v_mfma_f32_16x16x32_bf16 a[108:111], a[216:219], a[136:139], a[108:111]
  ds_read_b64_tr_b16 a[204:205], v107 offset:8200
  v_mfma_f32_16x16x32_bf16 a[108:111], a[220:223], a[140:143], a[108:111]
  v_mfma_f32_16x16x32_bf16 a[100:103], a[220:223], a[132:135], a[100:103]
  ds_read_b64_tr_b16 a[206:207], v107 offset:9224
  v_mfma_f32_16x16x32_bf16 a[100:103], a[216:219], a[128:131], a[100:103]
  s_waitcnt lgkmcnt(4)
  s_add_u32 s40, s40, 31744
  v_mfma_f32_16x16x32_bf16 v[224:227], a[192:195], a[128:131], v[224:227]
  ds_read_b64_tr_b16 a[208:209], v106 offset:0
  v_mfma_f32_16x16x32_bf16 v[224:227], a[196:199], a[132:135], v[224:227]
  buffer_load_dwordx4 v112, s[20:23], s40 offen offset:2048 lds
  v_mfma_f32_16x16x32_bf16 v[232:235], a[196:199], a[140:143], v[232:235]
  ds_read_b64_tr_b16 a[210:211], v106 offset:1024
  v_mfma_f32_16x16x32_bf16 v[232:235], a[192:195], a[136:139], v[232:235]
  s_add_u32 s40, s40, 31744
  v_mfma_f32_16x16x32_bf16 v[240:243], a[192:195], a[144:147], v[240:243]
  ds_read_b64_tr_b16 a[212:213], v106 offset:8192
  v_mfma_f32_16x16x32_bf16 v[240:243], a[196:199], a[148:151], v[240:243]
  buffer_load_dwordx4 v112, s[20:23], s40 offen offset:3072 lds
  v_mfma_f32_16x16x32_bf16 v[248:251], a[196:199], a[156:159], v[248:251]
  ds_read_b64_tr_b16 a[214:215], v106 offset:9216
  v_mfma_f32_16x16x32_bf16 v[248:251], a[192:195], a[152:155], v[248:251]
  s_waitcnt lgkmcnt(4)
  v_mfma_f32_16x16x32_bf16 v[252:255], a[200:203], a[152:155], v[252:255]
  s_add_u32 m0, s18, 81920
  ds_read_b64_tr_b16 a[216:217], v106 offset:8
  v_mfma_f32_16x16x32_bf16 v[252:255], a[204:207], a[156:159], v[252:255]
  s_add_u32 s41, s41, 221184
  v_mfma_f32_16x16x32_bf16 v[244:247], a[204:207], a[148:151], v[244:247]
  ds_read_b64_tr_b16 a[218:219], v106 offset:1032
  v_mfma_f32_16x16x32_bf16 v[244:247], a[200:203], a[144:147], v[244:247]
  buffer_load_dwordx4 v113, s[24:27], s41 offen offset:0 lds
  v_mfma_f32_16x16x32_bf16 v[236:239], a[200:203], a[136:139], v[236:239]
  ds_read_b64_tr_b16 a[220:221], v106 offset:8200
  v_mfma_f32_16x16x32_bf16 v[236:239], a[204:207], a[140:143], v[236:239]
  v_mfma_f32_16x16x32_bf16 v[228:231], a[204:207], a[132:135], v[228:231]
  ds_read_b64_tr_b16 a[222:223], v106 offset:9224
  v_mfma_f32_16x16x32_bf16 v[228:231], a[200:203], a[128:131], v[228:231]
  s_waitcnt lgkmcnt(4)
  v_mfma_f32_16x16x32_bf16 v[192:195], a[208:211], a[128:131], v[192:195]
  ds_read_b64_tr_b16 a[192:193], v105 offset:0
  v_mfma_f32_16x16x32_bf16 v[192:195], a[212:215], a[132:135], v[192:195]
  buffer_load_dwordx4 v114, s[24:27], s41 offen offset:1024 lds
  v_mfma_f32_16x16x32_bf16 v[200:203], a[212:215], a[140:143], v[200:203]
  ds_read_b64_tr_b16 a[194:195], v105 offset:1024
  v_mfma_f32_16x16x32_bf16 v[200:203], a[208:211], a[136:139], v[200:203]
  v_mfma_f32_16x16x32_bf16 v[208:211], a[208:211], a[144:147], v[208:211]
  ds_read_b64_tr_b16 a[196:197], v105 offset:8192
  v_mfma_f32_16x16x32_bf16 v[208:211], a[212:215], a[148:151], v[208:211]
  s_add_u32 m0, s18, 83968
  v_mfma_f32_16x16x32_bf16 v[216:219], a[212:215], a[156:159], v[216:219]
  ds_read_b64_tr_b16 a[198:199], v105 offset:9216
  v_mfma_f32_16x16x32_bf16 v[216:219], a[208:211], a[152:155], v[216:219]
  s_waitcnt lgkmcnt(4)
  buffer_load_dwordx4 v113, s[28:31], s41 offen offset:0 lds
  v_mfma_f32_16x16x32_bf16 v[220:223], a[216:219], a[152:155], v[220:223]
  ds_read_b64_tr_b16 a[200:201], v105 offset:8
  v_mfma_f32_16x16x32_bf16 v[220:223], a[220:223], a[156:159], v[220:223]
  v_mfma_f32_16x16x32_bf16 v[212:215], a[220:223], a[148:151], v[212:215]
  ds_read_b64_tr_b16 a[202:203], v105 offset:1032
  v_mfma_f32_16x16x32_bf16 v[212:215], a[216:219], a[144:147], v[212:215]
  v_mfma_f32_16x16x32_bf16 v[204:207], a[216:219], a[136:139], v[204:207]
  ds_read_b64_tr_b16 a[204:205], v105 offset:8200
  v_mfma_f32_16x16x32_bf16 v[204:207], a[220:223], a[140:143], v[204:207]
  buffer_load_dwordx4 v114, s[28:31], s41 offen offset:1024 lds
  v_mfma_f32_16x16x32_bf16 v[196:199], a[220:223], a[132:135], v[196:199]
  ds_read_b64_tr_b16 a[206:207], v105 offset:9224
  v_mfma_f32_16x16x32_bf16 v[196:199], a[216:219], a[128:131], v[196:199]
  s_waitcnt lgkmcnt(4)
  v_mfma_f32_16x16x32_bf16 v[160:163], a[192:195], a[128:131], v[160:163]
  ds_read_b64_tr_b16 a[208:209], v104 offset:0
  v_mfma_f32_16x16x32_bf16 v[160:163], a[196:199], a[132:135], v[160:163]
  v_mfma_f32_16x16x32_bf16 v[168:171], a[196:199], a[140:143], v[168:171]
  ds_read_b64_tr_b16 a[210:211], v104 offset:1024
  v_mfma_f32_16x16x32_bf16 v[168:171], a[192:195], a[136:139], v[168:171]
  v_mfma_f32_16x16x32_bf16 v[176:179], a[192:195], a[144:147], v[176:179]
  ds_read_b64_tr_b16 a[212:213], v104 offset:8192
  v_mfma_f32_16x16x32_bf16 v[176:179], a[196:199], a[148:151], v[176:179]
  v_mfma_f32_16x16x32_bf16 v[184:187], a[196:199], a[156:159], v[184:187]
  ds_read_b64_tr_b16 a[214:215], v104 offset:9216
  v_mfma_f32_16x16x32_bf16 v[184:187], a[192:195], a[152:155], v[184:187]
  s_waitcnt lgkmcnt(4)
  v_mfma_f32_16x16x32_bf16 v[188:191], a[200:203], a[152:155], v[188:191]
  ds_read_b64_tr_b16 a[216:217], v104 offset:8
  v_mfma_f32_16x16x32_bf16 v[188:191], a[204:207], a[156:159], v[188:191]
  v_mfma_f32_16x16x32_bf16 v[180:183], a[204:207], a[148:151], v[180:183]
  ds_read_b64_tr_b16 a[218:219], v104 offset:1032
  v_mfma_f32_16x16x32_bf16 v[180:183], a[200:203], a[144:147], v[180:183]
  v_mfma_f32_16x16x32_bf16 v[172:175], a[200:203], a[136:139], v[172:175]
  ds_read_b64_tr_b16 a[220:221], v104 offset:8200
  v_mfma_f32_16x16x32_bf16 v[172:175], a[204:207], a[140:143], v[172:175]
  v_mfma_f32_16x16x32_bf16 v[164:167], a[204:207], a[132:135], v[164:167]
  ds_read_b64_tr_b16 a[222:223], v104 offset:9224
  v_mfma_f32_16x16x32_bf16 v[164:167], a[200:203], a[128:131], v[164:167]
  s_waitcnt lgkmcnt(4)
  s_waitcnt vmcnt(16)
  s_barrier
  v_mfma_f32_16x16x32_bf16 v[128:131], a[208:211], a[128:131], v[128:131]
  ds_read_b64_tr_b16 a[192:193], v108 offset:32768
  v_mfma_f32_16x16x32_bf16 v[128:131], a[212:215], a[132:135], v[128:131]
  v_mfma_f32_16x16x32_bf16 v[136:139], a[212:215], a[140:143], v[136:139]
  ds_read_b64_tr_b16 a[194:195], v108 offset:33280
  v_mfma_f32_16x16x32_bf16 v[136:139], a[208:211], a[136:139], v[136:139]
  v_mfma_f32_16x16x32_bf16 v[144:147], a[208:211], a[144:147], v[144:147]
  ds_read_b64_tr_b16 a[196:197], v108 offset:40960
  v_mfma_f32_16x16x32_bf16 v[144:147], a[212:215], a[148:151], v[144:147]
  v_mfma_f32_16x16x32_bf16 v[152:155], a[212:215], a[156:159], v[152:155]
  ds_read_b64_tr_b16 a[198:199], v108 offset:41472
  v_mfma_f32_16x16x32_bf16 v[152:155], a[208:211], a[152:155], v[152:155]
  s_waitcnt lgkmcnt(4)
  v_mfma_f32_16x16x32_bf16 v[156:159], a[216:219], a[152:155], v[156:159]
  ds_read_b64_tr_b16 a[200:201], v108 offset:34816
  v_mfma_f32_16x16x32_bf16 v[156:159], a[220:223], a[156:159], v[156:159]
  v_mfma_f32_16x16x32_bf16 v[148:151], a[220:223], a[148:151], v[148:151]
  ds_read_b64_tr_b16 a[202:203], v108 offset:35328
  v_mfma_f32_16x16x32_bf16 v[148:151], a[216:219], a[144:147], v[148:151]
  v_mfma_f32_16x16x32_bf16 v[140:143], a[216:219], a[136:139], v[140:143]
  ds_read_b64_tr_b16 a[204:205], v108 offset:43008
  v_mfma_f32_16x16x32_bf16 v[140:143], a[220:223], a[140:143], v[140:143]
  s_waitcnt vmcnt(8)
  v_mfma_f32_16x16x32_bf16 v[132:135], a[220:223], a[132:135], v[132:135]
  ds_read_b64_tr_b16 a[206:207], v108 offset:43520
  v_mfma_f32_16x16x32_bf16 v[132:135], a[216:219], a[128:131], v[132:135]
  s_waitcnt lgkmcnt(4)
  v_mfma_f32_16x16x32_bf16 v[8:11], a[192:195], a[160:163], v[8:11]
  ds_read_b64_tr_b16 a[208:209], v109 offset:32768
  v_mfma_f32_16x16x32_bf16 v[8:11], a[196:199], a[164:167], v[8:11]
  s_cmp_ge_u32 s45, 6
  s_cselect_b32 s87, 5, 0
  v_mfma_f32_16x16x32_bf16 v[16:19], a[196:199], a[172:175], v[16:19]
  s_sub_u32 s19, s45, s87
  ds_read_b64_tr_b16 a[210:211], v109 offset:33280
  v_mfma_f32_16x16x32_bf16 v[16:19], a[192:195], a[168:171], v[16:19]
  s_lshl_b32 s99, s44, 1
  s_add_u32 s59, s99, s45
  v_mfma_f32_16x16x32_bf16 v[24:27], a[192:195], a[176:179], v[24:27]
  s_add_u32 s87, s59, 13
  ds_read_b64_tr_b16 a[212:213], v109 offset:40960
  v_mfma_f32_16x16x32_bf16 v[24:27], a[196:199], a[180:183], v[24:27]
  s_add_u32 s42, s42, 512
  s_and_b32 s79, s87, 7
  v_mfma_f32_16x16x32_bf16 v[32:35], a[196:199], a[188:191], v[32:35]
  s_add_u32 s87, s59, 12
  ds_read_b64_tr_b16 a[214:215], v109 offset:41472
  v_mfma_f32_16x16x32_bf16 v[32:35], a[192:195], a[184:187], v[32:35]
  s_waitcnt lgkmcnt(4)
  buffer_load_dwordx4 a[128:131], v100, s[32:35], s42 offen offset:0 sc1
  v_mfma_f32_16x16x32_bf16 a[88:91], a[200:203], a[184:187], a[88:91]
  s_and_b32 s87, s87, 7
  ds_read_b64_tr_b16 a[216:217], v109 offset:34816
  v_mfma_f32_16x16x32_bf16 a[88:91], a[204:207], a[188:191], a[88:91]
  s_lshl4_add_u32 s79, s79, s87
  s_add_u32 s87, s59, 11
  v_mfma_f32_16x16x32_bf16 a[80:83], a[204:207], a[180:183], a[80:83]
  s_and_b32 s87, s87, 7
  ds_read_b64_tr_b16 a[218:219], v109 offset:35328
  v_mfma_f32_16x16x32_bf16 a[80:83], a[200:203], a[176:179], a[80:83]
  buffer_load_dwordx4 a[132:135], v100, s[32:35], s42 offen offset:256 sc1
  v_mfma_f32_16x16x32_bf16 a[72:75], a[200:203], a[168:171], a[72:75]
  s_lshl4_add_u32 s79, s79, s87
  ds_read_b64_tr_b16 a[220:221], v109 offset:43008
  v_mfma_f32_16x16x32_bf16 a[72:75], a[204:207], a[172:175], a[72:75]
  s_add_u32 s87, s59, 10
  s_and_b32 s87, s87, 7
  v_mfma_f32_16x16x32_bf16 a[64:67], a[204:207], a[164:167], a[64:67]
  s_lshl4_add_u32 s79, s79, s87
  ds_read_b64_tr_b16 a[222:223], v109 offset:43520
  v_mfma_f32_16x16x32_bf16 a[64:67], a[200:203], a[160:163], a[64:67]
  s_waitcnt lgkmcnt(4)
  s_add_u32 s87, s59, 9
  v_mfma_f32_16x16x32_bf16 v[12:15], a[208:211], a[160:163], v[12:15]
  s_and_b32 s87, s87, 7
  ds_read_b64_tr_b16 a[192:193], v110 offset:32768
  v_mfma_f32_16x16x32_bf16 v[12:15], a[212:215], a[164:167], v[12:15]
  buffer_load_dwordx4 a[136:139], v101, s[32:35], s42 offen offset:0 sc1
  v_mfma_f32_16x16x32_bf16 v[20:23], a[212:215], a[172:175], v[20:23]
  s_lshl4_add_u32 s79, s79, s87
  ds_read_b64_tr_b16 a[194:195], v110 offset:33280
  v_mfma_f32_16x16x32_bf16 v[20:23], a[208:211], a[168:171], v[20:23]
  s_add_u32 s87, s59, 8
  s_and_b32 s87, s87, 7
  v_mfma_f32_16x16x32_bf16 v[28:31], a[208:211], a[176:179], v[28:31]
  s_lshl4_add_u32 s79, s79, s87
  ds_read_b64_tr_b16 a[196:197], v110 offset:40960
  v_mfma_f32_16x16x32_bf16 v[28:31], a[212:215], a[180:183], v[28:31]
  s_add_u32 s87, s59, 7
  s_and_b32 s78, s87, 7
  v_mfma_f32_16x16x32_bf16 v[36:39], a[212:215], a[188:191], v[36:39]
  s_add_u32 s87, s59, 6
  ds_read_b64_tr_b16 a[198:199], v110 offset:41472
  v_mfma_f32_16x16x32_bf16 v[36:39], a[208:211], a[184:187], v[36:39]
  s_waitcnt lgkmcnt(4)
  buffer_load_dwordx4 a[140:143], v101, s[32:35], s42 offen offset:256 sc1
  v_mfma_f32_16x16x32_bf16 a[92:95], a[216:219], a[184:187], a[92:95]
  s_and_b32 s87, s87, 7
  ds_read_b64_tr_b16 a[200:201], v110 offset:34816
  v_mfma_f32_16x16x32_bf16 a[92:95], a[220:223], a[188:191], a[92:95]
  s_lshl4_add_u32 s78, s78, s87
  s_add_u32 s59, s99, s19
  v_mfma_f32_16x16x32_bf16 a[84:87], a[220:223], a[180:183], a[84:87]
  ds_read_b64_tr_b16 a[202:203], v110 offset:35328
  v_mfma_f32_16x16x32_bf16 a[84:87], a[216:219], a[176:179], a[84:87]
  s_cmp_gt_u32 s19, 0
  s_cselect_b32 s87, 9, 7
  v_mfma_f32_16x16x32_bf16 a[76:79], a[216:219], a[168:171], a[76:79]
  s_add_u32 s87, s87, s59
  ds_read_b64_tr_b16 a[204:205], v110 offset:43008
  v_mfma_f32_16x16x32_bf16 a[76:79], a[220:223], a[172:175], a[76:79]
  buffer_load_dwordx4 a[144:147], v102, s[32:35], s42 offen offset:0 sc1
  v_mfma_f32_16x16x32_bf16 a[68:71], a[220:223], a[164:167], a[68:71]
  s_and_b32 s87, s87, 7
  ds_read_b64_tr_b16 a[206:207], v110 offset:43520
  v_mfma_f32_16x16x32_bf16 a[68:71], a[216:219], a[160:163], a[68:71]
  s_waitcnt lgkmcnt(4)
  s_lshl4_add_u32 s78, s78, s87
  v_mfma_f32_16x16x32_bf16 v[40:43], a[192:195], a[160:163], v[40:43]
  ds_read_b64_tr_b16 a[208:209], v111 offset:32768
  v_mfma_f32_16x16x32_bf16 v[40:43], a[196:199], a[164:167], v[40:43]
  s_cmp_gt_u32 s19, 1
  s_cselect_b32 s87, 8, 6
  v_mfma_f32_16x16x32_bf16 v[48:51], a[196:199], a[172:175], v[48:51]
  s_add_u32 s87, s87, s59
  ds_read_b64_tr_b16 a[210:211], v111 offset:33280
  v_mfma_f32_16x16x32_bf16 v[48:51], a[192:195], a[168:171], v[48:51]
  buffer_load_dwordx4 a[148:151], v102, s[32:35], s42 offen offset:256 sc1
  v_mfma_f32_16x16x32_bf16 v[56:59], a[192:195], a[176:179], v[56:59]
  s_and_b32 s87, s87, 7
  ds_read_b64_tr_b16 a[212:213], v111 offset:40960
  v_mfma_f32_16x16x32_bf16 v[56:59], a[196:199], a[180:183], v[56:59]
  s_lshl4_add_u32 s78, s78, s87
  v_mfma_f32_16x16x32_bf16 v[64:67], a[196:199], a[188:191], v[64:67]
  ds_read_b64_tr_b16 a[214:215], v111 offset:41472
  v_mfma_f32_16x16x32_bf16 v[64:67], a[192:195], a[184:187], v[64:67]
  s_waitcnt lgkmcnt(4)
  v_mfma_f32_16x16x32_bf16 a[120:123], a[200:203], a[184:187], a[120:123]
  ds_read_b64_tr_b16 a[216:217], v111 offset:34816
  v_mfma_f32_16x16x32_bf16 a[120:123], a[204:207], a[188:191], a[120:123]
  buffer_load_dwordx4 a[152:155], v103, s[32:35], s42 offen offset:0 sc1
  v_mfma_f32_16x16x32_bf16 a[112:115], a[204:207], a[180:183], a[112:115]
  ds_read_b64_tr_b16 a[218:219], v111 offset:35328
  v_mfma_f32_16x16x32_bf16 a[112:115], a[200:203], a[176:179], a[112:115]
  s_cmp_gt_u32 s19, 2
  s_cselect_b32 s87, 7, 5
  v_mfma_f32_16x16x32_bf16 a[104:107], a[200:203], a[168:171], a[104:107]
  s_add_u32 s87, s87, s59
  ds_read_b64_tr_b16 a[220:221], v111 offset:43008
  v_mfma_f32_16x16x32_bf16 a[104:107], a[204:207], a[172:175], a[104:107]
  s_and_b32 s87, s87, 7
  s_lshl4_add_u32 s78, s78, s87
  v_mfma_f32_16x16x32_bf16 a[96:99], a[204:207], a[164:167], a[96:99]
  ds_read_b64_tr_b16 a[222:223], v111 offset:43520
  v_mfma_f32_16x16x32_bf16 a[96:99], a[200:203], a[160:163], a[96:99]
  s_waitcnt lgkmcnt(4)
  buffer_load_dwordx4 a[156:159], v103, s[32:35], s42 offen offset:256 sc1
  v_mfma_f32_16x16x32_bf16 v[44:47], a[208:211], a[160:163], v[44:47]
  ds_read_b64_tr_b16 a[192:193], v107 offset:16384
  v_mfma_f32_16x16x32_bf16 v[44:47], a[212:215], a[164:167], v[44:47]
  s_cmp_gt_u32 s19, 3
  s_cselect_b32 s87, 6, 4
  v_mfma_f32_16x16x32_bf16 v[52:55], a[212:215], a[172:175], v[52:55]
  s_add_u32 m0, s18, 49152
  ds_read_b64_tr_b16 a[194:195], v107 offset:17408
  v_mfma_f32_16x16x32_bf16 v[52:55], a[208:211], a[168:171], v[52:55]
  s_add_u32 s40, s40, 429056
  s_add_u32 s87, s87, s59
  v_mfma_f32_16x16x32_bf16 v[60:63], a[208:211], a[176:179], v[60:63]
  s_and_b32 s87, s87, 7
  ds_read_b64_tr_b16 a[196:197], v107 offset:24576
  v_mfma_f32_16x16x32_bf16 v[60:63], a[212:215], a[180:183], v[60:63]
  buffer_load_dwordx4 v112, s[20:23], s40 offen offset:0 lds
  v_mfma_f32_16x16x32_bf16 v[68:71], a[212:215], a[188:191], v[68:71]
  s_lshl4_add_u32 s78, s78, s87
  ds_read_b64_tr_b16 a[198:199], v107 offset:25600
  v_mfma_f32_16x16x32_bf16 v[68:71], a[208:211], a[184:187], v[68:71]
  s_waitcnt lgkmcnt(4)
  v_mfma_f32_16x16x32_bf16 a[124:127], a[216:219], a[184:187], a[124:127]
  ds_read_b64_tr_b16 a[200:201], v107 offset:16392
  v_mfma_f32_16x16x32_bf16 a[124:127], a[220:223], a[188:191], a[124:127]
  s_add_u32 s40, s40, 31744
  v_mfma_f32_16x16x32_bf16 a[116:119], a[220:223], a[180:183], a[116:119]
  ds_read_b64_tr_b16 a[202:203], v107 offset:17416
  v_mfma_f32_16x16x32_bf16 a[116:119], a[216:219], a[176:179], a[116:119]
  buffer_load_dwordx4 v112, s[20:23], s40 offen offset:1024 lds
  v_mfma_f32_16x16x32_bf16 a[108:111], a[216:219], a[168:171], a[108:111]
  ds_read_b64_tr_b16 a[204:205], v107 offset:24584
  v_mfma_f32_16x16x32_bf16 a[108:111], a[220:223], a[172:175], a[108:111]
  s_cmp_gt_u32 s19, 4
  s_cselect_b32 s87, 5, 3
  v_mfma_f32_16x16x32_bf16 a[100:103], a[220:223], a[164:167], a[100:103]
  s_add_u32 s87, s87, s59
  ds_read_b64_tr_b16 a[206:207], v107 offset:25608
  v_mfma_f32_16x16x32_bf16 a[100:103], a[216:219], a[160:163], a[100:103]
  s_waitcnt lgkmcnt(4)
  s_add_u32 s40, s40, 31744
  v_mfma_f32_16x16x32_bf16 v[224:227], a[192:195], a[160:163], v[224:227]
  s_and_b32 s87, s87, 7
  ds_read_b64_tr_b16 a[208:209], v106 offset:16384
  v_mfma_f32_16x16x32_bf16 v[224:227], a[196:199], a[164:167], v[224:227]
  buffer_load_dwordx4 v112, s[20:23], s40 offen offset:2048 lds
  v_mfma_f32_16x16x32_bf16 v[232:235], a[196:199], a[172:175], v[232:235]
  s_lshl4_add_u32 s78, s78, s87
  ds_read_b64_tr_b16 a[210:211], v106 offset:17408
  v_mfma_f32_16x16x32_bf16 v[232:235], a[192:195], a[168:171], v[232:235]
  s_add_u32 s40, s40, 31744
  v_mfma_f32_16x16x32_bf16 v[240:243], a[192:195], a[176:179], v[240:243]
  ds_read_b64_tr_b16 a[212:213], v106 offset:24576
  v_mfma_f32_16x16x32_bf16 v[240:243], a[196:199], a[180:183], v[240:243]
  buffer_load_dwordx4 v112, s[20:23], s40 offen offset:3072 lds
  v_mfma_f32_16x16x32_bf16 v[248:251], a[196:199], a[188:191], v[248:251]
  ds_read_b64_tr_b16 a[214:215], v106 offset:25600
  v_mfma_f32_16x16x32_bf16 v[248:251], a[192:195], a[184:187], v[248:251]
  s_waitcnt lgkmcnt(4)
  v_mfma_f32_16x16x32_bf16 v[252:255], a[200:203], a[184:187], v[252:255]
  s_add_u32 m0, s18, 65536
  ds_read_b64_tr_b16 a[216:217], v106 offset:16392
  v_mfma_f32_16x16x32_bf16 v[252:255], a[204:207], a[188:191], v[252:255]
  s_add_u32 s41, s41, 221184
  v_mfma_f32_16x16x32_bf16 v[244:247], a[204:207], a[180:183], v[244:247]
  ds_read_b64_tr_b16 a[218:219], v106 offset:17416
  v_mfma_f32_16x16x32_bf16 v[244:247], a[200:203], a[176:179], v[244:247]
  buffer_load_dwordx4 v113, s[24:27], s41 offen offset:0 lds
  v_mfma_f32_16x16x32_bf16 v[236:239], a[200:203], a[168:171], v[236:239]
  ds_read_b64_tr_b16 a[220:221], v106 offset:24584
  v_mfma_f32_16x16x32_bf16 v[236:239], a[204:207], a[172:175], v[236:239]
  s_cmp_gt_u32 s19, 5
  s_cselect_b32 s87, 4, 2
  v_mfma_f32_16x16x32_bf16 v[228:231], a[204:207], a[164:167], v[228:231]
  s_add_u32 s87, s87, s59
  ds_read_b64_tr_b16 a[222:223], v106 offset:25608
  v_mfma_f32_16x16x32_bf16 v[228:231], a[200:203], a[160:163], v[228:231]
  s_waitcnt lgkmcnt(4)
  s_and_b32 s87, s87, 7
  v_mfma_f32_16x16x32_bf16 v[192:195], a[208:211], a[160:163], v[192:195]
  s_lshl4_add_u32 s78, s78, s87
  ds_read_b64_tr_b16 a[192:193], v105 offset:16384
  v_mfma_f32_16x16x32_bf16 v[192:195], a[212:215], a[164:167], v[192:195]
  buffer_load_dwordx4 v114, s[24:27], s41 offen offset:1024 lds
  v_mfma_f32_16x16x32_bf16 v[200:203], a[212:215], a[172:175], v[200:203]
  ds_read_b64_tr_b16 a[194:195], v105 offset:17408
  v_mfma_f32_16x16x32_bf16 v[200:203], a[208:211], a[168:171], v[200:203]
  s_bitcmp1_b32 s44, 2
  s_cselect_b32 s87, 0x88888888, 0
  v_mfma_f32_16x16x32_bf16 v[208:211], a[208:211], a[176:179], v[208:211]
  s_xor_b32 s78, s78, s87
  ds_read_b64_tr_b16 a[196:197], v105 offset:24576
  v_mfma_f32_16x16x32_bf16 v[208:211], a[212:215], a[180:183], v[208:211]
  s_add_u32 m0, s18, 67584
  s_xor_b32 s79, s79, s87
  v_mfma_f32_16x16x32_bf16 v[216:219], a[212:215], a[188:191], v[216:219]
  s_xor_b32 s78, s78, 0x88000000
  ds_read_b64_tr_b16 a[198:199], v105 offset:25600
  v_mfma_f32_16x16x32_bf16 v[216:219], a[208:211], a[184:187], v[216:219]
  s_waitcnt lgkmcnt(4)
  buffer_load_dwordx4 v113, s[28:31], s41 offen offset:0 lds
  v_mfma_f32_16x16x32_bf16 v[220:223], a[216:219], a[184:187], v[220:223]
  s_xor_b32 s79, s79, 0x88888888
  ds_read_b64_tr_b16 a[200:201], v105 offset:16392
  v_mfma_f32_16x16x32_bf16 v[220:223], a[220:223], a[188:191], v[220:223]
  v_mfma_f32_16x16x32_bf16 v[212:215], a[220:223], a[180:183], v[212:215]
  ds_read_b64_tr_b16 a[202:203], v105 offset:17416
  v_mfma_f32_16x16x32_bf16 v[212:215], a[216:219], a[176:179], v[212:215]
  v_mfma_f32_16x16x32_bf16 v[204:207], a[216:219], a[168:171], v[204:207]
  ds_read_b64_tr_b16 a[204:205], v105 offset:24584
  v_mfma_f32_16x16x32_bf16 v[204:207], a[220:223], a[172:175], v[204:207]
  buffer_load_dwordx4 v114, s[28:31], s41 offen offset:1024 lds
  v_mfma_f32_16x16x32_bf16 v[196:199], a[220:223], a[164:167], v[196:199]
  ds_read_b64_tr_b16 a[206:207], v105 offset:25608
  v_mfma_f32_16x16x32_bf16 v[196:199], a[216:219], a[160:163], v[196:199]
  s_waitcnt lgkmcnt(4)
  v_mfma_f32_16x16x32_bf16 v[160:163], a[192:195], a[160:163], v[160:163]
  ds_read_b64_tr_b16 a[208:209], v104 offset:16384
  v_mfma_f32_16x16x32_bf16 v[160:163], a[196:199], a[164:167], v[160:163]
  v_mfma_f32_16x16x32_bf16 v[168:171], a[196:199], a[172:175], v[168:171]
  ds_read_b64_tr_b16 a[210:211], v104 offset:17408
  v_mfma_f32_16x16x32_bf16 v[168:171], a[192:195], a[168:171], v[168:171]
  v_mfma_f32_16x16x32_bf16 v[176:179], a[192:195], a[176:179], v[176:179]
  ds_read_b64_tr_b16 a[212:213], v104 offset:24576
  v_mfma_f32_16x16x32_bf16 v[176:179], a[196:199], a[180:183], v[176:179]
  v_mfma_f32_16x16x32_bf16 v[184:187], a[196:199], a[188:191], v[184:187]
  ds_read_b64_tr_b16 a[214:215], v104 offset:25600
  v_mfma_f32_16x16x32_bf16 v[184:187], a[192:195], a[184:187], v[184:187]
  s_waitcnt lgkmcnt(4)
  v_mfma_f32_16x16x32_bf16 v[188:191], a[200:203], a[184:187], v[188:191]
  ds_read_b64_tr_b16 a[216:217], v104 offset:16392
  v_mfma_f32_16x16x32_bf16 v[188:191], a[204:207], a[188:191], v[188:191]
  v_mfma_f32_16x16x32_bf16 v[180:183], a[204:207], a[180:183], v[180:183]
  ds_read_b64_tr_b16 a[218:219], v104 offset:17416
  v_mfma_f32_16x16x32_bf16 v[180:183], a[200:203], a[176:179], v[180:183]
  v_mfma_f32_16x16x32_bf16 v[172:175], a[200:203], a[168:171], v[172:175]
  ds_read_b64_tr_b16 a[220:221], v104 offset:24584
  v_mfma_f32_16x16x32_bf16 v[172:175], a[204:207], a[172:175], v[172:175]
  v_mfma_f32_16x16x32_bf16 v[164:167], a[204:207], a[164:167], v[164:167]
  ds_read_b64_tr_b16 a[222:223], v104 offset:25608
  v_mfma_f32_16x16x32_bf16 v[164:167], a[200:203], a[160:163], v[164:167]
  s_waitcnt lgkmcnt(4)
  s_waitcnt vmcnt(16)
  s_barrier
  v_mfma_f32_16x16x32_bf16 v[128:131], a[208:211], a[160:163], v[128:131]
  ds_read_b64_tr_b16 a[192:193], v108 offset:16384
  v_mfma_f32_16x16x32_bf16 v[128:131], a[212:215], a[164:167], v[128:131]
  v_mfma_f32_16x16x32_bf16 v[136:139], a[212:215], a[172:175], v[136:139]
  ds_read_b64_tr_b16 a[194:195], v108 offset:16896
  v_mfma_f32_16x16x32_bf16 v[136:139], a[208:211], a[168:171], v[136:139]
  v_mfma_f32_16x16x32_bf16 v[144:147], a[208:211], a[176:179], v[144:147]
  ds_read_b64_tr_b16 a[196:197], v108 offset:24576
  v_mfma_f32_16x16x32_bf16 v[144:147], a[212:215], a[180:183], v[144:147]
  v_mfma_f32_16x16x32_bf16 v[152:155], a[212:215], a[188:191], v[152:155]
  ds_read_b64_tr_b16 a[198:199], v108 offset:25088
  v_mfma_f32_16x16x32_bf16 v[152:155], a[208:211], a[184:187], v[152:155]
  s_waitcnt lgkmcnt(4)
  v_mfma_f32_16x16x32_bf16 v[156:159], a[216:219], a[184:187], v[156:159]
  ds_read_b64_tr_b16 a[200:201], v108 offset:18432
  v_mfma_f32_16x16x32_bf16 v[156:159], a[220:223], a[188:191], v[156:159]
  v_mfma_f32_16x16x32_bf16 v[148:151], a[220:223], a[180:183], v[148:151]
  ds_read_b64_tr_b16 a[202:203], v108 offset:18944
  v_mfma_f32_16x16x32_bf16 v[148:151], a[216:219], a[176:179], v[148:151]
  v_mfma_f32_16x16x32_bf16 v[140:143], a[216:219], a[168:171], v[140:143]
  ds_read_b64_tr_b16 a[204:205], v108 offset:26624
  v_mfma_f32_16x16x32_bf16 v[140:143], a[220:223], a[172:175], v[140:143]
  s_waitcnt vmcnt(8)
  v_mfma_f32_16x16x32_bf16 v[132:135], a[220:223], a[164:167], v[132:135]
  ds_read_b64_tr_b16 a[206:207], v108 offset:27136
  v_mfma_f32_16x16x32_bf16 v[132:135], a[216:219], a[160:163], v[132:135]
  s_waitcnt lgkmcnt(4)
  v_mfma_f32_16x16x32_bf16 v[8:11], a[192:195], a[128:131], v[8:11]
  ds_read_b64_tr_b16 a[208:209], v109 offset:16384
  v_mfma_f32_16x16x32_bf16 v[8:11], a[196:199], a[132:135], v[8:11]
  v_mfma_f32_16x16x32_bf16 v[16:19], a[196:199], a[140:143], v[16:19]
  ds_read_b64_tr_b16 a[210:211], v109 offset:16896
  v_mfma_f32_16x16x32_bf16 v[16:19], a[192:195], a[136:139], v[16:19]
  v_mfma_f32_16x16x32_bf16 v[24:27], a[192:195], a[144:147], v[24:27]
  ds_read_b64_tr_b16 a[212:213], v109 offset:24576
  v_mfma_f32_16x16x32_bf16 v[24:27], a[196:199], a[148:151], v[24:27]
  s_add_u32 s42, s42, 512
  v_mfma_f32_16x16x32_bf16 v[32:35], a[196:199], a[156:159], v[32:35]
  ds_read_b64_tr_b16 a[214:215], v109 offset:25088
  v_mfma_f32_16x16x32_bf16 v[32:35], a[192:195], a[152:155], v[32:35]
  s_waitcnt lgkmcnt(4)
  buffer_load_dwordx4 a[160:163], v100, s[32:35], s42 offen offset:0 sc1
  v_mfma_f32_16x16x32_bf16 a[88:91], a[200:203], a[152:155], a[88:91]
  ds_read_b64_tr_b16 a[216:217], v109 offset:18432
  v_mfma_f32_16x16x32_bf16 a[88:91], a[204:207], a[156:159], a[88:91]
  v_mfma_f32_16x16x32_bf16 a[80:83], a[204:207], a[148:151], a[80:83]
  ds_read_b64_tr_b16 a[218:219], v109 offset:18944
  v_mfma_f32_16x16x32_bf16 a[80:83], a[200:203], a[144:147], a[80:83]
  buffer_load_dwordx4 a[164:167], v100, s[32:35], s42 offen offset:256 sc1
  v_mfma_f32_16x16x32_bf16 a[72:75], a[200:203], a[136:139], a[72:75]
  ds_read_b64_tr_b16 a[220:221], v109 offset:26624
  v_mfma_f32_16x16x32_bf16 a[72:75], a[204:207], a[140:143], a[72:75]
  v_mfma_f32_16x16x32_bf16 a[64:67], a[204:207], a[132:135], a[64:67]
  ds_read_b64_tr_b16 a[222:223], v109 offset:27136
  v_mfma_f32_16x16x32_bf16 a[64:67], a[200:203], a[128:131], a[64:67]
  s_waitcnt lgkmcnt(4)
  v_mfma_f32_16x16x32_bf16 v[12:15], a[208:211], a[128:131], v[12:15]
  ds_read_b64_tr_b16 a[192:193], v110 offset:16384
  v_mfma_f32_16x16x32_bf16 v[12:15], a[212:215], a[132:135], v[12:15]
  buffer_load_dwordx4 a[168:171], v101, s[32:35], s42 offen offset:0 sc1
  v_mfma_f32_16x16x32_bf16 v[20:23], a[212:215], a[140:143], v[20:23]
  ds_read_b64_tr_b16 a[194:195], v110 offset:16896
  v_mfma_f32_16x16x32_bf16 v[20:23], a[208:211], a[136:139], v[20:23]
  v_mfma_f32_16x16x32_bf16 v[28:31], a[208:211], a[144:147], v[28:31]
  ds_read_b64_tr_b16 a[196:197], v110 offset:24576
  v_mfma_f32_16x16x32_bf16 v[28:31], a[212:215], a[148:151], v[28:31]
  v_mfma_f32_16x16x32_bf16 v[36:39], a[212:215], a[156:159], v[36:39]
  ds_read_b64_tr_b16 a[198:199], v110 offset:25088
  v_mfma_f32_16x16x32_bf16 v[36:39], a[208:211], a[152:155], v[36:39]
  s_waitcnt lgkmcnt(4)
  buffer_load_dwordx4 a[172:175], v101, s[32:35], s42 offen offset:256 sc1
  v_mfma_f32_16x16x32_bf16 a[92:95], a[216:219], a[152:155], a[92:95]
  ds_read_b64_tr_b16 a[200:201], v110 offset:18432
  v_mfma_f32_16x16x32_bf16 a[92:95], a[220:223], a[156:159], a[92:95]
  v_mfma_f32_16x16x32_bf16 a[84:87], a[220:223], a[148:151], a[84:87]
  ds_read_b64_tr_b16 a[202:203], v110 offset:18944
  v_mfma_f32_16x16x32_bf16 a[84:87], a[216:219], a[144:147], a[84:87]
  v_mfma_f32_16x16x32_bf16 a[76:79], a[216:219], a[136:139], a[76:79]
  ds_read_b64_tr_b16 a[204:205], v110 offset:26624
  v_mfma_f32_16x16x32_bf16 a[76:79], a[220:223], a[140:143], a[76:79]
  buffer_load_dwordx4 a[176:179], v102, s[32:35], s42 offen offset:0 sc1
  v_mfma_f32_16x16x32_bf16 a[68:71], a[220:223], a[132:135], a[68:71]
  ds_read_b64_tr_b16 a[206:207], v110 offset:27136
  v_mfma_f32_16x16x32_bf16 a[68:71], a[216:219], a[128:131], a[68:71]
  s_waitcnt lgkmcnt(4)
  v_mfma_f32_16x16x32_bf16 v[40:43], a[192:195], a[128:131], v[40:43]
  ds_read_b64_tr_b16 a[208:209], v111 offset:16384
  v_mfma_f32_16x16x32_bf16 v[40:43], a[196:199], a[132:135], v[40:43]
  v_mfma_f32_16x16x32_bf16 v[48:51], a[196:199], a[140:143], v[48:51]
  ds_read_b64_tr_b16 a[210:211], v111 offset:16896
  v_mfma_f32_16x16x32_bf16 v[48:51], a[192:195], a[136:139], v[48:51]
  buffer_load_dwordx4 a[180:183], v102, s[32:35], s42 offen offset:256 sc1
  v_mfma_f32_16x16x32_bf16 v[56:59], a[192:195], a[144:147], v[56:59]
  ds_read_b64_tr_b16 a[212:213], v111 offset:24576
  v_mfma_f32_16x16x32_bf16 v[56:59], a[196:199], a[148:151], v[56:59]
  v_mfma_f32_16x16x32_bf16 v[64:67], a[196:199], a[156:159], v[64:67]
  ds_read_b64_tr_b16 a[214:215], v111 offset:25088
  v_mfma_f32_16x16x32_bf16 v[64:67], a[192:195], a[152:155], v[64:67]
  s_waitcnt lgkmcnt(4)
  v_mfma_f32_16x16x32_bf16 a[120:123], a[200:203], a[152:155], a[120:123]
  ds_read_b64_tr_b16 a[216:217], v111 offset:18432
  v_mfma_f32_16x16x32_bf16 a[120:123], a[204:207], a[156:159], a[120:123]
  buffer_load_dwordx4 a[184:187], v103, s[32:35], s42 offen offset:0 sc1
  v_mfma_f32_16x16x32_bf16 a[112:115], a[204:207], a[148:151], a[112:115]
  ds_read_b64_tr_b16 a[218:219], v111 offset:18944
  v_mfma_f32_16x16x32_bf16 a[112:115], a[200:203], a[144:147], a[112:115]
  v_mfma_f32_16x16x32_bf16 a[104:107], a[200:203], a[136:139], a[104:107]
  ds_read_b64_tr_b16 a[220:221], v111 offset:26624
  v_mfma_f32_16x16x32_bf16 a[104:107], a[204:207], a[140:143], a[104:107]
  v_mfma_f32_16x16x32_bf16 a[96:99], a[204:207], a[132:135], a[96:99]
  ds_read_b64_tr_b16 a[222:223], v111 offset:27136
  v_mfma_f32_16x16x32_bf16 a[96:99], a[200:203], a[128:131], a[96:99]
  s_waitcnt lgkmcnt(4)
  buffer_load_dwordx4 a[188:191], v103, s[32:35], s42 offen offset:256 sc1
  v_mfma_f32_16x16x32_bf16 v[44:47], a[208:211], a[128:131], v[44:47]
L_pad_proj02_2:
  s_cbranch_execz L_pad_proj02_3
  ds_read_b64_tr_b16 a[192:193], v107 offset:32768
  v_mfma_f32_16x16x32_bf16 v[44:47], a[212:215], a[132:135], v[44:47]
  v_mfma_f32_16x16x32_bf16 v[52:55], a[212:215], a[140:143], v[52:55]
  s_add_u32 m0, s18, 0
  ds_read_b64_tr_b16 a[194:195], v107 offset:33792
  v_mfma_f32_16x16x32_bf16 v[52:55], a[208:211], a[136:139], v[52:55]
  s_add_u32 s40, s40, 429056
  s_cmp_eq_u32 s83, 6
  s_cmov_b32 s40, s80
  v_mfma_f32_16x16x32_bf16 v[60:63], a[208:211], a[144:147], v[60:63]
  ds_read_b64_tr_b16 a[196:197], v107 offset:40960
  v_mfma_f32_16x16x32_bf16 v[60:63], a[212:215], a[148:151], v[60:63]
  buffer_load_dwordx4 v112, s[20:23], s40 offen offset:0 lds
  v_mfma_f32_16x16x32_bf16 v[68:71], a[212:215], a[156:159], v[68:71]
  ds_read_b64_tr_b16 a[198:199], v107 offset:41984
  v_mfma_f32_16x16x32_bf16 v[68:71], a[208:211], a[152:155], v[68:71]
  s_waitcnt lgkmcnt(4)
  v_mfma_f32_16x16x32_bf16 a[124:127], a[216:219], a[152:155], a[124:127]
  ds_read_b64_tr_b16 a[200:201], v107 offset:32776
  v_mfma_f32_16x16x32_bf16 a[124:127], a[220:223], a[156:159], a[124:127]
  s_add_u32 s40, s40, 31744
  v_mfma_f32_16x16x32_bf16 a[116:119], a[220:223], a[148:151], a[116:119]
  ds_read_b64_tr_b16 a[202:203], v107 offset:33800
  v_mfma_f32_16x16x32_bf16 a[116:119], a[216:219], a[144:147], a[116:119]
  buffer_load_dwordx4 v112, s[20:23], s40 offen offset:1024 lds
  v_mfma_f32_16x16x32_bf16 a[108:111], a[216:219], a[136:139], a[108:111]
  ds_read_b64_tr_b16 a[204:205], v107 offset:40968
  v_mfma_f32_16x16x32_bf16 a[108:111], a[220:223], a[140:143], a[108:111]
  v_mfma_f32_16x16x32_bf16 a[100:103], a[220:223], a[132:135], a[100:103]
  ds_read_b64_tr_b16 a[206:207], v107 offset:41992
  v_mfma_f32_16x16x32_bf16 a[100:103], a[216:219], a[128:131], a[100:103]
  s_waitcnt lgkmcnt(4)
  s_add_u32 s40, s40, 31744
  v_mfma_f32_16x16x32_bf16 v[224:227], a[192:195], a[128:131], v[224:227]
  ds_read_b64_tr_b16 a[208:209], v106 offset:32768
  v_mfma_f32_16x16x32_bf16 v[224:227], a[196:199], a[132:135], v[224:227]
  buffer_load_dwordx4 v112, s[20:23], s40 offen offset:2048 lds
  v_mfma_f32_16x16x32_bf16 v[232:235], a[196:199], a[140:143], v[232:235]
  ds_read_b64_tr_b16 a[210:211], v106 offset:33792
  v_mfma_f32_16x16x32_bf16 v[232:235], a[192:195], a[136:139], v[232:235]
  s_add_u32 s40, s40, 31744
  v_mfma_f32_16x16x32_bf16 v[240:243], a[192:195], a[144:147], v[240:243]
  ds_read_b64_tr_b16 a[212:213], v106 offset:40960
  v_mfma_f32_16x16x32_bf16 v[240:243], a[196:199], a[148:151], v[240:243]
  buffer_load_dwordx4 v112, s[20:23], s40 offen offset:3072 lds
  v_mfma_f32_16x16x32_bf16 v[248:251], a[196:199], a[156:159], v[248:251]
  ds_read_b64_tr_b16 a[214:215], v106 offset:41984
  v_mfma_f32_16x16x32_bf16 v[248:251], a[192:195], a[152:155], v[248:251]
  s_waitcnt lgkmcnt(4)
  v_mfma_f32_16x16x32_bf16 v[252:255], a[200:203], a[152:155], v[252:255]
  s_add_u32 m0, s18, 114688
  ds_read_b64_tr_b16 a[216:217], v106 offset:32776
  v_mfma_f32_16x16x32_bf16 v[252:255], a[204:207], a[156:159], v[252:255]
  s_add_u32 s41, s41, 221184
  s_cmp_eq_u32 s83, 6
  s_cmov_b32 s41, s81
  v_mfma_f32_16x16x32_bf16 v[244:247], a[204:207], a[148:151], v[244:247]
  ds_read_b64_tr_b16 a[218:219], v106 offset:33800
  v_mfma_f32_16x16x32_bf16 v[244:247], a[200:203], a[144:147], v[244:247]
  buffer_load_dwordx4 v113, s[24:27], s41 offen offset:0 lds
  v_mfma_f32_16x16x32_bf16 v[236:239], a[200:203], a[136:139], v[236:239]
  ds_read_b64_tr_b16 a[220:221], v106 offset:40968
  v_mfma_f32_16x16x32_bf16 v[236:239], a[204:207], a[140:143], v[236:239]
  v_mfma_f32_16x16x32_bf16 v[228:231], a[204:207], a[132:135], v[228:231]
  ds_read_b64_tr_b16 a[222:223], v106 offset:41992
  v_mfma_f32_16x16x32_bf16 v[228:231], a[200:203], a[128:131], v[228:231]
  s_waitcnt lgkmcnt(4)
  v_mfma_f32_16x16x32_bf16 v[192:195], a[208:211], a[128:131], v[192:195]
  ds_read_b64_tr_b16 a[192:193], v105 offset:32768
  v_mfma_f32_16x16x32_bf16 v[192:195], a[212:215], a[132:135], v[192:195]
  buffer_load_dwordx4 v114, s[24:27], s41 offen offset:1024 lds
  v_mfma_f32_16x16x32_bf16 v[200:203], a[212:215], a[140:143], v[200:203]
  ds_read_b64_tr_b16 a[194:195], v105 offset:33792
  v_mfma_f32_16x16x32_bf16 v[200:203], a[208:211], a[136:139], v[200:203]
  v_mfma_f32_16x16x32_bf16 v[208:211], a[208:211], a[144:147], v[208:211]
  ds_read_b64_tr_b16 a[196:197], v105 offset:40960
  v_mfma_f32_16x16x32_bf16 v[208:211], a[212:215], a[148:151], v[208:211]
  s_add_u32 m0, s18, 116736
  v_mfma_f32_16x16x32_bf16 v[216:219], a[212:215], a[156:159], v[216:219]
  ds_read_b64_tr_b16 a[198:199], v105 offset:41984
  v_mfma_f32_16x16x32_bf16 v[216:219], a[208:211], a[152:155], v[216:219]
  s_waitcnt lgkmcnt(4)
  buffer_load_dwordx4 v113, s[28:31], s41 offen offset:0 lds
  v_mfma_f32_16x16x32_bf16 v[220:223], a[216:219], a[152:155], v[220:223]
  ds_read_b64_tr_b16 a[200:201], v105 offset:32776
  v_mfma_f32_16x16x32_bf16 v[220:223], a[220:223], a[156:159], v[220:223]
  v_mfma_f32_16x16x32_bf16 v[212:215], a[220:223], a[148:151], v[212:215]
  ds_read_b64_tr_b16 a[202:203], v105 offset:33800
  v_mfma_f32_16x16x32_bf16 v[212:215], a[216:219], a[144:147], v[212:215]
  v_mfma_f32_16x16x32_bf16 v[204:207], a[216:219], a[136:139], v[204:207]
  ds_read_b64_tr_b16 a[204:205], v105 offset:40968
  v_mfma_f32_16x16x32_bf16 v[204:207], a[220:223], a[140:143], v[204:207]
  buffer_load_dwordx4 v114, s[28:31], s41 offen offset:1024 lds
  v_mfma_f32_16x16x32_bf16 v[196:199], a[220:223], a[132:135], v[196:199]
  ds_read_b64_tr_b16 a[206:207], v105 offset:41992
  v_mfma_f32_16x16x32_bf16 v[196:199], a[216:219], a[128:131], v[196:199]
  s_waitcnt lgkmcnt(4)
  v_mfma_f32_16x16x32_bf16 v[160:163], a[192:195], a[128:131], v[160:163]
  ds_read_b64_tr_b16 a[208:209], v104 offset:32768
  v_mfma_f32_16x16x32_bf16 v[160:163], a[196:199], a[132:135], v[160:163]
  v_mfma_f32_16x16x32_bf16 v[168:171], a[196:199], a[140:143], v[168:171]
  ds_read_b64_tr_b16 a[210:211], v104 offset:33792
  v_mfma_f32_16x16x32_bf16 v[168:171], a[192:195], a[136:139], v[168:171]
  v_mfma_f32_16x16x32_bf16 v[176:179], a[192:195], a[144:147], v[176:179]
  ds_read_b64_tr_b16 a[212:213], v104 offset:40960
  v_mfma_f32_16x16x32_bf16 v[176:179], a[196:199], a[148:151], v[176:179]
  v_mfma_f32_16x16x32_bf16 v[184:187], a[196:199], a[156:159], v[184:187]
  ds_read_b64_tr_b16 a[214:215], v104 offset:41984
  v_mfma_f32_16x16x32_bf16 v[184:187], a[192:195], a[152:155], v[184:187]
  s_waitcnt lgkmcnt(4)
  v_mfma_f32_16x16x32_bf16 v[188:191], a[200:203], a[152:155], v[188:191]
  ds_read_b64_tr_b16 a[216:217], v104 offset:32776
  v_mfma_f32_16x16x32_bf16 v[188:191], a[204:207], a[156:159], v[188:191]
  v_mfma_f32_16x16x32_bf16 v[180:183], a[204:207], a[148:151], v[180:183]
  ds_read_b64_tr_b16 a[218:219], v104 offset:33800
  v_mfma_f32_16x16x32_bf16 v[180:183], a[200:203], a[144:147], v[180:183]
  v_mfma_f32_16x16x32_bf16 v[172:175], a[200:203], a[136:139], v[172:175]
  ds_read_b64_tr_b16 a[220:221], v104 offset:40968
  v_mfma_f32_16x16x32_bf16 v[172:175], a[204:207], a[140:143], v[172:175]
  v_mfma_f32_16x16x32_bf16 v[164:167], a[204:207], a[132:135], v[164:167]
  ds_read_b64_tr_b16 a[222:223], v104 offset:41992
  v_mfma_f32_16x16x32_bf16 v[164:167], a[200:203], a[128:131], v[164:167]
  s_waitcnt lgkmcnt(4)
  s_waitcnt vmcnt(16)
  s_barrier
  v_mfma_f32_16x16x32_bf16 v[128:131], a[208:211], a[128:131], v[128:131]
  ds_read_b64_tr_b16 a[192:193], v108 offset:0
  v_mfma_f32_16x16x32_bf16 v[128:131], a[212:215], a[132:135], v[128:131]
  v_mfma_f32_16x16x32_bf16 v[136:139], a[212:215], a[140:143], v[136:139]
  ds_read_b64_tr_b16 a[194:195], v108 offset:512
  v_mfma_f32_16x16x32_bf16 v[136:139], a[208:211], a[136:139], v[136:139]
  v_mfma_f32_16x16x32_bf16 v[144:147], a[208:211], a[144:147], v[144:147]
  ds_read_b64_tr_b16 a[196:197], v108 offset:8192
  v_mfma_f32_16x16x32_bf16 v[144:147], a[212:215], a[148:151], v[144:147]
  v_mfma_f32_16x16x32_bf16 v[152:155], a[212:215], a[156:159], v[152:155]
  ds_read_b64_tr_b16 a[198:199], v108 offset:8704
  v_mfma_f32_16x16x32_bf16 v[152:155], a[208:211], a[152:155], v[152:155]
  s_waitcnt lgkmcnt(4)
  v_mfma_f32_16x16x32_bf16 v[156:159], a[216:219], a[152:155], v[156:159]
  ds_read_b64_tr_b16 a[200:201], v108 offset:2048
  v_mfma_f32_16x16x32_bf16 v[156:159], a[220:223], a[156:159], v[156:159]
  v_mfma_f32_16x16x32_bf16 v[148:151], a[220:223], a[148:151], v[148:151]
  ds_read_b64_tr_b16 a[202:203], v108 offset:2560
  v_mfma_f32_16x16x32_bf16 v[148:151], a[216:219], a[144:147], v[148:151]
  v_mfma_f32_16x16x32_bf16 v[140:143], a[216:219], a[136:139], v[140:143]
  ds_read_b64_tr_b16 a[204:205], v108 offset:10240
  v_mfma_f32_16x16x32_bf16 v[140:143], a[220:223], a[140:143], v[140:143]
  s_waitcnt vmcnt(8)
  v_mfma_f32_16x16x32_bf16 v[132:135], a[220:223], a[132:135], v[132:135]
  ds_read_b64_tr_b16 a[206:207], v108 offset:10752
  v_mfma_f32_16x16x32_bf16 v[132:135], a[216:219], a[128:131], v[132:135]
  s_waitcnt lgkmcnt(4)
  v_mfma_f32_16x16x32_bf16 v[8:11], a[192:195], a[160:163], v[8:11]
  ds_read_b64_tr_b16 a[208:209], v109 offset:0
  v_mfma_f32_16x16x32_bf16 v[8:11], a[196:199], a[164:167], v[8:11]
  v_mfma_f32_16x16x32_bf16 v[16:19], a[196:199], a[172:175], v[16:19]
  ds_read_b64_tr_b16 a[210:211], v109 offset:512
  v_mfma_f32_16x16x32_bf16 v[16:19], a[192:195], a[168:171], v[16:19]
  v_mfma_f32_16x16x32_bf16 v[24:27], a[192:195], a[176:179], v[24:27]
  ds_read_b64_tr_b16 a[212:213], v109 offset:8192
  v_mfma_f32_16x16x32_bf16 v[24:27], a[196:199], a[180:183], v[24:27]
  s_add_u32 s42, s42, 512
  s_cmp_eq_u32 s83, 6
  s_cmov_b32 s42, s82
  v_mfma_f32_16x16x32_bf16 v[32:35], a[196:199], a[188:191], v[32:35]
  ds_read_b64_tr_b16 a[214:215], v109 offset:8704
  v_mfma_f32_16x16x32_bf16 v[32:35], a[192:195], a[184:187], v[32:35]
  s_waitcnt lgkmcnt(4)
  buffer_load_dwordx4 a[128:131], v100, s[32:35], s42 offen offset:0 sc1
  v_mfma_f32_16x16x32_bf16 a[88:91], a[200:203], a[184:187], a[88:91]
  ds_read_b64_tr_b16 a[216:217], v109 offset:2048
  v_mfma_f32_16x16x32_bf16 a[88:91], a[204:207], a[188:191], a[88:91]
  v_mfma_f32_16x16x32_bf16 a[80:83], a[204:207], a[180:183], a[80:83]
  ds_read_b64_tr_b16 a[218:219], v109 offset:2560
  v_mfma_f32_16x16x32_bf16 a[80:83], a[200:203], a[176:179], a[80:83]
  buffer_load_dwordx4 a[132:135], v100, s[32:35], s42 offen offset:256 sc1
  v_mfma_f32_16x16x32_bf16 a[72:75], a[200:203], a[168:171], a[72:75]
  ds_read_b64_tr_b16 a[220:221], v109 offset:10240
  v_mfma_f32_16x16x32_bf16 a[72:75], a[204:207], a[172:175], a[72:75]
  v_mfma_f32_16x16x32_bf16 a[64:67], a[204:207], a[164:167], a[64:67]
  ds_read_b64_tr_b16 a[222:223], v109 offset:10752
  v_mfma_f32_16x16x32_bf16 a[64:67], a[200:203], a[160:163], a[64:67]
  s_waitcnt lgkmcnt(4)
  v_mfma_f32_16x16x32_bf16 v[12:15], a[208:211], a[160:163], v[12:15]
  ds_read_b64_tr_b16 a[192:193], v110 offset:0
  v_mfma_f32_16x16x32_bf16 v[12:15], a[212:215], a[164:167], v[12:15]
  buffer_load_dwordx4 a[136:139], v101, s[32:35], s42 offen offset:0 sc1
  v_mfma_f32_16x16x32_bf16 v[20:23], a[212:215], a[172:175], v[20:23]
  ds_read_b64_tr_b16 a[194:195], v110 offset:512
  v_mfma_f32_16x16x32_bf16 v[20:23], a[208:211], a[168:171], v[20:23]
  v_mfma_f32_16x16x32_bf16 v[28:31], a[208:211], a[176:179], v[28:31]
  ds_read_b64_tr_b16 a[196:197], v110 offset:8192
  v_mfma_f32_16x16x32_bf16 v[28:31], a[212:215], a[180:183], v[28:31]
  buffer_load_dwordx4 a[140:143], v101, s[32:35], s42 offen offset:256 sc1
  v_mfma_f32_16x16x32_bf16 v[36:39], a[212:215], a[188:191], v[36:39]
  ds_read_b64_tr_b16 a[198:199], v110 offset:8704
  v_mfma_f32_16x16x32_bf16 v[36:39], a[208:211], a[184:187], v[36:39]
  s_waitcnt lgkmcnt(4)
  v_mfma_f32_16x16x32_bf16 a[92:95], a[216:219], a[184:187], a[92:95]
  ds_read_b64_tr_b16 a[200:201], v110 offset:2048
  v_mfma_f32_16x16x32_bf16 a[92:95], a[220:223], a[188:191], a[92:95]
  v_mfma_f32_16x16x32_bf16 a[84:87], a[220:223], a[180:183], a[84:87]
  ds_read_b64_tr_b16 a[202:203], v110 offset:2560
  v_mfma_f32_16x16x32_bf16 a[84:87], a[216:219], a[176:179], a[84:87]
  buffer_load_dwordx4 a[144:147], v102, s[32:35], s42 offen offset:0 sc1
  v_mfma_f32_16x16x32_bf16 a[76:79], a[216:219], a[168:171], a[76:79]
  ds_read_b64_tr_b16 a[204:205], v110 offset:10240
  v_mfma_f32_16x16x32_bf16 a[76:79], a[220:223], a[172:175], a[76:79]
  v_mfma_f32_16x16x32_bf16 a[68:71], a[220:223], a[164:167], a[68:71]
  ds_read_b64_tr_b16 a[206:207], v110 offset:10752
  v_mfma_f32_16x16x32_bf16 a[68:71], a[216:219], a[160:163], a[68:71]
  s_waitcnt lgkmcnt(4)
  v_mfma_f32_16x16x32_bf16 v[40:43], a[192:195], a[160:163], v[40:43]
  ds_read_b64_tr_b16 a[208:209], v111 offset:0
  v_mfma_f32_16x16x32_bf16 v[40:43], a[196:199], a[164:167], v[40:43]
  buffer_load_dwordx4 a[148:151], v102, s[32:35], s42 offen offset:256 sc1
  v_mfma_f32_16x16x32_bf16 v[48:51], a[196:199], a[172:175], v[48:51]
  ds_read_b64_tr_b16 a[210:211], v111 offset:512
  v_mfma_f32_16x16x32_bf16 v[48:51], a[192:195], a[168:171], v[48:51]
  v_mfma_f32_16x16x32_bf16 v[56:59], a[192:195], a[176:179], v[56:59]
  ds_read_b64_tr_b16 a[212:213], v111 offset:8192
  v_mfma_f32_16x16x32_bf16 v[56:59], a[196:199], a[180:183], v[56:59]
  buffer_load_dwordx4 a[152:155], v103, s[32:35], s42 offen offset:0 sc1
  v_mfma_f32_16x16x32_bf16 v[64:67], a[196:199], a[188:191], v[64:67]
  ds_read_b64_tr_b16 a[214:215], v111 offset:8704
  v_mfma_f32_16x16x32_bf16 v[64:67], a[192:195], a[184:187], v[64:67]
  s_waitcnt lgkmcnt(4)
  v_mfma_f32_16x16x32_bf16 a[120:123], a[200:203], a[184:187], a[120:123]
  ds_read_b64_tr_b16 a[216:217], v111 offset:2048
  v_mfma_f32_16x16x32_bf16 a[120:123], a[204:207], a[188:191], a[120:123]
  v_mfma_f32_16x16x32_bf16 a[112:115], a[204:207], a[180:183], a[112:115]
  ds_read_b64_tr_b16 a[218:219], v111 offset:2560
  v_mfma_f32_16x16x32_bf16 a[112:115], a[200:203], a[176:179], a[112:115]
  buffer_load_dwordx4 a[156:159], v103, s[32:35], s42 offen offset:256 sc1
  v_mfma_f32_16x16x32_bf16 a[104:107], a[200:203], a[168:171], a[104:107]
  ds_read_b64_tr_b16 a[220:221], v111 offset:10240
  v_mfma_f32_16x16x32_bf16 a[104:107], a[204:207], a[172:175], a[104:107]
  v_mfma_f32_16x16x32_bf16 a[96:99], a[204:207], a[164:167], a[96:99]
  s_add_u32 m0, s18, 16384
  ds_read_b64_tr_b16 a[222:223], v111 offset:10752
  v_mfma_f32_16x16x32_bf16 a[96:99], a[200:203], a[160:163], a[96:99]
  s_waitcnt lgkmcnt(4)
  s_add_u32 s40, s40, 429056
  v_mfma_f32_16x16x32_bf16 v[44:47], a[208:211], a[160:163], v[44:47]
  ds_read_b64_tr_b16 a[192:193], v107 offset:49152
  v_mfma_f32_16x16x32_bf16 v[44:47], a[212:215], a[164:167], v[44:47]
  buffer_load_dwordx4 v112, s[20:23], s40 offen offset:0 lds
  v_mfma_f32_16x16x32_bf16 v[52:55], a[212:215], a[172:175], v[52:55]
  ds_read_b64_tr_b16 a[194:195], v107 offset:50176
  v_mfma_f32_16x16x32_bf16 v[52:55], a[208:211], a[168:171], v[52:55]
  s_add_u32 s40, s40, 31744
  v_mfma_f32_16x16x32_bf16 v[60:63], a[208:211], a[176:179], v[60:63]
  ds_read_b64_tr_b16 a[196:197], v107 offset:57344
  v_mfma_f32_16x16x32_bf16 v[60:63], a[212:215], a[180:183], v[60:63]
  buffer_load_dwordx4 v112, s[20:23], s40 offen offset:1024 lds
  v_mfma_f32_16x16x32_bf16 v[68:71], a[212:215], a[188:191], v[68:71]
  ds_read_b64_tr_b16 a[198:199], v107 offset:58368
  v_mfma_f32_16x16x32_bf16 v[68:71], a[208:211], a[184:187], v[68:71]
  s_waitcnt lgkmcnt(4)
  v_mfma_f32_16x16x32_bf16 a[124:127], a[216:219], a[184:187], a[124:127]
  ds_read_b64_tr_b16 a[200:201], v107 offset:49160
  v_mfma_f32_16x16x32_bf16 a[124:127], a[220:223], a[188:191], a[124:127]
  s_add_u32 s40, s40, 31744
  v_mfma_f32_16x16x32_bf16 a[116:119], a[220:223], a[180:183], a[116:119]
  ds_read_b64_tr_b16 a[202:203], v107 offset:50184
  v_mfma_f32_16x16x32_bf16 a[116:119], a[216:219], a[176:179], a[116:119]
  buffer_load_dwordx4 v112, s[20:23], s40 offen offset:2048 lds
  v_mfma_f32_16x16x32_bf16 a[108:111], a[216:219], a[168:171], a[108:111]
  ds_read_b64_tr_b16 a[204:205], v107 offset:57352
  v_mfma_f32_16x16x32_bf16 a[108:111], a[220:223], a[172:175], a[108:111]
  v_mfma_f32_16x16x32_bf16 a[100:103], a[220:223], a[164:167], a[100:103]
  ds_read_b64_tr_b16 a[206:207], v107 offset:58376
  v_mfma_f32_16x16x32_bf16 a[100:103], a[216:219], a[160:163], a[100:103]
  s_waitcnt lgkmcnt(4)
  v_mfma_f32_16x16x32_bf16 v[224:227], a[192:195], a[160:163], v[224:227]
  ds_read_b64_tr_b16 a[208:209], v106 offset:49152
  v_mfma_f32_16x16x32_bf16 v[224:227], a[196:199], a[164:167], v[224:227]
  buffer_store_dwordx4 a[32:35], v3, s[32:35], s86 offen offset:0 sc1
  v_mfma_f32_16x16x32_bf16 v[232:235], a[196:199], a[172:175], v[232:235]
  ds_read_b64_tr_b16 a[210:211], v106 offset:50176
  v_mfma_f32_16x16x32_bf16 v[232:235], a[192:195], a[168:171], v[232:235]
  v_mfma_f32_16x16x32_bf16 v[240:243], a[192:195], a[176:179], v[240:243]
  ds_read_b64_tr_b16 a[212:213], v106 offset:57344
  v_mfma_f32_16x16x32_bf16 v[240:243], a[196:199], a[180:183], v[240:243]
  v_mfma_f32_16x16x32_bf16 v[248:251], a[196:199], a[188:191], v[248:251]
  ds_read_b64_tr_b16 a[214:215], v106 offset:58368
  v_mfma_f32_16x16x32_bf16 v[248:251], a[192:195], a[184:187], v[248:251]
  s_waitcnt lgkmcnt(4)
  v_mfma_f32_16x16x32_bf16 v[252:255], a[200:203], a[184:187], v[252:255]
  ds_read_b64_tr_b16 a[216:217], v106 offset:49160
  v_mfma_f32_16x16x32_bf16 v[252:255], a[204:207], a[188:191], v[252:255]
  v_mfma_f32_16x16x32_bf16 v[244:247], a[204:207], a[180:183], v[244:247]
  ds_read_b64_tr_b16 a[218:219], v106 offset:50184
  v_mfma_f32_16x16x32_bf16 v[244:247], a[200:203], a[176:179], v[244:247]
  v_mfma_f32_16x16x32_bf16 v[236:239], a[200:203], a[168:171], v[236:239]
  ds_read_b64_tr_b16 a[220:221], v106 offset:57352
  v_mfma_f32_16x16x32_bf16 v[236:239], a[204:207], a[172:175], v[236:239]
  s_add_u32 s40, s40, 31744
  v_mfma_f32_16x16x32_bf16 v[228:231], a[204:207], a[164:167], v[228:231]
  ds_read_b64_tr_b16 a[222:223], v106 offset:58376
  v_mfma_f32_16x16x32_bf16 v[228:231], a[200:203], a[160:163], v[228:231]
  s_waitcnt lgkmcnt(4)
  buffer_load_dwordx4 v112, s[20:23], s40 offen offset:3072 lds
  v_mfma_f32_16x16x32_bf16 v[192:195], a[208:211], a[160:163], v[192:195]
  ds_read_b64_tr_b16 a[192:193], v105 offset:49152
  v_mfma_f32_16x16x32_bf16 v[192:195], a[212:215], a[164:167], v[192:195]
  v_mfma_f32_16x16x32_bf16 v[200:203], a[212:215], a[172:175], v[200:203]
  s_add_u32 m0, s18, 98304
  ds_read_b64_tr_b16 a[194:195], v105 offset:50176
  v_mfma_f32_16x16x32_bf16 v[200:203], a[208:211], a[168:171], v[200:203]
  s_add_u32 s41, s41, 221184
  v_mfma_f32_16x16x32_bf16 v[208:211], a[208:211], a[176:179], v[208:211]
  ds_read_b64_tr_b16 a[196:197], v105 offset:57344
  v_mfma_f32_16x16x32_bf16 v[208:211], a[212:215], a[180:183], v[208:211]
  buffer_load_dwordx4 v113, s[24:27], s41 offen offset:0 lds
  v_mfma_f32_16x16x32_bf16 v[216:219], a[212:215], a[188:191], v[216:219]
  ds_read_b64_tr_b16 a[198:199], v105 offset:58368
  v_mfma_f32_16x16x32_bf16 v[216:219], a[208:211], a[184:187], v[216:219]
  s_waitcnt lgkmcnt(4)
  v_mfma_f32_16x16x32_bf16 v[220:223], a[216:219], a[184:187], v[220:223]
  ds_read_b64_tr_b16 a[200:201], v105 offset:49160
  v_mfma_f32_16x16x32_bf16 v[220:223], a[220:223], a[188:191], v[220:223]
  v_mfma_f32_16x16x32_bf16 v[212:215], a[220:223], a[180:183], v[212:215]
  ds_read_b64_tr_b16 a[202:203], v105 offset:50184
  v_mfma_f32_16x16x32_bf16 v[212:215], a[216:219], a[176:179], v[212:215]
  buffer_store_dwordx4 a[32:35], v3, s[32:35], s86 offen offset:1024 sc1
  v_mfma_f32_16x16x32_bf16 v[204:207], a[216:219], a[168:171], v[204:207]
  ds_read_b64_tr_b16 a[204:205], v105 offset:57352
  v_mfma_f32_16x16x32_bf16 v[204:207], a[220:223], a[172:175], v[204:207]
  v_mfma_f32_16x16x32_bf16 v[196:199], a[220:223], a[164:167], v[196:199]
  ds_read_b64_tr_b16 a[206:207], v105 offset:58376
  v_mfma_f32_16x16x32_bf16 v[196:199], a[216:219], a[160:163], v[196:199]
  s_waitcnt lgkmcnt(4)
  v_mfma_f32_16x16x32_bf16 v[160:163], a[192:195], a[160:163], v[160:163]
  ds_read_b64_tr_b16 a[208:209], v104 offset:49152
  v_mfma_f32_16x16x32_bf16 v[160:163], a[196:199], a[164:167], v[160:163]
  v_mfma_f32_16x16x32_bf16 v[168:171], a[196:199], a[172:175], v[168:171]
  ds_read_b64_tr_b16 a[210:211], v104 offset:50176
  v_mfma_f32_16x16x32_bf16 v[168:171], a[192:195], a[168:171], v[168:171]
  v_mfma_f32_16x16x32_bf16 v[176:179], a[192:195], a[176:179], v[176:179]
  ds_read_b64_tr_b16 a[212:213], v104 offset:57344
  v_mfma_f32_16x16x32_bf16 v[176:179], a[196:199], a[180:183], v[176:179]
  v_mfma_f32_16x16x32_bf16 v[184:187], a[196:199], a[188:191], v[184:187]
  ds_read_b64_tr_b16 a[214:215], v104 offset:58368
  v_mfma_f32_16x16x32_bf16 v[184:187], a[192:195], a[184:187], v[184:187]
  s_waitcnt lgkmcnt(4)
  v_mfma_f32_16x16x32_bf16 v[188:191], a[200:203], a[184:187], v[188:191]
  ds_read_b64_tr_b16 a[216:217], v104 offset:49160
  v_mfma_f32_16x16x32_bf16 v[188:191], a[204:207], a[188:191], v[188:191]
  v_mfma_f32_16x16x32_bf16 v[180:183], a[204:207], a[180:183], v[180:183]
  ds_read_b64_tr_b16 a[218:219], v104 offset:50184
  v_mfma_f32_16x16x32_bf16 v[180:183], a[200:203], a[176:179], v[180:183]
  buffer_load_dwordx4 v114, s[24:27], s41 offen offset:1024 lds
  v_mfma_f32_16x16x32_bf16 v[172:175], a[200:203], a[168:171], v[172:175]
  ds_read_b64_tr_b16 a[220:221], v104 offset:57352
  v_mfma_f32_16x16x32_bf16 v[172:175], a[204:207], a[172:175], v[172:175]
  s_add_u32 m0, s18, 100352
  v_mfma_f32_16x16x32_bf16 v[164:167], a[204:207], a[164:167], v[164:167]
  ds_read_b64_tr_b16 a[222:223], v104 offset:58376
  v_mfma_f32_16x16x32_bf16 v[164:167], a[200:203], a[160:163], v[164:167]
  s_waitcnt lgkmcnt(4)
  s_waitcnt vmcnt(16)
  s_barrier
  buffer_load_dwordx4 v113, s[28:31], s41 offen offset:0 lds
  v_mfma_f32_16x16x32_bf16 v[128:131], a[208:211], a[160:163], v[128:131]
  ds_read_b64_tr_b16 a[192:193], v108 offset:49152
  v_mfma_f32_16x16x32_bf16 v[128:131], a[212:215], a[164:167], v[128:131]
  v_mfma_f32_16x16x32_bf16 v[136:139], a[212:215], a[172:175], v[136:139]
  ds_read_b64_tr_b16 a[194:195], v108 offset:49664
  v_mfma_f32_16x16x32_bf16 v[136:139], a[208:211], a[168:171], v[136:139]
  v_mfma_f32_16x16x32_bf16 v[144:147], a[208:211], a[176:179], v[144:147]
  ds_read_b64_tr_b16 a[196:197], v108 offset:57344
  v_mfma_f32_16x16x32_bf16 v[144:147], a[212:215], a[180:183], v[144:147]
  buffer_load_dwordx4 v114, s[28:31], s41 offen offset:1024 lds
  v_mfma_f32_16x16x32_bf16 v[152:155], a[212:215], a[188:191], v[152:155]
  ds_read_b64_tr_b16 a[198:199], v108 offset:57856
  v_mfma_f32_16x16x32_bf16 v[152:155], a[208:211], a[184:187], v[152:155]
  s_waitcnt lgkmcnt(4)
  v_mfma_f32_16x16x32_bf16 v[156:159], a[216:219], a[184:187], v[156:159]
  ds_read_b64_tr_b16 a[200:201], v108 offset:51200
  v_mfma_f32_16x16x32_bf16 v[156:159], a[220:223], a[188:191], v[156:159]
  v_mfma_f32_16x16x32_bf16 v[148:151], a[220:223], a[180:183], v[148:151]
  ds_read_b64_tr_b16 a[202:203], v108 offset:51712
  v_mfma_f32_16x16x32_bf16 v[148:151], a[216:219], a[176:179], v[148:151]
  v_mfma_f32_16x16x32_bf16 v[140:143], a[216:219], a[168:171], v[140:143]
  ds_read_b64_tr_b16 a[204:205], v108 offset:59392
  v_mfma_f32_16x16x32_bf16 v[140:143], a[220:223], a[172:175], v[140:143]
  s_waitcnt vmcnt(10)
  v_mfma_f32_16x16x32_bf16 v[132:135], a[220:223], a[164:167], v[132:135]
  ds_read_b64_tr_b16 a[206:207], v108 offset:59904
  v_mfma_f32_16x16x32_bf16 v[132:135], a[216:219], a[160:163], v[132:135]
  s_waitcnt lgkmcnt(4)
  v_mfma_f32_16x16x32_bf16 v[8:11], a[192:195], a[128:131], v[8:11]
  ds_read_b64_tr_b16 a[208:209], v109 offset:49152
  v_mfma_f32_16x16x32_bf16 v[8:11], a[196:199], a[132:135], v[8:11]
  v_mfma_f32_16x16x32_bf16 v[16:19], a[196:199], a[140:143], v[16:19]
  ds_read_b64_tr_b16 a[210:211], v109 offset:49664
  v_mfma_f32_16x16x32_bf16 v[16:19], a[192:195], a[136:139], v[16:19]
  v_mfma_f32_16x16x32_bf16 v[24:27], a[192:195], a[144:147], v[24:27]
  ds_read_b64_tr_b16 a[212:213], v109 offset:57344
  v_mfma_f32_16x16x32_bf16 v[24:27], a[196:199], a[148:151], v[24:27]
  s_add_u32 s42, s42, 512
  v_mfma_f32_16x16x32_bf16 v[32:35], a[196:199], a[156:159], v[32:35]
  ds_read_b64_tr_b16 a[214:215], v109 offset:57856
  v_mfma_f32_16x16x32_bf16 v[32:35], a[192:195], a[152:155], v[32:35]
  s_waitcnt lgkmcnt(4)
  buffer_load_dwordx4 a[160:163], v100, s[32:35], s42 offen offset:0 sc1
  v_mfma_f32_16x16x32_bf16 a[88:91], a[200:203], a[152:155], a[88:91]
  ds_read_b64_tr_b16 a[216:217], v109 offset:51200
  v_mfma_f32_16x16x32_bf16 a[88:91], a[204:207], a[156:159], a[88:91]
  v_mfma_f32_16x16x32_bf16 a[80:83], a[204:207], a[148:151], a[80:83]
  ds_read_b64_tr_b16 a[218:219], v109 offset:51712
  v_mfma_f32_16x16x32_bf16 a[80:83], a[200:203], a[144:147], a[80:83]
  buffer_load_dwordx4 a[164:167], v100, s[32:35], s42 offen offset:256 sc1
  v_mfma_f32_16x16x32_bf16 a[72:75], a[200:203], a[136:139], a[72:75]
  ds_read_b64_tr_b16 a[220:221], v109 offset:59392
  v_mfma_f32_16x16x32_bf16 a[72:75], a[204:207], a[140:143], a[72:75]
  v_mfma_f32_16x16x32_bf16 a[64:67], a[204:207], a[132:135], a[64:67]
  ds_read_b64_tr_b16 a[222:223], v109 offset:59904
  v_mfma_f32_16x16x32_bf16 a[64:67], a[200:203], a[128:131], a[64:67]
  s_waitcnt lgkmcnt(4)
  v_mfma_f32_16x16x32_bf16 v[12:15], a[208:211], a[128:131], v[12:15]
  ds_read_b64_tr_b16 a[192:193], v110 offset:49152
  v_mfma_f32_16x16x32_bf16 v[12:15], a[212:215], a[132:135], v[12:15]
  buffer_load_dwordx4 a[168:171], v101, s[32:35], s42 offen offset:0 sc1
  v_mfma_f32_16x16x32_bf16 v[20:23], a[212:215], a[140:143], v[20:23]
  ds_read_b64_tr_b16 a[194:195], v110 offset:49664
  v_mfma_f32_16x16x32_bf16 v[20:23], a[208:211], a[136:139], v[20:23]
  v_mfma_f32_16x16x32_bf16 v[28:31], a[208:211], a[144:147], v[28:31]
  ds_read_b64_tr_b16 a[196:197], v110 offset:57344
  v_mfma_f32_16x16x32_bf16 v[28:31], a[212:215], a[148:151], v[28:31]
  buffer_load_dwordx4 a[172:175], v101, s[32:35], s42 offen offset:256 sc1
  v_mfma_f32_16x16x32_bf16 v[36:39], a[212:215], a[156:159], v[36:39]
  ds_read_b64_tr_b16 a[198:199], v110 offset:57856
  v_mfma_f32_16x16x32_bf16 v[36:39], a[208:211], a[152:155], v[36:39]
  s_waitcnt lgkmcnt(4)
  v_mfma_f32_16x16x32_bf16 a[92:95], a[216:219], a[152:155], a[92:95]
  ds_read_b64_tr_b16 a[200:201], v110 offset:51200
  v_mfma_f32_16x16x32_bf16 a[92:95], a[220:223], a[156:159], a[92:95]
  v_mfma_f32_16x16x32_bf16 a[84:87], a[220:223], a[148:151], a[84:87]
  ds_read_b64_tr_b16 a[202:203], v110 offset:51712
  v_mfma_f32_16x16x32_bf16 a[84:87], a[216:219], a[144:147], a[84:87]
  buffer_load_dwordx4 a[176:179], v102, s[32:35], s42 offen offset:0 sc1
  v_mfma_f32_16x16x32_bf16 a[76:79], a[216:219], a[136:139], a[76:79]
  ds_read_b64_tr_b16 a[204:205], v110 offset:59392
  v_mfma_f32_16x16x32_bf16 a[76:79], a[220:223], a[140:143], a[76:79]
  v_mfma_f32_16x16x32_bf16 a[68:71], a[220:223], a[132:135], a[68:71]
  ds_read_b64_tr_b16 a[206:207], v110 offset:59904
  v_mfma_f32_16x16x32_bf16 a[68:71], a[216:219], a[128:131], a[68:71]
  s_waitcnt lgkmcnt(4)
  v_mfma_f32_16x16x32_bf16 v[40:43], a[192:195], a[128:131], v[40:43]
  ds_read_b64_tr_b16 a[208:209], v111 offset:49152
  v_mfma_f32_16x16x32_bf16 v[40:43], a[196:199], a[132:135], v[40:43]
  buffer_load_dwordx4 a[180:183], v102, s[32:35], s42 offen offset:256 sc1
  v_mfma_f32_16x16x32_bf16 v[48:51], a[196:199], a[140:143], v[48:51]
  ds_read_b64_tr_b16 a[210:211], v111 offset:49664
  v_mfma_f32_16x16x32_bf16 v[48:51], a[192:195], a[136:139], v[48:51]
  v_mfma_f32_16x16x32_bf16 v[56:59], a[192:195], a[144:147], v[56:59]
  ds_read_b64_tr_b16 a[212:213], v111 offset:57344
  v_mfma_f32_16x16x32_bf16 v[56:59], a[196:199], a[148:151], v[56:59]
  buffer_load_dwordx4 a[184:187], v103, s[32:35], s42 offen offset:0 sc1
  v_mfma_f32_16x16x32_bf16 v[64:67], a[196:199], a[156:159], v[64:67]
  ds_read_b64_tr_b16 a[214:215], v111 offset:57856
  v_mfma_f32_16x16x32_bf16 v[64:67], a[192:195], a[152:155], v[64:67]
  s_waitcnt lgkmcnt(4)
  v_mfma_f32_16x16x32_bf16 a[120:123], a[200:203], a[152:155], a[120:123]
  ds_read_b64_tr_b16 a[216:217], v111 offset:51200
  v_mfma_f32_16x16x32_bf16 a[120:123], a[204:207], a[156:159], a[120:123]
  v_mfma_f32_16x16x32_bf16 a[112:115], a[204:207], a[148:151], a[112:115]
  ds_read_b64_tr_b16 a[218:219], v111 offset:51712
  v_mfma_f32_16x16x32_bf16 a[112:115], a[200:203], a[144:147], a[112:115]
  buffer_load_dwordx4 a[188:191], v103, s[32:35], s42 offen offset:256 sc1
  v_mfma_f32_16x16x32_bf16 a[104:107], a[200:203], a[136:139], a[104:107]
  ds_read_b64_tr_b16 a[220:221], v111 offset:59392
  v_mfma_f32_16x16x32_bf16 a[104:107], a[204:207], a[140:143], a[104:107]
  v_mfma_f32_16x16x32_bf16 a[96:99], a[204:207], a[132:135], a[96:99]
  s_add_u32 m0, s18, 32768
  ds_read_b64_tr_b16 a[222:223], v111 offset:59904
  v_mfma_f32_16x16x32_bf16 a[96:99], a[200:203], a[128:131], a[96:99]
  s_waitcnt lgkmcnt(4)
  s_add_u32 s40, s40, 429056
  v_mfma_f32_16x16x32_bf16 v[44:47], a[208:211], a[128:131], v[44:47]
  ds_read_b64_tr_b16 a[192:193], v107 offset:0
  v_mfma_f32_16x16x32_bf16 v[44:47], a[212:215], a[132:135], v[44:47]
  buffer_load_dwordx4 v112, s[20:23], s40 offen offset:0 lds
  v_mfma_f32_16x16x32_bf16 v[52:55], a[212:215], a[140:143], v[52:55]
  ds_read_b64_tr_b16 a[194:195], v107 offset:1024
  v_mfma_f32_16x16x32_bf16 v[52:55], a[208:211], a[136:139], v[52:55]
  s_add_u32 s40, s40, 31744
  v_mfma_f32_16x16x32_bf16 v[60:63], a[208:211], a[144:147], v[60:63]
  ds_read_b64_tr_b16 a[196:197], v107 offset:8192
  v_mfma_f32_16x16x32_bf16 v[60:63], a[212:215], a[148:151], v[60:63]
  buffer_load_dwordx4 v112, s[20:23], s40 offen offset:1024 lds
  v_mfma_f32_16x16x32_bf16 v[68:71], a[212:215], a[156:159], v[68:71]
  ds_read_b64_tr_b16 a[198:199], v107 offset:9216
  v_mfma_f32_16x16x32_bf16 v[68:71], a[208:211], a[152:155], v[68:71]
  s_waitcnt lgkmcnt(4)
  v_mfma_f32_16x16x32_bf16 a[124:127], a[216:219], a[152:155], a[124:127]
  ds_read_b64_tr_b16 a[200:201], v107 offset:8
  v_mfma_f32_16x16x32_bf16 a[124:127], a[220:223], a[156:159], a[124:127]
  s_add_u32 s40, s40, 31744
  v_mfma_f32_16x16x32_bf16 a[116:119], a[220:223], a[148:151], a[116:119]
  ds_read_b64_tr_b16 a[202:203], v107 offset:1032
  v_mfma_f32_16x16x32_bf16 a[116:119], a[216:219], a[144:147], a[116:119]
  buffer_load_dwordx4 v112, s[20:23], s40 offen offset:2048 lds
  v_mfma_f32_16x16x32_bf16 a[108:111], a[216:219], a[136:139], a[108:111]
  ds_read_b64_tr_b16 a[204:205], v107 offset:8200
  v_mfma_f32_16x16x32_bf16 a[108:111], a[220:223], a[140:143], a[108:111]
  v_mfma_f32_16x16x32_bf16 a[100:103], a[220:223], a[132:135], a[100:103]
  ds_read_b64_tr_b16 a[206:207], v107 offset:9224
  v_mfma_f32_16x16x32_bf16 a[100:103], a[216:219], a[128:131], a[100:103]
  s_waitcnt lgkmcnt(4)
  v_mfma_f32_16x16x32_bf16 v[224:227], a[192:195], a[128:131], v[224:227]
  ds_read_b64_tr_b16 a[208:209], v106 offset:0
  v_mfma_f32_16x16x32_bf16 v[224:227], a[196:199], a[132:135], v[224:227]
  buffer_store_dwordx4 a[32:35], v3, s[32:35], s86 offen offset:2048 sc1
  v_mfma_f32_16x16x32_bf16 v[232:235], a[196:199], a[140:143], v[232:235]
  ds_read_b64_tr_b16 a[210:211], v106 offset:1024
  v_mfma_f32_16x16x32_bf16 v[232:235], a[192:195], a[136:139], v[232:235]
  v_mfma_f32_16x16x32_bf16 v[240:243], a[192:195], a[144:147], v[240:243]
  ds_read_b64_tr_b16 a[212:213], v106 offset:8192
  v_mfma_f32_16x16x32_bf16 v[240:243], a[196:199], a[148:151], v[240:243]
  v_mfma_f32_16x16x32_bf16 v[248:251], a[196:199], a[156:159], v[248:251]
  ds_read_b64_tr_b16 a[214:215], v106 offset:9216
  v_mfma_f32_16x16x32_bf16 v[248:251], a[192:195], a[152:155], v[248:251]
  s_waitcnt lgkmcnt(4)
  v_mfma_f32_16x16x32_bf16 v[252:255], a[200:203], a[152:155], v[252:255]
  ds_read_b64_tr_b16 a[216:217], v106 offset:8
  v_mfma_f32_16x16x32_bf16 v[252:255], a[204:207], a[156:159], v[252:255]
  v_mfma_f32_16x16x32_bf16 v[244:247], a[204:207], a[148:151], v[244:247]
  ds_read_b64_tr_b16 a[218:219], v106 offset:1032
  v_mfma_f32_16x16x32_bf16 v[244:247], a[200:203], a[144:147], v[244:247]
  v_mfma_f32_16x16x32_bf16 v[236:239], a[200:203], a[136:139], v[236:239]
L_pad_proj02_3:
  s_cbranch_execz L_pad_proj02_4
  ds_read_b64_tr_b16 a[220:221], v106 offset:8200
  v_mfma_f32_16x16x32_bf16 v[236:239], a[204:207], a[140:143], v[236:239]
  s_add_u32 s40, s40, 31744
  v_mfma_f32_16x16x32_bf16 v[228:231], a[204:207], a[132:135], v[228:231]
  ds_read_b64_tr_b16 a[222:223], v106 offset:9224
  v_mfma_f32_16x16x32_bf16 v[228:231], a[200:203], a[128:131], v[228:231]
  s_waitcnt lgkmcnt(4)
  buffer_load_dwordx4 v112, s[20:23], s40 offen offset:3072 lds
  v_mfma_f32_16x16x32_bf16 v[192:195], a[208:211], a[128:131], v[192:195]
  ds_read_b64_tr_b16 a[192:193], v105 offset:0
  v_mfma_f32_16x16x32_bf16 v[192:195], a[212:215], a[132:135], v[192:195]
  v_mfma_f32_16x16x32_bf16 v[200:203], a[212:215], a[140:143], v[200:203]
  s_add_u32 m0, s18, 81920
  ds_read_b64_tr_b16 a[194:195], v105 offset:1024
  v_mfma_f32_16x16x32_bf16 v[200:203], a[208:211], a[136:139], v[200:203]
  s_add_u32 s41, s41, 221184
  v_mfma_f32_16x16x32_bf16 v[208:211], a[208:211], a[144:147], v[208:211]
  ds_read_b64_tr_b16 a[196:197], v105 offset:8192
  v_mfma_f32_16x16x32_bf16 v[208:211], a[212:215], a[148:151], v[208:211]
  buffer_load_dwordx4 v113, s[24:27], s41 offen offset:0 lds
  v_mfma_f32_16x16x32_bf16 v[216:219], a[212:215], a[156:159], v[216:219]
  ds_read_b64_tr_b16 a[198:199], v105 offset:9216
  v_mfma_f32_16x16x32_bf16 v[216:219], a[208:211], a[152:155], v[216:219]
  s_waitcnt lgkmcnt(4)
  v_mfma_f32_16x16x32_bf16 v[220:223], a[216:219], a[152:155], v[220:223]
  ds_read_b64_tr_b16 a[200:201], v105 offset:8
  v_mfma_f32_16x16x32_bf16 v[220:223], a[220:223], a[156:159], v[220:223]
  v_mfma_f32_16x16x32_bf16 v[212:215], a[220:223], a[148:151], v[212:215]
  ds_read_b64_tr_b16 a[202:203], v105 offset:1032
  v_mfma_f32_16x16x32_bf16 v[212:215], a[216:219], a[144:147], v[212:215]
  buffer_store_dwordx4 a[32:35], v3, s[32:35], s86 offen offset:3072 sc1
  v_mfma_f32_16x16x32_bf16 v[204:207], a[216:219], a[136:139], v[204:207]
  ds_read_b64_tr_b16 a[204:205], v105 offset:8200
  v_mfma_f32_16x16x32_bf16 v[204:207], a[220:223], a[140:143], v[204:207]
  v_mfma_f32_16x16x32_bf16 v[196:199], a[220:223], a[132:135], v[196:199]
  ds_read_b64_tr_b16 a[206:207], v105 offset:9224
  v_mfma_f32_16x16x32_bf16 v[196:199], a[216:219], a[128:131], v[196:199]
  s_waitcnt lgkmcnt(4)
  v_mfma_f32_16x16x32_bf16 v[160:163], a[192:195], a[128:131], v[160:163]
  ds_read_b64_tr_b16 a[208:209], v104 offset:0
  v_mfma_f32_16x16x32_bf16 v[160:163], a[196:199], a[132:135], v[160:163]
  v_mfma_f32_16x16x32_bf16 v[168:171], a[196:199], a[140:143], v[168:171]
  ds_read_b64_tr_b16 a[210:211], v104 offset:1024
  v_mfma_f32_16x16x32_bf16 v[168:171], a[192:195], a[136:139], v[168:171]
  v_mfma_f32_16x16x32_bf16 v[176:179], a[192:195], a[144:147], v[176:179]
  ds_read_b64_tr_b16 a[212:213], v104 offset:8192
  v_mfma_f32_16x16x32_bf16 v[176:179], a[196:199], a[148:151], v[176:179]
  v_mfma_f32_16x16x32_bf16 v[184:187], a[196:199], a[156:159], v[184:187]
  ds_read_b64_tr_b16 a[214:215], v104 offset:9216
  v_mfma_f32_16x16x32_bf16 v[184:187], a[192:195], a[152:155], v[184:187]
  s_waitcnt lgkmcnt(4)
  v_mfma_f32_16x16x32_bf16 v[188:191], a[200:203], a[152:155], v[188:191]
  ds_read_b64_tr_b16 a[216:217], v104 offset:8
  v_mfma_f32_16x16x32_bf16 v[188:191], a[204:207], a[156:159], v[188:191]
  v_mfma_f32_16x16x32_bf16 v[180:183], a[204:207], a[148:151], v[180:183]
  ds_read_b64_tr_b16 a[218:219], v104 offset:1032
  v_mfma_f32_16x16x32_bf16 v[180:183], a[200:203], a[144:147], v[180:183]
  buffer_load_dwordx4 v114, s[24:27], s41 offen offset:1024 lds
  v_mfma_f32_16x16x32_bf16 v[172:175], a[200:203], a[136:139], v[172:175]
  ds_read_b64_tr_b16 a[220:221], v104 offset:8200
  v_mfma_f32_16x16x32_bf16 v[172:175], a[204:207], a[140:143], v[172:175]
  s_add_u32 m0, s18, 83968
  v_mfma_f32_16x16x32_bf16 v[164:167], a[204:207], a[132:135], v[164:167]
  ds_read_b64_tr_b16 a[222:223], v104 offset:9224
  v_mfma_f32_16x16x32_bf16 v[164:167], a[200:203], a[128:131], v[164:167]
  s_waitcnt lgkmcnt(4)
  s_waitcnt vmcnt(16)
  s_barrier
  buffer_load_dwordx4 v113, s[28:31], s41 offen offset:0 lds
  v_mfma_f32_16x16x32_bf16 v[128:131], a[208:211], a[128:131], v[128:131]
  ds_read_b64_tr_b16 a[192:193], v108 offset:32768
  v_mfma_f32_16x16x32_bf16 v[128:131], a[212:215], a[132:135], v[128:131]
  v_mfma_f32_16x16x32_bf16 v[136:139], a[212:215], a[140:143], v[136:139]
  ds_read_b64_tr_b16 a[194:195], v108 offset:33280
  v_mfma_f32_16x16x32_bf16 v[136:139], a[208:211], a[136:139], v[136:139]
  v_mfma_f32_16x16x32_bf16 v[144:147], a[208:211], a[144:147], v[144:147]
  ds_read_b64_tr_b16 a[196:197], v108 offset:40960
  v_mfma_f32_16x16x32_bf16 v[144:147], a[212:215], a[148:151], v[144:147]
  buffer_load_dwordx4 v114, s[28:31], s41 offen offset:1024 lds
  v_mfma_f32_16x16x32_bf16 v[152:155], a[212:215], a[156:159], v[152:155]
  ds_read_b64_tr_b16 a[198:199], v108 offset:41472
  v_mfma_f32_16x16x32_bf16 v[152:155], a[208:211], a[152:155], v[152:155]
  s_waitcnt lgkmcnt(4)
  v_mfma_f32_16x16x32_bf16 v[156:159], a[216:219], a[152:155], v[156:159]
  ds_read_b64_tr_b16 a[200:201], v108 offset:34816
  v_mfma_f32_16x16x32_bf16 v[156:159], a[220:223], a[156:159], v[156:159]
  v_mfma_f32_16x16x32_bf16 v[148:151], a[220:223], a[148:151], v[148:151]
  ds_read_b64_tr_b16 a[202:203], v108 offset:35328
  v_mfma_f32_16x16x32_bf16 v[148:151], a[216:219], a[144:147], v[148:151]
  v_mfma_f32_16x16x32_bf16 v[140:143], a[216:219], a[136:139], v[140:143]
  ds_read_b64_tr_b16 a[204:205], v108 offset:43008
  v_mfma_f32_16x16x32_bf16 v[140:143], a[220:223], a[140:143], v[140:143]
  s_waitcnt vmcnt(10)
  v_mfma_f32_16x16x32_bf16 v[132:135], a[220:223], a[132:135], v[132:135]
  ds_read_b64_tr_b16 a[206:207], v108 offset:43520
  v_mfma_f32_16x16x32_bf16 v[132:135], a[216:219], a[128:131], v[132:135]
  s_waitcnt lgkmcnt(4)
  v_mfma_f32_16x16x32_bf16 v[8:11], a[192:195], a[160:163], v[8:11]
  ds_read_b64_tr_b16 a[208:209], v109 offset:32768
  v_mfma_f32_16x16x32_bf16 v[8:11], a[196:199], a[164:167], v[8:11]
L_pp7_8:
  v_add_co_u32 v74, vcc, L_fm-L_post0, v126
  v_mfma_f32_16x16x32_bf16 v[16:19], a[196:199], a[172:175], v[16:19]
  ds_read_b64_tr_b16 a[210:211], v109 offset:33280
  v_mfma_f32_16x16x32_bf16 v[16:19], a[192:195], a[168:171], v[16:19]
  v_addc_co_u32 v75, vcc, -1, v127, vcc
  v_mfma_f32_16x16x32_bf16 v[24:27], a[192:195], a[176:179], v[24:27]
  ds_read_b64_tr_b16 a[212:213], v109 offset:40960
  v_mfma_f32_16x16x32_bf16 v[24:27], a[196:199], a[180:183], v[24:27]
  s_add_u32 s42, s42, 512
  v_mfma_f32_16x16x32_bf16 v[32:35], a[196:199], a[188:191], v[32:35]
  ds_read_b64_tr_b16 a[214:215], v109 offset:41472
  v_mfma_f32_16x16x32_bf16 v[32:35], a[192:195], a[184:187], v[32:35]
  s_waitcnt lgkmcnt(4)
  buffer_load_dwordx4 a[128:131], v100, s[32:35], s42 offen offset:0 sc1
  v_mfma_f32_16x16x32_bf16 a[88:91], a[200:203], a[184:187], a[88:91]
  ds_read_b64_tr_b16 a[216:217], v109 offset:34816
  v_mfma_f32_16x16x32_bf16 a[88:91], a[204:207], a[188:191], a[88:91]
  v_mfma_f32_16x16x32_bf16 a[80:83], a[204:207], a[180:183], a[80:83]
  ds_read_b64_tr_b16 a[218:219], v109 offset:35328
  v_mfma_f32_16x16x32_bf16 a[80:83], a[200:203], a[176:179], a[80:83]
  buffer_load_dwordx4 a[132:135], v100, s[32:35], s42 offen offset:256 sc1
  v_mfma_f32_16x16x32_bf16 a[72:75], a[200:203], a[168:171], a[72:75]
  ds_read_b64_tr_b16 a[220:221], v109 offset:43008
  v_mfma_f32_16x16x32_bf16 a[72:75], a[204:207], a[172:175], a[72:75]
  v_mfma_f32_16x16x32_bf16 a[64:67], a[204:207], a[164:167], a[64:67]
  ds_read_b64_tr_b16 a[222:223], v109 offset:43520
  v_mfma_f32_16x16x32_bf16 a[64:67], a[200:203], a[160:163], a[64:67]
  s_waitcnt lgkmcnt(4)
  v_mfma_f32_16x16x32_bf16 v[12:15], a[208:211], a[160:163], v[12:15]
  ds_read_b64_tr_b16 a[192:193], v110 offset:32768
  v_mfma_f32_16x16x32_bf16 v[12:15], a[212:215], a[164:167], v[12:15]
  buffer_load_dwordx4 a[136:139], v101, s[32:35], s42 offen offset:0 sc1
  v_mfma_f32_16x16x32_bf16 v[20:23], a[212:215], a[172:175], v[20:23]
  ds_read_b64_tr_b16 a[194:195], v110 offset:33280
  v_mfma_f32_16x16x32_bf16 v[20:23], a[208:211], a[168:171], v[20:23]
  v_mfma_f32_16x16x32_bf16 v[28:31], a[208:211], a[176:179], v[28:31]
  ds_read_b64_tr_b16 a[196:197], v110 offset:40960
  v_mfma_f32_16x16x32_bf16 v[28:31], a[212:215], a[180:183], v[28:31]
  buffer_load_dwordx4 a[140:143], v101, s[32:35], s42 offen offset:256 sc1
  v_mfma_f32_16x16x32_bf16 v[36:39], a[212:215], a[188:191], v[36:39]
  ds_read_b64_tr_b16 a[198:199], v110 offset:41472
  v_mfma_f32_16x16x32_bf16 v[36:39], a[208:211], a[184:187], v[36:39]
  s_waitcnt lgkmcnt(4)
  v_mfma_f32_16x16x32_bf16 a[92:95], a[216:219], a[184:187], a[92:95]
  ds_read_b64_tr_b16 a[200:201], v110 offset:34816
  v_mfma_f32_16x16x32_bf16 a[92:95], a[220:223], a[188:191], a[92:95]
  v_mfma_f32_16x16x32_bf16 a[84:87], a[220:223], a[180:183], a[84:87]
  ds_read_b64_tr_b16 a[202:203], v110 offset:35328
  v_mfma_f32_16x16x32_bf16 a[84:87], a[216:219], a[176:179], a[84:87]
  buffer_load_dwordx4 a[144:147], v102, s[32:35], s42 offen offset:0 sc1
  v_mfma_f32_16x16x32_bf16 a[76:79], a[216:219], a[168:171], a[76:79]
  ds_read_b64_tr_b16 a[204:205], v110 offset:43008
  v_mfma_f32_16x16x32_bf16 a[76:79], a[220:223], a[172:175], a[76:79]
  v_mfma_f32_16x16x32_bf16 a[68:71], a[220:223], a[164:167], a[68:71]
  ds_read_b64_tr_b16 a[206:207], v110 offset:43520
  v_mfma_f32_16x16x32_bf16 a[68:71], a[216:219], a[160:163], a[68:71]
  s_waitcnt lgkmcnt(4)
  buffer_load_dwordx4 a[148:151], v102, s[32:35], s42 offen offset:256 sc1
  v_mfma_f32_16x16x32_bf16 v[40:43], a[192:195], a[160:163], v[40:43]
  ds_read_b64_tr_b16 a[208:209], v111 offset:32768
  v_mfma_f32_16x16x32_bf16 v[40:43], a[196:199], a[164:167], v[40:43]
  v_mfma_f32_16x16x32_bf16 v[48:51], a[196:199], a[172:175], v[48:51]
  ds_read_b64_tr_b16 a[210:211], v111 offset:33280
  v_mfma_f32_16x16x32_bf16 v[48:51], a[192:195], a[168:171], v[48:51]
  v_mfma_f32_16x16x32_bf16 v[56:59], a[192:195], a[176:179], v[56:59]
  ds_read_b64_tr_b16 a[212:213], v111 offset:40960
  v_mfma_f32_16x16x32_bf16 v[56:59], a[196:199], a[180:183], v[56:59]
  buffer_load_dwordx4 a[152:155], v103, s[32:35], s42 offen offset:0 sc1
  v_mfma_f32_16x16x32_bf16 v[64:67], a[196:199], a[188:191], v[64:67]
  ds_read_b64_tr_b16 a[214:215], v111 offset:41472
  v_mfma_f32_16x16x32_bf16 v[64:67], a[192:195], a[184:187], v[64:67]
  s_waitcnt lgkmcnt(4)
  v_mfma_f32_16x16x32_bf16 a[120:123], a[200:203], a[184:187], a[120:123]
  ds_read_b64_tr_b16 a[216:217], v111 offset:34816
  v_mfma_f32_16x16x32_bf16 a[120:123], a[204:207], a[188:191], a[120:123]
  buffer_load_dwordx4 a[156:159], v103, s[32:35], s42 offen offset:256 sc1
  v_mfma_f32_16x16x32_bf16 a[112:115], a[204:207], a[180:183], a[112:115]
  ds_read_b64_tr_b16 a[218:219], v111 offset:35328
  v_mfma_f32_16x16x32_bf16 a[112:115], a[200:203], a[176:179], a[112:115]
  v_mfma_f32_16x16x32_bf16 a[104:107], a[200:203], a[168:171], a[104:107]
  s_add_u32 m0, s18, 49152
  ds_read_b64_tr_b16 a[220:221], v111 offset:43008
  v_mfma_f32_16x16x32_bf16 a[104:107], a[204:207], a[172:175], a[104:107]
  s_add_u32 s40, s40, 429056
  v_mfma_f32_16x16x32_bf16 a[96:99], a[204:207], a[164:167], a[96:99]
  ds_read_b64_tr_b16 a[222:223], v111 offset:43520
  v_mfma_f32_16x16x32_bf16 a[96:99], a[200:203], a[160:163], a[96:99]
  s_waitcnt lgkmcnt(4)
  buffer_load_dwordx4 v112, s[20:23], s40 offen offset:0 lds
  v_mfma_f32_16x16x32_bf16 v[44:47], a[208:211], a[160:163], v[44:47]
  ds_read_b64_tr_b16 a[192:193], v107 offset:16384
  v_mfma_f32_16x16x32_bf16 v[44:47], a[212:215], a[164:167], v[44:47]
  s_add_u32 s40, s40, 31744
  v_mfma_f32_16x16x32_bf16 v[52:55], a[212:215], a[172:175], v[52:55]
  ds_read_b64_tr_b16 a[194:195], v107 offset:17408
  v_mfma_f32_16x16x32_bf16 v[52:55], a[208:211], a[168:171], v[52:55]
  buffer_load_dwordx4 v112, s[20:23], s40 offen offset:1024 lds
  v_mfma_f32_16x16x32_bf16 v[60:63], a[208:211], a[176:179], v[60:63]
  ds_read_b64_tr_b16 a[196:197], v107 offset:24576
  v_mfma_f32_16x16x32_bf16 v[60:63], a[212:215], a[180:183], v[60:63]
  v_mfma_f32_16x16x32_bf16 v[68:71], a[212:215], a[188:191], v[68:71]
  ds_read_b64_tr_b16 a[198:199], v107 offset:25600
  v_mfma_f32_16x16x32_bf16 v[68:71], a[208:211], a[184:187], v[68:71]
  s_waitcnt lgkmcnt(4)
  s_add_u32 s40, s40, 31744
  v_mfma_f32_16x16x32_bf16 a[124:127], a[216:219], a[184:187], a[124:127]
  ds_read_b64_tr_b16 a[200:201], v107 offset:16392
  v_mfma_f32_16x16x32_bf16 a[124:127], a[220:223], a[188:191], a[124:127]
  buffer_load_dwordx4 v112, s[20:23], s40 offen offset:2048 lds
  v_mfma_f32_16x16x32_bf16 a[116:119], a[220:223], a[180:183], a[116:119]
  ds_read_b64_tr_b16 a[202:203], v107 offset:17416
  v_mfma_f32_16x16x32_bf16 a[116:119], a[216:219], a[176:179], a[116:119]
  s_add_u32 s86, s86, 4096
  v_mfma_f32_16x16x32_bf16 a[108:111], a[216:219], a[168:171], a[108:111]
  ds_read_b64_tr_b16 a[204:205], v107 offset:24584
  v_mfma_f32_16x16x32_bf16 a[108:111], a[220:223], a[172:175], a[108:111]
  buffer_store_dwordx4 a[32:35], v3, s[32:35], s86 offen offset:0 sc1
  v_mfma_f32_16x16x32_bf16 a[100:103], a[220:223], a[164:167], a[100:103]
  ds_read_b64_tr_b16 a[206:207], v107 offset:25608
  v_mfma_f32_16x16x32_bf16 a[100:103], a[216:219], a[160:163], a[100:103]
  s_waitcnt lgkmcnt(4)
  v_mfma_f32_16x16x32_bf16 v[224:227], a[192:195], a[160:163], v[224:227]
  ds_read_b64_tr_b16 a[208:209], v106 offset:16384
  v_mfma_f32_16x16x32_bf16 v[224:227], a[196:199], a[164:167], v[224:227]
  v_mfma_f32_16x16x32_bf16 v[232:235], a[196:199], a[172:175], v[232:235]
  ds_read_b64_tr_b16 a[210:211], v106 offset:17408
  v_mfma_f32_16x16x32_bf16 v[232:235], a[192:195], a[168:171], v[232:235]
  v_mfma_f32_16x16x32_bf16 v[240:243], a[192:195], a[176:179], v[240:243]
  ds_read_b64_tr_b16 a[212:213], v106 offset:24576
  v_mfma_f32_16x16x32_bf16 v[240:243], a[196:199], a[180:183], v[240:243]
  v_mfma_f32_16x16x32_bf16 v[248:251], a[196:199], a[188:191], v[248:251]
  ds_read_b64_tr_b16 a[214:215], v106 offset:25600
  v_mfma_f32_16x16x32_bf16 v[248:251], a[192:195], a[184:187], v[248:251]
  s_waitcnt lgkmcnt(4)
  v_mfma_f32_16x16x32_bf16 v[252:255], a[200:203], a[184:187], v[252:255]
  ds_read_b64_tr_b16 a[216:217], v106 offset:16392
  v_mfma_f32_16x16x32_bf16 v[252:255], a[204:207], a[188:191], v[252:255]
  v_mfma_f32_16x16x32_bf16 v[244:247], a[204:207], a[180:183], v[244:247]
  ds_read_b64_tr_b16 a[218:219], v106 offset:17416
  v_mfma_f32_16x16x32_bf16 v[244:247], a[200:203], a[176:179], v[244:247]
  s_add_u32 s40, s40, 31744
  v_mfma_f32_16x16x32_bf16 v[236:239], a[200:203], a[168:171], v[236:239]
  ds_read_b64_tr_b16 a[220:221], v106 offset:24584
  v_mfma_f32_16x16x32_bf16 v[236:239], a[204:207], a[172:175], v[236:239]
  buffer_load_dwordx4 v112, s[20:23], s40 offen offset:3072 lds
  v_mfma_f32_16x16x32_bf16 v[228:231], a[204:207], a[164:167], v[228:231]
  s_add_u32 m0, s18, 65536
  ds_read_b64_tr_b16 a[222:223], v106 offset:25608
  v_mfma_f32_16x16x32_bf16 v[228:231], a[200:203], a[160:163], v[228:231]
  s_waitcnt lgkmcnt(4)
  s_add_u32 s41, s41, 221184
  v_mfma_f32_16x16x32_bf16 v[192:195], a[208:211], a[160:163], v[192:195]
  ds_read_b64_tr_b16 a[192:193], v105 offset:16384
  v_mfma_f32_16x16x32_bf16 v[192:195], a[212:215], a[164:167], v[192:195]
  buffer_load_dwordx4 v113, s[24:27], s41 offen offset:0 lds
  v_mfma_f32_16x16x32_bf16 v[200:203], a[212:215], a[172:175], v[200:203]
  ds_read_b64_tr_b16 a[194:195], v105 offset:17408
  v_mfma_f32_16x16x32_bf16 v[200:203], a[208:211], a[168:171], v[200:203]
  v_mfma_f32_16x16x32_bf16 v[208:211], a[208:211], a[176:179], v[208:211]
  ds_read_b64_tr_b16 a[196:197], v105 offset:24576
  v_mfma_f32_16x16x32_bf16 v[208:211], a[212:215], a[180:183], v[208:211]
  v_mfma_f32_16x16x32_bf16 v[216:219], a[212:215], a[188:191], v[216:219]
  ds_read_b64_tr_b16 a[198:199], v105 offset:25600
  v_mfma_f32_16x16x32_bf16 v[216:219], a[208:211], a[184:187], v[216:219]
  s_waitcnt lgkmcnt(4)
  buffer_load_dwordx4 v114, s[24:27], s41 offen offset:1024 lds
  v_mfma_f32_16x16x32_bf16 v[220:223], a[216:219], a[184:187], v[220:223]
  ds_read_b64_tr_b16 a[200:201], v105 offset:16392
  v_mfma_f32_16x16x32_bf16 v[220:223], a[220:223], a[188:191], v[220:223]
  v_mfma_f32_16x16x32_bf16 v[212:215], a[220:223], a[180:183], v[212:215]
  ds_read_b64_tr_b16 a[202:203], v105 offset:17416
  v_mfma_f32_16x16x32_bf16 v[212:215], a[216:219], a[176:179], v[212:215]
  buffer_store_dwordx4 a[32:35], v3, s[32:35], s86 offen offset:1024 sc1
  v_mfma_f32_16x16x32_bf16 v[204:207], a[216:219], a[168:171], v[204:207]
  ds_read_b64_tr_b16 a[204:205], v105 offset:24584
  v_mfma_f32_16x16x32_bf16 v[204:207], a[220:223], a[172:175], v[204:207]
  v_mfma_f32_16x16x32_bf16 v[196:199], a[220:223], a[164:167], v[196:199]
  ds_read_b64_tr_b16 a[206:207], v105 offset:25608
  v_mfma_f32_16x16x32_bf16 v[196:199], a[216:219], a[160:163], v[196:199]
  s_waitcnt lgkmcnt(4)
  v_mfma_f32_16x16x32_bf16 v[160:163], a[192:195], a[160:163], v[160:163]
  ds_read_b64_tr_b16 a[208:209], v104 offset:16384
  v_mfma_f32_16x16x32_bf16 v[160:163], a[196:199], a[164:167], v[160:163]
  v_mfma_f32_16x16x32_bf16 v[168:171], a[196:199], a[172:175], v[168:171]
  ds_read_b64_tr_b16 a[210:211], v104 offset:17408
  v_mfma_f32_16x16x32_bf16 v[168:171], a[192:195], a[168:171], v[168:171]
  v_mfma_f32_16x16x32_bf16 v[176:179], a[192:195], a[176:179], v[176:179]
  ds_read_b64_tr_b16 a[212:213], v104 offset:24576
  v_mfma_f32_16x16x32_bf16 v[176:179], a[196:199], a[180:183], v[176:179]
  v_mfma_f32_16x16x32_bf16 v[184:187], a[196:199], a[188:191], v[184:187]
  ds_read_b64_tr_b16 a[214:215], v104 offset:25600
  v_mfma_f32_16x16x32_bf16 v[184:187], a[192:195], a[184:187], v[184:187]
  s_waitcnt lgkmcnt(4)
  v_mfma_f32_16x16x32_bf16 v[188:191], a[200:203], a[184:187], v[188:191]
  ds_read_b64_tr_b16 a[216:217], v104 offset:16392
  v_mfma_f32_16x16x32_bf16 v[188:191], a[204:207], a[188:191], v[188:191]
  s_add_u32 m0, s18, 67584
  v_mfma_f32_16x16x32_bf16 v[180:183], a[204:207], a[180:183], v[180:183]
  ds_read_b64_tr_b16 a[218:219], v104 offset:17416
  v_mfma_f32_16x16x32_bf16 v[180:183], a[200:203], a[176:179], v[180:183]
  buffer_load_dwordx4 v113, s[28:31], s41 offen offset:0 lds
  v_mfma_f32_16x16x32_bf16 v[172:175], a[200:203], a[168:171], v[172:175]
  ds_read_b64_tr_b16 a[220:221], v104 offset:24584
  v_mfma_f32_16x16x32_bf16 v[172:175], a[204:207], a[172:175], v[172:175]
  v_mfma_f32_16x16x32_bf16 v[164:167], a[204:207], a[164:167], v[164:167]
  ds_read_b64_tr_b16 a[222:223], v104 offset:25608
  v_mfma_f32_16x16x32_bf16 v[164:167], a[200:203], a[160:163], v[164:167]
  s_waitcnt lgkmcnt(4)
  s_waitcnt vmcnt(17)
  s_barrier
  buffer_load_dwordx4 v114, s[28:31], s41 offen offset:1024 lds
  v_mfma_f32_16x16x32_bf16 v[128:131], a[208:211], a[160:163], v[128:131]
  ds_read_b64_tr_b16 a[192:193], v108 offset:16384
  v_mfma_f32_16x16x32_bf16 v[128:131], a[212:215], a[164:167], v[128:131]
  v_mfma_f32_16x16x32_bf16 v[136:139], a[212:215], a[172:175], v[136:139]
  ds_read_b64_tr_b16 a[194:195], v108 offset:16896
  v_mfma_f32_16x16x32_bf16 v[136:139], a[208:211], a[168:171], v[136:139]
  v_mfma_f32_16x16x32_bf16 v[144:147], a[208:211], a[176:179], v[144:147]
  ds_read_b64_tr_b16 a[196:197], v108 offset:24576
  v_mfma_f32_16x16x32_bf16 v[144:147], a[212:215], a[180:183], v[144:147]
  global_load_dword v2, v[74:75], off
  v_mfma_f32_16x16x32_bf16 v[152:155], a[212:215], a[188:191], v[152:155]
  ds_read_b64_tr_b16 a[198:199], v108 offset:25088
  v_mfma_f32_16x16x32_bf16 v[152:155], a[208:211], a[184:187], v[152:155]
  s_waitcnt lgkmcnt(4)
  v_mfma_f32_16x16x32_bf16 v[156:159], a[216:219], a[184:187], v[156:159]
  ds_read_b64_tr_b16 a[200:201], v108 offset:18432
  v_mfma_f32_16x16x32_bf16 v[156:159], a[220:223], a[188:191], v[156:159]
  v_mfma_f32_16x16x32_bf16 v[148:151], a[220:223], a[180:183], v[148:151]
  ds_read_b64_tr_b16 a[202:203], v108 offset:18944
  v_mfma_f32_16x16x32_bf16 v[148:151], a[216:219], a[176:179], v[148:151]
  v_mfma_f32_16x16x32_bf16 v[140:143], a[216:219], a[168:171], v[140:143]
  ds_read_b64_tr_b16 a[204:205], v108 offset:26624
  v_mfma_f32_16x16x32_bf16 v[140:143], a[220:223], a[172:175], v[140:143]
  s_waitcnt vmcnt(11)
  v_mfma_f32_16x16x32_bf16 v[132:135], a[220:223], a[164:167], v[132:135]
  ds_read_b64_tr_b16 a[206:207], v108 offset:27136
  v_mfma_f32_16x16x32_bf16 v[132:135], a[216:219], a[160:163], v[132:135]
  s_waitcnt lgkmcnt(4)
  v_mfma_f32_16x16x32_bf16 v[8:11], a[192:195], a[128:131], v[8:11]
  s_add_u32 s42, s42, 512
  ds_read_b64_tr_b16 a[208:209], v109 offset:16384
  v_mfma_f32_16x16x32_bf16 v[8:11], a[196:199], a[132:135], v[8:11]
  buffer_load_dwordx4 a[160:163], v100, s[32:35], s42 offen offset:0 sc1
  v_mfma_f32_16x16x32_bf16 v[16:19], a[196:199], a[140:143], v[16:19]
  ds_read_b64_tr_b16 a[210:211], v109 offset:16896
  v_mfma_f32_16x16x32_bf16 v[16:19], a[192:195], a[136:139], v[16:19]
  buffer_load_dwordx4 a[164:167], v100, s[32:35], s42 offen offset:256 sc1
  v_mfma_f32_16x16x32_bf16 v[24:27], a[192:195], a[144:147], v[24:27]
  ds_read_b64_tr_b16 a[212:213], v109 offset:24576
  v_mfma_f32_16x16x32_bf16 v[24:27], a[196:199], a[148:151], v[24:27]
  buffer_load_dwordx4 a[168:171], v101, s[32:35], s42 offen offset:0 sc1
  v_mfma_f32_16x16x32_bf16 v[32:35], a[196:199], a[156:159], v[32:35]
  ds_read_b64_tr_b16 a[214:215], v109 offset:25088
  v_mfma_f32_16x16x32_bf16 v[32:35], a[192:195], a[152:155], v[32:35]
  s_waitcnt lgkmcnt(4)
  buffer_load_dwordx4 a[172:175], v101, s[32:35], s42 offen offset:256 sc1
  v_mfma_f32_16x16x32_bf16 a[88:91], a[200:203], a[152:155], a[88:91]
  ds_read_b64_tr_b16 a[216:217], v109 offset:18432
  v_mfma_f32_16x16x32_bf16 a[88:91], a[204:207], a[156:159], a[88:91]
  buffer_load_dwordx4 a[176:179], v102, s[32:35], s42 offen offset:0 sc1
  v_mfma_f32_16x16x32_bf16 a[80:83], a[204:207], a[148:151], a[80:83]
  ds_read_b64_tr_b16 a[218:219], v109 offset:18944
  v_mfma_f32_16x16x32_bf16 a[80:83], a[200:203], a[144:147], a[80:83]
  buffer_load_dwordx4 a[180:183], v102, s[32:35], s42 offen offset:256 sc1
  v_mfma_f32_16x16x32_bf16 a[72:75], a[200:203], a[136:139], a[72:75]
  ds_read_b64_tr_b16 a[220:221], v109 offset:26624
  v_mfma_f32_16x16x32_bf16 a[72:75], a[204:207], a[140:143], a[72:75]
  buffer_load_dwordx4 a[184:187], v103, s[32:35], s42 offen offset:0 sc1
  v_mfma_f32_16x16x32_bf16 a[64:67], a[204:207], a[132:135], a[64:67]
  ds_read_b64_tr_b16 a[222:223], v109 offset:27136
  v_mfma_f32_16x16x32_bf16 a[64:67], a[200:203], a[128:131], a[64:67]
  s_waitcnt lgkmcnt(4)
  buffer_load_dwordx4 a[188:191], v103, s[32:35], s42 offen offset:256 sc1
  v_mfma_f32_16x16x32_bf16 v[12:15], a[208:211], a[128:131], v[12:15]
  ds_read_b64_tr_b16 a[192:193], v110 offset:16384
  v_mfma_f32_16x16x32_bf16 v[12:15], a[212:215], a[132:135], v[12:15]
  v_mfma_f32_16x16x32_bf16 v[20:23], a[212:215], a[140:143], v[20:23]
  s_bfe_u32 s19, s47, 0x1000a
  ds_read_b64_tr_b16 a[194:195], v110 offset:16896
  v_mfma_f32_16x16x32_bf16 v[20:23], a[208:211], a[136:139], v[20:23]
  s_xor_b32 s19, s19, s44
  v_mfma_f32_16x16x32_bf16 v[28:31], a[208:211], a[144:147], v[28:31]
  ds_read_b64_tr_b16 a[196:197], v110 offset:24576
  v_mfma_f32_16x16x32_bf16 v[28:31], a[212:215], a[148:151], v[28:31]
  s_bitcmp1_b32 s19, 0
  s_cselect_b32 s19, 260096, 0
  v_mfma_f32_16x16x32_bf16 v[36:39], a[212:215], a[156:159], v[36:39]
  s_add_u32 s19, s19, 1024
  ds_read_b64_tr_b16 a[198:199], v110 offset:25088
  v_mfma_f32_16x16x32_bf16 v[36:39], a[208:211], a[152:155], v[36:39]
  s_waitcnt lgkmcnt(4)
  s_add_u32 m0, s18, 0
  v_mfma_f32_16x16x32_bf16 a[92:95], a[216:219], a[152:155], a[92:95]
  s_sub_u32 s59, 8, s19
  ds_read_b64_tr_b16 a[200:201], v110 offset:18432
  v_mfma_f32_16x16x32_bf16 a[92:95], a[220:223], a[156:159], a[92:95]
  buffer_load_dwordx4 v88, s[8:11], s16 offen offset:0 lds
  v_mfma_f32_16x16x32_bf16 a[84:87], a[220:223], a[148:151], a[84:87]
  ds_read_b64_tr_b16 a[202:203], v110 offset:18944
  v_mfma_f32_16x16x32_bf16 a[84:87], a[216:219], a[144:147], a[84:87]
  s_bitcmp1_b32 s44, 0
  s_cselect_b32 s19, s59, s19
  v_mfma_f32_16x16x32_bf16 a[76:79], a[216:219], a[136:139], a[76:79]
  s_add_u32 s80, s47, s19
  ds_read_b64_tr_b16 a[204:205], v110 offset:26624
  v_mfma_f32_16x16x32_bf16 a[76:79], a[220:223], a[140:143], a[76:79]
  s_lshl_b32 s87, s98, 11
  v_add_u32 v112, s87, v3
  v_mfma_f32_16x16x32_bf16 a[68:71], a[220:223], a[132:135], a[68:71]
  v_xor_b32 v113, 2048, v112
  ds_read_b64_tr_b16 a[206:207], v110 offset:27136
  v_mfma_f32_16x16x32_bf16 a[68:71], a[216:219], a[128:131], a[68:71]
  s_waitcnt lgkmcnt(4)
  buffer_load_dwordx4 v89, s[8:11], s16 offen offset:1024 lds
  v_mfma_f32_16x16x32_bf16 v[40:43], a[192:195], a[128:131], v[40:43]
  v_xor_b32 v95, 4096, v112
  ds_read_b64_tr_b16 a[208:209], v111 offset:16384
  v_mfma_f32_16x16x32_bf16 v[40:43], a[196:199], a[132:135], v[40:43]
  v_xor_b32 v115, 6144, v112
  v_lshlrev_b32 v114, 3, v1
  v_mfma_f32_16x16x32_bf16 v[48:51], a[196:199], a[140:143], v[48:51]
  v_and_b32 v116, 1, v1
  ds_read_b64_tr_b16 a[210:211], v111 offset:16896
  v_mfma_f32_16x16x32_bf16 v[48:51], a[192:195], a[136:139], v[48:51]
  v_mul_u32_u24 v116, 0xaaaa, v116
  v_add_u32 v116, 0x4444, v116
  v_mfma_f32_16x16x32_bf16 v[56:59], a[192:195], a[144:147], v[56:59]
  v_lshl_or_b32 v116, v116, 16, v116
  ds_read_b64_tr_b16 a[212:213], v111 offset:24576
  v_mfma_f32_16x16x32_bf16 v[56:59], a[196:199], a[148:151], v[56:59]
  buffer_load_dwordx4 v90, s[8:11], s16 offen offset:2048 lds
  v_mfma_f32_16x16x32_bf16 v[64:67], a[196:199], a[156:159], v[64:67]
  s_lshr_b32 s19, s44, 3
  ds_read_b64_tr_b16 a[214:215], v111 offset:25088
  v_mfma_f32_16x16x32_bf16 v[64:67], a[192:195], a[152:155], v[64:67]
  s_waitcnt lgkmcnt(4)
  s_and_b32 s87, s44, 3
  v_mfma_f32_16x16x32_bf16 a[120:123], a[200:203], a[152:155], a[120:123]
  s_mul_i32 s42, s43, 5120
  ds_read_b64_tr_b16 a[216:217], v111 offset:18432
  v_mfma_f32_16x16x32_bf16 a[120:123], a[204:207], a[156:159], a[120:123]
  s_lshr_b32 s99, s43, 1
  s_mul_i32 s40, s99, 40960
  v_mfma_f32_16x16x32_bf16 a[112:115], a[204:207], a[148:151], a[112:115]
  s_xor_b32 s99, s43, s19
  ds_read_b64_tr_b16 a[218:219], v111 offset:18944
  v_mfma_f32_16x16x32_bf16 a[112:115], a[200:203], a[144:147], a[112:115]
  buffer_load_dwordx4 v91, s[8:11], s16 offen offset:3072 lds
  v_mfma_f32_16x16x32_bf16 a[104:107], a[200:203], a[136:139], a[104:107]
  s_and_b32 s99, s99, 1
  ds_read_b64_tr_b16 a[220:221], v111 offset:26624
  v_mfma_f32_16x16x32_bf16 a[104:107], a[204:207], a[140:143], a[104:107]
  s_mul_i32 s99, s99, 5120
  s_add_u32 s40, s40, s99
  v_mfma_f32_16x16x32_bf16 a[96:99], a[204:207], a[132:135], a[96:99]
  s_mul_i32 s99, s87, 10240
  ds_read_b64_tr_b16 a[222:223], v111 offset:27136
  v_mfma_f32_16x16x32_bf16 a[96:99], a[200:203], a[128:131], a[96:99]
  s_waitcnt lgkmcnt(4)
  s_add_u32 m0, s18, 114688
  s_waitcnt vmcnt(13)
  s_barrier
  v_mfma_f32_16x16x32_bf16 v[44:47], a[208:211], a[128:131], v[44:47]
  s_add_u32 s40, s40, s99
  ds_read_b64_tr_b16 a[192:193], v108 offset:0
  v_mfma_f32_16x16x32_bf16 v[44:47], a[212:215], a[132:135], v[44:47]
  buffer_load_dwordx4 v92, s[12:15], s17 offen offset:0 lds
  v_mfma_f32_16x16x32_bf16 v[52:55], a[212:215], a[140:143], v[52:55]
  s_mul_i32 s99, s19, 1310720
  ds_read_b64_tr_b16 a[194:195], v108 offset:512
  v_mfma_f32_16x16x32_bf16 v[52:55], a[208:211], a[136:139], v[52:55]
  s_add_u32 s84, s40, s99
  s_add_u32 s84, s84, 2211840
  v_mfma_f32_16x16x32_bf16 v[60:63], a[208:211], a[144:147], v[60:63]
  s_and_b32 s99, s44, 7
  ds_read_b64_tr_b16 a[196:197], v108 offset:8192
  v_mfma_f32_16x16x32_bf16 v[60:63], a[212:215], a[148:151], v[60:63]
  s_mul_i32 s99, s99, 163840
  s_add_u32 s29, s84, s99
  v_mfma_f32_16x16x32_bf16 v[68:71], a[212:215], a[156:159], v[68:71]
  s_lshr_b32 s59, s19, 1
  ds_read_b64_tr_b16 a[198:199], v108 offset:8704
  v_mfma_f32_16x16x32_bf16 v[68:71], a[208:211], a[152:155], v[68:71]
  s_waitcnt lgkmcnt(4)
  buffer_load_dwordx4 v93, s[12:15], s17 offen offset:1024 lds
  v_mfma_f32_16x16x32_bf16 a[124:127], a[216:219], a[152:155], a[124:127]
  s_mul_i32 s59, s59, 14
  ds_read_b64_tr_b16 a[200:201], v108 offset:2048
  v_mfma_f32_16x16x32_bf16 a[124:127], a[220:223], a[156:159], a[124:127]
  s_and_b32 s99, s19, 1
  s_mul_i32 s99, s99, 8
  v_mfma_f32_16x16x32_bf16 a[116:119], a[220:223], a[148:151], a[116:119]
  s_add_u32 s59, s59, s99
  ds_read_b64_tr_b16 a[202:203], v108 offset:2560
  v_mfma_f32_16x16x32_bf16 a[116:119], a[216:219], a[144:147], a[116:119]
  s_mul_i32 s99, s59, 81920
  s_add_u32 s40, s40, s99
  v_mfma_f32_16x16x32_bf16 a[108:111], a[216:219], a[136:139], a[108:111]
  s_lshl2_add_u32 s28, s45, s43
  ds_read_b64_tr_b16 a[204:205], v108 offset:10240
  v_mfma_f32_16x16x32_bf16 a[108:111], a[220:223], a[140:143], a[108:111]
  buffer_load_dwordx4 v92, s[12:15], s17 offen offset:2048 lds
  v_mfma_f32_16x16x32_bf16 a[100:103], a[220:223], a[132:135], a[100:103]
  s_lshl_b32 s41, s28, 13
  ds_read_b64_tr_b16 a[206:207], v108 offset:10752
  v_mfma_f32_16x16x32_bf16 a[100:103], a[216:219], a[128:131], a[100:103]
  s_waitcnt lgkmcnt(4)
  s_waitcnt vmcnt(7)
  v_mfma_f32_16x16x32_bf16 v[8:11], a[192:195], a[160:163], v[8:11]
  s_lshl_b32 s99, s19, 22
  ds_read_b64_tr_b16 a[208:209], v109 offset:0
  v_mfma_f32_16x16x32_bf16 v[8:11], a[196:199], a[164:167], v[8:11]
  s_add_u32 s85, s41, s99
  s_add_u32 s85, s85, 12582912
  v_mfma_f32_16x16x32_bf16 v[16:19], a[196:199], a[172:175], v[16:19]
  s_lshl_b32 s99, s59, 18
  ds_read_b64_tr_b16 a[210:211], v109 offset:512
  v_mfma_f32_16x16x32_bf16 v[16:19], a[192:195], a[168:171], v[16:19]
  buffer_load_dwordx4 v93, s[12:15], s17 offen offset:3072 lds
  v_mfma_f32_16x16x32_bf16 v[24:27], a[192:195], a[176:179], v[24:27]
  s_add_u32 s41, s41, s99
  ds_read_b64_tr_b16 a[212:213], v109 offset:8192
  v_mfma_f32_16x16x32_bf16 v[24:27], a[196:199], a[180:183], v[24:27]
  s_lshl2_add_u32 s28, s28, s98
  s_mul_i32 s28, s28, 20480
  v_mfma_f32_16x16x32_bf16 v[32:35], a[196:199], a[188:191], v[32:35]
  s_add_u32 m0, s18, 16384
  ds_read_b64_tr_b16 a[214:215], v109 offset:8704
  v_mfma_f32_16x16x32_bf16 v[32:35], a[192:195], a[184:187], v[32:35]
  s_waitcnt lgkmcnt(4)
  s_add_u32 s16, s16, 16384
  v_mfma_f32_16x16x32_bf16 a[88:91], a[200:203], a[184:187], a[88:91]
  s_and_b32 s3, s19, 1
  ds_read_b64_tr_b16 a[216:217], v109 offset:2048
  v_mfma_f32_16x16x32_bf16 a[88:91], a[204:207], a[188:191], a[88:91]
  buffer_load_dwordx4 v88, s[8:11], s16 offen offset:0 lds
  v_mfma_f32_16x16x32_bf16 a[80:83], a[204:207], a[180:183], a[80:83]
  s_lshl1_add_u32 s99, s87, s3
  ds_read_b64_tr_b16 a[218:219], v109 offset:2560
  v_mfma_f32_16x16x32_bf16 a[80:83], a[200:203], a[176:179], a[80:83]
  s_mul_i32 s99, s99, 160
  s_add_u32 s28, s28, s99
  v_mfma_f32_16x16x32_bf16 a[72:75], a[200:203], a[168:171], a[72:75]
  s_andn2_b32 s30, s96, 15
  ds_read_b64_tr_b16 a[220:221], v109 offset:10240
  v_mfma_f32_16x16x32_bf16 a[72:75], a[204:207], a[172:175], a[72:75]
  s_add_u32 s82, s46, 262144
  s_lshl_b32 s81, s44, 19
  v_mfma_f32_16x16x32_bf16 a[64:67], a[204:207], a[164:167], a[64:67]
  s_add_u32 s81, s81, 458752
  ds_read_b64_tr_b16 a[222:223], v109 offset:10752
  v_mfma_f32_16x16x32_bf16 a[64:67], a[200:203], a[160:163], a[64:67]
  s_waitcnt lgkmcnt(4)
  buffer_load_dwordx4 v89, s[8:11], s16 offen offset:1024 lds
  v_mfma_f32_16x16x32_bf16 v[12:15], a[208:211], a[160:163], v[12:15]
  s_mov_b32 s20, s88
  ds_read_b64_tr_b16 a[192:193], v110 offset:0
  v_mfma_f32_16x16x32_bf16 v[12:15], a[212:215], a[164:167], v[12:15]
  s_mov_b32 s21, s89
  s_mov_b32 s22, 2621440
L_pad_proj02_4:
  s_cbranch_execz L_back0
  v_mfma_f32_16x16x32_bf16 v[20:23], a[212:215], a[172:175], v[20:23]
  s_mov_b32 s23, 0x20000
  ds_read_b64_tr_b16 a[194:195], v110 offset:512
  v_mfma_f32_16x16x32_bf16 v[20:23], a[208:211], a[168:171], v[20:23]
  s_mov_b32 s24, s90
  s_mov_b32 s25, s91
  v_mfma_f32_16x16x32_bf16 v[28:31], a[208:211], a[176:179], v[28:31]
  s_mov_b32 s26, 2621440
  ds_read_b64_tr_b16 a[196:197], v110 offset:8192
  v_mfma_f32_16x16x32_bf16 v[28:31], a[212:215], a[180:183], v[28:31]
  buffer_load_dwordx4 v90, s[8:11], s16 offen offset:2048 lds
  v_mfma_f32_16x16x32_bf16 v[36:39], a[212:215], a[188:191], v[36:39]
  s_mov_b32 s27, 0x20000
  ds_read_b64_tr_b16 a[198:199], v110 offset:8704
  v_mfma_f32_16x16x32_bf16 v[36:39], a[208:211], a[184:187], v[36:39]
  s_waitcnt lgkmcnt(4)
  v_mfma_f32_16x16x32_bf16 a[92:95], a[216:219], a[184:187], a[92:95]
  ds_read_b64_tr_b16 a[200:201], v110 offset:2048
  v_mfma_f32_16x16x32_bf16 a[92:95], a[220:223], a[188:191], a[92:95]
  v_mfma_f32_16x16x32_bf16 a[84:87], a[220:223], a[180:183], a[84:87]
  ds_read_b64_tr_b16 a[202:203], v110 offset:2560
  v_mfma_f32_16x16x32_bf16 a[84:87], a[216:219], a[176:179], a[84:87]
  buffer_load_dwordx4 v91, s[8:11], s16 offen offset:3072 lds
  v_mfma_f32_16x16x32_bf16 a[76:79], a[216:219], a[168:171], a[76:79]
  ds_read_b64_tr_b16 a[204:205], v110 offset:10240
  v_mfma_f32_16x16x32_bf16 a[76:79], a[220:223], a[172:175], a[76:79]
  v_mfma_f32_16x16x32_bf16 a[68:71], a[220:223], a[164:167], a[68:71]
  ds_read_b64_tr_b16 a[206:207], v110 offset:10752
  v_mfma_f32_16x16x32_bf16 a[68:71], a[216:219], a[160:163], a[68:71]
  s_waitcnt lgkmcnt(4)
  v_mfma_f32_16x16x32_bf16 v[40:43], a[192:195], a[160:163], v[40:43]
  ds_read_b64_tr_b16 a[208:209], v111 offset:0
  v_mfma_f32_16x16x32_bf16 v[40:43], a[196:199], a[164:167], v[40:43]
  v_mfma_f32_16x16x32_bf16 v[48:51], a[196:199], a[172:175], v[48:51]
  ds_read_b64_tr_b16 a[210:211], v111 offset:512
  v_mfma_f32_16x16x32_bf16 v[48:51], a[192:195], a[168:171], v[48:51]
  v_mfma_f32_16x16x32_bf16 v[56:59], a[192:195], a[176:179], v[56:59]
  ds_read_b64_tr_b16 a[212:213], v111 offset:8192
  v_accvgpr_read_b32 v96, a88
  v_mfma_f32_16x16x32_bf16 v[56:59], a[196:199], a[180:183], v[56:59]
  v_accvgpr_read_b32 v97, a89
  v_accvgpr_read_b32 v98, a90
  v_mfma_f32_16x16x32_bf16 v[64:67], a[196:199], a[188:191], v[64:67]
  ds_read_b64_tr_b16 a[214:215], v111 offset:8704
  v_accvgpr_read_b32 v99, a91
  v_mfma_f32_16x16x32_bf16 v[64:67], a[192:195], a[184:187], v[64:67]
  s_waitcnt lgkmcnt(4)
  v_accvgpr_read_b32 v100, a92
  v_accvgpr_read_b32 v101, a93
  v_mfma_f32_16x16x32_bf16 a[120:123], a[200:203], a[184:187], a[120:123]
  ds_read_b64_tr_b16 a[216:217], v111 offset:2048
  v_accvgpr_read_b32 v102, a94
  v_mfma_f32_16x16x32_bf16 a[120:123], a[204:207], a[188:191], a[120:123]
  v_accvgpr_read_b32 v103, a95
  v_mul_f32 v32, v32, v96
  v_mfma_f32_16x16x32_bf16 a[112:115], a[204:207], a[180:183], a[112:115]
  ds_read_b64_tr_b16 a[218:219], v111 offset:2560
  v_mul_f32 v33, v33, v97
  v_mfma_f32_16x16x32_bf16 a[112:115], a[200:203], a[176:179], a[112:115]
  v_mul_f32 v34, v34, v98
  v_mul_f32 v35, v35, v99
  v_mfma_f32_16x16x32_bf16 a[104:107], a[200:203], a[168:171], a[104:107]
  ds_read_b64_tr_b16 a[220:221], v111 offset:10240
  v_mul_f32 v36, v36, v100
  v_mfma_f32_16x16x32_bf16 a[104:107], a[204:207], a[172:175], a[104:107]
  v_mul_f32 v37, v37, v101
  v_mul_f32 v38, v38, v102
  v_mfma_f32_16x16x32_bf16 a[96:99], a[204:207], a[164:167], a[96:99]
  ds_read_b64_tr_b16 a[222:223], v111 offset:10752
  v_mul_f32 v39, v39, v103
  v_mfma_f32_16x16x32_bf16 a[96:99], a[200:203], a[160:163], a[96:99]
  s_waitcnt lgkmcnt(4)
  v_cvt_pk_bf16_f32 v32, v32, v33
  v_cvt_pk_bf16_f32 v33, v34, v35
  v_mfma_f32_16x16x32_bf16 v[44:47], a[208:211], a[160:163], v[44:47]
  ds_read_b64_tr_b16 a[192:193], v107 offset:32768
  v_cvt_pk_bf16_f32 v34, v36, v37
  v_mfma_f32_16x16x32_bf16 v[44:47], a[212:215], a[164:167], v[44:47]
  v_cvt_pk_bf16_f32 v35, v38, v39
  v_mfma_f32_16x16x32_bf16 v[52:55], a[212:215], a[172:175], v[52:55]
  ds_read_b64_tr_b16 a[194:195], v107 offset:33792
  v_mfma_f32_16x16x32_bf16 v[52:55], a[208:211], a[168:171], v[52:55]
  buffer_store_dwordx4 v[32:35], v115, s[36:39], s47 offen offset:0 sc1
  v_mfma_f32_16x16x32_bf16 v[60:63], a[208:211], a[176:179], v[60:63]
  ds_read_b64_tr_b16 a[196:197], v107 offset:40960
  v_accvgpr_read_b32 v96, a80
  v_mfma_f32_16x16x32_bf16 v[60:63], a[212:215], a[180:183], v[60:63]
  v_accvgpr_read_b32 v97, a81
  v_accvgpr_read_b32 v98, a82
  v_mfma_f32_16x16x32_bf16 v[68:71], a[212:215], a[188:191], v[68:71]
  ds_read_b64_tr_b16 a[198:199], v107 offset:41984
  v_accvgpr_read_b32 v99, a83
  v_mfma_f32_16x16x32_bf16 v[68:71], a[208:211], a[184:187], v[68:71]
  s_waitcnt lgkmcnt(4)
  v_accvgpr_read_b32 v100, a84
  v_accvgpr_read_b32 v101, a85
  v_mfma_f32_16x16x32_bf16 a[124:127], a[216:219], a[184:187], a[124:127]
  ds_read_b64_tr_b16 a[200:201], v107 offset:49152
  v_accvgpr_read_b32 v102, a86
  v_mfma_f32_16x16x32_bf16 a[124:127], a[220:223], a[188:191], a[124:127]
  v_accvgpr_read_b32 v103, a87
  v_mul_f32 v24, v24, v96
  v_mfma_f32_16x16x32_bf16 a[116:119], a[220:223], a[180:183], a[116:119]
  ds_read_b64_tr_b16 a[202:203], v107 offset:50176
  v_mul_f32 v25, v25, v97
  v_mfma_f32_16x16x32_bf16 a[116:119], a[216:219], a[176:179], a[116:119]
  v_mul_f32 v26, v26, v98
  v_mul_f32 v27, v27, v99
  v_mfma_f32_16x16x32_bf16 a[108:111], a[216:219], a[168:171], a[108:111]
  ds_read_b64_tr_b16 a[204:205], v107 offset:57344
  v_mul_f32 v28, v28, v100
  v_mfma_f32_16x16x32_bf16 a[108:111], a[220:223], a[172:175], a[108:111]
  v_mul_f32 v29, v29, v101
  v_mul_f32 v30, v30, v102
  v_mfma_f32_16x16x32_bf16 a[100:103], a[220:223], a[164:167], a[100:103]
  ds_read_b64_tr_b16 a[206:207], v107 offset:58368
  v_mul_f32 v31, v31, v103
  v_mfma_f32_16x16x32_bf16 a[100:103], a[216:219], a[160:163], a[100:103]
  s_waitcnt lgkmcnt(4)
  v_cvt_pk_bf16_f32 v24, v24, v25
  v_cvt_pk_bf16_f32 v25, v26, v27
  v_mfma_f32_16x16x32_bf16 v[224:227], a[192:195], a[128:131], v[224:227]
  ds_read_b64_tr_b16 a[208:209], v107 offset:32776
  v_cvt_pk_bf16_f32 v26, v28, v29
  v_mfma_f32_16x16x32_bf16 v[224:227], a[196:199], a[132:135], v[224:227]
  v_cvt_pk_bf16_f32 v27, v30, v31
  v_mfma_f32_16x16x32_bf16 v[232:235], a[196:199], a[140:143], v[232:235]
  ds_read_b64_tr_b16 a[210:211], v107 offset:33800
  v_mfma_f32_16x16x32_bf16 v[232:235], a[192:195], a[136:139], v[232:235]
  buffer_store_dwordx4 v[24:27], v95, s[36:39], s47 offen offset:0 sc1
  v_mfma_f32_16x16x32_bf16 v[240:243], a[192:195], a[144:147], v[240:243]
  ds_read_b64_tr_b16 a[212:213], v107 offset:40968
  v_accvgpr_read_b32 v96, a72
  v_mfma_f32_16x16x32_bf16 v[240:243], a[196:199], a[148:151], v[240:243]
  v_accvgpr_read_b32 v97, a73
  v_accvgpr_read_b32 v98, a74
  v_mfma_f32_16x16x32_bf16 v[248:251], a[196:199], a[156:159], v[248:251]
  ds_read_b64_tr_b16 a[214:215], v107 offset:41992
  v_accvgpr_read_b32 v99, a75
  v_mfma_f32_16x16x32_bf16 v[248:251], a[192:195], a[152:155], v[248:251]
  s_waitcnt lgkmcnt(4)
  v_accvgpr_read_b32 v100, a76
  v_accvgpr_read_b32 v101, a77
  v_mfma_f32_16x16x32_bf16 v[248:251], a[200:203], a[184:187], v[248:251]
  ds_read_b64_tr_b16 a[216:217], v107 offset:49160
  v_accvgpr_read_b32 v102, a78
  v_mfma_f32_16x16x32_bf16 v[248:251], a[204:207], a[188:191], v[248:251]
  v_accvgpr_read_b32 v103, a79
  v_mul_f32 v16, v16, v96
  v_mfma_f32_16x16x32_bf16 v[240:243], a[204:207], a[180:183], v[240:243]
  ds_read_b64_tr_b16 a[218:219], v107 offset:50184
  v_mul_f32 v17, v17, v97
  v_mfma_f32_16x16x32_bf16 v[240:243], a[200:203], a[176:179], v[240:243]
  v_mul_f32 v18, v18, v98
  v_mul_f32 v19, v19, v99
  v_mfma_f32_16x16x32_bf16 v[232:235], a[200:203], a[168:171], v[232:235]
  ds_read_b64_tr_b16 a[220:221], v107 offset:57352
  v_mul_f32 v20, v20, v100
  v_mfma_f32_16x16x32_bf16 v[232:235], a[204:207], a[172:175], v[232:235]
  v_mul_f32 v21, v21, v101
  v_mul_f32 v22, v22, v102
  v_mfma_f32_16x16x32_bf16 v[224:227], a[204:207], a[164:167], v[224:227]
  ds_read_b64_tr_b16 a[222:223], v107 offset:58376
  v_mul_f32 v23, v23, v103
  v_mfma_f32_16x16x32_bf16 v[224:227], a[200:203], a[160:163], v[224:227]
  s_waitcnt lgkmcnt(4)
  v_cvt_pk_bf16_f32 v16, v16, v17
  v_cvt_pk_bf16_f32 v17, v18, v19
  v_mfma_f32_16x16x32_bf16 v[228:231], a[208:211], a[128:131], v[228:231]
  ds_read_b64_tr_b16 a[192:193], v106 offset:32768
  v_cvt_pk_bf16_f32 v18, v20, v21
  v_mfma_f32_16x16x32_bf16 v[228:231], a[212:215], a[132:135], v[228:231]
  v_cvt_pk_bf16_f32 v19, v22, v23
  v_mfma_f32_16x16x32_bf16 v[236:239], a[212:215], a[140:143], v[236:239]
  ds_read_b64_tr_b16 a[194:195], v106 offset:33792
  v_mfma_f32_16x16x32_bf16 v[236:239], a[208:211], a[136:139], v[236:239]
  buffer_store_dwordx4 v[16:19], v113, s[36:39], s47 offen offset:0 sc1
  v_mfma_f32_16x16x32_bf16 v[244:247], a[208:211], a[144:147], v[244:247]
  ds_read_b64_tr_b16 a[196:197], v106 offset:40960
  v_accvgpr_read_b32 v96, a64
  v_mfma_f32_16x16x32_bf16 v[244:247], a[212:215], a[148:151], v[244:247]
  v_accvgpr_read_b32 v97, a65
  v_accvgpr_read_b32 v98, a66
  v_mfma_f32_16x16x32_bf16 v[252:255], a[212:215], a[156:159], v[252:255]
  ds_read_b64_tr_b16 a[198:199], v106 offset:41984
  v_accvgpr_read_b32 v99, a67
  v_mfma_f32_16x16x32_bf16 v[252:255], a[208:211], a[152:155], v[252:255]
  s_waitcnt lgkmcnt(4)
  v_accvgpr_read_b32 v100, a68
  v_accvgpr_read_b32 v101, a69
  v_mfma_f32_16x16x32_bf16 v[252:255], a[216:219], a[184:187], v[252:255]
  ds_read_b64_tr_b16 a[200:201], v106 offset:49152
  v_accvgpr_read_b32 v102, a70
  v_mfma_f32_16x16x32_bf16 v[252:255], a[220:223], a[188:191], v[252:255]
  v_accvgpr_read_b32 v103, a71
  v_mul_f32 v8, v8, v96
  v_mfma_f32_16x16x32_bf16 v[244:247], a[220:223], a[180:183], v[244:247]
  ds_read_b64_tr_b16 a[202:203], v106 offset:50176
  v_mul_f32 v9, v9, v97
  v_mfma_f32_16x16x32_bf16 v[244:247], a[216:219], a[176:179], v[244:247]
  v_mul_f32 v10, v10, v98
  v_mul_f32 v11, v11, v99
  v_mfma_f32_16x16x32_bf16 v[236:239], a[216:219], a[168:171], v[236:239]
  ds_read_b64_tr_b16 a[204:205], v106 offset:57344
  v_mul_f32 v12, v12, v100
  v_mfma_f32_16x16x32_bf16 v[236:239], a[220:223], a[172:175], v[236:239]
  v_mul_f32 v13, v13, v101
  v_mul_f32 v14, v14, v102
  v_mfma_f32_16x16x32_bf16 v[228:231], a[220:223], a[164:167], v[228:231]
  ds_read_b64_tr_b16 a[206:207], v106 offset:58368
  v_mul_f32 v15, v15, v103
  v_mfma_f32_16x16x32_bf16 v[228:231], a[216:219], a[160:163], v[228:231]
  s_waitcnt lgkmcnt(4)
  v_cvt_pk_bf16_f32 v8, v8, v9
  v_cvt_pk_bf16_f32 v9, v10, v11
  v_mfma_f32_16x16x32_bf16 v[192:195], a[192:195], a[128:131], v[192:195]
  ds_read_b64_tr_b16 a[208:209], v106 offset:32776
  v_cvt_pk_bf16_f32 v10, v12, v13
  v_mfma_f32_16x16x32_bf16 v[192:195], a[196:199], a[132:135], v[192:195]
  v_cvt_pk_bf16_f32 v11, v14, v15
  v_mfma_f32_16x16x32_bf16 v[200:203], a[196:199], a[140:143], v[200:203]
  ds_read_b64_tr_b16 a[210:211], v106 offset:33800
  v_mfma_f32_16x16x32_bf16 v[200:203], a[192:195], a[136:139], v[200:203]
  buffer_store_dwordx4 v[8:11], v112, s[36:39], s47 offen offset:0 sc1
  v_mfma_f32_16x16x32_bf16 v[208:211], a[192:195], a[144:147], v[208:211]
  ds_read_b64_tr_b16 a[212:213], v106 offset:40968
  v_accvgpr_read_b32 v96, a120
  v_mfma_f32_16x16x32_bf16 v[208:211], a[196:199], a[148:151], v[208:211]
  v_accvgpr_read_b32 v97, a121
  v_accvgpr_read_b32 v98, a122
  v_mfma_f32_16x16x32_bf16 v[216:219], a[196:199], a[156:159], v[216:219]
  ds_read_b64_tr_b16 a[214:215], v106 offset:41992
  v_accvgpr_read_b32 v99, a123
  v_mfma_f32_16x16x32_bf16 v[216:219], a[192:195], a[152:155], v[216:219]
  s_waitcnt lgkmcnt(4)
  v_accvgpr_read_b32 v100, a124
  v_accvgpr_read_b32 v101, a125
  v_mfma_f32_16x16x32_bf16 v[216:219], a[200:203], a[184:187], v[216:219]
  ds_read_b64_tr_b16 a[216:217], v106 offset:49160
  v_accvgpr_read_b32 v102, a126
  v_mfma_f32_16x16x32_bf16 v[216:219], a[204:207], a[188:191], v[216:219]
  v_accvgpr_read_b32 v103, a127
  v_mul_f32 v64, v64, v96
  v_mfma_f32_16x16x32_bf16 v[208:211], a[204:207], a[180:183], v[208:211]
  ds_read_b64_tr_b16 a[218:219], v106 offset:50184
  v_mul_f32 v65, v65, v97
  v_mfma_f32_16x16x32_bf16 v[208:211], a[200:203], a[176:179], v[208:211]
  v_mul_f32 v66, v66, v98
  v_mul_f32 v67, v67, v99
  v_mfma_f32_16x16x32_bf16 v[200:203], a[200:203], a[168:171], v[200:203]
  ds_read_b64_tr_b16 a[220:221], v106 offset:57352
  v_mul_f32 v68, v68, v100
  v_mfma_f32_16x16x32_bf16 v[200:203], a[204:207], a[172:175], v[200:203]
  v_mul_f32 v69, v69, v101
  v_mul_f32 v70, v70, v102
  v_mfma_f32_16x16x32_bf16 v[192:195], a[204:207], a[164:167], v[192:195]
  ds_read_b64_tr_b16 a[222:223], v106 offset:58376
  v_mul_f32 v71, v71, v103
  v_mfma_f32_16x16x32_bf16 v[192:195], a[200:203], a[160:163], v[192:195]
  s_waitcnt lgkmcnt(4)
  v_cvt_pk_bf16_f32 v64, v64, v65
  v_cvt_pk_bf16_f32 v65, v66, v67
  v_mfma_f32_16x16x32_bf16 v[196:199], a[208:211], a[128:131], v[196:199]
  ds_read_b64_tr_b16 a[192:193], v105 offset:32768
  v_cvt_pk_bf16_f32 v66, v68, v69
  v_mfma_f32_16x16x32_bf16 v[196:199], a[212:215], a[132:135], v[196:199]
  v_cvt_pk_bf16_f32 v67, v70, v71
  v_mfma_f32_16x16x32_bf16 v[204:207], a[212:215], a[140:143], v[204:207]
  ds_read_b64_tr_b16 a[194:195], v105 offset:33792
  v_mfma_f32_16x16x32_bf16 v[204:207], a[208:211], a[136:139], v[204:207]
  buffer_store_dwordx4 v[64:67], v115, s[36:39], s47 offen offset:1024 sc1
  v_mfma_f32_16x16x32_bf16 v[212:215], a[208:211], a[144:147], v[212:215]
  ds_read_b64_tr_b16 a[196:197], v105 offset:40960
  v_cvt_pk_bf16_f32 v255, v254, v255
  v_mfma_f32_16x16x32_bf16 v[212:215], a[212:215], a[148:151], v[212:215]
  v_cvt_pk_bf16_f32 v254, v252, v253
  v_cvt_pk_bf16_f32 v253, v250, v251
  v_mfma_f32_16x16x32_bf16 v[220:223], a[212:215], a[156:159], v[220:223]
  ds_read_b64_tr_b16 a[198:199], v105 offset:41984
  v_cvt_pk_bf16_f32 v252, v248, v249
  v_mfma_f32_16x16x32_bf16 v[220:223], a[208:211], a[152:155], v[220:223]
  s_waitcnt lgkmcnt(4)
  v_cvt_pk_bf16_f32 v251, v246, v247
  v_cvt_pk_bf16_f32 v250, v244, v245
  v_mfma_f32_16x16x32_bf16 v[220:223], a[216:219], a[184:187], v[220:223]
  ds_read_b64_tr_b16 a[200:201], v105 offset:49152
  v_cvt_pk_bf16_f32 v249, v242, v243
  v_mfma_f32_16x16x32_bf16 v[220:223], a[220:223], a[188:191], v[220:223]
  v_cvt_pk_bf16_f32 v248, v240, v241
  v_cvt_pk_bf16_f32 v247, v238, v239
  v_mfma_f32_16x16x32_bf16 v[212:215], a[220:223], a[180:183], v[212:215]
  ds_read_b64_tr_b16 a[202:203], v105 offset:50176
  v_cvt_pk_bf16_f32 v246, v236, v237
  v_mfma_f32_16x16x32_bf16 v[212:215], a[216:219], a[176:179], v[212:215]
  v_cvt_pk_bf16_f32 v245, v234, v235
  v_cvt_pk_bf16_f32 v244, v232, v233
  v_mfma_f32_16x16x32_bf16 v[204:207], a[216:219], a[168:171], v[204:207]
  ds_read_b64_tr_b16 a[204:205], v105 offset:57344
  v_cvt_pk_bf16_f32 v243, v230, v231
  v_mfma_f32_16x16x32_bf16 v[204:207], a[220:223], a[172:175], v[204:207]
  v_cvt_pk_bf16_f32 v242, v228, v229
  v_cvt_pk_bf16_f32 v241, v226, v227
  v_mfma_f32_16x16x32_bf16 v[196:199], a[220:223], a[164:167], v[196:199]
  ds_read_b64_tr_b16 a[206:207], v105 offset:58368
  v_cvt_pk_bf16_f32 v240, v224, v225
  v_mfma_f32_16x16x32_bf16 v[196:199], a[216:219], a[160:163], v[196:199]
  s_waitcnt lgkmcnt(4)
  v_accvgpr_read_b32 v96, a112
  v_accvgpr_read_b32 v97, a113
  v_mfma_f32_16x16x32_bf16 v[160:163], a[192:195], a[128:131], v[160:163]
  ds_read_b64_tr_b16 a[208:209], v105 offset:32776
  v_accvgpr_read_b32 v98, a114
  v_mfma_f32_16x16x32_bf16 v[160:163], a[196:199], a[132:135], v[160:163]
  v_accvgpr_read_b32 v99, a115
  v_accvgpr_read_b32 v100, a116
  v_mfma_f32_16x16x32_bf16 v[168:171], a[196:199], a[140:143], v[168:171]
  ds_read_b64_tr_b16 a[210:211], v105 offset:33800
  v_accvgpr_read_b32 v101, a117
  v_mfma_f32_16x16x32_bf16 v[168:171], a[192:195], a[136:139], v[168:171]
  v_accvgpr_read_b32 v102, a118
  v_accvgpr_read_b32 v103, a119
  v_mfma_f32_16x16x32_bf16 v[176:179], a[192:195], a[144:147], v[176:179]
  ds_read_b64_tr_b16 a[212:213], v105 offset:40968
  v_mul_f32 v56, v56, v96
  v_mfma_f32_16x16x32_bf16 v[176:179], a[196:199], a[148:151], v[176:179]
  v_mul_f32 v57, v57, v97
  v_mul_f32 v58, v58, v98
  v_mfma_f32_16x16x32_bf16 v[184:187], a[196:199], a[156:159], v[184:187]
  ds_read_b64_tr_b16 a[214:215], v105 offset:41992
  v_mul_f32 v59, v59, v99
  v_mfma_f32_16x16x32_bf16 v[184:187], a[192:195], a[152:155], v[184:187]
  s_waitcnt lgkmcnt(4)
  v_mul_f32 v60, v60, v100
  v_mul_f32 v61, v61, v101
  v_mfma_f32_16x16x32_bf16 v[184:187], a[200:203], a[184:187], v[184:187]
  ds_read_b64_tr_b16 a[216:217], v105 offset:49160
  v_mul_f32 v62, v62, v102
  v_mfma_f32_16x16x32_bf16 v[184:187], a[204:207], a[188:191], v[184:187]
  v_mul_f32 v63, v63, v103
  v_cvt_pk_bf16_f32 v56, v56, v57
  v_mfma_f32_16x16x32_bf16 v[176:179], a[204:207], a[180:183], v[176:179]
  ds_read_b64_tr_b16 a[218:219], v105 offset:50184
  v_cvt_pk_bf16_f32 v57, v58, v59
  v_mfma_f32_16x16x32_bf16 v[176:179], a[200:203], a[176:179], v[176:179]
  v_cvt_pk_bf16_f32 v58, v60, v61
  v_cvt_pk_bf16_f32 v59, v62, v63
  v_mfma_f32_16x16x32_bf16 v[168:171], a[200:203], a[168:171], v[168:171]
  ds_read_b64_tr_b16 a[220:221], v105 offset:57352
  v_mfma_f32_16x16x32_bf16 v[168:171], a[204:207], a[172:175], v[168:171]
  buffer_store_dwordx4 v[56:59], v95, s[36:39], s47 offen offset:1024 sc1
  v_mfma_f32_16x16x32_bf16 v[160:163], a[204:207], a[164:167], v[160:163]
  ds_read_b64_tr_b16 a[222:223], v105 offset:58376
  v_cvt_pk_bf16_f32 v239, v222, v223
  v_mfma_f32_16x16x32_bf16 v[160:163], a[200:203], a[160:163], v[160:163]
  s_waitcnt lgkmcnt(4)
  v_cvt_pk_bf16_f32 v238, v220, v221
  v_cvt_pk_bf16_f32 v237, v218, v219
  v_mfma_f32_16x16x32_bf16 v[164:167], a[208:211], a[128:131], v[164:167]
  ds_read_b64_tr_b16 a[192:193], v104 offset:32768
  v_cvt_pk_bf16_f32 v236, v216, v217
  v_mfma_f32_16x16x32_bf16 v[164:167], a[212:215], a[132:135], v[164:167]
  v_cvt_pk_bf16_f32 v235, v214, v215
  v_cvt_pk_bf16_f32 v234, v212, v213
  v_mfma_f32_16x16x32_bf16 v[172:175], a[212:215], a[140:143], v[172:175]
  ds_read_b64_tr_b16 a[194:195], v104 offset:33792
  v_cvt_pk_bf16_f32 v233, v210, v211
  v_mfma_f32_16x16x32_bf16 v[172:175], a[208:211], a[136:139], v[172:175]
  v_cvt_pk_bf16_f32 v232, v208, v209
  v_cvt_pk_bf16_f32 v231, v206, v207
  v_mfma_f32_16x16x32_bf16 v[180:183], a[208:211], a[144:147], v[180:183]
  ds_read_b64_tr_b16 a[196:197], v104 offset:40960
  v_cvt_pk_bf16_f32 v230, v204, v205
  v_mfma_f32_16x16x32_bf16 v[180:183], a[212:215], a[148:151], v[180:183]
  v_cvt_pk_bf16_f32 v229, v202, v203
  v_cvt_pk_bf16_f32 v228, v200, v201
  v_mfma_f32_16x16x32_bf16 v[188:191], a[212:215], a[156:159], v[188:191]
  ds_read_b64_tr_b16 a[198:199], v104 offset:41984
  v_cvt_pk_bf16_f32 v227, v198, v199
  v_mfma_f32_16x16x32_bf16 v[188:191], a[208:211], a[152:155], v[188:191]
  s_waitcnt lgkmcnt(4)
  v_cvt_pk_bf16_f32 v226, v196, v197
  v_cvt_pk_bf16_f32 v225, v194, v195
  v_mfma_f32_16x16x32_bf16 v[188:191], a[216:219], a[184:187], v[188:191]
  ds_read_b64_tr_b16 a[200:201], v104 offset:49152
  v_cvt_pk_bf16_f32 v224, v192, v193
  v_mfma_f32_16x16x32_bf16 v[188:191], a[220:223], a[188:191], v[188:191]
  v_accvgpr_read_b32 v96, a104
  v_accvgpr_read_b32 v97, a105
  v_mfma_f32_16x16x32_bf16 v[180:183], a[220:223], a[180:183], v[180:183]
  ds_read_b64_tr_b16 a[202:203], v104 offset:50176
  v_accvgpr_read_b32 v98, a106
  v_mfma_f32_16x16x32_bf16 v[180:183], a[216:219], a[176:179], v[180:183]
  v_accvgpr_read_b32 v99, a107
  v_accvgpr_read_b32 v100, a108
  v_mfma_f32_16x16x32_bf16 v[172:175], a[216:219], a[168:171], v[172:175]
  ds_read_b64_tr_b16 a[204:205], v104 offset:57344
  v_accvgpr_read_b32 v101, a109
  v_mfma_f32_16x16x32_bf16 v[172:175], a[220:223], a[172:175], v[172:175]
  v_accvgpr_read_b32 v102, a110
  v_accvgpr_read_b32 v103, a111
  v_mfma_f32_16x16x32_bf16 v[164:167], a[220:223], a[164:167], v[164:167]
  ds_read_b64_tr_b16 a[206:207], v104 offset:58368
  v_mul_f32 v48, v48, v96
  v_mfma_f32_16x16x32_bf16 v[164:167], a[216:219], a[160:163], v[164:167]
  s_waitcnt lgkmcnt(4)
  v_mul_f32 v49, v49, v97
  v_mul_f32 v50, v50, v98
  v_mfma_f32_16x16x32_bf16 v[128:131], a[192:195], a[128:131], v[128:131]
  ds_read_b64_tr_b16 a[208:209], v104 offset:32776
  v_mul_f32 v51, v51, v99
  v_mfma_f32_16x16x32_bf16 v[128:131], a[196:199], a[132:135], v[128:131]
  v_mul_f32 v52, v52, v100
  v_mul_f32 v53, v53, v101
  v_mfma_f32_16x16x32_bf16 v[136:139], a[196:199], a[140:143], v[136:139]
  ds_read_b64_tr_b16 a[210:211], v104 offset:33800
  v_mul_f32 v54, v54, v102
  v_mfma_f32_16x16x32_bf16 v[136:139], a[192:195], a[136:139], v[136:139]
  v_mul_f32 v55, v55, v103
  v_cvt_pk_bf16_f32 v48, v48, v49
  v_mfma_f32_16x16x32_bf16 v[144:147], a[192:195], a[144:147], v[144:147]
  ds_read_b64_tr_b16 a[212:213], v104 offset:40968
  v_cvt_pk_bf16_f32 v49, v50, v51
  v_mfma_f32_16x16x32_bf16 v[144:147], a[196:199], a[148:151], v[144:147]
  v_cvt_pk_bf16_f32 v50, v52, v53
  v_cvt_pk_bf16_f32 v51, v54, v55
  v_mfma_f32_16x16x32_bf16 v[152:155], a[196:199], a[156:159], v[152:155]
  ds_read_b64_tr_b16 a[214:215], v104 offset:41992
  v_mfma_f32_16x16x32_bf16 v[152:155], a[192:195], a[152:155], v[152:155]
  s_waitcnt lgkmcnt(4)
  buffer_store_dwordx4 v[48:51], v113, s[36:39], s47 offen offset:1024 sc1
  v_mfma_f32_16x16x32_bf16 v[152:155], a[200:203], a[184:187], v[152:155]
  ds_read_b64_tr_b16 a[216:217], v104 offset:49160
  v_cvt_pk_bf16_f32 v223, v190, v191
  v_mfma_f32_16x16x32_bf16 v[152:155], a[204:207], a[188:191], v[152:155]
  v_cvt_pk_bf16_f32 v222, v188, v189
  v_cvt_pk_bf16_f32 v221, v186, v187
  v_mfma_f32_16x16x32_bf16 v[144:147], a[204:207], a[180:183], v[144:147]
  ds_read_b64_tr_b16 a[218:219], v104 offset:50184
  v_cvt_pk_bf16_f32 v220, v184, v185
  v_mfma_f32_16x16x32_bf16 v[144:147], a[200:203], a[176:179], v[144:147]
  v_cvt_pk_bf16_f32 v219, v182, v183
  v_cvt_pk_bf16_f32 v218, v180, v181
  v_mfma_f32_16x16x32_bf16 v[136:139], a[200:203], a[168:171], v[136:139]
  ds_read_b64_tr_b16 a[220:221], v104 offset:57352
  v_cvt_pk_bf16_f32 v217, v178, v179
  v_mfma_f32_16x16x32_bf16 v[136:139], a[204:207], a[172:175], v[136:139]
  v_cvt_pk_bf16_f32 v216, v176, v177
  v_cvt_pk_bf16_f32 v215, v174, v175
  v_mfma_f32_16x16x32_bf16 v[128:131], a[204:207], a[164:167], v[128:131]
  ds_read_b64_tr_b16 a[222:223], v104 offset:58376
  v_cvt_pk_bf16_f32 v214, v172, v173
  v_mfma_f32_16x16x32_bf16 v[128:131], a[200:203], a[160:163], v[128:131]
  s_waitcnt lgkmcnt(4)
  v_cvt_pk_bf16_f32 v213, v170, v171
  v_cvt_pk_bf16_f32 v212, v168, v169
  v_mfma_f32_16x16x32_bf16 v[132:135], a[208:211], a[128:131], v[132:135]
  v_cvt_pk_bf16_f32 v211, v166, v167
  v_cvt_pk_bf16_f32 v210, v164, v165
  v_mfma_f32_16x16x32_bf16 v[132:135], a[212:215], a[132:135], v[132:135]
  v_cvt_pk_bf16_f32 v209, v162, v163
  v_cvt_pk_bf16_f32 v208, v160, v161
  v_mfma_f32_16x16x32_bf16 v[140:143], a[212:215], a[140:143], v[140:143]
  v_accvgpr_read_b32 v96, a96
  v_accvgpr_read_b32 v97, a97
  v_mfma_f32_16x16x32_bf16 v[140:143], a[208:211], a[136:139], v[140:143]
  v_accvgpr_read_b32 v98, a98
  v_accvgpr_read_b32 v99, a99
  v_mfma_f32_16x16x32_bf16 v[148:151], a[208:211], a[144:147], v[148:151]
  v_accvgpr_read_b32 v100, a100
  v_accvgpr_read_b32 v101, a101
  v_mfma_f32_16x16x32_bf16 v[148:151], a[212:215], a[148:151], v[148:151]
  v_accvgpr_read_b32 v102, a102
  v_accvgpr_read_b32 v103, a103
  v_mfma_f32_16x16x32_bf16 v[156:159], a[212:215], a[156:159], v[156:159]
  v_mul_f32 v40, v40, v96
  v_mul_f32 v41, v41, v97
  v_mfma_f32_16x16x32_bf16 v[156:159], a[208:211], a[152:155], v[156:159]
  s_waitcnt lgkmcnt(0)
  s_waitcnt vmcnt(15)
  s_barrier
  v_mul_f32 v42, v42, v98
  v_mul_f32 v43, v43, v99
  v_mfma_f32_16x16x32_bf16 v[156:159], a[216:219], a[184:187], v[156:159]
  ds_read_b128 a[204:207], v79 offset:0
  v_mul_f32 v44, v44, v100
  v_mfma_f32_16x16x32_bf16 v[156:159], a[220:223], a[188:191], v[156:159]
  v_mul_f32 v45, v45, v101
  v_mul_f32 v46, v46, v102
  v_mfma_f32_16x16x32_bf16 v[148:151], a[220:223], a[180:183], v[148:151]
  ds_read_b128 a[200:203], v78 offset:0
  v_mul_f32 v47, v47, v103
  v_mfma_f32_16x16x32_bf16 v[148:151], a[216:219], a[176:179], v[148:151]
  v_cvt_pk_bf16_f32 v40, v40, v41
  v_cvt_pk_bf16_f32 v41, v42, v43
  v_mfma_f32_16x16x32_bf16 v[140:143], a[216:219], a[168:171], v[140:143]
  ds_read_b128 a[196:199], v77 offset:0
  v_cvt_pk_bf16_f32 v42, v44, v45
  v_mfma_f32_16x16x32_bf16 v[140:143], a[220:223], a[172:175], v[140:143]
  v_cvt_pk_bf16_f32 v43, v46, v47
  v_mfma_f32_16x16x32_bf16 v[132:135], a[220:223], a[164:167], v[132:135]
  ds_read_b128 a[192:195], v76 offset:0
  v_mfma_f32_16x16x32_bf16 v[132:135], a[216:219], a[160:163], v[132:135]
  s_waitcnt lgkmcnt(0)
  buffer_store_dwordx4 v[40:43], v112, s[36:39], s47 offen offset:1024 sc1
  s_branch L_fm
.p2align 6
L_proj1:
  s_waitcnt vmcnt(7)
  s_waitcnt lgkmcnt(4)
  v_mfma_f32_16x16x32_bf16 v[8:11], a[192:195], a[128:131], 0
L_pad_proj12_0:
  s_cbranch_execz L_pad_proj12_1
  ds_read_b64_tr_b16 a[208:209], v109 offset:16384
  v_mfma_f32_16x16x32_bf16 v[8:11], a[196:199], a[132:135], v[8:11]
  s_waitcnt vmcnt(5)
  v_mfma_f32_16x16x32_bf16 v[16:19], a[196:199], a[140:143], 0
  ds_read_b64_tr_b16 a[210:211], v109 offset:16896
  v_mfma_f32_16x16x32_bf16 v[16:19], a[192:195], a[136:139], v[16:19]
  s_waitcnt vmcnt(3)
  v_mfma_f32_16x16x32_bf16 v[24:27], a[192:195], a[144:147], 0
  ds_read_b64_tr_b16 a[212:213], v109 offset:24576
  v_mfma_f32_16x16x32_bf16 v[24:27], a[196:199], a[148:151], v[24:27]
  s_waitcnt vmcnt(1)
  s_add_u32 s42, s42, 512
  v_mfma_f32_16x16x32_bf16 v[32:35], a[196:199], a[156:159], 0
  ds_read_b64_tr_b16 a[214:215], v109 offset:25088
  v_mfma_f32_16x16x32_bf16 v[32:35], a[192:195], a[152:155], v[32:35]
  s_waitcnt lgkmcnt(4)
  buffer_load_dwordx4 a[160:163], v100, s[32:35], s42 offen offset:0 sc1
  v_mfma_f32_16x16x32_bf16 a[88:91], a[200:203], a[152:155], 0
  ds_read_b64_tr_b16 a[216:217], v109 offset:18432
  v_mfma_f32_16x16x32_bf16 a[88:91], a[204:207], a[156:159], a[88:91]
  v_mfma_f32_16x16x32_bf16 a[80:83], a[204:207], a[148:151], 0
  ds_read_b64_tr_b16 a[218:219], v109 offset:18944
  v_mfma_f32_16x16x32_bf16 a[80:83], a[200:203], a[144:147], a[80:83]
  buffer_load_dwordx4 a[164:167], v100, s[32:35], s42 offen offset:256 sc1
  v_mfma_f32_16x16x32_bf16 a[72:75], a[200:203], a[136:139], 0
  ds_read_b64_tr_b16 a[220:221], v109 offset:26624
  v_mfma_f32_16x16x32_bf16 a[72:75], a[204:207], a[140:143], a[72:75]
  v_mfma_f32_16x16x32_bf16 a[64:67], a[204:207], a[132:135], 0
  ds_read_b64_tr_b16 a[222:223], v109 offset:27136
  v_mfma_f32_16x16x32_bf16 a[64:67], a[200:203], a[128:131], a[64:67]
  s_waitcnt lgkmcnt(4)
  v_mfma_f32_16x16x32_bf16 v[12:15], a[208:211], a[128:131], 0
  ds_read_b64_tr_b16 a[192:193], v110 offset:16384
  v_mfma_f32_16x16x32_bf16 v[12:15], a[212:215], a[132:135], v[12:15]
  buffer_load_dwordx4 a[168:171], v101, s[32:35], s42 offen offset:0 sc1
  v_mfma_f32_16x16x32_bf16 v[20:23], a[212:215], a[140:143], 0
  ds_read_b64_tr_b16 a[194:195], v110 offset:16896
  v_mfma_f32_16x16x32_bf16 v[20:23], a[208:211], a[136:139], v[20:23]
  v_mfma_f32_16x16x32_bf16 v[28:31], a[208:211], a[144:147], 0
  ds_read_b64_tr_b16 a[196:197], v110 offset:24576
  v_mfma_f32_16x16x32_bf16 v[28:31], a[212:215], a[148:151], v[28:31]
  buffer_load_dwordx4 a[172:175], v101, s[32:35], s42 offen offset:256 sc1
  v_mfma_f32_16x16x32_bf16 v[36:39], a[212:215], a[156:159], 0
L_pad_proj12_1:
  s_cbranch_execz L_pad_proj12_2
  ds_read_b64_tr_b16 a[198:199], v110 offset:25088
  v_mfma_f32_16x16x32_bf16 v[36:39], a[208:211], a[152:155], v[36:39]
  s_waitcnt lgkmcnt(4)
  v_mfma_f32_16x16x32_bf16 a[92:95], a[216:219], a[152:155], 0
  ds_read_b64_tr_b16 a[200:201], v110 offset:18432
  v_mfma_f32_16x16x32_bf16 a[92:95], a[220:223], a[156:159], a[92:95]
  v_mfma_f32_16x16x32_bf16 a[84:87], a[220:223], a[148:151], 0
  ds_read_b64_tr_b16 a[202:203], v110 offset:18944
  v_mfma_f32_16x16x32_bf16 a[84:87], a[216:219], a[144:147], a[84:87]
  buffer_load_dwordx4 a[176:179], v102, s[32:35], s42 offen offset:0 sc1
  v_mfma_f32_16x16x32_bf16 a[76:79], a[216:219], a[136:139], 0
  ds_read_b64_tr_b16 a[204:205], v110 offset:26624
  v_mfma_f32_16x16x32_bf16 a[76:79], a[220:223], a[140:143], a[76:79]
  v_mfma_f32_16x16x32_bf16 a[68:71], a[220:223], a[132:135], 0
  ds_read_b64_tr_b16 a[206:207], v110 offset:27136
  v_mfma_f32_16x16x32_bf16 a[68:71], a[216:219], a[128:131], a[68:71]
  s_waitcnt lgkmcnt(4)
  buffer_load_dwordx4 a[180:183], v102, s[32:35], s42 offen offset:256 sc1
  v_mfma_f32_16x16x32_bf16 v[40:43], a[192:195], a[128:131], 0
  ds_read_b64_tr_b16 a[208:209], v107 offset:32768
  v_mfma_f32_16x16x32_bf16 v[40:43], a[196:199], a[132:135], v[40:43]
  v_mfma_f32_16x16x32_bf16 v[48:51], a[196:199], a[140:143], 0
  ds_read_b64_tr_b16 a[210:211], v107 offset:33792
  v_mfma_f32_16x16x32_bf16 v[48:51], a[192:195], a[136:139], v[48:51]
  v_mfma_f32_16x16x32_bf16 v[56:59], a[192:195], a[144:147], 0
  ds_read_b64_tr_b16 a[212:213], v107 offset:40960
  v_mfma_f32_16x16x32_bf16 v[56:59], a[196:199], a[148:151], v[56:59]
  buffer_load_dwordx4 a[184:187], v103, s[32:35], s42 offen offset:0 sc1
  v_mfma_f32_16x16x32_bf16 v[64:67], a[196:199], a[156:159], 0
  ds_read_b64_tr_b16 a[214:215], v107 offset:41984
  v_mfma_f32_16x16x32_bf16 v[64:67], a[192:195], a[152:155], v[64:67]
  s_waitcnt lgkmcnt(4)
  v_mfma_f32_16x16x32_bf16 a[120:123], a[200:203], a[152:155], 0
  ds_read_b64_tr_b16 a[216:217], v107 offset:32776
  v_mfma_f32_16x16x32_bf16 a[120:123], a[204:207], a[156:159], a[120:123]
  buffer_load_dwordx4 a[188:191], v103, s[32:35], s42 offen offset:256 sc1
  v_mfma_f32_16x16x32_bf16 a[112:115], a[204:207], a[148:151], 0
  ds_read_b64_tr_b16 a[218:219], v107 offset:33800
  v_mfma_f32_16x16x32_bf16 a[112:115], a[200:203], a[144:147], a[112:115]
  v_mfma_f32_16x16x32_bf16 a[104:107], a[200:203], a[136:139], 0
  s_add_u32 m0, s18, 0
  ds_read_b64_tr_b16 a[220:221], v107 offset:40968
  v_mfma_f32_16x16x32_bf16 a[104:107], a[204:207], a[140:143], a[104:107]
  s_add_u32 s40, s40, 429056
  v_mfma_f32_16x16x32_bf16 a[96:99], a[204:207], a[132:135], 0
  ds_read_b64_tr_b16 a[222:223], v107 offset:41992
  v_mfma_f32_16x16x32_bf16 a[96:99], a[200:203], a[128:131], a[96:99]
  s_waitcnt lgkmcnt(4)
  buffer_load_dwordx4 v112, s[20:23], s40 offen offset:0 lds
  v_mfma_f32_16x16x32_bf16 v[224:227], a[208:211], a[128:131], 0
  ds_read_b64_tr_b16 a[192:193], v106 offset:32768
  v_mfma_f32_16x16x32_bf16 v[224:227], a[212:215], a[132:135], v[224:227]
  s_add_u32 s40, s40, 31744
  v_mfma_f32_16x16x32_bf16 v[232:235], a[212:215], a[140:143], 0
  ds_read_b64_tr_b16 a[194:195], v106 offset:33792
  v_mfma_f32_16x16x32_bf16 v[232:235], a[208:211], a[136:139], v[232:235]
  buffer_load_dwordx4 v112, s[20:23], s40 offen offset:1024 lds
  v_mfma_f32_16x16x32_bf16 v[240:243], a[208:211], a[144:147], 0
  ds_read_b64_tr_b16 a[196:197], v106 offset:40960
  v_mfma_f32_16x16x32_bf16 v[240:243], a[212:215], a[148:151], v[240:243]
  v_mfma_f32_16x16x32_bf16 v[248:251], a[212:215], a[156:159], 0
  ds_read_b64_tr_b16 a[198:199], v106 offset:41984
  v_mfma_f32_16x16x32_bf16 v[248:251], a[208:211], a[152:155], v[248:251]
  s_waitcnt lgkmcnt(4)
  s_add_u32 s40, s40, 31744
  v_mfma_f32_16x16x32_bf16 v[252:255], a[216:219], a[152:155], 0
  ds_read_b64_tr_b16 a[200:201], v106 offset:32776
  v_mfma_f32_16x16x32_bf16 v[252:255], a[220:223], a[156:159], v[252:255]
  buffer_load_dwordx4 v112, s[20:23], s40 offen offset:2048 lds
  v_mfma_f32_16x16x32_bf16 v[244:247], a[220:223], a[148:151], 0
  ds_read_b64_tr_b16 a[202:203], v106 offset:33800
  v_mfma_f32_16x16x32_bf16 v[244:247], a[216:219], a[144:147], v[244:247]
  s_add_u32 s40, s40, 31744
  v_mfma_f32_16x16x32_bf16 v[236:239], a[216:219], a[136:139], 0
  ds_read_b64_tr_b16 a[204:205], v106 offset:40968
  v_mfma_f32_16x16x32_bf16 v[236:239], a[220:223], a[140:143], v[236:239]
  buffer_load_dwordx4 v112, s[20:23], s40 offen offset:3072 lds
  v_mfma_f32_16x16x32_bf16 v[228:231], a[220:223], a[132:135], 0
  ds_read_b64_tr_b16 a[206:207], v106 offset:41992
  v_mfma_f32_16x16x32_bf16 v[228:231], a[216:219], a[128:131], v[228:231]
  s_waitcnt lgkmcnt(4)
  v_mfma_f32_16x16x32_bf16 v[192:195], a[192:195], a[128:131], 0
  s_add_u32 m0, s18, 114688
  ds_read_b64_tr_b16 a[208:209], v105 offset:32768
  v_mfma_f32_16x16x32_bf16 v[192:195], a[196:199], a[132:135], v[192:195]
  s_add_u32 s41, s41, 221184
  v_mfma_f32_16x16x32_bf16 v[200:203], a[196:199], a[140:143], 0
  ds_read_b64_tr_b16 a[210:211], v105 offset:33792
  v_mfma_f32_16x16x32_bf16 v[200:203], a[192:195], a[136:139], v[200:203]
  buffer_load_dwordx4 v113, s[24:27], s41 offen offset:0 lds
  v_mfma_f32_16x16x32_bf16 v[208:211], a[192:195], a[144:147], 0
  ds_read_b64_tr_b16 a[212:213], v105 offset:40960
  v_mfma_f32_16x16x32_bf16 v[208:211], a[196:199], a[148:151], v[208:211]
  v_mfma_f32_16x16x32_bf16 v[216:219], a[196:199], a[156:159], 0
  ds_read_b64_tr_b16 a[214:215], v105 offset:41984
  v_mfma_f32_16x16x32_bf16 v[216:219], a[192:195], a[152:155], v[216:219]
  s_waitcnt lgkmcnt(4)
  buffer_load_dwordx4 v114, s[24:27], s41 offen offset:1024 lds
  v_mfma_f32_16x16x32_bf16 v[220:223], a[200:203], a[152:155], 0
  ds_read_b64_tr_b16 a[216:217], v105 offset:32776
  v_mfma_f32_16x16x32_bf16 v[220:223], a[204:207], a[156:159], v[220:223]
  v_mfma_f32_16x16x32_bf16 v[212:215], a[204:207], a[148:151], 0
  ds_read_b64_tr_b16 a[218:219], v105 offset:33800
  v_mfma_f32_16x16x32_bf16 v[212:215], a[200:203], a[144:147], v[212:215]
  s_add_u32 m0, s18, 116736
  v_mfma_f32_16x16x32_bf16 v[204:207], a[200:203], a[136:139], 0
  ds_read_b64_tr_b16 a[220:221], v105 offset:40968
  v_mfma_f32_16x16x32_bf16 v[204:207], a[204:207], a[140:143], v[204:207]
  buffer_load_dwordx4 v113, s[28:31], s41 offen offset:0 lds
  v_mfma_f32_16x16x32_bf16 v[196:199], a[204:207], a[132:135], 0
  ds_read_b64_tr_b16 a[222:223], v105 offset:41992
  v_mfma_f32_16x16x32_bf16 v[196:199], a[200:203], a[128:131], v[196:199]
  s_waitcnt lgkmcnt(4)
  v_mfma_f32_16x16x32_bf16 v[160:163], a[208:211], a[128:131], 0
  ds_read_b64_tr_b16 a[192:193], v104 offset:32768
  v_mfma_f32_16x16x32_bf16 v[160:163], a[212:215], a[132:135], v[160:163]
  buffer_load_dwordx4 v114, s[28:31], s41 offen offset:1024 lds
  v_mfma_f32_16x16x32_bf16 v[168:171], a[212:215], a[140:143], 0
  ds_read_b64_tr_b16 a[194:195], v104 offset:33792
  v_mfma_f32_16x16x32_bf16 v[168:171], a[208:211], a[136:139], v[168:171]
  v_mfma_f32_16x16x32_bf16 v[176:179], a[208:211], a[144:147], 0
  ds_read_b64_tr_b16 a[196:197], v104 offset:40960
  v_mfma_f32_16x16x32_bf16 v[176:179], a[212:215], a[148:151], v[176:179]
  v_mfma_f32_16x16x32_bf16 v[184:187], a[212:215], a[156:159], 0
  ds_read_b64_tr_b16 a[198:199], v104 offset:41984
  v_mfma_f32_16x16x32_bf16 v[184:187], a[208:211], a[152:155], v[184:187]
  s_waitcnt lgkmcnt(4)
  v_mfma_f32_16x16x32_bf16 v[188:191], a[216:219], a[152:155], 0
  ds_read_b64_tr_b16 a[200:201], v104 offset:32776
  v_mfma_f32_16x16x32_bf16 v[188:191], a[220:223], a[156:159], v[188:191]
  v_mfma_f32_16x16x32_bf16 v[180:183], a[220:223], a[148:151], 0
  ds_read_b64_tr_b16 a[202:203], v104 offset:33800
  v_mfma_f32_16x16x32_bf16 v[180:183], a[216:219], a[144:147], v[180:183]
  v_mfma_f32_16x16x32_bf16 v[172:175], a[216:219], a[136:139], 0
  ds_read_b64_tr_b16 a[204:205], v104 offset:40968
  v_mfma_f32_16x16x32_bf16 v[172:175], a[220:223], a[140:143], v[172:175]
  v_mfma_f32_16x16x32_bf16 v[164:167], a[220:223], a[132:135], 0
  ds_read_b64_tr_b16 a[206:207], v104 offset:41992
  v_mfma_f32_16x16x32_bf16 v[164:167], a[216:219], a[128:131], v[164:167]
  s_waitcnt lgkmcnt(4)
  s_barrier
  v_mfma_f32_16x16x32_bf16 v[128:131], a[192:195], a[128:131], 0
  ds_read_b64_tr_b16 a[208:209], v108 offset:0
  v_mfma_f32_16x16x32_bf16 v[128:131], a[196:199], a[132:135], v[128:131]
  v_mfma_f32_16x16x32_bf16 v[136:139], a[196:199], a[140:143], 0
  ds_read_b64_tr_b16 a[210:211], v108 offset:512
  v_mfma_f32_16x16x32_bf16 v[136:139], a[192:195], a[136:139], v[136:139]
  v_mfma_f32_16x16x32_bf16 v[144:147], a[192:195], a[144:147], 0
  ds_read_b64_tr_b16 a[212:213], v108 offset:8192
  v_mfma_f32_16x16x32_bf16 v[144:147], a[196:199], a[148:151], v[144:147]
  v_mfma_f32_16x16x32_bf16 v[152:155], a[196:199], a[156:159], 0
  ds_read_b64_tr_b16 a[214:215], v108 offset:8704
  v_mfma_f32_16x16x32_bf16 v[152:155], a[192:195], a[152:155], v[152:155]
  s_waitcnt lgkmcnt(4)
  v_mfma_f32_16x16x32_bf16 v[156:159], a[200:203], a[152:155], 0
  ds_read_b64_tr_b16 a[216:217], v108 offset:2048
  v_mfma_f32_16x16x32_bf16 v[156:159], a[204:207], a[156:159], v[156:159]
  v_mfma_f32_16x16x32_bf16 v[148:151], a[204:207], a[148:151], 0
  ds_read_b64_tr_b16 a[218:219], v108 offset:2560
  v_mfma_f32_16x16x32_bf16 v[148:151], a[200:203], a[144:147], v[148:151]
  v_mfma_f32_16x16x32_bf16 v[140:143], a[200:203], a[136:139], 0
  ds_read_b64_tr_b16 a[220:221], v108 offset:10240
  v_mfma_f32_16x16x32_bf16 v[140:143], a[204:207], a[140:143], v[140:143]
  s_waitcnt vmcnt(8)
  v_mfma_f32_16x16x32_bf16 v[132:135], a[204:207], a[132:135], 0
  ds_read_b64_tr_b16 a[222:223], v108 offset:10752
  v_mfma_f32_16x16x32_bf16 v[132:135], a[200:203], a[128:131], v[132:135]
  s_waitcnt lgkmcnt(4)
  v_mfma_f32_16x16x32_bf16 v[8:11], a[208:211], a[160:163], v[8:11]
  ds_read_b64_tr_b16 a[192:193], v109 offset:0
  v_mfma_f32_16x16x32_bf16 v[8:11], a[212:215], a[164:167], v[8:11]
  v_mfma_f32_16x16x32_bf16 v[16:19], a[212:215], a[172:175], v[16:19]
  ds_read_b64_tr_b16 a[194:195], v109 offset:512
  v_mfma_f32_16x16x32_bf16 v[16:19], a[208:211], a[168:171], v[16:19]
  v_mfma_f32_16x16x32_bf16 v[24:27], a[208:211], a[176:179], v[24:27]
  ds_read_b64_tr_b16 a[196:197], v109 offset:8192
  v_mfma_f32_16x16x32_bf16 v[24:27], a[212:215], a[180:183], v[24:27]
  s_add_u32 s42, s42, s87
  v_mfma_f32_16x16x32_bf16 v[32:35], a[212:215], a[188:191], v[32:35]
  ds_read_b64_tr_b16 a[198:199], v109 offset:8704
  v_mfma_f32_16x16x32_bf16 v[32:35], a[208:211], a[184:187], v[32:35]
  s_waitcnt lgkmcnt(4)
  buffer_load_dwordx4 a[128:131], v100, s[32:35], s42 offen offset:0 sc1
  v_mfma_f32_16x16x32_bf16 a[88:91], a[216:219], a[184:187], a[88:91]
  ds_read_b64_tr_b16 a[200:201], v109 offset:2048
  v_mfma_f32_16x16x32_bf16 a[88:91], a[220:223], a[188:191], a[88:91]
  v_mfma_f32_16x16x32_bf16 a[80:83], a[220:223], a[180:183], a[80:83]
  ds_read_b64_tr_b16 a[202:203], v109 offset:2560
  v_mfma_f32_16x16x32_bf16 a[80:83], a[216:219], a[176:179], a[80:83]
  buffer_load_dwordx4 a[132:135], v100, s[32:35], s42 offen offset:256 sc1
  v_mfma_f32_16x16x32_bf16 a[72:75], a[216:219], a[168:171], a[72:75]
  ds_read_b64_tr_b16 a[204:205], v109 offset:10240
  v_mfma_f32_16x16x32_bf16 a[72:75], a[220:223], a[172:175], a[72:75]
  v_mfma_f32_16x16x32_bf16 a[64:67], a[220:223], a[164:167], a[64:67]
  ds_read_b64_tr_b16 a[206:207], v109 offset:10752
  v_mfma_f32_16x16x32_bf16 a[64:67], a[216:219], a[160:163], a[64:67]
  s_waitcnt lgkmcnt(4)
  v_mfma_f32_16x16x32_bf16 v[12:15], a[192:195], a[160:163], v[12:15]
  ds_read_b64_tr_b16 a[208:209], v110 offset:0
  v_mfma_f32_16x16x32_bf16 v[12:15], a[196:199], a[164:167], v[12:15]
  buffer_load_dwordx4 a[136:139], v101, s[32:35], s42 offen offset:0 sc1
  v_mfma_f32_16x16x32_bf16 v[20:23], a[196:199], a[172:175], v[20:23]
  ds_read_b64_tr_b16 a[210:211], v110 offset:512
  v_mfma_f32_16x16x32_bf16 v[20:23], a[192:195], a[168:171], v[20:23]
  v_mfma_f32_16x16x32_bf16 v[28:31], a[192:195], a[176:179], v[28:31]
  ds_read_b64_tr_b16 a[212:213], v110 offset:8192
  v_mfma_f32_16x16x32_bf16 v[28:31], a[196:199], a[180:183], v[28:31]
  buffer_load_dwordx4 a[140:143], v101, s[32:35], s42 offen offset:256 sc1
  v_mfma_f32_16x16x32_bf16 v[36:39], a[196:199], a[188:191], v[36:39]
  ds_read_b64_tr_b16 a[214:215], v110 offset:8704
  v_mfma_f32_16x16x32_bf16 v[36:39], a[192:195], a[184:187], v[36:39]
  s_waitcnt lgkmcnt(4)
  v_mfma_f32_16x16x32_bf16 a[92:95], a[200:203], a[184:187], a[92:95]
  ds_read_b64_tr_b16 a[216:217], v110 offset:2048
  v_mfma_f32_16x16x32_bf16 a[92:95], a[204:207], a[188:191], a[92:95]
  v_mfma_f32_16x16x32_bf16 a[84:87], a[204:207], a[180:183], a[84:87]
  ds_read_b64_tr_b16 a[218:219], v110 offset:2560
  v_mfma_f32_16x16x32_bf16 a[84:87], a[200:203], a[176:179], a[84:87]
  buffer_load_dwordx4 a[144:147], v102, s[32:35], s42 offen offset:0 sc1
  v_mfma_f32_16x16x32_bf16 a[76:79], a[200:203], a[168:171], a[76:79]
  ds_read_b64_tr_b16 a[220:221], v110 offset:10240
  v_mfma_f32_16x16x32_bf16 a[76:79], a[204:207], a[172:175], a[76:79]
  v_mfma_f32_16x16x32_bf16 a[68:71], a[204:207], a[164:167], a[68:71]
  ds_read_b64_tr_b16 a[222:223], v110 offset:10752
  v_mfma_f32_16x16x32_bf16 a[68:71], a[200:203], a[160:163], a[68:71]
  s_waitcnt lgkmcnt(4)
  buffer_load_dwordx4 a[148:151], v102, s[32:35], s42 offen offset:256 sc1
  v_mfma_f32_16x16x32_bf16 v[40:43], a[208:211], a[160:163], v[40:43]
  ds_read_b64_tr_b16 a[192:193], v107 offset:49152
  v_mfma_f32_16x16x32_bf16 v[40:43], a[212:215], a[164:167], v[40:43]
  v_mfma_f32_16x16x32_bf16 v[48:51], a[212:215], a[172:175], v[48:51]
  ds_read_b64_tr_b16 a[194:195], v107 offset:50176
  v_mfma_f32_16x16x32_bf16 v[48:51], a[208:211], a[168:171], v[48:51]
  v_mfma_f32_16x16x32_bf16 v[56:59], a[208:211], a[176:179], v[56:59]
  ds_read_b64_tr_b16 a[196:197], v107 offset:57344
  v_mfma_f32_16x16x32_bf16 v[56:59], a[212:215], a[180:183], v[56:59]
  buffer_load_dwordx4 a[152:155], v103, s[32:35], s42 offen offset:0 sc1
  v_mfma_f32_16x16x32_bf16 v[64:67], a[212:215], a[188:191], v[64:67]
  ds_read_b64_tr_b16 a[198:199], v107 offset:58368
  v_mfma_f32_16x16x32_bf16 v[64:67], a[208:211], a[184:187], v[64:67]
  s_waitcnt lgkmcnt(4)
  v_mfma_f32_16x16x32_bf16 a[120:123], a[216:219], a[184:187], a[120:123]
  ds_read_b64_tr_b16 a[200:201], v107 offset:49160
  v_mfma_f32_16x16x32_bf16 a[120:123], a[220:223], a[188:191], a[120:123]
  buffer_load_dwordx4 a[156:159], v103, s[32:35], s42 offen offset:256 sc1
  v_mfma_f32_16x16x32_bf16 a[112:115], a[220:223], a[180:183], a[112:115]
  ds_read_b64_tr_b16 a[202:203], v107 offset:50184
  v_mfma_f32_16x16x32_bf16 a[112:115], a[216:219], a[176:179], a[112:115]
  v_mfma_f32_16x16x32_bf16 a[104:107], a[216:219], a[168:171], a[104:107]
  s_add_u32 m0, s18, 16384
  ds_read_b64_tr_b16 a[204:205], v107 offset:57352
  v_mfma_f32_16x16x32_bf16 a[104:107], a[220:223], a[172:175], a[104:107]
  s_add_u32 s40, s40, 429056
  v_mfma_f32_16x16x32_bf16 a[96:99], a[220:223], a[164:167], a[96:99]
  ds_read_b64_tr_b16 a[206:207], v107 offset:58376
  v_mfma_f32_16x16x32_bf16 a[96:99], a[216:219], a[160:163], a[96:99]
  s_waitcnt lgkmcnt(4)
  buffer_load_dwordx4 v112, s[20:23], s40 offen offset:0 lds
  v_mfma_f32_16x16x32_bf16 v[224:227], a[192:195], a[160:163], v[224:227]
  ds_read_b64_tr_b16 a[208:209], v106 offset:49152
  v_mfma_f32_16x16x32_bf16 v[224:227], a[196:199], a[164:167], v[224:227]
  s_add_u32 s40, s40, 31744
  v_mfma_f32_16x16x32_bf16 v[232:235], a[196:199], a[172:175], v[232:235]
  ds_read_b64_tr_b16 a[210:211], v106 offset:50176
  v_mfma_f32_16x16x32_bf16 v[232:235], a[192:195], a[168:171], v[232:235]
  buffer_load_dwordx4 v112, s[20:23], s40 offen offset:1024 lds
  v_mfma_f32_16x16x32_bf16 v[240:243], a[192:195], a[176:179], v[240:243]
  ds_read_b64_tr_b16 a[212:213], v106 offset:57344
  v_mfma_f32_16x16x32_bf16 v[240:243], a[196:199], a[180:183], v[240:243]
  v_mfma_f32_16x16x32_bf16 v[248:251], a[196:199], a[188:191], v[248:251]
  ds_read_b64_tr_b16 a[214:215], v106 offset:58368
  v_mfma_f32_16x16x32_bf16 v[248:251], a[192:195], a[184:187], v[248:251]
  s_waitcnt lgkmcnt(4)
  s_add_u32 s40, s40, 31744
  v_mfma_f32_16x16x32_bf16 v[252:255], a[200:203], a[184:187], v[252:255]
  ds_read_b64_tr_b16 a[216:217], v106 offset:49160
  v_mfma_f32_16x16x32_bf16 v[252:255], a[204:207], a[188:191], v[252:255]
  buffer_load_dwordx4 v112, s[20:23], s40 offen offset:2048 lds
  v_mfma_f32_16x16x32_bf16 v[244:247], a[204:207], a[180:183], v[244:247]
  ds_read_b64_tr_b16 a[218:219], v106 offset:50184
  v_mfma_f32_16x16x32_bf16 v[244:247], a[200:203], a[176:179], v[244:247]
  s_add_u32 s40, s40, 31744
  v_mfma_f32_16x16x32_bf16 v[236:239], a[200:203], a[168:171], v[236:239]
  ds_read_b64_tr_b16 a[220:221], v106 offset:57352
  v_mfma_f32_16x16x32_bf16 v[236:239], a[204:207], a[172:175], v[236:239]
  buffer_load_dwordx4 v112, s[20:23], s40 offen offset:3072 lds
  v_mfma_f32_16x16x32_bf16 v[228:231], a[204:207], a[164:167], v[228:231]
  ds_read_b64_tr_b16 a[222:223], v106 offset:58376
  v_mfma_f32_16x16x32_bf16 v[228:231], a[200:203], a[160:163], v[228:231]
  s_waitcnt lgkmcnt(4)
  v_mfma_f32_16x16x32_bf16 v[192:195], a[208:211], a[160:163], v[192:195]
  s_add_u32 m0, s18, 98304
  ds_read_b64_tr_b16 a[192:193], v105 offset:49152
  v_mfma_f32_16x16x32_bf16 v[192:195], a[212:215], a[164:167], v[192:195]
  s_add_u32 s41, s41, 221184
  v_mfma_f32_16x16x32_bf16 v[200:203], a[212:215], a[172:175], v[200:203]
  ds_read_b64_tr_b16 a[194:195], v105 offset:50176
  v_mfma_f32_16x16x32_bf16 v[200:203], a[208:211], a[168:171], v[200:203]
  buffer_load_dwordx4 v113, s[24:27], s41 offen offset:0 lds
  v_mfma_f32_16x16x32_bf16 v[208:211], a[208:211], a[176:179], v[208:211]
  ds_read_b64_tr_b16 a[196:197], v105 offset:57344
  v_mfma_f32_16x16x32_bf16 v[208:211], a[212:215], a[180:183], v[208:211]
  v_mfma_f32_16x16x32_bf16 v[216:219], a[212:215], a[188:191], v[216:219]
  ds_read_b64_tr_b16 a[198:199], v105 offset:58368
  v_mfma_f32_16x16x32_bf16 v[216:219], a[208:211], a[184:187], v[216:219]
  s_waitcnt lgkmcnt(4)
  buffer_load_dwordx4 v114, s[24:27], s41 offen offset:1024 lds
  v_mfma_f32_16x16x32_bf16 v[220:223], a[216:219], a[184:187], v[220:223]
  ds_read_b64_tr_b16 a[200:201], v105 offset:49160
  v_mfma_f32_16x16x32_bf16 v[220:223], a[220:223], a[188:191], v[220:223]
  v_mfma_f32_16x16x32_bf16 v[212:215], a[220:223], a[180:183], v[212:215]
  ds_read_b64_tr_b16 a[202:203], v105 offset:50184
  v_mfma_f32_16x16x32_bf16 v[212:215], a[216:219], a[176:179], v[212:215]
  s_add_u32 m0, s18, 100352
  v_mfma_f32_16x16x32_bf16 v[204:207], a[216:219], a[168:171], v[204:207]
  ds_read_b64_tr_b16 a[204:205], v105 offset:57352
  v_mfma_f32_16x16x32_bf16 v[204:207], a[220:223], a[172:175], v[204:207]
  buffer_load_dwordx4 v113, s[28:31], s41 offen offset:0 lds
  v_mfma_f32_16x16x32_bf16 v[196:199], a[220:223], a[164:167], v[196:199]
  ds_read_b64_tr_b16 a[206:207], v105 offset:58376
  v_mfma_f32_16x16x32_bf16 v[196:199], a[216:219], a[160:163], v[196:199]
  s_waitcnt lgkmcnt(4)
  v_mfma_f32_16x16x32_bf16 v[160:163], a[192:195], a[160:163], v[160:163]
  ds_read_b64_tr_b16 a[208:209], v104 offset:49152
  v_mfma_f32_16x16x32_bf16 v[160:163], a[196:199], a[164:167], v[160:163]
  buffer_load_dwordx4 v114, s[28:31], s41 offen offset:1024 lds
  v_mfma_f32_16x16x32_bf16 v[168:171], a[196:199], a[172:175], v[168:171]
  ds_read_b64_tr_b16 a[210:211], v104 offset:50176
  v_mfma_f32_16x16x32_bf16 v[168:171], a[192:195], a[168:171], v[168:171]
  v_mfma_f32_16x16x32_bf16 v[176:179], a[192:195], a[176:179], v[176:179]
  ds_read_b64_tr_b16 a[212:213], v104 offset:57344
  v_mfma_f32_16x16x32_bf16 v[176:179], a[196:199], a[180:183], v[176:179]
  v_mfma_f32_16x16x32_bf16 v[184:187], a[196:199], a[188:191], v[184:187]
  ds_read_b64_tr_b16 a[214:215], v104 offset:58368
  v_mfma_f32_16x16x32_bf16 v[184:187], a[192:195], a[184:187], v[184:187]
  s_waitcnt lgkmcnt(4)
  v_mfma_f32_16x16x32_bf16 v[188:191], a[200:203], a[184:187], v[188:191]
  ds_read_b64_tr_b16 a[216:217], v104 offset:49160
  v_mfma_f32_16x16x32_bf16 v[188:191], a[204:207], a[188:191], v[188:191]
  v_mfma_f32_16x16x32_bf16 v[180:183], a[204:207], a[180:183], v[180:183]
  ds_read_b64_tr_b16 a[218:219], v104 offset:50184
  v_mfma_f32_16x16x32_bf16 v[180:183], a[200:203], a[176:179], v[180:183]
  v_mfma_f32_16x16x32_bf16 v[172:175], a[200:203], a[168:171], v[172:175]
  ds_read_b64_tr_b16 a[220:221], v104 offset:57352
  v_mfma_f32_16x16x32_bf16 v[172:175], a[204:207], a[172:175], v[172:175]
  v_mfma_f32_16x16x32_bf16 v[164:167], a[204:207], a[164:167], v[164:167]
  ds_read_b64_tr_b16 a[222:223], v104 offset:58376
  v_mfma_f32_16x16x32_bf16 v[164:167], a[200:203], a[160:163], v[164:167]
  s_waitcnt lgkmcnt(4)
  s_waitcnt vmcnt(16)
  s_barrier
  v_mfma_f32_16x16x32_bf16 v[128:131], a[208:211], a[160:163], v[128:131]
  ds_read_b64_tr_b16 a[192:193], v108 offset:49152
  v_mfma_f32_16x16x32_bf16 v[128:131], a[212:215], a[164:167], v[128:131]
  v_mfma_f32_16x16x32_bf16 v[136:139], a[212:215], a[172:175], v[136:139]
  ds_read_b64_tr_b16 a[194:195], v108 offset:49664
  v_mfma_f32_16x16x32_bf16 v[136:139], a[208:211], a[168:171], v[136:139]
  v_mfma_f32_16x16x32_bf16 v[144:147], a[208:211], a[176:179], v[144:147]
  ds_read_b64_tr_b16 a[196:197], v108 offset:57344
  v_mfma_f32_16x16x32_bf16 v[144:147], a[212:215], a[180:183], v[144:147]
  v_mfma_f32_16x16x32_bf16 v[152:155], a[212:215], a[188:191], v[152:155]
  ds_read_b64_tr_b16 a[198:199], v108 offset:57856
  v_mfma_f32_16x16x32_bf16 v[152:155], a[208:211], a[184:187], v[152:155]
  s_waitcnt lgkmcnt(4)
  v_mfma_f32_16x16x32_bf16 v[156:159], a[216:219], a[184:187], v[156:159]
  ds_read_b64_tr_b16 a[200:201], v108 offset:51200
  v_mfma_f32_16x16x32_bf16 v[156:159], a[220:223], a[188:191], v[156:159]
  v_mfma_f32_16x16x32_bf16 v[148:151], a[220:223], a[180:183], v[148:151]
  ds_read_b64_tr_b16 a[202:203], v108 offset:51712
  v_mfma_f32_16x16x32_bf16 v[148:151], a[216:219], a[176:179], v[148:151]
  v_mfma_f32_16x16x32_bf16 v[140:143], a[216:219], a[168:171], v[140:143]
  ds_read_b64_tr_b16 a[204:205], v108 offset:59392
  v_mfma_f32_16x16x32_bf16 v[140:143], a[220:223], a[172:175], v[140:143]
  s_waitcnt vmcnt(8)
  v_mfma_f32_16x16x32_bf16 v[132:135], a[220:223], a[164:167], v[132:135]
  ds_read_b64_tr_b16 a[206:207], v108 offset:59904
  v_mfma_f32_16x16x32_bf16 v[132:135], a[216:219], a[160:163], v[132:135]
  s_waitcnt lgkmcnt(4)
  v_mfma_f32_16x16x32_bf16 v[8:11], a[192:195], a[128:131], v[8:11]
  ds_read_b64_tr_b16 a[208:209], v109 offset:49152
  v_mfma_f32_16x16x32_bf16 v[8:11], a[196:199], a[132:135], v[8:11]
  v_mfma_f32_16x16x32_bf16 v[16:19], a[196:199], a[140:143], v[16:19]
  ds_read_b64_tr_b16 a[210:211], v109 offset:49664
  v_mfma_f32_16x16x32_bf16 v[16:19], a[192:195], a[136:139], v[16:19]
  v_mfma_f32_16x16x32_bf16 v[24:27], a[192:195], a[144:147], v[24:27]
  ds_read_b64_tr_b16 a[212:213], v109 offset:57344
  v_mfma_f32_16x16x32_bf16 v[24:27], a[196:199], a[148:151], v[24:27]
  s_add_u32 s42, s42, 512
  v_mfma_f32_16x16x32_bf16 v[32:35], a[196:199], a[156:159], v[32:35]
  ds_read_b64_tr_b16 a[214:215], v109 offset:57856
  v_mfma_f32_16x16x32_bf16 v[32:35], a[192:195], a[152:155], v[32:35]
  s_waitcnt lgkmcnt(4)
  buffer_load_dwordx4 a[160:163], v100, s[32:35], s42 offen offset:0 sc1
  v_mfma_f32_16x16x32_bf16 a[88:91], a[200:203], a[152:155], a[88:91]
  ds_read_b64_tr_b16 a[216:217], v109 offset:51200
  v_mfma_f32_16x16x32_bf16 a[88:91], a[204:207], a[156:159], a[88:91]
  v_mfma_f32_16x16x32_bf16 a[80:83], a[204:207], a[148:151], a[80:83]
  ds_read_b64_tr_b16 a[218:219], v109 offset:51712
  v_mfma_f32_16x16x32_bf16 a[80:83], a[200:203], a[144:147], a[80:83]
  buffer_load_dwordx4 a[164:167], v100, s[32:35], s42 offen offset:256 sc1
  v_mfma_f32_16x16x32_bf16 a[72:75], a[200:203], a[136:139], a[72:75]
  ds_read_b64_tr_b16 a[220:221], v109 offset:59392
  v_mfma_f32_16x16x32_bf16 a[72:75], a[204:207], a[140:143], a[72:75]
  v_mfma_f32_16x16x32_bf16 a[64:67], a[204:207], a[132:135], a[64:67]
  ds_read_b64_tr_b16 a[222:223], v109 offset:59904
  v_mfma_f32_16x16x32_bf16 a[64:67], a[200:203], a[128:131], a[64:67]
  s_waitcnt lgkmcnt(4)
  v_mfma_f32_16x16x32_bf16 v[12:15], a[208:211], a[128:131], v[12:15]
  ds_read_b64_tr_b16 a[192:193], v110 offset:49152
  v_mfma_f32_16x16x32_bf16 v[12:15], a[212:215], a[132:135], v[12:15]
  buffer_load_dwordx4 a[168:171], v101, s[32:35], s42 offen offset:0 sc1
  v_mfma_f32_16x16x32_bf16 v[20:23], a[212:215], a[140:143], v[20:23]
  ds_read_b64_tr_b16 a[194:195], v110 offset:49664
  v_mfma_f32_16x16x32_bf16 v[20:23], a[208:211], a[136:139], v[20:23]
  v_mfma_f32_16x16x32_bf16 v[28:31], a[208:211], a[144:147], v[28:31]
  ds_read_b64_tr_b16 a[196:197], v110 offset:57344
  v_mfma_f32_16x16x32_bf16 v[28:31], a[212:215], a[148:151], v[28:31]
  buffer_load_dwordx4 a[172:175], v101, s[32:35], s42 offen offset:256 sc1
  v_mfma_f32_16x16x32_bf16 v[36:39], a[212:215], a[156:159], v[36:39]
  ds_read_b64_tr_b16 a[198:199], v110 offset:57856
  v_mfma_f32_16x16x32_bf16 v[36:39], a[208:211], a[152:155], v[36:39]
  s_waitcnt lgkmcnt(4)
  v_mfma_f32_16x16x32_bf16 a[92:95], a[216:219], a[152:155], a[92:95]
  ds_read_b64_tr_b16 a[200:201], v110 offset:51200
  v_mfma_f32_16x16x32_bf16 a[92:95], a[220:223], a[156:159], a[92:95]
  v_mfma_f32_16x16x32_bf16 a[84:87], a[220:223], a[148:151], a[84:87]
  ds_read_b64_tr_b16 a[202:203], v110 offset:51712
  v_mfma_f32_16x16x32_bf16 a[84:87], a[216:219], a[144:147], a[84:87]
  buffer_load_dwordx4 a[176:179], v102, s[32:35], s42 offen offset:0 sc1
  v_mfma_f32_16x16x32_bf16 a[76:79], a[216:219], a[136:139], a[76:79]
  ds_read_b64_tr_b16 a[204:205], v110 offset:59392
  v_mfma_f32_16x16x32_bf16 a[76:79], a[220:223], a[140:143], a[76:79]
  v_mfma_f32_16x16x32_bf16 a[68:71], a[220:223], a[132:135], a[68:71]
  ds_read_b64_tr_b16 a[206:207], v110 offset:59904
  v_mfma_f32_16x16x32_bf16 a[68:71], a[216:219], a[128:131], a[68:71]
  s_waitcnt lgkmcnt(4)
  buffer_load_dwordx4 a[180:183], v102, s[32:35], s42 offen offset:256 sc1
  v_mfma_f32_16x16x32_bf16 v[40:43], a[192:195], a[128:131], v[40:43]
  ds_read_b64_tr_b16 a[208:209], v107 offset:0
  v_mfma_f32_16x16x32_bf16 v[40:43], a[196:199], a[132:135], v[40:43]
  v_mfma_f32_16x16x32_bf16 v[48:51], a[196:199], a[140:143], v[48:51]
  ds_read_b64_tr_b16 a[210:211], v107 offset:1024
  v_mfma_f32_16x16x32_bf16 v[48:51], a[192:195], a[136:139], v[48:51]
  v_mfma_f32_16x16x32_bf16 v[56:59], a[192:195], a[144:147], v[56:59]
  ds_read_b64_tr_b16 a[212:213], v107 offset:8192
  v_mfma_f32_16x16x32_bf16 v[56:59], a[196:199], a[148:151], v[56:59]
  buffer_load_dwordx4 a[184:187], v103, s[32:35], s42 offen offset:0 sc1
  v_mfma_f32_16x16x32_bf16 v[64:67], a[196:199], a[156:159], v[64:67]
  ds_read_b64_tr_b16 a[214:215], v107 offset:9216
  v_mfma_f32_16x16x32_bf16 v[64:67], a[192:195], a[152:155], v[64:67]
  s_waitcnt lgkmcnt(4)
  v_mfma_f32_16x16x32_bf16 a[120:123], a[200:203], a[152:155], a[120:123]
  ds_read_b64_tr_b16 a[216:217], v107 offset:8
  v_mfma_f32_16x16x32_bf16 a[120:123], a[204:207], a[156:159], a[120:123]
  buffer_load_dwordx4 a[188:191], v103, s[32:35], s42 offen offset:256 sc1
  v_mfma_f32_16x16x32_bf16 a[112:115], a[204:207], a[148:151], a[112:115]
  ds_read_b64_tr_b16 a[218:219], v107 offset:1032
  v_mfma_f32_16x16x32_bf16 a[112:115], a[200:203], a[144:147], a[112:115]
  v_mfma_f32_16x16x32_bf16 a[104:107], a[200:203], a[136:139], a[104:107]
  s_add_u32 m0, s18, 32768
  ds_read_b64_tr_b16 a[220:221], v107 offset:8200
  v_mfma_f32_16x16x32_bf16 a[104:107], a[204:207], a[140:143], a[104:107]
  s_add_u32 s40, s40, 429056
  v_mfma_f32_16x16x32_bf16 a[96:99], a[204:207], a[132:135], a[96:99]
  ds_read_b64_tr_b16 a[222:223], v107 offset:9224
  v_mfma_f32_16x16x32_bf16 a[96:99], a[200:203], a[128:131], a[96:99]
  s_waitcnt lgkmcnt(4)
  buffer_load_dwordx4 v112, s[20:23], s40 offen offset:0 lds
  v_mfma_f32_16x16x32_bf16 v[224:227], a[208:211], a[128:131], v[224:227]
  ds_read_b64_tr_b16 a[192:193], v106 offset:0
  v_mfma_f32_16x16x32_bf16 v[224:227], a[212:215], a[132:135], v[224:227]
  s_add_u32 s40, s40, 31744
  v_mfma_f32_16x16x32_bf16 v[232:235], a[212:215], a[140:143], v[232:235]
  ds_read_b64_tr_b16 a[194:195], v106 offset:1024
  v_mfma_f32_16x16x32_bf16 v[232:235], a[208:211], a[136:139], v[232:235]
  buffer_load_dwordx4 v112, s[20:23], s40 offen offset:1024 lds
  v_mfma_f32_16x16x32_bf16 v[240:243], a[208:211], a[144:147], v[240:243]
  ds_read_b64_tr_b16 a[196:197], v106 offset:8192
  v_mfma_f32_16x16x32_bf16 v[240:243], a[212:215], a[148:151], v[240:243]
  v_mfma_f32_16x16x32_bf16 v[248:251], a[212:215], a[156:159], v[248:251]
  ds_read_b64_tr_b16 a[198:199], v106 offset:9216
  v_mfma_f32_16x16x32_bf16 v[248:251], a[208:211], a[152:155], v[248:251]
  s_waitcnt lgkmcnt(4)
  s_add_u32 s40, s40, 31744
  v_mfma_f32_16x16x32_bf16 v[252:255], a[216:219], a[152:155], v[252:255]
  ds_read_b64_tr_b16 a[200:201], v106 offset:8
  v_mfma_f32_16x16x32_bf16 v[252:255], a[220:223], a[156:159], v[252:255]
  buffer_load_dwordx4 v112, s[20:23], s40 offen offset:2048 lds
  v_mfma_f32_16x16x32_bf16 v[244:247], a[220:223], a[148:151], v[244:247]
  ds_read_b64_tr_b16 a[202:203], v106 offset:1032
  v_mfma_f32_16x16x32_bf16 v[244:247], a[216:219], a[144:147], v[244:247]
  s_add_u32 s40, s40, 31744
  v_mfma_f32_16x16x32_bf16 v[236:239], a[216:219], a[136:139], v[236:239]
  ds_read_b64_tr_b16 a[204:205], v106 offset:8200
  v_mfma_f32_16x16x32_bf16 v[236:239], a[220:223], a[140:143], v[236:239]
  buffer_load_dwordx4 v112, s[20:23], s40 offen offset:3072 lds
  v_mfma_f32_16x16x32_bf16 v[228:231], a[220:223], a[132:135], v[228:231]
  ds_read_b64_tr_b16 a[206:207], v106 offset:9224
  v_mfma_f32_16x16x32_bf16 v[228:231], a[216:219], a[128:131], v[228:231]
  s_waitcnt lgkmcnt(4)
  v_mfma_f32_16x16x32_bf16 v[192:195], a[192:195], a[128:131], v[192:195]
  s_add_u32 m0, s18, 81920
  ds_read_b64_tr_b16 a[208:209], v105 offset:0
  v_mfma_f32_16x16x32_bf16 v[192:195], a[196:199], a[132:135], v[192:195]
  s_add_u32 s41, s41, 221184
  v_mfma_f32_16x16x32_bf16 v[200:203], a[196:199], a[140:143], v[200:203]
  ds_read_b64_tr_b16 a[210:211], v105 offset:1024
  v_mfma_f32_16x16x32_bf16 v[200:203], a[192:195], a[136:139], v[200:203]
  buffer_load_dwordx4 v113, s[24:27], s41 offen offset:0 lds
  v_mfma_f32_16x16x32_bf16 v[208:211], a[192:195], a[144:147], v[208:211]
  ds_read_b64_tr_b16 a[212:213], v105 offset:8192
  v_mfma_f32_16x16x32_bf16 v[208:211], a[196:199], a[148:151], v[208:211]
  v_mfma_f32_16x16x32_bf16 v[216:219], a[196:199], a[156:159], v[216:219]
  ds_read_b64_tr_b16 a[214:215], v105 offset:9216
  v_mfma_f32_16x16x32_bf16 v[216:219], a[192:195], a[152:155], v[216:219]
  s_waitcnt lgkmcnt(4)
  buffer_load_dwordx4 v114, s[24:27], s41 offen offset:1024 lds
  v_mfma_f32_16x16x32_bf16 v[220:223], a[200:203], a[152:155], v[220:223]
  ds_read_b64_tr_b16 a[216:217], v105 offset:8
  v_mfma_f32_16x16x32_bf16 v[220:223], a[204:207], a[156:159], v[220:223]
  v_mfma_f32_16x16x32_bf16 v[212:215], a[204:207], a[148:151], v[212:215]
  ds_read_b64_tr_b16 a[218:219], v105 offset:1032
  v_mfma_f32_16x16x32_bf16 v[212:215], a[200:203], a[144:147], v[212:215]
  s_add_u32 m0, s18, 83968
  v_mfma_f32_16x16x32_bf16 v[204:207], a[200:203], a[136:139], v[204:207]
  ds_read_b64_tr_b16 a[220:221], v105 offset:8200
  v_mfma_f32_16x16x32_bf16 v[204:207], a[204:207], a[140:143], v[204:207]
  buffer_load_dwordx4 v113, s[28:31], s41 offen offset:0 lds
  v_mfma_f32_16x16x32_bf16 v[196:199], a[204:207], a[132:135], v[196:199]
  ds_read_b64_tr_b16 a[222:223], v105 offset:9224
  v_mfma_f32_16x16x32_bf16 v[196:199], a[200:203], a[128:131], v[196:199]
  s_waitcnt lgkmcnt(4)
  v_mfma_f32_16x16x32_bf16 v[160:163], a[208:211], a[128:131], v[160:163]
L_pad_proj12_2:
  s_cbranch_execz L_pad_proj12_3
  ds_read_b64_tr_b16 a[192:193], v104 offset:0
  v_mfma_f32_16x16x32_bf16 v[160:163], a[212:215], a[132:135], v[160:163]
  buffer_load_dwordx4 v114, s[28:31], s41 offen offset:1024 lds
  v_mfma_f32_16x16x32_bf16 v[168:171], a[212:215], a[140:143], v[168:171]
  ds_read_b64_tr_b16 a[194:195], v104 offset:1024
  v_mfma_f32_16x16x32_bf16 v[168:171], a[208:211], a[136:139], v[168:171]
  v_mfma_f32_16x16x32_bf16 v[176:179], a[208:211], a[144:147], v[176:179]
  ds_read_b64_tr_b16 a[196:197], v104 offset:8192
  v_mfma_f32_16x16x32_bf16 v[176:179], a[212:215], a[148:151], v[176:179]
  v_mfma_f32_16x16x32_bf16 v[184:187], a[212:215], a[156:159], v[184:187]
  ds_read_b64_tr_b16 a[198:199], v104 offset:9216
  v_mfma_f32_16x16x32_bf16 v[184:187], a[208:211], a[152:155], v[184:187]
  s_waitcnt lgkmcnt(4)
  v_mfma_f32_16x16x32_bf16 v[188:191], a[216:219], a[152:155], v[188:191]
  ds_read_b64_tr_b16 a[200:201], v104 offset:8
  v_mfma_f32_16x16x32_bf16 v[188:191], a[220:223], a[156:159], v[188:191]
  v_mfma_f32_16x16x32_bf16 v[180:183], a[220:223], a[148:151], v[180:183]
  ds_read_b64_tr_b16 a[202:203], v104 offset:1032
  v_mfma_f32_16x16x32_bf16 v[180:183], a[216:219], a[144:147], v[180:183]
  v_mfma_f32_16x16x32_bf16 v[172:175], a[216:219], a[136:139], v[172:175]
  ds_read_b64_tr_b16 a[204:205], v104 offset:8200
  v_mfma_f32_16x16x32_bf16 v[172:175], a[220:223], a[140:143], v[172:175]
  v_mfma_f32_16x16x32_bf16 v[164:167], a[220:223], a[132:135], v[164:167]
  ds_read_b64_tr_b16 a[206:207], v104 offset:9224
  v_mfma_f32_16x16x32_bf16 v[164:167], a[216:219], a[128:131], v[164:167]
  s_waitcnt lgkmcnt(4)
  s_waitcnt vmcnt(16)
  s_barrier
  v_mfma_f32_16x16x32_bf16 v[128:131], a[192:195], a[128:131], v[128:131]
  ds_read_b64_tr_b16 a[208:209], v108 offset:32768
  v_mfma_f32_16x16x32_bf16 v[128:131], a[196:199], a[132:135], v[128:131]
  v_mfma_f32_16x16x32_bf16 v[136:139], a[196:199], a[140:143], v[136:139]
  ds_read_b64_tr_b16 a[210:211], v108 offset:33280
  v_mfma_f32_16x16x32_bf16 v[136:139], a[192:195], a[136:139], v[136:139]
  v_mfma_f32_16x16x32_bf16 v[144:147], a[192:195], a[144:147], v[144:147]
  ds_read_b64_tr_b16 a[212:213], v108 offset:40960
  v_mfma_f32_16x16x32_bf16 v[144:147], a[196:199], a[148:151], v[144:147]
  v_mfma_f32_16x16x32_bf16 v[152:155], a[196:199], a[156:159], v[152:155]
  ds_read_b64_tr_b16 a[214:215], v108 offset:41472
  v_mfma_f32_16x16x32_bf16 v[152:155], a[192:195], a[152:155], v[152:155]
  s_waitcnt lgkmcnt(4)
  v_mfma_f32_16x16x32_bf16 v[156:159], a[200:203], a[152:155], v[156:159]
  ds_read_b64_tr_b16 a[216:217], v108 offset:34816
  v_mfma_f32_16x16x32_bf16 v[156:159], a[204:207], a[156:159], v[156:159]
  v_mfma_f32_16x16x32_bf16 v[148:151], a[204:207], a[148:151], v[148:151]
  ds_read_b64_tr_b16 a[218:219], v108 offset:35328
  v_mfma_f32_16x16x32_bf16 v[148:151], a[200:203], a[144:147], v[148:151]
  v_mfma_f32_16x16x32_bf16 v[140:143], a[200:203], a[136:139], v[140:143]
  ds_read_b64_tr_b16 a[220:221], v108 offset:43008
  v_mfma_f32_16x16x32_bf16 v[140:143], a[204:207], a[140:143], v[140:143]
  s_waitcnt vmcnt(8)
  v_mfma_f32_16x16x32_bf16 v[132:135], a[204:207], a[132:135], v[132:135]
  ds_read_b64_tr_b16 a[222:223], v108 offset:43520
  v_mfma_f32_16x16x32_bf16 v[132:135], a[200:203], a[128:131], v[132:135]
  s_waitcnt lgkmcnt(4)
  v_mfma_f32_16x16x32_bf16 v[8:11], a[208:211], a[160:163], v[8:11]
  ds_read_b64_tr_b16 a[192:193], v109 offset:32768
  v_mfma_f32_16x16x32_bf16 v[8:11], a[212:215], a[164:167], v[8:11]
  s_cmp_ge_u32 s45, 6
  s_cselect_b32 s87, 5, 0
  v_mfma_f32_16x16x32_bf16 v[16:19], a[212:215], a[172:175], v[16:19]
  s_sub_u32 s19, s45, s87
  ds_read_b64_tr_b16 a[194:195], v109 offset:33280
  v_mfma_f32_16x16x32_bf16 v[16:19], a[208:211], a[168:171], v[16:19]
  s_lshl_b32 s99, s44, 1
  s_add_u32 s59, s99, s45
  v_mfma_f32_16x16x32_bf16 v[24:27], a[208:211], a[176:179], v[24:27]
  s_add_u32 s87, s59, 13
  ds_read_b64_tr_b16 a[196:197], v109 offset:40960
  v_mfma_f32_16x16x32_bf16 v[24:27], a[212:215], a[180:183], v[24:27]
  s_add_u32 s42, s42, 512
  s_and_b32 s79, s87, 7
  v_mfma_f32_16x16x32_bf16 v[32:35], a[212:215], a[188:191], v[32:35]
  s_add_u32 s87, s59, 12
  ds_read_b64_tr_b16 a[198:199], v109 offset:41472
  v_mfma_f32_16x16x32_bf16 v[32:35], a[208:211], a[184:187], v[32:35]
  s_waitcnt lgkmcnt(4)
  buffer_load_dwordx4 a[128:131], v100, s[32:35], s42 offen offset:0 sc1
  v_mfma_f32_16x16x32_bf16 a[88:91], a[216:219], a[184:187], a[88:91]
  s_and_b32 s87, s87, 7
  ds_read_b64_tr_b16 a[200:201], v109 offset:34816
  v_mfma_f32_16x16x32_bf16 a[88:91], a[220:223], a[188:191], a[88:91]
  s_lshl4_add_u32 s79, s79, s87
  s_add_u32 s87, s59, 11
  v_mfma_f32_16x16x32_bf16 a[80:83], a[220:223], a[180:183], a[80:83]
  s_and_b32 s87, s87, 7
  ds_read_b64_tr_b16 a[202:203], v109 offset:35328
  v_mfma_f32_16x16x32_bf16 a[80:83], a[216:219], a[176:179], a[80:83]
  buffer_load_dwordx4 a[132:135], v100, s[32:35], s42 offen offset:256 sc1
  v_mfma_f32_16x16x32_bf16 a[72:75], a[216:219], a[168:171], a[72:75]
  s_lshl4_add_u32 s79, s79, s87
  ds_read_b64_tr_b16 a[204:205], v109 offset:43008
  v_mfma_f32_16x16x32_bf16 a[72:75], a[220:223], a[172:175], a[72:75]
  s_add_u32 s87, s59, 10
  s_and_b32 s87, s87, 7
  v_mfma_f32_16x16x32_bf16 a[64:67], a[220:223], a[164:167], a[64:67]
  s_lshl4_add_u32 s79, s79, s87
  ds_read_b64_tr_b16 a[206:207], v109 offset:43520
  v_mfma_f32_16x16x32_bf16 a[64:67], a[216:219], a[160:163], a[64:67]
  s_waitcnt lgkmcnt(4)
  s_add_u32 s87, s59, 9
  v_mfma_f32_16x16x32_bf16 v[12:15], a[192:195], a[160:163], v[12:15]
  s_and_b32 s87, s87, 7
  ds_read_b64_tr_b16 a[208:209], v110 offset:32768
  v_mfma_f32_16x16x32_bf16 v[12:15], a[196:199], a[164:167], v[12:15]
  buffer_load_dwordx4 a[136:139], v101, s[32:35], s42 offen offset:0 sc1
  v_mfma_f32_16x16x32_bf16 v[20:23], a[196:199], a[172:175], v[20:23]
  s_lshl4_add_u32 s79, s79, s87
  ds_read_b64_tr_b16 a[210:211], v110 offset:33280
  v_mfma_f32_16x16x32_bf16 v[20:23], a[192:195], a[168:171], v[20:23]
  s_add_u32 s87, s59, 8
  s_and_b32 s87, s87, 7
  v_mfma_f32_16x16x32_bf16 v[28:31], a[192:195], a[176:179], v[28:31]
  s_lshl4_add_u32 s79, s79, s87
  ds_read_b64_tr_b16 a[212:213], v110 offset:40960
  v_mfma_f32_16x16x32_bf16 v[28:31], a[196:199], a[180:183], v[28:31]
  buffer_load_dwordx4 a[140:143], v101, s[32:35], s42 offen offset:256 sc1
  v_mfma_f32_16x16x32_bf16 v[36:39], a[196:199], a[188:191], v[36:39]
  s_add_u32 s87, s59, 7
  ds_read_b64_tr_b16 a[214:215], v110 offset:41472
  v_mfma_f32_16x16x32_bf16 v[36:39], a[192:195], a[184:187], v[36:39]
  s_waitcnt lgkmcnt(4)
  s_and_b32 s78, s87, 7
  v_mfma_f32_16x16x32_bf16 a[92:95], a[200:203], a[184:187], a[92:95]
  s_add_u32 s87, s59, 6
  ds_read_b64_tr_b16 a[216:217], v110 offset:34816
  v_mfma_f32_16x16x32_bf16 a[92:95], a[204:207], a[188:191], a[92:95]
  s_and_b32 s87, s87, 7
  s_lshl4_add_u32 s78, s78, s87
  v_mfma_f32_16x16x32_bf16 a[84:87], a[204:207], a[180:183], a[84:87]
  s_add_u32 s59, s99, s19
  ds_read_b64_tr_b16 a[218:219], v110 offset:35328
  v_mfma_f32_16x16x32_bf16 a[84:87], a[200:203], a[176:179], a[84:87]
  buffer_load_dwordx4 a[144:147], v102, s[32:35], s42 offen offset:0 sc1
  v_mfma_f32_16x16x32_bf16 a[76:79], a[200:203], a[168:171], a[76:79]
  ds_read_b64_tr_b16 a[220:221], v110 offset:43008
  v_mfma_f32_16x16x32_bf16 a[76:79], a[204:207], a[172:175], a[76:79]
  s_cmp_gt_u32 s19, 0
  s_cselect_b32 s87, 9, 7
  v_mfma_f32_16x16x32_bf16 a[68:71], a[204:207], a[164:167], a[68:71]
  s_add_u32 s87, s87, s59
  ds_read_b64_tr_b16 a[222:223], v110 offset:43520
  v_mfma_f32_16x16x32_bf16 a[68:71], a[200:203], a[160:163], a[68:71]
  s_waitcnt lgkmcnt(4)
  buffer_load_dwordx4 a[148:151], v102, s[32:35], s42 offen offset:256 sc1
  v_mfma_f32_16x16x32_bf16 v[40:43], a[208:211], a[160:163], v[40:43]
  s_and_b32 s87, s87, 7
  ds_read_b64_tr_b16 a[192:193], v107 offset:16384
  v_mfma_f32_16x16x32_bf16 v[40:43], a[212:215], a[164:167], v[40:43]
  s_lshl4_add_u32 s78, s78, s87
  v_mfma_f32_16x16x32_bf16 v[48:51], a[212:215], a[172:175], v[48:51]
  ds_read_b64_tr_b16 a[194:195], v107 offset:17408
  v_mfma_f32_16x16x32_bf16 v[48:51], a[208:211], a[168:171], v[48:51]
  s_cmp_gt_u32 s19, 1
  s_cselect_b32 s87, 8, 6
  v_mfma_f32_16x16x32_bf16 v[56:59], a[208:211], a[176:179], v[56:59]
  s_add_u32 s87, s87, s59
  ds_read_b64_tr_b16 a[196:197], v107 offset:24576
  v_mfma_f32_16x16x32_bf16 v[56:59], a[212:215], a[180:183], v[56:59]
  buffer_load_dwordx4 a[152:155], v103, s[32:35], s42 offen offset:0 sc1
  v_mfma_f32_16x16x32_bf16 v[64:67], a[212:215], a[188:191], v[64:67]
  s_and_b32 s87, s87, 7
  ds_read_b64_tr_b16 a[198:199], v107 offset:25600
  v_mfma_f32_16x16x32_bf16 v[64:67], a[208:211], a[184:187], v[64:67]
  s_waitcnt lgkmcnt(4)
  s_lshl4_add_u32 s78, s78, s87
  v_mfma_f32_16x16x32_bf16 a[120:123], a[216:219], a[184:187], a[120:123]
  ds_read_b64_tr_b16 a[200:201], v107 offset:16392
  v_mfma_f32_16x16x32_bf16 a[120:123], a[220:223], a[188:191], a[120:123]
  buffer_load_dwordx4 a[156:159], v103, s[32:35], s42 offen offset:256 sc1
  v_mfma_f32_16x16x32_bf16 a[112:115], a[220:223], a[180:183], a[112:115]
  ds_read_b64_tr_b16 a[202:203], v107 offset:17416
  v_mfma_f32_16x16x32_bf16 a[112:115], a[216:219], a[176:179], a[112:115]
  s_cmp_gt_u32 s19, 2
  s_cselect_b32 s87, 7, 5
  v_mfma_f32_16x16x32_bf16 a[104:107], a[216:219], a[168:171], a[104:107]
  s_add_u32 m0, s18, 49152
  ds_read_b64_tr_b16 a[204:205], v107 offset:24584
  v_mfma_f32_16x16x32_bf16 a[104:107], a[220:223], a[172:175], a[104:107]
  s_add_u32 s40, s40, 429056
  s_add_u32 s87, s87, s59
  v_mfma_f32_16x16x32_bf16 a[96:99], a[220:223], a[164:167], a[96:99]
  s_and_b32 s87, s87, 7
  ds_read_b64_tr_b16 a[206:207], v107 offset:25608
  v_mfma_f32_16x16x32_bf16 a[96:99], a[216:219], a[160:163], a[96:99]
  s_waitcnt lgkmcnt(4)
  buffer_load_dwordx4 v112, s[20:23], s40 offen offset:0 lds
  v_mfma_f32_16x16x32_bf16 v[224:227], a[192:195], a[160:163], v[224:227]
  s_lshl4_add_u32 s78, s78, s87
  ds_read_b64_tr_b16 a[208:209], v106 offset:16384
  v_mfma_f32_16x16x32_bf16 v[224:227], a[196:199], a[164:167], v[224:227]
  s_add_u32 s40, s40, 31744
  v_mfma_f32_16x16x32_bf16 v[232:235], a[196:199], a[172:175], v[232:235]
  ds_read_b64_tr_b16 a[210:211], v106 offset:17408
  v_mfma_f32_16x16x32_bf16 v[232:235], a[192:195], a[168:171], v[232:235]
  buffer_load_dwordx4 v112, s[20:23], s40 offen offset:1024 lds
  v_mfma_f32_16x16x32_bf16 v[240:243], a[192:195], a[176:179], v[240:243]
  ds_read_b64_tr_b16 a[212:213], v106 offset:24576
  v_mfma_f32_16x16x32_bf16 v[240:243], a[196:199], a[180:183], v[240:243]
  s_cmp_gt_u32 s19, 3
  s_cselect_b32 s87, 6, 4
  v_mfma_f32_16x16x32_bf16 v[248:251], a[196:199], a[188:191], v[248:251]
  s_add_u32 s87, s87, s59
  ds_read_b64_tr_b16 a[214:215], v106 offset:25600
  v_mfma_f32_16x16x32_bf16 v[248:251], a[192:195], a[184:187], v[248:251]
  s_waitcnt lgkmcnt(4)
  s_add_u32 s40, s40, 31744
  v_mfma_f32_16x16x32_bf16 v[252:255], a[200:203], a[184:187], v[252:255]
  s_and_b32 s87, s87, 7
  ds_read_b64_tr_b16 a[216:217], v106 offset:16392
  v_mfma_f32_16x16x32_bf16 v[252:255], a[204:207], a[188:191], v[252:255]
  buffer_load_dwordx4 v112, s[20:23], s40 offen offset:2048 lds
  v_mfma_f32_16x16x32_bf16 v[244:247], a[204:207], a[180:183], v[244:247]
  s_lshl4_add_u32 s78, s78, s87
  ds_read_b64_tr_b16 a[218:219], v106 offset:17416
  v_mfma_f32_16x16x32_bf16 v[244:247], a[200:203], a[176:179], v[244:247]
  s_add_u32 s40, s40, 31744
  v_mfma_f32_16x16x32_bf16 v[236:239], a[200:203], a[168:171], v[236:239]
  ds_read_b64_tr_b16 a[220:221], v106 offset:24584
  v_mfma_f32_16x16x32_bf16 v[236:239], a[204:207], a[172:175], v[236:239]
  buffer_load_dwordx4 v112, s[20:23], s40 offen offset:3072 lds
  v_mfma_f32_16x16x32_bf16 v[228:231], a[204:207], a[164:167], v[228:231]
  ds_read_b64_tr_b16 a[222:223], v106 offset:25608
  v_mfma_f32_16x16x32_bf16 v[228:231], a[200:203], a[160:163], v[228:231]
  s_waitcnt lgkmcnt(4)
  v_mfma_f32_16x16x32_bf16 v[192:195], a[208:211], a[160:163], v[192:195]
  s_add_u32 m0, s18, 65536
  ds_read_b64_tr_b16 a[192:193], v105 offset:16384
  v_mfma_f32_16x16x32_bf16 v[192:195], a[212:215], a[164:167], v[192:195]
  s_add_u32 s41, s41, 221184
  v_mfma_f32_16x16x32_bf16 v[200:203], a[212:215], a[172:175], v[200:203]
  ds_read_b64_tr_b16 a[194:195], v105 offset:17408
  v_mfma_f32_16x16x32_bf16 v[200:203], a[208:211], a[168:171], v[200:203]
  buffer_load_dwordx4 v113, s[24:27], s41 offen offset:0 lds
  v_mfma_f32_16x16x32_bf16 v[208:211], a[208:211], a[176:179], v[208:211]
  ds_read_b64_tr_b16 a[196:197], v105 offset:24576
  v_mfma_f32_16x16x32_bf16 v[208:211], a[212:215], a[180:183], v[208:211]
  s_cmp_gt_u32 s19, 4
  s_cselect_b32 s87, 5, 3
  v_mfma_f32_16x16x32_bf16 v[216:219], a[212:215], a[188:191], v[216:219]
  s_add_u32 s87, s87, s59
  ds_read_b64_tr_b16 a[198:199], v105 offset:25600
  v_mfma_f32_16x16x32_bf16 v[216:219], a[208:211], a[184:187], v[216:219]
  s_waitcnt lgkmcnt(4)
  buffer_load_dwordx4 v114, s[24:27], s41 offen offset:1024 lds
  v_mfma_f32_16x16x32_bf16 v[220:223], a[216:219], a[184:187], v[220:223]
  s_and_b32 s87, s87, 7
  ds_read_b64_tr_b16 a[200:201], v105 offset:16392
  v_mfma_f32_16x16x32_bf16 v[220:223], a[220:223], a[188:191], v[220:223]
  s_lshl4_add_u32 s78, s78, s87
  v_mfma_f32_16x16x32_bf16 v[212:215], a[220:223], a[180:183], v[212:215]
  ds_read_b64_tr_b16 a[202:203], v105 offset:17416
  v_mfma_f32_16x16x32_bf16 v[212:215], a[216:219], a[176:179], v[212:215]
  s_add_u32 m0, s18, 67584
  v_mfma_f32_16x16x32_bf16 v[204:207], a[216:219], a[168:171], v[204:207]
  ds_read_b64_tr_b16 a[204:205], v105 offset:24584
  v_mfma_f32_16x16x32_bf16 v[204:207], a[220:223], a[172:175], v[204:207]
  buffer_load_dwordx4 v113, s[28:31], s41 offen offset:0 lds
  v_mfma_f32_16x16x32_bf16 v[196:199], a[220:223], a[164:167], v[196:199]
  ds_read_b64_tr_b16 a[206:207], v105 offset:25608
  v_mfma_f32_16x16x32_bf16 v[196:199], a[216:219], a[160:163], v[196:199]
  s_waitcnt lgkmcnt(4)
  v_mfma_f32_16x16x32_bf16 v[160:163], a[192:195], a[160:163], v[160:163]
  ds_read_b64_tr_b16 a[208:209], v104 offset:16384
  v_mfma_f32_16x16x32_bf16 v[160:163], a[196:199], a[164:167], v[160:163]
  buffer_load_dwordx4 v114, s[28:31], s41 offen offset:1024 lds
  v_mfma_f32_16x16x32_bf16 v[168:171], a[196:199], a[172:175], v[168:171]
  ds_read_b64_tr_b16 a[210:211], v104 offset:17408
  v_mfma_f32_16x16x32_bf16 v[168:171], a[192:195], a[168:171], v[168:171]
  s_cmp_gt_u32 s19, 5
  s_cselect_b32 s87, 4, 2
  v_mfma_f32_16x16x32_bf16 v[176:179], a[192:195], a[176:179], v[176:179]
  s_add_u32 s87, s87, s59
  ds_read_b64_tr_b16 a[212:213], v104 offset:24576
  v_mfma_f32_16x16x32_bf16 v[176:179], a[196:199], a[180:183], v[176:179]
  s_and_b32 s87, s87, 7
  s_lshl4_add_u32 s78, s78, s87
  v_mfma_f32_16x16x32_bf16 v[184:187], a[196:199], a[188:191], v[184:187]
  ds_read_b64_tr_b16 a[214:215], v104 offset:25600
  v_mfma_f32_16x16x32_bf16 v[184:187], a[192:195], a[184:187], v[184:187]
  s_waitcnt lgkmcnt(4)
  v_mfma_f32_16x16x32_bf16 v[188:191], a[200:203], a[184:187], v[188:191]
  ds_read_b64_tr_b16 a[216:217], v104 offset:16392
  v_mfma_f32_16x16x32_bf16 v[188:191], a[204:207], a[188:191], v[188:191]
  s_bitcmp1_b32 s44, 2
  s_cselect_b32 s87, 0x88888888, 0
  v_mfma_f32_16x16x32_bf16 v[180:183], a[204:207], a[180:183], v[180:183]
  s_xor_b32 s78, s78, s87
  ds_read_b64_tr_b16 a[218:219], v104 offset:17416
  v_mfma_f32_16x16x32_bf16 v[180:183], a[200:203], a[176:179], v[180:183]
  s_xor_b32 s79, s79, s87
  s_xor_b32 s78, s78, 0x88000000
  v_mfma_f32_16x16x32_bf16 v[172:175], a[200:203], a[168:171], v[172:175]
  s_xor_b32 s79, s79, 0x88888888
  ds_read_b64_tr_b16 a[220:221], v104 offset:24584
  v_mfma_f32_16x16x32_bf16 v[172:175], a[204:207], a[172:175], v[172:175]
  v_mfma_f32_16x16x32_bf16 v[164:167], a[204:207], a[164:167], v[164:167]
  ds_read_b64_tr_b16 a[222:223], v104 offset:25608
  v_mfma_f32_16x16x32_bf16 v[164:167], a[200:203], a[160:163], v[164:167]
  s_waitcnt lgkmcnt(4)
  s_waitcnt vmcnt(16)
  s_barrier
  v_mfma_f32_16x16x32_bf16 v[128:131], a[208:211], a[160:163], v[128:131]
  ds_read_b64_tr_b16 a[192:193], v108 offset:16384
  v_mfma_f32_16x16x32_bf16 v[128:131], a[212:215], a[164:167], v[128:131]
  v_mfma_f32_16x16x32_bf16 v[136:139], a[212:215], a[172:175], v[136:139]
  ds_read_b64_tr_b16 a[194:195], v108 offset:16896
  v_mfma_f32_16x16x32_bf16 v[136:139], a[208:211], a[168:171], v[136:139]
  v_mfma_f32_16x16x32_bf16 v[144:147], a[208:211], a[176:179], v[144:147]
  ds_read_b64_tr_b16 a[196:197], v108 offset:24576
  v_mfma_f32_16x16x32_bf16 v[144:147], a[212:215], a[180:183], v[144:147]
  v_mfma_f32_16x16x32_bf16 v[152:155], a[212:215], a[188:191], v[152:155]
  ds_read_b64_tr_b16 a[198:199], v108 offset:25088
  v_mfma_f32_16x16x32_bf16 v[152:155], a[208:211], a[184:187], v[152:155]
  s_waitcnt lgkmcnt(4)
  v_mfma_f32_16x16x32_bf16 v[156:159], a[216:219], a[184:187], v[156:159]
  ds_read_b64_tr_b16 a[200:201], v108 offset:18432
  v_mfma_f32_16x16x32_bf16 v[156:159], a[220:223], a[188:191], v[156:159]
  v_mfma_f32_16x16x32_bf16 v[148:151], a[220:223], a[180:183], v[148:151]
  ds_read_b64_tr_b16 a[202:203], v108 offset:18944
  v_mfma_f32_16x16x32_bf16 v[148:151], a[216:219], a[176:179], v[148:151]
  v_mfma_f32_16x16x32_bf16 v[140:143], a[216:219], a[168:171], v[140:143]
  ds_read_b64_tr_b16 a[204:205], v108 offset:26624
  v_mfma_f32_16x16x32_bf16 v[140:143], a[220:223], a[172:175], v[140:143]
  s_waitcnt vmcnt(8)
  v_mfma_f32_16x16x32_bf16 v[132:135], a[220:223], a[164:167], v[132:135]
  ds_read_b64_tr_b16 a[206:207], v108 offset:27136
  v_mfma_f32_16x16x32_bf16 v[132:135], a[216:219], a[160:163], v[132:135]
  s_waitcnt lgkmcnt(4)
  v_mfma_f32_16x16x32_bf16 v[8:11], a[192:195], a[128:131], v[8:11]
  ds_read_b64_tr_b16 a[208:209], v109 offset:16384
  v_mfma_f32_16x16x32_bf16 v[8:11], a[196:199], a[132:135], v[8:11]
  v_mfma_f32_16x16x32_bf16 v[16:19], a[196:199], a[140:143], v[16:19]
  ds_read_b64_tr_b16 a[210:211], v109 offset:16896
  v_mfma_f32_16x16x32_bf16 v[16:19], a[192:195], a[136:139], v[16:19]
  v_mfma_f32_16x16x32_bf16 v[24:27], a[192:195], a[144:147], v[24:27]
  ds_read_b64_tr_b16 a[212:213], v109 offset:24576
  v_mfma_f32_16x16x32_bf16 v[24:27], a[196:199], a[148:151], v[24:27]
  s_add_u32 s42, s42, 512
  v_mfma_f32_16x16x32_bf16 v[32:35], a[196:199], a[156:159], v[32:35]
  ds_read_b64_tr_b16 a[214:215], v109 offset:25088
  v_mfma_f32_16x16x32_bf16 v[32:35], a[192:195], a[152:155], v[32:35]
  s_waitcnt lgkmcnt(4)
  buffer_load_dwordx4 a[160:163], v100, s[32:35], s42 offen offset:0 sc1
  v_mfma_f32_16x16x32_bf16 a[88:91], a[200:203], a[152:155], a[88:91]
  ds_read_b64_tr_b16 a[216:217], v109 offset:18432
  v_mfma_f32_16x16x32_bf16 a[88:91], a[204:207], a[156:159], a[88:91]
  v_mfma_f32_16x16x32_bf16 a[80:83], a[204:207], a[148:151], a[80:83]
  ds_read_b64_tr_b16 a[218:219], v109 offset:18944
  v_mfma_f32_16x16x32_bf16 a[80:83], a[200:203], a[144:147], a[80:83]
  buffer_load_dwordx4 a[164:167], v100, s[32:35], s42 offen offset:256 sc1
  v_mfma_f32_16x16x32_bf16 a[72:75], a[200:203], a[136:139], a[72:75]
  ds_read_b64_tr_b16 a[220:221], v109 offset:26624
  v_mfma_f32_16x16x32_bf16 a[72:75], a[204:207], a[140:143], a[72:75]
  v_mfma_f32_16x16x32_bf16 a[64:67], a[204:207], a[132:135], a[64:67]
  ds_read_b64_tr_b16 a[222:223], v109 offset:27136
  v_mfma_f32_16x16x32_bf16 a[64:67], a[200:203], a[128:131], a[64:67]
  s_waitcnt lgkmcnt(4)
  v_mfma_f32_16x16x32_bf16 v[12:15], a[208:211], a[128:131], v[12:15]
  ds_read_b64_tr_b16 a[192:193], v110 offset:16384
  v_mfma_f32_16x16x32_bf16 v[12:15], a[212:215], a[132:135], v[12:15]
  buffer_load_dwordx4 a[168:171], v101, s[32:35], s42 offen offset:0 sc1
  v_mfma_f32_16x16x32_bf16 v[20:23], a[212:215], a[140:143], v[20:23]
  ds_read_b64_tr_b16 a[194:195], v110 offset:16896
  v_mfma_f32_16x16x32_bf16 v[20:23], a[208:211], a[136:139], v[20:23]
  v_mfma_f32_16x16x32_bf16 v[28:31], a[208:211], a[144:147], v[28:31]
  ds_read_b64_tr_b16 a[196:197], v110 offset:24576
  v_mfma_f32_16x16x32_bf16 v[28:31], a[212:215], a[148:151], v[28:31]
  buffer_load_dwordx4 a[172:175], v101, s[32:35], s42 offen offset:256 sc1
  v_mfma_f32_16x16x32_bf16 v[36:39], a[212:215], a[156:159], v[36:39]
  ds_read_b64_tr_b16 a[198:199], v110 offset:25088
  v_mfma_f32_16x16x32_bf16 v[36:39], a[208:211], a[152:155], v[36:39]
  s_waitcnt lgkmcnt(4)
  v_mfma_f32_16x16x32_bf16 a[92:95], a[216:219], a[152:155], a[92:95]
  ds_read_b64_tr_b16 a[200:201], v110 offset:18432
  v_mfma_f32_16x16x32_bf16 a[92:95], a[220:223], a[156:159], a[92:95]
  v_mfma_f32_16x16x32_bf16 a[84:87], a[220:223], a[148:151], a[84:87]
  ds_read_b64_tr_b16 a[202:203], v110 offset:18944
  v_mfma_f32_16x16x32_bf16 a[84:87], a[216:219], a[144:147], a[84:87]
  buffer_load_dwordx4 a[176:179], v102, s[32:35], s42 offen offset:0 sc1
  v_mfma_f32_16x16x32_bf16 a[76:79], a[216:219], a[136:139], a[76:79]
  ds_read_b64_tr_b16 a[204:205], v110 offset:26624
  v_mfma_f32_16x16x32_bf16 a[76:79], a[220:223], a[140:143], a[76:79]
  v_mfma_f32_16x16x32_bf16 a[68:71], a[220:223], a[132:135], a[68:71]
  ds_read_b64_tr_b16 a[206:207], v110 offset:27136
  v_mfma_f32_16x16x32_bf16 a[68:71], a[216:219], a[128:131], a[68:71]
  s_waitcnt lgkmcnt(4)
  buffer_load_dwordx4 a[180:183], v102, s[32:35], s42 offen offset:256 sc1
  v_mfma_f32_16x16x32_bf16 v[40:43], a[192:195], a[128:131], v[40:43]
  ds_read_b64_tr_b16 a[208:209], v107 offset:32768
  v_mfma_f32_16x16x32_bf16 v[40:43], a[196:199], a[132:135], v[40:43]
  v_mfma_f32_16x16x32_bf16 v[48:51], a[196:199], a[140:143], v[48:51]
  ds_read_b64_tr_b16 a[210:211], v107 offset:33792
  v_mfma_f32_16x16x32_bf16 v[48:51], a[192:195], a[136:139], v[48:51]
  v_mfma_f32_16x16x32_bf16 v[56:59], a[192:195], a[144:147], v[56:59]
  ds_read_b64_tr_b16 a[212:213], v107 offset:40960
  v_mfma_f32_16x16x32_bf16 v[56:59], a[196:199], a[148:151], v[56:59]
  buffer_load_dwordx4 a[184:187], v103, s[32:35], s42 offen offset:0 sc1
  v_mfma_f32_16x16x32_bf16 v[64:67], a[196:199], a[156:159], v[64:67]
  ds_read_b64_tr_b16 a[214:215], v107 offset:41984
  v_mfma_f32_16x16x32_bf16 v[64:67], a[192:195], a[152:155], v[64:67]
  s_waitcnt lgkmcnt(4)
  v_mfma_f32_16x16x32_bf16 a[120:123], a[200:203], a[152:155], a[120:123]
  ds_read_b64_tr_b16 a[216:217], v107 offset:32776
  v_mfma_f32_16x16x32_bf16 a[120:123], a[204:207], a[156:159], a[120:123]
  buffer_load_dwordx4 a[188:191], v103, s[32:35], s42 offen offset:256 sc1
  v_mfma_f32_16x16x32_bf16 a[112:115], a[204:207], a[148:151], a[112:115]
  ds_read_b64_tr_b16 a[218:219], v107 offset:33800
  v_mfma_f32_16x16x32_bf16 a[112:115], a[200:203], a[144:147], a[112:115]
  v_mfma_f32_16x16x32_bf16 a[104:107], a[200:203], a[136:139], a[104:107]
  s_add_u32 m0, s18, 0
  ds_read_b64_tr_b16 a[220:221], v107 offset:40968
  v_mfma_f32_16x16x32_bf16 a[104:107], a[204:207], a[140:143], a[104:107]
  s_add_u32 s40, s40, 429056
  s_cmp_eq_u32 s83, 6
  s_cmov_b32 s40, s80
  v_mfma_f32_16x16x32_bf16 a[96:99], a[204:207], a[132:135], a[96:99]
  ds_read_b64_tr_b16 a[222:223], v107 offset:41992
  v_mfma_f32_16x16x32_bf16 a[96:99], a[200:203], a[128:131], a[96:99]
  s_waitcnt lgkmcnt(4)
  buffer_load_dwordx4 v112, s[20:23], s40 offen offset:0 lds
  v_mfma_f32_16x16x32_bf16 v[224:227], a[208:211], a[128:131], v[224:227]
  ds_read_b64_tr_b16 a[192:193], v106 offset:32768
  v_mfma_f32_16x16x32_bf16 v[224:227], a[212:215], a[132:135], v[224:227]
  s_add_u32 s40, s40, 31744
  v_mfma_f32_16x16x32_bf16 v[232:235], a[212:215], a[140:143], v[232:235]
  ds_read_b64_tr_b16 a[194:195], v106 offset:33792
  v_mfma_f32_16x16x32_bf16 v[232:235], a[208:211], a[136:139], v[232:235]
  buffer_load_dwordx4 v112, s[20:23], s40 offen offset:1024 lds
  v_mfma_f32_16x16x32_bf16 v[240:243], a[208:211], a[144:147], v[240:243]
  ds_read_b64_tr_b16 a[196:197], v106 offset:40960
  v_mfma_f32_16x16x32_bf16 v[240:243], a[212:215], a[148:151], v[240:243]
  v_mfma_f32_16x16x32_bf16 v[248:251], a[212:215], a[156:159], v[248:251]
  ds_read_b64_tr_b16 a[198:199], v106 offset:41984
  v_mfma_f32_16x16x32_bf16 v[248:251], a[208:211], a[152:155], v[248:251]
  s_waitcnt lgkmcnt(4)
  s_add_u32 s40, s40, 31744
  v_mfma_f32_16x16x32_bf16 v[252:255], a[216:219], a[152:155], v[252:255]
  ds_read_b64_tr_b16 a[200:201], v106 offset:32776
  v_mfma_f32_16x16x32_bf16 v[252:255], a[220:223], a[156:159], v[252:255]
  buffer_load_dwordx4 v112, s[20:23], s40 offen offset:2048 lds
  v_mfma_f32_16x16x32_bf16 v[244:247], a[220:223], a[148:151], v[244:247]
  ds_read_b64_tr_b16 a[202:203], v106 offset:33800
  v_mfma_f32_16x16x32_bf16 v[244:247], a[216:219], a[144:147], v[244:247]
  s_add_u32 s40, s40, 31744
  v_mfma_f32_16x16x32_bf16 v[236:239], a[216:219], a[136:139], v[236:239]
  ds_read_b64_tr_b16 a[204:205], v106 offset:40968
  v_mfma_f32_16x16x32_bf16 v[236:239], a[220:223], a[140:143], v[236:239]
  buffer_load_dwordx4 v112, s[20:23], s40 offen offset:3072 lds
  v_mfma_f32_16x16x32_bf16 v[228:231], a[220:223], a[132:135], v[228:231]
  ds_read_b64_tr_b16 a[206:207], v106 offset:41992
  v_mfma_f32_16x16x32_bf16 v[228:231], a[216:219], a[128:131], v[228:231]
  s_waitcnt lgkmcnt(4)
  v_mfma_f32_16x16x32_bf16 v[192:195], a[192:195], a[128:131], v[192:195]
  s_add_u32 m0, s18, 114688
  ds_read_b64_tr_b16 a[208:209], v105 offset:32768
  v_mfma_f32_16x16x32_bf16 v[192:195], a[196:199], a[132:135], v[192:195]
  s_add_u32 s41, s41, 221184
  s_cmp_eq_u32 s83, 6
  s_cmov_b32 s41, s81
  v_mfma_f32_16x16x32_bf16 v[200:203], a[196:199], a[140:143], v[200:203]
  ds_read_b64_tr_b16 a[210:211], v105 offset:33792
  v_mfma_f32_16x16x32_bf16 v[200:203], a[192:195], a[136:139], v[200:203]
  buffer_load_dwordx4 v113, s[24:27], s41 offen offset:0 lds
  v_mfma_f32_16x16x32_bf16 v[208:211], a[192:195], a[144:147], v[208:211]
  ds_read_b64_tr_b16 a[212:213], v105 offset:40960
  v_mfma_f32_16x16x32_bf16 v[208:211], a[196:199], a[148:151], v[208:211]
  v_mfma_f32_16x16x32_bf16 v[216:219], a[196:199], a[156:159], v[216:219]
  ds_read_b64_tr_b16 a[214:215], v105 offset:41984
  v_mfma_f32_16x16x32_bf16 v[216:219], a[192:195], a[152:155], v[216:219]
  s_waitcnt lgkmcnt(4)
  buffer_load_dwordx4 v114, s[24:27], s41 offen offset:1024 lds
  v_mfma_f32_16x16x32_bf16 v[220:223], a[200:203], a[152:155], v[220:223]
  ds_read_b64_tr_b16 a[216:217], v105 offset:32776
  v_mfma_f32_16x16x32_bf16 v[220:223], a[204:207], a[156:159], v[220:223]
  v_mfma_f32_16x16x32_bf16 v[212:215], a[204:207], a[148:151], v[212:215]
  ds_read_b64_tr_b16 a[218:219], v105 offset:33800
  v_mfma_f32_16x16x32_bf16 v[212:215], a[200:203], a[144:147], v[212:215]
  s_add_u32 m0, s18, 116736
  v_mfma_f32_16x16x32_bf16 v[204:207], a[200:203], a[136:139], v[204:207]
  ds_read_b64_tr_b16 a[220:221], v105 offset:40968
  v_mfma_f32_16x16x32_bf16 v[204:207], a[204:207], a[140:143], v[204:207]
  buffer_load_dwordx4 v113, s[28:31], s41 offen offset:0 lds
  v_mfma_f32_16x16x32_bf16 v[196:199], a[204:207], a[132:135], v[196:199]
  ds_read_b64_tr_b16 a[222:223], v105 offset:41992
  v_mfma_f32_16x16x32_bf16 v[196:199], a[200:203], a[128:131], v[196:199]
  s_waitcnt lgkmcnt(4)
  v_mfma_f32_16x16x32_bf16 v[160:163], a[208:211], a[128:131], v[160:163]
  ds_read_b64_tr_b16 a[192:193], v104 offset:32768
  v_mfma_f32_16x16x32_bf16 v[160:163], a[212:215], a[132:135], v[160:163]
  buffer_load_dwordx4 v114, s[28:31], s41 offen offset:1024 lds
  v_mfma_f32_16x16x32_bf16 v[168:171], a[212:215], a[140:143], v[168:171]
  ds_read_b64_tr_b16 a[194:195], v104 offset:33792
  v_mfma_f32_16x16x32_bf16 v[168:171], a[208:211], a[136:139], v[168:171]
  v_mfma_f32_16x16x32_bf16 v[176:179], a[208:211], a[144:147], v[176:179]
  ds_read_b64_tr_b16 a[196:197], v104 offset:40960
  v_mfma_f32_16x16x32_bf16 v[176:179], a[212:215], a[148:151], v[176:179]
  v_mfma_f32_16x16x32_bf16 v[184:187], a[212:215], a[156:159], v[184:187]
  ds_read_b64_tr_b16 a[198:199], v104 offset:41984
  v_mfma_f32_16x16x32_bf16 v[184:187], a[208:211], a[152:155], v[184:187]
  s_waitcnt lgkmcnt(4)
  v_mfma_f32_16x16x32_bf16 v[188:191], a[216:219], a[152:155], v[188:191]
  ds_read_b64_tr_b16 a[200:201], v104 offset:32776
  v_mfma_f32_16x16x32_bf16 v[188:191], a[220:223], a[156:159], v[188:191]
  v_mfma_f32_16x16x32_bf16 v[180:183], a[220:223], a[148:151], v[180:183]
  ds_read_b64_tr_b16 a[202:203], v104 offset:33800
  v_mfma_f32_16x16x32_bf16 v[180:183], a[216:219], a[144:147], v[180:183]
  v_mfma_f32_16x16x32_bf16 v[172:175], a[216:219], a[136:139], v[172:175]
  ds_read_b64_tr_b16 a[204:205], v104 offset:40968
  v_mfma_f32_16x16x32_bf16 v[172:175], a[220:223], a[140:143], v[172:175]
  v_mfma_f32_16x16x32_bf16 v[164:167], a[220:223], a[132:135], v[164:167]
  ds_read_b64_tr_b16 a[206:207], v104 offset:41992
  v_mfma_f32_16x16x32_bf16 v[164:167], a[216:219], a[128:131], v[164:167]
  s_waitcnt lgkmcnt(4)
  s_waitcnt vmcnt(16)
  s_barrier
  v_mfma_f32_16x16x32_bf16 v[128:131], a[192:195], a[128:131], v[128:131]
  ds_read_b64_tr_b16 a[208:209], v108 offset:0
  v_mfma_f32_16x16x32_bf16 v[128:131], a[196:199], a[132:135], v[128:131]
  v_mfma_f32_16x16x32_bf16 v[136:139], a[196:199], a[140:143], v[136:139]
  ds_read_b64_tr_b16 a[210:211], v108 offset:512
  v_mfma_f32_16x16x32_bf16 v[136:139], a[192:195], a[136:139], v[136:139]
  v_mfma_f32_16x16x32_bf16 v[144:147], a[192:195], a[144:147], v[144:147]
  ds_read_b64_tr_b16 a[212:213], v108 offset:8192
  v_mfma_f32_16x16x32_bf16 v[144:147], a[196:199], a[148:151], v[144:147]
  v_mfma_f32_16x16x32_bf16 v[152:155], a[196:199], a[156:159], v[152:155]
  ds_read_b64_tr_b16 a[214:215], v108 offset:8704
  v_mfma_f32_16x16x32_bf16 v[152:155], a[192:195], a[152:155], v[152:155]
  s_waitcnt lgkmcnt(4)
  v_mfma_f32_16x16x32_bf16 v[156:159], a[200:203], a[152:155], v[156:159]
  ds_read_b64_tr_b16 a[216:217], v108 offset:2048
  v_mfma_f32_16x16x32_bf16 v[156:159], a[204:207], a[156:159], v[156:159]
  v_mfma_f32_16x16x32_bf16 v[148:151], a[204:207], a[148:151], v[148:151]
  ds_read_b64_tr_b16 a[218:219], v108 offset:2560
  v_mfma_f32_16x16x32_bf16 v[148:151], a[200:203], a[144:147], v[148:151]
  v_mfma_f32_16x16x32_bf16 v[140:143], a[200:203], a[136:139], v[140:143]
  ds_read_b64_tr_b16 a[220:221], v108 offset:10240
  v_mfma_f32_16x16x32_bf16 v[140:143], a[204:207], a[140:143], v[140:143]
  s_waitcnt vmcnt(8)
  v_mfma_f32_16x16x32_bf16 v[132:135], a[204:207], a[132:135], v[132:135]
  ds_read_b64_tr_b16 a[222:223], v108 offset:10752
  v_mfma_f32_16x16x32_bf16 v[132:135], a[200:203], a[128:131], v[132:135]
  s_waitcnt lgkmcnt(4)
  v_mfma_f32_16x16x32_bf16 v[8:11], a[208:211], a[160:163], v[8:11]
  ds_read_b64_tr_b16 a[192:193], v109 offset:0
  v_mfma_f32_16x16x32_bf16 v[8:11], a[212:215], a[164:167], v[8:11]
  v_mfma_f32_16x16x32_bf16 v[16:19], a[212:215], a[172:175], v[16:19]
  ds_read_b64_tr_b16 a[194:195], v109 offset:512
  v_mfma_f32_16x16x32_bf16 v[16:19], a[208:211], a[168:171], v[16:19]
  v_mfma_f32_16x16x32_bf16 v[24:27], a[208:211], a[176:179], v[24:27]
  ds_read_b64_tr_b16 a[196:197], v109 offset:8192
  v_mfma_f32_16x16x32_bf16 v[24:27], a[212:215], a[180:183], v[24:27]
  s_add_u32 s42, s42, 512
  s_cmp_eq_u32 s83, 6
  s_cmov_b32 s42, s82
  v_mfma_f32_16x16x32_bf16 v[32:35], a[212:215], a[188:191], v[32:35]
  ds_read_b64_tr_b16 a[198:199], v109 offset:8704
  v_mfma_f32_16x16x32_bf16 v[32:35], a[208:211], a[184:187], v[32:35]
  s_waitcnt lgkmcnt(4)
  buffer_load_dwordx4 a[128:131], v100, s[32:35], s42 offen offset:0 sc1
  v_mfma_f32_16x16x32_bf16 a[88:91], a[216:219], a[184:187], a[88:91]
  ds_read_b64_tr_b16 a[200:201], v109 offset:2048
  v_mfma_f32_16x16x32_bf16 a[88:91], a[220:223], a[188:191], a[88:91]
  v_mfma_f32_16x16x32_bf16 a[80:83], a[220:223], a[180:183], a[80:83]
L_pad_proj12_3:
  s_cbranch_execz L_pad_proj12_4
  ds_read_b64_tr_b16 a[202:203], v109 offset:2560
  v_mfma_f32_16x16x32_bf16 a[80:83], a[216:219], a[176:179], a[80:83]
  buffer_load_dwordx4 a[132:135], v100, s[32:35], s42 offen offset:256 sc1
  v_mfma_f32_16x16x32_bf16 a[72:75], a[216:219], a[168:171], a[72:75]
  ds_read_b64_tr_b16 a[204:205], v109 offset:10240
  v_mfma_f32_16x16x32_bf16 a[72:75], a[220:223], a[172:175], a[72:75]
  v_mfma_f32_16x16x32_bf16 a[64:67], a[220:223], a[164:167], a[64:67]
  ds_read_b64_tr_b16 a[206:207], v109 offset:10752
  v_mfma_f32_16x16x32_bf16 a[64:67], a[216:219], a[160:163], a[64:67]
  s_waitcnt lgkmcnt(4)
  buffer_load_dwordx4 a[136:139], v101, s[32:35], s42 offen offset:0 sc1
  v_mfma_f32_16x16x32_bf16 v[12:15], a[192:195], a[160:163], v[12:15]
  ds_read_b64_tr_b16 a[208:209], v110 offset:0
  v_mfma_f32_16x16x32_bf16 v[12:15], a[196:199], a[164:167], v[12:15]
  v_mfma_f32_16x16x32_bf16 v[20:23], a[196:199], a[172:175], v[20:23]
  ds_read_b64_tr_b16 a[210:211], v110 offset:512
  v_mfma_f32_16x16x32_bf16 v[20:23], a[192:195], a[168:171], v[20:23]
  buffer_load_dwordx4 a[140:143], v101, s[32:35], s42 offen offset:256 sc1
  v_mfma_f32_16x16x32_bf16 v[28:31], a[192:195], a[176:179], v[28:31]
  ds_read_b64_tr_b16 a[212:213], v110 offset:8192
  v_mfma_f32_16x16x32_bf16 v[28:31], a[196:199], a[180:183], v[28:31]
  v_mfma_f32_16x16x32_bf16 v[36:39], a[196:199], a[188:191], v[36:39]
  ds_read_b64_tr_b16 a[214:215], v110 offset:8704
  v_mfma_f32_16x16x32_bf16 v[36:39], a[192:195], a[184:187], v[36:39]
  s_waitcnt lgkmcnt(4)
  v_mfma_f32_16x16x32_bf16 a[92:95], a[200:203], a[184:187], a[92:95]
  ds_read_b64_tr_b16 a[216:217], v110 offset:2048
  v_mfma_f32_16x16x32_bf16 a[92:95], a[204:207], a[188:191], a[92:95]
  buffer_load_dwordx4 a[144:147], v102, s[32:35], s42 offen offset:0 sc1
  v_mfma_f32_16x16x32_bf16 a[84:87], a[204:207], a[180:183], a[84:87]
  ds_read_b64_tr_b16 a[218:219], v110 offset:2560
  v_mfma_f32_16x16x32_bf16 a[84:87], a[200:203], a[176:179], a[84:87]
  v_mfma_f32_16x16x32_bf16 a[76:79], a[200:203], a[168:171], a[76:79]
  ds_read_b64_tr_b16 a[220:221], v110 offset:10240
  v_mfma_f32_16x16x32_bf16 a[76:79], a[204:207], a[172:175], a[76:79]
  buffer_load_dwordx4 a[148:151], v102, s[32:35], s42 offen offset:256 sc1
  v_mfma_f32_16x16x32_bf16 a[68:71], a[204:207], a[164:167], a[68:71]
  ds_read_b64_tr_b16 a[222:223], v110 offset:10752
  v_mfma_f32_16x16x32_bf16 a[68:71], a[200:203], a[160:163], a[68:71]
  s_waitcnt lgkmcnt(4)
  v_mfma_f32_16x16x32_bf16 v[40:43], a[208:211], a[160:163], v[40:43]
  ds_read_b64_tr_b16 a[192:193], v107 offset:49152
  v_mfma_f32_16x16x32_bf16 v[40:43], a[212:215], a[164:167], v[40:43]
  buffer_load_dwordx4 a[152:155], v103, s[32:35], s42 offen offset:0 sc1
  v_mfma_f32_16x16x32_bf16 v[48:51], a[212:215], a[172:175], v[48:51]
  ds_read_b64_tr_b16 a[194:195], v107 offset:50176
  v_mfma_f32_16x16x32_bf16 v[48:51], a[208:211], a[168:171], v[48:51]
  v_mfma_f32_16x16x32_bf16 v[56:59], a[208:211], a[176:179], v[56:59]
  ds_read_b64_tr_b16 a[196:197], v107 offset:57344
  v_mfma_f32_16x16x32_bf16 v[56:59], a[212:215], a[180:183], v[56:59]
  buffer_load_dwordx4 a[156:159], v103, s[32:35], s42 offen offset:256 sc1
  v_mfma_f32_16x16x32_bf16 v[64:67], a[212:215], a[188:191], v[64:67]
  ds_read_b64_tr_b16 a[198:199], v107 offset:58368
  v_mfma_f32_16x16x32_bf16 v[64:67], a[208:211], a[184:187], v[64:67]
  s_waitcnt lgkmcnt(4)
  v_mfma_f32_16x16x32_bf16 a[120:123], a[216:219], a[184:187], a[120:123]
  s_add_u32 m0, s18, 16384
  ds_read_b64_tr_b16 a[200:201], v107 offset:49160
  v_mfma_f32_16x16x32_bf16 a[120:123], a[220:223], a[188:191], a[120:123]
  s_add_u32 s40, s40, 429056
  v_mfma_f32_16x16x32_bf16 a[112:115], a[220:223], a[180:183], a[112:115]
  ds_read_b64_tr_b16 a[202:203], v107 offset:50184
  v_mfma_f32_16x16x32_bf16 a[112:115], a[216:219], a[176:179], a[112:115]
  buffer_load_dwordx4 v112, s[20:23], s40 offen offset:0 lds
  v_mfma_f32_16x16x32_bf16 a[104:107], a[216:219], a[168:171], a[104:107]
  ds_read_b64_tr_b16 a[204:205], v107 offset:57352
  v_mfma_f32_16x16x32_bf16 a[104:107], a[220:223], a[172:175], a[104:107]
  s_add_u32 s40, s40, 31744
  v_mfma_f32_16x16x32_bf16 a[96:99], a[220:223], a[164:167], a[96:99]
  ds_read_b64_tr_b16 a[206:207], v107 offset:58376
  v_mfma_f32_16x16x32_bf16 a[96:99], a[216:219], a[160:163], a[96:99]
  s_waitcnt lgkmcnt(4)
  buffer_load_dwordx4 v112, s[20:23], s40 offen offset:1024 lds
  v_mfma_f32_16x16x32_bf16 v[224:227], a[192:195], a[160:163], v[224:227]
  ds_read_b64_tr_b16 a[208:209], v106 offset:49152
  v_mfma_f32_16x16x32_bf16 v[224:227], a[196:199], a[164:167], v[224:227]
  s_add_u32 s40, s40, 31744
  v_mfma_f32_16x16x32_bf16 v[232:235], a[196:199], a[172:175], v[232:235]
  ds_read_b64_tr_b16 a[210:211], v106 offset:50176
  v_mfma_f32_16x16x32_bf16 v[232:235], a[192:195], a[168:171], v[232:235]
  buffer_load_dwordx4 v112, s[20:23], s40 offen offset:2048 lds
  v_mfma_f32_16x16x32_bf16 v[240:243], a[192:195], a[176:179], v[240:243]
  ds_read_b64_tr_b16 a[212:213], v106 offset:57344
  v_mfma_f32_16x16x32_bf16 v[240:243], a[196:199], a[180:183], v[240:243]
  v_mfma_f32_16x16x32_bf16 v[248:251], a[196:199], a[188:191], v[248:251]
  ds_read_b64_tr_b16 a[214:215], v106 offset:58368
  v_mfma_f32_16x16x32_bf16 v[248:251], a[192:195], a[184:187], v[248:251]
  s_waitcnt lgkmcnt(4)
  v_mfma_f32_16x16x32_bf16 v[252:255], a[200:203], a[184:187], v[252:255]
  ds_read_b64_tr_b16 a[216:217], v106 offset:49160
  v_mfma_f32_16x16x32_bf16 v[252:255], a[204:207], a[188:191], v[252:255]
  buffer_store_dwordx4 a[32:35], v3, s[32:35], s86 offen offset:0 sc1
  v_mfma_f32_16x16x32_bf16 v[244:247], a[204:207], a[180:183], v[244:247]
  ds_read_b64_tr_b16 a[218:219], v106 offset:50184
  v_mfma_f32_16x16x32_bf16 v[244:247], a[200:203], a[176:179], v[244:247]
  v_mfma_f32_16x16x32_bf16 v[236:239], a[200:203], a[168:171], v[236:239]
  ds_read_b64_tr_b16 a[220:221], v106 offset:57352
  v_mfma_f32_16x16x32_bf16 v[236:239], a[204:207], a[172:175], v[236:239]
  v_mfma_f32_16x16x32_bf16 v[228:231], a[204:207], a[164:167], v[228:231]
  ds_read_b64_tr_b16 a[222:223], v106 offset:58376
  v_mfma_f32_16x16x32_bf16 v[228:231], a[200:203], a[160:163], v[228:231]
  s_waitcnt lgkmcnt(4)
  v_mfma_f32_16x16x32_bf16 v[192:195], a[208:211], a[160:163], v[192:195]
  ds_read_b64_tr_b16 a[192:193], v105 offset:49152
  v_mfma_f32_16x16x32_bf16 v[192:195], a[212:215], a[164:167], v[192:195]
  v_mfma_f32_16x16x32_bf16 v[200:203], a[212:215], a[172:175], v[200:203]
  ds_read_b64_tr_b16 a[194:195], v105 offset:50176
  v_mfma_f32_16x16x32_bf16 v[200:203], a[208:211], a[168:171], v[200:203]
  s_add_u32 s40, s40, 31744
  v_mfma_f32_16x16x32_bf16 v[208:211], a[208:211], a[176:179], v[208:211]
  ds_read_b64_tr_b16 a[196:197], v105 offset:57344
  v_mfma_f32_16x16x32_bf16 v[208:211], a[212:215], a[180:183], v[208:211]
  buffer_load_dwordx4 v112, s[20:23], s40 offen offset:3072 lds
  v_mfma_f32_16x16x32_bf16 v[216:219], a[212:215], a[188:191], v[216:219]
  ds_read_b64_tr_b16 a[198:199], v105 offset:58368
  v_mfma_f32_16x16x32_bf16 v[216:219], a[208:211], a[184:187], v[216:219]
  s_waitcnt lgkmcnt(4)
  v_mfma_f32_16x16x32_bf16 v[220:223], a[216:219], a[184:187], v[220:223]
  s_add_u32 m0, s18, 98304
  ds_read_b64_tr_b16 a[200:201], v105 offset:49160
  v_mfma_f32_16x16x32_bf16 v[220:223], a[220:223], a[188:191], v[220:223]
  s_add_u32 s41, s41, 221184
  v_mfma_f32_16x16x32_bf16 v[212:215], a[220:223], a[180:183], v[212:215]
  ds_read_b64_tr_b16 a[202:203], v105 offset:50184
  v_mfma_f32_16x16x32_bf16 v[212:215], a[216:219], a[176:179], v[212:215]
  buffer_load_dwordx4 v113, s[24:27], s41 offen offset:0 lds
  v_mfma_f32_16x16x32_bf16 v[204:207], a[216:219], a[168:171], v[204:207]
  ds_read_b64_tr_b16 a[204:205], v105 offset:57352
  v_mfma_f32_16x16x32_bf16 v[204:207], a[220:223], a[172:175], v[204:207]
  v_mfma_f32_16x16x32_bf16 v[196:199], a[220:223], a[164:167], v[196:199]
  ds_read_b64_tr_b16 a[206:207], v105 offset:58376
  v_mfma_f32_16x16x32_bf16 v[196:199], a[216:219], a[160:163], v[196:199]
  s_waitcnt lgkmcnt(4)
  buffer_store_dwordx4 a[32:35], v3, s[32:35], s86 offen offset:1024 sc1
  v_mfma_f32_16x16x32_bf16 v[160:163], a[192:195], a[160:163], v[160:163]
  ds_read_b64_tr_b16 a[208:209], v104 offset:49152
  v_mfma_f32_16x16x32_bf16 v[160:163], a[196:199], a[164:167], v[160:163]
  v_mfma_f32_16x16x32_bf16 v[168:171], a[196:199], a[172:175], v[168:171]
  ds_read_b64_tr_b16 a[210:211], v104 offset:50176
  v_mfma_f32_16x16x32_bf16 v[168:171], a[192:195], a[168:171], v[168:171]
  v_mfma_f32_16x16x32_bf16 v[176:179], a[192:195], a[176:179], v[176:179]
  ds_read_b64_tr_b16 a[212:213], v104 offset:57344
  v_mfma_f32_16x16x32_bf16 v[176:179], a[196:199], a[180:183], v[176:179]
  v_mfma_f32_16x16x32_bf16 v[184:187], a[196:199], a[188:191], v[184:187]
  ds_read_b64_tr_b16 a[214:215], v104 offset:58368
  v_mfma_f32_16x16x32_bf16 v[184:187], a[192:195], a[184:187], v[184:187]
  s_waitcnt lgkmcnt(4)
  v_mfma_f32_16x16x32_bf16 v[188:191], a[200:203], a[184:187], v[188:191]
  ds_read_b64_tr_b16 a[216:217], v104 offset:49160
  v_mfma_f32_16x16x32_bf16 v[188:191], a[204:207], a[188:191], v[188:191]
  v_mfma_f32_16x16x32_bf16 v[180:183], a[204:207], a[180:183], v[180:183]
  ds_read_b64_tr_b16 a[218:219], v104 offset:50184
  v_mfma_f32_16x16x32_bf16 v[180:183], a[200:203], a[176:179], v[180:183]
  v_mfma_f32_16x16x32_bf16 v[172:175], a[200:203], a[168:171], v[172:175]
  ds_read_b64_tr_b16 a[220:221], v104 offset:57352
  v_mfma_f32_16x16x32_bf16 v[172:175], a[204:207], a[172:175], v[172:175]
  buffer_load_dwordx4 v114, s[24:27], s41 offen offset:1024 lds
  v_mfma_f32_16x16x32_bf16 v[164:167], a[204:207], a[164:167], v[164:167]
  ds_read_b64_tr_b16 a[222:223], v104 offset:58376
  v_mfma_f32_16x16x32_bf16 v[164:167], a[200:203], a[160:163], v[164:167]
  s_waitcnt lgkmcnt(4)
  s_add_u32 m0, s18, 100352
  s_waitcnt vmcnt(16)
  s_barrier
  v_mfma_f32_16x16x32_bf16 v[128:131], a[208:211], a[160:163], v[128:131]
  ds_read_b64_tr_b16 a[192:193], v108 offset:49152
  v_mfma_f32_16x16x32_bf16 v[128:131], a[212:215], a[164:167], v[128:131]
  buffer_load_dwordx4 v113, s[28:31], s41 offen offset:0 lds
  v_mfma_f32_16x16x32_bf16 v[136:139], a[212:215], a[172:175], v[136:139]
  ds_read_b64_tr_b16 a[194:195], v108 offset:49664
  v_mfma_f32_16x16x32_bf16 v[136:139], a[208:211], a[168:171], v[136:139]
  v_mfma_f32_16x16x32_bf16 v[144:147], a[208:211], a[176:179], v[144:147]
  ds_read_b64_tr_b16 a[196:197], v108 offset:57344
  v_mfma_f32_16x16x32_bf16 v[144:147], a[212:215], a[180:183], v[144:147]
  buffer_load_dwordx4 v114, s[28:31], s41 offen offset:1024 lds
  v_mfma_f32_16x16x32_bf16 v[152:155], a[212:215], a[188:191], v[152:155]
  ds_read_b64_tr_b16 a[198:199], v108 offset:57856
  v_mfma_f32_16x16x32_bf16 v[152:155], a[208:211], a[184:187], v[152:155]
  s_waitcnt lgkmcnt(4)
  v_mfma_f32_16x16x32_bf16 v[156:159], a[216:219], a[184:187], v[156:159]
  ds_read_b64_tr_b16 a[200:201], v108 offset:51200
  v_mfma_f32_16x16x32_bf16 v[156:159], a[220:223], a[188:191], v[156:159]
  v_mfma_f32_16x16x32_bf16 v[148:151], a[220:223], a[180:183], v[148:151]
  ds_read_b64_tr_b16 a[202:203], v108 offset:51712
  v_mfma_f32_16x16x32_bf16 v[148:151], a[216:219], a[176:179], v[148:151]
  v_mfma_f32_16x16x32_bf16 v[140:143], a[216:219], a[168:171], v[140:143]
  ds_read_b64_tr_b16 a[204:205], v108 offset:59392
  v_mfma_f32_16x16x32_bf16 v[140:143], a[220:223], a[172:175], v[140:143]
  s_waitcnt vmcnt(10)
  v_mfma_f32_16x16x32_bf16 v[132:135], a[220:223], a[164:167], v[132:135]
  ds_read_b64_tr_b16 a[206:207], v108 offset:59904
  v_mfma_f32_16x16x32_bf16 v[132:135], a[216:219], a[160:163], v[132:135]
  s_waitcnt lgkmcnt(4)
  v_mfma_f32_16x16x32_bf16 v[8:11], a[192:195], a[128:131], v[8:11]
  ds_read_b64_tr_b16 a[208:209], v109 offset:49152
  v_mfma_f32_16x16x32_bf16 v[8:11], a[196:199], a[132:135], v[8:11]
  v_mfma_f32_16x16x32_bf16 v[16:19], a[196:199], a[140:143], v[16:19]
  ds_read_b64_tr_b16 a[210:211], v109 offset:49664
  v_mfma_f32_16x16x32_bf16 v[16:19], a[192:195], a[136:139], v[16:19]
  v_mfma_f32_16x16x32_bf16 v[24:27], a[192:195], a[144:147], v[24:27]
  ds_read_b64_tr_b16 a[212:213], v109 offset:57344
  v_mfma_f32_16x16x32_bf16 v[24:27], a[196:199], a[148:151], v[24:27]
  s_add_u32 s42, s42, 512
  v_mfma_f32_16x16x32_bf16 v[32:35], a[196:199], a[156:159], v[32:35]
  ds_read_b64_tr_b16 a[214:215], v109 offset:57856
  v_mfma_f32_16x16x32_bf16 v[32:35], a[192:195], a[152:155], v[32:35]
  s_waitcnt lgkmcnt(4)
  buffer_load_dwordx4 a[160:163], v100, s[32:35], s42 offen offset:0 sc1
  v_mfma_f32_16x16x32_bf16 a[88:91], a[200:203], a[152:155], a[88:91]
  ds_read_b64_tr_b16 a[216:217], v109 offset:51200
  v_mfma_f32_16x16x32_bf16 a[88:91], a[204:207], a[156:159], a[88:91]
  v_mfma_f32_16x16x32_bf16 a[80:83], a[204:207], a[148:151], a[80:83]
  ds_read_b64_tr_b16 a[218:219], v109 offset:51712
  v_mfma_f32_16x16x32_bf16 a[80:83], a[200:203], a[144:147], a[80:83]
  buffer_load_dwordx4 a[164:167], v100, s[32:35], s42 offen offset:256 sc1
  v_mfma_f32_16x16x32_bf16 a[72:75], a[200:203], a[136:139], a[72:75]
  ds_read_b64_tr_b16 a[220:221], v109 offset:59392
  v_mfma_f32_16x16x32_bf16 a[72:75], a[204:207], a[140:143], a[72:75]
  v_mfma_f32_16x16x32_bf16 a[64:67], a[204:207], a[132:135], a[64:67]
  ds_read_b64_tr_b16 a[222:223], v109 offset:59904
  v_mfma_f32_16x16x32_bf16 a[64:67], a[200:203], a[128:131], a[64:67]
  s_waitcnt lgkmcnt(4)
  buffer_load_dwordx4 a[168:171], v101, s[32:35], s42 offen offset:0 sc1
  v_mfma_f32_16x16x32_bf16 v[12:15], a[208:211], a[128:131], v[12:15]
  ds_read_b64_tr_b16 a[192:193], v110 offset:49152
  v_mfma_f32_16x16x32_bf16 v[12:15], a[212:215], a[132:135], v[12:15]
  v_mfma_f32_16x16x32_bf16 v[20:23], a[212:215], a[140:143], v[20:23]
  ds_read_b64_tr_b16 a[194:195], v110 offset:49664
  v_mfma_f32_16x16x32_bf16 v[20:23], a[208:211], a[136:139], v[20:23]
  buffer_load_dwordx4 a[172:175], v101, s[32:35], s42 offen offset:256 sc1
  v_mfma_f32_16x16x32_bf16 v[28:31], a[208:211], a[144:147], v[28:31]
  ds_read_b64_tr_b16 a[196:197], v110 offset:57344
  v_mfma_f32_16x16x32_bf16 v[28:31], a[212:215], a[148:151], v[28:31]
  v_mfma_f32_16x16x32_bf16 v[36:39], a[212:215], a[156:159], v[36:39]
  ds_read_b64_tr_b16 a[198:199], v110 offset:57856
  v_mfma_f32_16x16x32_bf16 v[36:39], a[208:211], a[152:155], v[36:39]
  s_waitcnt lgkmcnt(4)
  v_mfma_f32_16x16x32_bf16 a[92:95], a[216:219], a[152:155], a[92:95]
  ds_read_b64_tr_b16 a[200:201], v110 offset:51200
  v_mfma_f32_16x16x32_bf16 a[92:95], a[220:223], a[156:159], a[92:95]
  buffer_load_dwordx4 a[176:179], v102, s[32:35], s42 offen offset:0 sc1
  v_mfma_f32_16x16x32_bf16 a[84:87], a[220:223], a[148:151], a[84:87]
  ds_read_b64_tr_b16 a[202:203], v110 offset:51712
  v_mfma_f32_16x16x32_bf16 a[84:87], a[216:219], a[144:147], a[84:87]
  v_mfma_f32_16x16x32_bf16 a[76:79], a[216:219], a[136:139], a[76:79]
  ds_read_b64_tr_b16 a[204:205], v110 offset:59392
  v_mfma_f32_16x16x32_bf16 a[76:79], a[220:223], a[140:143], a[76:79]
  buffer_load_dwordx4 a[180:183], v102, s[32:35], s42 offen offset:256 sc1
  v_mfma_f32_16x16x32_bf16 a[68:71], a[220:223], a[132:135], a[68:71]
  ds_read_b64_tr_b16 a[206:207], v110 offset:59904
  v_mfma_f32_16x16x32_bf16 a[68:71], a[216:219], a[128:131], a[68:71]
  s_waitcnt lgkmcnt(4)
  v_mfma_f32_16x16x32_bf16 v[40:43], a[192:195], a[128:131], v[40:43]
  ds_read_b64_tr_b16 a[208:209], v107 offset:0
  v_mfma_f32_16x16x32_bf16 v[40:43], a[196:199], a[132:135], v[40:43]
  buffer_load_dwordx4 a[184:187], v103, s[32:35], s42 offen offset:0 sc1
  v_mfma_f32_16x16x32_bf16 v[48:51], a[196:199], a[140:143], v[48:51]
  ds_read_b64_tr_b16 a[210:211], v107 offset:1024
  v_mfma_f32_16x16x32_bf16 v[48:51], a[192:195], a[136:139], v[48:51]
  v_mfma_f32_16x16x32_bf16 v[56:59], a[192:195], a[144:147], v[56:59]
  ds_read_b64_tr_b16 a[212:213], v107 offset:8192
  v_mfma_f32_16x16x32_bf16 v[56:59], a[196:199], a[148:151], v[56:59]
  buffer_load_dwordx4 a[188:191], v103, s[32:35], s42 offen offset:256 sc1
  v_mfma_f32_16x16x32_bf16 v[64:67], a[196:199], a[156:159], v[64:67]
  ds_read_b64_tr_b16 a[214:215], v107 offset:9216
  v_mfma_f32_16x16x32_bf16 v[64:67], a[192:195], a[152:155], v[64:67]
  s_waitcnt lgkmcnt(4)
  v_mfma_f32_16x16x32_bf16 a[120:123], a[200:203], a[152:155], a[120:123]
  s_add_u32 m0, s18, 32768
  ds_read_b64_tr_b16 a[216:217], v107 offset:8
  v_mfma_f32_16x16x32_bf16 a[120:123], a[204:207], a[156:159], a[120:123]
  s_add_u32 s40, s40, 429056
  v_mfma_f32_16x16x32_bf16 a[112:115], a[204:207], a[148:151], a[112:115]
  ds_read_b64_tr_b16 a[218:219], v107 offset:1032
  v_mfma_f32_16x16x32_bf16 a[112:115], a[200:203], a[144:147], a[112:115]
  buffer_load_dwordx4 v112, s[20:23], s40 offen offset:0 lds
  v_mfma_f32_16x16x32_bf16 a[104:107], a[200:203], a[136:139], a[104:107]
  ds_read_b64_tr_b16 a[220:221], v107 offset:8200
  v_mfma_f32_16x16x32_bf16 a[104:107], a[204:207], a[140:143], a[104:107]
  s_add_u32 s40, s40, 31744
  v_mfma_f32_16x16x32_bf16 a[96:99], a[204:207], a[132:135], a[96:99]
  ds_read_b64_tr_b16 a[222:223], v107 offset:9224
  v_mfma_f32_16x16x32_bf16 a[96:99], a[200:203], a[128:131], a[96:99]
  s_waitcnt lgkmcnt(4)
  buffer_load_dwordx4 v112, s[20:23], s40 offen offset:1024 lds
  v_mfma_f32_16x16x32_bf16 v[224:227], a[208:211], a[128:131], v[224:227]
  ds_read_b64_tr_b16 a[192:193], v106 offset:0
  v_mfma_f32_16x16x32_bf16 v[224:227], a[212:215], a[132:135], v[224:227]
  s_add_u32 s40, s40, 31744
  v_mfma_f32_16x16x32_bf16 v[232:235], a[212:215], a[140:143], v[232:235]
  ds_read_b64_tr_b16 a[194:195], v106 offset:1024
  v_mfma_f32_16x16x32_bf16 v[232:235], a[208:211], a[136:139], v[232:235]
  buffer_load_dwordx4 v112, s[20:23], s40 offen offset:2048 lds
  v_mfma_f32_16x16x32_bf16 v[240:243], a[208:211], a[144:147], v[240:243]
  ds_read_b64_tr_b16 a[196:197], v106 offset:8192
  v_mfma_f32_16x16x32_bf16 v[240:243], a[212:215], a[148:151], v[240:243]
  v_mfma_f32_16x16x32_bf16 v[248:251], a[212:215], a[156:159], v[248:251]
  ds_read_b64_tr_b16 a[198:199], v106 offset:9216
  v_mfma_f32_16x16x32_bf16 v[248:251], a[208:211], a[152:155], v[248:251]
  s_waitcnt lgkmcnt(4)
  v_mfma_f32_16x16x32_bf16 v[252:255], a[216:219], a[152:155], v[252:255]
  ds_read_b64_tr_b16 a[200:201], v106 offset:8
  v_mfma_f32_16x16x32_bf16 v[252:255], a[220:223], a[156:159], v[252:255]
  buffer_store_dwordx4 a[32:35], v3, s[32:35], s86 offen offset:2048 sc1
  v_mfma_f32_16x16x32_bf16 v[244:247], a[220:223], a[148:151], v[244:247]
  ds_read_b64_tr_b16 a[202:203], v106 offset:1032
  v_mfma_f32_16x16x32_bf16 v[244:247], a[216:219], a[144:147], v[244:247]
  v_mfma_f32_16x16x32_bf16 v[236:239], a[216:219], a[136:139], v[236:239]
  ds_read_b64_tr_b16 a[204:205], v106 offset:8200
  v_mfma_f32_16x16x32_bf16 v[236:239], a[220:223], a[140:143], v[236:239]
  v_mfma_f32_16x16x32_bf16 v[228:231], a[220:223], a[132:135], v[228:231]
  ds_read_b64_tr_b16 a[206:207], v106 offset:9224
  v_mfma_f32_16x16x32_bf16 v[228:231], a[216:219], a[128:131], v[228:231]
  s_waitcnt lgkmcnt(4)
  v_mfma_f32_16x16x32_bf16 v[192:195], a[192:195], a[128:131], v[192:195]
  ds_read_b64_tr_b16 a[208:209], v105 offset:0
  v_mfma_f32_16x16x32_bf16 v[192:195], a[196:199], a[132:135], v[192:195]
  v_mfma_f32_16x16x32_bf16 v[200:203], a[196:199], a[140:143], v[200:203]
  ds_read_b64_tr_b16 a[210:211], v105 offset:1024
  v_mfma_f32_16x16x32_bf16 v[200:203], a[192:195], a[136:139], v[200:203]
  s_add_u32 s40, s40, 31744
  v_mfma_f32_16x16x32_bf16 v[208:211], a[192:195], a[144:147], v[208:211]
  ds_read_b64_tr_b16 a[212:213], v105 offset:8192
  v_mfma_f32_16x16x32_bf16 v[208:211], a[196:199], a[148:151], v[208:211]
  buffer_load_dwordx4 v112, s[20:23], s40 offen offset:3072 lds
  v_mfma_f32_16x16x32_bf16 v[216:219], a[196:199], a[156:159], v[216:219]
  ds_read_b64_tr_b16 a[214:215], v105 offset:9216
  v_mfma_f32_16x16x32_bf16 v[216:219], a[192:195], a[152:155], v[216:219]
  s_waitcnt lgkmcnt(4)
  v_mfma_f32_16x16x32_bf16 v[220:223], a[200:203], a[152:155], v[220:223]
  s_add_u32 m0, s18, 81920
  ds_read_b64_tr_b16 a[216:217], v105 offset:8
  v_mfma_f32_16x16x32_bf16 v[220:223], a[204:207], a[156:159], v[220:223]
  s_add_u32 s41, s41, 221184
  v_mfma_f32_16x16x32_bf16 v[212:215], a[204:207], a[148:151], v[212:215]
  ds_read_b64_tr_b16 a[218:219], v105 offset:1032
  v_mfma_f32_16x16x32_bf16 v[212:215], a[200:203], a[144:147], v[212:215]
  buffer_load_dwordx4 v113, s[24:27], s41 offen offset:0 lds
  v_mfma_f32_16x16x32_bf16 v[204:207], a[200:203], a[136:139], v[204:207]
  ds_read_b64_tr_b16 a[220:221], v105 offset:8200
  v_mfma_f32_16x16x32_bf16 v[204:207], a[204:207], a[140:143], v[204:207]
  v_mfma_f32_16x16x32_bf16 v[196:199], a[204:207], a[132:135], v[196:199]
  ds_read_b64_tr_b16 a[222:223], v105 offset:9224
  v_mfma_f32_16x16x32_bf16 v[196:199], a[200:203], a[128:131], v[196:199]
  s_waitcnt lgkmcnt(4)
  buffer_store_dwordx4 a[32:35], v3, s[32:35], s86 offen offset:3072 sc1
  v_mfma_f32_16x16x32_bf16 v[160:163], a[208:211], a[128:131], v[160:163]
  ds_read_b64_tr_b16 a[192:193], v104 offset:0
  v_mfma_f32_16x16x32_bf16 v[160:163], a[212:215], a[132:135], v[160:163]
  v_mfma_f32_16x16x32_bf16 v[168:171], a[212:215], a[140:143], v[168:171]
  ds_read_b64_tr_b16 a[194:195], v104 offset:1024
  v_mfma_f32_16x16x32_bf16 v[168:171], a[208:211], a[136:139], v[168:171]
  v_mfma_f32_16x16x32_bf16 v[176:179], a[208:211], a[144:147], v[176:179]
  ds_read_b64_tr_b16 a[196:197], v104 offset:8192
  v_mfma_f32_16x16x32_bf16 v[176:179], a[212:215], a[148:151], v[176:179]
  v_mfma_f32_16x16x32_bf16 v[184:187], a[212:215], a[156:159], v[184:187]
  ds_read_b64_tr_b16 a[198:199], v104 offset:9216
  v_mfma_f32_16x16x32_bf16 v[184:187], a[208:211], a[152:155], v[184:187]
  s_waitcnt lgkmcnt(4)
  v_mfma_f32_16x16x32_bf16 v[188:191], a[216:219], a[152:155], v[188:191]
  ds_read_b64_tr_b16 a[200:201], v104 offset:8
  v_mfma_f32_16x16x32_bf16 v[188:191], a[220:223], a[156:159], v[188:191]
  v_mfma_f32_16x16x32_bf16 v[180:183], a[220:223], a[148:151], v[180:183]
  ds_read_b64_tr_b16 a[202:203], v104 offset:1032
  v_mfma_f32_16x16x32_bf16 v[180:183], a[216:219], a[144:147], v[180:183]
  v_mfma_f32_16x16x32_bf16 v[172:175], a[216:219], a[136:139], v[172:175]
  ds_read_b64_tr_b16 a[204:205], v104 offset:8200
  v_mfma_f32_16x16x32_bf16 v[172:175], a[220:223], a[140:143], v[172:175]
  buffer_load_dwordx4 v114, s[24:27], s41 offen offset:1024 lds
  v_mfma_f32_16x16x32_bf16 v[164:167], a[220:223], a[132:135], v[164:167]
  ds_read_b64_tr_b16 a[206:207], v104 offset:9224
  v_mfma_f32_16x16x32_bf16 v[164:167], a[216:219], a[128:131], v[164:167]
  s_waitcnt lgkmcnt(4)
  s_add_u32 m0, s18, 83968
  s_waitcnt vmcnt(16)
  s_barrier
  v_mfma_f32_16x16x32_bf16 v[128:131], a[192:195], a[128:131], v[128:131]
  ds_read_b64_tr_b16 a[208:209], v108 offset:32768
  v_mfma_f32_16x16x32_bf16 v[128:131], a[196:199], a[132:135], v[128:131]
  buffer_load_dwordx4 v113, s[28:31], s41 offen offset:0 lds
  v_mfma_f32_16x16x32_bf16 v[136:139], a[196:199], a[140:143], v[136:139]
  ds_read_b64_tr_b16 a[210:211], v108 offset:33280
  v_mfma_f32_16x16x32_bf16 v[136:139], a[192:195], a[136:139], v[136:139]
  v_mfma_f32_16x16x32_bf16 v[144:147], a[192:195], a[144:147], v[144:147]
  ds_read_b64_tr_b16 a[212:213], v108 offset:40960
  v_mfma_f32_16x16x32_bf16 v[144:147], a[196:199], a[148:151], v[144:147]
  buffer_load_dwordx4 v114, s[28:31], s41 offen offset:1024 lds
  v_mfma_f32_16x16x32_bf16 v[152:155], a[196:199], a[156:159], v[152:155]
  ds_read_b64_tr_b16 a[214:215], v108 offset:41472
  v_mfma_f32_16x16x32_bf16 v[152:155], a[192:195], a[152:155], v[152:155]
  s_waitcnt lgkmcnt(4)
  v_mfma_f32_16x16x32_bf16 v[156:159], a[200:203], a[152:155], v[156:159]
  ds_read_b64_tr_b16 a[216:217], v108 offset:34816
  v_mfma_f32_16x16x32_bf16 v[156:159], a[204:207], a[156:159], v[156:159]
  v_mfma_f32_16x16x32_bf16 v[148:151], a[204:207], a[148:151], v[148:151]
  ds_read_b64_tr_b16 a[218:219], v108 offset:35328
  v_mfma_f32_16x16x32_bf16 v[148:151], a[200:203], a[144:147], v[148:151]
  v_mfma_f32_16x16x32_bf16 v[140:143], a[200:203], a[136:139], v[140:143]
  ds_read_b64_tr_b16 a[220:221], v108 offset:43008
  v_mfma_f32_16x16x32_bf16 v[140:143], a[204:207], a[140:143], v[140:143]
  s_waitcnt vmcnt(10)
  v_mfma_f32_16x16x32_bf16 v[132:135], a[204:207], a[132:135], v[132:135]
  ds_read_b64_tr_b16 a[222:223], v108 offset:43520
  v_mfma_f32_16x16x32_bf16 v[132:135], a[200:203], a[128:131], v[132:135]
  s_waitcnt lgkmcnt(4)
  v_mfma_f32_16x16x32_bf16 v[8:11], a[208:211], a[160:163], v[8:11]
  ds_read_b64_tr_b16 a[192:193], v109 offset:32768
  v_mfma_f32_16x16x32_bf16 v[8:11], a[212:215], a[164:167], v[8:11]
L_pp7_6:
  v_add_co_u32 v74, vcc, L_fm-L_post1, v126
  v_mfma_f32_16x16x32_bf16 v[16:19], a[212:215], a[172:175], v[16:19]
  ds_read_b64_tr_b16 a[194:195], v109 offset:33280
  v_mfma_f32_16x16x32_bf16 v[16:19], a[208:211], a[168:171], v[16:19]
  v_addc_co_u32 v75, vcc, -1, v127, vcc
  v_mfma_f32_16x16x32_bf16 v[24:27], a[208:211], a[176:179], v[24:27]
  ds_read_b64_tr_b16 a[196:197], v109 offset:40960
  v_mfma_f32_16x16x32_bf16 v[24:27], a[212:215], a[180:183], v[24:27]
  s_add_u32 s42, s42, 512
  v_mfma_f32_16x16x32_bf16 v[32:35], a[212:215], a[188:191], v[32:35]
  ds_read_b64_tr_b16 a[198:199], v109 offset:41472
  v_mfma_f32_16x16x32_bf16 v[32:35], a[208:211], a[184:187], v[32:35]
  s_waitcnt lgkmcnt(4)
  buffer_load_dwordx4 a[128:131], v100, s[32:35], s42 offen offset:0 sc1
  v_mfma_f32_16x16x32_bf16 a[88:91], a[216:219], a[184:187], a[88:91]
  ds_read_b64_tr_b16 a[200:201], v109 offset:34816
  v_mfma_f32_16x16x32_bf16 a[88:91], a[220:223], a[188:191], a[88:91]
  v_mfma_f32_16x16x32_bf16 a[80:83], a[220:223], a[180:183], a[80:83]
  ds_read_b64_tr_b16 a[202:203], v109 offset:35328
  v_mfma_f32_16x16x32_bf16 a[80:83], a[216:219], a[176:179], a[80:83]
  buffer_load_dwordx4 a[132:135], v100, s[32:35], s42 offen offset:256 sc1
  v_mfma_f32_16x16x32_bf16 a[72:75], a[216:219], a[168:171], a[72:75]
  ds_read_b64_tr_b16 a[204:205], v109 offset:43008
  v_mfma_f32_16x16x32_bf16 a[72:75], a[220:223], a[172:175], a[72:75]
  v_mfma_f32_16x16x32_bf16 a[64:67], a[220:223], a[164:167], a[64:67]
  ds_read_b64_tr_b16 a[206:207], v109 offset:43520
  v_mfma_f32_16x16x32_bf16 a[64:67], a[216:219], a[160:163], a[64:67]
  s_waitcnt lgkmcnt(4)
  buffer_load_dwordx4 a[136:139], v101, s[32:35], s42 offen offset:0 sc1
  v_mfma_f32_16x16x32_bf16 v[12:15], a[192:195], a[160:163], v[12:15]
  ds_read_b64_tr_b16 a[208:209], v110 offset:32768
  v_mfma_f32_16x16x32_bf16 v[12:15], a[196:199], a[164:167], v[12:15]
  v_mfma_f32_16x16x32_bf16 v[20:23], a[196:199], a[172:175], v[20:23]
  ds_read_b64_tr_b16 a[210:211], v110 offset:33280
  v_mfma_f32_16x16x32_bf16 v[20:23], a[192:195], a[168:171], v[20:23]
  buffer_load_dwordx4 a[140:143], v101, s[32:35], s42 offen offset:256 sc1
  v_mfma_f32_16x16x32_bf16 v[28:31], a[192:195], a[176:179], v[28:31]
  ds_read_b64_tr_b16 a[212:213], v110 offset:40960
  v_mfma_f32_16x16x32_bf16 v[28:31], a[196:199], a[180:183], v[28:31]
  v_mfma_f32_16x16x32_bf16 v[36:39], a[196:199], a[188:191], v[36:39]
  ds_read_b64_tr_b16 a[214:215], v110 offset:41472
  v_mfma_f32_16x16x32_bf16 v[36:39], a[192:195], a[184:187], v[36:39]
  s_waitcnt lgkmcnt(4)
  buffer_load_dwordx4 a[144:147], v102, s[32:35], s42 offen offset:0 sc1
  v_mfma_f32_16x16x32_bf16 a[92:95], a[200:203], a[184:187], a[92:95]
  ds_read_b64_tr_b16 a[216:217], v110 offset:34816
  v_mfma_f32_16x16x32_bf16 a[92:95], a[204:207], a[188:191], a[92:95]
  v_mfma_f32_16x16x32_bf16 a[84:87], a[204:207], a[180:183], a[84:87]
  ds_read_b64_tr_b16 a[218:219], v110 offset:35328
  v_mfma_f32_16x16x32_bf16 a[84:87], a[200:203], a[176:179], a[84:87]
  buffer_load_dwordx4 a[148:151], v102, s[32:35], s42 offen offset:256 sc1
  v_mfma_f32_16x16x32_bf16 a[76:79], a[200:203], a[168:171], a[76:79]
  ds_read_b64_tr_b16 a[220:221], v110 offset:43008
  v_mfma_f32_16x16x32_bf16 a[76:79], a[204:207], a[172:175], a[76:79]
  v_mfma_f32_16x16x32_bf16 a[68:71], a[204:207], a[164:167], a[68:71]
  ds_read_b64_tr_b16 a[222:223], v110 offset:43520
  v_mfma_f32_16x16x32_bf16 a[68:71], a[200:203], a[160:163], a[68:71]
  s_waitcnt lgkmcnt(4)
  v_mfma_f32_16x16x32_bf16 v[40:43], a[208:211], a[160:163], v[40:43]
  ds_read_b64_tr_b16 a[192:193], v107 offset:16384
  v_mfma_f32_16x16x32_bf16 v[40:43], a[212:215], a[164:167], v[40:43]
  buffer_load_dwordx4 a[152:155], v103, s[32:35], s42 offen offset:0 sc1
  v_mfma_f32_16x16x32_bf16 v[48:51], a[212:215], a[172:175], v[48:51]
  ds_read_b64_tr_b16 a[194:195], v107 offset:17408
  v_mfma_f32_16x16x32_bf16 v[48:51], a[208:211], a[168:171], v[48:51]
  v_mfma_f32_16x16x32_bf16 v[56:59], a[208:211], a[176:179], v[56:59]
  ds_read_b64_tr_b16 a[196:197], v107 offset:24576
  v_mfma_f32_16x16x32_bf16 v[56:59], a[212:215], a[180:183], v[56:59]
  buffer_load_dwordx4 a[156:159], v103, s[32:35], s42 offen offset:256 sc1
  v_mfma_f32_16x16x32_bf16 v[64:67], a[212:215], a[188:191], v[64:67]
  s_add_u32 m0, s18, 49152
  ds_read_b64_tr_b16 a[198:199], v107 offset:25600
  v_mfma_f32_16x16x32_bf16 v[64:67], a[208:211], a[184:187], v[64:67]
  s_waitcnt lgkmcnt(4)
  s_add_u32 s40, s40, 429056
  v_mfma_f32_16x16x32_bf16 a[120:123], a[216:219], a[184:187], a[120:123]
  ds_read_b64_tr_b16 a[200:201], v107 offset:16392
  v_mfma_f32_16x16x32_bf16 a[120:123], a[220:223], a[188:191], a[120:123]
  buffer_load_dwordx4 v112, s[20:23], s40 offen offset:0 lds
  v_mfma_f32_16x16x32_bf16 a[112:115], a[220:223], a[180:183], a[112:115]
  ds_read_b64_tr_b16 a[202:203], v107 offset:17416
  v_mfma_f32_16x16x32_bf16 a[112:115], a[216:219], a[176:179], a[112:115]
  s_add_u32 s40, s40, 31744
  v_mfma_f32_16x16x32_bf16 a[104:107], a[216:219], a[168:171], a[104:107]
  ds_read_b64_tr_b16 a[204:205], v107 offset:24584
  v_mfma_f32_16x16x32_bf16 a[104:107], a[220:223], a[172:175], a[104:107]
  buffer_load_dwordx4 v112, s[20:23], s40 offen offset:1024 lds
  v_mfma_f32_16x16x32_bf16 a[96:99], a[220:223], a[164:167], a[96:99]
  ds_read_b64_tr_b16 a[206:207], v107 offset:25608
  v_mfma_f32_16x16x32_bf16 a[96:99], a[216:219], a[160:163], a[96:99]
  s_waitcnt lgkmcnt(4)
  s_add_u32 s40, s40, 31744
  v_mfma_f32_16x16x32_bf16 v[224:227], a[192:195], a[160:163], v[224:227]
  ds_read_b64_tr_b16 a[208:209], v106 offset:16384
  v_mfma_f32_16x16x32_bf16 v[224:227], a[196:199], a[164:167], v[224:227]
  buffer_load_dwordx4 v112, s[20:23], s40 offen offset:2048 lds
  v_mfma_f32_16x16x32_bf16 v[232:235], a[196:199], a[172:175], v[232:235]
  ds_read_b64_tr_b16 a[210:211], v106 offset:17408
  v_mfma_f32_16x16x32_bf16 v[232:235], a[192:195], a[168:171], v[232:235]
  s_add_u32 s86, s86, 4096
  v_mfma_f32_16x16x32_bf16 v[240:243], a[192:195], a[176:179], v[240:243]
  ds_read_b64_tr_b16 a[212:213], v106 offset:24576
  v_mfma_f32_16x16x32_bf16 v[240:243], a[196:199], a[180:183], v[240:243]
  buffer_store_dwordx4 a[32:35], v3, s[32:35], s86 offen offset:0 sc1
  v_mfma_f32_16x16x32_bf16 v[248:251], a[196:199], a[188:191], v[248:251]
  ds_read_b64_tr_b16 a[214:215], v106 offset:25600
  v_mfma_f32_16x16x32_bf16 v[248:251], a[192:195], a[184:187], v[248:251]
  s_waitcnt lgkmcnt(4)
  v_mfma_f32_16x16x32_bf16 v[252:255], a[200:203], a[184:187], v[252:255]
  ds_read_b64_tr_b16 a[216:217], v106 offset:16392
  v_mfma_f32_16x16x32_bf16 v[252:255], a[204:207], a[188:191], v[252:255]
  v_mfma_f32_16x16x32_bf16 v[244:247], a[204:207], a[180:183], v[244:247]
  ds_read_b64_tr_b16 a[218:219], v106 offset:17416
  v_mfma_f32_16x16x32_bf16 v[244:247], a[200:203], a[176:179], v[244:247]
  v_mfma_f32_16x16x32_bf16 v[236:239], a[200:203], a[168:171], v[236:239]
  ds_read_b64_tr_b16 a[220:221], v106 offset:24584
  v_mfma_f32_16x16x32_bf16 v[236:239], a[204:207], a[172:175], v[236:239]
  v_mfma_f32_16x16x32_bf16 v[228:231], a[204:207], a[164:167], v[228:231]
  ds_read_b64_tr_b16 a[222:223], v106 offset:25608
  v_mfma_f32_16x16x32_bf16 v[228:231], a[200:203], a[160:163], v[228:231]
  s_waitcnt lgkmcnt(4)
  v_mfma_f32_16x16x32_bf16 v[192:195], a[208:211], a[160:163], v[192:195]
  ds_read_b64_tr_b16 a[192:193], v105 offset:16384
  v_mfma_f32_16x16x32_bf16 v[192:195], a[212:215], a[164:167], v[192:195]
  s_add_u32 s40, s40, 31744
  v_mfma_f32_16x16x32_bf16 v[200:203], a[212:215], a[172:175], v[200:203]
L_pad_proj12_4:
  s_cbranch_execz L_pad_proj12_5
  ds_read_b64_tr_b16 a[194:195], v105 offset:17408
  v_mfma_f32_16x16x32_bf16 v[200:203], a[208:211], a[168:171], v[200:203]
  buffer_load_dwordx4 v112, s[20:23], s40 offen offset:3072 lds
  v_mfma_f32_16x16x32_bf16 v[208:211], a[208:211], a[176:179], v[208:211]
  s_add_u32 m0, s18, 65536
  ds_read_b64_tr_b16 a[196:197], v105 offset:24576
  v_mfma_f32_16x16x32_bf16 v[208:211], a[212:215], a[180:183], v[208:211]
  s_add_u32 s41, s41, 221184
  v_mfma_f32_16x16x32_bf16 v[216:219], a[212:215], a[188:191], v[216:219]
  ds_read_b64_tr_b16 a[198:199], v105 offset:25600
  v_mfma_f32_16x16x32_bf16 v[216:219], a[208:211], a[184:187], v[216:219]
  s_waitcnt lgkmcnt(4)
  buffer_load_dwordx4 v113, s[24:27], s41 offen offset:0 lds
  v_mfma_f32_16x16x32_bf16 v[220:223], a[216:219], a[184:187], v[220:223]
  ds_read_b64_tr_b16 a[200:201], v105 offset:16392
  v_mfma_f32_16x16x32_bf16 v[220:223], a[220:223], a[188:191], v[220:223]
  v_mfma_f32_16x16x32_bf16 v[212:215], a[220:223], a[180:183], v[212:215]
  ds_read_b64_tr_b16 a[202:203], v105 offset:17416
  v_mfma_f32_16x16x32_bf16 v[212:215], a[216:219], a[176:179], v[212:215]
  buffer_load_dwordx4 v114, s[24:27], s41 offen offset:1024 lds
  v_mfma_f32_16x16x32_bf16 v[204:207], a[216:219], a[168:171], v[204:207]
  ds_read_b64_tr_b16 a[204:205], v105 offset:24584
  v_mfma_f32_16x16x32_bf16 v[204:207], a[220:223], a[172:175], v[204:207]
  v_mfma_f32_16x16x32_bf16 v[196:199], a[220:223], a[164:167], v[196:199]
  ds_read_b64_tr_b16 a[206:207], v105 offset:25608
  v_mfma_f32_16x16x32_bf16 v[196:199], a[216:219], a[160:163], v[196:199]
  s_waitcnt lgkmcnt(4)
  buffer_store_dwordx4 a[32:35], v3, s[32:35], s86 offen offset:1024 sc1
  v_mfma_f32_16x16x32_bf16 v[160:163], a[192:195], a[160:163], v[160:163]
  ds_read_b64_tr_b16 a[208:209], v104 offset:16384
  v_mfma_f32_16x16x32_bf16 v[160:163], a[196:199], a[164:167], v[160:163]
  v_mfma_f32_16x16x32_bf16 v[168:171], a[196:199], a[172:175], v[168:171]
  ds_read_b64_tr_b16 a[210:211], v104 offset:17408
  v_mfma_f32_16x16x32_bf16 v[168:171], a[192:195], a[168:171], v[168:171]
  v_mfma_f32_16x16x32_bf16 v[176:179], a[192:195], a[176:179], v[176:179]
  ds_read_b64_tr_b16 a[212:213], v104 offset:24576
  v_mfma_f32_16x16x32_bf16 v[176:179], a[196:199], a[180:183], v[176:179]
  v_mfma_f32_16x16x32_bf16 v[184:187], a[196:199], a[188:191], v[184:187]
  ds_read_b64_tr_b16 a[214:215], v104 offset:25600
  v_mfma_f32_16x16x32_bf16 v[184:187], a[192:195], a[184:187], v[184:187]
  s_waitcnt lgkmcnt(4)
  v_mfma_f32_16x16x32_bf16 v[188:191], a[200:203], a[184:187], v[188:191]
  ds_read_b64_tr_b16 a[216:217], v104 offset:16392
  v_mfma_f32_16x16x32_bf16 v[188:191], a[204:207], a[188:191], v[188:191]
  v_mfma_f32_16x16x32_bf16 v[180:183], a[204:207], a[180:183], v[180:183]
  ds_read_b64_tr_b16 a[218:219], v104 offset:17416
  v_mfma_f32_16x16x32_bf16 v[180:183], a[200:203], a[176:179], v[180:183]
  s_add_u32 m0, s18, 67584
  v_mfma_f32_16x16x32_bf16 v[172:175], a[200:203], a[168:171], v[172:175]
  ds_read_b64_tr_b16 a[220:221], v104 offset:24584
  v_mfma_f32_16x16x32_bf16 v[172:175], a[204:207], a[172:175], v[172:175]
  buffer_load_dwordx4 v113, s[28:31], s41 offen offset:0 lds
  v_mfma_f32_16x16x32_bf16 v[164:167], a[204:207], a[164:167], v[164:167]
  ds_read_b64_tr_b16 a[222:223], v104 offset:25608
  v_mfma_f32_16x16x32_bf16 v[164:167], a[200:203], a[160:163], v[164:167]
  s_waitcnt lgkmcnt(4)
  s_waitcnt vmcnt(17)
  s_barrier
  v_mfma_f32_16x16x32_bf16 v[128:131], a[208:211], a[160:163], v[128:131]
  ds_read_b64_tr_b16 a[192:193], v108 offset:16384
  v_mfma_f32_16x16x32_bf16 v[128:131], a[212:215], a[164:167], v[128:131]
  buffer_load_dwordx4 v114, s[28:31], s41 offen offset:1024 lds
  v_mfma_f32_16x16x32_bf16 v[136:139], a[212:215], a[172:175], v[136:139]
  ds_read_b64_tr_b16 a[194:195], v108 offset:16896
  v_mfma_f32_16x16x32_bf16 v[136:139], a[208:211], a[168:171], v[136:139]
  v_mfma_f32_16x16x32_bf16 v[144:147], a[208:211], a[176:179], v[144:147]
  ds_read_b64_tr_b16 a[196:197], v108 offset:24576
  v_mfma_f32_16x16x32_bf16 v[144:147], a[212:215], a[180:183], v[144:147]
  global_load_dword v2, v[74:75], off
  v_mfma_f32_16x16x32_bf16 v[152:155], a[212:215], a[188:191], v[152:155]
  ds_read_b64_tr_b16 a[198:199], v108 offset:25088
  v_mfma_f32_16x16x32_bf16 v[152:155], a[208:211], a[184:187], v[152:155]
  s_waitcnt lgkmcnt(4)
  v_mfma_f32_16x16x32_bf16 v[156:159], a[216:219], a[184:187], v[156:159]
  ds_read_b64_tr_b16 a[200:201], v108 offset:18432
  v_mfma_f32_16x16x32_bf16 v[156:159], a[220:223], a[188:191], v[156:159]
  v_mfma_f32_16x16x32_bf16 v[148:151], a[220:223], a[180:183], v[148:151]
  ds_read_b64_tr_b16 a[202:203], v108 offset:18944
  v_mfma_f32_16x16x32_bf16 v[148:151], a[216:219], a[176:179], v[148:151]
  v_mfma_f32_16x16x32_bf16 v[140:143], a[216:219], a[168:171], v[140:143]
  ds_read_b64_tr_b16 a[204:205], v108 offset:26624
  v_mfma_f32_16x16x32_bf16 v[140:143], a[220:223], a[172:175], v[140:143]
  s_waitcnt vmcnt(11)
  v_mfma_f32_16x16x32_bf16 v[132:135], a[220:223], a[164:167], v[132:135]
  ds_read_b64_tr_b16 a[206:207], v108 offset:27136
  v_mfma_f32_16x16x32_bf16 v[132:135], a[216:219], a[160:163], v[132:135]
  s_waitcnt lgkmcnt(4)
  v_mfma_f32_16x16x32_bf16 v[8:11], a[192:195], a[128:131], v[8:11]
  s_add_u32 s42, s42, 512
  ds_read_b64_tr_b16 a[208:209], v109 offset:16384
  v_mfma_f32_16x16x32_bf16 v[8:11], a[196:199], a[132:135], v[8:11]
  buffer_load_dwordx4 a[160:163], v100, s[32:35], s42 offen offset:0 sc1
  v_mfma_f32_16x16x32_bf16 v[16:19], a[196:199], a[140:143], v[16:19]
  ds_read_b64_tr_b16 a[210:211], v109 offset:16896
  v_mfma_f32_16x16x32_bf16 v[16:19], a[192:195], a[136:139], v[16:19]
  buffer_load_dwordx4 a[164:167], v100, s[32:35], s42 offen offset:256 sc1
  v_mfma_f32_16x16x32_bf16 v[24:27], a[192:195], a[144:147], v[24:27]
  ds_read_b64_tr_b16 a[212:213], v109 offset:24576
  v_mfma_f32_16x16x32_bf16 v[24:27], a[196:199], a[148:151], v[24:27]
  buffer_load_dwordx4 a[168:171], v101, s[32:35], s42 offen offset:0 sc1
  v_mfma_f32_16x16x32_bf16 v[32:35], a[196:199], a[156:159], v[32:35]
  ds_read_b64_tr_b16 a[214:215], v109 offset:25088
  v_mfma_f32_16x16x32_bf16 v[32:35], a[192:195], a[152:155], v[32:35]
  s_waitcnt lgkmcnt(4)
  buffer_load_dwordx4 a[172:175], v101, s[32:35], s42 offen offset:256 sc1
  v_mfma_f32_16x16x32_bf16 a[88:91], a[200:203], a[152:155], a[88:91]
  ds_read_b64_tr_b16 a[216:217], v109 offset:18432
  v_mfma_f32_16x16x32_bf16 a[88:91], a[204:207], a[156:159], a[88:91]
  buffer_load_dwordx4 a[176:179], v102, s[32:35], s42 offen offset:0 sc1
  v_mfma_f32_16x16x32_bf16 a[80:83], a[204:207], a[148:151], a[80:83]
  ds_read_b64_tr_b16 a[218:219], v109 offset:18944
  v_mfma_f32_16x16x32_bf16 a[80:83], a[200:203], a[144:147], a[80:83]
  buffer_load_dwordx4 a[180:183], v102, s[32:35], s42 offen offset:256 sc1
  v_mfma_f32_16x16x32_bf16 a[72:75], a[200:203], a[136:139], a[72:75]
  ds_read_b64_tr_b16 a[220:221], v109 offset:26624
  v_mfma_f32_16x16x32_bf16 a[72:75], a[204:207], a[140:143], a[72:75]
  buffer_load_dwordx4 a[184:187], v103, s[32:35], s42 offen offset:0 sc1
  v_mfma_f32_16x16x32_bf16 a[64:67], a[204:207], a[132:135], a[64:67]
  ds_read_b64_tr_b16 a[222:223], v109 offset:27136
  v_mfma_f32_16x16x32_bf16 a[64:67], a[200:203], a[128:131], a[64:67]
  s_waitcnt lgkmcnt(4)
  buffer_load_dwordx4 a[188:191], v103, s[32:35], s42 offen offset:256 sc1
  v_mfma_f32_16x16x32_bf16 v[12:15], a[208:211], a[128:131], v[12:15]
  ds_read_b64_tr_b16 a[192:193], v110 offset:16384
  v_mfma_f32_16x16x32_bf16 v[12:15], a[212:215], a[132:135], v[12:15]
  v_mfma_f32_16x16x32_bf16 v[20:23], a[212:215], a[140:143], v[20:23]
  s_bfe_u32 s19, s47, 0x1000a
  ds_read_b64_tr_b16 a[194:195], v110 offset:16896
  v_mfma_f32_16x16x32_bf16 v[20:23], a[208:211], a[136:139], v[20:23]
  s_xor_b32 s19, s19, s44
  v_mfma_f32_16x16x32_bf16 v[28:31], a[208:211], a[144:147], v[28:31]
  ds_read_b64_tr_b16 a[196:197], v110 offset:24576
  v_mfma_f32_16x16x32_bf16 v[28:31], a[212:215], a[148:151], v[28:31]
  s_bitcmp1_b32 s19, 0
  s_cselect_b32 s19, 260096, 0
  v_mfma_f32_16x16x32_bf16 v[36:39], a[212:215], a[156:159], v[36:39]
  s_add_u32 s19, s19, 1024
  ds_read_b64_tr_b16 a[198:199], v110 offset:25088
  v_mfma_f32_16x16x32_bf16 v[36:39], a[208:211], a[152:155], v[36:39]
  s_waitcnt lgkmcnt(4)
  s_add_u32 m0, s18, 0
  v_mfma_f32_16x16x32_bf16 a[92:95], a[216:219], a[152:155], a[92:95]
  s_sub_u32 s59, 8, s19
  ds_read_b64_tr_b16 a[200:201], v110 offset:18432
  v_mfma_f32_16x16x32_bf16 a[92:95], a[220:223], a[156:159], a[92:95]
  buffer_load_dwordx4 v88, s[8:11], s16 offen offset:0 lds
  v_mfma_f32_16x16x32_bf16 a[84:87], a[220:223], a[148:151], a[84:87]
  ds_read_b64_tr_b16 a[202:203], v110 offset:18944
  v_mfma_f32_16x16x32_bf16 a[84:87], a[216:219], a[144:147], a[84:87]
  s_bitcmp1_b32 s44, 0
  s_cselect_b32 s19, s59, s19
  v_mfma_f32_16x16x32_bf16 a[76:79], a[216:219], a[136:139], a[76:79]
  s_add_u32 s80, s47, s19
  ds_read_b64_tr_b16 a[204:205], v110 offset:26624
  v_mfma_f32_16x16x32_bf16 a[76:79], a[220:223], a[140:143], a[76:79]
  s_lshl_b32 s87, s98, 11
  v_add_u32 v112, s87, v3
  v_mfma_f32_16x16x32_bf16 a[68:71], a[220:223], a[132:135], a[68:71]
  v_xor_b32 v113, 2048, v112
  ds_read_b64_tr_b16 a[206:207], v110 offset:27136
  v_mfma_f32_16x16x32_bf16 a[68:71], a[216:219], a[128:131], a[68:71]
  s_waitcnt lgkmcnt(4)
  s_waitcnt vmcnt(10)
  s_barrier
  buffer_load_dwordx4 v89, s[8:11], s16 offen offset:1024 lds
  v_mfma_f32_16x16x32_bf16 v[40:43], a[192:195], a[128:131], v[40:43]
  v_xor_b32 v95, 4096, v112
  ds_read_b64_tr_b16 a[208:209], v108 offset:0
  v_mfma_f32_16x16x32_bf16 v[40:43], a[196:199], a[132:135], v[40:43]
  v_xor_b32 v115, 6144, v112
  v_lshlrev_b32 v114, 3, v1
  v_mfma_f32_16x16x32_bf16 v[48:51], a[196:199], a[140:143], v[48:51]
  v_and_b32 v116, 1, v1
  ds_read_b64_tr_b16 a[210:211], v108 offset:512
  v_mfma_f32_16x16x32_bf16 v[48:51], a[192:195], a[136:139], v[48:51]
  v_mul_u32_u24 v116, 0xaaaa, v116
  v_add_u32 v116, 0x4444, v116
  v_mfma_f32_16x16x32_bf16 v[56:59], a[192:195], a[144:147], v[56:59]
  v_lshl_or_b32 v116, v116, 16, v116
  ds_read_b64_tr_b16 a[212:213], v108 offset:8192
  v_mfma_f32_16x16x32_bf16 v[56:59], a[196:199], a[148:151], v[56:59]
  buffer_load_dwordx4 v90, s[8:11], s16 offen offset:2048 lds
  v_mfma_f32_16x16x32_bf16 v[64:67], a[196:199], a[156:159], v[64:67]
  s_lshr_b32 s19, s44, 3
  ds_read_b64_tr_b16 a[214:215], v108 offset:8704
  v_mfma_f32_16x16x32_bf16 v[64:67], a[192:195], a[152:155], v[64:67]
  s_waitcnt lgkmcnt(4)
  s_and_b32 s87, s44, 3
  v_mfma_f32_16x16x32_bf16 a[120:123], a[200:203], a[152:155], a[120:123]
  s_mul_i32 s42, s43, 5120
  ds_read_b64_tr_b16 a[216:217], v108 offset:2048
  v_mfma_f32_16x16x32_bf16 a[120:123], a[204:207], a[156:159], a[120:123]
  s_lshr_b32 s99, s43, 1
  s_mul_i32 s40, s99, 40960
  v_mfma_f32_16x16x32_bf16 a[112:115], a[204:207], a[148:151], a[112:115]
  s_xor_b32 s99, s43, s19
  ds_read_b64_tr_b16 a[218:219], v108 offset:2560
  v_mfma_f32_16x16x32_bf16 a[112:115], a[200:203], a[144:147], a[112:115]
  buffer_load_dwordx4 v91, s[8:11], s16 offen offset:3072 lds
  v_mfma_f32_16x16x32_bf16 a[104:107], a[200:203], a[136:139], a[104:107]
  s_and_b32 s99, s99, 1
  ds_read_b64_tr_b16 a[220:221], v108 offset:10240
  v_mfma_f32_16x16x32_bf16 a[104:107], a[204:207], a[140:143], a[104:107]
  s_mul_i32 s99, s99, 5120
  s_add_u32 s40, s40, s99
  v_mfma_f32_16x16x32_bf16 a[96:99], a[204:207], a[132:135], a[96:99]
  s_mul_i32 s99, s87, 10240
  ds_read_b64_tr_b16 a[222:223], v108 offset:10752
  v_mfma_f32_16x16x32_bf16 a[96:99], a[200:203], a[128:131], a[96:99]
  s_waitcnt lgkmcnt(4)
  s_add_u32 m0, s18, 114688
  s_waitcnt vmcnt(4)
  v_mfma_f32_16x16x32_bf16 v[8:11], a[208:211], a[160:163], v[8:11]
  s_add_u32 s40, s40, s99
  ds_read_b64_tr_b16 a[192:193], v109 offset:0
  v_mfma_f32_16x16x32_bf16 v[8:11], a[212:215], a[164:167], v[8:11]
  buffer_load_dwordx4 v92, s[12:15], s17 offen offset:0 lds
  v_mfma_f32_16x16x32_bf16 v[16:19], a[212:215], a[172:175], v[16:19]
  s_mul_i32 s99, s19, 1310720
  ds_read_b64_tr_b16 a[194:195], v109 offset:512
  v_mfma_f32_16x16x32_bf16 v[16:19], a[208:211], a[168:171], v[16:19]
  s_add_u32 s84, s40, s99
  s_add_u32 s84, s84, 2211840
  v_mfma_f32_16x16x32_bf16 v[24:27], a[208:211], a[176:179], v[24:27]
  s_and_b32 s99, s44, 7
  ds_read_b64_tr_b16 a[196:197], v109 offset:8192
  v_mfma_f32_16x16x32_bf16 v[24:27], a[212:215], a[180:183], v[24:27]
  s_mul_i32 s99, s99, 163840
  s_add_u32 s29, s84, s99
  v_mfma_f32_16x16x32_bf16 v[32:35], a[212:215], a[188:191], v[32:35]
  s_lshr_b32 s59, s19, 1
  ds_read_b64_tr_b16 a[198:199], v109 offset:8704
  v_mfma_f32_16x16x32_bf16 v[32:35], a[208:211], a[184:187], v[32:35]
  s_waitcnt lgkmcnt(4)
  buffer_load_dwordx4 v93, s[12:15], s17 offen offset:1024 lds
  v_mfma_f32_16x16x32_bf16 a[88:91], a[216:219], a[184:187], a[88:91]
  s_mul_i32 s59, s59, 14
  ds_read_b64_tr_b16 a[200:201], v109 offset:2048
  v_mfma_f32_16x16x32_bf16 a[88:91], a[220:223], a[188:191], a[88:91]
  s_and_b32 s99, s19, 1
  s_mul_i32 s99, s99, 8
  v_mfma_f32_16x16x32_bf16 a[80:83], a[220:223], a[180:183], a[80:83]
  s_add_u32 s59, s59, s99
  ds_read_b64_tr_b16 a[202:203], v109 offset:2560
  v_mfma_f32_16x16x32_bf16 a[80:83], a[216:219], a[176:179], a[80:83]
  s_mul_i32 s99, s59, 81920
  s_add_u32 s40, s40, s99
  v_mfma_f32_16x16x32_bf16 a[72:75], a[216:219], a[168:171], a[72:75]
  s_lshl2_add_u32 s28, s45, s43
  ds_read_b64_tr_b16 a[204:205], v109 offset:10240
  v_mfma_f32_16x16x32_bf16 a[72:75], a[220:223], a[172:175], a[72:75]
  buffer_load_dwordx4 v92, s[12:15], s17 offen offset:2048 lds
  v_mfma_f32_16x16x32_bf16 a[64:67], a[220:223], a[164:167], a[64:67]
  s_lshl_b32 s41, s28, 13
  ds_read_b64_tr_b16 a[206:207], v109 offset:10752
  v_mfma_f32_16x16x32_bf16 a[64:67], a[216:219], a[160:163], a[64:67]
  s_waitcnt lgkmcnt(4)
  s_lshl_b32 s99, s19, 22
  v_mfma_f32_16x16x32_bf16 v[12:15], a[192:195], a[160:163], v[12:15]
  s_add_u32 s85, s41, s99
  ds_read_b64_tr_b16 a[208:209], v110 offset:0
  v_mfma_f32_16x16x32_bf16 v[12:15], a[196:199], a[164:167], v[12:15]
  s_add_u32 s85, s85, 12582912
  s_lshl_b32 s99, s59, 18
  v_mfma_f32_16x16x32_bf16 v[20:23], a[196:199], a[172:175], v[20:23]
  s_add_u32 s41, s41, s99
  ds_read_b64_tr_b16 a[210:211], v110 offset:512
  v_mfma_f32_16x16x32_bf16 v[20:23], a[192:195], a[168:171], v[20:23]
  buffer_load_dwordx4 v93, s[12:15], s17 offen offset:3072 lds
  v_mfma_f32_16x16x32_bf16 v[28:31], a[192:195], a[176:179], v[28:31]
  s_lshl2_add_u32 s28, s28, s98
  ds_read_b64_tr_b16 a[212:213], v110 offset:8192
  v_mfma_f32_16x16x32_bf16 v[28:31], a[196:199], a[180:183], v[28:31]
  s_mul_i32 s28, s28, 20480
  s_and_b32 s3, s19, 1
  v_mfma_f32_16x16x32_bf16 v[36:39], a[196:199], a[188:191], v[36:39]
  s_add_u32 m0, s18, 16384
  ds_read_b64_tr_b16 a[214:215], v110 offset:8704
  v_mfma_f32_16x16x32_bf16 v[36:39], a[192:195], a[184:187], v[36:39]
  s_waitcnt lgkmcnt(4)
  s_add_u32 s16, s16, 16384
  v_mfma_f32_16x16x32_bf16 a[92:95], a[200:203], a[184:187], a[92:95]
  s_lshl1_add_u32 s99, s87, s3
  ds_read_b64_tr_b16 a[216:217], v110 offset:2048
  v_mfma_f32_16x16x32_bf16 a[92:95], a[204:207], a[188:191], a[92:95]
  buffer_load_dwordx4 v88, s[8:11], s16 offen offset:0 lds
  v_mfma_f32_16x16x32_bf16 a[84:87], a[204:207], a[180:183], a[84:87]
  s_mul_i32 s99, s99, 160
  ds_read_b64_tr_b16 a[218:219], v110 offset:2560
  v_mfma_f32_16x16x32_bf16 a[84:87], a[200:203], a[176:179], a[84:87]
  s_add_u32 s28, s28, s99
  s_andn2_b32 s30, s96, 15
  v_mfma_f32_16x16x32_bf16 a[76:79], a[200:203], a[168:171], a[76:79]
  s_add_u32 s82, s46, 262144
  ds_read_b64_tr_b16 a[220:221], v110 offset:10240
  v_mfma_f32_16x16x32_bf16 a[76:79], a[204:207], a[172:175], a[76:79]
  s_lshl_b32 s81, s44, 19
  s_add_u32 s81, s81, 458752
  v_mfma_f32_16x16x32_bf16 a[68:71], a[204:207], a[164:167], a[68:71]
  s_mov_b32 s20, s88
  ds_read_b64_tr_b16 a[222:223], v110 offset:10752
  v_mfma_f32_16x16x32_bf16 a[68:71], a[200:203], a[160:163], a[68:71]
  s_waitcnt lgkmcnt(4)
  buffer_load_dwordx4 v89, s[8:11], s16 offen offset:1024 lds
  v_mfma_f32_16x16x32_bf16 v[40:43], a[208:211], a[160:163], v[40:43]
  s_mov_b32 s21, s89
  ds_read_b64_tr_b16 a[192:193], v107 offset:32768
  v_mfma_f32_16x16x32_bf16 v[40:43], a[212:215], a[164:167], v[40:43]
  s_mov_b32 s22, 2621440
  s_mov_b32 s23, 0x20000
  v_mfma_f32_16x16x32_bf16 v[48:51], a[212:215], a[172:175], v[48:51]
  s_mov_b32 s24, s90
  ds_read_b64_tr_b16 a[194:195], v107 offset:33792
  v_mfma_f32_16x16x32_bf16 v[48:51], a[208:211], a[168:171], v[48:51]
  s_mov_b32 s25, s91
  s_mov_b32 s26, 2621440
  v_mfma_f32_16x16x32_bf16 v[56:59], a[208:211], a[176:179], v[56:59]
  s_mov_b32 s27, 0x20000
  ds_read_b64_tr_b16 a[196:197], v107 offset:40960
  v_accvgpr_read_b32 v96, a88
  v_mfma_f32_16x16x32_bf16 v[56:59], a[212:215], a[180:183], v[56:59]
  buffer_load_dwordx4 v90, s[8:11], s16 offen offset:2048 lds
  v_mfma_f32_16x16x32_bf16 v[64:67], a[212:215], a[188:191], v[64:67]
  ds_read_b64_tr_b16 a[198:199], v107 offset:41984
  v_accvgpr_read_b32 v97, a89
  v_mfma_f32_16x16x32_bf16 v[64:67], a[208:211], a[184:187], v[64:67]
  s_waitcnt lgkmcnt(4)
  v_accvgpr_read_b32 v98, a90
  v_accvgpr_read_b32 v99, a91
  v_mfma_f32_16x16x32_bf16 a[120:123], a[216:219], a[184:187], a[120:123]
  ds_read_b64_tr_b16 a[200:201], v107 offset:49152
  v_accvgpr_read_b32 v100, a92
  v_mfma_f32_16x16x32_bf16 a[120:123], a[220:223], a[188:191], a[120:123]
  v_accvgpr_read_b32 v101, a93
  v_accvgpr_read_b32 v102, a94
  v_mfma_f32_16x16x32_bf16 a[112:115], a[220:223], a[180:183], a[112:115]
  ds_read_b64_tr_b16 a[202:203], v107 offset:50176
  v_accvgpr_read_b32 v103, a95
  v_mfma_f32_16x16x32_bf16 a[112:115], a[216:219], a[176:179], a[112:115]
  buffer_load_dwordx4 v91, s[8:11], s16 offen offset:3072 lds
  v_mfma_f32_16x16x32_bf16 a[104:107], a[216:219], a[168:171], a[104:107]
  ds_read_b64_tr_b16 a[204:205], v107 offset:57344
  v_mul_f32 v32, v32, v96
  v_mfma_f32_16x16x32_bf16 a[104:107], a[220:223], a[172:175], a[104:107]
  v_mul_f32 v33, v33, v97
  v_mul_f32 v34, v34, v98
  v_mfma_f32_16x16x32_bf16 a[96:99], a[220:223], a[164:167], a[96:99]
  ds_read_b64_tr_b16 a[206:207], v107 offset:58368
  v_mul_f32 v35, v35, v99
  v_mfma_f32_16x16x32_bf16 a[96:99], a[216:219], a[160:163], a[96:99]
  s_waitcnt lgkmcnt(4)
  v_mul_f32 v36, v36, v100
  v_mul_f32 v37, v37, v101
  v_mfma_f32_16x16x32_bf16 v[224:227], a[192:195], a[128:131], v[224:227]
  ds_read_b64_tr_b16 a[208:209], v107 offset:32776
  v_mul_f32 v38, v38, v102
  v_mfma_f32_16x16x32_bf16 v[224:227], a[196:199], a[132:135], v[224:227]
  v_mul_f32 v39, v39, v103
  v_cvt_pk_bf16_f32 v32, v32, v33
  v_mfma_f32_16x16x32_bf16 v[232:235], a[196:199], a[140:143], v[232:235]
  ds_read_b64_tr_b16 a[210:211], v107 offset:33800
  v_cvt_pk_bf16_f32 v33, v34, v35
  v_mfma_f32_16x16x32_bf16 v[232:235], a[192:195], a[136:139], v[232:235]
  v_cvt_pk_bf16_f32 v34, v36, v37
  v_cvt_pk_bf16_f32 v35, v38, v39
  v_mfma_f32_16x16x32_bf16 v[240:243], a[192:195], a[144:147], v[240:243]
  ds_read_b64_tr_b16 a[212:213], v107 offset:40968
  v_mfma_f32_16x16x32_bf16 v[240:243], a[196:199], a[148:151], v[240:243]
  buffer_store_dwordx4 v[32:35], v115, s[36:39], s47 offen offset:0 sc1
  v_mfma_f32_16x16x32_bf16 v[248:251], a[196:199], a[156:159], v[248:251]
  ds_read_b64_tr_b16 a[214:215], v107 offset:41992
  v_accvgpr_read_b32 v96, a80
  v_mfma_f32_16x16x32_bf16 v[248:251], a[192:195], a[152:155], v[248:251]
  s_waitcnt lgkmcnt(4)
  v_accvgpr_read_b32 v97, a81
  v_accvgpr_read_b32 v98, a82
  v_mfma_f32_16x16x32_bf16 v[248:251], a[200:203], a[184:187], v[248:251]
  ds_read_b64_tr_b16 a[216:217], v107 offset:49160
  v_accvgpr_read_b32 v99, a83
  v_mfma_f32_16x16x32_bf16 v[248:251], a[204:207], a[188:191], v[248:251]
  v_accvgpr_read_b32 v100, a84
  v_accvgpr_read_b32 v101, a85
  v_mfma_f32_16x16x32_bf16 v[240:243], a[204:207], a[180:183], v[240:243]
  ds_read_b64_tr_b16 a[218:219], v107 offset:50184
  v_accvgpr_read_b32 v102, a86
  v_mfma_f32_16x16x32_bf16 v[240:243], a[200:203], a[176:179], v[240:243]
  v_accvgpr_read_b32 v103, a87
  v_mul_f32 v24, v24, v96
  v_mfma_f32_16x16x32_bf16 v[232:235], a[200:203], a[168:171], v[232:235]
  ds_read_b64_tr_b16 a[220:221], v107 offset:57352
  v_mul_f32 v25, v25, v97
  v_mfma_f32_16x16x32_bf16 v[232:235], a[204:207], a[172:175], v[232:235]
  v_mul_f32 v26, v26, v98
  v_mul_f32 v27, v27, v99
  v_mfma_f32_16x16x32_bf16 v[224:227], a[204:207], a[164:167], v[224:227]
  ds_read_b64_tr_b16 a[222:223], v107 offset:58376
  v_mul_f32 v28, v28, v100
  v_mfma_f32_16x16x32_bf16 v[224:227], a[200:203], a[160:163], v[224:227]
  s_waitcnt lgkmcnt(4)
  v_mul_f32 v29, v29, v101
  v_mul_f32 v30, v30, v102
  v_mfma_f32_16x16x32_bf16 v[228:231], a[208:211], a[128:131], v[228:231]
  ds_read_b64_tr_b16 a[192:193], v106 offset:32768
  v_mul_f32 v31, v31, v103
  v_mfma_f32_16x16x32_bf16 v[228:231], a[212:215], a[132:135], v[228:231]
  v_cvt_pk_bf16_f32 v24, v24, v25
  v_cvt_pk_bf16_f32 v25, v26, v27
  v_mfma_f32_16x16x32_bf16 v[236:239], a[212:215], a[140:143], v[236:239]
  ds_read_b64_tr_b16 a[194:195], v106 offset:33792
  v_cvt_pk_bf16_f32 v26, v28, v29
  v_mfma_f32_16x16x32_bf16 v[236:239], a[208:211], a[136:139], v[236:239]
  v_cvt_pk_bf16_f32 v27, v30, v31
  v_mfma_f32_16x16x32_bf16 v[244:247], a[208:211], a[144:147], v[244:247]
  ds_read_b64_tr_b16 a[196:197], v106 offset:40960
  v_mfma_f32_16x16x32_bf16 v[244:247], a[212:215], a[148:151], v[244:247]
  buffer_store_dwordx4 v[24:27], v95, s[36:39], s47 offen offset:0 sc1
  v_mfma_f32_16x16x32_bf16 v[252:255], a[212:215], a[156:159], v[252:255]
  ds_read_b64_tr_b16 a[198:199], v106 offset:41984
  v_accvgpr_read_b32 v96, a72
  v_mfma_f32_16x16x32_bf16 v[252:255], a[208:211], a[152:155], v[252:255]
  s_waitcnt lgkmcnt(4)
  v_accvgpr_read_b32 v97, a73
  v_accvgpr_read_b32 v98, a74
  v_mfma_f32_16x16x32_bf16 v[252:255], a[216:219], a[184:187], v[252:255]
  ds_read_b64_tr_b16 a[200:201], v106 offset:49152
  v_accvgpr_read_b32 v99, a75
  v_mfma_f32_16x16x32_bf16 v[252:255], a[220:223], a[188:191], v[252:255]
  v_accvgpr_read_b32 v100, a76
  v_accvgpr_read_b32 v101, a77
  v_mfma_f32_16x16x32_bf16 v[244:247], a[220:223], a[180:183], v[244:247]
  ds_read_b64_tr_b16 a[202:203], v106 offset:50176
  v_accvgpr_read_b32 v102, a78
  v_mfma_f32_16x16x32_bf16 v[244:247], a[216:219], a[176:179], v[244:247]
  v_accvgpr_read_b32 v103, a79
  v_mul_f32 v16, v16, v96
  v_mfma_f32_16x16x32_bf16 v[236:239], a[216:219], a[168:171], v[236:239]
  ds_read_b64_tr_b16 a[204:205], v106 offset:57344
  v_mul_f32 v17, v17, v97
  v_mfma_f32_16x16x32_bf16 v[236:239], a[220:223], a[172:175], v[236:239]
  v_mul_f32 v18, v18, v98
  v_mul_f32 v19, v19, v99
  v_mfma_f32_16x16x32_bf16 v[228:231], a[220:223], a[164:167], v[228:231]
  ds_read_b64_tr_b16 a[206:207], v106 offset:58368
  v_mul_f32 v20, v20, v100
  v_mfma_f32_16x16x32_bf16 v[228:231], a[216:219], a[160:163], v[228:231]
  s_waitcnt lgkmcnt(4)
  v_mul_f32 v21, v21, v101
  v_mul_f32 v22, v22, v102
  v_mfma_f32_16x16x32_bf16 v[192:195], a[192:195], a[128:131], v[192:195]
  ds_read_b64_tr_b16 a[208:209], v106 offset:32776
  v_mul_f32 v23, v23, v103
  v_mfma_f32_16x16x32_bf16 v[192:195], a[196:199], a[132:135], v[192:195]
  v_cvt_pk_bf16_f32 v16, v16, v17
  v_cvt_pk_bf16_f32 v17, v18, v19
  v_mfma_f32_16x16x32_bf16 v[200:203], a[196:199], a[140:143], v[200:203]
  ds_read_b64_tr_b16 a[210:211], v106 offset:33800
  v_cvt_pk_bf16_f32 v18, v20, v21
  v_mfma_f32_16x16x32_bf16 v[200:203], a[192:195], a[136:139], v[200:203]
  v_cvt_pk_bf16_f32 v19, v22, v23
  v_mfma_f32_16x16x32_bf16 v[208:211], a[192:195], a[144:147], v[208:211]
  ds_read_b64_tr_b16 a[212:213], v106 offset:40968
  v_mfma_f32_16x16x32_bf16 v[208:211], a[196:199], a[148:151], v[208:211]
  buffer_store_dwordx4 v[16:19], v113, s[36:39], s47 offen offset:0 sc1
  v_mfma_f32_16x16x32_bf16 v[216:219], a[196:199], a[156:159], v[216:219]
  ds_read_b64_tr_b16 a[214:215], v106 offset:41992
  v_cvt_pk_bf16_f32 v255, v254, v255
  v_mfma_f32_16x16x32_bf16 v[216:219], a[192:195], a[152:155], v[216:219]
  s_waitcnt lgkmcnt(4)
  v_cvt_pk_bf16_f32 v254, v252, v253
  v_cvt_pk_bf16_f32 v253, v250, v251
  v_mfma_f32_16x16x32_bf16 v[216:219], a[200:203], a[184:187], v[216:219]
  ds_read_b64_tr_b16 a[216:217], v106 offset:49160
  v_cvt_pk_bf16_f32 v252, v248, v249
  v_mfma_f32_16x16x32_bf16 v[216:219], a[204:207], a[188:191], v[216:219]
  v_cvt_pk_bf16_f32 v251, v246, v247
  v_cvt_pk_bf16_f32 v250, v244, v245
  v_mfma_f32_16x16x32_bf16 v[208:211], a[204:207], a[180:183], v[208:211]
  ds_read_b64_tr_b16 a[218:219], v106 offset:50184
  v_cvt_pk_bf16_f32 v249, v242, v243
  v_mfma_f32_16x16x32_bf16 v[208:211], a[200:203], a[176:179], v[208:211]
  v_cvt_pk_bf16_f32 v248, v240, v241
  v_cvt_pk_bf16_f32 v247, v238, v239
  v_mfma_f32_16x16x32_bf16 v[200:203], a[200:203], a[168:171], v[200:203]
  ds_read_b64_tr_b16 a[220:221], v106 offset:57352
  v_cvt_pk_bf16_f32 v246, v236, v237
  v_mfma_f32_16x16x32_bf16 v[200:203], a[204:207], a[172:175], v[200:203]
  v_cvt_pk_bf16_f32 v245, v234, v235
  v_cvt_pk_bf16_f32 v244, v232, v233
  v_mfma_f32_16x16x32_bf16 v[192:195], a[204:207], a[164:167], v[192:195]
  ds_read_b64_tr_b16 a[222:223], v106 offset:58376
  v_cvt_pk_bf16_f32 v243, v230, v231
  v_mfma_f32_16x16x32_bf16 v[192:195], a[200:203], a[160:163], v[192:195]
  s_waitcnt lgkmcnt(4)
  v_cvt_pk_bf16_f32 v242, v228, v229
  v_cvt_pk_bf16_f32 v241, v226, v227
  v_mfma_f32_16x16x32_bf16 v[196:199], a[208:211], a[128:131], v[196:199]
  ds_read_b64_tr_b16 a[192:193], v105 offset:32768
  v_cvt_pk_bf16_f32 v240, v224, v225
  v_mfma_f32_16x16x32_bf16 v[196:199], a[212:215], a[132:135], v[196:199]
  v_accvgpr_read_b32 v96, a64
  v_accvgpr_read_b32 v97, a65
  v_mfma_f32_16x16x32_bf16 v[204:207], a[212:215], a[140:143], v[204:207]
  ds_read_b64_tr_b16 a[194:195], v105 offset:33792
  v_accvgpr_read_b32 v98, a66
  v_mfma_f32_16x16x32_bf16 v[204:207], a[208:211], a[136:139], v[204:207]
  v_accvgpr_read_b32 v99, a67
  v_accvgpr_read_b32 v100, a68
  v_mfma_f32_16x16x32_bf16 v[212:215], a[208:211], a[144:147], v[212:215]
  ds_read_b64_tr_b16 a[196:197], v105 offset:40960
  v_accvgpr_read_b32 v101, a69
  v_mfma_f32_16x16x32_bf16 v[212:215], a[212:215], a[148:151], v[212:215]
  v_accvgpr_read_b32 v102, a70
  v_accvgpr_read_b32 v103, a71
  v_mfma_f32_16x16x32_bf16 v[220:223], a[212:215], a[156:159], v[220:223]
  ds_read_b64_tr_b16 a[198:199], v105 offset:41984
  v_mul_f32 v8, v8, v96
  v_mfma_f32_16x16x32_bf16 v[220:223], a[208:211], a[152:155], v[220:223]
  s_waitcnt lgkmcnt(4)
  v_mul_f32 v9, v9, v97
  v_mul_f32 v10, v10, v98
  v_mfma_f32_16x16x32_bf16 v[220:223], a[216:219], a[184:187], v[220:223]
  ds_read_b64_tr_b16 a[200:201], v105 offset:49152
  v_mul_f32 v11, v11, v99
  v_mfma_f32_16x16x32_bf16 v[220:223], a[220:223], a[188:191], v[220:223]
  v_mul_f32 v12, v12, v100
  v_mul_f32 v13, v13, v101
  v_mfma_f32_16x16x32_bf16 v[212:215], a[220:223], a[180:183], v[212:215]
  ds_read_b64_tr_b16 a[202:203], v105 offset:50176
  v_mul_f32 v14, v14, v102
  v_mfma_f32_16x16x32_bf16 v[212:215], a[216:219], a[176:179], v[212:215]
  v_mul_f32 v15, v15, v103
  v_cvt_pk_bf16_f32 v8, v8, v9
  v_mfma_f32_16x16x32_bf16 v[204:207], a[216:219], a[168:171], v[204:207]
  ds_read_b64_tr_b16 a[204:205], v105 offset:57344
  v_cvt_pk_bf16_f32 v9, v10, v11
  v_mfma_f32_16x16x32_bf16 v[204:207], a[220:223], a[172:175], v[204:207]
  v_cvt_pk_bf16_f32 v10, v12, v13
  v_cvt_pk_bf16_f32 v11, v14, v15
  v_mfma_f32_16x16x32_bf16 v[196:199], a[220:223], a[164:167], v[196:199]
  ds_read_b64_tr_b16 a[206:207], v105 offset:58368
  v_mfma_f32_16x16x32_bf16 v[196:199], a[216:219], a[160:163], v[196:199]
  s_waitcnt lgkmcnt(4)
  buffer_store_dwordx4 v[8:11], v112, s[36:39], s47 offen offset:0 sc1
  v_mfma_f32_16x16x32_bf16 v[160:163], a[192:195], a[128:131], v[160:163]
  ds_read_b64_tr_b16 a[208:209], v105 offset:32776
  v_accvgpr_read_b32 v96, a120
  v_mfma_f32_16x16x32_bf16 v[160:163], a[196:199], a[132:135], v[160:163]
  v_accvgpr_read_b32 v97, a121
  v_accvgpr_read_b32 v98, a122
  v_mfma_f32_16x16x32_bf16 v[168:171], a[196:199], a[140:143], v[168:171]
  ds_read_b64_tr_b16 a[210:211], v105 offset:33800
  v_accvgpr_read_b32 v99, a123
  v_mfma_f32_16x16x32_bf16 v[168:171], a[192:195], a[136:139], v[168:171]
  v_mul_f32 v64, v64, v96
  v_mul_f32 v65, v65, v97
  v_mfma_f32_16x16x32_bf16 v[176:179], a[192:195], a[144:147], v[176:179]
  ds_read_b64_tr_b16 a[212:213], v105 offset:40968
  v_mul_f32 v66, v66, v98
  v_mfma_f32_16x16x32_bf16 v[176:179], a[196:199], a[148:151], v[176:179]
  v_mul_f32 v67, v67, v99
  v_cvt_pk_bf16_f32 v64, v64, v65
  v_mfma_f32_16x16x32_bf16 v[184:187], a[196:199], a[156:159], v[184:187]
  ds_read_b64_tr_b16 a[214:215], v105 offset:41992
  v_cvt_pk_bf16_f32 v65, v66, v67
  v_mfma_f32_16x16x32_bf16 v[184:187], a[192:195], a[152:155], v[184:187]
  s_waitcnt lgkmcnt(4)
  buffer_store_dwordx2 v[64:65], v115, s[36:39], s80 offen offset:0 sc1
  v_mfma_f32_16x16x32_bf16 v[184:187], a[200:203], a[184:187], v[184:187]
  ds_read_b64_tr_b16 a[216:217], v105 offset:49160
  v_cvt_pk_bf16_f32 v239, v222, v223
  v_mfma_f32_16x16x32_bf16 v[184:187], a[204:207], a[188:191], v[184:187]
  v_cvt_pk_bf16_f32 v238, v220, v221
  v_cvt_pk_bf16_f32 v237, v218, v219
L_pad_proj12_5:
  s_cbranch_execz L_back0
  v_mfma_f32_16x16x32_bf16 v[176:179], a[204:207], a[180:183], v[176:179]
  ds_read_b64_tr_b16 a[218:219], v105 offset:50184
  v_cvt_pk_bf16_f32 v236, v216, v217
  v_mfma_f32_16x16x32_bf16 v[176:179], a[200:203], a[176:179], v[176:179]
  v_cvt_pk_bf16_f32 v235, v214, v215
  v_cvt_pk_bf16_f32 v234, v212, v213
  v_mfma_f32_16x16x32_bf16 v[168:171], a[200:203], a[168:171], v[168:171]
  ds_read_b64_tr_b16 a[220:221], v105 offset:57352
  v_cvt_pk_bf16_f32 v233, v210, v211
  v_mfma_f32_16x16x32_bf16 v[168:171], a[204:207], a[172:175], v[168:171]
  v_cvt_pk_bf16_f32 v232, v208, v209
  v_cvt_pk_bf16_f32 v231, v206, v207
  v_mfma_f32_16x16x32_bf16 v[160:163], a[204:207], a[164:167], v[160:163]
  ds_read_b64_tr_b16 a[222:223], v105 offset:58376
  v_cvt_pk_bf16_f32 v230, v204, v205
  v_mfma_f32_16x16x32_bf16 v[160:163], a[200:203], a[160:163], v[160:163]
  s_waitcnt lgkmcnt(4)
  v_cvt_pk_bf16_f32 v229, v202, v203
  v_cvt_pk_bf16_f32 v228, v200, v201
  v_mfma_f32_16x16x32_bf16 v[164:167], a[208:211], a[128:131], v[164:167]
  ds_read_b64_tr_b16 a[192:193], v104 offset:32768
  v_cvt_pk_bf16_f32 v227, v198, v199
  v_mfma_f32_16x16x32_bf16 v[164:167], a[212:215], a[132:135], v[164:167]
  v_cvt_pk_bf16_f32 v226, v196, v197
  v_cvt_pk_bf16_f32 v225, v194, v195
  v_mfma_f32_16x16x32_bf16 v[172:175], a[212:215], a[140:143], v[172:175]
  ds_read_b64_tr_b16 a[194:195], v104 offset:33792
  v_cvt_pk_bf16_f32 v224, v192, v193
  v_mfma_f32_16x16x32_bf16 v[172:175], a[208:211], a[136:139], v[172:175]
  v_accvgpr_read_b32 v96, a112
  v_accvgpr_read_b32 v97, a113
  v_mfma_f32_16x16x32_bf16 v[180:183], a[208:211], a[144:147], v[180:183]
  ds_read_b64_tr_b16 a[196:197], v104 offset:40960
  v_accvgpr_read_b32 v98, a114
  v_mfma_f32_16x16x32_bf16 v[180:183], a[212:215], a[148:151], v[180:183]
  v_accvgpr_read_b32 v99, a115
  v_mul_f32 v56, v56, v96
  v_mfma_f32_16x16x32_bf16 v[188:191], a[212:215], a[156:159], v[188:191]
  ds_read_b64_tr_b16 a[198:199], v104 offset:41984
  v_mul_f32 v57, v57, v97
  v_mfma_f32_16x16x32_bf16 v[188:191], a[208:211], a[152:155], v[188:191]
  s_waitcnt lgkmcnt(4)
  v_mul_f32 v58, v58, v98
  v_mul_f32 v59, v59, v99
  v_mfma_f32_16x16x32_bf16 v[188:191], a[216:219], a[184:187], v[188:191]
  ds_read_b64_tr_b16 a[200:201], v104 offset:49152
  v_cvt_pk_bf16_f32 v56, v56, v57
  v_mfma_f32_16x16x32_bf16 v[188:191], a[220:223], a[188:191], v[188:191]
  v_cvt_pk_bf16_f32 v57, v58, v59
  v_mfma_f32_16x16x32_bf16 v[180:183], a[220:223], a[180:183], v[180:183]
  ds_read_b64_tr_b16 a[202:203], v104 offset:50176
  v_mfma_f32_16x16x32_bf16 v[180:183], a[216:219], a[176:179], v[180:183]
  buffer_store_dwordx2 v[56:57], v95, s[36:39], s80 offen offset:0 sc1
  v_mfma_f32_16x16x32_bf16 v[172:175], a[216:219], a[168:171], v[172:175]
  ds_read_b64_tr_b16 a[204:205], v104 offset:57344
  v_accvgpr_read_b32 v96, a104
  v_mfma_f32_16x16x32_bf16 v[172:175], a[220:223], a[172:175], v[172:175]
  v_accvgpr_read_b32 v97, a105
  v_accvgpr_read_b32 v98, a106
  v_mfma_f32_16x16x32_bf16 v[164:167], a[220:223], a[164:167], v[164:167]
  ds_read_b64_tr_b16 a[206:207], v104 offset:58368
  v_accvgpr_read_b32 v99, a107
  v_mfma_f32_16x16x32_bf16 v[164:167], a[216:219], a[160:163], v[164:167]
  s_waitcnt lgkmcnt(4)
  v_mul_f32 v48, v48, v96
  v_mul_f32 v49, v49, v97
  v_mfma_f32_16x16x32_bf16 v[128:131], a[192:195], a[128:131], v[128:131]
  ds_read_b64_tr_b16 a[208:209], v104 offset:32776
  v_mul_f32 v50, v50, v98
  v_mfma_f32_16x16x32_bf16 v[128:131], a[196:199], a[132:135], v[128:131]
  v_mul_f32 v51, v51, v99
  v_cvt_pk_bf16_f32 v48, v48, v49
  v_mfma_f32_16x16x32_bf16 v[136:139], a[196:199], a[140:143], v[136:139]
  ds_read_b64_tr_b16 a[210:211], v104 offset:33800
  v_cvt_pk_bf16_f32 v49, v50, v51
  v_mfma_f32_16x16x32_bf16 v[136:139], a[192:195], a[136:139], v[136:139]
  buffer_store_dwordx2 v[48:49], v113, s[36:39], s80 offen offset:0 sc1
  v_mfma_f32_16x16x32_bf16 v[144:147], a[192:195], a[144:147], v[144:147]
  ds_read_b64_tr_b16 a[212:213], v104 offset:40968
  v_accvgpr_read_b32 v96, a96
  v_mfma_f32_16x16x32_bf16 v[144:147], a[196:199], a[148:151], v[144:147]
  v_accvgpr_read_b32 v97, a97
  v_accvgpr_read_b32 v98, a98
  v_mfma_f32_16x16x32_bf16 v[152:155], a[196:199], a[156:159], v[152:155]
  ds_read_b64_tr_b16 a[214:215], v104 offset:41992
  v_accvgpr_read_b32 v99, a99
  v_mfma_f32_16x16x32_bf16 v[152:155], a[192:195], a[152:155], v[152:155]
  s_waitcnt lgkmcnt(4)
  v_mul_f32 v40, v40, v96
  v_mul_f32 v41, v41, v97
  v_mfma_f32_16x16x32_bf16 v[152:155], a[200:203], a[184:187], v[152:155]
  ds_read_b64_tr_b16 a[216:217], v104 offset:49160
  v_mul_f32 v42, v42, v98
  v_mfma_f32_16x16x32_bf16 v[152:155], a[204:207], a[188:191], v[152:155]
  v_mul_f32 v43, v43, v99
  v_cvt_pk_bf16_f32 v40, v40, v41
  v_mfma_f32_16x16x32_bf16 v[144:147], a[204:207], a[180:183], v[144:147]
  ds_read_b64_tr_b16 a[218:219], v104 offset:50184
  v_cvt_pk_bf16_f32 v41, v42, v43
  v_mfma_f32_16x16x32_bf16 v[144:147], a[200:203], a[176:179], v[144:147]
  buffer_store_dwordx2 v[40:41], v112, s[36:39], s80 offen offset:0 sc1
  v_mfma_f32_16x16x32_bf16 v[136:139], a[200:203], a[168:171], v[136:139]
  ds_read_b64_tr_b16 a[220:221], v104 offset:57352
  v_cvt_pk_bf16_f32 v223, v190, v191
  v_mfma_f32_16x16x32_bf16 v[136:139], a[204:207], a[172:175], v[136:139]
  v_cvt_pk_bf16_f32 v222, v188, v189
  v_cvt_pk_bf16_f32 v221, v186, v187
  v_mfma_f32_16x16x32_bf16 v[128:131], a[204:207], a[164:167], v[128:131]
  ds_read_b64_tr_b16 a[222:223], v104 offset:58376
  v_cvt_pk_bf16_f32 v220, v184, v185
  v_mfma_f32_16x16x32_bf16 v[128:131], a[200:203], a[160:163], v[128:131]
  s_waitcnt lgkmcnt(4)
  v_cvt_pk_bf16_f32 v219, v182, v183
  v_cvt_pk_bf16_f32 v218, v180, v181
  v_mfma_f32_16x16x32_bf16 v[132:135], a[208:211], a[128:131], v[132:135]
  v_cvt_pk_bf16_f32 v217, v178, v179
  v_cvt_pk_bf16_f32 v216, v176, v177
  v_mfma_f32_16x16x32_bf16 v[132:135], a[212:215], a[132:135], v[132:135]
  v_cvt_pk_bf16_f32 v215, v174, v175
  v_cvt_pk_bf16_f32 v214, v172, v173
  v_mfma_f32_16x16x32_bf16 v[140:143], a[212:215], a[140:143], v[140:143]
  v_cvt_pk_bf16_f32 v213, v170, v171
  v_cvt_pk_bf16_f32 v212, v168, v169
  v_mfma_f32_16x16x32_bf16 v[140:143], a[208:211], a[136:139], v[140:143]
  v_cvt_pk_bf16_f32 v211, v166, v167
  v_cvt_pk_bf16_f32 v210, v164, v165
  v_mfma_f32_16x16x32_bf16 v[148:151], a[208:211], a[144:147], v[148:151]
  v_cvt_pk_bf16_f32 v209, v162, v163
  v_cvt_pk_bf16_f32 v208, v160, v161
  v_mfma_f32_16x16x32_bf16 v[148:151], a[212:215], a[148:151], v[148:151]
  v_mfma_f32_16x16x32_bf16 v[156:159], a[212:215], a[156:159], v[156:159]
  v_mfma_f32_16x16x32_bf16 v[156:159], a[208:211], a[152:155], v[156:159]
  s_waitcnt lgkmcnt(0)
  s_waitcnt vmcnt(16)
  s_barrier
  v_mfma_f32_16x16x32_bf16 v[156:159], a[216:219], a[184:187], v[156:159]
  ds_read_b128 a[204:207], v79 offset:0
  v_mfma_f32_16x16x32_bf16 v[156:159], a[220:223], a[188:191], v[156:159]
  v_mfma_f32_16x16x32_bf16 v[148:151], a[220:223], a[180:183], v[148:151]
  ds_read_b128 a[200:203], v78 offset:0
  v_mfma_f32_16x16x32_bf16 v[148:151], a[216:219], a[176:179], v[148:151]
  v_mfma_f32_16x16x32_bf16 v[140:143], a[216:219], a[168:171], v[140:143]
  ds_read_b128 a[196:199], v77 offset:0
  v_mfma_f32_16x16x32_bf16 v[140:143], a[220:223], a[172:175], v[140:143]
  v_mfma_f32_16x16x32_bf16 v[132:135], a[220:223], a[164:167], v[132:135]
  ds_read_b128 a[192:195], v76 offset:0
  v_mfma_f32_16x16x32_bf16 v[132:135], a[216:219], a[160:163], v[132:135]
  s_waitcnt lgkmcnt(0)
L_fm:
  s_waitcnt lgkmcnt(0)
  v_mfma_f32_16x16x32_bf16 v[68:71], a[204:207], v[252:255], 0
L_pad_fm3_0:
  s_cbranch_execz L_pad_fm3_1
  v_mfma_f32_16x16x32_bf16 v[64:67], a[204:207], v[248:251], 0
  v_mfma_f32_16x16x32_bf16 v[60:63], a[204:207], v[244:247], 0
  v_cvt_pk_bf16_f32 v207, v158, v159
  v_cvt_pk_bf16_f32 v206, v156, v157
  v_mfma_f32_16x16x32_bf16 v[56:59], a[204:207], v[240:243], 0
  v_cvt_pk_bf16_f32 v205, v154, v155
  v_cvt_pk_bf16_f32 v204, v152, v153
  v_mfma_f32_16x16x32_bf16 v[68:71], a[200:203], v[236:239], v[68:71]
  v_cvt_pk_bf16_f32 v203, v150, v151
  v_cvt_pk_bf16_f32 v202, v148, v149
  v_mfma_f32_16x16x32_bf16 v[64:67], a[200:203], v[232:235], v[64:67]
  v_cvt_pk_bf16_f32 v201, v146, v147
  v_cvt_pk_bf16_f32 v200, v144, v145
  v_mfma_f32_16x16x32_bf16 v[60:63], a[200:203], v[228:231], v[60:63]
  v_cvt_pk_bf16_f32 v199, v142, v143
  v_cvt_pk_bf16_f32 v198, v140, v141
  v_mfma_f32_16x16x32_bf16 v[56:59], a[200:203], v[224:227], v[56:59]
  v_cvt_pk_bf16_f32 v197, v138, v139
  v_cvt_pk_bf16_f32 v196, v136, v137
  v_mfma_f32_16x16x32_bf16 v[68:71], a[196:199], v[220:223], v[68:71]
  v_cvt_pk_bf16_f32 v195, v134, v135
  v_cvt_pk_bf16_f32 v194, v132, v133
  v_mfma_f32_16x16x32_bf16 v[64:67], a[196:199], v[216:219], v[64:67]
  v_cvt_pk_bf16_f32 v193, v130, v131
  v_cvt_pk_bf16_f32 v192, v128, v129
  v_mfma_f32_16x16x32_bf16 v[60:63], a[196:199], v[212:215], v[60:63]
  v_mov_b32 v8, 0
  v_mov_b32 v9, 0
  v_mfma_f32_16x16x32_bf16 v[56:59], a[196:199], v[208:211], v[56:59]
  v_mov_b32 v12, 0
  v_mov_b32 v13, 0
  v_mfma_f32_16x16x32_bf16 v[68:71], a[192:195], v[204:207], v[68:71]
  v_mov_b32 v16, 0
  v_mov_b32 v17, 0
  v_mfma_f32_16x16x32_bf16 v[64:67], a[192:195], v[200:203], v[64:67]
  v_mov_b32 v20, 0
  v_mov_b32 v21, 0
  v_mfma_f32_16x16x32_bf16 v[60:63], a[192:195], v[196:199], v[60:63]
  v_mfma_f32_16x16x32_bf16 v[56:59], a[192:195], v[192:195], v[56:59]
  s_nop 0
  v_max3_f32 v68, v68, v69, v70
  s_nop 1
  v_max3_f32 v64, v64, v65, v66
  s_nop 1
  v_max3_f32 v60, v60, v61, v62
  v_max3_f32 v56, v56, v57, v58
  v_max_f32 v68, v68, v71
  v_max_f32 v64, v64, v67
  v_max_f32 v60, v60, v63
  v_max_f32 v56, v56, v59
  v_mov_b32 v69, v68
  v_mov_b32 v65, v64
  v_mov_b32 v61, v60
  v_mov_b32 v57, v56
  v_permlane32_swap_b32 v68, v69
  v_permlane32_swap_b32 v64, v65
  v_permlane32_swap_b32 v60, v61
  v_permlane32_swap_b32 v56, v57
  v_max_f32 v68, v68, v69
  v_max_f32 v64, v64, v65
  v_max_f32 v60, v60, v61
  v_max_f32 v56, v56, v57
  v_mov_b32 v69, v68
  v_mov_b32 v65, v64
  v_mov_b32 v61, v60
  v_mov_b32 v57, v56
  v_permlane16_swap_b32 v68, v69
  v_permlane16_swap_b32 v64, v65
  v_permlane16_swap_b32 v60, v61
  v_permlane16_swap_b32 v56, v57
  v_max_f32 v68, v68, v69
  v_max_f32 v64, v64, v65
  v_max_f32 v60, v60, v61
  v_max_f32 v56, v56, v57
  v_sub_f32 v36, 0, v68
  v_sub_f32 v32, 0, v64
  v_sub_f32 v28, 0, v60
  v_sub_f32 v24, 0, v56
  v_sub_f32 v37, 0, v68
  v_sub_f32 v33, 0, v64
  v_sub_f32 v29, 0, v60
  v_sub_f32 v25, 0, v56
  v_sub_f32 v38, 0, v68
  v_sub_f32 v34, 0, v64
  v_sub_f32 v30, 0, v60
  v_sub_f32 v26, 0, v56
  v_sub_f32 v39, 0, v68
  v_sub_f32 v35, 0, v64
  v_sub_f32 v31, 0, v60
  v_sub_f32 v27, 0, v56
L_attn:
  s_nop 1
  v_mfma_f32_16x16x32_bf16 v[40:43], a[192:195], v[192:195], v[24:27]
  v_mfma_f32_16x16x32_bf16 v[40:43], a[196:199], v[208:211], v[40:43]
  v_mfma_f32_16x16x32_bf16 v[40:43], a[200:203], v[224:227], v[40:43]
  v_mfma_f32_16x16x32_bf16 v[40:43], a[204:207], v[240:243], v[40:43]
  s_add_u32 m0, s18, 32768
  v_mfma_f32_16x16x32_bf16 v[44:47], a[204:207], v[244:247], v[28:31]
  v_mfma_f32_16x16x32_bf16 v[44:47], a[200:203], v[228:231], v[44:47]
  s_add_u32 s16, s16, 16384
  v_mfma_f32_16x16x32_bf16 v[44:47], a[196:199], v[212:215], v[44:47]
  v_mfma_f32_16x16x32_bf16 v[44:47], a[192:195], v[196:199], v[44:47]
  buffer_load_dwordx4 v88, s[8:11], s16 offen offset:0 lds
  v_mfma_f32_16x16x32_bf16 v[48:51], a[192:195], v[200:203], v[32:35]
  v_exp_f32 v40, v40
  v_mfma_f32_16x16x32_bf16 v[48:51], a[196:199], v[216:219], v[48:51]
  v_mfma_f32_16x16x32_bf16 v[48:51], a[200:203], v[232:235], v[48:51]
  v_exp_f32 v41, v41
  v_mfma_f32_16x16x32_bf16 v[48:51], a[204:207], v[248:251], v[48:51]
  ds_read_b128 a[208:211], v76 offset:4096
  v_cvt_pk_bf16_f32 v128, v40, v41
  v_mfma_f32_16x16x32_bf16 v[52:55], a[204:207], v[252:255], v[36:39]
  v_exp_f32 v42, v42
  v_mfma_f32_16x16x32_bf16 v[52:55], a[200:203], v[236:239], v[52:55]
  ds_read_b128 a[212:215], v77 offset:4096
  v_mfma_f32_16x16x32_bf16 v[52:55], a[196:199], v[220:223], v[52:55]
  v_exp_f32 v43, v43
  v_mfma_f32_16x16x32_bf16 v[52:55], a[192:195], v[204:207], v[52:55]
  v_cvt_pk_bf16_f32 v129, v42, v43
  v_exp_f32 v44, v44
  ds_read_b128 a[216:219], v78 offset:4096
  v_exp_f32 v45, v45
  ds_read_b128 a[220:223], v79 offset:4096
  v_cvt_pk_bf16_f32 v136, v44, v45
  v_exp_f32 v46, v46
  v_exp_f32 v47, v47
  buffer_load_dwordx4 v89, s[8:11], s16 offen offset:1024 lds
  v_exp_f32 v48, v48
  v_cvt_pk_bf16_f32 v137, v46, v47
  v_exp_f32 v49, v49
  s_nop 0
  v_cvt_pk_bf16_f32 v144, v48, v49
  v_exp_f32 v50, v50
  v_exp_f32 v51, v51
  s_waitcnt lgkmcnt(0)
  v_cvt_pk_bf16_f32 v145, v50, v51
  v_mfma_f32_16x16x32_bf16 v[56:59], a[208:211], v[192:195], v[24:27]
  v_exp_f32 v52, v52
  v_mfma_f32_16x16x32_bf16 v[56:59], a[212:215], v[208:211], v[56:59]
  v_mfma_f32_16x16x32_bf16 v[56:59], a[216:219], v[224:227], v[56:59]
  v_exp_f32 v53, v53
  v_mfma_f32_16x16x32_bf16 v[56:59], a[220:223], v[240:243], v[56:59]
  v_cvt_pk_bf16_f32 v152, v52, v53
  v_mfma_f32_16x16x32_bf16 v[60:63], a[220:223], v[244:247], v[28:31]
  v_exp_f32 v54, v54
  v_mfma_f32_16x16x32_bf16 v[60:63], a[216:219], v[228:231], v[60:63]
  v_mfma_f32_16x16x32_bf16 v[60:63], a[212:215], v[212:215], v[60:63]
  v_exp_f32 v55, v55
  v_mfma_f32_16x16x32_bf16 v[60:63], a[208:211], v[196:199], v[60:63]
  buffer_load_dwordx4 v90, s[8:11], s16 offen offset:2048 lds
  v_mfma_f32_16x16x32_bf16 v[64:67], a[208:211], v[200:203], v[32:35]
  v_exp_f32 v56, v56
  v_mfma_f32_16x16x32_bf16 v[64:67], a[212:215], v[216:219], v[64:67]
  v_cvt_pk_bf16_f32 v153, v54, v55
  v_mfma_f32_16x16x32_bf16 v[64:67], a[216:219], v[232:235], v[64:67]
  v_exp_f32 v57, v57
  v_mfma_f32_16x16x32_bf16 v[64:67], a[220:223], v[248:251], v[64:67]
  ds_read_b128 a[192:195], v76 offset:8192
  v_cvt_pk_bf16_f32 v130, v56, v57
  v_mfma_f32_16x16x32_bf16 v[68:71], a[220:223], v[252:255], v[36:39]
  v_exp_f32 v58, v58
  v_mfma_f32_16x16x32_bf16 v[68:71], a[216:219], v[236:239], v[68:71]
  ds_read_b128 a[196:199], v77 offset:8192
  v_mfma_f32_16x16x32_bf16 v[68:71], a[212:215], v[220:223], v[68:71]
  v_exp_f32 v59, v59
  v_mfma_f32_16x16x32_bf16 v[68:71], a[208:211], v[204:207], v[68:71]
  v_cvt_pk_bf16_f32 v131, v58, v59
  v_exp_f32 v60, v60
  ds_read_b128 a[200:203], v78 offset:8192
  v_exp_f32 v61, v61
  ds_read_b128 a[204:207], v79 offset:8192
  v_cvt_pk_bf16_f32 v138, v60, v61
  v_exp_f32 v62, v62
  v_exp_f32 v63, v63
  buffer_load_dwordx4 v91, s[8:11], s16 offen offset:3072 lds
  v_exp_f32 v64, v64
  v_cvt_pk_bf16_f32 v139, v62, v63
  v_exp_f32 v65, v65
  s_nop 0
  v_cvt_pk_bf16_f32 v146, v64, v65
  v_exp_f32 v66, v66
  v_exp_f32 v67, v67
  s_nop 0
  v_cvt_pk_bf16_f32 v147, v66, v67
  v_exp_f32 v68, v68
  s_waitcnt lgkmcnt(0)
  v_mfma_f32_16x16x32_bf16 v[40:43], a[192:195], v[192:195], v[24:27]
  v_exp_f32 v69, v69
  v_mfma_f32_16x16x32_bf16 v[40:43], a[196:199], v[208:211], v[40:43]
  v_cvt_pk_bf16_f32 v154, v68, v69
  v_mfma_f32_16x16x32_bf16 v[40:43], a[200:203], v[224:227], v[40:43]
  v_exp_f32 v70, v70
  v_mfma_f32_16x16x32_bf16 v[40:43], a[204:207], v[240:243], v[40:43]
  s_add_u32 m0, s18, 98304
  v_mfma_f32_16x16x32_bf16 v[44:47], a[204:207], v[244:247], v[28:31]
  v_exp_f32 v71, v71
  v_mfma_f32_16x16x32_bf16 v[44:47], a[200:203], v[228:231], v[44:47]
  s_add_u32 s17, s17, 16384
  v_cvt_pk_bf16_f32 v155, v70, v71
  v_mfma_f32_16x16x32_bf16 v[44:47], a[196:199], v[212:215], v[44:47]
  v_mfma_f32_16x16x32_bf16 v[44:47], a[192:195], v[196:199], v[44:47]
  buffer_load_dwordx4 v92, s[12:15], s17 offen offset:0 lds
  v_mfma_f32_16x16x32_bf16 v[48:51], a[192:195], v[200:203], v[32:35]
  v_exp_f32 v40, v40
  v_mfma_f32_16x16x32_bf16 v[48:51], a[196:199], v[216:219], v[48:51]
  v_mfma_f32_16x16x32_bf16 v[48:51], a[200:203], v[232:235], v[48:51]
  v_exp_f32 v41, v41
  v_mfma_f32_16x16x32_bf16 v[48:51], a[204:207], v[248:251], v[48:51]
  ds_read_b128 a[208:211], v76 offset:12288
  v_cvt_pk_bf16_f32 v132, v40, v41
  v_mfma_f32_16x16x32_bf16 v[52:55], a[204:207], v[252:255], v[36:39]
  v_exp_f32 v42, v42
  v_mfma_f32_16x16x32_bf16 v[52:55], a[200:203], v[236:239], v[52:55]
  ds_read_b128 a[212:215], v77 offset:12288
  v_mfma_f32_16x16x32_bf16 v[52:55], a[196:199], v[220:223], v[52:55]
  v_exp_f32 v43, v43
  v_mfma_f32_16x16x32_bf16 v[52:55], a[192:195], v[204:207], v[52:55]
  v_cvt_pk_bf16_f32 v133, v42, v43
  v_exp_f32 v44, v44
  ds_read_b128 a[216:219], v78 offset:12288
  v_exp_f32 v45, v45
  ds_read_b128 a[220:223], v79 offset:12288
  v_cvt_pk_bf16_f32 v140, v44, v45
  v_exp_f32 v46, v46
  v_exp_f32 v47, v47
  buffer_load_dwordx4 v93, s[12:15], s17 offen offset:1024 lds
  v_exp_f32 v48, v48
  v_cvt_pk_bf16_f32 v141, v46, v47
  v_exp_f32 v49, v49
  s_nop 0
  v_cvt_pk_bf16_f32 v148, v48, v49
  v_exp_f32 v50, v50
  v_exp_f32 v51, v51
  s_waitcnt lgkmcnt(0)
  v_cvt_pk_bf16_f32 v149, v50, v51
  v_mfma_f32_16x16x32_bf16 v[56:59], a[208:211], v[192:195], v[24:27]
  v_exp_f32 v52, v52
  v_mfma_f32_16x16x32_bf16 v[56:59], a[212:215], v[208:211], v[56:59]
  v_mfma_f32_16x16x32_bf16 v[56:59], a[216:219], v[224:227], v[56:59]
  v_exp_f32 v53, v53
  v_mfma_f32_16x16x32_bf16 v[56:59], a[220:223], v[240:243], v[56:59]
  v_cvt_pk_bf16_f32 v156, v52, v53
  v_mfma_f32_16x16x32_bf16 v[60:63], a[220:223], v[244:247], v[28:31]
  v_exp_f32 v54, v54
  v_mfma_f32_16x16x32_bf16 v[60:63], a[216:219], v[228:231], v[60:63]
  v_mfma_f32_16x16x32_bf16 v[60:63], a[212:215], v[212:215], v[60:63]
  s_waitcnt vmcnt(14)
  s_barrier
  v_exp_f32 v55, v55
  v_mfma_f32_16x16x32_bf16 v[60:63], a[208:211], v[196:199], v[60:63]
  buffer_load_dwordx4 v92, s[12:15], s17 offen offset:2048 lds
  v_mfma_f32_16x16x32_bf16 v[64:67], a[208:211], v[200:203], v[32:35]
  v_exp_f32 v56, v56
  v_mfma_f32_16x16x32_bf16 v[64:67], a[212:215], v[216:219], v[64:67]
  v_cvt_pk_bf16_f32 v157, v54, v55
  v_mfma_f32_16x16x32_bf16 v[64:67], a[216:219], v[232:235], v[64:67]
  v_exp_f32 v57, v57
  v_mfma_f32_16x16x32_bf16 v[64:67], a[220:223], v[248:251], v[64:67]
  ds_read_b128 a[192:195], v76 offset:16384
  v_cvt_pk_bf16_f32 v134, v56, v57
  v_mfma_f32_16x16x32_bf16 v[68:71], a[220:223], v[252:255], v[36:39]
  v_exp_f32 v58, v58
  v_mfma_f32_16x16x32_bf16 v[68:71], a[216:219], v[236:239], v[68:71]
  ds_read_b128 a[196:199], v77 offset:16384
  v_mfma_f32_16x16x32_bf16 v[68:71], a[212:215], v[220:223], v[68:71]
  v_exp_f32 v59, v59
  v_mfma_f32_16x16x32_bf16 v[68:71], a[208:211], v[204:207], v[68:71]
  v_cvt_pk_bf16_f32 v135, v58, v59
  v_exp_f32 v60, v60
  ds_read_b128 a[200:203], v78 offset:16384
  v_exp_f32 v61, v61
  ds_read_b128 a[204:207], v79 offset:16384
  v_cvt_pk_bf16_f32 v142, v60, v61
  v_exp_f32 v62, v62
  v_exp_f32 v63, v63
  buffer_load_dwordx4 v93, s[12:15], s17 offen offset:3072 lds
  v_exp_f32 v64, v64
  ds_read_b64_tr_b16 a[224:225], v80 offset:49152
  v_cvt_pk_bf16_f32 v143, v62, v63
  v_exp_f32 v65, v65
  ds_read_b64_tr_b16 a[226:227], v80 offset:53248
  v_cvt_pk_bf16_f32 v150, v64, v65
  v_exp_f32 v66, v66
  ds_read_b64_tr_b16 a[228:229], v80 offset:57344
  v_exp_f32 v67, v67
  ds_read_b64_tr_b16 a[230:231], v80 offset:61440
  v_cvt_pk_bf16_f32 v151, v66, v67
  s_add_u32 m0, s100, 131072
  v_exp_f32 v68, v68
  s_waitcnt lgkmcnt(4)
  buffer_load_dwordx4 v72, s[4:7], s56 offen offset:0 lds
  v_mfma_f32_16x16x32_bf16 v[40:43], a[192:195], v[192:195], v[24:27]
  v_exp_f32 v69, v69
  v_mfma_f32_16x16x32_bf16 v[40:43], a[196:199], v[208:211], v[40:43]
  ds_read_b64_tr_b16 a[232:233], v81 offset:49152
  v_cvt_pk_bf16_f32 v158, v68, v69
  v_mfma_f32_16x16x32_bf16 v[40:43], a[200:203], v[224:227], v[40:43]
  v_exp_f32 v70, v70
  v_mfma_f32_16x16x32_bf16 v[40:43], a[204:207], v[240:243], v[40:43]
  s_add_u32 s16, s16, 16384
  ds_read_b64_tr_b16 a[234:235], v81 offset:53248
  v_mfma_f32_16x16x32_bf16 v[44:47], a[204:207], v[244:247], v[28:31]
  v_exp_f32 v71, v71
  v_mfma_f32_16x16x32_bf16 v[44:47], a[200:203], v[228:231], v[44:47]
  ds_read_b64_tr_b16 a[236:237], v81 offset:57344
  v_cvt_pk_bf16_f32 v159, v70, v71
  v_mfma_f32_16x16x32_bf16 v[44:47], a[196:199], v[212:215], v[44:47]
  s_add_u32 m0, s18, 49152
  v_mfma_f32_16x16x32_bf16 v[44:47], a[192:195], v[196:199], v[44:47]
  buffer_load_dwordx4 v88, s[8:11], s16 offen offset:0 lds
  v_mfma_f32_16x16x32_bf16 v[48:51], a[192:195], v[200:203], v[32:35]
  v_exp_f32 v40, v40
  v_mfma_f32_16x16x32_bf16 v[48:51], a[196:199], v[216:219], v[48:51]
  ds_read_b64_tr_b16 a[238:239], v81 offset:61440
  v_mfma_f32_16x16x32_bf16 v[48:51], a[200:203], v[232:235], v[48:51]
  v_exp_f32 v41, v41
  v_mfma_f32_16x16x32_bf16 v[48:51], a[204:207], v[248:251], v[48:51]
  ds_read_b128 a[208:211], v76 offset:20480
  v_cvt_pk_bf16_f32 v160, v40, v41
  v_mfma_f32_16x16x32_bf16 v[52:55], a[204:207], v[252:255], v[36:39]
  v_exp_f32 v42, v42
  v_mfma_f32_16x16x32_bf16 v[52:55], a[200:203], v[236:239], v[52:55]
  s_add_u32 m0, s100, 131072
  ds_read_b128 a[212:215], v77 offset:20480
  v_mfma_f32_16x16x32_bf16 v[52:55], a[196:199], v[220:223], v[52:55]
  s_add_u32 s56, s56, 4096
  v_exp_f32 v43, v43
  v_mfma_f32_16x16x32_bf16 v[52:55], a[192:195], v[204:207], v[52:55]
  s_waitcnt lgkmcnt(6)
  buffer_load_dwordx4 v73, s[4:7], s56 offen offset:1024 lds
  v_mfma_f32_16x16x32_bf16 a[0:3], a[224:227], v[128:131], 0
  v_exp_f32 v44, v44
  v_mfma_f32_16x16x32_bf16 a[0:3], a[228:231], v[132:135], a[0:3]
  ds_read_b128 a[216:219], v78 offset:20480
  v_cvt_pk_bf16_f32 v161, v42, v43
  v_mfma_f32_16x16x32_bf16 a[4:7], a[228:231], v[140:143], 0
  v_exp_f32 v45, v45
  v_mfma_f32_16x16x32_bf16 a[4:7], a[224:227], v[136:139], a[4:7]
  s_add_u32 m0, s100, 131072
  ds_read_b128 a[220:223], v79 offset:20480
  v_cvt_pk_bf16_f32 v168, v44, v45
  v_mfma_f32_16x16x32_bf16 a[8:11], a[224:227], v[144:147], 0
  s_add_u32 s56, s56, 4096
  v_exp_f32 v46, v46
  v_mfma_f32_16x16x32_bf16 a[8:11], a[228:231], v[148:151], a[8:11]
  buffer_load_dwordx4 v72, s[4:7], s56 offen offset:2048 lds
  v_mfma_f32_16x16x32_bf16 a[12:15], a[228:231], v[156:159], 0
  s_add_u32 m0, s18, 49152
  v_exp_f32 v47, v47
  v_mfma_f32_16x16x32_bf16 a[12:15], a[224:227], v[152:155], a[12:15]
  s_waitcnt lgkmcnt(4)
  buffer_load_dwordx4 v89, s[8:11], s16 offen offset:1024 lds
  v_mfma_f32_16x16x32_bf16 a[28:31], a[232:235], v[152:155], 0
  v_exp_f32 v48, v48
  v_mfma_f32_16x16x32_bf16 a[28:31], a[236:239], v[156:159], a[28:31]
  ds_read_b64_tr_b16 a[240:241], v82 offset:49152
  v_cvt_pk_bf16_f32 v169, v46, v47
  v_mfma_f32_16x16x32_bf16 a[24:27], a[236:239], v[148:151], 0
  v_exp_f32 v49, v49
  v_mfma_f32_16x16x32_bf16 a[24:27], a[232:235], v[144:147], a[24:27]
  ds_read_b64_tr_b16 a[242:243], v82 offset:53248
  v_cvt_pk_bf16_f32 v176, v48, v49
  v_mfma_f32_16x16x32_bf16 a[20:23], a[232:235], v[136:139], 0
  v_exp_f32 v50, v50
  v_mfma_f32_16x16x32_bf16 a[20:23], a[236:239], v[140:143], a[20:23]
  ds_read_b64_tr_b16 a[244:245], v82 offset:57344
  v_mfma_f32_16x16x32_bf16 a[16:19], a[236:239], v[132:135], 0
  v_exp_f32 v51, v51
  v_mfma_f32_16x16x32_bf16 a[16:19], a[232:235], v[128:131], a[16:19]
  s_waitcnt lgkmcnt(3)
  ds_read_b64_tr_b16 a[246:247], v82 offset:61440
  v_cvt_pk_bf16_f32 v177, v50, v51
  v_mfma_f32_16x16x32_bf16 v[56:59], a[208:211], v[192:195], v[24:27]
  v_exp_f32 v52, v52
  v_mfma_f32_16x16x32_bf16 v[56:59], a[212:215], v[208:211], v[56:59]
  ds_read_b64_tr_b16 a[248:249], v83 offset:49152
  v_mfma_f32_16x16x32_bf16 v[56:59], a[216:219], v[224:227], v[56:59]
  v_exp_f32 v53, v53
  v_mfma_f32_16x16x32_bf16 v[56:59], a[220:223], v[240:243], v[56:59]
  ds_read_b64_tr_b16 a[250:251], v83 offset:53248
  v_cvt_pk_bf16_f32 v184, v52, v53
  v_mfma_f32_16x16x32_bf16 v[60:63], a[220:223], v[244:247], v[28:31]
  v_exp_f32 v54, v54
  v_mfma_f32_16x16x32_bf16 v[60:63], a[216:219], v[228:231], v[60:63]
  ds_read_b64_tr_b16 a[252:253], v83 offset:57344
  v_mfma_f32_16x16x32_bf16 v[60:63], a[212:215], v[212:215], v[60:63]
  s_add_u32 m0, s18, 49152
  v_exp_f32 v55, v55
  v_mfma_f32_16x16x32_bf16 v[60:63], a[208:211], v[196:199], v[60:63]
  buffer_load_dwordx4 v90, s[8:11], s16 offen offset:2048 lds
  v_mfma_f32_16x16x32_bf16 v[64:67], a[208:211], v[200:203], v[32:35]
  v_exp_f32 v56, v56
  v_mfma_f32_16x16x32_bf16 v[64:67], a[212:215], v[216:219], v[64:67]
  ds_read_b64_tr_b16 a[254:255], v83 offset:61440
  v_cvt_pk_bf16_f32 v185, v54, v55
  v_mfma_f32_16x16x32_bf16 v[64:67], a[216:219], v[232:235], v[64:67]
  v_exp_f32 v57, v57
  v_mfma_f32_16x16x32_bf16 v[64:67], a[220:223], v[248:251], v[64:67]
  ds_read_b128 a[192:195], v76 offset:24576
  v_cvt_pk_bf16_f32 v162, v56, v57
  v_mfma_f32_16x16x32_bf16 v[68:71], a[220:223], v[252:255], v[36:39]
  v_exp_f32 v58, v58
  v_mfma_f32_16x16x32_bf16 v[68:71], a[216:219], v[236:239], v[68:71]
  s_add_u32 m0, s100, 131072
  ds_read_b128 a[196:199], v77 offset:24576
  v_mfma_f32_16x16x32_bf16 v[68:71], a[212:215], v[220:223], v[68:71]
  s_add_u32 s56, s56, 4096
  v_exp_f32 v59, v59
  v_mfma_f32_16x16x32_bf16 v[68:71], a[208:211], v[204:207], v[68:71]
  s_waitcnt lgkmcnt(6)
  buffer_load_dwordx4 v73, s[4:7], s56 offen offset:3072 lds
  v_mfma_f32_16x16x32_bf16 a[32:35], a[240:243], v[128:131], 0
  v_exp_f32 v60, v60
  v_mfma_f32_16x16x32_bf16 a[32:35], a[244:247], v[132:135], a[32:35]
  ds_read_b128 a[200:203], v78 offset:24576
  v_cvt_pk_bf16_f32 v163, v58, v59
  v_mfma_f32_16x16x32_bf16 a[36:39], a[244:247], v[140:143], 0
  v_exp_f32 v61, v61
  v_mfma_f32_16x16x32_bf16 a[36:39], a[240:243], v[136:139], a[36:39]
  s_add_u32 m0, s100, 135168
  ds_read_b128 a[204:207], v79 offset:24576
  v_cvt_pk_bf16_f32 v170, v60, v61
  v_mfma_f32_16x16x32_bf16 a[40:43], a[240:243], v[144:147], 0
  s_add_u32 s56, s56, 8192
  v_exp_f32 v62, v62
  v_mfma_f32_16x16x32_bf16 a[40:43], a[244:247], v[148:151], a[40:43]
  buffer_load_dwordx4 v72, s[4:7], s56 offen offset:0 lds
  v_mfma_f32_16x16x32_bf16 a[44:47], a[244:247], v[156:159], 0
  s_add_u32 m0, s18, 49152
  v_exp_f32 v63, v63
  v_mfma_f32_16x16x32_bf16 a[44:47], a[240:243], v[152:155], a[44:47]
  s_waitcnt lgkmcnt(4)
  buffer_load_dwordx4 v91, s[8:11], s16 offen offset:3072 lds
  v_mfma_f32_16x16x32_bf16 a[60:63], a[248:251], v[152:155], 0
  v_exp_f32 v64, v64
  v_mfma_f32_16x16x32_bf16 a[60:63], a[252:255], v[156:159], a[60:63]
  ds_read_b64_tr_b16 a[224:225], v84 offset:49152
  v_cvt_pk_bf16_f32 v171, v62, v63
  v_mfma_f32_16x16x32_bf16 a[56:59], a[252:255], v[148:151], 0
  v_exp_f32 v65, v65
  v_mfma_f32_16x16x32_bf16 a[56:59], a[248:251], v[144:147], a[56:59]
  ds_read_b64_tr_b16 a[226:227], v84 offset:53248
  v_cvt_pk_bf16_f32 v178, v64, v65
  v_mfma_f32_16x16x32_bf16 a[52:55], a[248:251], v[136:139], 0
  v_exp_f32 v66, v66
  v_mfma_f32_16x16x32_bf16 a[52:55], a[252:255], v[140:143], a[52:55]
  ds_read_b64_tr_b16 a[228:229], v84 offset:57344
  v_mfma_f32_16x16x32_bf16 a[48:51], a[252:255], v[132:135], 0
  v_exp_f32 v67, v67
  v_mfma_f32_16x16x32_bf16 a[48:51], a[248:251], v[128:131], a[48:51]
  s_add_u32 m0, s100, 135168
  ds_read_b64_tr_b16 a[230:231], v84 offset:61440
  v_cvt_pk_bf16_f32 v179, v66, v67
  v_smfmac_f32_16x16x64_bf16 v[8:11], v[4:7], v[128:135], v116
L_pad_fm3_1:
  s_cbranch_execz L_pad_fm3_2
  s_add_u32 s56, s56, 4096
  v_exp_f32 v68, v68
  v_smfmac_f32_16x16x64_bf16 v[12:15], v[4:7], v[136:143], v116
  s_waitcnt lgkmcnt(4)
  buffer_load_dwordx4 v73, s[4:7], s56 offen offset:1024 lds
  v_mfma_f32_16x16x32_bf16 v[40:43], a[192:195], v[192:195], v[24:27]
  v_exp_f32 v69, v69
  v_mfma_f32_16x16x32_bf16 v[40:43], a[196:199], v[208:211], v[40:43]
  ds_read_b64_tr_b16 a[232:233], v85 offset:49152
  v_cvt_pk_bf16_f32 v186, v68, v69
  v_mfma_f32_16x16x32_bf16 v[40:43], a[200:203], v[224:227], v[40:43]
  v_exp_f32 v70, v70
  v_mfma_f32_16x16x32_bf16 v[40:43], a[204:207], v[240:243], v[40:43]
  s_add_u32 s17, s17, 16384
  ds_read_b64_tr_b16 a[234:235], v85 offset:53248
  v_mfma_f32_16x16x32_bf16 v[44:47], a[204:207], v[244:247], v[28:31]
  v_exp_f32 v71, v71
  v_mfma_f32_16x16x32_bf16 v[44:47], a[200:203], v[228:231], v[44:47]
  ds_read_b64_tr_b16 a[236:237], v85 offset:57344
  v_cvt_pk_bf16_f32 v187, v70, v71
  v_mfma_f32_16x16x32_bf16 v[44:47], a[196:199], v[212:215], v[44:47]
  s_add_u32 m0, s18, 81920
  v_accvgpr_write_b32 a160, -1
  v_accvgpr_write_b32 a161, -1
  v_mfma_f32_16x16x32_bf16 v[44:47], a[192:195], v[196:199], v[44:47]
  buffer_load_dwordx4 v92, s[12:15], s17 offen offset:0 lds
  v_mfma_f32_16x16x32_bf16 v[48:51], a[192:195], v[200:203], v[32:35]
  v_exp_f32 v40, v40
  v_mfma_f32_16x16x32_bf16 v[48:51], a[196:199], v[216:219], v[48:51]
  ds_read_b64_tr_b16 a[238:239], v85 offset:61440
  v_accvgpr_write_b32 a162, -1
  v_mfma_f32_16x16x32_bf16 v[48:51], a[200:203], v[232:235], v[48:51]
  v_exp_f32 v41, v41
  v_mfma_f32_16x16x32_bf16 v[48:51], a[204:207], v[248:251], v[48:51]
  ds_read_b128 a[208:211], v76 offset:28672
  v_cvt_pk_bf16_f32 v164, v40, v41
  v_mfma_f32_16x16x32_bf16 v[52:55], a[204:207], v[252:255], v[36:39]
  v_exp_f32 v42, v42
  v_mfma_f32_16x16x32_bf16 v[52:55], a[200:203], v[236:239], v[52:55]
  s_add_u32 m0, s100, 135168
  ds_read_b128 a[212:215], v77 offset:28672
  v_accvgpr_write_b32 a163, -1
  v_mfma_f32_16x16x32_bf16 v[52:55], a[196:199], v[220:223], v[52:55]
  s_add_u32 s56, s56, 4096
  v_exp_f32 v43, v43
  v_mfma_f32_16x16x32_bf16 v[52:55], a[192:195], v[204:207], v[52:55]
  s_waitcnt lgkmcnt(6)
  buffer_load_dwordx4 v72, s[4:7], s56 offen offset:2048 lds
  v_mfma_f32_16x16x32_bf16 a[64:67], a[224:227], v[128:131], 0
  v_exp_f32 v44, v44
  v_mfma_f32_16x16x32_bf16 a[64:67], a[228:231], v[132:135], a[64:67]
  ds_read_b128 a[216:219], v78 offset:28672
  v_cvt_pk_bf16_f32 v165, v42, v43
  v_mfma_f32_16x16x32_bf16 a[68:71], a[228:231], v[140:143], 0
  v_exp_f32 v45, v45
  v_mfma_f32_16x16x32_bf16 a[68:71], a[224:227], v[136:139], a[68:71]
  s_add_u32 m0, s100, 135168
  ds_read_b128 a[220:223], v79 offset:28672
  v_cvt_pk_bf16_f32 v172, v44, v45
  v_mfma_f32_16x16x32_bf16 a[72:75], a[224:227], v[144:147], 0
  s_add_u32 s56, s56, 4096
  v_exp_f32 v46, v46
  v_mfma_f32_16x16x32_bf16 a[72:75], a[228:231], v[148:151], a[72:75]
  buffer_load_dwordx4 v73, s[4:7], s56 offen offset:3072 lds
  v_mfma_f32_16x16x32_bf16 a[76:79], a[228:231], v[156:159], 0
  s_add_u32 m0, s18, 81920
  v_exp_f32 v47, v47
  v_mfma_f32_16x16x32_bf16 a[76:79], a[224:227], v[152:155], a[76:79]
  s_waitcnt lgkmcnt(4)
  buffer_load_dwordx4 v93, s[12:15], s17 offen offset:1024 lds
  v_mfma_f32_16x16x32_bf16 a[92:95], a[232:235], v[152:155], 0
  v_exp_f32 v48, v48
  v_mfma_f32_16x16x32_bf16 a[92:95], a[236:239], v[156:159], a[92:95]
  ds_read_b64_tr_b16 a[240:241], v86 offset:49152
  v_cvt_pk_bf16_f32 v173, v46, v47
  v_mfma_f32_16x16x32_bf16 a[88:91], a[236:239], v[148:151], 0
  v_exp_f32 v49, v49
  v_mfma_f32_16x16x32_bf16 a[88:91], a[232:235], v[144:147], a[88:91]
  ds_read_b64_tr_b16 a[242:243], v86 offset:53248
  v_cvt_pk_bf16_f32 v180, v48, v49
  v_mfma_f32_16x16x32_bf16 a[84:87], a[232:235], v[136:139], 0
  v_exp_f32 v50, v50
  v_mfma_f32_16x16x32_bf16 a[84:87], a[236:239], v[140:143], a[84:87]
  ds_read_b64_tr_b16 a[244:245], v86 offset:57344
  v_mfma_f32_16x16x32_bf16 a[80:83], a[236:239], v[132:135], 0
  v_exp_f32 v51, v51
  v_mfma_f32_16x16x32_bf16 a[80:83], a[232:235], v[128:131], a[80:83]
  s_waitcnt lgkmcnt(3)
  ds_read_b64_tr_b16 a[246:247], v86 offset:61440
  v_cvt_pk_bf16_f32 v181, v50, v51
  v_mfma_f32_16x16x32_bf16 v[56:59], a[208:211], v[192:195], v[24:27]
  v_exp_f32 v52, v52
  v_mfma_f32_16x16x32_bf16 v[56:59], a[212:215], v[208:211], v[56:59]
  ds_read_b64_tr_b16 a[248:249], v87 offset:49152
  v_mfma_f32_16x16x32_bf16 v[56:59], a[216:219], v[224:227], v[56:59]
  v_exp_f32 v53, v53
  v_mfma_f32_16x16x32_bf16 v[56:59], a[220:223], v[240:243], v[56:59]
  ds_read_b64_tr_b16 a[250:251], v87 offset:53248
  v_cvt_pk_bf16_f32 v188, v52, v53
  v_mfma_f32_16x16x32_bf16 v[60:63], a[220:223], v[244:247], v[28:31]
  v_exp_f32 v54, v54
  v_mfma_f32_16x16x32_bf16 v[60:63], a[216:219], v[228:231], v[60:63]
  ds_read_b64_tr_b16 a[252:253], v87 offset:57344
  v_mfma_f32_16x16x32_bf16 v[60:63], a[212:215], v[212:215], v[60:63]
  s_add_u32 m0, s18, 81920
  s_waitcnt vmcnt(14)
  s_barrier
  v_exp_f32 v55, v55
  v_mfma_f32_16x16x32_bf16 v[60:63], a[208:211], v[196:199], v[60:63]
  buffer_load_dwordx4 v92, s[12:15], s17 offen offset:2048 lds
  v_mfma_f32_16x16x32_bf16 v[64:67], a[208:211], v[200:203], v[32:35]
  v_exp_f32 v56, v56
  v_mfma_f32_16x16x32_bf16 v[64:67], a[212:215], v[216:219], v[64:67]
  ds_read_b64_tr_b16 a[254:255], v87 offset:61440
  v_cvt_pk_bf16_f32 v189, v54, v55
  v_mfma_f32_16x16x32_bf16 v[64:67], a[216:219], v[232:235], v[64:67]
  v_exp_f32 v57, v57
  v_mfma_f32_16x16x32_bf16 v[64:67], a[220:223], v[248:251], v[64:67]
  ds_read_b128 a[192:195], v76 offset:32768
  v_cvt_pk_bf16_f32 v166, v56, v57
  v_mfma_f32_16x16x32_bf16 v[68:71], a[220:223], v[252:255], v[36:39]
  v_exp_f32 v58, v58
  v_mfma_f32_16x16x32_bf16 v[68:71], a[216:219], v[236:239], v[68:71]
  ds_read_b128 a[196:199], v77 offset:32768
  v_mfma_f32_16x16x32_bf16 v[68:71], a[212:215], v[220:223], v[68:71]
  v_exp_f32 v59, v59
  v_mfma_f32_16x16x32_bf16 v[68:71], a[208:211], v[204:207], v[68:71]
  s_waitcnt lgkmcnt(6)
  v_cvt_pk_bf16_f32 v167, v58, v59
  v_mfma_f32_16x16x32_bf16 a[96:99], a[240:243], v[128:131], 0
  v_exp_f32 v60, v60
  v_mfma_f32_16x16x32_bf16 a[96:99], a[244:247], v[132:135], a[96:99]
  ds_read_b128 a[200:203], v78 offset:32768
  v_mfma_f32_16x16x32_bf16 a[100:103], a[244:247], v[140:143], 0
  v_exp_f32 v61, v61
  v_mfma_f32_16x16x32_bf16 a[100:103], a[240:243], v[136:139], a[100:103]
  ds_read_b128 a[204:207], v79 offset:32768
  v_cvt_pk_bf16_f32 v174, v60, v61
  v_mfma_f32_16x16x32_bf16 a[104:107], a[240:243], v[144:147], 0
  v_exp_f32 v62, v62
  v_mfma_f32_16x16x32_bf16 a[104:107], a[244:247], v[148:151], a[104:107]
  v_mfma_f32_16x16x32_bf16 a[108:111], a[244:247], v[156:159], 0
  s_add_u32 m0, s18, 81920
  v_exp_f32 v63, v63
  v_mfma_f32_16x16x32_bf16 a[108:111], a[240:243], v[152:155], a[108:111]
  s_waitcnt lgkmcnt(4)
  buffer_load_dwordx4 v93, s[12:15], s17 offen offset:3072 lds
  v_mfma_f32_16x16x32_bf16 a[124:127], a[248:251], v[152:155], 0
  v_exp_f32 v64, v64
  v_mfma_f32_16x16x32_bf16 a[124:127], a[252:255], v[156:159], a[124:127]
  ds_read_b64_tr_b16 a[224:225], v80 offset:32768
  v_cvt_pk_bf16_f32 v175, v62, v63
  v_mfma_f32_16x16x32_bf16 a[120:123], a[252:255], v[148:151], 0
  v_exp_f32 v65, v65
  v_mfma_f32_16x16x32_bf16 a[120:123], a[248:251], v[144:147], a[120:123]
  ds_read_b64_tr_b16 a[226:227], v80 offset:36864
  v_cvt_pk_bf16_f32 v182, v64, v65
  v_mfma_f32_16x16x32_bf16 a[116:119], a[248:251], v[136:139], 0
  v_exp_f32 v66, v66
  v_mfma_f32_16x16x32_bf16 a[116:119], a[252:255], v[140:143], a[116:119]
  ds_read_b64_tr_b16 a[228:229], v80 offset:40960
  v_mfma_f32_16x16x32_bf16 a[112:115], a[252:255], v[132:135], 0
  v_exp_f32 v67, v67
  v_mfma_f32_16x16x32_bf16 a[112:115], a[248:251], v[128:131], a[112:115]
  ds_read_b64_tr_b16 a[230:231], v80 offset:45056
  v_cvt_pk_bf16_f32 v183, v66, v67
  v_smfmac_f32_16x16x64_bf16 v[16:19], v[4:7], v[144:151], v116
  v_exp_f32 v68, v68
  v_smfmac_f32_16x16x64_bf16 v[20:23], v[4:7], v[152:159], v116
  s_waitcnt lgkmcnt(4)
  v_mfma_f32_16x16x32_bf16 v[40:43], a[192:195], v[192:195], v[24:27]
  v_exp_f32 v69, v69
  v_mfma_f32_16x16x32_bf16 v[40:43], a[196:199], v[208:211], v[40:43]
  ds_read_b64_tr_b16 a[232:233], v81 offset:32768
  v_cvt_pk_bf16_f32 v190, v68, v69
  v_mfma_f32_16x16x32_bf16 v[40:43], a[200:203], v[224:227], v[40:43]
  v_exp_f32 v70, v70
  v_mfma_f32_16x16x32_bf16 v[40:43], a[204:207], v[240:243], v[40:43]
  s_add_u32 m0, s18, 0
  ds_read_b64_tr_b16 a[234:235], v81 offset:36864
  v_mfma_f32_16x16x32_bf16 v[44:47], a[204:207], v[244:247], v[28:31]
  v_exp_f32 v71, v71
  v_mfma_f32_16x16x32_bf16 v[44:47], a[200:203], v[228:231], v[44:47]
  s_add_u32 s16, s16, 16384
  ds_read_b64_tr_b16 a[236:237], v81 offset:40960
  v_cvt_pk_bf16_f32 v191, v70, v71
  v_mfma_f32_16x16x32_bf16 v[44:47], a[196:199], v[212:215], v[44:47]
  v_mfma_f32_16x16x32_bf16 v[44:47], a[192:195], v[196:199], v[44:47]
  buffer_load_dwordx4 v88, s[8:11], s16 offen offset:0 lds
  v_mfma_f32_16x16x32_bf16 v[48:51], a[192:195], v[200:203], v[32:35]
  v_exp_f32 v40, v40
  v_mfma_f32_16x16x32_bf16 v[48:51], a[196:199], v[216:219], v[48:51]
  ds_read_b64_tr_b16 a[238:239], v81 offset:45056
  v_mfma_f32_16x16x32_bf16 v[48:51], a[200:203], v[232:235], v[48:51]
  v_exp_f32 v41, v41
  v_mfma_f32_16x16x32_bf16 v[48:51], a[204:207], v[248:251], v[48:51]
  ds_read_b128 a[208:211], v76 offset:36864
  v_cvt_pk_bf16_f32 v128, v40, v41
  v_mfma_f32_16x16x32_bf16 v[52:55], a[204:207], v[252:255], v[36:39]
  v_exp_f32 v42, v42
  v_mfma_f32_16x16x32_bf16 v[52:55], a[200:203], v[236:239], v[52:55]
  ds_read_b128 a[212:215], v77 offset:36864
  v_mfma_f32_16x16x32_bf16 v[52:55], a[196:199], v[220:223], v[52:55]
  v_exp_f32 v43, v43
  v_mfma_f32_16x16x32_bf16 v[52:55], a[192:195], v[204:207], v[52:55]
  s_waitcnt lgkmcnt(6)
  v_cvt_pk_bf16_f32 v129, v42, v43
  v_mfma_f32_16x16x32_bf16 a[0:3], a[224:227], v[160:163], a[0:3]
  v_exp_f32 v44, v44
  v_mfma_f32_16x16x32_bf16 a[0:3], a[228:231], v[164:167], a[0:3]
  ds_read_b128 a[216:219], v78 offset:36864
  v_mfma_f32_16x16x32_bf16 a[4:7], a[228:231], v[172:175], a[4:7]
  v_exp_f32 v45, v45
  v_mfma_f32_16x16x32_bf16 a[4:7], a[224:227], v[168:171], a[4:7]
  ds_read_b128 a[220:223], v79 offset:36864
  v_cvt_pk_bf16_f32 v136, v44, v45
  v_mfma_f32_16x16x32_bf16 a[8:11], a[224:227], v[176:179], a[8:11]
  v_exp_f32 v46, v46
  v_mfma_f32_16x16x32_bf16 a[8:11], a[228:231], v[180:183], a[8:11]
  buffer_store_dwordx4 a[160:163], v3, s[32:35], s86 offen offset:2048 sc1
  v_mfma_f32_16x16x32_bf16 a[12:15], a[228:231], v[188:191], a[12:15]
  v_exp_f32 v47, v47
  v_mfma_f32_16x16x32_bf16 a[12:15], a[224:227], v[184:187], a[12:15]
  s_waitcnt lgkmcnt(4)
  buffer_load_dwordx4 v89, s[8:11], s16 offen offset:1024 lds
  v_mfma_f32_16x16x32_bf16 a[28:31], a[232:235], v[184:187], a[28:31]
  v_exp_f32 v48, v48
  v_mfma_f32_16x16x32_bf16 a[28:31], a[236:239], v[188:191], a[28:31]
  ds_read_b64_tr_b16 a[240:241], v82 offset:32768
  v_cvt_pk_bf16_f32 v137, v46, v47
  v_mfma_f32_16x16x32_bf16 a[24:27], a[236:239], v[180:183], a[24:27]
  v_exp_f32 v49, v49
  v_mfma_f32_16x16x32_bf16 a[24:27], a[232:235], v[176:179], a[24:27]
  ds_read_b64_tr_b16 a[242:243], v82 offset:36864
  v_cvt_pk_bf16_f32 v144, v48, v49
  v_mfma_f32_16x16x32_bf16 a[20:23], a[232:235], v[168:171], a[20:23]
  v_exp_f32 v50, v50
  v_mfma_f32_16x16x32_bf16 a[20:23], a[236:239], v[172:175], a[20:23]
  ds_read_b64_tr_b16 a[244:245], v82 offset:40960
  v_mfma_f32_16x16x32_bf16 a[16:19], a[236:239], v[164:167], a[16:19]
  v_exp_f32 v51, v51
  v_mfma_f32_16x16x32_bf16 a[16:19], a[232:235], v[160:163], a[16:19]
  s_waitcnt lgkmcnt(3)
  ds_read_b64_tr_b16 a[246:247], v82 offset:45056
  v_cvt_pk_bf16_f32 v145, v50, v51
  v_mfma_f32_16x16x32_bf16 v[56:59], a[208:211], v[192:195], v[24:27]
  v_exp_f32 v52, v52
  v_mfma_f32_16x16x32_bf16 v[56:59], a[212:215], v[208:211], v[56:59]
  ds_read_b64_tr_b16 a[248:249], v83 offset:32768
  v_mfma_f32_16x16x32_bf16 v[56:59], a[216:219], v[224:227], v[56:59]
  v_exp_f32 v53, v53
  v_mfma_f32_16x16x32_bf16 v[56:59], a[220:223], v[240:243], v[56:59]
  ds_read_b64_tr_b16 a[250:251], v83 offset:36864
  v_cvt_pk_bf16_f32 v152, v52, v53
  v_mfma_f32_16x16x32_bf16 v[60:63], a[220:223], v[244:247], v[28:31]
  v_exp_f32 v54, v54
  v_mfma_f32_16x16x32_bf16 v[60:63], a[216:219], v[228:231], v[60:63]
  ds_read_b64_tr_b16 a[252:253], v83 offset:40960
  v_mfma_f32_16x16x32_bf16 v[60:63], a[212:215], v[212:215], v[60:63]
  v_exp_f32 v55, v55
  v_mfma_f32_16x16x32_bf16 v[60:63], a[208:211], v[196:199], v[60:63]
  buffer_load_dwordx4 v90, s[8:11], s16 offen offset:2048 lds
  v_mfma_f32_16x16x32_bf16 v[64:67], a[208:211], v[200:203], v[32:35]
  v_exp_f32 v56, v56
  v_mfma_f32_16x16x32_bf16 v[64:67], a[212:215], v[216:219], v[64:67]
  ds_read_b64_tr_b16 a[254:255], v83 offset:45056
  v_cvt_pk_bf16_f32 v153, v54, v55
  v_mfma_f32_16x16x32_bf16 v[64:67], a[216:219], v[232:235], v[64:67]
  v_exp_f32 v57, v57
  v_mfma_f32_16x16x32_bf16 v[64:67], a[220:223], v[248:251], v[64:67]
  ds_read_b128 a[192:195], v76 offset:40960
  v_cvt_pk_bf16_f32 v130, v56, v57
  v_mfma_f32_16x16x32_bf16 v[68:71], a[220:223], v[252:255], v[36:39]
  v_exp_f32 v58, v58
  v_mfma_f32_16x16x32_bf16 v[68:71], a[216:219], v[236:239], v[68:71]
  ds_read_b128 a[196:199], v77 offset:40960
  v_mfma_f32_16x16x32_bf16 v[68:71], a[212:215], v[220:223], v[68:71]
  v_exp_f32 v59, v59
  v_mfma_f32_16x16x32_bf16 v[68:71], a[208:211], v[204:207], v[68:71]
  s_waitcnt lgkmcnt(6)
  v_cvt_pk_bf16_f32 v131, v58, v59
  v_mfma_f32_16x16x32_bf16 a[32:35], a[240:243], v[160:163], a[32:35]
  v_exp_f32 v60, v60
  v_mfma_f32_16x16x32_bf16 a[32:35], a[244:247], v[164:167], a[32:35]
  ds_read_b128 a[200:203], v78 offset:40960
  v_mfma_f32_16x16x32_bf16 a[36:39], a[244:247], v[172:175], a[36:39]
  v_exp_f32 v61, v61
  v_mfma_f32_16x16x32_bf16 a[36:39], a[240:243], v[168:171], a[36:39]
  ds_read_b128 a[204:207], v79 offset:40960
  v_cvt_pk_bf16_f32 v138, v60, v61
  v_mfma_f32_16x16x32_bf16 a[40:43], a[240:243], v[176:179], a[40:43]
  v_exp_f32 v62, v62
  v_mfma_f32_16x16x32_bf16 a[40:43], a[244:247], v[180:183], a[40:43]
  v_mfma_f32_16x16x32_bf16 a[44:47], a[244:247], v[188:191], a[44:47]
  v_exp_f32 v63, v63
  v_mfma_f32_16x16x32_bf16 a[44:47], a[240:243], v[184:187], a[44:47]
  s_waitcnt lgkmcnt(4)
  buffer_load_dwordx4 v91, s[8:11], s16 offen offset:3072 lds
  v_mfma_f32_16x16x32_bf16 a[60:63], a[248:251], v[184:187], a[60:63]
  v_exp_f32 v64, v64
  v_mfma_f32_16x16x32_bf16 a[60:63], a[252:255], v[188:191], a[60:63]
  ds_read_b64_tr_b16 a[224:225], v84 offset:32768
  v_cvt_pk_bf16_f32 v139, v62, v63
  v_mfma_f32_16x16x32_bf16 a[56:59], a[252:255], v[180:183], a[56:59]
  v_exp_f32 v65, v65
  v_mfma_f32_16x16x32_bf16 a[56:59], a[248:251], v[176:179], a[56:59]
  ds_read_b64_tr_b16 a[226:227], v84 offset:36864
  v_cvt_pk_bf16_f32 v146, v64, v65
  v_mfma_f32_16x16x32_bf16 a[52:55], a[248:251], v[168:171], a[52:55]
  v_exp_f32 v66, v66
  v_mfma_f32_16x16x32_bf16 a[52:55], a[252:255], v[172:175], a[52:55]
  ds_read_b64_tr_b16 a[228:229], v84 offset:40960
  v_mfma_f32_16x16x32_bf16 a[48:51], a[252:255], v[164:167], a[48:51]
  v_exp_f32 v67, v67
  v_mfma_f32_16x16x32_bf16 a[48:51], a[248:251], v[160:163], a[48:51]
  ds_read_b64_tr_b16 a[230:231], v84 offset:45056
  v_cvt_pk_bf16_f32 v147, v66, v67
  v_smfmac_f32_16x16x64_bf16 v[8:11], v[4:7], v[160:167], v116
  v_exp_f32 v68, v68
  v_smfmac_f32_16x16x64_bf16 v[12:15], v[4:7], v[168:175], v116
  s_waitcnt lgkmcnt(4)
  v_mfma_f32_16x16x32_bf16 v[40:43], a[192:195], v[192:195], v[24:27]
  v_exp_f32 v69, v69
  v_mfma_f32_16x16x32_bf16 v[40:43], a[196:199], v[208:211], v[40:43]
  ds_read_b64_tr_b16 a[232:233], v85 offset:32768
  v_cvt_pk_bf16_f32 v154, v68, v69
  v_mfma_f32_16x16x32_bf16 v[40:43], a[200:203], v[224:227], v[40:43]
  v_exp_f32 v70, v70
  v_mfma_f32_16x16x32_bf16 v[40:43], a[204:207], v[240:243], v[40:43]
  s_add_u32 m0, s18, 65536
  ds_read_b64_tr_b16 a[234:235], v85 offset:36864
  v_mfma_f32_16x16x32_bf16 v[44:47], a[204:207], v[244:247], v[28:31]
  v_exp_f32 v71, v71
  v_mfma_f32_16x16x32_bf16 v[44:47], a[200:203], v[228:231], v[44:47]
  s_add_u32 s17, s17, 16384
  ds_read_b64_tr_b16 a[236:237], v85 offset:40960
  v_cvt_pk_bf16_f32 v155, v70, v71
  v_mfma_f32_16x16x32_bf16 v[44:47], a[196:199], v[212:215], v[44:47]
  v_mfma_f32_16x16x32_bf16 v[44:47], a[192:195], v[196:199], v[44:47]
  buffer_load_dwordx4 v92, s[12:15], s17 offen offset:0 lds
  v_mfma_f32_16x16x32_bf16 v[48:51], a[192:195], v[200:203], v[32:35]
  v_exp_f32 v40, v40
  v_mfma_f32_16x16x32_bf16 v[48:51], a[196:199], v[216:219], v[48:51]
  ds_read_b64_tr_b16 a[238:239], v85 offset:45056
  v_mfma_f32_16x16x32_bf16 v[48:51], a[200:203], v[232:235], v[48:51]
  v_exp_f32 v41, v41
  v_mfma_f32_16x16x32_bf16 v[48:51], a[204:207], v[248:251], v[48:51]
  ds_read_b128 a[208:211], v76 offset:45056
  v_cvt_pk_bf16_f32 v132, v40, v41
  v_mfma_f32_16x16x32_bf16 v[52:55], a[204:207], v[252:255], v[36:39]
  v_exp_f32 v42, v42
  v_mfma_f32_16x16x32_bf16 v[52:55], a[200:203], v[236:239], v[52:55]
  ds_read_b128 a[212:215], v77 offset:45056
  v_mfma_f32_16x16x32_bf16 v[52:55], a[196:199], v[220:223], v[52:55]
  v_exp_f32 v43, v43
  v_mfma_f32_16x16x32_bf16 v[52:55], a[192:195], v[204:207], v[52:55]
  s_waitcnt lgkmcnt(6)
  buffer_store_dwordx4 a[160:163], v3, s[32:35], s86 offen offset:3072 sc1
  v_mfma_f32_16x16x32_bf16 a[64:67], a[224:227], v[160:163], a[64:67]
  v_exp_f32 v44, v44
  v_mfma_f32_16x16x32_bf16 a[64:67], a[228:231], v[164:167], a[64:67]
  ds_read_b128 a[216:219], v78 offset:45056
  v_cvt_pk_bf16_f32 v133, v42, v43
  v_mfma_f32_16x16x32_bf16 a[68:71], a[228:231], v[172:175], a[68:71]
  v_exp_f32 v45, v45
  v_mfma_f32_16x16x32_bf16 a[68:71], a[224:227], v[168:171], a[68:71]
  ds_read_b128 a[220:223], v79 offset:45056
  v_cvt_pk_bf16_f32 v140, v44, v45
  v_mfma_f32_16x16x32_bf16 a[72:75], a[224:227], v[176:179], a[72:75]
  v_exp_f32 v46, v46
  v_mfma_f32_16x16x32_bf16 a[72:75], a[228:231], v[180:183], a[72:75]
  v_mfma_f32_16x16x32_bf16 a[76:79], a[228:231], v[188:191], a[76:79]
  v_exp_f32 v47, v47
  v_mfma_f32_16x16x32_bf16 a[76:79], a[224:227], v[184:187], a[76:79]
  s_waitcnt lgkmcnt(4)
  buffer_load_dwordx4 v93, s[12:15], s17 offen offset:1024 lds
  v_mfma_f32_16x16x32_bf16 a[92:95], a[232:235], v[184:187], a[92:95]
  v_exp_f32 v48, v48
  v_mfma_f32_16x16x32_bf16 a[92:95], a[236:239], v[188:191], a[92:95]
  ds_read_b64_tr_b16 a[240:241], v86 offset:32768
  v_cvt_pk_bf16_f32 v141, v46, v47
  v_mfma_f32_16x16x32_bf16 a[88:91], a[236:239], v[180:183], a[88:91]
  v_exp_f32 v49, v49
  v_mfma_f32_16x16x32_bf16 a[88:91], a[232:235], v[176:179], a[88:91]
  ds_read_b64_tr_b16 a[242:243], v86 offset:36864
  v_cvt_pk_bf16_f32 v148, v48, v49
  v_mfma_f32_16x16x32_bf16 a[84:87], a[232:235], v[168:171], a[84:87]
  v_exp_f32 v50, v50
  v_mfma_f32_16x16x32_bf16 a[84:87], a[236:239], v[172:175], a[84:87]
  ds_read_b64_tr_b16 a[244:245], v86 offset:40960
  v_mfma_f32_16x16x32_bf16 a[80:83], a[236:239], v[164:167], a[80:83]
  v_exp_f32 v51, v51
  v_mfma_f32_16x16x32_bf16 a[80:83], a[232:235], v[160:163], a[80:83]
  s_waitcnt lgkmcnt(3)
  ds_read_b64_tr_b16 a[246:247], v86 offset:45056
  v_cvt_pk_bf16_f32 v149, v50, v51
  v_mfma_f32_16x16x32_bf16 v[56:59], a[208:211], v[192:195], v[24:27]
  v_exp_f32 v52, v52
  v_mfma_f32_16x16x32_bf16 v[56:59], a[212:215], v[208:211], v[56:59]
  ds_read_b64_tr_b16 a[248:249], v87 offset:32768
  v_mfma_f32_16x16x32_bf16 v[56:59], a[216:219], v[224:227], v[56:59]
  v_exp_f32 v53, v53
  v_mfma_f32_16x16x32_bf16 v[56:59], a[220:223], v[240:243], v[56:59]
  ds_read_b64_tr_b16 a[250:251], v87 offset:36864
  v_cvt_pk_bf16_f32 v156, v52, v53
  v_mfma_f32_16x16x32_bf16 v[60:63], a[220:223], v[244:247], v[28:31]
  v_exp_f32 v54, v54
  v_mfma_f32_16x16x32_bf16 v[60:63], a[216:219], v[228:231], v[60:63]
  ds_read_b64_tr_b16 a[252:253], v87 offset:40960
  v_mfma_f32_16x16x32_bf16 v[60:63], a[212:215], v[212:215], v[60:63]
  s_waitcnt vmcnt(8)
  s_barrier
  v_exp_f32 v55, v55
  v_mfma_f32_16x16x32_bf16 v[60:63], a[208:211], v[196:199], v[60:63]
  buffer_load_dwordx4 v92, s[12:15], s17 offen offset:2048 lds
  v_mfma_f32_16x16x32_bf16 v[64:67], a[208:211], v[200:203], v[32:35]
  v_exp_f32 v56, v56
  v_mfma_f32_16x16x32_bf16 v[64:67], a[212:215], v[216:219], v[64:67]
  ds_read_b64_tr_b16 a[254:255], v87 offset:45056
  v_add_u32 v96, s101, v80
  v_mfma_f32_16x16x32_bf16 v[64:67], a[216:219], v[232:235], v[64:67]
  v_exp_f32 v57, v57
  v_mfma_f32_16x16x32_bf16 v[64:67], a[220:223], v[248:251], v[64:67]
  ds_read_b128 a[192:195], v76 offset:49152
  v_cvt_pk_bf16_f32 v157, v54, v55
  v_mfma_f32_16x16x32_bf16 v[68:71], a[220:223], v[252:255], v[36:39]
  v_exp_f32 v58, v58
  v_mfma_f32_16x16x32_bf16 v[68:71], a[216:219], v[236:239], v[68:71]
  ds_read_b128 a[196:199], v77 offset:49152
  ds_read_b64_tr_b16 a[128:129], v96 offset:0
  v_mfma_f32_16x16x32_bf16 v[68:71], a[212:215], v[220:223], v[68:71]
  v_exp_f32 v59, v59
  v_mfma_f32_16x16x32_bf16 v[68:71], a[208:211], v[204:207], v[68:71]
  s_waitcnt lgkmcnt(7)
  v_cvt_pk_bf16_f32 v134, v56, v57
  v_cvt_pk_bf16_f32 v135, v58, v59
  v_mfma_f32_16x16x32_bf16 a[96:99], a[240:243], v[160:163], a[96:99]
  v_exp_f32 v60, v60
  v_mfma_f32_16x16x32_bf16 a[96:99], a[244:247], v[164:167], a[96:99]
  ds_read_b128 a[200:203], v78 offset:49152
  ds_read_b64_tr_b16 a[130:131], v96 offset:4096
  v_mfma_f32_16x16x32_bf16 a[100:103], a[244:247], v[172:175], a[100:103]
  v_exp_f32 v61, v61
  v_mfma_f32_16x16x32_bf16 a[100:103], a[240:243], v[168:171], a[100:103]
  s_add_u32 s86, s86, 4096
  ds_read_b128 a[204:207], v79 offset:49152
  v_add_u32 v97, s101, v81
  v_mfma_f32_16x16x32_bf16 a[104:107], a[240:243], v[176:179], a[104:107]
  v_exp_f32 v62, v62
  v_mfma_f32_16x16x32_bf16 a[104:107], a[244:247], v[180:183], a[104:107]
  buffer_store_dwordx4 a[160:163], v3, s[32:35], s86 offen offset:0 sc1
  v_mfma_f32_16x16x32_bf16 a[108:111], a[244:247], v[188:191], a[108:111]
  v_exp_f32 v63, v63
  v_mfma_f32_16x16x32_bf16 a[108:111], a[240:243], v[184:187], a[108:111]
  s_waitcnt lgkmcnt(6)
  buffer_load_dwordx4 v93, s[12:15], s17 offen offset:3072 lds
  v_mfma_f32_16x16x32_bf16 a[124:127], a[248:251], v[184:187], a[124:127]
  v_exp_f32 v64, v64
  v_mfma_f32_16x16x32_bf16 a[124:127], a[252:255], v[188:191], a[124:127]
  ds_read_b64_tr_b16 a[224:225], v80 offset:16384
  ds_read_b64_tr_b16 a[132:133], v97 offset:0
  v_mfma_f32_16x16x32_bf16 a[120:123], a[252:255], v[180:183], a[120:123]
  v_exp_f32 v65, v65
  v_mfma_f32_16x16x32_bf16 a[120:123], a[248:251], v[176:179], a[120:123]
  ds_read_b64_tr_b16 a[226:227], v80 offset:20480
  v_cvt_pk_bf16_f32 v142, v60, v61
  v_mfma_f32_16x16x32_bf16 a[116:119], a[248:251], v[168:171], a[116:119]
  v_exp_f32 v66, v66
  v_mfma_f32_16x16x32_bf16 a[116:119], a[252:255], v[172:175], a[116:119]
  ds_read_b64_tr_b16 a[228:229], v80 offset:24576
  ds_read_b64_tr_b16 a[134:135], v97 offset:4096
  v_mfma_f32_16x16x32_bf16 a[112:115], a[252:255], v[164:167], a[112:115]
  v_exp_f32 v67, v67
  v_mfma_f32_16x16x32_bf16 a[112:115], a[248:251], v[160:163], a[112:115]
  ds_read_b64_tr_b16 a[230:231], v80 offset:28672
  v_cvt_pk_bf16_f32 v143, v62, v63
  v_smfmac_f32_16x16x64_bf16 v[16:19], v[4:7], v[176:183], v116
  v_exp_f32 v68, v68
  v_smfmac_f32_16x16x64_bf16 v[20:23], v[4:7], v[184:191], v116
  s_waitcnt lgkmcnt(6)
  v_cvt_pk_bf16_f32 v150, v64, v65
  v_cvt_pk_bf16_f32 v151, v66, v67
  v_mfma_f32_16x16x32_bf16 v[40:43], a[192:195], v[192:195], v[24:27]
  v_exp_f32 v69, v69
  v_mfma_f32_16x16x32_bf16 v[40:43], a[196:199], v[208:211], v[40:43]
  ds_read_b64_tr_b16 a[232:233], v81 offset:16384
  v_cvt_pk_bf16_f32 v158, v68, v69
  v_mfma_f32_16x16x32_bf16 v[40:43], a[200:203], v[224:227], v[40:43]
  v_exp_f32 v70, v70
  v_mfma_f32_16x16x32_bf16 v[40:43], a[204:207], v[240:243], v[40:43]
  s_add_u32 m0, s18, 16384
  ds_read_b64_tr_b16 a[234:235], v81 offset:20480
  v_mfma_f32_16x16x32_bf16 v[44:47], a[204:207], v[244:247], v[28:31]
  v_exp_f32 v71, v71
  v_mfma_f32_16x16x32_bf16 v[44:47], a[200:203], v[228:231], v[44:47]
  s_add_u32 s16, s16, 16384
  ds_read_b64_tr_b16 a[236:237], v81 offset:24576
  v_cvt_pk_bf16_f32 v159, v70, v71
  v_mfma_f32_16x16x32_bf16 v[44:47], a[196:199], v[212:215], v[44:47]
  v_mfma_f32_16x16x32_bf16 v[44:47], a[192:195], v[196:199], v[44:47]
  buffer_load_dwordx4 v88, s[8:11], s16 offen offset:0 lds
  v_mfma_f32_16x16x32_bf16 v[48:51], a[192:195], v[200:203], v[32:35]
  v_exp_f32 v40, v40
  v_mfma_f32_16x16x32_bf16 v[48:51], a[196:199], v[216:219], v[48:51]
  ds_read_b64_tr_b16 a[238:239], v81 offset:28672
  v_add_u32 v96, s101, v82
  v_mfma_f32_16x16x32_bf16 v[48:51], a[200:203], v[232:235], v[48:51]
  v_exp_f32 v41, v41
  v_mfma_f32_16x16x32_bf16 v[48:51], a[204:207], v[248:251], v[48:51]
  ds_read_b128 a[208:211], v76 offset:53248
  v_cvt_pk_bf16_f32 v160, v40, v41
  v_mfma_f32_16x16x32_bf16 v[52:55], a[204:207], v[252:255], v[36:39]
  v_exp_f32 v42, v42
  v_mfma_f32_16x16x32_bf16 v[52:55], a[200:203], v[236:239], v[52:55]
  ds_read_b128 a[212:215], v77 offset:53248
  ds_read_b64_tr_b16 a[136:137], v96 offset:0
  v_mfma_f32_16x16x32_bf16 v[52:55], a[196:199], v[220:223], v[52:55]
  v_exp_f32 v43, v43
  v_mfma_f32_16x16x32_bf16 v[52:55], a[192:195], v[204:207], v[52:55]
  s_waitcnt lgkmcnt(7)
  v_cvt_pk_bf16_f32 v161, v42, v43
  v_mfma_f32_16x16x32_bf16 a[0:3], a[224:227], v[128:131], a[0:3]
  v_exp_f32 v44, v44
  v_mfma_f32_16x16x32_bf16 a[0:3], a[228:231], v[132:135], a[0:3]
  ds_read_b128 a[216:219], v78 offset:53248
  ds_read_b64_tr_b16 a[138:139], v96 offset:4096
  v_mfma_f32_16x16x32_bf16 a[4:7], a[228:231], v[140:143], a[4:7]
  v_exp_f32 v45, v45
  v_mfma_f32_16x16x32_bf16 a[4:7], a[224:227], v[136:139], a[4:7]
  ds_read_b128 a[220:223], v79 offset:53248
  v_add_u32 v97, s101, v83
  v_mfma_f32_16x16x32_bf16 a[8:11], a[224:227], v[144:147], a[8:11]
  v_exp_f32 v46, v46
  v_mfma_f32_16x16x32_bf16 a[8:11], a[228:231], v[148:151], a[8:11]
  buffer_store_dwordx4 a[128:131], v3, s[52:55], s57 offen offset:0 sc1
  v_mfma_f32_16x16x32_bf16 a[12:15], a[228:231], v[156:159], a[12:15]
  v_exp_f32 v47, v47
  v_mfma_f32_16x16x32_bf16 a[12:15], a[224:227], v[152:155], a[12:15]
  s_waitcnt lgkmcnt(6)
  buffer_load_dwordx4 v89, s[8:11], s16 offen offset:1024 lds
  v_mfma_f32_16x16x32_bf16 a[28:31], a[232:235], v[152:155], a[28:31]
  v_exp_f32 v48, v48
  v_mfma_f32_16x16x32_bf16 a[28:31], a[236:239], v[156:159], a[28:31]
  ds_read_b64_tr_b16 a[240:241], v82 offset:16384
  ds_read_b64_tr_b16 a[140:141], v97 offset:0
  v_mfma_f32_16x16x32_bf16 a[24:27], a[236:239], v[148:151], a[24:27]
  v_exp_f32 v49, v49
  v_mfma_f32_16x16x32_bf16 a[24:27], a[232:235], v[144:147], a[24:27]
  ds_read_b64_tr_b16 a[242:243], v82 offset:20480
  v_cvt_pk_bf16_f32 v168, v44, v45
  v_mfma_f32_16x16x32_bf16 a[20:23], a[232:235], v[136:139], a[20:23]
  v_exp_f32 v50, v50
  v_mfma_f32_16x16x32_bf16 a[20:23], a[236:239], v[140:143], a[20:23]
  ds_read_b64_tr_b16 a[244:245], v82 offset:24576
  ds_read_b64_tr_b16 a[142:143], v97 offset:4096
  v_mfma_f32_16x16x32_bf16 a[16:19], a[236:239], v[132:135], a[16:19]
  v_exp_f32 v51, v51
  v_mfma_f32_16x16x32_bf16 a[16:19], a[232:235], v[128:131], a[16:19]
  s_waitcnt lgkmcnt(5)
  ds_read_b64_tr_b16 a[246:247], v82 offset:28672
  v_cvt_pk_bf16_f32 v169, v46, v47
  v_mfma_f32_16x16x32_bf16 v[56:59], a[208:211], v[192:195], v[24:27]
  v_exp_f32 v52, v52
  v_mfma_f32_16x16x32_bf16 v[56:59], a[212:215], v[208:211], v[56:59]
  ds_read_b64_tr_b16 a[248:249], v83 offset:16384
  v_cvt_pk_bf16_f32 v176, v48, v49
  v_mfma_f32_16x16x32_bf16 v[56:59], a[216:219], v[224:227], v[56:59]
  v_exp_f32 v53, v53
  v_mfma_f32_16x16x32_bf16 v[56:59], a[220:223], v[240:243], v[56:59]
  ds_read_b64_tr_b16 a[250:251], v83 offset:20480
  v_cvt_pk_bf16_f32 v177, v50, v51
  v_mfma_f32_16x16x32_bf16 v[60:63], a[220:223], v[244:247], v[28:31]
  v_exp_f32 v54, v54
  v_mfma_f32_16x16x32_bf16 v[60:63], a[216:219], v[228:231], v[60:63]
  ds_read_b64_tr_b16 a[252:253], v83 offset:24576
  v_cvt_pk_bf16_f32 v184, v52, v53
  v_mfma_f32_16x16x32_bf16 v[60:63], a[212:215], v[212:215], v[60:63]
  v_exp_f32 v55, v55
  v_mfma_f32_16x16x32_bf16 v[60:63], a[208:211], v[196:199], v[60:63]
  buffer_load_dwordx4 v90, s[8:11], s16 offen offset:2048 lds
  v_mfma_f32_16x16x32_bf16 v[64:67], a[208:211], v[200:203], v[32:35]
  v_exp_f32 v56, v56
  v_mfma_f32_16x16x32_bf16 v[64:67], a[212:215], v[216:219], v[64:67]
  ds_read_b64_tr_b16 a[254:255], v83 offset:28672
  v_add_u32 v96, s101, v84
  v_mfma_f32_16x16x32_bf16 v[64:67], a[216:219], v[232:235], v[64:67]
  v_exp_f32 v57, v57
L_pad_fm3_2:
  s_cbranch_execz L_pad_fm3_3
  v_mfma_f32_16x16x32_bf16 v[64:67], a[220:223], v[248:251], v[64:67]
  ds_read_b128 a[192:195], v76 offset:57344
  v_cvt_pk_bf16_f32 v185, v54, v55
  v_mfma_f32_16x16x32_bf16 v[68:71], a[220:223], v[252:255], v[36:39]
  v_exp_f32 v58, v58
  v_mfma_f32_16x16x32_bf16 v[68:71], a[216:219], v[236:239], v[68:71]
  ds_read_b128 a[196:199], v77 offset:57344
  ds_read_b64_tr_b16 a[144:145], v96 offset:0
  v_mfma_f32_16x16x32_bf16 v[68:71], a[212:215], v[220:223], v[68:71]
  v_exp_f32 v59, v59
  v_mfma_f32_16x16x32_bf16 v[68:71], a[208:211], v[204:207], v[68:71]
  s_waitcnt lgkmcnt(7)
  v_cvt_pk_bf16_f32 v162, v56, v57
  v_cvt_pk_bf16_f32 v163, v58, v59
  v_mfma_f32_16x16x32_bf16 a[32:35], a[240:243], v[128:131], a[32:35]
  v_exp_f32 v60, v60
  v_mfma_f32_16x16x32_bf16 a[32:35], a[244:247], v[132:135], a[32:35]
  ds_read_b128 a[200:203], v78 offset:57344
  ds_read_b64_tr_b16 a[146:147], v96 offset:4096
  v_mfma_f32_16x16x32_bf16 a[36:39], a[244:247], v[140:143], a[36:39]
  v_exp_f32 v61, v61
  v_mfma_f32_16x16x32_bf16 a[36:39], a[240:243], v[136:139], a[36:39]
  ds_read_b128 a[204:207], v79 offset:57344
  v_add_u32 v97, s101, v85
  v_mfma_f32_16x16x32_bf16 a[40:43], a[240:243], v[144:147], a[40:43]
  v_exp_f32 v62, v62
  v_mfma_f32_16x16x32_bf16 a[40:43], a[244:247], v[148:151], a[40:43]
  v_cvt_pk_bf16_f32 v170, v60, v61
  v_mfma_f32_16x16x32_bf16 a[44:47], a[244:247], v[156:159], a[44:47]
  v_exp_f32 v63, v63
  v_mfma_f32_16x16x32_bf16 a[44:47], a[240:243], v[152:155], a[44:47]
  s_waitcnt lgkmcnt(6)
  buffer_load_dwordx4 v91, s[8:11], s16 offen offset:3072 lds
  v_mfma_f32_16x16x32_bf16 a[60:63], a[248:251], v[152:155], a[60:63]
  v_exp_f32 v64, v64
  v_mfma_f32_16x16x32_bf16 a[60:63], a[252:255], v[156:159], a[60:63]
  ds_read_b64_tr_b16 a[224:225], v84 offset:16384
  ds_read_b64_tr_b16 a[148:149], v97 offset:0
  v_mfma_f32_16x16x32_bf16 a[56:59], a[252:255], v[148:151], a[56:59]
  v_exp_f32 v65, v65
  v_mfma_f32_16x16x32_bf16 a[56:59], a[248:251], v[144:147], a[56:59]
  ds_read_b64_tr_b16 a[226:227], v84 offset:20480
  v_cvt_pk_bf16_f32 v171, v62, v63
  v_mfma_f32_16x16x32_bf16 a[52:55], a[248:251], v[136:139], a[52:55]
  v_exp_f32 v66, v66
  v_mfma_f32_16x16x32_bf16 a[52:55], a[252:255], v[140:143], a[52:55]
  ds_read_b64_tr_b16 a[228:229], v84 offset:24576
  ds_read_b64_tr_b16 a[150:151], v97 offset:4096
  v_mfma_f32_16x16x32_bf16 a[48:51], a[252:255], v[132:135], a[48:51]
  v_exp_f32 v67, v67
  v_mfma_f32_16x16x32_bf16 a[48:51], a[248:251], v[128:131], a[48:51]
  ds_read_b64_tr_b16 a[230:231], v84 offset:28672
  v_cvt_pk_bf16_f32 v178, v64, v65
  v_smfmac_f32_16x16x64_bf16 v[8:11], v[4:7], v[128:135], v116
  v_exp_f32 v68, v68
  v_smfmac_f32_16x16x64_bf16 v[12:15], v[4:7], v[136:143], v116
  s_waitcnt lgkmcnt(6)
  v_cvt_pk_bf16_f32 v179, v66, v67
  v_mfma_f32_16x16x32_bf16 v[40:43], a[192:195], v[192:195], v[24:27]
  v_exp_f32 v69, v69
  v_mfma_f32_16x16x32_bf16 v[40:43], a[196:199], v[208:211], v[40:43]
  ds_read_b64_tr_b16 a[232:233], v85 offset:16384
  v_cvt_pk_bf16_f32 v186, v68, v69
  v_mfma_f32_16x16x32_bf16 v[40:43], a[200:203], v[224:227], v[40:43]
  v_exp_f32 v70, v70
  v_mfma_f32_16x16x32_bf16 v[40:43], a[204:207], v[240:243], v[40:43]
  s_add_u32 m0, s18, 114688
  ds_read_b64_tr_b16 a[234:235], v85 offset:20480
  v_mfma_f32_16x16x32_bf16 v[44:47], a[204:207], v[244:247], v[28:31]
  v_exp_f32 v71, v71
  v_mfma_f32_16x16x32_bf16 v[44:47], a[200:203], v[228:231], v[44:47]
  s_add_u32 s17, s17, 16384
  ds_read_b64_tr_b16 a[236:237], v85 offset:24576
  v_cvt_pk_bf16_f32 v187, v70, v71
  v_mfma_f32_16x16x32_bf16 v[44:47], a[196:199], v[212:215], v[44:47]
  v_mfma_f32_16x16x32_bf16 v[44:47], a[192:195], v[196:199], v[44:47]
  buffer_load_dwordx4 v92, s[12:15], s17 offen offset:0 lds
  v_mfma_f32_16x16x32_bf16 v[48:51], a[192:195], v[200:203], v[32:35]
  v_exp_f32 v40, v40
  v_mfma_f32_16x16x32_bf16 v[48:51], a[196:199], v[216:219], v[48:51]
  ds_read_b64_tr_b16 a[238:239], v85 offset:28672
  v_add_u32 v96, s101, v86
  v_mfma_f32_16x16x32_bf16 v[48:51], a[200:203], v[232:235], v[48:51]
  v_exp_f32 v41, v41
  v_mfma_f32_16x16x32_bf16 v[48:51], a[204:207], v[248:251], v[48:51]
  ds_read_b128 a[208:211], v76 offset:61440
  v_cvt_pk_bf16_f32 v164, v40, v41
  v_mfma_f32_16x16x32_bf16 v[52:55], a[204:207], v[252:255], v[36:39]
  v_exp_f32 v42, v42
  v_mfma_f32_16x16x32_bf16 v[52:55], a[200:203], v[236:239], v[52:55]
  ds_read_b128 a[212:215], v77 offset:61440
  ds_read_b64_tr_b16 a[152:153], v96 offset:0
  v_mfma_f32_16x16x32_bf16 v[52:55], a[196:199], v[220:223], v[52:55]
  v_exp_f32 v43, v43
  v_mfma_f32_16x16x32_bf16 v[52:55], a[192:195], v[204:207], v[52:55]
  s_waitcnt lgkmcnt(7)
  buffer_store_dwordx4 a[132:135], v3, s[52:55], s57 offen offset:1024 sc1
  v_mfma_f32_16x16x32_bf16 a[64:67], a[224:227], v[128:131], a[64:67]
  v_exp_f32 v44, v44
  v_mfma_f32_16x16x32_bf16 a[64:67], a[228:231], v[132:135], a[64:67]
  ds_read_b128 a[216:219], v78 offset:61440
  ds_read_b64_tr_b16 a[154:155], v96 offset:4096
  v_mfma_f32_16x16x32_bf16 a[68:71], a[228:231], v[140:143], a[68:71]
  v_exp_f32 v45, v45
  v_mfma_f32_16x16x32_bf16 a[68:71], a[224:227], v[136:139], a[68:71]
  ds_read_b128 a[220:223], v79 offset:61440
  v_add_u32 v97, s101, v87
  v_mfma_f32_16x16x32_bf16 a[72:75], a[224:227], v[144:147], a[72:75]
  v_exp_f32 v46, v46
  v_mfma_f32_16x16x32_bf16 a[72:75], a[228:231], v[148:151], a[72:75]
  v_cvt_pk_bf16_f32 v165, v42, v43
  v_cvt_pk_bf16_f32 v172, v44, v45
  v_mfma_f32_16x16x32_bf16 a[76:79], a[228:231], v[156:159], a[76:79]
  v_exp_f32 v47, v47
  v_mfma_f32_16x16x32_bf16 a[76:79], a[224:227], v[152:155], a[76:79]
  s_waitcnt lgkmcnt(6)
  buffer_load_dwordx4 v93, s[12:15], s17 offen offset:1024 lds
  v_mfma_f32_16x16x32_bf16 a[92:95], a[232:235], v[152:155], a[92:95]
  v_exp_f32 v48, v48
  v_mfma_f32_16x16x32_bf16 a[92:95], a[236:239], v[156:159], a[92:95]
  ds_read_b64_tr_b16 a[240:241], v86 offset:16384
  ds_read_b64_tr_b16 a[156:157], v97 offset:0
  v_mfma_f32_16x16x32_bf16 a[88:91], a[236:239], v[148:151], a[88:91]
  v_exp_f32 v49, v49
  v_mfma_f32_16x16x32_bf16 a[88:91], a[232:235], v[144:147], a[88:91]
  ds_read_b64_tr_b16 a[242:243], v86 offset:20480
  v_cvt_pk_bf16_f32 v173, v46, v47
  v_mfma_f32_16x16x32_bf16 a[84:87], a[232:235], v[136:139], a[84:87]
  v_exp_f32 v50, v50
  v_mfma_f32_16x16x32_bf16 a[84:87], a[236:239], v[140:143], a[84:87]
  ds_read_b64_tr_b16 a[244:245], v86 offset:24576
  ds_read_b64_tr_b16 a[158:159], v97 offset:4096
  v_mfma_f32_16x16x32_bf16 a[80:83], a[236:239], v[132:135], a[80:83]
  v_exp_f32 v51, v51
  v_mfma_f32_16x16x32_bf16 a[80:83], a[232:235], v[128:131], a[80:83]
  s_waitcnt lgkmcnt(5)
  ds_read_b64_tr_b16 a[246:247], v86 offset:28672
  v_cvt_pk_bf16_f32 v180, v48, v49
  v_mfma_f32_16x16x32_bf16 v[56:59], a[208:211], v[192:195], v[24:27]
  v_exp_f32 v52, v52
  v_mfma_f32_16x16x32_bf16 v[56:59], a[212:215], v[208:211], v[56:59]
  ds_read_b64_tr_b16 a[248:249], v87 offset:16384
  v_cvt_pk_bf16_f32 v181, v50, v51
  v_mfma_f32_16x16x32_bf16 v[56:59], a[216:219], v[224:227], v[56:59]
  v_exp_f32 v53, v53
  v_mfma_f32_16x16x32_bf16 v[56:59], a[220:223], v[240:243], v[56:59]
  ds_read_b64_tr_b16 a[250:251], v87 offset:20480
  v_cvt_pk_bf16_f32 v188, v52, v53
  v_mfma_f32_16x16x32_bf16 v[60:63], a[220:223], v[244:247], v[28:31]
  v_exp_f32 v54, v54
  v_mfma_f32_16x16x32_bf16 v[60:63], a[216:219], v[228:231], v[60:63]
  ds_read_b64_tr_b16 a[252:253], v87 offset:24576
  v_mfma_f32_16x16x32_bf16 v[60:63], a[212:215], v[212:215], v[60:63]
  s_waitcnt vmcnt(8)
  s_barrier
  v_exp_f32 v55, v55
  v_mfma_f32_16x16x32_bf16 v[60:63], a[208:211], v[196:199], v[60:63]
  buffer_load_dwordx4 v92, s[12:15], s17 offen offset:2048 lds
  v_mfma_f32_16x16x32_bf16 v[64:67], a[208:211], v[200:203], v[32:35]
  v_exp_f32 v56, v56
  v_mfma_f32_16x16x32_bf16 v[64:67], a[212:215], v[216:219], v[64:67]
  ds_read_b64_tr_b16 a[254:255], v87 offset:28672
  v_cvt_pk_bf16_f32 v189, v54, v55
  v_mfma_f32_16x16x32_bf16 v[64:67], a[216:219], v[232:235], v[64:67]
  v_exp_f32 v57, v57
  v_mfma_f32_16x16x32_bf16 v[64:67], a[220:223], v[248:251], v[64:67]
  ds_read_b128 a[192:195], v76 offset:0
  v_cvt_pk_bf16_f32 v166, v56, v57
  v_mfma_f32_16x16x32_bf16 v[68:71], a[220:223], v[252:255], v[36:39]
  v_exp_f32 v58, v58
  v_mfma_f32_16x16x32_bf16 v[68:71], a[216:219], v[236:239], v[68:71]
  ds_read_b128 a[196:199], v77 offset:0
  v_mfma_f32_16x16x32_bf16 v[68:71], a[212:215], v[220:223], v[68:71]
  v_exp_f32 v59, v59
  v_mfma_f32_16x16x32_bf16 v[68:71], a[208:211], v[204:207], v[68:71]
  s_waitcnt lgkmcnt(6)
  v_cvt_pk_bf16_f32 v167, v58, v59
  v_mfma_f32_16x16x32_bf16 a[96:99], a[240:243], v[128:131], a[96:99]
  v_exp_f32 v60, v60
  v_mfma_f32_16x16x32_bf16 a[96:99], a[244:247], v[132:135], a[96:99]
  ds_read_b128 a[200:203], v78 offset:0
  v_mfma_f32_16x16x32_bf16 a[100:103], a[244:247], v[140:143], a[100:103]
  v_exp_f32 v61, v61
  v_mfma_f32_16x16x32_bf16 a[100:103], a[240:243], v[136:139], a[100:103]
  ds_read_b128 a[204:207], v79 offset:0
  v_cvt_pk_bf16_f32 v174, v60, v61
  v_mfma_f32_16x16x32_bf16 a[104:107], a[240:243], v[144:147], a[104:107]
  v_exp_f32 v62, v62
  v_mfma_f32_16x16x32_bf16 a[104:107], a[244:247], v[148:151], a[104:107]
  buffer_store_dwordx4 a[136:139], v3, s[52:55], s57 offen offset:2048 sc1
  v_mfma_f32_16x16x32_bf16 a[108:111], a[244:247], v[156:159], a[108:111]
  v_exp_f32 v63, v63
  v_mfma_f32_16x16x32_bf16 a[108:111], a[240:243], v[152:155], a[108:111]
  s_waitcnt lgkmcnt(4)
  buffer_load_dwordx4 v93, s[12:15], s17 offen offset:3072 lds
  v_mfma_f32_16x16x32_bf16 a[124:127], a[248:251], v[152:155], a[124:127]
  v_exp_f32 v64, v64
  v_mfma_f32_16x16x32_bf16 a[124:127], a[252:255], v[156:159], a[124:127]
  ds_read_b64_tr_b16 a[224:225], v80 offset:0
  v_cvt_pk_bf16_f32 v175, v62, v63
  v_mfma_f32_16x16x32_bf16 a[120:123], a[252:255], v[148:151], a[120:123]
  v_exp_f32 v65, v65
  v_mfma_f32_16x16x32_bf16 a[120:123], a[248:251], v[144:147], a[120:123]
  ds_read_b64_tr_b16 a[226:227], v80 offset:4096
  v_cvt_pk_bf16_f32 v182, v64, v65
  v_mfma_f32_16x16x32_bf16 a[116:119], a[248:251], v[136:139], a[116:119]
  v_exp_f32 v66, v66
  v_mfma_f32_16x16x32_bf16 a[116:119], a[252:255], v[140:143], a[116:119]
  ds_read_b64_tr_b16 a[228:229], v80 offset:8192
  v_mfma_f32_16x16x32_bf16 a[112:115], a[252:255], v[132:135], a[112:115]
  v_exp_f32 v67, v67
  v_mfma_f32_16x16x32_bf16 a[112:115], a[248:251], v[128:131], a[112:115]
  ds_read_b64_tr_b16 a[230:231], v80 offset:12288
  v_cvt_pk_bf16_f32 v183, v66, v67
  v_smfmac_f32_16x16x64_bf16 v[16:19], v[4:7], v[144:151], v116
  v_exp_f32 v68, v68
  v_smfmac_f32_16x16x64_bf16 v[20:23], v[4:7], v[152:159], v116
  s_waitcnt lgkmcnt(4)
  v_mfma_f32_16x16x32_bf16 v[40:43], a[192:195], v[192:195], v[24:27]
  v_exp_f32 v69, v69
  v_mfma_f32_16x16x32_bf16 v[40:43], a[196:199], v[208:211], v[40:43]
  ds_read_b64_tr_b16 a[232:233], v81 offset:0
  v_cvt_pk_bf16_f32 v190, v68, v69
  v_mfma_f32_16x16x32_bf16 v[40:43], a[200:203], v[224:227], v[40:43]
  v_exp_f32 v70, v70
  v_mfma_f32_16x16x32_bf16 v[40:43], a[204:207], v[240:243], v[40:43]
  s_add_u32 m0, s18, 32768
  ds_read_b64_tr_b16 a[234:235], v81 offset:4096
  v_mfma_f32_16x16x32_bf16 v[44:47], a[204:207], v[244:247], v[28:31]
  v_exp_f32 v71, v71
  v_mfma_f32_16x16x32_bf16 v[44:47], a[200:203], v[228:231], v[44:47]
  s_add_u32 s16, s16, 16384
  ds_read_b64_tr_b16 a[236:237], v81 offset:8192
  v_cvt_pk_bf16_f32 v191, v70, v71
  v_mfma_f32_16x16x32_bf16 v[44:47], a[196:199], v[212:215], v[44:47]
  v_mfma_f32_16x16x32_bf16 v[44:47], a[192:195], v[196:199], v[44:47]
  buffer_load_dwordx4 v88, s[8:11], s16 offen offset:0 lds
  v_mfma_f32_16x16x32_bf16 v[48:51], a[192:195], v[200:203], v[32:35]
  v_exp_f32 v40, v40
  v_mfma_f32_16x16x32_bf16 v[48:51], a[196:199], v[216:219], v[48:51]
  ds_read_b64_tr_b16 a[238:239], v81 offset:12288
  v_mfma_f32_16x16x32_bf16 v[48:51], a[200:203], v[232:235], v[48:51]
  v_exp_f32 v41, v41
  v_mfma_f32_16x16x32_bf16 v[48:51], a[204:207], v[248:251], v[48:51]
  ds_read_b128 a[208:211], v76 offset:4096
  v_cvt_pk_bf16_f32 v128, v40, v41
  v_mfma_f32_16x16x32_bf16 v[52:55], a[204:207], v[252:255], v[36:39]
  v_exp_f32 v42, v42
  v_mfma_f32_16x16x32_bf16 v[52:55], a[200:203], v[236:239], v[52:55]
  ds_read_b128 a[212:215], v77 offset:4096
  v_mfma_f32_16x16x32_bf16 v[52:55], a[196:199], v[220:223], v[52:55]
  v_exp_f32 v43, v43
  v_mfma_f32_16x16x32_bf16 v[52:55], a[192:195], v[204:207], v[52:55]
  s_waitcnt lgkmcnt(6)
  v_cvt_pk_bf16_f32 v129, v42, v43
  v_mfma_f32_16x16x32_bf16 a[0:3], a[224:227], v[160:163], a[0:3]
  v_exp_f32 v44, v44
  v_mfma_f32_16x16x32_bf16 a[0:3], a[228:231], v[164:167], a[0:3]
  ds_read_b128 a[216:219], v78 offset:4096
  v_mfma_f32_16x16x32_bf16 a[4:7], a[228:231], v[172:175], a[4:7]
  v_exp_f32 v45, v45
  v_mfma_f32_16x16x32_bf16 a[4:7], a[224:227], v[168:171], a[4:7]
  ds_read_b128 a[220:223], v79 offset:4096
  v_cvt_pk_bf16_f32 v136, v44, v45
  v_mfma_f32_16x16x32_bf16 a[8:11], a[224:227], v[176:179], a[8:11]
  v_exp_f32 v46, v46
  v_mfma_f32_16x16x32_bf16 a[8:11], a[228:231], v[180:183], a[8:11]
  buffer_store_dwordx4 a[140:143], v3, s[52:55], s57 offen offset:3072 sc1
  v_mfma_f32_16x16x32_bf16 a[12:15], a[228:231], v[188:191], a[12:15]
  v_exp_f32 v47, v47
  v_mfma_f32_16x16x32_bf16 a[12:15], a[224:227], v[184:187], a[12:15]
  s_waitcnt lgkmcnt(4)
  buffer_load_dwordx4 v89, s[8:11], s16 offen offset:1024 lds
  v_mfma_f32_16x16x32_bf16 a[28:31], a[232:235], v[184:187], a[28:31]
  v_exp_f32 v48, v48
  v_mfma_f32_16x16x32_bf16 a[28:31], a[236:239], v[188:191], a[28:31]
  ds_read_b64_tr_b16 a[240:241], v82 offset:0
  v_cvt_pk_bf16_f32 v137, v46, v47
  v_mfma_f32_16x16x32_bf16 a[24:27], a[236:239], v[180:183], a[24:27]
  v_exp_f32 v49, v49
  v_mfma_f32_16x16x32_bf16 a[24:27], a[232:235], v[176:179], a[24:27]
  ds_read_b64_tr_b16 a[242:243], v82 offset:4096
  v_cvt_pk_bf16_f32 v144, v48, v49
  v_mfma_f32_16x16x32_bf16 a[20:23], a[232:235], v[168:171], a[20:23]
  v_exp_f32 v50, v50
  v_mfma_f32_16x16x32_bf16 a[20:23], a[236:239], v[172:175], a[20:23]
  ds_read_b64_tr_b16 a[244:245], v82 offset:8192
  v_mfma_f32_16x16x32_bf16 a[16:19], a[236:239], v[164:167], a[16:19]
  v_exp_f32 v51, v51
  v_mfma_f32_16x16x32_bf16 a[16:19], a[232:235], v[160:163], a[16:19]
  s_waitcnt lgkmcnt(3)
  ds_read_b64_tr_b16 a[246:247], v82 offset:12288
  v_cvt_pk_bf16_f32 v145, v50, v51
  v_mfma_f32_16x16x32_bf16 v[56:59], a[208:211], v[192:195], v[24:27]
  v_exp_f32 v52, v52
  v_mfma_f32_16x16x32_bf16 v[56:59], a[212:215], v[208:211], v[56:59]
  ds_read_b64_tr_b16 a[248:249], v83 offset:0
  v_mfma_f32_16x16x32_bf16 v[56:59], a[216:219], v[224:227], v[56:59]
  v_exp_f32 v53, v53
  v_mfma_f32_16x16x32_bf16 v[56:59], a[220:223], v[240:243], v[56:59]
  ds_read_b64_tr_b16 a[250:251], v83 offset:4096
  v_cvt_pk_bf16_f32 v152, v52, v53
  v_mfma_f32_16x16x32_bf16 v[60:63], a[220:223], v[244:247], v[28:31]
  v_exp_f32 v54, v54
  v_mfma_f32_16x16x32_bf16 v[60:63], a[216:219], v[228:231], v[60:63]
  ds_read_b64_tr_b16 a[252:253], v83 offset:8192
  v_mfma_f32_16x16x32_bf16 v[60:63], a[212:215], v[212:215], v[60:63]
  v_exp_f32 v55, v55
  v_mfma_f32_16x16x32_bf16 v[60:63], a[208:211], v[196:199], v[60:63]
  buffer_load_dwordx4 v90, s[8:11], s16 offen offset:2048 lds
  v_mfma_f32_16x16x32_bf16 v[64:67], a[208:211], v[200:203], v[32:35]
  v_exp_f32 v56, v56
  v_mfma_f32_16x16x32_bf16 v[64:67], a[212:215], v[216:219], v[64:67]
  ds_read_b64_tr_b16 a[254:255], v83 offset:12288
  v_cvt_pk_bf16_f32 v153, v54, v55
  v_mfma_f32_16x16x32_bf16 v[64:67], a[216:219], v[232:235], v[64:67]
  v_exp_f32 v57, v57
  v_mfma_f32_16x16x32_bf16 v[64:67], a[220:223], v[248:251], v[64:67]
  ds_read_b128 a[192:195], v76 offset:8192
  v_cvt_pk_bf16_f32 v130, v56, v57
  v_mfma_f32_16x16x32_bf16 v[68:71], a[220:223], v[252:255], v[36:39]
  v_exp_f32 v58, v58
  v_mfma_f32_16x16x32_bf16 v[68:71], a[216:219], v[236:239], v[68:71]
  ds_read_b128 a[196:199], v77 offset:8192
  v_mfma_f32_16x16x32_bf16 v[68:71], a[212:215], v[220:223], v[68:71]
  v_exp_f32 v59, v59
  v_mfma_f32_16x16x32_bf16 v[68:71], a[208:211], v[204:207], v[68:71]
  s_waitcnt lgkmcnt(6)
  v_cvt_pk_bf16_f32 v131, v58, v59
  v_mfma_f32_16x16x32_bf16 a[32:35], a[240:243], v[160:163], a[32:35]
  v_exp_f32 v60, v60
  v_mfma_f32_16x16x32_bf16 a[32:35], a[244:247], v[164:167], a[32:35]
  ds_read_b128 a[200:203], v78 offset:8192
  v_mfma_f32_16x16x32_bf16 a[36:39], a[244:247], v[172:175], a[36:39]
  v_exp_f32 v61, v61
  v_mfma_f32_16x16x32_bf16 a[36:39], a[240:243], v[168:171], a[36:39]
  s_add_u32 s57, s57, 4096
  ds_read_b128 a[204:207], v79 offset:8192
  v_cvt_pk_bf16_f32 v138, v60, v61
  v_mfma_f32_16x16x32_bf16 a[40:43], a[240:243], v[176:179], a[40:43]
  v_exp_f32 v62, v62
  v_mfma_f32_16x16x32_bf16 a[40:43], a[244:247], v[180:183], a[40:43]
  buffer_store_dwordx4 a[144:147], v3, s[52:55], s57 offen offset:0 sc1
  v_mfma_f32_16x16x32_bf16 a[44:47], a[244:247], v[188:191], a[44:47]
  v_exp_f32 v63, v63
  v_mfma_f32_16x16x32_bf16 a[44:47], a[240:243], v[184:187], a[44:47]
  s_waitcnt lgkmcnt(4)
  buffer_load_dwordx4 v91, s[8:11], s16 offen offset:3072 lds
  v_mfma_f32_16x16x32_bf16 a[60:63], a[248:251], v[184:187], a[60:63]
  v_exp_f32 v64, v64
  v_mfma_f32_16x16x32_bf16 a[60:63], a[252:255], v[188:191], a[60:63]
  ds_read_b64_tr_b16 a[224:225], v84 offset:0
  v_cvt_pk_bf16_f32 v139, v62, v63
  v_mfma_f32_16x16x32_bf16 a[56:59], a[252:255], v[180:183], a[56:59]
  v_exp_f32 v65, v65
  v_mfma_f32_16x16x32_bf16 a[56:59], a[248:251], v[176:179], a[56:59]
  ds_read_b64_tr_b16 a[226:227], v84 offset:4096
  v_cvt_pk_bf16_f32 v146, v64, v65
  v_mfma_f32_16x16x32_bf16 a[52:55], a[248:251], v[168:171], a[52:55]
  v_exp_f32 v66, v66
  v_mfma_f32_16x16x32_bf16 a[52:55], a[252:255], v[172:175], a[52:55]
  ds_read_b64_tr_b16 a[228:229], v84 offset:8192
  v_mfma_f32_16x16x32_bf16 a[48:51], a[252:255], v[164:167], a[48:51]
  v_exp_f32 v67, v67
  v_mfma_f32_16x16x32_bf16 a[48:51], a[248:251], v[160:163], a[48:51]
  ds_read_b64_tr_b16 a[230:231], v84 offset:12288
  v_cvt_pk_bf16_f32 v147, v66, v67
  v_smfmac_f32_16x16x64_bf16 v[8:11], v[4:7], v[160:167], v116
  v_exp_f32 v68, v68
  v_smfmac_f32_16x16x64_bf16 v[12:15], v[4:7], v[168:175], v116
  s_waitcnt lgkmcnt(4)
  v_mfma_f32_16x16x32_bf16 v[40:43], a[192:195], v[192:195], v[24:27]
  v_exp_f32 v69, v69
  v_mfma_f32_16x16x32_bf16 v[40:43], a[196:199], v[208:211], v[40:43]
  ds_read_b64_tr_b16 a[232:233], v85 offset:0
  v_cvt_pk_bf16_f32 v154, v68, v69
  v_mfma_f32_16x16x32_bf16 v[40:43], a[200:203], v[224:227], v[40:43]
  v_exp_f32 v70, v70
  v_mfma_f32_16x16x32_bf16 v[40:43], a[204:207], v[240:243], v[40:43]
  s_add_u32 m0, s18, 98304
  ds_read_b64_tr_b16 a[234:235], v85 offset:4096
  v_mfma_f32_16x16x32_bf16 v[44:47], a[204:207], v[244:247], v[28:31]
  v_exp_f32 v71, v71
  v_mfma_f32_16x16x32_bf16 v[44:47], a[200:203], v[228:231], v[44:47]
  s_add_u32 s17, s17, 16384
  ds_read_b64_tr_b16 a[236:237], v85 offset:8192
  v_cvt_pk_bf16_f32 v155, v70, v71
  v_mfma_f32_16x16x32_bf16 v[44:47], a[196:199], v[212:215], v[44:47]
  v_mfma_f32_16x16x32_bf16 v[44:47], a[192:195], v[196:199], v[44:47]
  buffer_load_dwordx4 v92, s[12:15], s17 offen offset:0 lds
  v_mfma_f32_16x16x32_bf16 v[48:51], a[192:195], v[200:203], v[32:35]
  v_exp_f32 v40, v40
  v_mfma_f32_16x16x32_bf16 v[48:51], a[196:199], v[216:219], v[48:51]
  ds_read_b64_tr_b16 a[238:239], v85 offset:12288
  v_mfma_f32_16x16x32_bf16 v[48:51], a[200:203], v[232:235], v[48:51]
  v_exp_f32 v41, v41
  v_mfma_f32_16x16x32_bf16 v[48:51], a[204:207], v[248:251], v[48:51]
  ds_read_b128 a[208:211], v76 offset:12288
  v_cvt_pk_bf16_f32 v132, v40, v41
  v_mfma_f32_16x16x32_bf16 v[52:55], a[204:207], v[252:255], v[36:39]
  v_exp_f32 v42, v42
  v_mfma_f32_16x16x32_bf16 v[52:55], a[200:203], v[236:239], v[52:55]
  ds_read_b128 a[212:215], v77 offset:12288
  v_mfma_f32_16x16x32_bf16 v[52:55], a[196:199], v[220:223], v[52:55]
  v_exp_f32 v43, v43
  v_mfma_f32_16x16x32_bf16 v[52:55], a[192:195], v[204:207], v[52:55]
  s_waitcnt lgkmcnt(6)
  buffer_store_dwordx4 a[148:151], v3, s[52:55], s57 offen offset:1024 sc1
  v_mfma_f32_16x16x32_bf16 a[64:67], a[224:227], v[160:163], a[64:67]
  v_exp_f32 v44, v44
  v_mfma_f32_16x16x32_bf16 a[64:67], a[228:231], v[164:167], a[64:67]
  ds_read_b128 a[216:219], v78 offset:12288
  v_cvt_pk_bf16_f32 v133, v42, v43
  v_mfma_f32_16x16x32_bf16 a[68:71], a[228:231], v[172:175], a[68:71]
  v_exp_f32 v45, v45
  v_mfma_f32_16x16x32_bf16 a[68:71], a[224:227], v[168:171], a[68:71]
  ds_read_b128 a[220:223], v79 offset:12288
  v_cvt_pk_bf16_f32 v140, v44, v45
  v_mfma_f32_16x16x32_bf16 a[72:75], a[224:227], v[176:179], a[72:75]
  v_exp_f32 v46, v46
  v_mfma_f32_16x16x32_bf16 a[72:75], a[228:231], v[180:183], a[72:75]
  v_mfma_f32_16x16x32_bf16 a[76:79], a[228:231], v[188:191], a[76:79]
  v_exp_f32 v47, v47
  v_mfma_f32_16x16x32_bf16 a[76:79], a[224:227], v[184:187], a[76:79]
  s_waitcnt lgkmcnt(4)
  buffer_load_dwordx4 v93, s[12:15], s17 offen offset:1024 lds
  v_mfma_f32_16x16x32_bf16 a[92:95], a[232:235], v[184:187], a[92:95]
  v_exp_f32 v48, v48
  v_mfma_f32_16x16x32_bf16 a[92:95], a[236:239], v[188:191], a[92:95]
  ds_read_b64_tr_b16 a[240:241], v86 offset:0
  v_cvt_pk_bf16_f32 v141, v46, v47
  v_mfma_f32_16x16x32_bf16 a[88:91], a[236:239], v[180:183], a[88:91]
  v_exp_f32 v49, v49
  v_mfma_f32_16x16x32_bf16 a[88:91], a[232:235], v[176:179], a[88:91]
  ds_read_b64_tr_b16 a[242:243], v86 offset:4096
  v_cvt_pk_bf16_f32 v148, v48, v49
  v_mfma_f32_16x16x32_bf16 a[84:87], a[232:235], v[168:171], a[84:87]
  v_exp_f32 v50, v50
  v_mfma_f32_16x16x32_bf16 a[84:87], a[236:239], v[172:175], a[84:87]
  ds_read_b64_tr_b16 a[244:245], v86 offset:8192
  v_mfma_f32_16x16x32_bf16 a[80:83], a[236:239], v[164:167], a[80:83]
  v_exp_f32 v51, v51
  v_mfma_f32_16x16x32_bf16 a[80:83], a[232:235], v[160:163], a[80:83]
  s_waitcnt lgkmcnt(3)
  ds_read_b64_tr_b16 a[246:247], v86 offset:12288
  v_cvt_pk_bf16_f32 v149, v50, v51
  v_mfma_f32_16x16x32_bf16 v[56:59], a[208:211], v[192:195], v[24:27]
  v_exp_f32 v52, v52
  v_mfma_f32_16x16x32_bf16 v[56:59], a[212:215], v[208:211], v[56:59]
  ds_read_b64_tr_b16 a[248:249], v87 offset:0
  v_mfma_f32_16x16x32_bf16 v[56:59], a[216:219], v[224:227], v[56:59]
  v_exp_f32 v53, v53
  v_mfma_f32_16x16x32_bf16 v[56:59], a[220:223], v[240:243], v[56:59]
  ds_read_b64_tr_b16 a[250:251], v87 offset:4096
  v_cvt_pk_bf16_f32 v156, v52, v53
  v_mfma_f32_16x16x32_bf16 v[60:63], a[220:223], v[244:247], v[28:31]
  v_exp_f32 v54, v54
  v_mfma_f32_16x16x32_bf16 v[60:63], a[216:219], v[228:231], v[60:63]
  ds_read_b64_tr_b16 a[252:253], v87 offset:8192
  v_mfma_f32_16x16x32_bf16 v[60:63], a[212:215], v[212:215], v[60:63]
  s_waitcnt vmcnt(9)
  s_barrier
  v_exp_f32 v55, v55
  v_mfma_f32_16x16x32_bf16 v[60:63], a[208:211], v[196:199], v[60:63]
  buffer_load_dwordx4 v92, s[12:15], s17 offen offset:2048 lds
  v_mfma_f32_16x16x32_bf16 v[64:67], a[208:211], v[200:203], v[32:35]
  v_exp_f32 v56, v56
  v_mfma_f32_16x16x32_bf16 v[64:67], a[212:215], v[216:219], v[64:67]
  ds_read_b64_tr_b16 a[254:255], v87 offset:12288
  v_cvt_pk_bf16_f32 v157, v54, v55
  v_mfma_f32_16x16x32_bf16 v[64:67], a[216:219], v[232:235], v[64:67]
  v_exp_f32 v57, v57
  v_mfma_f32_16x16x32_bf16 v[64:67], a[220:223], v[248:251], v[64:67]
  ds_read_b128 a[192:195], v76 offset:16384
  v_cvt_pk_bf16_f32 v134, v56, v57
  v_mfma_f32_16x16x32_bf16 v[68:71], a[220:223], v[252:255], v[36:39]
  v_exp_f32 v58, v58
  v_mfma_f32_16x16x32_bf16 v[68:71], a[216:219], v[236:239], v[68:71]
  ds_read_b128 a[196:199], v77 offset:16384
  v_mfma_f32_16x16x32_bf16 v[68:71], a[212:215], v[220:223], v[68:71]
  v_exp_f32 v59, v59
  v_mfma_f32_16x16x32_bf16 v[68:71], a[208:211], v[204:207], v[68:71]
  s_waitcnt lgkmcnt(6)
  buffer_store_dwordx4 a[152:155], v3, s[52:55], s57 offen offset:2048 sc1
  v_mfma_f32_16x16x32_bf16 a[96:99], a[240:243], v[160:163], a[96:99]
  v_exp_f32 v60, v60
  v_mfma_f32_16x16x32_bf16 a[96:99], a[244:247], v[164:167], a[96:99]
  ds_read_b128 a[200:203], v78 offset:16384
  v_cvt_pk_bf16_f32 v135, v58, v59
  v_mfma_f32_16x16x32_bf16 a[100:103], a[244:247], v[172:175], a[100:103]
  v_exp_f32 v61, v61
  v_mfma_f32_16x16x32_bf16 a[100:103], a[240:243], v[168:171], a[100:103]
  ds_read_b128 a[204:207], v79 offset:16384
  v_cvt_pk_bf16_f32 v142, v60, v61
  v_mfma_f32_16x16x32_bf16 a[104:107], a[240:243], v[176:179], a[104:107]
  v_exp_f32 v62, v62
  v_mfma_f32_16x16x32_bf16 a[104:107], a[244:247], v[180:183], a[104:107]
  v_mfma_f32_16x16x32_bf16 a[108:111], a[244:247], v[188:191], a[108:111]
  v_exp_f32 v63, v63
  v_mfma_f32_16x16x32_bf16 a[108:111], a[240:243], v[184:187], a[108:111]
  s_waitcnt lgkmcnt(4)
  buffer_load_dwordx4 v93, s[12:15], s17 offen offset:3072 lds
  v_mfma_f32_16x16x32_bf16 a[124:127], a[248:251], v[184:187], a[124:127]
  v_exp_f32 v64, v64
  v_mfma_f32_16x16x32_bf16 a[124:127], a[252:255], v[188:191], a[124:127]
  ds_read_b64_tr_b16 a[224:225], v80 offset:49152
  v_cvt_pk_bf16_f32 v143, v62, v63
  v_mfma_f32_16x16x32_bf16 a[120:123], a[252:255], v[180:183], a[120:123]
  v_exp_f32 v65, v65
  v_mfma_f32_16x16x32_bf16 a[120:123], a[248:251], v[176:179], a[120:123]
  ds_read_b64_tr_b16 a[226:227], v80 offset:53248
  v_cvt_pk_bf16_f32 v150, v64, v65
  v_mfma_f32_16x16x32_bf16 a[116:119], a[248:251], v[168:171], a[116:119]
  v_exp_f32 v66, v66
  v_mfma_f32_16x16x32_bf16 a[116:119], a[252:255], v[172:175], a[116:119]
  ds_read_b64_tr_b16 a[228:229], v80 offset:57344
  v_mfma_f32_16x16x32_bf16 a[112:115], a[252:255], v[164:167], a[112:115]
  v_exp_f32 v67, v67
  v_mfma_f32_16x16x32_bf16 a[112:115], a[248:251], v[160:163], a[112:115]
  ds_read_b64_tr_b16 a[230:231], v80 offset:61440
  v_cvt_pk_bf16_f32 v151, v66, v67
  v_smfmac_f32_16x16x64_bf16 v[16:19], v[4:7], v[176:183], v116
  v_exp_f32 v68, v68
  v_smfmac_f32_16x16x64_bf16 v[20:23], v[4:7], v[184:191], v116
  s_waitcnt lgkmcnt(4)
  buffer_store_dwordx4 a[156:159], v3, s[52:55], s57 offen offset:3072 sc1
  v_mfma_f32_16x16x32_bf16 v[40:43], a[192:195], v[192:195], v[24:27]
  v_exp_f32 v69, v69
  v_mfma_f32_16x16x32_bf16 v[40:43], a[196:199], v[208:211], v[40:43]
  ds_read_b64_tr_b16 a[232:233], v81 offset:49152
  v_cvt_pk_bf16_f32 v158, v68, v69
  v_mfma_f32_16x16x32_bf16 v[40:43], a[200:203], v[224:227], v[40:43]
  v_exp_f32 v70, v70
  v_mfma_f32_16x16x32_bf16 v[40:43], a[204:207], v[240:243], v[40:43]
  s_add_u32 m0, s18, 49152
  ds_read_b64_tr_b16 a[234:235], v81 offset:53248
  v_mfma_f32_16x16x32_bf16 v[44:47], a[204:207], v[244:247], v[28:31]
  v_exp_f32 v71, v71
  v_mfma_f32_16x16x32_bf16 v[44:47], a[200:203], v[228:231], v[44:47]
  s_add_u32 s16, s16, 16384
  ds_read_b64_tr_b16 a[236:237], v81 offset:57344
  v_cvt_pk_bf16_f32 v159, v70, v71
  v_mfma_f32_16x16x32_bf16 v[44:47], a[196:199], v[212:215], v[44:47]
  v_mfma_f32_16x16x32_bf16 v[44:47], a[192:195], v[196:199], v[44:47]
  buffer_load_dwordx4 v88, s[8:11], s16 offen offset:0 lds
  v_mfma_f32_16x16x32_bf16 v[48:51], a[192:195], v[200:203], v[32:35]
  v_exp_f32 v40, v40
  v_mfma_f32_16x16x32_bf16 v[48:51], a[196:199], v[216:219], v[48:51]
  ds_read_b64_tr_b16 a[238:239], v81 offset:61440
  v_mfma_f32_16x16x32_bf16 v[48:51], a[200:203], v[232:235], v[48:51]
  v_exp_f32 v41, v41
  v_mfma_f32_16x16x32_bf16 v[48:51], a[204:207], v[248:251], v[48:51]
  ds_read_b128 a[208:211], v76 offset:20480
  v_cvt_pk_bf16_f32 v160, v40, v41
  v_mfma_f32_16x16x32_bf16 v[52:55], a[204:207], v[252:255], v[36:39]
  v_exp_f32 v42, v42
  v_mfma_f32_16x16x32_bf16 v[52:55], a[200:203], v[236:239], v[52:55]
  ds_read_b128 a[212:215], v77 offset:20480
  v_mfma_f32_16x16x32_bf16 v[52:55], a[196:199], v[220:223], v[52:55]
  v_exp_f32 v43, v43
  v_mfma_f32_16x16x32_bf16 v[52:55], a[192:195], v[204:207], v[52:55]
  s_waitcnt lgkmcnt(6)
  v_cvt_pk_bf16_f32 v161, v42, v43
  v_mfma_f32_16x16x32_bf16 a[0:3], a[224:227], v[128:131], a[0:3]
  v_exp_f32 v44, v44
  v_mfma_f32_16x16x32_bf16 a[0:3], a[228:231], v[132:135], a[0:3]
  ds_read_b128 a[216:219], v78 offset:20480
  v_mfma_f32_16x16x32_bf16 a[4:7], a[228:231], v[140:143], a[4:7]
  v_exp_f32 v45, v45
  v_mfma_f32_16x16x32_bf16 a[4:7], a[224:227], v[136:139], a[4:7]
  ds_read_b128 a[220:223], v79 offset:20480
  v_cvt_pk_bf16_f32 v168, v44, v45
  v_mfma_f32_16x16x32_bf16 a[8:11], a[224:227], v[144:147], a[8:11]
  v_exp_f32 v46, v46
  v_mfma_f32_16x16x32_bf16 a[8:11], a[228:231], v[148:151], a[8:11]
  s_lshl2_add_u32 s3, s45, s43
  s_lshl_b32 s3, s3, 11
  v_lshl_add_u32 v108, v1, 5, s3
  v_mfma_f32_16x16x32_bf16 a[12:15], a[228:231], v[156:159], a[12:15]
  v_exp_f32 v47, v47
  v_mfma_f32_16x16x32_bf16 a[12:15], a[224:227], v[152:155], a[12:15]
  s_waitcnt lgkmcnt(4)
  buffer_load_dwordx4 v89, s[8:11], s16 offen offset:1024 lds
  v_mfma_f32_16x16x32_bf16 a[28:31], a[232:235], v[152:155], a[28:31]
  v_exp_f32 v48, v48
  v_mfma_f32_16x16x32_bf16 a[28:31], a[236:239], v[156:159], a[28:31]
  ds_read_b64_tr_b16 a[240:241], v82 offset:49152
L_pad_fm3_3:
  s_cbranch_execz L_pad_fm3_4
  v_cvt_pk_bf16_f32 v169, v46, v47
  v_mfma_f32_16x16x32_bf16 a[24:27], a[236:239], v[148:151], a[24:27]
  v_exp_f32 v49, v49
  v_mfma_f32_16x16x32_bf16 a[24:27], a[232:235], v[144:147], a[24:27]
  ds_read_b64_tr_b16 a[242:243], v82 offset:53248
  v_cvt_pk_bf16_f32 v176, v48, v49
  v_mfma_f32_16x16x32_bf16 a[20:23], a[232:235], v[136:139], a[20:23]
  v_exp_f32 v50, v50
  v_mfma_f32_16x16x32_bf16 a[20:23], a[236:239], v[140:143], a[20:23]
  ds_read_b64_tr_b16 a[244:245], v82 offset:57344
  v_mfma_f32_16x16x32_bf16 a[16:19], a[236:239], v[132:135], a[16:19]
  v_exp_f32 v51, v51
  v_mfma_f32_16x16x32_bf16 a[16:19], a[232:235], v[128:131], a[16:19]
  s_waitcnt lgkmcnt(3)
  ds_read_b64_tr_b16 a[246:247], v82 offset:61440
  v_cvt_pk_bf16_f32 v177, v50, v51
  v_mfma_f32_16x16x32_bf16 v[56:59], a[208:211], v[192:195], v[24:27]
  v_exp_f32 v52, v52
  v_mfma_f32_16x16x32_bf16 v[56:59], a[212:215], v[208:211], v[56:59]
  ds_read_b64_tr_b16 a[248:249], v83 offset:49152
  v_mfma_f32_16x16x32_bf16 v[56:59], a[216:219], v[224:227], v[56:59]
  v_exp_f32 v53, v53
  v_mfma_f32_16x16x32_bf16 v[56:59], a[220:223], v[240:243], v[56:59]
  ds_read_b64_tr_b16 a[250:251], v83 offset:53248
  v_cvt_pk_bf16_f32 v184, v52, v53
  v_mfma_f32_16x16x32_bf16 v[60:63], a[220:223], v[244:247], v[28:31]
  v_exp_f32 v54, v54
  v_mfma_f32_16x16x32_bf16 v[60:63], a[216:219], v[228:231], v[60:63]
  ds_read_b64_tr_b16 a[252:253], v83 offset:57344
  v_mfma_f32_16x16x32_bf16 v[60:63], a[212:215], v[212:215], v[60:63]
  v_exp_f32 v55, v55
  v_mfma_f32_16x16x32_bf16 v[60:63], a[208:211], v[196:199], v[60:63]
  buffer_load_dwordx4 v90, s[8:11], s16 offen offset:2048 lds
  v_mfma_f32_16x16x32_bf16 v[64:67], a[208:211], v[200:203], v[32:35]
  v_exp_f32 v56, v56
  v_mfma_f32_16x16x32_bf16 v[64:67], a[212:215], v[216:219], v[64:67]
  ds_read_b64_tr_b16 a[254:255], v83 offset:61440
  v_cvt_pk_bf16_f32 v185, v54, v55
  v_mfma_f32_16x16x32_bf16 v[64:67], a[216:219], v[232:235], v[64:67]
  v_exp_f32 v57, v57
  v_mfma_f32_16x16x32_bf16 v[64:67], a[220:223], v[248:251], v[64:67]
  ds_read_b128 a[192:195], v76 offset:24576
  v_cvt_pk_bf16_f32 v162, v56, v57
  v_mfma_f32_16x16x32_bf16 v[68:71], a[220:223], v[252:255], v[36:39]
  v_exp_f32 v58, v58
  v_mfma_f32_16x16x32_bf16 v[68:71], a[216:219], v[236:239], v[68:71]
  ds_read_b128 a[196:199], v77 offset:24576
  v_mfma_f32_16x16x32_bf16 v[68:71], a[212:215], v[220:223], v[68:71]
  v_exp_f32 v59, v59
  v_mfma_f32_16x16x32_bf16 v[68:71], a[208:211], v[204:207], v[68:71]
  s_waitcnt lgkmcnt(6)
  global_load_dword v2, v[126:127], off
  v_cvt_pk_bf16_f32 v163, v58, v59
  v_mfma_f32_16x16x32_bf16 a[32:35], a[240:243], v[128:131], a[32:35]
  v_exp_f32 v60, v60
  v_mfma_f32_16x16x32_bf16 a[32:35], a[244:247], v[132:135], a[32:35]
  ds_read_b128 a[200:203], v78 offset:24576
  v_mfma_f32_16x16x32_bf16 a[36:39], a[244:247], v[140:143], a[36:39]
  v_exp_f32 v61, v61
  v_mfma_f32_16x16x32_bf16 a[36:39], a[240:243], v[136:139], a[36:39]
  ds_read_b128 a[204:207], v79 offset:24576
  v_cvt_pk_bf16_f32 v170, v60, v61
  v_mfma_f32_16x16x32_bf16 a[40:43], a[240:243], v[144:147], a[40:43]
  v_exp_f32 v62, v62
  v_mfma_f32_16x16x32_bf16 a[40:43], a[244:247], v[148:151], a[40:43]
  v_mfma_f32_16x16x32_bf16 a[44:47], a[244:247], v[156:159], a[44:47]
  v_exp_f32 v63, v63
  v_mfma_f32_16x16x32_bf16 a[44:47], a[240:243], v[152:155], a[44:47]
  s_waitcnt lgkmcnt(4)
  buffer_load_dwordx4 v91, s[8:11], s16 offen offset:3072 lds
  v_mfma_f32_16x16x32_bf16 a[60:63], a[248:251], v[152:155], a[60:63]
  v_exp_f32 v64, v64
  v_mfma_f32_16x16x32_bf16 a[60:63], a[252:255], v[156:159], a[60:63]
  ds_read_b64_tr_b16 a[224:225], v84 offset:49152
  v_cvt_pk_bf16_f32 v171, v62, v63
  v_mfma_f32_16x16x32_bf16 a[56:59], a[252:255], v[148:151], a[56:59]
  v_exp_f32 v65, v65
  v_mfma_f32_16x16x32_bf16 a[56:59], a[248:251], v[144:147], a[56:59]
  ds_read_b64_tr_b16 a[226:227], v84 offset:53248
  v_cvt_pk_bf16_f32 v178, v64, v65
  v_mfma_f32_16x16x32_bf16 a[52:55], a[248:251], v[136:139], a[52:55]
  v_exp_f32 v66, v66
  v_mfma_f32_16x16x32_bf16 a[52:55], a[252:255], v[140:143], a[52:55]
  ds_read_b64_tr_b16 a[228:229], v84 offset:57344
  v_mfma_f32_16x16x32_bf16 a[48:51], a[252:255], v[132:135], a[48:51]
  v_exp_f32 v67, v67
  v_mfma_f32_16x16x32_bf16 a[48:51], a[248:251], v[128:131], a[48:51]
  ds_read_b64_tr_b16 a[230:231], v84 offset:61440
  v_cvt_pk_bf16_f32 v179, v66, v67
  v_smfmac_f32_16x16x64_bf16 v[8:11], v[4:7], v[128:135], v116
  v_exp_f32 v68, v68
  v_smfmac_f32_16x16x64_bf16 v[12:15], v[4:7], v[136:143], v116
  s_waitcnt lgkmcnt(4)
  v_mfma_f32_16x16x32_bf16 v[40:43], a[192:195], v[192:195], v[24:27]
  v_exp_f32 v69, v69
  v_mfma_f32_16x16x32_bf16 v[40:43], a[196:199], v[208:211], v[40:43]
  ds_read_b64_tr_b16 a[232:233], v85 offset:49152
  v_cvt_pk_bf16_f32 v186, v68, v69
  v_mfma_f32_16x16x32_bf16 v[40:43], a[200:203], v[224:227], v[40:43]
  v_exp_f32 v70, v70
  v_mfma_f32_16x16x32_bf16 v[40:43], a[204:207], v[240:243], v[40:43]
  s_add_u32 m0, s18, 81920
  ds_read_b64_tr_b16 a[234:235], v85 offset:53248
  v_mfma_f32_16x16x32_bf16 v[44:47], a[204:207], v[244:247], v[28:31]
  v_exp_f32 v71, v71
  v_mfma_f32_16x16x32_bf16 v[44:47], a[200:203], v[228:231], v[44:47]
  s_add_u32 s17, s17, 16384
  ds_read_b64_tr_b16 a[236:237], v85 offset:57344
  v_cvt_pk_bf16_f32 v187, v70, v71
  v_mfma_f32_16x16x32_bf16 v[44:47], a[196:199], v[212:215], v[44:47]
  v_mfma_f32_16x16x32_bf16 v[44:47], a[192:195], v[196:199], v[44:47]
  buffer_load_dwordx4 v92, s[12:15], s17 offen offset:0 lds
  v_mfma_f32_16x16x32_bf16 v[48:51], a[192:195], v[200:203], v[32:35]
  v_exp_f32 v40, v40
  v_mfma_f32_16x16x32_bf16 v[48:51], a[196:199], v[216:219], v[48:51]
  ds_read_b64_tr_b16 a[238:239], v85 offset:61440
  v_mfma_f32_16x16x32_bf16 v[48:51], a[200:203], v[232:235], v[48:51]
  v_exp_f32 v41, v41
  v_mfma_f32_16x16x32_bf16 v[48:51], a[204:207], v[248:251], v[48:51]
  ds_read_b128 a[208:211], v76 offset:28672
  v_cvt_pk_bf16_f32 v164, v40, v41
  v_mfma_f32_16x16x32_bf16 v[52:55], a[204:207], v[252:255], v[36:39]
  v_exp_f32 v42, v42
  v_mfma_f32_16x16x32_bf16 v[52:55], a[200:203], v[236:239], v[52:55]
  ds_read_b128 a[212:215], v77 offset:28672
  v_mfma_f32_16x16x32_bf16 v[52:55], a[196:199], v[220:223], v[52:55]
  v_exp_f32 v43, v43
  v_mfma_f32_16x16x32_bf16 v[52:55], a[192:195], v[204:207], v[52:55]
  s_waitcnt lgkmcnt(6)
  v_cvt_pk_bf16_f32 v165, v42, v43
  v_mfma_f32_16x16x32_bf16 a[64:67], a[224:227], v[128:131], a[64:67]
  v_exp_f32 v44, v44
  v_mfma_f32_16x16x32_bf16 a[64:67], a[228:231], v[132:135], a[64:67]
  ds_read_b128 a[216:219], v78 offset:28672
  v_mfma_f32_16x16x32_bf16 a[68:71], a[228:231], v[140:143], a[68:71]
  v_exp_f32 v45, v45
  v_mfma_f32_16x16x32_bf16 a[68:71], a[224:227], v[136:139], a[68:71]
  ds_read_b128 a[220:223], v79 offset:28672
  v_cvt_pk_bf16_f32 v172, v44, v45
  v_mfma_f32_16x16x32_bf16 a[72:75], a[224:227], v[144:147], a[72:75]
  v_exp_f32 v46, v46
  v_mfma_f32_16x16x32_bf16 a[72:75], a[228:231], v[148:151], a[72:75]
  v_mfma_f32_16x16x32_bf16 a[76:79], a[228:231], v[156:159], a[76:79]
  v_exp_f32 v47, v47
  v_mfma_f32_16x16x32_bf16 a[76:79], a[224:227], v[152:155], a[76:79]
  s_waitcnt lgkmcnt(4)
  buffer_load_dwordx4 v93, s[12:15], s17 offen offset:1024 lds
  v_mfma_f32_16x16x32_bf16 a[92:95], a[232:235], v[152:155], a[92:95]
  v_exp_f32 v48, v48
  v_mfma_f32_16x16x32_bf16 a[92:95], a[236:239], v[156:159], a[92:95]
  ds_read_b64_tr_b16 a[240:241], v86 offset:49152
  v_cvt_pk_bf16_f32 v173, v46, v47
  v_mfma_f32_16x16x32_bf16 a[88:91], a[236:239], v[148:151], a[88:91]
  v_exp_f32 v49, v49
  v_mfma_f32_16x16x32_bf16 a[88:91], a[232:235], v[144:147], a[88:91]
  ds_read_b64_tr_b16 a[242:243], v86 offset:53248
  v_cvt_pk_bf16_f32 v180, v48, v49
  v_mfma_f32_16x16x32_bf16 a[84:87], a[232:235], v[136:139], a[84:87]
  v_exp_f32 v50, v50
  v_mfma_f32_16x16x32_bf16 a[84:87], a[236:239], v[140:143], a[84:87]
  ds_read_b64_tr_b16 a[244:245], v86 offset:57344
  v_mfma_f32_16x16x32_bf16 a[80:83], a[236:239], v[132:135], a[80:83]
  v_exp_f32 v51, v51
  v_mfma_f32_16x16x32_bf16 a[80:83], a[232:235], v[128:131], a[80:83]
  s_waitcnt lgkmcnt(3)
  ds_read_b64_tr_b16 a[246:247], v86 offset:61440
  v_cvt_pk_bf16_f32 v181, v50, v51
  v_mfma_f32_16x16x32_bf16 v[56:59], a[208:211], v[192:195], v[24:27]
  v_exp_f32 v52, v52
  v_mfma_f32_16x16x32_bf16 v[56:59], a[212:215], v[208:211], v[56:59]
  ds_read_b64_tr_b16 a[248:249], v87 offset:49152
  v_mfma_f32_16x16x32_bf16 v[56:59], a[216:219], v[224:227], v[56:59]
  v_exp_f32 v53, v53
  v_mfma_f32_16x16x32_bf16 v[56:59], a[220:223], v[240:243], v[56:59]
  ds_read_b64_tr_b16 a[250:251], v87 offset:53248
  v_cvt_pk_bf16_f32 v188, v52, v53
  v_mfma_f32_16x16x32_bf16 v[60:63], a[220:223], v[244:247], v[28:31]
  v_exp_f32 v54, v54
  v_mfma_f32_16x16x32_bf16 v[60:63], a[216:219], v[228:231], v[60:63]
  ds_read_b64_tr_b16 a[252:253], v87 offset:57344
  v_mfma_f32_16x16x32_bf16 v[60:63], a[212:215], v[212:215], v[60:63]
  s_waitcnt vmcnt(7)
  s_barrier
  v_exp_f32 v55, v55
  v_mfma_f32_16x16x32_bf16 v[60:63], a[208:211], v[196:199], v[60:63]
  buffer_load_dwordx4 v92, s[12:15], s17 offen offset:2048 lds
  v_mfma_f32_16x16x32_bf16 v[64:67], a[208:211], v[200:203], v[32:35]
  v_exp_f32 v56, v56
  v_mfma_f32_16x16x32_bf16 v[64:67], a[212:215], v[216:219], v[64:67]
  ds_read_b64_tr_b16 a[254:255], v87 offset:61440
  v_cvt_pk_bf16_f32 v189, v54, v55
  v_mfma_f32_16x16x32_bf16 v[64:67], a[216:219], v[232:235], v[64:67]
  v_exp_f32 v57, v57
  v_mfma_f32_16x16x32_bf16 v[64:67], a[220:223], v[248:251], v[64:67]
  ds_read_b128 a[192:195], v76 offset:32768
  v_cvt_pk_bf16_f32 v166, v56, v57
  v_mfma_f32_16x16x32_bf16 v[68:71], a[220:223], v[252:255], v[36:39]
  v_exp_f32 v58, v58
  v_mfma_f32_16x16x32_bf16 v[68:71], a[216:219], v[236:239], v[68:71]
  ds_read_b128 a[196:199], v77 offset:32768
  v_mfma_f32_16x16x32_bf16 v[68:71], a[212:215], v[220:223], v[68:71]
  v_exp_f32 v59, v59
  v_mfma_f32_16x16x32_bf16 v[68:71], a[208:211], v[204:207], v[68:71]
  s_waitcnt lgkmcnt(6)
  v_cvt_pk_bf16_f32 v167, v58, v59
  v_mfma_f32_16x16x32_bf16 a[96:99], a[240:243], v[128:131], a[96:99]
  v_exp_f32 v60, v60
  v_mfma_f32_16x16x32_bf16 a[96:99], a[244:247], v[132:135], a[96:99]
  ds_read_b128 a[200:203], v78 offset:32768
  v_mfma_f32_16x16x32_bf16 a[100:103], a[244:247], v[140:143], a[100:103]
  v_exp_f32 v61, v61
  v_mfma_f32_16x16x32_bf16 a[100:103], a[240:243], v[136:139], a[100:103]
  ds_read_b128 a[204:207], v79 offset:32768
  v_cvt_pk_bf16_f32 v174, v60, v61
  v_mfma_f32_16x16x32_bf16 a[104:107], a[240:243], v[144:147], a[104:107]
  v_exp_f32 v62, v62
  v_mfma_f32_16x16x32_bf16 a[104:107], a[244:247], v[148:151], a[104:107]
  buffer_atomic_add v118, v94, s[48:51], 0 offen offset:16
  v_mfma_f32_16x16x32_bf16 a[108:111], a[244:247], v[156:159], a[108:111]
  v_exp_f32 v63, v63
  v_mfma_f32_16x16x32_bf16 a[108:111], a[240:243], v[152:155], a[108:111]
  s_waitcnt lgkmcnt(4)
  buffer_load_dwordx4 v93, s[12:15], s17 offen offset:3072 lds
  v_mfma_f32_16x16x32_bf16 a[124:127], a[248:251], v[152:155], a[124:127]
  v_exp_f32 v64, v64
  v_mfma_f32_16x16x32_bf16 a[124:127], a[252:255], v[156:159], a[124:127]
  ds_read_b64_tr_b16 a[224:225], v80 offset:32768
  v_cvt_pk_bf16_f32 v175, v62, v63
  v_mfma_f32_16x16x32_bf16 a[120:123], a[252:255], v[148:151], a[120:123]
  v_exp_f32 v65, v65
  v_mfma_f32_16x16x32_bf16 a[120:123], a[248:251], v[144:147], a[120:123]
  ds_read_b64_tr_b16 a[226:227], v80 offset:36864
  v_cvt_pk_bf16_f32 v182, v64, v65
  v_mfma_f32_16x16x32_bf16 a[116:119], a[248:251], v[136:139], a[116:119]
  v_exp_f32 v66, v66
  v_mfma_f32_16x16x32_bf16 a[116:119], a[252:255], v[140:143], a[116:119]
  ds_read_b64_tr_b16 a[228:229], v80 offset:40960
  v_mfma_f32_16x16x32_bf16 a[112:115], a[252:255], v[132:135], a[112:115]
  v_exp_f32 v67, v67
  v_mfma_f32_16x16x32_bf16 a[112:115], a[248:251], v[128:131], a[112:115]
  ds_read_b64_tr_b16 a[230:231], v80 offset:45056
  v_cvt_pk_bf16_f32 v183, v66, v67
  v_smfmac_f32_16x16x64_bf16 v[16:19], v[4:7], v[144:151], v116
  v_exp_f32 v68, v68
  v_smfmac_f32_16x16x64_bf16 v[20:23], v[4:7], v[152:159], v116
  s_waitcnt lgkmcnt(4)
  s_mov_b32 s19, 6
  s_branch L_loop
L_c0:
  buffer_load_dword v109, v108, s[8:11], s81 offen
  buffer_load_dword v110, v108, s[12:15], s81 offen
  s_branch L_c0_ok
L_c1:
  buffer_load_dword v117, v124, s[48:51], 0 offen offset:16 sc1
  global_load_dword v2, v[126:127], off
  s_branch L_c1_ok
.p2align 6
L_loop:
  v_mfma_f32_16x16x32_bf16 v[40:43], a[192:195], v[192:195], v[24:27]
  v_exp_f32 v69, v69
  v_mfma_f32_16x16x32_bf16 v[40:43], a[196:199], v[208:211], v[40:43]
  ds_read_b64_tr_b16 a[232:233], v81 offset:32768
  v_cvt_pk_bf16_f32 v190, v68, v69
  v_mfma_f32_16x16x32_bf16 v[40:43], a[200:203], v[224:227], v[40:43]
  v_exp_f32 v70, v70
  v_mfma_f32_16x16x32_bf16 v[40:43], a[204:207], v[240:243], v[40:43]
  s_add_u32 m0, s18, 0
  ds_read_b64_tr_b16 a[234:235], v81 offset:36864
  v_mfma_f32_16x16x32_bf16 v[44:47], a[204:207], v[244:247], v[28:31]
  v_exp_f32 v71, v71
  v_mfma_f32_16x16x32_bf16 v[44:47], a[200:203], v[228:231], v[44:47]
  s_add_u32 s16, s16, 16384
  ds_read_b64_tr_b16 a[236:237], v81 offset:40960
  v_cvt_pk_bf16_f32 v191, v70, v71
  v_mfma_f32_16x16x32_bf16 v[44:47], a[196:199], v[212:215], v[44:47]
  v_mfma_f32_16x16x32_bf16 v[44:47], a[192:195], v[196:199], v[44:47]
  buffer_load_dwordx4 v88, s[8:11], s16 offen offset:0 lds
  v_mfma_f32_16x16x32_bf16 v[48:51], a[192:195], v[200:203], v[32:35]
  v_exp_f32 v40, v40
  v_mfma_f32_16x16x32_bf16 v[48:51], a[196:199], v[216:219], v[48:51]
  ds_read_b64_tr_b16 a[238:239], v81 offset:45056
  v_mfma_f32_16x16x32_bf16 v[48:51], a[200:203], v[232:235], v[48:51]
  v_exp_f32 v41, v41
  v_mfma_f32_16x16x32_bf16 v[48:51], a[204:207], v[248:251], v[48:51]
  ds_read_b128 a[208:211], v76 offset:36864
  v_cvt_pk_bf16_f32 v128, v40, v41
  v_mfma_f32_16x16x32_bf16 v[52:55], a[204:207], v[252:255], v[36:39]
  v_exp_f32 v42, v42
  v_mfma_f32_16x16x32_bf16 v[52:55], a[200:203], v[236:239], v[52:55]
  ds_read_b128 a[212:215], v77 offset:36864
  v_mfma_f32_16x16x32_bf16 v[52:55], a[196:199], v[220:223], v[52:55]
  v_exp_f32 v43, v43
  v_mfma_f32_16x16x32_bf16 v[52:55], a[192:195], v[204:207], v[52:55]
  s_waitcnt lgkmcnt(6)
  v_cvt_pk_bf16_f32 v129, v42, v43
  v_mfma_f32_16x16x32_bf16 a[0:3], a[224:227], v[160:163], a[0:3]
  v_exp_f32 v44, v44
  v_mfma_f32_16x16x32_bf16 a[0:3], a[228:231], v[164:167], a[0:3]
  ds_read_b128 a[216:219], v78 offset:36864
  v_mfma_f32_16x16x32_bf16 a[4:7], a[228:231], v[172:175], a[4:7]
  v_exp_f32 v45, v45
  v_mfma_f32_16x16x32_bf16 a[4:7], a[224:227], v[168:171], a[4:7]
  ds_read_b128 a[220:223], v79 offset:36864
  v_cvt_pk_bf16_f32 v136, v44, v45
  v_mfma_f32_16x16x32_bf16 a[8:11], a[224:227], v[176:179], a[8:11]
  v_exp_f32 v46, v46
  v_mfma_f32_16x16x32_bf16 a[8:11], a[228:231], v[180:183], a[8:11]
  v_mfma_f32_16x16x32_bf16 a[12:15], a[228:231], v[188:191], a[12:15]
  v_exp_f32 v47, v47
  v_mfma_f32_16x16x32_bf16 a[12:15], a[224:227], v[184:187], a[12:15]
  s_waitcnt lgkmcnt(4)
  buffer_load_dwordx4 v89, s[8:11], s16 offen offset:1024 lds
  v_mfma_f32_16x16x32_bf16 a[28:31], a[232:235], v[184:187], a[28:31]
  v_exp_f32 v48, v48
  v_mfma_f32_16x16x32_bf16 a[28:31], a[236:239], v[188:191], a[28:31]
  ds_read_b64_tr_b16 a[240:241], v82 offset:32768
  v_cvt_pk_bf16_f32 v137, v46, v47
  v_mfma_f32_16x16x32_bf16 a[24:27], a[236:239], v[180:183], a[24:27]
  v_exp_f32 v49, v49
  v_mfma_f32_16x16x32_bf16 a[24:27], a[232:235], v[176:179], a[24:27]
  ds_read_b64_tr_b16 a[242:243], v82 offset:36864
  v_cvt_pk_bf16_f32 v144, v48, v49
  v_mfma_f32_16x16x32_bf16 a[20:23], a[232:235], v[168:171], a[20:23]
  v_exp_f32 v50, v50
  v_mfma_f32_16x16x32_bf16 a[20:23], a[236:239], v[172:175], a[20:23]
  ds_read_b64_tr_b16 a[244:245], v82 offset:40960
  v_mfma_f32_16x16x32_bf16 a[16:19], a[236:239], v[164:167], a[16:19]
  v_exp_f32 v51, v51
  v_mfma_f32_16x16x32_bf16 a[16:19], a[232:235], v[160:163], a[16:19]
  s_waitcnt lgkmcnt(3)
  ds_read_b64_tr_b16 a[246:247], v82 offset:45056
  v_cvt_pk_bf16_f32 v145, v50, v51
  v_mfma_f32_16x16x32_bf16 v[56:59], a[208:211], v[192:195], v[24:27]
  v_exp_f32 v52, v52
  v_mfma_f32_16x16x32_bf16 v[56:59], a[212:215], v[208:211], v[56:59]
  ds_read_b64_tr_b16 a[248:249], v83 offset:32768
  v_mfma_f32_16x16x32_bf16 v[56:59], a[216:219], v[224:227], v[56:59]
  v_exp_f32 v53, v53
  v_mfma_f32_16x16x32_bf16 v[56:59], a[220:223], v[240:243], v[56:59]
  ds_read_b64_tr_b16 a[250:251], v83 offset:36864
  v_cvt_pk_bf16_f32 v152, v52, v53
  v_mfma_f32_16x16x32_bf16 v[60:63], a[220:223], v[244:247], v[28:31]
  v_exp_f32 v54, v54
  v_mfma_f32_16x16x32_bf16 v[60:63], a[216:219], v[228:231], v[60:63]
  ds_read_b64_tr_b16 a[252:253], v83 offset:40960
  v_mfma_f32_16x16x32_bf16 v[60:63], a[212:215], v[212:215], v[60:63]
  v_exp_f32 v55, v55
  v_mfma_f32_16x16x32_bf16 v[60:63], a[208:211], v[196:199], v[60:63]
  buffer_load_dwordx4 v90, s[8:11], s16 offen offset:2048 lds
  v_mfma_f32_16x16x32_bf16 v[64:67], a[208:211], v[200:203], v[32:35]
  v_exp_f32 v56, v56
  v_mfma_f32_16x16x32_bf16 v[64:67], a[212:215], v[216:219], v[64:67]
  ds_read_b64_tr_b16 a[254:255], v83 offset:45056
  v_cvt_pk_bf16_f32 v153, v54, v55
  v_mfma_f32_16x16x32_bf16 v[64:67], a[216:219], v[232:235], v[64:67]
  v_exp_f32 v57, v57
  v_mfma_f32_16x16x32_bf16 v[64:67], a[220:223], v[248:251], v[64:67]
  ds_read_b128 a[192:195], v76 offset:40960
  v_cvt_pk_bf16_f32 v130, v56, v57
  v_mfma_f32_16x16x32_bf16 v[68:71], a[220:223], v[252:255], v[36:39]
  v_exp_f32 v58, v58
  v_mfma_f32_16x16x32_bf16 v[68:71], a[216:219], v[236:239], v[68:71]
  ds_read_b128 a[196:199], v77 offset:40960
  v_mfma_f32_16x16x32_bf16 v[68:71], a[212:215], v[220:223], v[68:71]
  v_exp_f32 v59, v59
  v_mfma_f32_16x16x32_bf16 v[68:71], a[208:211], v[204:207], v[68:71]
  s_waitcnt lgkmcnt(6)
  v_cvt_pk_bf16_f32 v131, v58, v59
  v_mfma_f32_16x16x32_bf16 a[32:35], a[240:243], v[160:163], a[32:35]
  v_exp_f32 v60, v60
  v_mfma_f32_16x16x32_bf16 a[32:35], a[244:247], v[164:167], a[32:35]
  ds_read_b128 a[200:203], v78 offset:40960
  v_mfma_f32_16x16x32_bf16 a[36:39], a[244:247], v[172:175], a[36:39]
  v_exp_f32 v61, v61
  v_mfma_f32_16x16x32_bf16 a[36:39], a[240:243], v[168:171], a[36:39]
  ds_read_b128 a[204:207], v79 offset:40960
  v_cvt_pk_bf16_f32 v138, v60, v61
  v_mfma_f32_16x16x32_bf16 a[40:43], a[240:243], v[176:179], a[40:43]
  s_cmp_eq_u32 s19, 2
  v_exp_f32 v62, v62
  v_mfma_f32_16x16x32_bf16 a[40:43], a[244:247], v[180:183], a[40:43]
  s_cbranch_scc1 L_c0
L_c0_ok:
  v_mfma_f32_16x16x32_bf16 a[44:47], a[244:247], v[188:191], a[44:47]
  v_exp_f32 v63, v63
  v_mfma_f32_16x16x32_bf16 a[44:47], a[240:243], v[184:187], a[44:47]
  s_waitcnt lgkmcnt(4)
  buffer_load_dwordx4 v91, s[8:11], s16 offen offset:3072 lds
  v_mfma_f32_16x16x32_bf16 a[60:63], a[248:251], v[184:187], a[60:63]
  v_exp_f32 v64, v64
  v_mfma_f32_16x16x32_bf16 a[60:63], a[252:255], v[188:191], a[60:63]
  ds_read_b64_tr_b16 a[224:225], v84 offset:32768
  v_cvt_pk_bf16_f32 v139, v62, v63
  v_mfma_f32_16x16x32_bf16 a[56:59], a[252:255], v[180:183], a[56:59]
  v_exp_f32 v65, v65
  v_mfma_f32_16x16x32_bf16 a[56:59], a[248:251], v[176:179], a[56:59]
  ds_read_b64_tr_b16 a[226:227], v84 offset:36864
  v_cvt_pk_bf16_f32 v146, v64, v65
  v_mfma_f32_16x16x32_bf16 a[52:55], a[248:251], v[168:171], a[52:55]
  v_exp_f32 v66, v66
  v_mfma_f32_16x16x32_bf16 a[52:55], a[252:255], v[172:175], a[52:55]
  ds_read_b64_tr_b16 a[228:229], v84 offset:40960
  v_mfma_f32_16x16x32_bf16 a[48:51], a[252:255], v[164:167], a[48:51]
  v_exp_f32 v67, v67
  v_mfma_f32_16x16x32_bf16 a[48:51], a[248:251], v[160:163], a[48:51]
  ds_read_b64_tr_b16 a[230:231], v84 offset:45056
  v_cvt_pk_bf16_f32 v147, v66, v67
  v_smfmac_f32_16x16x64_bf16 v[8:11], v[4:7], v[160:167], v116
  v_exp_f32 v68, v68
  v_smfmac_f32_16x16x64_bf16 v[12:15], v[4:7], v[168:175], v116
  s_waitcnt lgkmcnt(4)
  v_mfma_f32_16x16x32_bf16 v[40:43], a[192:195], v[192:195], v[24:27]
  v_exp_f32 v69, v69
  v_mfma_f32_16x16x32_bf16 v[40:43], a[196:199], v[208:211], v[40:43]
  ds_read_b64_tr_b16 a[232:233], v85 offset:32768
  v_cvt_pk_bf16_f32 v154, v68, v69
  v_mfma_f32_16x16x32_bf16 v[40:43], a[200:203], v[224:227], v[40:43]
  v_exp_f32 v70, v70
  v_mfma_f32_16x16x32_bf16 v[40:43], a[204:207], v[240:243], v[40:43]
  s_add_u32 m0, s18, 65536
  ds_read_b64_tr_b16 a[234:235], v85 offset:36864
  v_mfma_f32_16x16x32_bf16 v[44:47], a[204:207], v[244:247], v[28:31]
  v_exp_f32 v71, v71
  v_mfma_f32_16x16x32_bf16 v[44:47], a[200:203], v[228:231], v[44:47]
  s_add_u32 s17, s17, 16384
  ds_read_b64_tr_b16 a[236:237], v85 offset:40960
  v_cvt_pk_bf16_f32 v155, v70, v71
  v_mfma_f32_16x16x32_bf16 v[44:47], a[196:199], v[212:215], v[44:47]
  v_mfma_f32_16x16x32_bf16 v[44:47], a[192:195], v[196:199], v[44:47]
  buffer_load_dwordx4 v92, s[12:15], s17 offen offset:0 lds
  v_mfma_f32_16x16x32_bf16 v[48:51], a[192:195], v[200:203], v[32:35]
  v_exp_f32 v40, v40
  v_mfma_f32_16x16x32_bf16 v[48:51], a[196:199], v[216:219], v[48:51]
  ds_read_b64_tr_b16 a[238:239], v85 offset:45056
  v_mfma_f32_16x16x32_bf16 v[48:51], a[200:203], v[232:235], v[48:51]
  v_exp_f32 v41, v41
  v_mfma_f32_16x16x32_bf16 v[48:51], a[204:207], v[248:251], v[48:51]
  ds_read_b128 a[208:211], v76 offset:45056
  v_cvt_pk_bf16_f32 v132, v40, v41
  v_mfma_f32_16x16x32_bf16 v[52:55], a[204:207], v[252:255], v[36:39]
  v_exp_f32 v42, v42
  v_mfma_f32_16x16x32_bf16 v[52:55], a[200:203], v[236:239], v[52:55]
  ds_read_b128 a[212:215], v77 offset:45056
  v_mfma_f32_16x16x32_bf16 v[52:55], a[196:199], v[220:223], v[52:55]
  v_exp_f32 v43, v43
  v_mfma_f32_16x16x32_bf16 v[52:55], a[192:195], v[204:207], v[52:55]
  s_waitcnt lgkmcnt(6)
  v_cvt_pk_bf16_f32 v133, v42, v43
  v_mfma_f32_16x16x32_bf16 a[64:67], a[224:227], v[160:163], a[64:67]
  v_exp_f32 v44, v44
  v_mfma_f32_16x16x32_bf16 a[64:67], a[228:231], v[164:167], a[64:67]
  ds_read_b128 a[216:219], v78 offset:45056
  v_mfma_f32_16x16x32_bf16 a[68:71], a[228:231], v[172:175], a[68:71]
  v_exp_f32 v45, v45
  v_mfma_f32_16x16x32_bf16 a[68:71], a[224:227], v[168:171], a[68:71]
  ds_read_b128 a[220:223], v79 offset:45056
  v_cvt_pk_bf16_f32 v140, v44, v45
  v_mfma_f32_16x16x32_bf16 a[72:75], a[224:227], v[176:179], a[72:75]
  v_exp_f32 v46, v46
  v_mfma_f32_16x16x32_bf16 a[72:75], a[228:231], v[180:183], a[72:75]
  v_mfma_f32_16x16x32_bf16 a[76:79], a[228:231], v[188:191], a[76:79]
  v_exp_f32 v47, v47
  v_mfma_f32_16x16x32_bf16 a[76:79], a[224:227], v[184:187], a[76:79]
  s_waitcnt lgkmcnt(4)
  buffer_load_dwordx4 v93, s[12:15], s17 offen offset:1024 lds
  v_mfma_f32_16x16x32_bf16 a[92:95], a[232:235], v[184:187], a[92:95]
  v_exp_f32 v48, v48
  v_mfma_f32_16x16x32_bf16 a[92:95], a[236:239], v[188:191], a[92:95]
  ds_read_b64_tr_b16 a[240:241], v86 offset:32768
  v_cvt_pk_bf16_f32 v141, v46, v47
  v_mfma_f32_16x16x32_bf16 a[88:91], a[236:239], v[180:183], a[88:91]
  v_exp_f32 v49, v49
  v_mfma_f32_16x16x32_bf16 a[88:91], a[232:235], v[176:179], a[88:91]
  ds_read_b64_tr_b16 a[242:243], v86 offset:36864
  v_cvt_pk_bf16_f32 v148, v48, v49
  v_mfma_f32_16x16x32_bf16 a[84:87], a[232:235], v[168:171], a[84:87]
  v_exp_f32 v50, v50
  v_mfma_f32_16x16x32_bf16 a[84:87], a[236:239], v[172:175], a[84:87]
  ds_read_b64_tr_b16 a[244:245], v86 offset:40960
  v_mfma_f32_16x16x32_bf16 a[80:83], a[236:239], v[164:167], a[80:83]
  v_exp_f32 v51, v51
  v_mfma_f32_16x16x32_bf16 a[80:83], a[232:235], v[160:163], a[80:83]
  s_waitcnt lgkmcnt(3)
  ds_read_b64_tr_b16 a[246:247], v86 offset:45056
  v_cvt_pk_bf16_f32 v149, v50, v51
  v_mfma_f32_16x16x32_bf16 v[56:59], a[208:211], v[192:195], v[24:27]
  v_exp_f32 v52, v52
  v_mfma_f32_16x16x32_bf16 v[56:59], a[212:215], v[208:211], v[56:59]
  ds_read_b64_tr_b16 a[248:249], v87 offset:32768
  v_mfma_f32_16x16x32_bf16 v[56:59], a[216:219], v[224:227], v[56:59]
  v_exp_f32 v53, v53
  v_mfma_f32_16x16x32_bf16 v[56:59], a[220:223], v[240:243], v[56:59]
  ds_read_b64_tr_b16 a[250:251], v87 offset:36864
  v_cvt_pk_bf16_f32 v156, v52, v53
  v_mfma_f32_16x16x32_bf16 v[60:63], a[220:223], v[244:247], v[28:31]
  v_exp_f32 v54, v54
  v_mfma_f32_16x16x32_bf16 v[60:63], a[216:219], v[228:231], v[60:63]
  ds_read_b64_tr_b16 a[252:253], v87 offset:40960
  v_mfma_f32_16x16x32_bf16 v[60:63], a[212:215], v[212:215], v[60:63]
  s_waitcnt vmcnt(6)
  s_barrier
  v_exp_f32 v55, v55
  v_mfma_f32_16x16x32_bf16 v[60:63], a[208:211], v[196:199], v[60:63]
  buffer_load_dwordx4 v92, s[12:15], s17 offen offset:2048 lds
  v_mfma_f32_16x16x32_bf16 v[64:67], a[208:211], v[200:203], v[32:35]
  v_exp_f32 v56, v56
  v_mfma_f32_16x16x32_bf16 v[64:67], a[212:215], v[216:219], v[64:67]
  ds_read_b64_tr_b16 a[254:255], v87 offset:45056
  v_cvt_pk_bf16_f32 v157, v54, v55
  v_mfma_f32_16x16x32_bf16 v[64:67], a[216:219], v[232:235], v[64:67]
  v_exp_f32 v57, v57
  v_mfma_f32_16x16x32_bf16 v[64:67], a[220:223], v[248:251], v[64:67]
  ds_read_b128 a[192:195], v76 offset:49152
  v_cvt_pk_bf16_f32 v134, v56, v57
  v_mfma_f32_16x16x32_bf16 v[68:71], a[220:223], v[252:255], v[36:39]
  v_exp_f32 v58, v58
  v_mfma_f32_16x16x32_bf16 v[68:71], a[216:219], v[236:239], v[68:71]
  ds_read_b128 a[196:199], v77 offset:49152
  v_mfma_f32_16x16x32_bf16 v[68:71], a[212:215], v[220:223], v[68:71]
  v_exp_f32 v59, v59
  v_mfma_f32_16x16x32_bf16 v[68:71], a[208:211], v[204:207], v[68:71]
  s_waitcnt lgkmcnt(6)
  v_cvt_pk_bf16_f32 v135, v58, v59
  v_mfma_f32_16x16x32_bf16 a[96:99], a[240:243], v[160:163], a[96:99]
  v_exp_f32 v60, v60
  v_mfma_f32_16x16x32_bf16 a[96:99], a[244:247], v[164:167], a[96:99]
  ds_read_b128 a[200:203], v78 offset:49152
  v_mfma_f32_16x16x32_bf16 a[100:103], a[244:247], v[172:175], a[100:103]
  v_exp_f32 v61, v61
  v_mfma_f32_16x16x32_bf16 a[100:103], a[240:243], v[168:171], a[100:103]
  ds_read_b128 a[204:207], v79 offset:49152
  v_cvt_pk_bf16_f32 v142, v60, v61
  v_mfma_f32_16x16x32_bf16 a[104:107], a[240:243], v[176:179], a[104:107]
  v_exp_f32 v62, v62
  v_mfma_f32_16x16x32_bf16 a[104:107], a[244:247], v[180:183], a[104:107]
  v_mfma_f32_16x16x32_bf16 a[108:111], a[244:247], v[188:191], a[108:111]
  v_exp_f32 v63, v63
  v_mfma_f32_16x16x32_bf16 a[108:111], a[240:243], v[184:187], a[108:111]
  s_waitcnt lgkmcnt(4)
  buffer_load_dwordx4 v93, s[12:15], s17 offen offset:3072 lds
  v_mfma_f32_16x16x32_bf16 a[124:127], a[248:251], v[184:187], a[124:127]
  v_exp_f32 v64, v64
  v_mfma_f32_16x16x32_bf16 a[124:127], a[252:255], v[188:191], a[124:127]
  ds_read_b64_tr_b16 a[224:225], v80 offset:16384
  v_cvt_pk_bf16_f32 v143, v62, v63
  v_mfma_f32_16x16x32_bf16 a[120:123], a[252:255], v[180:183], a[120:123]
  v_exp_f32 v65, v65
  v_mfma_f32_16x16x32_bf16 a[120:123], a[248:251], v[176:179], a[120:123]
  ds_read_b64_tr_b16 a[226:227], v80 offset:20480
  v_cvt_pk_bf16_f32 v150, v64, v65
  v_mfma_f32_16x16x32_bf16 a[116:119], a[248:251], v[168:171], a[116:119]
  v_exp_f32 v66, v66
  v_mfma_f32_16x16x32_bf16 a[116:119], a[252:255], v[172:175], a[116:119]
  ds_read_b64_tr_b16 a[228:229], v80 offset:24576
  v_mfma_f32_16x16x32_bf16 a[112:115], a[252:255], v[164:167], a[112:115]
  v_exp_f32 v67, v67
  v_mfma_f32_16x16x32_bf16 a[112:115], a[248:251], v[160:163], a[112:115]
  ds_read_b64_tr_b16 a[230:231], v80 offset:28672
  v_cvt_pk_bf16_f32 v151, v66, v67
  v_smfmac_f32_16x16x64_bf16 v[16:19], v[4:7], v[176:183], v116
  v_exp_f32 v68, v68
  v_smfmac_f32_16x16x64_bf16 v[20:23], v[4:7], v[184:191], v116
  s_waitcnt lgkmcnt(4)
  v_mfma_f32_16x16x32_bf16 v[40:43], a[192:195], v[192:195], v[24:27]
  v_exp_f32 v69, v69
  v_mfma_f32_16x16x32_bf16 v[40:43], a[196:199], v[208:211], v[40:43]
  ds_read_b64_tr_b16 a[232:233], v81 offset:16384
  v_cvt_pk_bf16_f32 v158, v68, v69
  v_mfma_f32_16x16x32_bf16 v[40:43], a[200:203], v[224:227], v[40:43]
  v_exp_f32 v70, v70
  v_mfma_f32_16x16x32_bf16 v[40:43], a[204:207], v[240:243], v[40:43]
  s_add_u32 m0, s18, 16384
  ds_read_b64_tr_b16 a[234:235], v81 offset:20480
  v_mfma_f32_16x16x32_bf16 v[44:47], a[204:207], v[244:247], v[28:31]
  v_exp_f32 v71, v71
  v_mfma_f32_16x16x32_bf16 v[44:47], a[200:203], v[228:231], v[44:47]
  s_add_u32 s16, s16, 16384
  ds_read_b64_tr_b16 a[236:237], v81 offset:24576
  v_cvt_pk_bf16_f32 v159, v70, v71
  v_mfma_f32_16x16x32_bf16 v[44:47], a[196:199], v[212:215], v[44:47]
  v_mfma_f32_16x16x32_bf16 v[44:47], a[192:195], v[196:199], v[44:47]
  buffer_load_dwordx4 v88, s[8:11], s16 offen offset:0 lds
  v_mfma_f32_16x16x32_bf16 v[48:51], a[192:195], v[200:203], v[32:35]
  v_exp_f32 v40, v40
  v_mfma_f32_16x16x32_bf16 v[48:51], a[196:199], v[216:219], v[48:51]
L_pad_fm3_4:
  s_cbranch_execz L_pad_fm3_5
  ds_read_b64_tr_b16 a[238:239], v81 offset:28672
  v_mfma_f32_16x16x32_bf16 v[48:51], a[200:203], v[232:235], v[48:51]
  v_exp_f32 v41, v41
  v_mfma_f32_16x16x32_bf16 v[48:51], a[204:207], v[248:251], v[48:51]
  ds_read_b128 a[208:211], v76 offset:53248
  v_cvt_pk_bf16_f32 v160, v40, v41
  v_mfma_f32_16x16x32_bf16 v[52:55], a[204:207], v[252:255], v[36:39]
  v_exp_f32 v42, v42
  v_mfma_f32_16x16x32_bf16 v[52:55], a[200:203], v[236:239], v[52:55]
  ds_read_b128 a[212:215], v77 offset:53248
  v_mfma_f32_16x16x32_bf16 v[52:55], a[196:199], v[220:223], v[52:55]
  v_exp_f32 v43, v43
  v_mfma_f32_16x16x32_bf16 v[52:55], a[192:195], v[204:207], v[52:55]
  s_waitcnt lgkmcnt(6)
  v_cvt_pk_bf16_f32 v161, v42, v43
  v_mfma_f32_16x16x32_bf16 a[0:3], a[224:227], v[128:131], a[0:3]
  v_exp_f32 v44, v44
  v_mfma_f32_16x16x32_bf16 a[0:3], a[228:231], v[132:135], a[0:3]
  ds_read_b128 a[216:219], v78 offset:53248
  v_mfma_f32_16x16x32_bf16 a[4:7], a[228:231], v[140:143], a[4:7]
  v_exp_f32 v45, v45
  v_mfma_f32_16x16x32_bf16 a[4:7], a[224:227], v[136:139], a[4:7]
  ds_read_b128 a[220:223], v79 offset:53248
  v_cvt_pk_bf16_f32 v168, v44, v45
  v_mfma_f32_16x16x32_bf16 a[8:11], a[224:227], v[144:147], a[8:11]
  v_exp_f32 v46, v46
  v_mfma_f32_16x16x32_bf16 a[8:11], a[228:231], v[148:151], a[8:11]
  v_mfma_f32_16x16x32_bf16 a[12:15], a[228:231], v[156:159], a[12:15]
  v_exp_f32 v47, v47
  v_mfma_f32_16x16x32_bf16 a[12:15], a[224:227], v[152:155], a[12:15]
  s_waitcnt lgkmcnt(4)
  buffer_load_dwordx4 v89, s[8:11], s16 offen offset:1024 lds
  v_mfma_f32_16x16x32_bf16 a[28:31], a[232:235], v[152:155], a[28:31]
  v_exp_f32 v48, v48
  v_mfma_f32_16x16x32_bf16 a[28:31], a[236:239], v[156:159], a[28:31]
  ds_read_b64_tr_b16 a[240:241], v82 offset:16384
  v_cvt_pk_bf16_f32 v169, v46, v47
  v_mfma_f32_16x16x32_bf16 a[24:27], a[236:239], v[148:151], a[24:27]
  v_exp_f32 v49, v49
  v_mfma_f32_16x16x32_bf16 a[24:27], a[232:235], v[144:147], a[24:27]
  ds_read_b64_tr_b16 a[242:243], v82 offset:20480
  v_cvt_pk_bf16_f32 v176, v48, v49
  v_mfma_f32_16x16x32_bf16 a[20:23], a[232:235], v[136:139], a[20:23]
  v_exp_f32 v50, v50
  v_mfma_f32_16x16x32_bf16 a[20:23], a[236:239], v[140:143], a[20:23]
  ds_read_b64_tr_b16 a[244:245], v82 offset:24576
  v_mfma_f32_16x16x32_bf16 a[16:19], a[236:239], v[132:135], a[16:19]
  v_exp_f32 v51, v51
  v_mfma_f32_16x16x32_bf16 a[16:19], a[232:235], v[128:131], a[16:19]
  s_waitcnt lgkmcnt(3)
  ds_read_b64_tr_b16 a[246:247], v82 offset:28672
  v_cvt_pk_bf16_f32 v177, v50, v51
  v_mfma_f32_16x16x32_bf16 v[56:59], a[208:211], v[192:195], v[24:27]
  v_exp_f32 v52, v52
  v_mfma_f32_16x16x32_bf16 v[56:59], a[212:215], v[208:211], v[56:59]
  ds_read_b64_tr_b16 a[248:249], v83 offset:16384
  v_mfma_f32_16x16x32_bf16 v[56:59], a[216:219], v[224:227], v[56:59]
  v_exp_f32 v53, v53
  v_mfma_f32_16x16x32_bf16 v[56:59], a[220:223], v[240:243], v[56:59]
  ds_read_b64_tr_b16 a[250:251], v83 offset:20480
  v_cvt_pk_bf16_f32 v184, v52, v53
  v_mfma_f32_16x16x32_bf16 v[60:63], a[220:223], v[244:247], v[28:31]
  v_exp_f32 v54, v54
  v_mfma_f32_16x16x32_bf16 v[60:63], a[216:219], v[228:231], v[60:63]
  ds_read_b64_tr_b16 a[252:253], v83 offset:24576
  v_mfma_f32_16x16x32_bf16 v[60:63], a[212:215], v[212:215], v[60:63]
  v_exp_f32 v55, v55
  v_mfma_f32_16x16x32_bf16 v[60:63], a[208:211], v[196:199], v[60:63]
  buffer_load_dwordx4 v90, s[8:11], s16 offen offset:2048 lds
  v_mfma_f32_16x16x32_bf16 v[64:67], a[208:211], v[200:203], v[32:35]
  v_exp_f32 v56, v56
  v_mfma_f32_16x16x32_bf16 v[64:67], a[212:215], v[216:219], v[64:67]
  ds_read_b64_tr_b16 a[254:255], v83 offset:28672
  v_cvt_pk_bf16_f32 v185, v54, v55
  v_mfma_f32_16x16x32_bf16 v[64:67], a[216:219], v[232:235], v[64:67]
  v_exp_f32 v57, v57
  v_mfma_f32_16x16x32_bf16 v[64:67], a[220:223], v[248:251], v[64:67]
  ds_read_b128 a[192:195], v76 offset:57344
  v_cvt_pk_bf16_f32 v162, v56, v57
  v_mfma_f32_16x16x32_bf16 v[68:71], a[220:223], v[252:255], v[36:39]
  v_exp_f32 v58, v58
  v_mfma_f32_16x16x32_bf16 v[68:71], a[216:219], v[236:239], v[68:71]
  ds_read_b128 a[196:199], v77 offset:57344
  v_mfma_f32_16x16x32_bf16 v[68:71], a[212:215], v[220:223], v[68:71]
  v_exp_f32 v59, v59
  v_mfma_f32_16x16x32_bf16 v[68:71], a[208:211], v[204:207], v[68:71]
  s_waitcnt lgkmcnt(6)
  v_cvt_pk_bf16_f32 v163, v58, v59
  v_mfma_f32_16x16x32_bf16 a[32:35], a[240:243], v[128:131], a[32:35]
  v_exp_f32 v60, v60
  v_mfma_f32_16x16x32_bf16 a[32:35], a[244:247], v[132:135], a[32:35]
  ds_read_b128 a[200:203], v78 offset:57344
  v_mfma_f32_16x16x32_bf16 a[36:39], a[244:247], v[140:143], a[36:39]
  v_exp_f32 v61, v61
  v_mfma_f32_16x16x32_bf16 a[36:39], a[240:243], v[136:139], a[36:39]
  ds_read_b128 a[204:207], v79 offset:57344
  v_cvt_pk_bf16_f32 v170, v60, v61
  v_mfma_f32_16x16x32_bf16 a[40:43], a[240:243], v[144:147], a[40:43]
  s_cmp_eq_u32 s19, 2
  v_exp_f32 v62, v62
  v_mfma_f32_16x16x32_bf16 a[40:43], a[244:247], v[148:151], a[40:43]
  s_cbranch_scc1 L_c1
L_c1_ok:
  v_mfma_f32_16x16x32_bf16 a[44:47], a[244:247], v[156:159], a[44:47]
  v_exp_f32 v63, v63
  v_mfma_f32_16x16x32_bf16 a[44:47], a[240:243], v[152:155], a[44:47]
  s_waitcnt lgkmcnt(4)
  buffer_load_dwordx4 v91, s[8:11], s16 offen offset:3072 lds
  v_mfma_f32_16x16x32_bf16 a[60:63], a[248:251], v[152:155], a[60:63]
  v_exp_f32 v64, v64
  v_mfma_f32_16x16x32_bf16 a[60:63], a[252:255], v[156:159], a[60:63]
  ds_read_b64_tr_b16 a[224:225], v84 offset:16384
  v_cvt_pk_bf16_f32 v171, v62, v63
  v_mfma_f32_16x16x32_bf16 a[56:59], a[252:255], v[148:151], a[56:59]
  v_exp_f32 v65, v65
  v_mfma_f32_16x16x32_bf16 a[56:59], a[248:251], v[144:147], a[56:59]
  ds_read_b64_tr_b16 a[226:227], v84 offset:20480
  v_cvt_pk_bf16_f32 v178, v64, v65
  v_mfma_f32_16x16x32_bf16 a[52:55], a[248:251], v[136:139], a[52:55]
  v_exp_f32 v66, v66
  v_mfma_f32_16x16x32_bf16 a[52:55], a[252:255], v[140:143], a[52:55]
  ds_read_b64_tr_b16 a[228:229], v84 offset:24576
  v_mfma_f32_16x16x32_bf16 a[48:51], a[252:255], v[132:135], a[48:51]
  v_exp_f32 v67, v67
  v_mfma_f32_16x16x32_bf16 a[48:51], a[248:251], v[128:131], a[48:51]
  ds_read_b64_tr_b16 a[230:231], v84 offset:28672
  v_cvt_pk_bf16_f32 v179, v66, v67
  v_smfmac_f32_16x16x64_bf16 v[8:11], v[4:7], v[128:135], v116
  v_exp_f32 v68, v68
  v_smfmac_f32_16x16x64_bf16 v[12:15], v[4:7], v[136:143], v116
  s_waitcnt lgkmcnt(4)
  v_mfma_f32_16x16x32_bf16 v[40:43], a[192:195], v[192:195], v[24:27]
  v_exp_f32 v69, v69
  v_mfma_f32_16x16x32_bf16 v[40:43], a[196:199], v[208:211], v[40:43]
  ds_read_b64_tr_b16 a[232:233], v85 offset:16384
  v_cvt_pk_bf16_f32 v186, v68, v69
  v_mfma_f32_16x16x32_bf16 v[40:43], a[200:203], v[224:227], v[40:43]
  v_exp_f32 v70, v70
  v_mfma_f32_16x16x32_bf16 v[40:43], a[204:207], v[240:243], v[40:43]
  s_add_u32 m0, s18, 114688
  ds_read_b64_tr_b16 a[234:235], v85 offset:20480
  v_mfma_f32_16x16x32_bf16 v[44:47], a[204:207], v[244:247], v[28:31]
  v_exp_f32 v71, v71
  v_mfma_f32_16x16x32_bf16 v[44:47], a[200:203], v[228:231], v[44:47]
  s_add_u32 s17, s17, 16384
  ds_read_b64_tr_b16 a[236:237], v85 offset:24576
  v_cvt_pk_bf16_f32 v187, v70, v71
  v_mfma_f32_16x16x32_bf16 v[44:47], a[196:199], v[212:215], v[44:47]
  v_mfma_f32_16x16x32_bf16 v[44:47], a[192:195], v[196:199], v[44:47]
  buffer_load_dwordx4 v92, s[12:15], s17 offen offset:0 lds
  v_mfma_f32_16x16x32_bf16 v[48:51], a[192:195], v[200:203], v[32:35]
  v_exp_f32 v40, v40
  v_mfma_f32_16x16x32_bf16 v[48:51], a[196:199], v[216:219], v[48:51]
  ds_read_b64_tr_b16 a[238:239], v85 offset:28672
  v_mfma_f32_16x16x32_bf16 v[48:51], a[200:203], v[232:235], v[48:51]
  v_exp_f32 v41, v41
  v_mfma_f32_16x16x32_bf16 v[48:51], a[204:207], v[248:251], v[48:51]
  ds_read_b128 a[208:211], v76 offset:61440
  v_cvt_pk_bf16_f32 v164, v40, v41
  v_mfma_f32_16x16x32_bf16 v[52:55], a[204:207], v[252:255], v[36:39]
  v_exp_f32 v42, v42
  v_mfma_f32_16x16x32_bf16 v[52:55], a[200:203], v[236:239], v[52:55]
  ds_read_b128 a[212:215], v77 offset:61440
  v_mfma_f32_16x16x32_bf16 v[52:55], a[196:199], v[220:223], v[52:55]
  v_exp_f32 v43, v43
  v_mfma_f32_16x16x32_bf16 v[52:55], a[192:195], v[204:207], v[52:55]
  s_waitcnt lgkmcnt(6)
  v_cvt_pk_bf16_f32 v165, v42, v43
  v_mfma_f32_16x16x32_bf16 a[64:67], a[224:227], v[128:131], a[64:67]
  v_exp_f32 v44, v44
  v_mfma_f32_16x16x32_bf16 a[64:67], a[228:231], v[132:135], a[64:67]
  ds_read_b128 a[216:219], v78 offset:61440
  v_mfma_f32_16x16x32_bf16 a[68:71], a[228:231], v[140:143], a[68:71]
  v_exp_f32 v45, v45
  v_mfma_f32_16x16x32_bf16 a[68:71], a[224:227], v[136:139], a[68:71]
  ds_read_b128 a[220:223], v79 offset:61440
  v_cvt_pk_bf16_f32 v172, v44, v45
  v_mfma_f32_16x16x32_bf16 a[72:75], a[224:227], v[144:147], a[72:75]
  v_exp_f32 v46, v46
  v_mfma_f32_16x16x32_bf16 a[72:75], a[228:231], v[148:151], a[72:75]
  v_mfma_f32_16x16x32_bf16 a[76:79], a[228:231], v[156:159], a[76:79]
  v_exp_f32 v47, v47
  v_mfma_f32_16x16x32_bf16 a[76:79], a[224:227], v[152:155], a[76:79]
  s_waitcnt lgkmcnt(4)
  buffer_load_dwordx4 v93, s[12:15], s17 offen offset:1024 lds
  v_mfma_f32_16x16x32_bf16 a[92:95], a[232:235], v[152:155], a[92:95]
  v_exp_f32 v48, v48
  v_mfma_f32_16x16x32_bf16 a[92:95], a[236:239], v[156:159], a[92:95]
  ds_read_b64_tr_b16 a[240:241], v86 offset:16384
  v_cvt_pk_bf16_f32 v173, v46, v47
  v_mfma_f32_16x16x32_bf16 a[88:91], a[236:239], v[148:151], a[88:91]
  v_exp_f32 v49, v49
  v_mfma_f32_16x16x32_bf16 a[88:91], a[232:235], v[144:147], a[88:91]
  ds_read_b64_tr_b16 a[242:243], v86 offset:20480
  v_cvt_pk_bf16_f32 v180, v48, v49
  v_mfma_f32_16x16x32_bf16 a[84:87], a[232:235], v[136:139], a[84:87]
  v_exp_f32 v50, v50
  v_mfma_f32_16x16x32_bf16 a[84:87], a[236:239], v[140:143], a[84:87]
  ds_read_b64_tr_b16 a[244:245], v86 offset:24576
  v_mfma_f32_16x16x32_bf16 a[80:83], a[236:239], v[132:135], a[80:83]
  v_exp_f32 v51, v51
  v_mfma_f32_16x16x32_bf16 a[80:83], a[232:235], v[128:131], a[80:83]
  s_waitcnt lgkmcnt(3)
  ds_read_b64_tr_b16 a[246:247], v86 offset:28672
  v_cvt_pk_bf16_f32 v181, v50, v51
  v_mfma_f32_16x16x32_bf16 v[56:59], a[208:211], v[192:195], v[24:27]
  v_exp_f32 v52, v52
  v_mfma_f32_16x16x32_bf16 v[56:59], a[212:215], v[208:211], v[56:59]
  ds_read_b64_tr_b16 a[248:249], v87 offset:16384
  v_mfma_f32_16x16x32_bf16 v[56:59], a[216:219], v[224:227], v[56:59]
  v_exp_f32 v53, v53
  v_mfma_f32_16x16x32_bf16 v[56:59], a[220:223], v[240:243], v[56:59]
  ds_read_b64_tr_b16 a[250:251], v87 offset:20480
  v_cvt_pk_bf16_f32 v188, v52, v53
  v_mfma_f32_16x16x32_bf16 v[60:63], a[220:223], v[244:247], v[28:31]
  v_exp_f32 v54, v54
  v_mfma_f32_16x16x32_bf16 v[60:63], a[216:219], v[228:231], v[60:63]
  ds_read_b64_tr_b16 a[252:253], v87 offset:24576
  v_mfma_f32_16x16x32_bf16 v[60:63], a[212:215], v[212:215], v[60:63]
  s_waitcnt vmcnt(6)
  s_barrier
  v_exp_f32 v55, v55
  v_mfma_f32_16x16x32_bf16 v[60:63], a[208:211], v[196:199], v[60:63]
  buffer_load_dwordx4 v92, s[12:15], s17 offen offset:2048 lds
  v_mfma_f32_16x16x32_bf16 v[64:67], a[208:211], v[200:203], v[32:35]
  v_exp_f32 v56, v56
  v_mfma_f32_16x16x32_bf16 v[64:67], a[212:215], v[216:219], v[64:67]
  ds_read_b64_tr_b16 a[254:255], v87 offset:28672
  v_cvt_pk_bf16_f32 v189, v54, v55
  v_mfma_f32_16x16x32_bf16 v[64:67], a[216:219], v[232:235], v[64:67]
  v_exp_f32 v57, v57
  v_mfma_f32_16x16x32_bf16 v[64:67], a[220:223], v[248:251], v[64:67]
  ds_read_b128 a[192:195], v76 offset:0
  v_cvt_pk_bf16_f32 v166, v56, v57
  v_mfma_f32_16x16x32_bf16 v[68:71], a[220:223], v[252:255], v[36:39]
  v_exp_f32 v58, v58
  v_mfma_f32_16x16x32_bf16 v[68:71], a[216:219], v[236:239], v[68:71]
  ds_read_b128 a[196:199], v77 offset:0
  v_mfma_f32_16x16x32_bf16 v[68:71], a[212:215], v[220:223], v[68:71]
  v_exp_f32 v59, v59
  v_mfma_f32_16x16x32_bf16 v[68:71], a[208:211], v[204:207], v[68:71]
  s_waitcnt lgkmcnt(6)
  v_cvt_pk_bf16_f32 v167, v58, v59
  v_mfma_f32_16x16x32_bf16 a[96:99], a[240:243], v[128:131], a[96:99]
  v_exp_f32 v60, v60
  v_mfma_f32_16x16x32_bf16 a[96:99], a[244:247], v[132:135], a[96:99]
  ds_read_b128 a[200:203], v78 offset:0
  v_mfma_f32_16x16x32_bf16 a[100:103], a[244:247], v[140:143], a[100:103]
  v_exp_f32 v61, v61
  v_mfma_f32_16x16x32_bf16 a[100:103], a[240:243], v[136:139], a[100:103]
  ds_read_b128 a[204:207], v79 offset:0
  v_cvt_pk_bf16_f32 v174, v60, v61
  v_mfma_f32_16x16x32_bf16 a[104:107], a[240:243], v[144:147], a[104:107]
  v_exp_f32 v62, v62
  v_mfma_f32_16x16x32_bf16 a[104:107], a[244:247], v[148:151], a[104:107]
  v_mfma_f32_16x16x32_bf16 a[108:111], a[244:247], v[156:159], a[108:111]
  v_exp_f32 v63, v63
  v_mfma_f32_16x16x32_bf16 a[108:111], a[240:243], v[152:155], a[108:111]
  s_waitcnt lgkmcnt(4)
  buffer_load_dwordx4 v93, s[12:15], s17 offen offset:3072 lds
  v_mfma_f32_16x16x32_bf16 a[124:127], a[248:251], v[152:155], a[124:127]
  v_exp_f32 v64, v64
  v_mfma_f32_16x16x32_bf16 a[124:127], a[252:255], v[156:159], a[124:127]
  ds_read_b64_tr_b16 a[224:225], v80 offset:0
  v_cvt_pk_bf16_f32 v175, v62, v63
  v_mfma_f32_16x16x32_bf16 a[120:123], a[252:255], v[148:151], a[120:123]
  v_exp_f32 v65, v65
  v_mfma_f32_16x16x32_bf16 a[120:123], a[248:251], v[144:147], a[120:123]
  ds_read_b64_tr_b16 a[226:227], v80 offset:4096
  v_cvt_pk_bf16_f32 v182, v64, v65
  v_mfma_f32_16x16x32_bf16 a[116:119], a[248:251], v[136:139], a[116:119]
  v_exp_f32 v66, v66
  v_mfma_f32_16x16x32_bf16 a[116:119], a[252:255], v[140:143], a[116:119]
  ds_read_b64_tr_b16 a[228:229], v80 offset:8192
  v_mfma_f32_16x16x32_bf16 a[112:115], a[252:255], v[132:135], a[112:115]
  v_exp_f32 v67, v67
  v_mfma_f32_16x16x32_bf16 a[112:115], a[248:251], v[128:131], a[112:115]
  ds_read_b64_tr_b16 a[230:231], v80 offset:12288
  v_cvt_pk_bf16_f32 v183, v66, v67
  v_smfmac_f32_16x16x64_bf16 v[16:19], v[4:7], v[144:151], v116
  v_exp_f32 v68, v68
  v_smfmac_f32_16x16x64_bf16 v[20:23], v[4:7], v[152:159], v116
  s_waitcnt lgkmcnt(4)
  v_mfma_f32_16x16x32_bf16 v[40:43], a[192:195], v[192:195], v[24:27]
  v_exp_f32 v69, v69
  v_mfma_f32_16x16x32_bf16 v[40:43], a[196:199], v[208:211], v[40:43]
  ds_read_b64_tr_b16 a[232:233], v81 offset:0
  v_cvt_pk_bf16_f32 v190, v68, v69
  v_mfma_f32_16x16x32_bf16 v[40:43], a[200:203], v[224:227], v[40:43]
  v_exp_f32 v70, v70
  v_mfma_f32_16x16x32_bf16 v[40:43], a[204:207], v[240:243], v[40:43]
  s_add_u32 m0, s18, 32768
  ds_read_b64_tr_b16 a[234:235], v81 offset:4096
  v_mfma_f32_16x16x32_bf16 v[44:47], a[204:207], v[244:247], v[28:31]
  v_exp_f32 v71, v71
  v_mfma_f32_16x16x32_bf16 v[44:47], a[200:203], v[228:231], v[44:47]
  s_add_u32 s16, s16, 16384
  ds_read_b64_tr_b16 a[236:237], v81 offset:8192
  v_cvt_pk_bf16_f32 v191, v70, v71
  v_mfma_f32_16x16x32_bf16 v[44:47], a[196:199], v[212:215], v[44:47]
  v_mfma_f32_16x16x32_bf16 v[44:47], a[192:195], v[196:199], v[44:47]
  buffer_load_dwordx4 v88, s[8:11], s16 offen offset:0 lds
  v_mfma_f32_16x16x32_bf16 v[48:51], a[192:195], v[200:203], v[32:35]
  v_exp_f32 v40, v40
  v_mfma_f32_16x16x32_bf16 v[48:51], a[196:199], v[216:219], v[48:51]
  ds_read_b64_tr_b16 a[238:239], v81 offset:12288
  v_mfma_f32_16x16x32_bf16 v[48:51], a[200:203], v[232:235], v[48:51]
  v_exp_f32 v41, v41
  v_mfma_f32_16x16x32_bf16 v[48:51], a[204:207], v[248:251], v[48:51]
  ds_read_b128 a[208:211], v76 offset:4096
  v_cvt_pk_bf16_f32 v128, v40, v41
  v_mfma_f32_16x16x32_bf16 v[52:55], a[204:207], v[252:255], v[36:39]
  v_exp_f32 v42, v42
  v_mfma_f32_16x16x32_bf16 v[52:55], a[200:203], v[236:239], v[52:55]
  ds_read_b128 a[212:215], v77 offset:4096
  v_mfma_f32_16x16x32_bf16 v[52:55], a[196:199], v[220:223], v[52:55]
  v_exp_f32 v43, v43
  v_mfma_f32_16x16x32_bf16 v[52:55], a[192:195], v[204:207], v[52:55]
  s_waitcnt lgkmcnt(6)
  v_cvt_pk_bf16_f32 v129, v42, v43
  v_mfma_f32_16x16x32_bf16 a[0:3], a[224:227], v[160:163], a[0:3]
  v_exp_f32 v44, v44
  v_mfma_f32_16x16x32_bf16 a[0:3], a[228:231], v[164:167], a[0:3]
  ds_read_b128 a[216:219], v78 offset:4096
  v_mfma_f32_16x16x32_bf16 a[4:7], a[228:231], v[172:175], a[4:7]
  v_exp_f32 v45, v45
  v_mfma_f32_16x16x32_bf16 a[4:7], a[224:227], v[168:171], a[4:7]
  ds_read_b128 a[220:223], v79 offset:4096
  v_cvt_pk_bf16_f32 v136, v44, v45
  v_mfma_f32_16x16x32_bf16 a[8:11], a[224:227], v[176:179], a[8:11]
  v_exp_f32 v46, v46
  v_mfma_f32_16x16x32_bf16 a[8:11], a[228:231], v[180:183], a[8:11]
  v_mfma_f32_16x16x32_bf16 a[12:15], a[228:231], v[188:191], a[12:15]
  v_exp_f32 v47, v47
  v_mfma_f32_16x16x32_bf16 a[12:15], a[224:227], v[184:187], a[12:15]
  s_waitcnt lgkmcnt(4)
  buffer_load_dwordx4 v89, s[8:11], s16 offen offset:1024 lds
  v_mfma_f32_16x16x32_bf16 a[28:31], a[232:235], v[184:187], a[28:31]
  v_exp_f32 v48, v48
  v_mfma_f32_16x16x32_bf16 a[28:31], a[236:239], v[188:191], a[28:31]
  ds_read_b64_tr_b16 a[240:241], v82 offset:0
  v_cvt_pk_bf16_f32 v137, v46, v47
  v_mfma_f32_16x16x32_bf16 a[24:27], a[236:239], v[180:183], a[24:27]
  v_exp_f32 v49, v49
  v_mfma_f32_16x16x32_bf16 a[24:27], a[232:235], v[176:179], a[24:27]
  ds_read_b64_tr_b16 a[242:243], v82 offset:4096
  v_cvt_pk_bf16_f32 v144, v48, v49
  v_mfma_f32_16x16x32_bf16 a[20:23], a[232:235], v[168:171], a[20:23]
  v_exp_f32 v50, v50
  v_mfma_f32_16x16x32_bf16 a[20:23], a[236:239], v[172:175], a[20:23]
  ds_read_b64_tr_b16 a[244:245], v82 offset:8192
  v_mfma_f32_16x16x32_bf16 a[16:19], a[236:239], v[164:167], a[16:19]
  v_exp_f32 v51, v51
  v_mfma_f32_16x16x32_bf16 a[16:19], a[232:235], v[160:163], a[16:19]
  s_waitcnt lgkmcnt(3)
  ds_read_b64_tr_b16 a[246:247], v82 offset:12288
  v_cvt_pk_bf16_f32 v145, v50, v51
  v_mfma_f32_16x16x32_bf16 v[56:59], a[208:211], v[192:195], v[24:27]
  v_exp_f32 v52, v52
  v_mfma_f32_16x16x32_bf16 v[56:59], a[212:215], v[208:211], v[56:59]
  ds_read_b64_tr_b16 a[248:249], v83 offset:0
  v_mfma_f32_16x16x32_bf16 v[56:59], a[216:219], v[224:227], v[56:59]
  v_exp_f32 v53, v53
  v_mfma_f32_16x16x32_bf16 v[56:59], a[220:223], v[240:243], v[56:59]
  ds_read_b64_tr_b16 a[250:251], v83 offset:4096
  v_cvt_pk_bf16_f32 v152, v52, v53
  v_mfma_f32_16x16x32_bf16 v[60:63], a[220:223], v[244:247], v[28:31]
  v_exp_f32 v54, v54
  v_mfma_f32_16x16x32_bf16 v[60:63], a[216:219], v[228:231], v[60:63]
  ds_read_b64_tr_b16 a[252:253], v83 offset:8192
  v_mfma_f32_16x16x32_bf16 v[60:63], a[212:215], v[212:215], v[60:63]
  v_exp_f32 v55, v55
  v_mfma_f32_16x16x32_bf16 v[60:63], a[208:211], v[196:199], v[60:63]
  buffer_load_dwordx4 v90, s[8:11], s16 offen offset:2048 lds
  v_mfma_f32_16x16x32_bf16 v[64:67], a[208:211], v[200:203], v[32:35]
  v_exp_f32 v56, v56
  v_mfma_f32_16x16x32_bf16 v[64:67], a[212:215], v[216:219], v[64:67]
  ds_read_b64_tr_b16 a[254:255], v83 offset:12288
  v_cvt_pk_bf16_f32 v153, v54, v55
  v_mfma_f32_16x16x32_bf16 v[64:67], a[216:219], v[232:235], v[64:67]
  v_exp_f32 v57, v57
  v_mfma_f32_16x16x32_bf16 v[64:67], a[220:223], v[248:251], v[64:67]
  ds_read_b128 a[192:195], v76 offset:8192
  v_cvt_pk_bf16_f32 v130, v56, v57
  v_mfma_f32_16x16x32_bf16 v[68:71], a[220:223], v[252:255], v[36:39]
  v_exp_f32 v58, v58
  v_mfma_f32_16x16x32_bf16 v[68:71], a[216:219], v[236:239], v[68:71]
  ds_read_b128 a[196:199], v77 offset:8192
  v_mfma_f32_16x16x32_bf16 v[68:71], a[212:215], v[220:223], v[68:71]
  v_exp_f32 v59, v59
  v_mfma_f32_16x16x32_bf16 v[68:71], a[208:211], v[204:207], v[68:71]
  s_waitcnt lgkmcnt(6)
  v_cvt_pk_bf16_f32 v131, v58, v59
  v_mfma_f32_16x16x32_bf16 a[32:35], a[240:243], v[160:163], a[32:35]
  v_exp_f32 v60, v60
  v_mfma_f32_16x16x32_bf16 a[32:35], a[244:247], v[164:167], a[32:35]
  ds_read_b128 a[200:203], v78 offset:8192
  v_mfma_f32_16x16x32_bf16 a[36:39], a[244:247], v[172:175], a[36:39]
  v_exp_f32 v61, v61
  v_mfma_f32_16x16x32_bf16 a[36:39], a[240:243], v[168:171], a[36:39]
  ds_read_b128 a[204:207], v79 offset:8192
  v_cvt_pk_bf16_f32 v138, v60, v61
  v_mfma_f32_16x16x32_bf16 a[40:43], a[240:243], v[176:179], a[40:43]
  v_exp_f32 v62, v62
  v_mfma_f32_16x16x32_bf16 a[40:43], a[244:247], v[180:183], a[40:43]
  v_mfma_f32_16x16x32_bf16 a[44:47], a[244:247], v[188:191], a[44:47]
  v_exp_f32 v63, v63
  v_mfma_f32_16x16x32_bf16 a[44:47], a[240:243], v[184:187], a[44:47]
  s_waitcnt lgkmcnt(4)
  buffer_load_dwordx4 v91, s[8:11], s16 offen offset:3072 lds
  v_mfma_f32_16x16x32_bf16 a[60:63], a[248:251], v[184:187], a[60:63]
  v_exp_f32 v64, v64
  v_mfma_f32_16x16x32_bf16 a[60:63], a[252:255], v[188:191], a[60:63]
  ds_read_b64_tr_b16 a[224:225], v84 offset:0
  v_cvt_pk_bf16_f32 v139, v62, v63
  v_mfma_f32_16x16x32_bf16 a[56:59], a[252:255], v[180:183], a[56:59]
  v_exp_f32 v65, v65
  v_mfma_f32_16x16x32_bf16 a[56:59], a[248:251], v[176:179], a[56:59]
  ds_read_b64_tr_b16 a[226:227], v84 offset:4096
  v_cvt_pk_bf16_f32 v146, v64, v65
  v_mfma_f32_16x16x32_bf16 a[52:55], a[248:251], v[168:171], a[52:55]
  v_exp_f32 v66, v66
  v_mfma_f32_16x16x32_bf16 a[52:55], a[252:255], v[172:175], a[52:55]
  ds_read_b64_tr_b16 a[228:229], v84 offset:8192
  v_mfma_f32_16x16x32_bf16 a[48:51], a[252:255], v[164:167], a[48:51]
  v_exp_f32 v67, v67
  v_mfma_f32_16x16x32_bf16 a[48:51], a[248:251], v[160:163], a[48:51]
  ds_read_b64_tr_b16 a[230:231], v84 offset:12288
  v_cvt_pk_bf16_f32 v147, v66, v67
  v_smfmac_f32_16x16x64_bf16 v[8:11], v[4:7], v[160:167], v116
  v_exp_f32 v68, v68
  v_smfmac_f32_16x16x64_bf16 v[12:15], v[4:7], v[168:175], v116
  s_waitcnt lgkmcnt(4)
  v_mfma_f32_16x16x32_bf16 v[40:43], a[192:195], v[192:195], v[24:27]
  v_exp_f32 v69, v69
  v_mfma_f32_16x16x32_bf16 v[40:43], a[196:199], v[208:211], v[40:43]
  ds_read_b64_tr_b16 a[232:233], v85 offset:0
  v_cvt_pk_bf16_f32 v154, v68, v69
  v_mfma_f32_16x16x32_bf16 v[40:43], a[200:203], v[224:227], v[40:43]
  v_exp_f32 v70, v70
  v_mfma_f32_16x16x32_bf16 v[40:43], a[204:207], v[240:243], v[40:43]
  s_add_u32 m0, s18, 98304
  ds_read_b64_tr_b16 a[234:235], v85 offset:4096
  v_mfma_f32_16x16x32_bf16 v[44:47], a[204:207], v[244:247], v[28:31]
  v_exp_f32 v71, v71
  v_mfma_f32_16x16x32_bf16 v[44:47], a[200:203], v[228:231], v[44:47]
  s_add_u32 s17, s17, 16384
  ds_read_b64_tr_b16 a[236:237], v85 offset:8192
  v_cvt_pk_bf16_f32 v155, v70, v71
  v_mfma_f32_16x16x32_bf16 v[44:47], a[196:199], v[212:215], v[44:47]
  v_mfma_f32_16x16x32_bf16 v[44:47], a[192:195], v[196:199], v[44:47]
  buffer_load_dwordx4 v92, s[12:15], s17 offen offset:0 lds
  v_mfma_f32_16x16x32_bf16 v[48:51], a[192:195], v[200:203], v[32:35]
  v_exp_f32 v40, v40
  v_mfma_f32_16x16x32_bf16 v[48:51], a[196:199], v[216:219], v[48:51]
  ds_read_b64_tr_b16 a[238:239], v85 offset:12288
  v_mfma_f32_16x16x32_bf16 v[48:51], a[200:203], v[232:235], v[48:51]
  v_exp_f32 v41, v41
  v_mfma_f32_16x16x32_bf16 v[48:51], a[204:207], v[248:251], v[48:51]
  ds_read_b128 a[208:211], v76 offset:12288
  v_cvt_pk_bf16_f32 v132, v40, v41
  v_mfma_f32_16x16x32_bf16 v[52:55], a[204:207], v[252:255], v[36:39]
  v_exp_f32 v42, v42
  v_mfma_f32_16x16x32_bf16 v[52:55], a[200:203], v[236:239], v[52:55]
  ds_read_b128 a[212:215], v77 offset:12288
  v_mfma_f32_16x16x32_bf16 v[52:55], a[196:199], v[220:223], v[52:55]
  v_exp_f32 v43, v43
  v_mfma_f32_16x16x32_bf16 v[52:55], a[192:195], v[204:207], v[52:55]
  s_waitcnt lgkmcnt(6)
  v_cvt_pk_bf16_f32 v133, v42, v43
  v_mfma_f32_16x16x32_bf16 a[64:67], a[224:227], v[160:163], a[64:67]
  v_exp_f32 v44, v44
  v_mfma_f32_16x16x32_bf16 a[64:67], a[228:231], v[164:167], a[64:67]
  ds_read_b128 a[216:219], v78 offset:12288
  v_mfma_f32_16x16x32_bf16 a[68:71], a[228:231], v[172:175], a[68:71]
  v_exp_f32 v45, v45
  v_mfma_f32_16x16x32_bf16 a[68:71], a[224:227], v[168:171], a[68:71]
  ds_read_b128 a[220:223], v79 offset:12288
  v_cvt_pk_bf16_f32 v140, v44, v45
  v_mfma_f32_16x16x32_bf16 a[72:75], a[224:227], v[176:179], a[72:75]
  v_exp_f32 v46, v46
  v_mfma_f32_16x16x32_bf16 a[72:75], a[228:231], v[180:183], a[72:75]
  v_mfma_f32_16x16x32_bf16 a[76:79], a[228:231], v[188:191], a[76:79]
  v_exp_f32 v47, v47
  v_mfma_f32_16x16x32_bf16 a[76:79], a[224:227], v[184:187], a[76:79]
  s_waitcnt lgkmcnt(4)
  buffer_load_dwordx4 v93, s[12:15], s17 offen offset:1024 lds
  v_mfma_f32_16x16x32_bf16 a[92:95], a[232:235], v[184:187], a[92:95]
  v_exp_f32 v48, v48
  v_mfma_f32_16x16x32_bf16 a[92:95], a[236:239], v[188:191], a[92:95]
  ds_read_b64_tr_b16 a[240:241], v86 offset:0
  v_cvt_pk_bf16_f32 v141, v46, v47
  v_mfma_f32_16x16x32_bf16 a[88:91], a[236:239], v[180:183], a[88:91]
  v_exp_f32 v49, v49
  v_mfma_f32_16x16x32_bf16 a[88:91], a[232:235], v[176:179], a[88:91]
  ds_read_b64_tr_b16 a[242:243], v86 offset:4096
  v_cvt_pk_bf16_f32 v148, v48, v49
  v_mfma_f32_16x16x32_bf16 a[84:87], a[232:235], v[168:171], a[84:87]
  v_exp_f32 v50, v50
  v_mfma_f32_16x16x32_bf16 a[84:87], a[236:239], v[172:175], a[84:87]
  ds_read_b64_tr_b16 a[244:245], v86 offset:8192
  v_mfma_f32_16x16x32_bf16 a[80:83], a[236:239], v[164:167], a[80:83]
  v_exp_f32 v51, v51
  v_mfma_f32_16x16x32_bf16 a[80:83], a[232:235], v[160:163], a[80:83]
  s_waitcnt lgkmcnt(3)
  ds_read_b64_tr_b16 a[246:247], v86 offset:12288
  v_cvt_pk_bf16_f32 v149, v50, v51
  v_mfma_f32_16x16x32_bf16 v[56:59], a[208:211], v[192:195], v[24:27]
  v_exp_f32 v52, v52
  v_mfma_f32_16x16x32_bf16 v[56:59], a[212:215], v[208:211], v[56:59]
  ds_read_b64_tr_b16 a[248:249], v87 offset:0
  v_mfma_f32_16x16x32_bf16 v[56:59], a[216:219], v[224:227], v[56:59]
  v_exp_f32 v53, v53
  v_mfma_f32_16x16x32_bf16 v[56:59], a[220:223], v[240:243], v[56:59]
  ds_read_b64_tr_b16 a[250:251], v87 offset:4096
  v_cvt_pk_bf16_f32 v156, v52, v53
  v_mfma_f32_16x16x32_bf16 v[60:63], a[220:223], v[244:247], v[28:31]
  v_exp_f32 v54, v54
  v_mfma_f32_16x16x32_bf16 v[60:63], a[216:219], v[228:231], v[60:63]
  ds_read_b64_tr_b16 a[252:253], v87 offset:8192
  v_mfma_f32_16x16x32_bf16 v[60:63], a[212:215], v[212:215], v[60:63]
  s_waitcnt vmcnt(6)
  s_barrier
  v_exp_f32 v55, v55
  v_mfma_f32_16x16x32_bf16 v[60:63], a[208:211], v[196:199], v[60:63]
  buffer_load_dwordx4 v92, s[12:15], s17 offen offset:2048 lds
  v_mfma_f32_16x16x32_bf16 v[64:67], a[208:211], v[200:203], v[32:35]
  v_exp_f32 v56, v56
  v_mfma_f32_16x16x32_bf16 v[64:67], a[212:215], v[216:219], v[64:67]
  ds_read_b64_tr_b16 a[254:255], v87 offset:12288
  v_cvt_pk_bf16_f32 v157, v54, v55
  v_mfma_f32_16x16x32_bf16 v[64:67], a[216:219], v[232:235], v[64:67]
  v_exp_f32 v57, v57
  v_mfma_f32_16x16x32_bf16 v[64:67], a[220:223], v[248:251], v[64:67]
  ds_read_b128 a[192:195], v76 offset:16384
  v_cvt_pk_bf16_f32 v134, v56, v57
  v_mfma_f32_16x16x32_bf16 v[68:71], a[220:223], v[252:255], v[36:39]
  v_exp_f32 v58, v58
  v_mfma_f32_16x16x32_bf16 v[68:71], a[216:219], v[236:239], v[68:71]
  ds_read_b128 a[196:199], v77 offset:16384
  v_mfma_f32_16x16x32_bf16 v[68:71], a[212:215], v[220:223], v[68:71]
  v_exp_f32 v59, v59
  v_mfma_f32_16x16x32_bf16 v[68:71], a[208:211], v[204:207], v[68:71]
  s_waitcnt lgkmcnt(6)
  v_cvt_pk_bf16_f32 v135, v58, v59
  v_mfma_f32_16x16x32_bf16 a[96:99], a[240:243], v[160:163], a[96:99]
  v_exp_f32 v60, v60
  v_mfma_f32_16x16x32_bf16 a[96:99], a[244:247], v[164:167], a[96:99]
  ds_read_b128 a[200:203], v78 offset:16384
  v_mfma_f32_16x16x32_bf16 a[100:103], a[244:247], v[172:175], a[100:103]
  v_exp_f32 v61, v61
  v_mfma_f32_16x16x32_bf16 a[100:103], a[240:243], v[168:171], a[100:103]
  ds_read_b128 a[204:207], v79 offset:16384
  v_cvt_pk_bf16_f32 v142, v60, v61
  v_mfma_f32_16x16x32_bf16 a[104:107], a[240:243], v[176:179], a[104:107]
  v_exp_f32 v62, v62
  v_mfma_f32_16x16x32_bf16 a[104:107], a[244:247], v[180:183], a[104:107]
  v_mfma_f32_16x16x32_bf16 a[108:111], a[244:247], v[188:191], a[108:111]
  v_exp_f32 v63, v63
  v_mfma_f32_16x16x32_bf16 a[108:111], a[240:243], v[184:187], a[108:111]
  s_waitcnt lgkmcnt(4)
  buffer_load_dwordx4 v93, s[12:15], s17 offen offset:3072 lds
  v_mfma_f32_16x16x32_bf16 a[124:127], a[248:251], v[184:187], a[124:127]
  v_exp_f32 v64, v64
  v_mfma_f32_16x16x32_bf16 a[124:127], a[252:255], v[188:191], a[124:127]
  ds_read_b64_tr_b16 a[224:225], v80 offset:49152
  v_cvt_pk_bf16_f32 v143, v62, v63
  v_mfma_f32_16x16x32_bf16 a[120:123], a[252:255], v[180:183], a[120:123]
  v_exp_f32 v65, v65
  v_mfma_f32_16x16x32_bf16 a[120:123], a[248:251], v[176:179], a[120:123]
  ds_read_b64_tr_b16 a[226:227], v80 offset:53248
  v_cvt_pk_bf16_f32 v150, v64, v65
  v_mfma_f32_16x16x32_bf16 a[116:119], a[248:251], v[168:171], a[116:119]
  v_exp_f32 v66, v66
  v_mfma_f32_16x16x32_bf16 a[116:119], a[252:255], v[172:175], a[116:119]
  ds_read_b64_tr_b16 a[228:229], v80 offset:57344
  v_mfma_f32_16x16x32_bf16 a[112:115], a[252:255], v[164:167], a[112:115]
  v_exp_f32 v67, v67
  v_mfma_f32_16x16x32_bf16 a[112:115], a[248:251], v[160:163], a[112:115]
  ds_read_b64_tr_b16 a[230:231], v80 offset:61440
  v_cvt_pk_bf16_f32 v151, v66, v67
  v_smfmac_f32_16x16x64_bf16 v[16:19], v[4:7], v[176:183], v116
  v_exp_f32 v68, v68
  v_smfmac_f32_16x16x64_bf16 v[20:23], v[4:7], v[184:191], v116
  s_waitcnt lgkmcnt(4)
  v_mfma_f32_16x16x32_bf16 v[40:43], a[192:195], v[192:195], v[24:27]
  v_exp_f32 v69, v69
  v_mfma_f32_16x16x32_bf16 v[40:43], a[196:199], v[208:211], v[40:43]
  ds_read_b64_tr_b16 a[232:233], v81 offset:49152
  v_cvt_pk_bf16_f32 v158, v68, v69
  v_mfma_f32_16x16x32_bf16 v[40:43], a[200:203], v[224:227], v[40:43]
  v_exp_f32 v70, v70
  v_mfma_f32_16x16x32_bf16 v[40:43], a[204:207], v[240:243], v[40:43]
  s_add_u32 m0, s18, 49152
L_pad_fm3_5:
  s_cbranch_execz L_back0
  ds_read_b64_tr_b16 a[234:235], v81 offset:53248
  v_mfma_f32_16x16x32_bf16 v[44:47], a[204:207], v[244:247], v[28:31]
  v_exp_f32 v71, v71
  v_mfma_f32_16x16x32_bf16 v[44:47], a[200:203], v[228:231], v[44:47]
  s_add_u32 s16, s16, 16384
  ds_read_b64_tr_b16 a[236:237], v81 offset:57344
  v_cvt_pk_bf16_f32 v159, v70, v71
  v_mfma_f32_16x16x32_bf16 v[44:47], a[196:199], v[212:215], v[44:47]
  v_mfma_f32_16x16x32_bf16 v[44:47], a[192:195], v[196:199], v[44:47]
  buffer_load_dwordx4 v88, s[8:11], s16 offen offset:0 lds
  v_mfma_f32_16x16x32_bf16 v[48:51], a[192:195], v[200:203], v[32:35]
  v_exp_f32 v40, v40
  v_mfma_f32_16x16x32_bf16 v[48:51], a[196:199], v[216:219], v[48:51]
  ds_read_b64_tr_b16 a[238:239], v81 offset:61440
  v_mfma_f32_16x16x32_bf16 v[48:51], a[200:203], v[232:235], v[48:51]
  v_exp_f32 v41, v41
  v_mfma_f32_16x16x32_bf16 v[48:51], a[204:207], v[248:251], v[48:51]
  ds_read_b128 a[208:211], v76 offset:20480
  v_cvt_pk_bf16_f32 v160, v40, v41
  v_mfma_f32_16x16x32_bf16 v[52:55], a[204:207], v[252:255], v[36:39]
  v_exp_f32 v42, v42
  v_mfma_f32_16x16x32_bf16 v[52:55], a[200:203], v[236:239], v[52:55]
  ds_read_b128 a[212:215], v77 offset:20480
  v_mfma_f32_16x16x32_bf16 v[52:55], a[196:199], v[220:223], v[52:55]
  v_exp_f32 v43, v43
  v_mfma_f32_16x16x32_bf16 v[52:55], a[192:195], v[204:207], v[52:55]
  s_waitcnt lgkmcnt(6)
  v_cvt_pk_bf16_f32 v161, v42, v43
  v_mfma_f32_16x16x32_bf16 a[0:3], a[224:227], v[128:131], a[0:3]
  v_exp_f32 v44, v44
  v_mfma_f32_16x16x32_bf16 a[0:3], a[228:231], v[132:135], a[0:3]
  ds_read_b128 a[216:219], v78 offset:20480
  v_mfma_f32_16x16x32_bf16 a[4:7], a[228:231], v[140:143], a[4:7]
  v_exp_f32 v45, v45
  v_mfma_f32_16x16x32_bf16 a[4:7], a[224:227], v[136:139], a[4:7]
  ds_read_b128 a[220:223], v79 offset:20480
  v_cvt_pk_bf16_f32 v168, v44, v45
  v_mfma_f32_16x16x32_bf16 a[8:11], a[224:227], v[144:147], a[8:11]
  v_exp_f32 v46, v46
  v_mfma_f32_16x16x32_bf16 a[8:11], a[228:231], v[148:151], a[8:11]
  v_mfma_f32_16x16x32_bf16 a[12:15], a[228:231], v[156:159], a[12:15]
  v_exp_f32 v47, v47
  v_mfma_f32_16x16x32_bf16 a[12:15], a[224:227], v[152:155], a[12:15]
  s_waitcnt lgkmcnt(4)
  buffer_load_dwordx4 v89, s[8:11], s16 offen offset:1024 lds
  v_mfma_f32_16x16x32_bf16 a[28:31], a[232:235], v[152:155], a[28:31]
  v_exp_f32 v48, v48
  v_mfma_f32_16x16x32_bf16 a[28:31], a[236:239], v[156:159], a[28:31]
  ds_read_b64_tr_b16 a[240:241], v82 offset:49152
  v_cvt_pk_bf16_f32 v169, v46, v47
  v_mfma_f32_16x16x32_bf16 a[24:27], a[236:239], v[148:151], a[24:27]
  v_exp_f32 v49, v49
  v_mfma_f32_16x16x32_bf16 a[24:27], a[232:235], v[144:147], a[24:27]
  ds_read_b64_tr_b16 a[242:243], v82 offset:53248
  v_cvt_pk_bf16_f32 v176, v48, v49
  v_mfma_f32_16x16x32_bf16 a[20:23], a[232:235], v[136:139], a[20:23]
  v_exp_f32 v50, v50
  v_mfma_f32_16x16x32_bf16 a[20:23], a[236:239], v[140:143], a[20:23]
  ds_read_b64_tr_b16 a[244:245], v82 offset:57344
  v_mfma_f32_16x16x32_bf16 a[16:19], a[236:239], v[132:135], a[16:19]
  v_exp_f32 v51, v51
  v_mfma_f32_16x16x32_bf16 a[16:19], a[232:235], v[128:131], a[16:19]
  s_waitcnt lgkmcnt(3)
  ds_read_b64_tr_b16 a[246:247], v82 offset:61440
  v_cvt_pk_bf16_f32 v177, v50, v51
  v_mfma_f32_16x16x32_bf16 v[56:59], a[208:211], v[192:195], v[24:27]
  v_exp_f32 v52, v52
  v_mfma_f32_16x16x32_bf16 v[56:59], a[212:215], v[208:211], v[56:59]
  ds_read_b64_tr_b16 a[248:249], v83 offset:49152
  v_mfma_f32_16x16x32_bf16 v[56:59], a[216:219], v[224:227], v[56:59]
  v_exp_f32 v53, v53
  v_mfma_f32_16x16x32_bf16 v[56:59], a[220:223], v[240:243], v[56:59]
  ds_read_b64_tr_b16 a[250:251], v83 offset:53248
  v_cvt_pk_bf16_f32 v184, v52, v53
  v_mfma_f32_16x16x32_bf16 v[60:63], a[220:223], v[244:247], v[28:31]
  v_exp_f32 v54, v54
  v_mfma_f32_16x16x32_bf16 v[60:63], a[216:219], v[228:231], v[60:63]
  ds_read_b64_tr_b16 a[252:253], v83 offset:57344
  v_mfma_f32_16x16x32_bf16 v[60:63], a[212:215], v[212:215], v[60:63]
  v_exp_f32 v55, v55
  v_mfma_f32_16x16x32_bf16 v[60:63], a[208:211], v[196:199], v[60:63]
  buffer_load_dwordx4 v90, s[8:11], s16 offen offset:2048 lds
  v_mfma_f32_16x16x32_bf16 v[64:67], a[208:211], v[200:203], v[32:35]
  v_exp_f32 v56, v56
  v_mfma_f32_16x16x32_bf16 v[64:67], a[212:215], v[216:219], v[64:67]
  ds_read_b64_tr_b16 a[254:255], v83 offset:61440
  v_cvt_pk_bf16_f32 v185, v54, v55
  v_mfma_f32_16x16x32_bf16 v[64:67], a[216:219], v[232:235], v[64:67]
  v_exp_f32 v57, v57
  v_mfma_f32_16x16x32_bf16 v[64:67], a[220:223], v[248:251], v[64:67]
  ds_read_b128 a[192:195], v76 offset:24576
  v_cvt_pk_bf16_f32 v162, v56, v57
  v_mfma_f32_16x16x32_bf16 v[68:71], a[220:223], v[252:255], v[36:39]
  v_exp_f32 v58, v58
  v_mfma_f32_16x16x32_bf16 v[68:71], a[216:219], v[236:239], v[68:71]
  ds_read_b128 a[196:199], v77 offset:24576
  v_mfma_f32_16x16x32_bf16 v[68:71], a[212:215], v[220:223], v[68:71]
  v_exp_f32 v59, v59
  v_mfma_f32_16x16x32_bf16 v[68:71], a[208:211], v[204:207], v[68:71]
  s_waitcnt lgkmcnt(6)
  v_cvt_pk_bf16_f32 v163, v58, v59
  v_mfma_f32_16x16x32_bf16 a[32:35], a[240:243], v[128:131], a[32:35]
  v_exp_f32 v60, v60
  v_mfma_f32_16x16x32_bf16 a[32:35], a[244:247], v[132:135], a[32:35]
  ds_read_b128 a[200:203], v78 offset:24576
  v_mfma_f32_16x16x32_bf16 a[36:39], a[244:247], v[140:143], a[36:39]
  v_exp_f32 v61, v61
  v_mfma_f32_16x16x32_bf16 a[36:39], a[240:243], v[136:139], a[36:39]
  ds_read_b128 a[204:207], v79 offset:24576
  v_cvt_pk_bf16_f32 v170, v60, v61
  v_mfma_f32_16x16x32_bf16 a[40:43], a[240:243], v[144:147], a[40:43]
  v_exp_f32 v62, v62
  v_mfma_f32_16x16x32_bf16 a[40:43], a[244:247], v[148:151], a[40:43]
  v_mfma_f32_16x16x32_bf16 a[44:47], a[244:247], v[156:159], a[44:47]
  v_exp_f32 v63, v63
  v_mfma_f32_16x16x32_bf16 a[44:47], a[240:243], v[152:155], a[44:47]
  s_waitcnt lgkmcnt(4)
  buffer_load_dwordx4 v91, s[8:11], s16 offen offset:3072 lds
  v_mfma_f32_16x16x32_bf16 a[60:63], a[248:251], v[152:155], a[60:63]
  v_exp_f32 v64, v64
  v_mfma_f32_16x16x32_bf16 a[60:63], a[252:255], v[156:159], a[60:63]
  ds_read_b64_tr_b16 a[224:225], v84 offset:49152
  v_cvt_pk_bf16_f32 v171, v62, v63
  v_mfma_f32_16x16x32_bf16 a[56:59], a[252:255], v[148:151], a[56:59]
  v_exp_f32 v65, v65
  v_mfma_f32_16x16x32_bf16 a[56:59], a[248:251], v[144:147], a[56:59]
  ds_read_b64_tr_b16 a[226:227], v84 offset:53248
  v_cvt_pk_bf16_f32 v178, v64, v65
  v_mfma_f32_16x16x32_bf16 a[52:55], a[248:251], v[136:139], a[52:55]
  v_exp_f32 v66, v66
  v_mfma_f32_16x16x32_bf16 a[52:55], a[252:255], v[140:143], a[52:55]
  ds_read_b64_tr_b16 a[228:229], v84 offset:57344
  v_mfma_f32_16x16x32_bf16 a[48:51], a[252:255], v[132:135], a[48:51]
  v_exp_f32 v67, v67
  v_mfma_f32_16x16x32_bf16 a[48:51], a[248:251], v[128:131], a[48:51]
  ds_read_b64_tr_b16 a[230:231], v84 offset:61440
  v_cvt_pk_bf16_f32 v179, v66, v67
  v_smfmac_f32_16x16x64_bf16 v[8:11], v[4:7], v[128:135], v116
  v_exp_f32 v68, v68
  v_smfmac_f32_16x16x64_bf16 v[12:15], v[4:7], v[136:143], v116
  s_waitcnt lgkmcnt(4)
  v_mfma_f32_16x16x32_bf16 v[40:43], a[192:195], v[192:195], v[24:27]
  v_exp_f32 v69, v69
  v_mfma_f32_16x16x32_bf16 v[40:43], a[196:199], v[208:211], v[40:43]
  ds_read_b64_tr_b16 a[232:233], v85 offset:49152
  v_cvt_pk_bf16_f32 v186, v68, v69
  v_mfma_f32_16x16x32_bf16 v[40:43], a[200:203], v[224:227], v[40:43]
  v_exp_f32 v70, v70
  v_mfma_f32_16x16x32_bf16 v[40:43], a[204:207], v[240:243], v[40:43]
  s_add_u32 m0, s18, 81920
  ds_read_b64_tr_b16 a[234:235], v85 offset:53248
  v_mfma_f32_16x16x32_bf16 v[44:47], a[204:207], v[244:247], v[28:31]
  v_exp_f32 v71, v71
  v_mfma_f32_16x16x32_bf16 v[44:47], a[200:203], v[228:231], v[44:47]
  s_add_u32 s17, s17, 16384
  ds_read_b64_tr_b16 a[236:237], v85 offset:57344
  v_cvt_pk_bf16_f32 v187, v70, v71
  v_mfma_f32_16x16x32_bf16 v[44:47], a[196:199], v[212:215], v[44:47]
  v_mfma_f32_16x16x32_bf16 v[44:47], a[192:195], v[196:199], v[44:47]
  buffer_load_dwordx4 v92, s[12:15], s17 offen offset:0 lds
  v_mfma_f32_16x16x32_bf16 v[48:51], a[192:195], v[200:203], v[32:35]
  v_exp_f32 v40, v40
  v_mfma_f32_16x16x32_bf16 v[48:51], a[196:199], v[216:219], v[48:51]
  ds_read_b64_tr_b16 a[238:239], v85 offset:61440
  v_mfma_f32_16x16x32_bf16 v[48:51], a[200:203], v[232:235], v[48:51]
  v_exp_f32 v41, v41
  v_mfma_f32_16x16x32_bf16 v[48:51], a[204:207], v[248:251], v[48:51]
  ds_read_b128 a[208:211], v76 offset:28672
  v_cvt_pk_bf16_f32 v164, v40, v41
  v_mfma_f32_16x16x32_bf16 v[52:55], a[204:207], v[252:255], v[36:39]
  v_exp_f32 v42, v42
  v_mfma_f32_16x16x32_bf16 v[52:55], a[200:203], v[236:239], v[52:55]
  ds_read_b128 a[212:215], v77 offset:28672
  v_mfma_f32_16x16x32_bf16 v[52:55], a[196:199], v[220:223], v[52:55]
  v_exp_f32 v43, v43
  v_mfma_f32_16x16x32_bf16 v[52:55], a[192:195], v[204:207], v[52:55]
  s_waitcnt lgkmcnt(6)
  v_cvt_pk_bf16_f32 v165, v42, v43
  v_mfma_f32_16x16x32_bf16 a[64:67], a[224:227], v[128:131], a[64:67]
  v_exp_f32 v44, v44
  v_mfma_f32_16x16x32_bf16 a[64:67], a[228:231], v[132:135], a[64:67]
  ds_read_b128 a[216:219], v78 offset:28672
  v_mfma_f32_16x16x32_bf16 a[68:71], a[228:231], v[140:143], a[68:71]
  v_exp_f32 v45, v45
  v_mfma_f32_16x16x32_bf16 a[68:71], a[224:227], v[136:139], a[68:71]
  ds_read_b128 a[220:223], v79 offset:28672
  v_cvt_pk_bf16_f32 v172, v44, v45
  v_mfma_f32_16x16x32_bf16 a[72:75], a[224:227], v[144:147], a[72:75]
  v_exp_f32 v46, v46
  v_mfma_f32_16x16x32_bf16 a[72:75], a[228:231], v[148:151], a[72:75]
  v_mfma_f32_16x16x32_bf16 a[76:79], a[228:231], v[156:159], a[76:79]
  v_exp_f32 v47, v47
  v_mfma_f32_16x16x32_bf16 a[76:79], a[224:227], v[152:155], a[76:79]
  s_waitcnt lgkmcnt(4)
  buffer_load_dwordx4 v93, s[12:15], s17 offen offset:1024 lds
  v_mfma_f32_16x16x32_bf16 a[92:95], a[232:235], v[152:155], a[92:95]
  v_exp_f32 v48, v48
  v_mfma_f32_16x16x32_bf16 a[92:95], a[236:239], v[156:159], a[92:95]
  ds_read_b64_tr_b16 a[240:241], v86 offset:49152
  v_cvt_pk_bf16_f32 v173, v46, v47
  v_mfma_f32_16x16x32_bf16 a[88:91], a[236:239], v[148:151], a[88:91]
  v_exp_f32 v49, v49
  v_mfma_f32_16x16x32_bf16 a[88:91], a[232:235], v[144:147], a[88:91]
  ds_read_b64_tr_b16 a[242:243], v86 offset:53248
  v_cvt_pk_bf16_f32 v180, v48, v49
  v_mfma_f32_16x16x32_bf16 a[84:87], a[232:235], v[136:139], a[84:87]
  v_exp_f32 v50, v50
  v_mfma_f32_16x16x32_bf16 a[84:87], a[236:239], v[140:143], a[84:87]
  ds_read_b64_tr_b16 a[244:245], v86 offset:57344
  v_mfma_f32_16x16x32_bf16 a[80:83], a[236:239], v[132:135], a[80:83]
  v_exp_f32 v51, v51
  v_mfma_f32_16x16x32_bf16 a[80:83], a[232:235], v[128:131], a[80:83]
  s_waitcnt lgkmcnt(3)
  ds_read_b64_tr_b16 a[246:247], v86 offset:61440
  v_cvt_pk_bf16_f32 v181, v50, v51
  v_mfma_f32_16x16x32_bf16 v[56:59], a[208:211], v[192:195], v[24:27]
  v_exp_f32 v52, v52
  v_mfma_f32_16x16x32_bf16 v[56:59], a[212:215], v[208:211], v[56:59]
  ds_read_b64_tr_b16 a[248:249], v87 offset:49152
  v_mfma_f32_16x16x32_bf16 v[56:59], a[216:219], v[224:227], v[56:59]
  v_exp_f32 v53, v53
  v_mfma_f32_16x16x32_bf16 v[56:59], a[220:223], v[240:243], v[56:59]
  ds_read_b64_tr_b16 a[250:251], v87 offset:53248
  v_cvt_pk_bf16_f32 v188, v52, v53
  v_mfma_f32_16x16x32_bf16 v[60:63], a[220:223], v[244:247], v[28:31]
  v_exp_f32 v54, v54
  v_mfma_f32_16x16x32_bf16 v[60:63], a[216:219], v[228:231], v[60:63]
  ds_read_b64_tr_b16 a[252:253], v87 offset:57344
  v_mfma_f32_16x16x32_bf16 v[60:63], a[212:215], v[212:215], v[60:63]
  s_waitcnt vmcnt(6)
  s_barrier
  v_exp_f32 v55, v55
  v_mfma_f32_16x16x32_bf16 v[60:63], a[208:211], v[196:199], v[60:63]
  buffer_load_dwordx4 v92, s[12:15], s17 offen offset:2048 lds
  v_mfma_f32_16x16x32_bf16 v[64:67], a[208:211], v[200:203], v[32:35]
  v_exp_f32 v56, v56
  v_mfma_f32_16x16x32_bf16 v[64:67], a[212:215], v[216:219], v[64:67]
  ds_read_b64_tr_b16 a[254:255], v87 offset:61440
  v_cvt_pk_bf16_f32 v189, v54, v55
  v_mfma_f32_16x16x32_bf16 v[64:67], a[216:219], v[232:235], v[64:67]
  v_exp_f32 v57, v57
  v_mfma_f32_16x16x32_bf16 v[64:67], a[220:223], v[248:251], v[64:67]
  ds_read_b128 a[192:195], v76 offset:32768
  v_cvt_pk_bf16_f32 v166, v56, v57
  v_mfma_f32_16x16x32_bf16 v[68:71], a[220:223], v[252:255], v[36:39]
  v_exp_f32 v58, v58
  v_mfma_f32_16x16x32_bf16 v[68:71], a[216:219], v[236:239], v[68:71]
  ds_read_b128 a[196:199], v77 offset:32768
  v_mfma_f32_16x16x32_bf16 v[68:71], a[212:215], v[220:223], v[68:71]
  v_exp_f32 v59, v59
  v_mfma_f32_16x16x32_bf16 v[68:71], a[208:211], v[204:207], v[68:71]
  s_waitcnt lgkmcnt(6)
  v_cvt_pk_bf16_f32 v167, v58, v59
  v_mfma_f32_16x16x32_bf16 a[96:99], a[240:243], v[128:131], a[96:99]
  v_exp_f32 v60, v60
  v_mfma_f32_16x16x32_bf16 a[96:99], a[244:247], v[132:135], a[96:99]
  ds_read_b128 a[200:203], v78 offset:32768
  v_mfma_f32_16x16x32_bf16 a[100:103], a[244:247], v[140:143], a[100:103]
  v_exp_f32 v61, v61
  v_mfma_f32_16x16x32_bf16 a[100:103], a[240:243], v[136:139], a[100:103]
  ds_read_b128 a[204:207], v79 offset:32768
  v_cvt_pk_bf16_f32 v174, v60, v61
  v_mfma_f32_16x16x32_bf16 a[104:107], a[240:243], v[144:147], a[104:107]
  v_exp_f32 v62, v62
  v_mfma_f32_16x16x32_bf16 a[104:107], a[244:247], v[148:151], a[104:107]
  v_mfma_f32_16x16x32_bf16 a[108:111], a[244:247], v[156:159], a[108:111]
  v_exp_f32 v63, v63
  v_mfma_f32_16x16x32_bf16 a[108:111], a[240:243], v[152:155], a[108:111]
  s_waitcnt lgkmcnt(4)
  buffer_load_dwordx4 v93, s[12:15], s17 offen offset:3072 lds
  v_mfma_f32_16x16x32_bf16 a[124:127], a[248:251], v[152:155], a[124:127]
  v_exp_f32 v64, v64
  v_mfma_f32_16x16x32_bf16 a[124:127], a[252:255], v[156:159], a[124:127]
  ds_read_b64_tr_b16 a[224:225], v80 offset:32768
  v_cvt_pk_bf16_f32 v175, v62, v63
  v_mfma_f32_16x16x32_bf16 a[120:123], a[252:255], v[148:151], a[120:123]
  v_exp_f32 v65, v65
  v_mfma_f32_16x16x32_bf16 a[120:123], a[248:251], v[144:147], a[120:123]
  ds_read_b64_tr_b16 a[226:227], v80 offset:36864
  v_cvt_pk_bf16_f32 v182, v64, v65
  v_mfma_f32_16x16x32_bf16 a[116:119], a[248:251], v[136:139], a[116:119]
  v_exp_f32 v66, v66
  v_mfma_f32_16x16x32_bf16 a[116:119], a[252:255], v[140:143], a[116:119]
  ds_read_b64_tr_b16 a[228:229], v80 offset:40960
  v_mfma_f32_16x16x32_bf16 a[112:115], a[252:255], v[132:135], a[112:115]
  s_sub_u32 s19, s19, 1
  v_exp_f32 v67, v67
  v_mfma_f32_16x16x32_bf16 a[112:115], a[248:251], v[128:131], a[112:115]
  s_cmp_lg_u32 s19, 0
  ds_read_b64_tr_b16 a[230:231], v80 offset:45056
  v_cvt_pk_bf16_f32 v183, v66, v67
  v_smfmac_f32_16x16x64_bf16 v[16:19], v[4:7], v[144:151], v116
  v_exp_f32 v68, v68
  v_smfmac_f32_16x16x64_bf16 v[20:23], v[4:7], v[152:159], v116
  s_waitcnt lgkmcnt(4)
  s_cbranch_scc1 L_loop
  s_bitcmp1_b32 s44, 3
  s_cbranch_scc0 L_post0
L_post1:
  v_mfma_f32_16x16x32_bf16 v[40:43], a[192:195], v[192:195], v[24:27]
  v_cmp_gt_u32 vcc, 0x100, v117
  s_nop 1
  s_cbranch_vccnz L_cw_1
L_cw_ok_1:
  v_exp_f32 v69, v69
  v_mfma_f32_16x16x32_bf16 v[40:43], a[196:199], v[208:211], v[40:43]
  ds_read_b64_tr_b16 a[232:233], v81 offset:32768
  v_cvt_pk_bf16_f32 v190, v68, v69
  v_mfma_f32_16x16x32_bf16 v[40:43], a[200:203], v[224:227], v[40:43]
  v_exp_f32 v70, v70
  v_mfma_f32_16x16x32_bf16 v[40:43], a[204:207], v[240:243], v[40:43]
  ds_read_b64_tr_b16 a[234:235], v81 offset:36864
  v_mfma_f32_16x16x32_bf16 v[44:47], a[204:207], v[244:247], v[28:31]
  v_exp_f32 v71, v71
  v_mfma_f32_16x16x32_bf16 v[44:47], a[200:203], v[228:231], v[44:47]
  ds_read_b64_tr_b16 a[236:237], v81 offset:40960
  v_cvt_pk_bf16_f32 v191, v70, v71
  v_mfma_f32_16x16x32_bf16 v[44:47], a[196:199], v[212:215], v[44:47]
  s_add_u32 m0, s42, 143360
  v_mfma_f32_16x16x32_bf16 v[44:47], a[192:195], v[196:199], v[44:47]
  buffer_load_dwordx4 v3, s[52:55], s40 offen offset:0 sc1 lds
  v_mfma_f32_16x16x32_bf16 v[48:51], a[192:195], v[200:203], v[32:35]
  v_exp_f32 v40, v40
  v_mfma_f32_16x16x32_bf16 v[48:51], a[196:199], v[216:219], v[48:51]
  ds_read_b64_tr_b16 a[238:239], v81 offset:45056
  v_mfma_f32_16x16x32_bf16 v[48:51], a[200:203], v[232:235], v[48:51]
  v_exp_f32 v41, v41
  v_mfma_f32_16x16x32_bf16 v[48:51], a[204:207], v[248:251], v[48:51]
  ds_read_b128 a[208:211], v76 offset:36864
  v_cvt_pk_bf16_f32 v128, v40, v41
  v_mfma_f32_16x16x32_bf16 v[52:55], a[204:207], v[252:255], v[36:39]
  v_exp_f32 v42, v42
  v_mfma_f32_16x16x32_bf16 v[52:55], a[200:203], v[236:239], v[52:55]
  ds_read_b128 a[212:215], v77 offset:36864
  v_mfma_f32_16x16x32_bf16 v[52:55], a[196:199], v[220:223], v[52:55]
  v_exp_f32 v43, v43
  v_mfma_f32_16x16x32_bf16 v[52:55], a[192:195], v[204:207], v[52:55]
  s_waitcnt lgkmcnt(6)
  buffer_load_dwordx4 v3, s[52:55], s40 offen offset:1024 sc1 lds
  v_mfma_f32_16x16x32_bf16 a[0:3], a[224:227], v[160:163], a[0:3]
  v_exp_f32 v44, v44
  v_mfma_f32_16x16x32_bf16 a[0:3], a[228:231], v[164:167], a[0:3]
  ds_read_b128 a[216:219], v78 offset:36864
  v_cvt_pk_bf16_f32 v129, v42, v43
  v_mfma_f32_16x16x32_bf16 a[4:7], a[228:231], v[172:175], a[4:7]
  v_exp_f32 v45, v45
  v_mfma_f32_16x16x32_bf16 a[4:7], a[224:227], v[168:171], a[4:7]
  ds_read_b128 a[220:223], v79 offset:36864
  v_cvt_pk_bf16_f32 v136, v44, v45
  v_mfma_f32_16x16x32_bf16 a[8:11], a[224:227], v[176:179], a[8:11]
  v_exp_f32 v46, v46
  v_mfma_f32_16x16x32_bf16 a[8:11], a[228:231], v[180:183], a[8:11]
  buffer_load_dwordx4 v3, s[52:55], s40 offen offset:2048 sc1 lds
  v_mfma_f32_16x16x32_bf16 a[12:15], a[228:231], v[188:191], a[12:15]
  v_exp_f32 v47, v47
  v_mfma_f32_16x16x32_bf16 a[12:15], a[224:227], v[184:187], a[12:15]
  s_waitcnt lgkmcnt(4)
  buffer_load_dwordx4 v3, s[52:55], s40 offen offset:3072 sc1 lds
  v_mfma_f32_16x16x32_bf16 a[28:31], a[232:235], v[184:187], a[28:31]
  v_exp_f32 v48, v48
  v_mfma_f32_16x16x32_bf16 a[28:31], a[236:239], v[188:191], a[28:31]
  ds_read_b64_tr_b16 a[240:241], v82 offset:32768
  v_cvt_pk_bf16_f32 v137, v46, v47
  v_mfma_f32_16x16x32_bf16 a[24:27], a[236:239], v[180:183], a[24:27]
  v_exp_f32 v49, v49
  v_mfma_f32_16x16x32_bf16 a[24:27], a[232:235], v[176:179], a[24:27]
  ds_read_b64_tr_b16 a[242:243], v82 offset:36864
  v_cvt_pk_bf16_f32 v144, v48, v49
  v_mfma_f32_16x16x32_bf16 a[20:23], a[232:235], v[168:171], a[20:23]
  v_exp_f32 v50, v50
  v_mfma_f32_16x16x32_bf16 a[20:23], a[236:239], v[172:175], a[20:23]
  ds_read_b64_tr_b16 a[244:245], v82 offset:40960
  v_mfma_f32_16x16x32_bf16 a[16:19], a[236:239], v[164:167], a[16:19]
  v_exp_f32 v51, v51
  v_mfma_f32_16x16x32_bf16 a[16:19], a[232:235], v[160:163], a[16:19]
  s_add_u32 m0, s42, 147456
  ds_read_b64_tr_b16 a[246:247], v82 offset:45056
  v_cvt_pk_bf16_f32 v145, v50, v51
  s_add_u32 s40, s40, 4096
  v_exp_f32 v52, v52
  v_smfmac_f32_16x16x64_bf16 v[8:11], v[4:7], v[160:167], v116
  s_waitcnt lgkmcnt(4)
  buffer_load_dwordx4 v3, s[52:55], s40 offen offset:0 sc1 lds
  v_mfma_f32_16x16x32_bf16 v[56:59], a[208:211], v[192:195], v[24:27]
  v_exp_f32 v53, v53
  v_mfma_f32_16x16x32_bf16 v[56:59], a[212:215], v[208:211], v[56:59]
  ds_read_b64_tr_b16 a[248:249], v83 offset:32768
  v_cvt_pk_bf16_f32 v152, v52, v53
  v_mfma_f32_16x16x32_bf16 v[56:59], a[216:219], v[224:227], v[56:59]
  v_exp_f32 v54, v54
  v_mfma_f32_16x16x32_bf16 v[56:59], a[220:223], v[240:243], v[56:59]
  ds_read_b64_tr_b16 a[250:251], v83 offset:36864
  v_mfma_f32_16x16x32_bf16 v[60:63], a[220:223], v[244:247], v[28:31]
  v_exp_f32 v55, v55
  v_mfma_f32_16x16x32_bf16 v[60:63], a[216:219], v[228:231], v[60:63]
  s_add_u32 m0, s42, 0
  ds_read_b64_tr_b16 a[252:253], v83 offset:40960
  v_cvt_pk_bf16_f32 v153, v54, v55
  v_mfma_f32_16x16x32_bf16 v[60:63], a[212:215], v[212:215], v[60:63]
  s_add_u32 s40, s40, 77824
  v_mfma_f32_16x16x32_bf16 v[60:63], a[208:211], v[196:199], v[60:63]
  buffer_load_dwordx4 v3, s[52:55], s40 offen offset:0 sc1 lds
  v_mfma_f32_16x16x32_bf16 v[64:67], a[208:211], v[200:203], v[32:35]
  v_exp_f32 v56, v56
  v_mfma_f32_16x16x32_bf16 v[64:67], a[212:215], v[216:219], v[64:67]
  ds_read_b64_tr_b16 a[254:255], v83 offset:45056
  v_mfma_f32_16x16x32_bf16 v[64:67], a[216:219], v[232:235], v[64:67]
  v_exp_f32 v57, v57
  v_mfma_f32_16x16x32_bf16 v[64:67], a[220:223], v[248:251], v[64:67]
  ds_read_b128 a[192:195], v76 offset:40960
  v_cvt_pk_bf16_f32 v130, v56, v57
  v_mfma_f32_16x16x32_bf16 v[68:71], a[220:223], v[252:255], v[36:39]
  v_exp_f32 v58, v58
  v_mfma_f32_16x16x32_bf16 v[68:71], a[216:219], v[236:239], v[68:71]
  ds_read_b128 a[196:199], v77 offset:40960
  v_mfma_f32_16x16x32_bf16 v[68:71], a[212:215], v[220:223], v[68:71]
  v_exp_f32 v59, v59
  v_mfma_f32_16x16x32_bf16 v[68:71], a[208:211], v[204:207], v[68:71]
  s_waitcnt lgkmcnt(6)
  buffer_load_dwordx4 v3, s[52:55], s40 offen offset:1024 sc1 lds
  v_mfma_f32_16x16x32_bf16 a[32:35], a[240:243], v[160:163], a[32:35]
  v_exp_f32 v60, v60
  v_mfma_f32_16x16x32_bf16 a[32:35], a[244:247], v[164:167], a[32:35]
  ds_read_b128 a[200:203], v78 offset:40960
  v_cvt_pk_bf16_f32 v131, v58, v59
  v_mfma_f32_16x16x32_bf16 a[36:39], a[244:247], v[172:175], a[36:39]
  v_exp_f32 v61, v61
  v_mfma_f32_16x16x32_bf16 a[36:39], a[240:243], v[168:171], a[36:39]
  ds_read_b128 a[204:207], v79 offset:40960
  v_cvt_pk_bf16_f32 v138, v60, v61
  v_mfma_f32_16x16x32_bf16 a[40:43], a[240:243], v[176:179], a[40:43]
  v_exp_f32 v62, v62
  v_mfma_f32_16x16x32_bf16 a[40:43], a[244:247], v[180:183], a[40:43]
  buffer_load_dwordx4 v3, s[52:55], s40 offen offset:2048 sc1 lds
  v_mfma_f32_16x16x32_bf16 a[44:47], a[244:247], v[188:191], a[44:47]
  v_exp_f32 v63, v63
  v_mfma_f32_16x16x32_bf16 a[44:47], a[240:243], v[184:187], a[44:47]
  s_waitcnt lgkmcnt(4)
  buffer_load_dwordx4 v3, s[52:55], s40 offen offset:3072 sc1 lds
  v_mfma_f32_16x16x32_bf16 a[60:63], a[248:251], v[184:187], a[60:63]
  v_exp_f32 v64, v64
  v_mfma_f32_16x16x32_bf16 a[60:63], a[252:255], v[188:191], a[60:63]
  ds_read_b64_tr_b16 a[224:225], v84 offset:32768
  v_cvt_pk_bf16_f32 v139, v62, v63
  v_mfma_f32_16x16x32_bf16 a[56:59], a[252:255], v[180:183], a[56:59]
  v_exp_f32 v65, v65
  v_mfma_f32_16x16x32_bf16 a[56:59], a[248:251], v[176:179], a[56:59]
  ds_read_b64_tr_b16 a[226:227], v84 offset:36864
  v_cvt_pk_bf16_f32 v146, v64, v65
  v_mfma_f32_16x16x32_bf16 a[52:55], a[248:251], v[168:171], a[52:55]
  v_exp_f32 v66, v66
  v_mfma_f32_16x16x32_bf16 a[52:55], a[252:255], v[172:175], a[52:55]
  ds_read_b64_tr_b16 a[228:229], v84 offset:40960
  v_mfma_f32_16x16x32_bf16 a[48:51], a[252:255], v[164:167], a[48:51]
  v_exp_f32 v67, v67
  v_mfma_f32_16x16x32_bf16 a[48:51], a[248:251], v[160:163], a[48:51]
  s_add_u32 m0, s42, 4096
  ds_read_b64_tr_b16 a[230:231], v84 offset:45056
  v_cvt_pk_bf16_f32 v147, v66, v67
  s_add_u32 s40, s40, 4096
  v_exp_f32 v68, v68
  v_smfmac_f32_16x16x64_bf16 v[12:15], v[4:7], v[168:175], v116
  s_waitcnt lgkmcnt(4)
  buffer_load_dwordx4 v3, s[52:55], s40 offen offset:0 sc1 lds
  v_mfma_f32_16x16x32_bf16 v[40:43], a[192:195], v[192:195], v[24:27]
  v_exp_f32 v69, v69
  v_mfma_f32_16x16x32_bf16 v[40:43], a[196:199], v[208:211], v[40:43]
  ds_read_b64_tr_b16 a[232:233], v85 offset:32768
  v_cvt_pk_bf16_f32 v154, v68, v69
  v_mfma_f32_16x16x32_bf16 v[40:43], a[200:203], v[224:227], v[40:43]
  v_exp_f32 v70, v70
  v_mfma_f32_16x16x32_bf16 v[40:43], a[204:207], v[240:243], v[40:43]
  s_add_u32 m0, s18, 65536
  ds_read_b64_tr_b16 a[234:235], v85 offset:36864
  v_mfma_f32_16x16x32_bf16 v[44:47], a[204:207], v[244:247], v[28:31]
  v_exp_f32 v71, v71
  v_mfma_f32_16x16x32_bf16 v[44:47], a[200:203], v[228:231], v[44:47]
  s_add_u32 s17, s17, 16384
  ds_read_b64_tr_b16 a[236:237], v85 offset:40960
  v_cvt_pk_bf16_f32 v155, v70, v71
  v_mfma_f32_16x16x32_bf16 v[44:47], a[196:199], v[212:215], v[44:47]
  v_mfma_f32_16x16x32_bf16 v[44:47], a[192:195], v[196:199], v[44:47]
  buffer_load_dwordx4 v92, s[12:15], s17 offen offset:0 lds
  v_mfma_f32_16x16x32_bf16 v[48:51], a[192:195], v[200:203], v[32:35]
  v_exp_f32 v40, v40
  v_mfma_f32_16x16x32_bf16 v[48:51], a[196:199], v[216:219], v[48:51]
  ds_read_b64_tr_b16 a[238:239], v85 offset:45056
  v_mfma_f32_16x16x32_bf16 v[48:51], a[200:203], v[232:235], v[48:51]
  v_exp_f32 v41, v41
  v_mfma_f32_16x16x32_bf16 v[48:51], a[204:207], v[248:251], v[48:51]
  ds_read_b128 a[208:211], v76 offset:45056
  v_cvt_pk_bf16_f32 v132, v40, v41
  v_mfma_f32_16x16x32_bf16 v[52:55], a[204:207], v[252:255], v[36:39]
  v_exp_f32 v42, v42
  v_mfma_f32_16x16x32_bf16 v[52:55], a[200:203], v[236:239], v[52:55]
  ds_read_b128 a[212:215], v77 offset:45056
  v_mfma_f32_16x16x32_bf16 v[52:55], a[196:199], v[220:223], v[52:55]
  v_exp_f32 v43, v43
  v_mfma_f32_16x16x32_bf16 v[52:55], a[192:195], v[204:207], v[52:55]
  s_waitcnt lgkmcnt(6)
  buffer_load_dwordx4 a[128:131], v112, s[36:39], s41 offen offset:0 sc1
  v_mfma_f32_16x16x32_bf16 a[64:67], a[224:227], v[160:163], a[64:67]
  v_exp_f32 v44, v44
  v_mfma_f32_16x16x32_bf16 a[64:67], a[228:231], v[164:167], a[64:67]
  ds_read_b128 a[216:219], v78 offset:45056
  v_cvt_pk_bf16_f32 v133, v42, v43
  v_mfma_f32_16x16x32_bf16 a[68:71], a[228:231], v[172:175], a[68:71]
  v_exp_f32 v45, v45
  v_mfma_f32_16x16x32_bf16 a[68:71], a[224:227], v[168:171], a[68:71]
  ds_read_b128 a[220:223], v79 offset:45056
  v_cvt_pk_bf16_f32 v140, v44, v45
  v_mfma_f32_16x16x32_bf16 a[72:75], a[224:227], v[176:179], a[72:75]
  v_exp_f32 v46, v46
  v_mfma_f32_16x16x32_bf16 a[72:75], a[228:231], v[180:183], a[72:75]
  buffer_load_dwordx4 a[132:135], v112, s[36:39], s41 offen offset:1024 sc1
  v_mfma_f32_16x16x32_bf16 a[76:79], a[228:231], v[188:191], a[76:79]
  v_exp_f32 v47, v47
  v_mfma_f32_16x16x32_bf16 a[76:79], a[224:227], v[184:187], a[76:79]
  s_waitcnt lgkmcnt(4)
  buffer_load_dwordx4 v93, s[12:15], s17 offen offset:1024 lds
  v_mfma_f32_16x16x32_bf16 a[92:95], a[232:235], v[184:187], a[92:95]
  v_exp_f32 v48, v48
  v_mfma_f32_16x16x32_bf16 a[92:95], a[236:239], v[188:191], a[92:95]
  ds_read_b64_tr_b16 a[240:241], v86 offset:32768
  v_cvt_pk_bf16_f32 v141, v46, v47
  v_mfma_f32_16x16x32_bf16 a[88:91], a[236:239], v[180:183], a[88:91]
  v_exp_f32 v49, v49
  v_mfma_f32_16x16x32_bf16 a[88:91], a[232:235], v[176:179], a[88:91]
  ds_read_b64_tr_b16 a[242:243], v86 offset:36864
  v_cvt_pk_bf16_f32 v148, v48, v49
  v_mfma_f32_16x16x32_bf16 a[84:87], a[232:235], v[168:171], a[84:87]
  v_exp_f32 v50, v50
  v_mfma_f32_16x16x32_bf16 a[84:87], a[236:239], v[172:175], a[84:87]
  ds_read_b64_tr_b16 a[244:245], v86 offset:40960
  v_mfma_f32_16x16x32_bf16 a[80:83], a[236:239], v[164:167], a[80:83]
  v_exp_f32 v51, v51
  v_mfma_f32_16x16x32_bf16 a[80:83], a[232:235], v[160:163], a[80:83]
  ds_read_b64_tr_b16 a[246:247], v86 offset:45056
  v_cvt_pk_bf16_f32 v149, v50, v51
  v_exp_f32 v52, v52
  v_smfmac_f32_16x16x64_bf16 v[16:19], v[4:7], v[176:183], v116
  s_waitcnt lgkmcnt(4)
  buffer_load_dwordx4 a[136:139], v113, s[36:39], s41 offen offset:0 sc1
  v_mfma_f32_16x16x32_bf16 v[56:59], a[208:211], v[192:195], v[24:27]
  v_exp_f32 v53, v53
  v_mfma_f32_16x16x32_bf16 v[56:59], a[212:215], v[208:211], v[56:59]
  ds_read_b64_tr_b16 a[248:249], v87 offset:32768
  v_cvt_pk_bf16_f32 v156, v52, v53
  v_mfma_f32_16x16x32_bf16 v[56:59], a[216:219], v[224:227], v[56:59]
  v_exp_f32 v54, v54
  v_mfma_f32_16x16x32_bf16 v[56:59], a[220:223], v[240:243], v[56:59]
  ds_read_b64_tr_b16 a[250:251], v87 offset:36864
  v_mfma_f32_16x16x32_bf16 v[60:63], a[220:223], v[244:247], v[28:31]
  v_exp_f32 v55, v55
  v_mfma_f32_16x16x32_bf16 v[60:63], a[216:219], v[228:231], v[60:63]
  ds_read_b64_tr_b16 a[252:253], v87 offset:40960
  v_cvt_pk_bf16_f32 v157, v54, v55
  v_mfma_f32_16x16x32_bf16 v[60:63], a[212:215], v[212:215], v[60:63]
  s_waitcnt vmcnt(15)
  s_barrier
  v_mfma_f32_16x16x32_bf16 v[60:63], a[208:211], v[196:199], v[60:63]
  buffer_load_dwordx4 v92, s[12:15], s17 offen offset:2048 lds
  v_mfma_f32_16x16x32_bf16 v[64:67], a[208:211], v[200:203], v[32:35]
  v_exp_f32 v56, v56
  v_mfma_f32_16x16x32_bf16 v[64:67], a[212:215], v[216:219], v[64:67]
  ds_read_b64_tr_b16 a[254:255], v87 offset:45056
  v_mfma_f32_16x16x32_bf16 v[64:67], a[216:219], v[232:235], v[64:67]
  v_exp_f32 v57, v57
  v_mfma_f32_16x16x32_bf16 v[64:67], a[220:223], v[248:251], v[64:67]
  ds_read_b128 a[192:195], v76 offset:49152
  v_cvt_pk_bf16_f32 v134, v56, v57
  v_mfma_f32_16x16x32_bf16 v[68:71], a[220:223], v[252:255], v[36:39]
  v_exp_f32 v58, v58
  v_mfma_f32_16x16x32_bf16 v[68:71], a[216:219], v[236:239], v[68:71]
  ds_read_b128 a[196:199], v77 offset:49152
  v_mfma_f32_16x16x32_bf16 v[68:71], a[212:215], v[220:223], v[68:71]
  v_exp_f32 v59, v59
  v_mfma_f32_16x16x32_bf16 v[68:71], a[208:211], v[204:207], v[68:71]
  s_waitcnt lgkmcnt(6)
  buffer_load_dwordx4 a[140:143], v113, s[36:39], s41 offen offset:1024 sc1
  v_mfma_f32_16x16x32_bf16 a[96:99], a[240:243], v[160:163], a[96:99]
  v_exp_f32 v60, v60
  v_mfma_f32_16x16x32_bf16 a[96:99], a[244:247], v[164:167], a[96:99]
  ds_read_b128 a[200:203], v78 offset:49152
  v_cvt_pk_bf16_f32 v135, v58, v59
  v_mfma_f32_16x16x32_bf16 a[100:103], a[244:247], v[172:175], a[100:103]
  v_exp_f32 v61, v61
  v_mfma_f32_16x16x32_bf16 a[100:103], a[240:243], v[168:171], a[100:103]
  ds_read_b128 a[204:207], v79 offset:49152
  v_cvt_pk_bf16_f32 v142, v60, v61
L_pad_post10_0:
  s_cbranch_execz L_pad_post10_1
  v_mfma_f32_16x16x32_bf16 a[104:107], a[240:243], v[176:179], a[104:107]
  s_add_u32 s41, s41, 262144
  v_exp_f32 v62, v62
  v_mfma_f32_16x16x32_bf16 a[104:107], a[244:247], v[180:183], a[104:107]
  buffer_load_dwordx4 a[144:147], v112, s[36:39], s41 offen offset:0 sc1
  v_mfma_f32_16x16x32_bf16 a[108:111], a[244:247], v[188:191], a[108:111]
  v_exp_f32 v63, v63
  v_mfma_f32_16x16x32_bf16 a[108:111], a[240:243], v[184:187], a[108:111]
  s_waitcnt lgkmcnt(4)
  buffer_load_dwordx4 v93, s[12:15], s17 offen offset:3072 lds
  v_mfma_f32_16x16x32_bf16 a[124:127], a[248:251], v[184:187], a[124:127]
  v_exp_f32 v64, v64
  v_mfma_f32_16x16x32_bf16 a[124:127], a[252:255], v[188:191], a[124:127]
  ds_read_b64_tr_b16 a[224:225], v80 offset:16384
  v_cvt_pk_bf16_f32 v143, v62, v63
  v_mfma_f32_16x16x32_bf16 a[120:123], a[252:255], v[180:183], a[120:123]
  v_exp_f32 v65, v65
  v_mfma_f32_16x16x32_bf16 a[120:123], a[248:251], v[176:179], a[120:123]
  ds_read_b64_tr_b16 a[226:227], v80 offset:20480
  v_cvt_pk_bf16_f32 v150, v64, v65
  v_mfma_f32_16x16x32_bf16 a[116:119], a[248:251], v[168:171], a[116:119]
  v_exp_f32 v66, v66
  v_mfma_f32_16x16x32_bf16 a[116:119], a[252:255], v[172:175], a[116:119]
  ds_read_b64_tr_b16 a[228:229], v80 offset:24576
  v_mfma_f32_16x16x32_bf16 a[112:115], a[252:255], v[164:167], a[112:115]
  v_exp_f32 v67, v67
  v_mfma_f32_16x16x32_bf16 a[112:115], a[248:251], v[160:163], a[112:115]
  ds_read_b64_tr_b16 a[230:231], v80 offset:28672
  v_cvt_pk_bf16_f32 v151, v66, v67
  v_exp_f32 v68, v68
  v_smfmac_f32_16x16x64_bf16 v[20:23], v[4:7], v[184:191], v116
  s_waitcnt lgkmcnt(4)
  buffer_load_dwordx4 a[148:151], v112, s[36:39], s41 offen offset:1024 sc1
  v_mfma_f32_16x16x32_bf16 v[40:43], a[192:195], v[192:195], v[24:27]
  v_exp_f32 v69, v69
  v_mfma_f32_16x16x32_bf16 v[40:43], a[196:199], v[208:211], v[40:43]
  ds_read_b64_tr_b16 a[232:233], v81 offset:16384
  v_cvt_pk_bf16_f32 v158, v68, v69
  v_mfma_f32_16x16x32_bf16 v[40:43], a[200:203], v[224:227], v[40:43]
  v_exp_f32 v70, v70
  v_mfma_f32_16x16x32_bf16 v[40:43], a[204:207], v[240:243], v[40:43]
  ds_read_b64_tr_b16 a[234:235], v81 offset:20480
  v_mfma_f32_16x16x32_bf16 v[44:47], a[204:207], v[244:247], v[28:31]
  v_exp_f32 v71, v71
  v_mfma_f32_16x16x32_bf16 v[44:47], a[200:203], v[228:231], v[44:47]
  ds_read_b64_tr_b16 a[236:237], v81 offset:24576
  v_cvt_pk_bf16_f32 v159, v70, v71
  v_mfma_f32_16x16x32_bf16 v[44:47], a[196:199], v[212:215], v[44:47]
  v_mfma_f32_16x16x32_bf16 v[44:47], a[192:195], v[196:199], v[44:47]
  buffer_load_dwordx4 a[152:155], v113, s[36:39], s41 offen offset:0 sc1
  v_mfma_f32_16x16x32_bf16 v[48:51], a[192:195], v[200:203], v[32:35]
  v_exp_f32 v40, v40
  v_mfma_f32_16x16x32_bf16 v[48:51], a[196:199], v[216:219], v[48:51]
  ds_read_b64_tr_b16 a[238:239], v81 offset:28672
  v_mfma_f32_16x16x32_bf16 v[48:51], a[200:203], v[232:235], v[48:51]
  v_exp_f32 v41, v41
  v_mfma_f32_16x16x32_bf16 v[48:51], a[204:207], v[248:251], v[48:51]
  ds_read_b128 a[208:211], v76 offset:53248
  v_cvt_pk_bf16_f32 v160, v40, v41
  v_mfma_f32_16x16x32_bf16 v[52:55], a[204:207], v[252:255], v[36:39]
  v_exp_f32 v42, v42
  v_mfma_f32_16x16x32_bf16 v[52:55], a[200:203], v[236:239], v[52:55]
  ds_read_b128 a[212:215], v77 offset:53248
  v_mfma_f32_16x16x32_bf16 v[52:55], a[196:199], v[220:223], v[52:55]
  v_exp_f32 v43, v43
  v_mfma_f32_16x16x32_bf16 v[52:55], a[192:195], v[204:207], v[52:55]
  s_waitcnt lgkmcnt(6)
  buffer_load_dwordx4 a[156:159], v113, s[36:39], s41 offen offset:1024 sc1
  v_mfma_f32_16x16x32_bf16 a[0:3], a[224:227], v[128:131], a[0:3]
  v_exp_f32 v44, v44
  v_mfma_f32_16x16x32_bf16 a[0:3], a[228:231], v[132:135], a[0:3]
  ds_read_b128 a[216:219], v78 offset:53248
  v_cvt_pk_bf16_f32 v161, v42, v43
  v_mfma_f32_16x16x32_bf16 a[4:7], a[228:231], v[140:143], a[4:7]
  v_exp_f32 v45, v45
  v_mfma_f32_16x16x32_bf16 a[4:7], a[224:227], v[136:139], a[4:7]
  s_add_u32 m0, s42, 20480
  ds_read_b128 a[220:223], v79 offset:53248
  v_cvt_pk_bf16_f32 v168, v44, v45
  v_mfma_f32_16x16x32_bf16 a[8:11], a[224:227], v[144:147], a[8:11]
  s_add_u32 s40, s40, 77824
  v_exp_f32 v46, v46
  v_mfma_f32_16x16x32_bf16 a[8:11], a[228:231], v[148:151], a[8:11]
  buffer_load_dwordx4 v3, s[52:55], s40 offen offset:0 sc1 lds
  v_mfma_f32_16x16x32_bf16 a[12:15], a[228:231], v[156:159], a[12:15]
  v_exp_f32 v47, v47
  v_mfma_f32_16x16x32_bf16 a[12:15], a[224:227], v[152:155], a[12:15]
  s_waitcnt lgkmcnt(4)
  buffer_load_dwordx4 v3, s[52:55], s40 offen offset:1024 sc1 lds
  v_mfma_f32_16x16x32_bf16 a[28:31], a[232:235], v[152:155], a[28:31]
  v_exp_f32 v48, v48
  v_mfma_f32_16x16x32_bf16 a[28:31], a[236:239], v[156:159], a[28:31]
  ds_read_b64_tr_b16 a[240:241], v82 offset:16384
  v_cvt_pk_bf16_f32 v169, v46, v47
  v_mfma_f32_16x16x32_bf16 a[24:27], a[236:239], v[148:151], a[24:27]
  v_exp_f32 v49, v49
  v_mfma_f32_16x16x32_bf16 a[24:27], a[232:235], v[144:147], a[24:27]
  ds_read_b64_tr_b16 a[242:243], v82 offset:20480
  v_cvt_pk_bf16_f32 v176, v48, v49
  v_mfma_f32_16x16x32_bf16 a[20:23], a[232:235], v[136:139], a[20:23]
  v_exp_f32 v50, v50
  v_mfma_f32_16x16x32_bf16 a[20:23], a[236:239], v[140:143], a[20:23]
  ds_read_b64_tr_b16 a[244:245], v82 offset:24576
  v_mfma_f32_16x16x32_bf16 a[16:19], a[236:239], v[132:135], a[16:19]
  v_exp_f32 v51, v51
  v_mfma_f32_16x16x32_bf16 a[16:19], a[232:235], v[128:131], a[16:19]
  ds_read_b64_tr_b16 a[246:247], v82 offset:28672
  v_cvt_pk_bf16_f32 v177, v50, v51
  v_exp_f32 v52, v52
  v_smfmac_f32_16x16x64_bf16 v[8:11], v[4:7], v[128:135], v116
  s_waitcnt lgkmcnt(4)
  buffer_load_dwordx4 v3, s[52:55], s40 offen offset:2048 sc1 lds
  v_mfma_f32_16x16x32_bf16 v[56:59], a[208:211], v[192:195], v[24:27]
  v_exp_f32 v53, v53
  v_mfma_f32_16x16x32_bf16 v[56:59], a[212:215], v[208:211], v[56:59]
  ds_read_b64_tr_b16 a[248:249], v83 offset:16384
  v_cvt_pk_bf16_f32 v184, v52, v53
  v_mfma_f32_16x16x32_bf16 v[56:59], a[216:219], v[224:227], v[56:59]
  v_exp_f32 v54, v54
  v_mfma_f32_16x16x32_bf16 v[56:59], a[220:223], v[240:243], v[56:59]
  ds_read_b64_tr_b16 a[250:251], v83 offset:20480
  v_mfma_f32_16x16x32_bf16 v[60:63], a[220:223], v[244:247], v[28:31]
  v_exp_f32 v55, v55
  v_mfma_f32_16x16x32_bf16 v[60:63], a[216:219], v[228:231], v[60:63]
  ds_read_b64_tr_b16 a[252:253], v83 offset:24576
  v_cvt_pk_bf16_f32 v185, v54, v55
  v_mfma_f32_16x16x32_bf16 v[60:63], a[212:215], v[212:215], v[60:63]
  v_mfma_f32_16x16x32_bf16 v[60:63], a[208:211], v[196:199], v[60:63]
  buffer_load_dwordx4 v3, s[52:55], s40 offen offset:3072 sc1 lds
  v_mfma_f32_16x16x32_bf16 v[64:67], a[208:211], v[200:203], v[32:35]
  v_exp_f32 v56, v56
  v_mfma_f32_16x16x32_bf16 v[64:67], a[212:215], v[216:219], v[64:67]
  ds_read_b64_tr_b16 a[254:255], v83 offset:28672
  v_mfma_f32_16x16x32_bf16 v[64:67], a[216:219], v[232:235], v[64:67]
  v_exp_f32 v57, v57
  v_mfma_f32_16x16x32_bf16 v[64:67], a[220:223], v[248:251], v[64:67]
  ds_read_b128 a[192:195], v76 offset:57344
  v_cvt_pk_bf16_f32 v162, v56, v57
  v_mfma_f32_16x16x32_bf16 v[68:71], a[220:223], v[252:255], v[36:39]
  v_exp_f32 v58, v58
  v_mfma_f32_16x16x32_bf16 v[68:71], a[216:219], v[236:239], v[68:71]
  s_add_u32 m0, s42, 24576
  ds_read_b128 a[196:199], v77 offset:57344
  v_mfma_f32_16x16x32_bf16 v[68:71], a[212:215], v[220:223], v[68:71]
  s_add_u32 s40, s40, 4096
  v_exp_f32 v59, v59
  v_mfma_f32_16x16x32_bf16 v[68:71], a[208:211], v[204:207], v[68:71]
  s_waitcnt lgkmcnt(6)
  buffer_load_dwordx4 v3, s[52:55], s40 offen offset:0 sc1 lds
  v_mfma_f32_16x16x32_bf16 a[32:35], a[240:243], v[128:131], a[32:35]
  v_exp_f32 v60, v60
  v_mfma_f32_16x16x32_bf16 a[32:35], a[244:247], v[132:135], a[32:35]
  ds_read_b128 a[200:203], v78 offset:57344
  v_cvt_pk_bf16_f32 v163, v58, v59
  v_mfma_f32_16x16x32_bf16 a[36:39], a[244:247], v[140:143], a[36:39]
  v_exp_f32 v61, v61
  v_mfma_f32_16x16x32_bf16 a[36:39], a[240:243], v[136:139], a[36:39]
  s_add_u32 m0, s42, 122880
  ds_read_b128 a[204:207], v79 offset:57344
  v_cvt_pk_bf16_f32 v170, v60, v61
  v_mfma_f32_16x16x32_bf16 a[40:43], a[240:243], v[144:147], a[40:43]
  s_add_u32 s40, s40, 77824
  v_exp_f32 v62, v62
  v_mfma_f32_16x16x32_bf16 a[40:43], a[244:247], v[148:151], a[40:43]
  buffer_load_dwordx4 v3, s[52:55], s40 offen offset:0 sc1 lds
  v_mfma_f32_16x16x32_bf16 a[44:47], a[244:247], v[156:159], a[44:47]
  v_exp_f32 v63, v63
  v_mfma_f32_16x16x32_bf16 a[44:47], a[240:243], v[152:155], a[44:47]
  s_waitcnt lgkmcnt(4)
  buffer_load_dwordx4 v3, s[52:55], s40 offen offset:1024 sc1 lds
  v_mfma_f32_16x16x32_bf16 a[60:63], a[248:251], v[152:155], a[60:63]
  v_exp_f32 v64, v64
  v_mfma_f32_16x16x32_bf16 a[60:63], a[252:255], v[156:159], a[60:63]
  ds_read_b64_tr_b16 a[224:225], v84 offset:16384
  v_cvt_pk_bf16_f32 v171, v62, v63
  v_mfma_f32_16x16x32_bf16 a[56:59], a[252:255], v[148:151], a[56:59]
  v_exp_f32 v65, v65
  v_mfma_f32_16x16x32_bf16 a[56:59], a[248:251], v[144:147], a[56:59]
  ds_read_b64_tr_b16 a[226:227], v84 offset:20480
  v_cvt_pk_bf16_f32 v178, v64, v65
  v_mfma_f32_16x16x32_bf16 a[52:55], a[248:251], v[136:139], a[52:55]
  v_exp_f32 v66, v66
  v_mfma_f32_16x16x32_bf16 a[52:55], a[252:255], v[140:143], a[52:55]
  ds_read_b64_tr_b16 a[228:229], v84 offset:24576
  v_mfma_f32_16x16x32_bf16 a[48:51], a[252:255], v[132:135], a[48:51]
  v_exp_f32 v67, v67
  v_mfma_f32_16x16x32_bf16 a[48:51], a[248:251], v[128:131], a[48:51]
  ds_read_b64_tr_b16 a[230:231], v84 offset:28672
  v_cvt_pk_bf16_f32 v179, v66, v67
  v_exp_f32 v68, v68
  v_smfmac_f32_16x16x64_bf16 v[12:15], v[4:7], v[136:143], v116
  s_waitcnt lgkmcnt(4)
  buffer_load_dwordx4 v3, s[52:55], s40 offen offset:2048 sc1 lds
  v_mfma_f32_16x16x32_bf16 v[40:43], a[192:195], v[192:195], v[24:27]
  v_exp_f32 v69, v69
  v_mfma_f32_16x16x32_bf16 v[40:43], a[196:199], v[208:211], v[40:43]
  ds_read_b64_tr_b16 a[232:233], v85 offset:16384
  v_cvt_pk_bf16_f32 v186, v68, v69
  v_mfma_f32_16x16x32_bf16 v[40:43], a[200:203], v[224:227], v[40:43]
  v_exp_f32 v70, v70
  v_mfma_f32_16x16x32_bf16 v[40:43], a[204:207], v[240:243], v[40:43]
  ds_read_b64_tr_b16 a[234:235], v85 offset:20480
  v_mfma_f32_16x16x32_bf16 v[44:47], a[204:207], v[244:247], v[28:31]
  v_exp_f32 v71, v71
  v_mfma_f32_16x16x32_bf16 v[44:47], a[200:203], v[228:231], v[44:47]
  ds_read_b64_tr_b16 a[236:237], v85 offset:24576
  v_cvt_pk_bf16_f32 v187, v70, v71
  v_mfma_f32_16x16x32_bf16 v[44:47], a[196:199], v[212:215], v[44:47]
  v_mfma_f32_16x16x32_bf16 v[44:47], a[192:195], v[196:199], v[44:47]
  buffer_load_dwordx4 v3, s[52:55], s40 offen offset:3072 sc1 lds
  v_mfma_f32_16x16x32_bf16 v[48:51], a[192:195], v[200:203], v[32:35]
  v_exp_f32 v40, v40
  v_mfma_f32_16x16x32_bf16 v[48:51], a[196:199], v[216:219], v[48:51]
  ds_read_b64_tr_b16 a[238:239], v85 offset:28672
  v_mfma_f32_16x16x32_bf16 v[48:51], a[200:203], v[232:235], v[48:51]
  v_exp_f32 v41, v41
  v_mfma_f32_16x16x32_bf16 v[48:51], a[204:207], v[248:251], v[48:51]
  ds_read_b128 a[208:211], v76 offset:61440
  v_cvt_pk_bf16_f32 v164, v40, v41
  v_mfma_f32_16x16x32_bf16 v[52:55], a[204:207], v[252:255], v[36:39]
  v_exp_f32 v42, v42
  v_mfma_f32_16x16x32_bf16 v[52:55], a[200:203], v[236:239], v[52:55]
  s_add_u32 m0, s42, 126976
  ds_read_b128 a[212:215], v77 offset:61440
  v_mfma_f32_16x16x32_bf16 v[52:55], a[196:199], v[220:223], v[52:55]
  s_add_u32 s40, s40, 4096
  v_exp_f32 v43, v43
  v_mfma_f32_16x16x32_bf16 v[52:55], a[192:195], v[204:207], v[52:55]
  s_waitcnt lgkmcnt(6)
  buffer_load_dwordx4 v3, s[52:55], s40 offen offset:0 sc1 lds
  v_mfma_f32_16x16x32_bf16 a[64:67], a[224:227], v[128:131], a[64:67]
  v_exp_f32 v44, v44
  v_mfma_f32_16x16x32_bf16 a[64:67], a[228:231], v[132:135], a[64:67]
  ds_read_b128 a[216:219], v78 offset:61440
  v_cvt_pk_bf16_f32 v165, v42, v43
  v_mfma_f32_16x16x32_bf16 a[68:71], a[228:231], v[140:143], a[68:71]
  v_exp_f32 v45, v45
  v_mfma_f32_16x16x32_bf16 a[68:71], a[224:227], v[136:139], a[68:71]
  ds_read_b128 a[220:223], v79 offset:61440
  v_cvt_pk_bf16_f32 v172, v44, v45
  v_mfma_f32_16x16x32_bf16 a[72:75], a[224:227], v[144:147], a[72:75]
  s_add_u32 s41, s41, 262144
  v_exp_f32 v46, v46
  v_mfma_f32_16x16x32_bf16 a[72:75], a[228:231], v[148:151], a[72:75]
  buffer_load_dwordx4 a[160:163], v112, s[36:39], s41 offen offset:0 sc1
  v_mfma_f32_16x16x32_bf16 a[76:79], a[228:231], v[156:159], a[76:79]
  v_exp_f32 v47, v47
  v_mfma_f32_16x16x32_bf16 a[76:79], a[224:227], v[152:155], a[76:79]
  s_waitcnt lgkmcnt(4)
  buffer_load_dwordx4 a[164:167], v112, s[36:39], s41 offen offset:1024 sc1
  v_mfma_f32_16x16x32_bf16 a[92:95], a[232:235], v[152:155], a[92:95]
  v_exp_f32 v48, v48
  v_mfma_f32_16x16x32_bf16 a[92:95], a[236:239], v[156:159], a[92:95]
  ds_read_b64_tr_b16 a[240:241], v86 offset:16384
  v_cvt_pk_bf16_f32 v173, v46, v47
  v_mfma_f32_16x16x32_bf16 a[88:91], a[236:239], v[148:151], a[88:91]
  v_exp_f32 v49, v49
  v_mfma_f32_16x16x32_bf16 a[88:91], a[232:235], v[144:147], a[88:91]
  ds_read_b64_tr_b16 a[242:243], v86 offset:20480
  v_cvt_pk_bf16_f32 v180, v48, v49
  v_mfma_f32_16x16x32_bf16 a[84:87], a[232:235], v[136:139], a[84:87]
  v_exp_f32 v50, v50
  v_mfma_f32_16x16x32_bf16 a[84:87], a[236:239], v[140:143], a[84:87]
  ds_read_b64_tr_b16 a[244:245], v86 offset:24576
  v_mfma_f32_16x16x32_bf16 a[80:83], a[236:239], v[132:135], a[80:83]
  v_exp_f32 v51, v51
  v_mfma_f32_16x16x32_bf16 a[80:83], a[232:235], v[128:131], a[80:83]
  ds_read_b64_tr_b16 a[246:247], v86 offset:28672
  v_cvt_pk_bf16_f32 v181, v50, v51
  v_exp_f32 v52, v52
  v_smfmac_f32_16x16x64_bf16 v[16:19], v[4:7], v[144:151], v116
  s_waitcnt lgkmcnt(4)
  buffer_load_dwordx4 a[168:171], v113, s[36:39], s41 offen offset:0 sc1
  v_mfma_f32_16x16x32_bf16 v[56:59], a[208:211], v[192:195], v[24:27]
  v_exp_f32 v53, v53
  v_mfma_f32_16x16x32_bf16 v[56:59], a[212:215], v[208:211], v[56:59]
  ds_read_b64_tr_b16 a[248:249], v87 offset:16384
  v_cvt_pk_bf16_f32 v188, v52, v53
  v_mfma_f32_16x16x32_bf16 v[56:59], a[216:219], v[224:227], v[56:59]
  v_exp_f32 v54, v54
  v_mfma_f32_16x16x32_bf16 v[56:59], a[220:223], v[240:243], v[56:59]
  ds_read_b64_tr_b16 a[250:251], v87 offset:20480
  v_mfma_f32_16x16x32_bf16 v[60:63], a[220:223], v[244:247], v[28:31]
  v_exp_f32 v55, v55
  v_mfma_f32_16x16x32_bf16 v[60:63], a[216:219], v[228:231], v[60:63]
  s_add_u32 m0, s42, 40960
  ds_read_b64_tr_b16 a[252:253], v87 offset:24576
  v_cvt_pk_bf16_f32 v189, v54, v55
  v_mfma_f32_16x16x32_bf16 v[60:63], a[212:215], v[212:215], v[60:63]
  s_waitcnt vmcnt(16)
  s_barrier
  s_add_u32 s40, s40, 77824
  v_mfma_f32_16x16x32_bf16 v[60:63], a[208:211], v[196:199], v[60:63]
  buffer_load_dwordx4 a[172:175], v113, s[36:39], s41 offen offset:1024 sc1
  buffer_load_dwordx4 v3, s[52:55], s40 offen offset:0 sc1 lds
  v_mfma_f32_16x16x32_bf16 v[64:67], a[208:211], v[200:203], v[32:35]
  v_exp_f32 v56, v56
  v_mfma_f32_16x16x32_bf16 v[64:67], a[212:215], v[216:219], v[64:67]
  ds_read_b64_tr_b16 a[254:255], v87 offset:28672
  v_mfma_f32_16x16x32_bf16 v[64:67], a[216:219], v[232:235], v[64:67]
  v_exp_f32 v57, v57
  v_mfma_f32_16x16x32_bf16 v[64:67], a[220:223], v[248:251], v[64:67]
  buffer_load_dwordx4 v3, s[52:55], s40 offen offset:1024 sc1 lds
  v_mfma_f32_16x16x32_bf16 v[68:71], a[220:223], v[252:255], v[36:39]
  v_exp_f32 v58, v58
  v_mfma_f32_16x16x32_bf16 v[68:71], a[216:219], v[236:239], v[68:71]
  buffer_load_dwordx4 v3, s[52:55], s40 offen offset:2048 sc1 lds
  v_mfma_f32_16x16x32_bf16 v[68:71], a[212:215], v[220:223], v[68:71]
  v_exp_f32 v59, v59
  v_mfma_f32_16x16x32_bf16 v[68:71], a[208:211], v[204:207], v[68:71]
  s_waitcnt lgkmcnt(4)
  buffer_load_dwordx4 v3, s[52:55], s40 offen offset:3072 sc1 lds
  v_mfma_f32_16x16x32_bf16 a[96:99], a[240:243], v[128:131], a[96:99]
  s_add_u32 m0, s42, 45056
  s_add_u32 s40, s40, 4096
  v_exp_f32 v60, v60
  v_mfma_f32_16x16x32_bf16 a[96:99], a[244:247], v[132:135], a[96:99]
  buffer_load_dwordx4 v3, s[52:55], s40 offen offset:0 sc1 lds
  v_mfma_f32_16x16x32_bf16 a[100:103], a[244:247], v[140:143], a[100:103]
  s_add_u32 s41, s41, 262144
  v_exp_f32 v61, v61
  v_mfma_f32_16x16x32_bf16 a[100:103], a[240:243], v[136:139], a[100:103]
  buffer_load_dwordx4 a[176:179], v112, s[36:39], s41 offen offset:0 sc1
  v_mfma_f32_16x16x32_bf16 a[104:107], a[240:243], v[144:147], a[104:107]
  v_exp_f32 v62, v62
  v_mfma_f32_16x16x32_bf16 a[104:107], a[244:247], v[148:151], a[104:107]
  buffer_load_dwordx4 a[180:183], v112, s[36:39], s41 offen offset:1024 sc1
  v_mfma_f32_16x16x32_bf16 a[108:111], a[244:247], v[156:159], a[108:111]
  v_exp_f32 v63, v63
  v_mfma_f32_16x16x32_bf16 a[108:111], a[240:243], v[152:155], a[108:111]
  s_waitcnt lgkmcnt(0)
  buffer_load_dwordx4 a[184:187], v113, s[36:39], s41 offen offset:0 sc1
  v_cvt_pk_bf16_f32 v166, v56, v57
  v_mfma_f32_16x16x32_bf16 a[124:127], a[248:251], v[152:155], a[124:127]
  v_exp_f32 v64, v64
  v_mfma_f32_16x16x32_bf16 a[124:127], a[252:255], v[156:159], a[124:127]
  ds_read_b64_tr_b16 a[224:225], v80 offset:0
  v_cvt_pk_bf16_f32 v167, v58, v59
  v_mfma_f32_16x16x32_bf16 a[120:123], a[252:255], v[148:151], a[120:123]
  v_exp_f32 v65, v65
  v_mfma_f32_16x16x32_bf16 a[120:123], a[248:251], v[144:147], a[120:123]
  ds_read_b64_tr_b16 a[226:227], v80 offset:4096
  v_cvt_pk_bf16_f32 v174, v60, v61
  v_mfma_f32_16x16x32_bf16 a[116:119], a[248:251], v[136:139], a[116:119]
  v_exp_f32 v66, v66
  v_mfma_f32_16x16x32_bf16 a[116:119], a[252:255], v[140:143], a[116:119]
  ds_read_b64_tr_b16 a[228:229], v80 offset:8192
  v_cvt_pk_bf16_f32 v175, v62, v63
  v_mfma_f32_16x16x32_bf16 a[112:115], a[252:255], v[132:135], a[112:115]
  v_exp_f32 v67, v67
  v_mfma_f32_16x16x32_bf16 a[112:115], a[248:251], v[128:131], a[112:115]
  ds_read_b64_tr_b16 a[230:231], v80 offset:12288
  v_cvt_pk_bf16_f32 v182, v64, v65
  v_exp_f32 v68, v68
  v_smfmac_f32_16x16x64_bf16 v[20:23], v[4:7], v[152:159], v116
  buffer_load_dwordx4 a[188:191], v113, s[36:39], s41 offen offset:1024 sc1
  v_exp_f32 v69, v69
  ds_read_b64_tr_b16 a[232:233], v81 offset:0
  v_cvt_pk_bf16_f32 v183, v66, v67
  v_exp_f32 v70, v70
  ds_read_b64_tr_b16 a[234:235], v81 offset:4096
  v_cvt_pk_bf16_f32 v190, v68, v69
  v_exp_f32 v71, v71
  ds_read_b64_tr_b16 a[236:237], v81 offset:8192
  v_cvt_pk_bf16_f32 v191, v70, v71
  s_add_u32 m0, s42, 102400
  v_smfmac_f32_16x16x64_bf16 v[8:11], v[4:7], v[160:167], v116
  s_add_u32 s40, s40, 77824
  ds_read_b64_tr_b16 a[238:239], v81 offset:12288
  buffer_load_dwordx4 v3, s[52:55], s40 offen offset:0 sc1 lds
  v_smfmac_f32_16x16x64_bf16 v[12:15], v[4:7], v[168:175], v116
  buffer_load_dwordx4 v3, s[52:55], s40 offen offset:1024 sc1 lds
  buffer_load_dwordx4 v3, s[52:55], s40 offen offset:2048 sc1 lds
  v_smfmac_f32_16x16x64_bf16 v[16:19], v[4:7], v[176:183], v116
  v_smfmac_f32_16x16x64_bf16 v[20:23], v[4:7], v[184:191], v116
  s_waitcnt lgkmcnt(4)
  v_mfma_f32_16x16x32_bf16 a[0:3], a[224:227], v[160:163], a[0:3]
  buffer_load_dwordx4 v3, s[52:55], s40 offen offset:3072 sc1 lds
  v_mfma_f32_16x16x32_bf16 a[0:3], a[228:231], v[164:167], a[0:3]
  s_add_u32 m0, s42, 106496
  s_add_u32 s40, s40, 4096
  v_mfma_f32_16x16x32_bf16 a[4:7], a[228:231], v[172:175], a[4:7]
  buffer_load_dwordx4 v3, s[52:55], s40 offen offset:0 sc1 lds
  v_mfma_f32_16x16x32_bf16 a[4:7], a[224:227], v[168:171], a[4:7]
  v_mfma_f32_16x16x32_bf16 a[8:11], a[224:227], v[176:179], a[8:11]
  v_add_f32 v72, v8, v9
  v_mfma_f32_16x16x32_bf16 a[8:11], a[228:231], v[180:183], a[8:11]
  v_add_f32 v73, v12, v13
  v_mfma_f32_16x16x32_bf16 a[12:15], a[228:231], v[188:191], a[12:15]
  v_add_f32 v74, v16, v17
  v_mfma_f32_16x16x32_bf16 a[12:15], a[224:227], v[184:187], a[12:15]
  s_waitcnt lgkmcnt(0)
  v_mfma_f32_16x16x32_bf16 a[28:31], a[232:235], v[184:187], a[28:31]
  v_add_f32 v75, v20, v21
  v_mfma_f32_16x16x32_bf16 a[28:31], a[236:239], v[188:191], a[28:31]
  ds_read_b64_tr_b16 a[240:241], v82 offset:0
  v_rcp_f32 v100, v72
  v_mfma_f32_16x16x32_bf16 a[24:27], a[236:239], v[180:183], a[24:27]
  v_rcp_f32 v101, v73
  v_mfma_f32_16x16x32_bf16 a[24:27], a[232:235], v[176:179], a[24:27]
  ds_read_b64_tr_b16 a[242:243], v82 offset:4096
  v_mfma_f32_16x16x32_bf16 a[20:23], a[232:235], v[168:171], a[20:23]
  v_rcp_f32 v102, v74
  v_mfma_f32_16x16x32_bf16 a[20:23], a[236:239], v[172:175], a[20:23]
  ds_read_b64_tr_b16 a[244:245], v82 offset:8192
  v_rcp_f32 v103, v75
  v_mfma_f32_16x16x32_bf16 a[16:19], a[236:239], v[164:167], a[16:19]
  v_mfma_f32_16x16x32_bf16 a[16:19], a[232:235], v[160:163], a[16:19]
  ds_read_b64_tr_b16 a[246:247], v82 offset:12288
  ds_read_b64_tr_b16 a[248:249], v83 offset:0
  ds_read_b64_tr_b16 a[250:251], v83 offset:4096
  ds_read_b64_tr_b16 a[252:253], v83 offset:8192
  ds_read_b64_tr_b16 a[254:255], v83 offset:12288
  v_accvgpr_read_b32 v40, a0
  v_accvgpr_read_b32 v41, a1
  v_accvgpr_read_b32 v42, a2
  v_accvgpr_read_b32 v43, a3
  v_accvgpr_read_b32 v44, a16
  v_accvgpr_read_b32 v45, a17
  v_accvgpr_read_b32 v46, a18
  v_accvgpr_read_b32 v47, a19
  v_mul_f32 v40, v40, v100
  v_mul_f32 v41, v41, v100
  v_mul_f32 v42, v42, v100
  v_mul_f32 v43, v43, v100
  v_mul_f32 v44, v44, v100
  v_mul_f32 v45, v45, v100
  v_mul_f32 v46, v46, v100
  v_mul_f32 v47, v47, v100
  v_cvt_pk_bf16_f32 v128, v40, v41
  v_cvt_pk_bf16_f32 v129, v42, v43
  v_cvt_pk_bf16_f32 v130, v44, v45
  v_cvt_pk_bf16_f32 v131, v46, v47
  buffer_store_dwordx4 v[128:131], v112, s[32:35], s46 offen offset:0 sc1
  s_waitcnt lgkmcnt(4)
  v_mfma_f32_16x16x32_bf16 a[32:35], a[240:243], v[160:163], a[32:35]
  v_accvgpr_read_b32 v48, a4
  v_accvgpr_read_b32 v49, a5
  v_accvgpr_read_b32 v50, a6
  v_mfma_f32_16x16x32_bf16 v[104:107], v[4:7], v[128:131], 0
  v_accvgpr_read_b32 v51, a7
  v_mfma_f32_16x16x32_bf16 a[32:35], a[244:247], v[164:167], a[32:35]
  v_accvgpr_read_b32 v52, a20
  v_accvgpr_read_b32 v53, a21
  v_accvgpr_read_b32 v54, a22
  v_accvgpr_read_b32 v55, a23
  v_mfma_f32_16x16x32_bf16 a[36:39], a[244:247], v[172:175], a[36:39]
  v_mul_f32 v48, v48, v101
  v_mul_f32 v49, v49, v101
  v_mul_f32 v50, v50, v101
  v_mul_f32 v51, v51, v101
  v_mfma_f32_16x16x32_bf16 a[36:39], a[240:243], v[168:171], a[36:39]
  v_mul_f32 v52, v52, v101
  v_mul_f32 v53, v53, v101
  v_mul_f32 v54, v54, v101
  v_mul_f32 v55, v55, v101
  v_mfma_f32_16x16x32_bf16 a[40:43], a[240:243], v[176:179], a[40:43]
  v_cvt_pk_bf16_f32 v132, v48, v49
  v_cvt_pk_bf16_f32 v133, v50, v51
  v_cvt_pk_bf16_f32 v134, v52, v53
  v_cvt_pk_bf16_f32 v135, v54, v55
  v_mfma_f32_16x16x32_bf16 a[40:43], a[244:247], v[180:183], a[40:43]
  buffer_store_dwordx4 v[132:135], v113, s[32:35], s46 offen offset:0 sc1
  v_accvgpr_read_b32 v56, a8
  v_accvgpr_read_b32 v57, a9
  v_accvgpr_read_b32 v58, a10
  v_mfma_f32_16x16x32_bf16 v[104:107], v[4:7], v[132:135], v[104:107]
  v_mfma_f32_16x16x32_bf16 a[44:47], a[244:247], v[188:191], a[44:47]
  v_accvgpr_read_b32 v59, a11
  v_accvgpr_read_b32 v60, a24
  v_accvgpr_read_b32 v61, a25
  v_accvgpr_read_b32 v62, a26
  v_mfma_f32_16x16x32_bf16 a[44:47], a[240:243], v[184:187], a[44:47]
  s_waitcnt lgkmcnt(0)
  v_accvgpr_read_b32 v63, a27
  v_mul_f32 v56, v56, v102
  v_mul_f32 v57, v57, v102
  v_mul_f32 v58, v58, v102
  v_mfma_f32_16x16x32_bf16 a[60:63], a[248:251], v[184:187], a[60:63]
  v_mul_f32 v59, v59, v102
  v_mul_f32 v60, v60, v102
  v_mul_f32 v61, v61, v102
  v_mul_f32 v62, v62, v102
  v_mfma_f32_16x16x32_bf16 a[60:63], a[252:255], v[188:191], a[60:63]
  ds_read_b64_tr_b16 a[224:225], v84 offset:0
  v_mul_f32 v63, v63, v102
  v_cvt_pk_bf16_f32 v56, v56, v57
  v_cvt_pk_bf16_f32 v57, v58, v59
  v_cvt_pk_bf16_f32 v58, v60, v61
  v_mfma_f32_16x16x32_bf16 a[56:59], a[252:255], v[180:183], a[56:59]
  v_cvt_pk_bf16_f32 v59, v62, v63
  buffer_store_dwordx4 v[56:59], v95, s[32:35], s46 offen offset:0 sc1
  v_accvgpr_read_b32 v64, a12
  v_accvgpr_read_b32 v65, a13
  v_accvgpr_read_b32 v66, a14
  v_mfma_f32_16x16x32_bf16 a[56:59], a[248:251], v[176:179], a[56:59]
  ds_read_b64_tr_b16 a[226:227], v84 offset:4096
  v_mfma_f32_16x16x32_bf16 v[104:107], v[4:7], v[56:59], v[104:107]
  v_accvgpr_read_b32 v67, a15
  v_accvgpr_read_b32 v68, a28
  v_accvgpr_read_b32 v69, a29
  v_mfma_f32_16x16x32_bf16 a[52:55], a[248:251], v[168:171], a[52:55]
  v_accvgpr_read_b32 v70, a30
  v_accvgpr_read_b32 v71, a31
  v_mul_f32 v64, v64, v103
  v_mul_f32 v65, v65, v103
  v_mfma_f32_16x16x32_bf16 a[52:55], a[252:255], v[172:175], a[52:55]
  ds_read_b64_tr_b16 a[228:229], v84 offset:8192
  v_mul_f32 v66, v66, v103
  v_mul_f32 v67, v67, v103
  v_mul_f32 v68, v68, v103
  v_mul_f32 v69, v69, v103
  v_mfma_f32_16x16x32_bf16 a[48:51], a[252:255], v[164:167], a[48:51]
  v_mul_f32 v70, v70, v103
  v_mul_f32 v71, v71, v103
  v_cvt_pk_bf16_f32 v64, v64, v65
  v_cvt_pk_bf16_f32 v65, v66, v67
  v_mfma_f32_16x16x32_bf16 a[48:51], a[248:251], v[160:163], a[48:51]
  ds_read_b64_tr_b16 a[230:231], v84 offset:12288
  v_cvt_pk_bf16_f32 v66, v68, v69
  v_cvt_pk_bf16_f32 v67, v70, v71
  buffer_store_dwordx4 v[64:67], v115, s[32:35], s46 offen offset:0 sc1
  s_nop 0
  v_mfma_f32_16x16x32_bf16 v[104:107], v[4:7], v[64:67], v[104:107]
  ds_read_b64_tr_b16 a[232:233], v85 offset:0
  ds_read_b64_tr_b16 a[234:235], v85 offset:4096
  ds_read_b64_tr_b16 a[236:237], v85 offset:8192
  ds_read_b64_tr_b16 a[238:239], v85 offset:12288
  v_accvgpr_read_b32 v40, a32
  v_accvgpr_read_b32 v41, a33
  v_accvgpr_read_b32 v42, a34
  v_accvgpr_read_b32 v43, a35
  v_accvgpr_read_b32 v44, a48
  v_accvgpr_read_b32 v45, a49
  v_accvgpr_read_b32 v46, a50
  v_accvgpr_read_b32 v47, a51
  v_mul_f32 v40, v40, v100
  v_mul_f32 v41, v41, v100
  v_mul_f32 v42, v42, v100
  v_mul_f32 v43, v43, v100
  v_mul_f32 v44, v44, v100
  v_mul_f32 v45, v45, v100
  v_mul_f32 v46, v46, v100
  v_mul_f32 v47, v47, v100
  v_cvt_pk_bf16_f32 v136, v40, v41
  v_cvt_pk_bf16_f32 v137, v42, v43
  v_cvt_pk_bf16_f32 v138, v44, v45
  v_cvt_pk_bf16_f32 v139, v46, v47
  buffer_store_dwordx4 v[136:139], v112, s[32:35], s46 offen offset:1024 sc1
  s_waitcnt lgkmcnt(4)
  v_mfma_f32_16x16x32_bf16 a[64:67], a[224:227], v[160:163], a[64:67]
  v_accvgpr_read_b32 v48, a36
  v_accvgpr_read_b32 v49, a37
  v_accvgpr_read_b32 v50, a38
  v_mfma_f32_16x16x32_bf16 v[104:107], v[4:7], v[136:139], v[104:107]
  v_accvgpr_read_b32 v51, a39
  v_mfma_f32_16x16x32_bf16 a[64:67], a[228:231], v[164:167], a[64:67]
  v_accvgpr_read_b32 v52, a52
  v_accvgpr_read_b32 v53, a53
  v_accvgpr_read_b32 v54, a54
  v_accvgpr_read_b32 v55, a55
  v_mfma_f32_16x16x32_bf16 a[68:71], a[228:231], v[172:175], a[68:71]
  v_mul_f32 v48, v48, v101
  v_mul_f32 v49, v49, v101
  v_mul_f32 v50, v50, v101
  v_mul_f32 v51, v51, v101
  v_mfma_f32_16x16x32_bf16 a[68:71], a[224:227], v[168:171], a[68:71]
  v_mul_f32 v52, v52, v101
  v_mul_f32 v53, v53, v101
  v_mul_f32 v54, v54, v101
  v_mul_f32 v55, v55, v101
  v_mfma_f32_16x16x32_bf16 a[72:75], a[224:227], v[176:179], a[72:75]
  v_cvt_pk_bf16_f32 v140, v48, v49
  v_cvt_pk_bf16_f32 v141, v50, v51
  v_cvt_pk_bf16_f32 v142, v52, v53
  v_cvt_pk_bf16_f32 v143, v54, v55
  v_mfma_f32_16x16x32_bf16 a[72:75], a[228:231], v[180:183], a[72:75]
  buffer_store_dwordx4 v[140:143], v113, s[32:35], s46 offen offset:1024 sc1
  v_accvgpr_read_b32 v56, a40
  v_accvgpr_read_b32 v57, a41
  v_accvgpr_read_b32 v58, a42
  v_mfma_f32_16x16x32_bf16 v[104:107], v[4:7], v[140:143], v[104:107]
L_pad_post11_0:
  s_cbranch_execz L_pad_post11_1
  v_mfma_f32_16x16x32_bf16 a[76:79], a[228:231], v[188:191], a[76:79]
  v_accvgpr_read_b32 v59, a43
  v_accvgpr_read_b32 v60, a56
  v_accvgpr_read_b32 v61, a57
  v_accvgpr_read_b32 v62, a58
  v_mfma_f32_16x16x32_bf16 a[76:79], a[224:227], v[184:187], a[76:79]
  s_waitcnt lgkmcnt(0)
  v_accvgpr_read_b32 v63, a59
  v_mul_f32 v56, v56, v102
  v_mul_f32 v57, v57, v102
  v_mul_f32 v58, v58, v102
  v_mfma_f32_16x16x32_bf16 a[92:95], a[232:235], v[184:187], a[92:95]
  v_mul_f32 v59, v59, v102
  v_mul_f32 v60, v60, v102
  v_mul_f32 v61, v61, v102
  v_mul_f32 v62, v62, v102
  v_mfma_f32_16x16x32_bf16 a[92:95], a[236:239], v[188:191], a[92:95]
  ds_read_b64_tr_b16 a[240:241], v86 offset:0
  v_mul_f32 v63, v63, v102
  v_cvt_pk_bf16_f32 v56, v56, v57
  v_cvt_pk_bf16_f32 v57, v58, v59
  v_cvt_pk_bf16_f32 v58, v60, v61
  v_mfma_f32_16x16x32_bf16 a[88:91], a[236:239], v[180:183], a[88:91]
  v_cvt_pk_bf16_f32 v59, v62, v63
  buffer_store_dwordx4 v[56:59], v95, s[32:35], s46 offen offset:1024 sc1
  v_accvgpr_read_b32 v64, a44
  v_accvgpr_read_b32 v65, a45
  v_accvgpr_read_b32 v66, a46
  v_mfma_f32_16x16x32_bf16 a[88:91], a[232:235], v[176:179], a[88:91]
  ds_read_b64_tr_b16 a[242:243], v86 offset:4096
  v_mfma_f32_16x16x32_bf16 v[104:107], v[4:7], v[56:59], v[104:107]
  v_accvgpr_read_b32 v67, a47
  v_accvgpr_read_b32 v68, a60
  v_accvgpr_read_b32 v69, a61
  v_mfma_f32_16x16x32_bf16 a[84:87], a[232:235], v[168:171], a[84:87]
  v_accvgpr_read_b32 v70, a62
  v_accvgpr_read_b32 v71, a63
  v_mul_f32 v64, v64, v103
  v_mul_f32 v65, v65, v103
  v_mfma_f32_16x16x32_bf16 a[84:87], a[236:239], v[172:175], a[84:87]
  ds_read_b64_tr_b16 a[244:245], v86 offset:8192
  v_mul_f32 v66, v66, v103
  v_mul_f32 v67, v67, v103
  v_mul_f32 v68, v68, v103
  v_mul_f32 v69, v69, v103
  v_mfma_f32_16x16x32_bf16 a[80:83], a[236:239], v[164:167], a[80:83]
  v_mul_f32 v70, v70, v103
  v_mul_f32 v71, v71, v103
  v_cvt_pk_bf16_f32 v64, v64, v65
  v_cvt_pk_bf16_f32 v65, v66, v67
  v_mfma_f32_16x16x32_bf16 a[80:83], a[232:235], v[160:163], a[80:83]
  ds_read_b64_tr_b16 a[246:247], v86 offset:12288
  v_cvt_pk_bf16_f32 v66, v68, v69
  v_cvt_pk_bf16_f32 v67, v70, v71
  buffer_store_dwordx4 v[64:67], v115, s[32:35], s46 offen offset:1024 sc1
  s_nop 0
  v_mfma_f32_16x16x32_bf16 v[104:107], v[4:7], v[64:67], v[104:107]
  ds_read_b64_tr_b16 a[248:249], v87 offset:0
  ds_read_b64_tr_b16 a[250:251], v87 offset:4096
  ds_read_b64_tr_b16 a[252:253], v87 offset:8192
  ds_read_b64_tr_b16 a[254:255], v87 offset:12288
  v_accvgpr_read_b32 v40, a64
  v_accvgpr_read_b32 v41, a65
  v_accvgpr_read_b32 v42, a66
  v_accvgpr_read_b32 v43, a67
  v_accvgpr_read_b32 v44, a80
  v_accvgpr_read_b32 v45, a81
  v_accvgpr_read_b32 v46, a82
  v_accvgpr_read_b32 v47, a83
  v_mul_f32 v40, v40, v100
  v_mul_f32 v41, v41, v100
  v_mul_f32 v42, v42, v100
  v_mul_f32 v43, v43, v100
  v_mul_f32 v44, v44, v100
  v_mul_f32 v45, v45, v100
  v_mul_f32 v46, v46, v100
  v_mul_f32 v47, v47, v100
  v_cvt_pk_bf16_f32 v144, v40, v41
  v_cvt_pk_bf16_f32 v145, v42, v43
  v_cvt_pk_bf16_f32 v146, v44, v45
  v_cvt_pk_bf16_f32 v147, v46, v47
  buffer_store_dwordx4 v[144:147], v112, s[32:35], s82 offen offset:0 sc1
  s_waitcnt lgkmcnt(4)
  v_mfma_f32_16x16x32_bf16 a[96:99], a[240:243], v[160:163], a[96:99]
  v_accvgpr_read_b32 v48, a68
  v_accvgpr_read_b32 v49, a69
  v_accvgpr_read_b32 v50, a70
  v_mfma_f32_16x16x32_bf16 v[104:107], v[4:7], v[144:147], v[104:107]
  v_accvgpr_read_b32 v51, a71
  v_mfma_f32_16x16x32_bf16 a[96:99], a[244:247], v[164:167], a[96:99]
  v_accvgpr_read_b32 v52, a84
  v_accvgpr_read_b32 v53, a85
  v_accvgpr_read_b32 v54, a86
  v_accvgpr_read_b32 v55, a87
  v_mfma_f32_16x16x32_bf16 a[100:103], a[244:247], v[172:175], a[100:103]
  v_mul_f32 v48, v48, v101
  v_mul_f32 v49, v49, v101
  v_mul_f32 v50, v50, v101
  v_mul_f32 v51, v51, v101
  v_mfma_f32_16x16x32_bf16 a[100:103], a[240:243], v[168:171], a[100:103]
  v_mul_f32 v52, v52, v101
  v_mul_f32 v53, v53, v101
  v_mul_f32 v54, v54, v101
  v_mul_f32 v55, v55, v101
  v_mfma_f32_16x16x32_bf16 a[104:107], a[240:243], v[176:179], a[104:107]
  v_cvt_pk_bf16_f32 v148, v48, v49
  v_cvt_pk_bf16_f32 v149, v50, v51
  v_cvt_pk_bf16_f32 v150, v52, v53
  v_cvt_pk_bf16_f32 v151, v54, v55
  v_mfma_f32_16x16x32_bf16 a[104:107], a[244:247], v[180:183], a[104:107]
  buffer_store_dwordx4 v[148:151], v113, s[32:35], s82 offen offset:0 sc1
  v_accvgpr_read_b32 v56, a72
  v_accvgpr_read_b32 v57, a73
  v_accvgpr_read_b32 v58, a74
  v_mfma_f32_16x16x32_bf16 a[108:111], a[244:247], v[188:191], a[108:111]
  v_mfma_f32_16x16x32_bf16 v[104:107], v[4:7], v[148:151], v[104:107]
  v_accvgpr_read_b32 v59, a75
  v_accvgpr_read_b32 v60, a88
  v_accvgpr_read_b32 v61, a89
  v_mfma_f32_16x16x32_bf16 a[108:111], a[240:243], v[184:187], a[108:111]
  s_waitcnt lgkmcnt(0)
  v_accvgpr_read_b32 v62, a90
  v_accvgpr_read_b32 v63, a91
  v_mul_f32 v56, v56, v102
  v_mul_f32 v57, v57, v102
  v_mfma_f32_16x16x32_bf16 a[124:127], a[248:251], v[184:187], a[124:127]
  v_mul_f32 v58, v58, v102
  v_mul_f32 v59, v59, v102
  v_mul_f32 v60, v60, v102
  v_mul_f32 v61, v61, v102
  v_mfma_f32_16x16x32_bf16 a[124:127], a[252:255], v[188:191], a[124:127]
  v_mul_f32 v62, v62, v102
  v_mul_f32 v63, v63, v102
  v_cvt_pk_bf16_f32 v56, v56, v57
  v_cvt_pk_bf16_f32 v57, v58, v59
  v_mfma_f32_16x16x32_bf16 a[120:123], a[252:255], v[180:183], a[120:123]
  v_cvt_pk_bf16_f32 v58, v60, v61
  v_cvt_pk_bf16_f32 v59, v62, v63
  v_accvgpr_read_b32 v64, a76
  v_accvgpr_read_b32 v65, a77
  v_mfma_f32_16x16x32_bf16 a[120:123], a[248:251], v[176:179], a[120:123]
  v_accvgpr_read_b32 v66, a78
  v_mfma_f32_16x16x32_bf16 v[104:107], v[4:7], v[56:59], v[104:107]
  v_accvgpr_read_b32 v67, a79
  v_accvgpr_read_b32 v68, a92
  v_mfma_f32_16x16x32_bf16 a[116:119], a[248:251], v[168:171], a[116:119]
  v_accvgpr_read_b32 v69, a93
  v_accvgpr_read_b32 v70, a94
  v_accvgpr_read_b32 v71, a95
  v_mul_f32 v64, v64, v103
  v_mfma_f32_16x16x32_bf16 a[116:119], a[252:255], v[172:175], a[116:119]
  v_mul_f32 v65, v65, v103
  v_mul_f32 v66, v66, v103
  v_mul_f32 v67, v67, v103
  v_mul_f32 v68, v68, v103
  v_mfma_f32_16x16x32_bf16 a[112:115], a[252:255], v[164:167], a[112:115]
  v_mul_f32 v69, v69, v103
  v_mul_f32 v70, v70, v103
  v_mul_f32 v71, v71, v103
  v_cvt_pk_bf16_f32 v64, v64, v65
  v_mfma_f32_16x16x32_bf16 a[112:115], a[248:251], v[160:163], a[112:115]
  v_cvt_pk_bf16_f32 v65, v66, v67
  v_cvt_pk_bf16_f32 v66, v68, v69
  v_cvt_pk_bf16_f32 v67, v70, v71
  s_nop 1
  v_mfma_f32_16x16x32_bf16 v[104:107], v[4:7], v[64:67], v[104:107]
  s_waitcnt vmcnt(38)
  s_waitcnt lgkmcnt(0)
  s_barrier
  ds_read_b128 a[192:195], v121 offset:20480
  ds_read_b128 a[196:199], v121 offset:30720
  ds_read_b128 a[200:203], v121 offset:21504
  ds_read_b128 a[204:207], v121 offset:31744
  ds_read_b128 a[208:211], v121 offset:22528
  ds_read_b128 a[212:215], v121 offset:32768
  ds_read_b128 a[216:219], v121 offset:23552
  ds_read_b128 a[220:223], v121 offset:33792
  s_waitcnt lgkmcnt(4)
  v_mfma_f32_16x16x32_bf16 a[0:3], a[192:195], a[128:131], 0
  ds_read_b128 a[224:227], v121 offset:24576
  v_accvgpr_read_b32 v160, a96
  v_accvgpr_read_b32 v161, a97
  v_mfma_f32_16x16x32_bf16 a[0:3], a[196:199], a[132:135], a[0:3]
  v_accvgpr_read_b32 v162, a98
  v_accvgpr_read_b32 v163, a99
  v_accvgpr_read_b32 v164, a112
  v_mfma_f32_16x16x32_bf16 a[4:7], a[196:199], a[140:143], 0
  ds_read_b128 a[228:231], v121 offset:34816
  v_accvgpr_read_b32 v165, a113
  v_accvgpr_read_b32 v166, a114
  v_mfma_f32_16x16x32_bf16 a[4:7], a[192:195], a[136:139], a[4:7]
  buffer_store_dwordx4 v[56:59], v95, s[32:35], s82 offen offset:0 sc1
  v_mfma_f32_16x16x32_bf16 a[12:15], a[200:203], a[136:139], 0
  ds_read_b128 a[232:235], v121 offset:25600
  v_accvgpr_read_b32 v167, a115
  v_mul_f32 v160, v160, v100
  v_mfma_f32_16x16x32_bf16 a[12:15], a[204:207], a[140:143], a[12:15]
  v_mul_f32 v161, v161, v100
  v_mul_f32 v162, v162, v100
  v_mul_f32 v163, v163, v100
  v_mfma_f32_16x16x32_bf16 a[8:11], a[204:207], a[132:135], 0
  ds_read_b128 a[236:239], v121 offset:35840
  v_mul_f32 v164, v164, v100
  v_mul_f32 v165, v165, v100
  v_mfma_f32_16x16x32_bf16 a[8:11], a[200:203], a[128:131], a[8:11]
  s_waitcnt lgkmcnt(4)
  buffer_store_dwordx4 v[64:67], v115, s[32:35], s82 offen offset:0 sc1
  v_mfma_f32_16x16x32_bf16 a[16:19], a[208:211], a[128:131], 0
  ds_read_b128 a[240:243], v121 offset:26624
  v_mul_f32 v166, v166, v100
  v_mul_f32 v167, v167, v100
  v_mfma_f32_16x16x32_bf16 a[16:19], a[212:215], a[132:135], a[16:19]
  v_cvt_pk_bf16_f32 v152, v160, v161
  v_cvt_pk_bf16_f32 v153, v162, v163
  v_cvt_pk_bf16_f32 v154, v164, v165
  v_mfma_f32_16x16x32_bf16 a[20:23], a[212:215], a[140:143], 0
  ds_read_b128 a[244:247], v121 offset:36864
  v_cvt_pk_bf16_f32 v155, v166, v167
  v_mfma_f32_16x16x32_bf16 a[20:23], a[208:211], a[136:139], a[20:23]
  v_mfma_f32_16x16x32_bf16 a[28:31], a[216:219], a[136:139], 0
  ds_read_b128 a[248:251], v121 offset:27648
  v_accvgpr_read_b32 v168, a100
  v_accvgpr_read_b32 v169, a101
  v_mfma_f32_16x16x32_bf16 a[28:31], a[220:223], a[140:143], a[28:31]
  v_accvgpr_read_b32 v170, a102
  v_mfma_f32_16x16x32_bf16 v[104:107], v[4:7], v[152:155], v[104:107]
  v_accvgpr_read_b32 v171, a103
  v_mfma_f32_16x16x32_bf16 a[24:27], a[220:223], a[132:135], 0
  ds_read_b128 a[252:255], v121 offset:37888
  v_accvgpr_read_b32 v172, a116
  v_accvgpr_read_b32 v173, a117
  v_mfma_f32_16x16x32_bf16 a[24:27], a[216:219], a[128:131], a[24:27]
  s_waitcnt lgkmcnt(4)
  v_mfma_f32_16x16x32_bf16 a[32:35], a[224:227], a[128:131], 0
  ds_read_b128 a[192:195], v121 offset:28672
  v_accvgpr_read_b32 v174, a118
  v_accvgpr_read_b32 v175, a119
  v_mfma_f32_16x16x32_bf16 a[32:35], a[228:231], a[132:135], a[32:35]
  v_mul_f32 v168, v168, v101
  v_mul_f32 v169, v169, v101
  v_mul_f32 v170, v170, v101
  v_mfma_f32_16x16x32_bf16 a[36:39], a[228:231], a[140:143], 0
  s_add_u32 s41, s41, 262144
  ds_read_b128 a[196:199], v121 offset:38912
  v_mul_f32 v171, v171, v101
  v_mul_f32 v172, v172, v101
  v_mfma_f32_16x16x32_bf16 a[36:39], a[224:227], a[136:139], a[36:39]
  buffer_load_dwordx4 a[80:83], v112, s[36:39], s41 offen offset:0 sc1
  v_mfma_f32_16x16x32_bf16 a[44:47], a[232:235], a[136:139], 0
  ds_read_b128 a[200:203], v121 offset:29696
  v_mul_f32 v173, v173, v101
  v_mul_f32 v174, v174, v101
  v_mfma_f32_16x16x32_bf16 a[44:47], a[236:239], a[140:143], a[44:47]
  v_mul_f32 v175, v175, v101
  v_cvt_pk_bf16_f32 v156, v168, v169
  v_cvt_pk_bf16_f32 v157, v170, v171
  v_mfma_f32_16x16x32_bf16 a[40:43], a[236:239], a[132:135], 0
  ds_read_b128 a[204:207], v121 offset:39936
  v_cvt_pk_bf16_f32 v158, v172, v173
  v_cvt_pk_bf16_f32 v159, v174, v175
  v_mfma_f32_16x16x32_bf16 a[40:43], a[232:235], a[128:131], a[40:43]
  s_waitcnt lgkmcnt(4)
  buffer_load_dwordx4 a[84:87], v112, s[36:39], s41 offen offset:1024 sc1
  v_mfma_f32_16x16x32_bf16 a[48:51], a[240:243], a[128:131], 0
  ds_read_b128 a[208:211], v119 offset:0
  v_accvgpr_read_b32 v176, a104
  v_accvgpr_read_b32 v177, a105
  v_mfma_f32_16x16x32_bf16 a[48:51], a[244:247], a[132:135], a[48:51]
  v_accvgpr_read_b32 v178, a106
  v_mfma_f32_16x16x32_bf16 v[104:107], v[4:7], v[156:159], v[104:107]
  v_accvgpr_read_b32 v179, a107
  v_mfma_f32_16x16x32_bf16 a[52:55], a[244:247], a[140:143], 0
  ds_read_b128 a[212:215], v119 offset:10240
  v_accvgpr_read_b32 v180, a120
  v_accvgpr_read_b32 v181, a121
  v_mfma_f32_16x16x32_bf16 a[52:55], a[240:243], a[136:139], a[52:55]
  buffer_load_dwordx4 a[88:91], v113, s[36:39], s41 offen offset:0 sc1
  v_mfma_f32_16x16x32_bf16 a[60:63], a[248:251], a[136:139], 0
  ds_read_b128 a[216:219], v119 offset:1024
  v_accvgpr_read_b32 v182, a122
  v_accvgpr_read_b32 v183, a123
  v_mfma_f32_16x16x32_bf16 a[60:63], a[252:255], a[140:143], a[60:63]
  v_mul_f32 v176, v176, v102
  v_mul_f32 v177, v177, v102
  v_mul_f32 v178, v178, v102
  v_mfma_f32_16x16x32_bf16 a[56:59], a[252:255], a[132:135], 0
  ds_read_b128 a[220:223], v119 offset:11264
  v_mul_f32 v179, v179, v102
  v_mul_f32 v180, v180, v102
  v_mfma_f32_16x16x32_bf16 a[56:59], a[248:251], a[128:131], a[56:59]
  s_waitcnt lgkmcnt(4)
  buffer_load_dwordx4 a[92:95], v113, s[36:39], s41 offen offset:1024 sc1
  v_mfma_f32_16x16x32_bf16 a[64:67], a[192:195], a[128:131], 0
  ds_read_b128 a[224:227], v119 offset:2048
  v_mul_f32 v181, v181, v102
  v_mul_f32 v182, v182, v102
  v_mfma_f32_16x16x32_bf16 a[64:67], a[196:199], a[132:135], a[64:67]
  v_mul_f32 v183, v183, v102
  v_cvt_pk_bf16_f32 v176, v176, v177
  v_cvt_pk_bf16_f32 v177, v178, v179
  v_mfma_f32_16x16x32_bf16 a[68:71], a[196:199], a[140:143], 0
  ds_read_b128 a[228:231], v119 offset:12288
  v_cvt_pk_bf16_f32 v178, v180, v181
  v_cvt_pk_bf16_f32 v179, v182, v183
  v_mfma_f32_16x16x32_bf16 a[68:71], a[192:195], a[136:139], a[68:71]
  buffer_store_dwordx4 v[152:155], v112, s[32:35], s82 offen offset:1024 sc1
  v_mfma_f32_16x16x32_bf16 a[76:79], a[200:203], a[136:139], 0
  ds_read_b128 a[232:235], v119 offset:3072
  v_accvgpr_read_b32 v184, a108
  v_accvgpr_read_b32 v185, a109
  v_mfma_f32_16x16x32_bf16 a[76:79], a[204:207], a[140:143], a[76:79]
  v_accvgpr_read_b32 v186, a110
  v_mfma_f32_16x16x32_bf16 v[104:107], v[4:7], v[176:179], v[104:107]
  v_accvgpr_read_b32 v187, a111
  v_mfma_f32_16x16x32_bf16 a[72:75], a[204:207], a[132:135], 0
  ds_read_b128 a[236:239], v119 offset:13312
  v_accvgpr_read_b32 v188, a124
  v_accvgpr_read_b32 v189, a125
  v_mfma_f32_16x16x32_bf16 a[72:75], a[200:203], a[128:131], a[72:75]
  s_waitcnt lgkmcnt(4)
  v_mfma_f32_16x16x32_bf16 a[0:3], a[208:211], a[144:147], a[0:3]
  ds_read_b128 a[240:243], v119 offset:4096
  v_accvgpr_read_b32 v190, a126
  v_accvgpr_read_b32 v191, a127
  v_mfma_f32_16x16x32_bf16 a[0:3], a[212:215], a[148:151], a[0:3]
  v_mul_f32 v184, v184, v103
  v_mul_f32 v185, v185, v103
  v_mul_f32 v186, v186, v103
  v_mfma_f32_16x16x32_bf16 a[4:7], a[212:215], a[156:159], a[4:7]
  ds_read_b128 a[244:247], v119 offset:14336
  v_mul_f32 v187, v187, v103
  v_mul_f32 v188, v188, v103
  v_mfma_f32_16x16x32_bf16 a[4:7], a[208:211], a[152:155], a[4:7]
  v_mfma_f32_16x16x32_bf16 a[12:15], a[216:219], a[152:155], a[12:15]
  ds_read_b128 a[248:251], v119 offset:5120
  v_mul_f32 v189, v189, v103
  v_mul_f32 v190, v190, v103
  v_mfma_f32_16x16x32_bf16 a[12:15], a[220:223], a[156:159], a[12:15]
  v_mul_f32 v191, v191, v103
  v_cvt_pk_bf16_f32 v184, v184, v185
  v_cvt_pk_bf16_f32 v185, v186, v187
  v_mfma_f32_16x16x32_bf16 a[8:11], a[220:223], a[148:151], a[8:11]
  ds_read_b128 a[252:255], v119 offset:15360
  v_cvt_pk_bf16_f32 v186, v188, v189
  v_cvt_pk_bf16_f32 v187, v190, v191
  v_mfma_f32_16x16x32_bf16 a[8:11], a[216:219], a[144:147], a[8:11]
  s_waitcnt lgkmcnt(4)
  v_mfma_f32_16x16x32_bf16 a[16:19], a[224:227], a[144:147], a[16:19]
  ds_read_b128 a[192:195], v119 offset:6144
  v_mfma_f32_16x16x32_bf16 v[104:107], v[4:7], v[184:187], v[104:107]
  v_mfma_f32_16x16x32_bf16 a[16:19], a[228:231], a[148:151], a[16:19]
  v_mfma_f32_16x16x32_bf16 a[20:23], a[228:231], a[156:159], a[20:23]
  ds_read_b128 a[196:199], v119 offset:16384
  v_mfma_f32_16x16x32_bf16 a[20:23], a[224:227], a[152:155], a[20:23]
  buffer_store_dwordx4 v[156:159], v113, s[32:35], s82 offen offset:1024 sc1
  v_mfma_f32_16x16x32_bf16 a[28:31], a[232:235], a[152:155], a[28:31]
  ds_read_b128 a[200:203], v119 offset:7168
  v_mfma_f32_16x16x32_bf16 a[28:31], a[236:239], a[156:159], a[28:31]
  v_mfma_f32_16x16x32_bf16 a[24:27], a[236:239], a[148:151], a[24:27]
  ds_read_b128 a[204:207], v119 offset:17408
  v_add_f32 v96, v72, v73
  v_mfma_f32_16x16x32_bf16 a[24:27], a[232:235], a[144:147], a[24:27]
  s_waitcnt lgkmcnt(4)
  v_mfma_f32_16x16x32_bf16 a[32:35], a[240:243], a[144:147], a[32:35]
  ds_read_b128 a[208:211], v119 offset:8192
  v_add_f32 v97, v74, v75
  v_mfma_f32_16x16x32_bf16 a[32:35], a[244:247], a[148:151], a[32:35]
  v_mfma_f32_16x16x32_bf16 a[36:39], a[244:247], a[156:159], a[36:39]
  ds_read_b128 a[212:215], v119 offset:18432
  v_add_f32 v96, v96, v106
  v_mfma_f32_16x16x32_bf16 a[36:39], a[240:243], a[152:155], a[36:39]
  v_mfma_f32_16x16x32_bf16 a[44:47], a[248:251], a[152:155], a[44:47]
  ds_read_b128 a[216:219], v119 offset:9216
  v_add_f32 v96, v96, v97
  v_mfma_f32_16x16x32_bf16 a[44:47], a[252:255], a[156:159], a[44:47]
  v_mfma_f32_16x16x32_bf16 a[40:43], a[252:255], a[148:151], a[40:43]
  ds_read_b128 a[220:223], v119 offset:19456
  v_cmp_ngt_f32 vcc, 0x53800000, v96
  v_mfma_f32_16x16x32_bf16 a[40:43], a[248:251], a[144:147], a[40:43]
  s_waitcnt lgkmcnt(4)
  v_mfma_f32_16x16x32_bf16 a[48:51], a[192:195], a[144:147], a[48:51]
  v_and_b32 v97, 3, v1
  v_mfma_f32_16x16x32_bf16 a[48:51], a[196:199], a[148:151], a[48:51]
  buffer_store_dwordx4 v[176:179], v95, s[32:35], s82 offen offset:1024 sc1
  v_mfma_f32_16x16x32_bf16 a[52:55], a[196:199], a[156:159], a[52:55]
  v_mul_u32_u24 v97, 5120, v97
  v_mfma_f32_16x16x32_bf16 a[52:55], a[192:195], a[152:155], a[52:55]
  s_waitcnt vmcnt(37)
  s_waitcnt lgkmcnt(0)
  s_barrier
  v_mfma_f32_16x16x32_bf16 a[60:63], a[200:203], a[152:155], a[60:63]
  ds_read_b128 a[224:227], v119 offset:20480
  s_and_b32 s47, vcc_lo, s58
  s_cselect_b32 s59, 0, 1
  v_mov_b32 v118, s59
  v_mfma_f32_16x16x32_bf16 a[60:63], a[204:207], a[156:159], a[60:63]
  ds_read_b128 a[228:231], v119 offset:30720
  v_mfma_f32_16x16x32_bf16 a[56:59], a[204:207], a[148:151], a[56:59]
  ds_read_b128 a[232:235], v119 offset:21504
  v_lshl_add_u32 v97, s43, 2, v97
  v_mfma_f32_16x16x32_bf16 a[56:59], a[200:203], a[144:147], a[56:59]
  ds_read_b128 a[236:239], v119 offset:31744
  v_mfma_f32_16x16x32_bf16 a[64:67], a[208:211], a[144:147], a[64:67]
  ds_read_b128 a[240:243], v119 offset:22528
  v_mov_b32 v96, s47
  v_mfma_f32_16x16x32_bf16 a[64:67], a[212:215], a[148:151], a[64:67]
  v_mfma_f32_16x16x32_bf16 a[68:71], a[212:215], a[156:159], a[68:71]
  ds_read_b128 a[244:247], v119 offset:32768
  v_add_u32 v97, 122880, v97
  v_mfma_f32_16x16x32_bf16 a[68:71], a[208:211], a[152:155], a[68:71]
  v_mfma_f32_16x16x32_bf16 a[76:79], a[216:219], a[152:155], a[76:79]
  ds_read_b128 a[248:251], v119 offset:23552
  v_mov_b32 v98, s42
  v_mfma_f32_16x16x32_bf16 a[76:79], a[220:223], a[156:159], a[76:79]
  s_waitcnt vmcnt(33)
  v_mfma_f32_16x16x32_bf16 a[72:75], a[220:223], a[148:151], a[72:75]
  ds_read_b128 a[252:255], v119 offset:33792
  v_add_u32 v98, 122880, v98
  v_mfma_f32_16x16x32_bf16 a[72:75], a[216:219], a[144:147], a[72:75]
  s_waitcnt lgkmcnt(4)
  v_mfma_f32_16x16x32_bf16 a[0:3], a[224:227], a[160:163], a[0:3]
  ds_read_b128 a[192:195], v119 offset:24576
  v_mfma_f32_16x16x32_bf16 a[0:3], a[228:231], a[164:167], a[0:3]
  ds_write_b32 v97, v96 offset:20480
  v_mfma_f32_16x16x32_bf16 a[4:7], a[228:231], a[172:175], a[4:7]
  ds_read_b128 a[196:199], v119 offset:34816
  v_mfma_f32_16x16x32_bf16 a[4:7], a[224:227], a[168:171], a[4:7]
  buffer_store_dwordx4 v[184:187], v115, s[32:35], s82 offen offset:1024 sc1
  v_mfma_f32_16x16x32_bf16 a[12:15], a[232:235], a[168:171], a[12:15]
  ds_read_b128 a[200:203], v119 offset:25600
  v_mfma_f32_16x16x32_bf16 a[12:15], a[236:239], a[172:175], a[12:15]
  v_mfma_f32_16x16x32_bf16 a[8:11], a[236:239], a[164:167], a[8:11]
  ds_read_b128 a[204:207], v119 offset:35840
  v_mfma_f32_16x16x32_bf16 a[8:11], a[232:235], a[160:163], a[8:11]
  s_waitcnt lgkmcnt(5)
  v_mfma_f32_16x16x32_bf16 a[16:19], a[240:243], a[160:163], a[16:19]
  ds_read_b128 a[208:211], v119 offset:26624
  v_mfma_f32_16x16x32_bf16 a[16:19], a[244:247], a[164:167], a[16:19]
  v_mfma_f32_16x16x32_bf16 a[20:23], a[244:247], a[172:175], a[20:23]
  ds_read_b128 a[212:215], v119 offset:36864
  v_mfma_f32_16x16x32_bf16 a[20:23], a[240:243], a[168:171], a[20:23]
  v_mfma_f32_16x16x32_bf16 a[28:31], a[248:251], a[168:171], a[28:31]
  ds_read_b128 a[216:219], v119 offset:27648
  v_mfma_f32_16x16x32_bf16 a[28:31], a[252:255], a[172:175], a[28:31]
  v_mfma_f32_16x16x32_bf16 a[24:27], a[252:255], a[164:167], a[24:27]
  s_add_u32 s41, s41, 262144
  ds_read_b128 a[220:223], v119 offset:37888
  v_mfma_f32_16x16x32_bf16 a[24:27], a[248:251], a[160:163], a[24:27]
  s_waitcnt lgkmcnt(4)
  buffer_load_dwordx4 a[96:99], v112, s[36:39], s41 offen offset:0 sc1
  v_mfma_f32_16x16x32_bf16 a[32:35], a[192:195], a[160:163], a[32:35]
  ds_read_b128 a[224:227], v119 offset:28672
  v_mfma_f32_16x16x32_bf16 a[32:35], a[196:199], a[164:167], a[32:35]
  v_mfma_f32_16x16x32_bf16 a[36:39], a[196:199], a[172:175], a[36:39]
  ds_read_b128 a[228:231], v119 offset:38912
  v_mfma_f32_16x16x32_bf16 a[36:39], a[192:195], a[168:171], a[36:39]
  v_mfma_f32_16x16x32_bf16 a[44:47], a[200:203], a[168:171], a[44:47]
  ds_read_b128 a[232:235], v119 offset:29696
  v_mfma_f32_16x16x32_bf16 a[44:47], a[204:207], a[172:175], a[44:47]
  buffer_load_dwordx4 a[100:103], v112, s[36:39], s41 offen offset:1024 sc1
  v_mfma_f32_16x16x32_bf16 a[40:43], a[204:207], a[164:167], a[40:43]
  ds_read_b128 a[236:239], v119 offset:39936
  v_mfma_f32_16x16x32_bf16 a[40:43], a[200:203], a[160:163], a[40:43]
  s_waitcnt lgkmcnt(4)
  v_mfma_f32_16x16x32_bf16 a[48:51], a[208:211], a[160:163], a[48:51]
  ds_read_b128 a[240:243], v121 offset:0
  v_mfma_f32_16x16x32_bf16 a[48:51], a[212:215], a[164:167], a[48:51]
  buffer_load_dwordx4 a[104:107], v113, s[36:39], s41 offen offset:0 sc1
  v_mfma_f32_16x16x32_bf16 a[52:55], a[212:215], a[172:175], a[52:55]
  s_waitcnt vmcnt(3)
  ds_read_b128 a[244:247], v121 offset:10240
  v_mfma_f32_16x16x32_bf16 a[52:55], a[208:211], a[168:171], a[52:55]
  buffer_store_dword v118, v125, s[32:35], s96 offen offset:0 sc1
  v_mfma_f32_16x16x32_bf16 a[60:63], a[216:219], a[168:171], a[60:63]
  ds_read_b128 a[248:251], v121 offset:1024
  v_mfma_f32_16x16x32_bf16 a[60:63], a[220:223], a[172:175], a[60:63]
  buffer_load_dwordx4 a[108:111], v113, s[36:39], s41 offen offset:1024 sc1
  v_mfma_f32_16x16x32_bf16 a[56:59], a[220:223], a[164:167], a[56:59]
  s_add_u32 m0, s42, 81920
  ds_read_b128 a[252:255], v121 offset:11264
  v_mfma_f32_16x16x32_bf16 a[56:59], a[216:219], a[160:163], a[56:59]
  s_waitcnt lgkmcnt(4)
  v_mfma_f32_16x16x32_bf16 a[64:67], a[224:227], a[160:163], a[64:67]
  s_mov_b32 s40, s29
  ds_read_b128 a[192:195], v121 offset:2048
  v_mfma_f32_16x16x32_bf16 a[64:67], a[228:231], a[164:167], a[64:67]
  buffer_load_dwordx4 v3, s[52:55], s40 offen offset:0 sc1 lds
  v_mfma_f32_16x16x32_bf16 a[68:71], a[228:231], a[172:175], a[68:71]
  ds_read_b128 a[196:199], v121 offset:12288
  v_mfma_f32_16x16x32_bf16 a[68:71], a[224:227], a[168:171], a[68:71]
  v_mfma_f32_16x16x32_bf16 a[76:79], a[232:235], a[168:171], a[76:79]
  ds_read_b128 a[200:203], v121 offset:3072
  v_mfma_f32_16x16x32_bf16 a[76:79], a[236:239], a[172:175], a[76:79]
  buffer_load_dwordx4 v3, s[52:55], s40 offen offset:1024 sc1 lds
  v_mfma_f32_16x16x32_bf16 a[72:75], a[236:239], a[164:167], a[72:75]
  ds_read_b128 a[204:207], v121 offset:13312
  v_mfma_f32_16x16x32_bf16 a[72:75], a[232:235], a[160:163], a[72:75]
  s_waitcnt lgkmcnt(4)
  v_mfma_f32_16x16x32_bf16 a[0:3], a[240:243], a[176:179], a[0:3]
  ds_read_b128 a[208:211], v121 offset:4096
  v_mfma_f32_16x16x32_bf16 a[0:3], a[244:247], a[180:183], a[0:3]
  v_mfma_f32_16x16x32_bf16 a[4:7], a[244:247], a[188:191], a[4:7]
  ds_read_b128 a[212:215], v121 offset:14336
  v_mfma_f32_16x16x32_bf16 a[4:7], a[240:243], a[184:187], a[4:7]
  buffer_load_dwordx4 v3, s[52:55], s40 offen offset:2048 sc1 lds
  v_mfma_f32_16x16x32_bf16 a[12:15], a[248:251], a[184:187], a[12:15]
  ds_read_b128 a[216:219], v121 offset:5120
  v_mfma_f32_16x16x32_bf16 a[12:15], a[252:255], a[188:191], a[12:15]
  v_mfma_f32_16x16x32_bf16 a[8:11], a[252:255], a[180:183], a[8:11]
  ds_read_b128 a[220:223], v121 offset:15360
  v_mfma_f32_16x16x32_bf16 a[8:11], a[248:251], a[176:179], a[8:11]
  s_waitcnt lgkmcnt(4)
  buffer_load_dwordx4 v3, s[52:55], s40 offen offset:3072 sc1 lds
  v_mfma_f32_16x16x32_bf16 a[16:19], a[192:195], a[176:179], a[16:19]
  s_add_u32 m0, s42, 86016
  ds_read_b128 a[224:227], v121 offset:6144
  v_mfma_f32_16x16x32_bf16 a[16:19], a[196:199], a[180:183], a[16:19]
  v_mfma_f32_16x16x32_bf16 a[20:23], a[196:199], a[188:191], a[20:23]
  s_add_u32 s40, s40, 4096
  ds_read_b128 a[228:231], v121 offset:16384
  v_mfma_f32_16x16x32_bf16 a[20:23], a[192:195], a[184:187], a[20:23]
  buffer_load_dwordx4 v3, s[52:55], s40 offen offset:0 sc1 lds
  v_mfma_f32_16x16x32_bf16 a[28:31], a[200:203], a[184:187], a[28:31]
  s_add_u32 m0, s42, 61440
  ds_read_b128 a[232:235], v121 offset:7168
  v_mfma_f32_16x16x32_bf16 a[28:31], a[204:207], a[188:191], a[28:31]
  v_mfma_f32_16x16x32_bf16 a[24:27], a[204:207], a[180:183], a[24:27]
  s_add_u32 s40, s40, 77824
  ds_read_b128 a[236:239], v121 offset:17408
  v_mfma_f32_16x16x32_bf16 a[24:27], a[200:203], a[176:179], a[24:27]
  s_waitcnt lgkmcnt(4)
  buffer_load_dwordx4 v3, s[52:55], s40 offen offset:0 sc1 lds
  v_mfma_f32_16x16x32_bf16 a[32:35], a[208:211], a[176:179], a[32:35]
  ds_read_b128 a[240:243], v121 offset:8192
  v_mfma_f32_16x16x32_bf16 a[32:35], a[212:215], a[180:183], a[32:35]
  v_mfma_f32_16x16x32_bf16 a[36:39], a[212:215], a[188:191], a[36:39]
  ds_read_b128 a[244:247], v121 offset:18432
  v_mfma_f32_16x16x32_bf16 a[36:39], a[208:211], a[184:187], a[36:39]
  buffer_load_dwordx4 v3, s[52:55], s40 offen offset:1024 sc1 lds
  v_mfma_f32_16x16x32_bf16 a[44:47], a[216:219], a[184:187], a[44:47]
  ds_read_b128 a[248:251], v121 offset:9216
  v_mfma_f32_16x16x32_bf16 a[44:47], a[220:223], a[188:191], a[44:47]
  v_mfma_f32_16x16x32_bf16 a[40:43], a[220:223], a[180:183], a[40:43]
  ds_read_b128 a[252:255], v121 offset:19456
  v_mfma_f32_16x16x32_bf16 a[40:43], a[216:219], a[176:179], a[40:43]
  s_waitcnt lgkmcnt(4)
  v_mfma_f32_16x16x32_bf16 a[48:51], a[224:227], a[176:179], a[48:51]
  buffer_load_dwordx4 v3, s[52:55], s40 offen offset:2048 sc1 lds
  v_mfma_f32_16x16x32_bf16 a[48:51], a[228:231], a[180:183], a[48:51]
  v_mfma_f32_16x16x32_bf16 a[52:55], a[228:231], a[188:191], a[52:55]
  v_mfma_f32_16x16x32_bf16 a[52:55], a[224:227], a[184:187], a[52:55]
  s_waitcnt lgkmcnt(0)
  s_barrier
  v_mfma_f32_16x16x32_bf16 a[60:63], a[232:235], a[184:187], a[60:63]
  ds_read_b128 a[192:195], v119 offset:40960
  v_mfma_f32_16x16x32_bf16 a[60:63], a[236:239], a[188:191], a[60:63]
  ds_read_b128 a[196:199], v119 offset:51200
  v_mfma_f32_16x16x32_bf16 a[56:59], a[236:239], a[180:183], a[56:59]
  ds_read_b128 a[200:203], v119 offset:41984
  v_mfma_f32_16x16x32_bf16 a[56:59], a[232:235], a[176:179], a[56:59]
  ds_read_b128 a[204:207], v119 offset:52224
  v_mfma_f32_16x16x32_bf16 a[64:67], a[240:243], a[176:179], a[64:67]
  ds_read_b128 a[208:211], v119 offset:43008
  v_mfma_f32_16x16x32_bf16 a[64:67], a[244:247], a[180:183], a[64:67]
  ds_read_b128 v[100:103], v98 offset:20480
  v_mfma_f32_16x16x32_bf16 a[68:71], a[244:247], a[188:191], a[68:71]
  ds_read_b128 a[212:215], v119 offset:53248
  v_mfma_f32_16x16x32_bf16 a[68:71], a[240:243], a[184:187], a[68:71]
  buffer_load_dwordx4 v3, s[52:55], s40 offen offset:3072 sc1 lds
  v_mfma_f32_16x16x32_bf16 a[76:79], a[248:251], a[184:187], a[76:79]
  s_add_u32 m0, s42, 65536
  s_add_u32 s40, s40, 4096
  ds_read_b128 a[216:219], v119 offset:44032
  v_mfma_f32_16x16x32_bf16 a[76:79], a[252:255], a[188:191], a[76:79]
  buffer_load_dwordx4 v3, s[52:55], s40 offen offset:0 sc1 lds
  v_mfma_f32_16x16x32_bf16 a[72:75], a[252:255], a[180:183], a[72:75]
L_pad_post12_0:
  s_cbranch_execz L_pad_post12_1
  ds_read_b128 a[220:223], v119 offset:54272
  v_mfma_f32_16x16x32_bf16 a[72:75], a[248:251], a[176:179], a[72:75]
  s_waitcnt lgkmcnt(3)
  v_mfma_f32_16x16x32_bf16 a[0:3], a[192:195], a[80:83], a[0:3]
  ds_read_b128 a[224:227], v119 offset:45056
  v_or3_b32 v100, v100, v101, v102
  v_mfma_f32_16x16x32_bf16 a[0:3], a[196:199], a[84:87], a[0:3]
  v_or_b32 v100, v100, v103
  v_cmp_ne_u32 vcc, 0, v100
  v_mfma_f32_16x16x32_bf16 a[4:7], a[196:199], a[92:95], a[4:7]
  ds_read_b128 a[228:231], v119 offset:55296
  v_mfma_f32_16x16x32_bf16 a[4:7], a[192:195], a[88:91], a[4:7]
  s_cbranch_vccnz L_slow
  v_mfma_f32_16x16x32_bf16 a[12:15], a[200:203], a[88:91], a[12:15]
  s_add_u32 m0, s42, 143360
  s_bfe_u32 s40, s78, 262144
  s_mul_i32 s40, s40, 81920
  s_add_u32 s40, s40, s84
  ds_read_b128 a[232:235], v119 offset:46080
  v_mfma_f32_16x16x32_bf16 a[12:15], a[204:207], a[92:95], a[12:15]
  buffer_load_dwordx4 v3, s[52:55], s40 offen offset:0 sc1 lds
  v_mfma_f32_16x16x32_bf16 a[8:11], a[204:207], a[84:87], a[8:11]
  ds_read_b128 a[236:239], v119 offset:56320
  v_mfma_f32_16x16x32_bf16 a[8:11], a[200:203], a[80:83], a[8:11]
  s_waitcnt lgkmcnt(4)
  buffer_load_dwordx4 v3, s[52:55], s40 offen offset:1024 sc1 lds
  v_mfma_f32_16x16x32_bf16 a[16:19], a[208:211], a[80:83], a[16:19]
  ds_read_b128 a[240:243], v119 offset:47104
  v_mfma_f32_16x16x32_bf16 a[16:19], a[212:215], a[84:87], a[16:19]
  buffer_load_dwordx4 v3, s[52:55], s40 offen offset:2048 sc1 lds
  v_mfma_f32_16x16x32_bf16 a[20:23], a[212:215], a[92:95], a[20:23]
  ds_read_b128 a[244:247], v119 offset:57344
  v_mfma_f32_16x16x32_bf16 a[20:23], a[208:211], a[88:91], a[20:23]
  buffer_load_dwordx4 v3, s[52:55], s40 offen offset:3072 sc1 lds
  v_mfma_f32_16x16x32_bf16 a[28:31], a[216:219], a[88:91], a[28:31]
  s_add_u32 m0, s42, 147456
  ds_read_b128 a[248:251], v119 offset:48128
  v_mfma_f32_16x16x32_bf16 a[28:31], a[220:223], a[92:95], a[28:31]
  v_mfma_f32_16x16x32_bf16 a[24:27], a[220:223], a[84:87], a[24:27]
  s_add_u32 s40, s40, 4096
  ds_read_b128 a[252:255], v119 offset:58368
  v_mfma_f32_16x16x32_bf16 a[24:27], a[216:219], a[80:83], a[24:27]
  s_waitcnt lgkmcnt(4)
  buffer_load_dwordx4 v3, s[52:55], s40 offen offset:0 sc1 lds
  v_mfma_f32_16x16x32_bf16 a[32:35], a[224:227], a[80:83], a[32:35]
  s_add_u32 m0, s42, 0
  ds_read_b128 a[192:195], v119 offset:49152
  v_mfma_f32_16x16x32_bf16 a[32:35], a[228:231], a[84:87], a[32:35]
  v_mfma_f32_16x16x32_bf16 a[36:39], a[228:231], a[92:95], a[36:39]
  s_bfe_u32 s40, s78, 262148
  s_mul_i32 s40, s40, 81920
  s_add_u32 s40, s40, s84
  ds_read_b128 a[196:199], v119 offset:59392
  v_mfma_f32_16x16x32_bf16 a[36:39], a[224:227], a[88:91], a[36:39]
  buffer_load_dwordx4 v3, s[52:55], s40 offen offset:0 sc1 lds
  v_mfma_f32_16x16x32_bf16 a[44:47], a[232:235], a[88:91], a[44:47]
  ds_read_b128 a[200:203], v119 offset:50176
  v_mfma_f32_16x16x32_bf16 a[44:47], a[236:239], a[92:95], a[44:47]
  v_mfma_f32_16x16x32_bf16 a[40:43], a[236:239], a[84:87], a[40:43]
  ds_read_b128 a[204:207], v119 offset:60416
  v_mfma_f32_16x16x32_bf16 a[40:43], a[232:235], a[80:83], a[40:43]
  s_waitcnt lgkmcnt(4)
  buffer_load_dwordx4 v3, s[52:55], s40 offen offset:1024 sc1 lds
  v_mfma_f32_16x16x32_bf16 a[48:51], a[240:243], a[80:83], a[48:51]
  ds_read_b128 a[208:211], v120 offset:40960
  v_mfma_f32_16x16x32_bf16 a[48:51], a[244:247], a[84:87], a[48:51]
  v_mfma_f32_16x16x32_bf16 a[52:55], a[244:247], a[92:95], a[52:55]
  ds_read_b128 a[212:215], v120 offset:51200
  v_mfma_f32_16x16x32_bf16 a[52:55], a[240:243], a[88:91], a[52:55]
  buffer_load_dwordx4 v3, s[52:55], s40 offen offset:2048 sc1 lds
  v_mfma_f32_16x16x32_bf16 a[60:63], a[248:251], a[88:91], a[60:63]
  ds_read_b128 a[216:219], v120 offset:41984
  v_mfma_f32_16x16x32_bf16 a[60:63], a[252:255], a[92:95], a[60:63]
  v_mfma_f32_16x16x32_bf16 a[56:59], a[252:255], a[84:87], a[56:59]
  ds_read_b128 a[220:223], v120 offset:52224
  v_mfma_f32_16x16x32_bf16 a[56:59], a[248:251], a[80:83], a[56:59]
  s_waitcnt lgkmcnt(4)
  v_mfma_f32_16x16x32_bf16 a[64:67], a[192:195], a[80:83], a[64:67]
  ds_read_b128 a[224:227], v120 offset:43008
  v_mfma_f32_16x16x32_bf16 a[64:67], a[196:199], a[84:87], a[64:67]
  buffer_load_dwordx4 v3, s[52:55], s40 offen offset:3072 sc1 lds
  v_mfma_f32_16x16x32_bf16 a[68:71], a[196:199], a[92:95], a[68:71]
  s_add_u32 m0, s42, 4096
  ds_read_b128 a[228:231], v120 offset:53248
  v_mfma_f32_16x16x32_bf16 a[68:71], a[192:195], a[88:91], a[68:71]
  v_mfma_f32_16x16x32_bf16 a[76:79], a[200:203], a[88:91], a[76:79]
  s_add_u32 s40, s40, 4096
  ds_read_b128 a[232:235], v120 offset:44032
  v_mfma_f32_16x16x32_bf16 a[76:79], a[204:207], a[92:95], a[76:79]
  s_waitcnt vmcnt(19)
  buffer_load_dwordx4 v3, s[52:55], s40 offen offset:0 sc1 lds
  v_mfma_f32_16x16x32_bf16 a[72:75], a[204:207], a[84:87], a[72:75]
  s_add_u32 m0, s42, 20480
  ds_read_b128 a[236:239], v120 offset:54272
  v_mfma_f32_16x16x32_bf16 a[72:75], a[200:203], a[80:83], a[72:75]
  s_waitcnt lgkmcnt(4)
  v_mfma_f32_16x16x32_bf16 a[0:3], a[208:211], a[96:99], a[0:3]
  s_bfe_u32 s40, s78, 262152
  s_mul_i32 s40, s40, 81920
  s_add_u32 s40, s40, s84
  ds_read_b128 a[240:243], v120 offset:45056
  v_mfma_f32_16x16x32_bf16 a[0:3], a[212:215], a[100:103], a[0:3]
  buffer_load_dwordx4 v3, s[52:55], s40 offen offset:0 sc1 lds
  v_mfma_f32_16x16x32_bf16 a[4:7], a[212:215], a[108:111], a[4:7]
  ds_read_b128 a[244:247], v120 offset:55296
  v_mfma_f32_16x16x32_bf16 a[4:7], a[208:211], a[104:107], a[4:7]
  v_mfma_f32_16x16x32_bf16 a[12:15], a[216:219], a[104:107], a[12:15]
  ds_read_b128 a[248:251], v120 offset:46080
  v_mfma_f32_16x16x32_bf16 a[12:15], a[220:223], a[108:111], a[12:15]
  buffer_load_dwordx4 v3, s[52:55], s40 offen offset:1024 sc1 lds
  v_mfma_f32_16x16x32_bf16 a[8:11], a[220:223], a[100:103], a[8:11]
  ds_read_b128 a[252:255], v120 offset:56320
  v_mfma_f32_16x16x32_bf16 a[8:11], a[216:219], a[96:99], a[8:11]
  s_waitcnt lgkmcnt(4)
  v_mfma_f32_16x16x32_bf16 a[16:19], a[224:227], a[96:99], a[16:19]
  ds_read_b128 a[192:195], v120 offset:47104
  v_mfma_f32_16x16x32_bf16 a[16:19], a[228:231], a[100:103], a[16:19]
  buffer_load_dwordx4 v3, s[52:55], s40 offen offset:2048 sc1 lds
  v_mfma_f32_16x16x32_bf16 a[20:23], a[228:231], a[108:111], a[20:23]
  ds_read_b128 a[196:199], v120 offset:57344
  v_mfma_f32_16x16x32_bf16 a[20:23], a[224:227], a[104:107], a[20:23]
  v_mfma_f32_16x16x32_bf16 a[28:31], a[232:235], a[104:107], a[28:31]
  ds_read_b128 a[200:203], v120 offset:48128
  v_mfma_f32_16x16x32_bf16 a[28:31], a[236:239], a[108:111], a[28:31]
  v_mfma_f32_16x16x32_bf16 a[24:27], a[236:239], a[100:103], a[24:27]
  ds_read_b128 a[204:207], v120 offset:58368
  v_mfma_f32_16x16x32_bf16 a[24:27], a[232:235], a[96:99], a[24:27]
  s_waitcnt lgkmcnt(4)
  buffer_load_dwordx4 v3, s[52:55], s40 offen offset:3072 sc1 lds
  v_mfma_f32_16x16x32_bf16 a[32:35], a[240:243], a[96:99], a[32:35]
  s_add_u32 m0, s42, 24576
  ds_read_b128 a[208:211], v120 offset:49152
  v_mfma_f32_16x16x32_bf16 a[32:35], a[244:247], a[100:103], a[32:35]
  v_mfma_f32_16x16x32_bf16 a[36:39], a[244:247], a[108:111], a[36:39]
  s_add_u32 s40, s40, 4096
  ds_read_b128 a[212:215], v120 offset:59392
  v_mfma_f32_16x16x32_bf16 a[36:39], a[240:243], a[104:107], a[36:39]
  buffer_load_dwordx4 v3, s[52:55], s40 offen offset:0 sc1 lds
  v_mfma_f32_16x16x32_bf16 a[44:47], a[248:251], a[104:107], a[44:47]
  s_add_u32 m0, s42, 122880
  ds_read_b128 a[216:219], v120 offset:50176
  v_mfma_f32_16x16x32_bf16 a[44:47], a[252:255], a[108:111], a[44:47]
  v_mfma_f32_16x16x32_bf16 a[40:43], a[252:255], a[100:103], a[40:43]
  s_bfe_u32 s40, s78, 262156
  s_mul_i32 s40, s40, 81920
  s_add_u32 s40, s40, s84
  ds_read_b128 a[220:223], v120 offset:60416
  v_mfma_f32_16x16x32_bf16 a[40:43], a[248:251], a[96:99], a[40:43]
  s_waitcnt lgkmcnt(4)
  buffer_load_dwordx4 v3, s[52:55], s40 offen offset:0 sc1 lds
  v_mfma_f32_16x16x32_bf16 a[48:51], a[192:195], a[96:99], a[48:51]
  v_mfma_f32_16x16x32_bf16 a[48:51], a[196:199], a[100:103], a[48:51]
  v_mfma_f32_16x16x32_bf16 a[52:55], a[196:199], a[108:111], a[52:55]
  v_mfma_f32_16x16x32_bf16 a[52:55], a[192:195], a[104:107], a[52:55]
  s_waitcnt vmcnt(16)
  s_waitcnt lgkmcnt(0)
  s_barrier
  buffer_load_dwordx4 v3, s[52:55], s40 offen offset:1024 sc1 lds
  v_mfma_f32_16x16x32_bf16 a[60:63], a[200:203], a[104:107], a[60:63]
  ds_read_b128 a[224:227], v120 offset:20480
  v_mfma_f32_16x16x32_bf16 a[60:63], a[204:207], a[108:111], a[60:63]
  ds_read_b128 a[228:231], v120 offset:30720
  v_mfma_f32_16x16x32_bf16 a[56:59], a[204:207], a[100:103], a[56:59]
  ds_read_b128 a[232:235], v120 offset:21504
  v_mfma_f32_16x16x32_bf16 a[56:59], a[200:203], a[96:99], a[56:59]
  ds_read_b128 a[236:239], v120 offset:31744
  v_mfma_f32_16x16x32_bf16 a[64:67], a[208:211], a[96:99], a[64:67]
  ds_read_b128 a[240:243], v120 offset:22528
  v_mfma_f32_16x16x32_bf16 a[64:67], a[212:215], a[100:103], a[64:67]
  buffer_load_dwordx4 v3, s[52:55], s40 offen offset:2048 sc1 lds
  v_mfma_f32_16x16x32_bf16 a[68:71], a[212:215], a[108:111], a[68:71]
  ds_read_b128 a[244:247], v120 offset:32768
  v_mfma_f32_16x16x32_bf16 a[68:71], a[208:211], a[104:107], a[68:71]
  buffer_load_dwordx4 v3, s[52:55], s40 offen offset:3072 sc1 lds
  v_mfma_f32_16x16x32_bf16 a[76:79], a[216:219], a[104:107], a[76:79]
  ds_read_b128 a[248:251], v120 offset:23552
  v_mfma_f32_16x16x32_bf16 a[76:79], a[220:223], a[108:111], a[76:79]
  v_mfma_f32_16x16x32_bf16 a[72:75], a[220:223], a[100:103], a[72:75]
  ds_read_b128 a[252:255], v120 offset:33792
  v_mfma_f32_16x16x32_bf16 a[72:75], a[216:219], a[96:99], a[72:75]
  s_waitcnt lgkmcnt(4)
  v_mfma_f32_16x16x32_bf16 v[176:179], a[224:227], v[128:131], 0
  s_add_u32 m0, s42, 126976
  ds_read_b128 a[192:195], v120 offset:24576
  v_mfma_f32_16x16x32_bf16 v[176:179], a[228:231], v[136:139], v[176:179]
  buffer_load_dword v117, v122, s[32:35], s30 offen sc1
  v_mfma_f32_16x16x32_bf16 v[180:183], a[228:231], v[140:143], 0
  s_add_u32 s40, s40, 4096
  ds_read_b128 a[196:199], v120 offset:34816
  v_mfma_f32_16x16x32_bf16 v[180:183], a[224:227], v[132:135], v[180:183]
  buffer_load_dwordx4 v3, s[52:55], s40 offen offset:0 sc1 lds
  v_mfma_f32_16x16x32_bf16 v[188:191], a[232:235], v[132:135], 0
  s_add_u32 m0, s42, 40960
  s_bfe_u32 s40, s78, 262160
  s_mul_i32 s40, s40, 81920
  s_add_u32 s40, s40, s84
  ds_read_b128 a[200:203], v120 offset:25600
  v_mfma_f32_16x16x32_bf16 v[188:191], a[236:239], v[140:143], v[188:191]
  buffer_load_dwordx4 v3, s[52:55], s40 offen offset:0 sc1 lds
  v_mfma_f32_16x16x32_bf16 v[184:187], a[236:239], v[136:139], 0
  ds_read_b128 a[204:207], v120 offset:35840
  v_mfma_f32_16x16x32_bf16 v[184:187], a[232:235], v[128:131], v[184:187]
  s_waitcnt lgkmcnt(4)
  v_mfma_f32_16x16x32_bf16 v[192:195], a[240:243], v[128:131], 0
  ds_read_b128 a[208:211], v120 offset:26624
  v_accvgpr_read_b32 v96, a44
  v_mfma_f32_16x16x32_bf16 v[192:195], a[244:247], v[136:139], v[192:195]
  buffer_load_dwordx4 v3, s[52:55], s40 offen offset:1024 sc1 lds
  v_mfma_f32_16x16x32_bf16 v[196:199], a[244:247], v[140:143], 0
  ds_read_b128 a[212:215], v120 offset:36864
  v_accvgpr_read_b32 v97, a45
  v_mfma_f32_16x16x32_bf16 v[196:199], a[240:243], v[132:135], v[196:199]
  v_accvgpr_read_b32 v98, a46
  v_accvgpr_read_b32 v99, a47
  v_mfma_f32_16x16x32_bf16 v[204:207], a[248:251], v[132:135], 0
  ds_read_b128 a[216:219], v120 offset:27648
  v_accvgpr_read_b32 v100, a52
  v_mfma_f32_16x16x32_bf16 v[204:207], a[252:255], v[140:143], v[204:207]
  buffer_load_dwordx4 v3, s[52:55], s40 offen offset:2048 sc1 lds
  v_mfma_f32_16x16x32_bf16 v[200:203], a[252:255], v[136:139], 0
  ds_read_b128 a[220:223], v120 offset:37888
  v_accvgpr_read_b32 v101, a53
  v_mfma_f32_16x16x32_bf16 v[200:203], a[248:251], v[128:131], v[200:203]
  s_waitcnt lgkmcnt(4)
  v_accvgpr_read_b32 v102, a54
  v_accvgpr_read_b32 v103, a55
  v_mfma_f32_16x16x32_bf16 v[208:211], a[192:195], v[128:131], 0
  ds_read_b128 a[224:227], v120 offset:28672
  v_cvt_pk_bf16_f32 v40, v96, v97
  v_mfma_f32_16x16x32_bf16 v[208:211], a[196:199], v[136:139], v[208:211]
  buffer_load_dwordx4 v3, s[52:55], s40 offen offset:3072 sc1 lds
  v_mfma_f32_16x16x32_bf16 v[212:215], a[196:199], v[140:143], 0
  ds_read_b128 a[228:231], v120 offset:38912
  v_cvt_pk_bf16_f32 v41, v98, v99
  v_mfma_f32_16x16x32_bf16 v[212:215], a[192:195], v[132:135], v[212:215]
  v_cvt_pk_bf16_f32 v42, v100, v101
  v_cvt_pk_bf16_f32 v43, v102, v103
  v_mfma_f32_16x16x32_bf16 v[220:223], a[200:203], v[132:135], 0
  ds_read_b128 a[232:235], v120 offset:29696
  v_accvgpr_read_b32 v96, a40
  v_mfma_f32_16x16x32_bf16 v[220:223], a[204:207], v[140:143], v[220:223]
  v_mfma_f32_16x16x32_bf16 v[216:219], a[204:207], v[136:139], 0
  s_add_u32 m0, s42, 45056
  ds_read_b128 a[236:239], v120 offset:39936
  v_accvgpr_read_b32 v97, a41
  v_mfma_f32_16x16x32_bf16 v[216:219], a[200:203], v[128:131], v[216:219]
  s_waitcnt lgkmcnt(4)
  v_accvgpr_read_b32 v98, a42
  v_accvgpr_read_b32 v99, a43
  v_mfma_f32_16x16x32_bf16 v[224:227], a[208:211], v[128:131], 0
  s_add_u32 s40, s40, 4096
  ds_read_b128 a[240:243], v120 offset:0
  v_accvgpr_read_b32 v100, a48
  v_mfma_f32_16x16x32_bf16 v[224:227], a[212:215], v[136:139], v[224:227]
  buffer_load_dwordx4 v3, s[52:55], s40 offen offset:0 sc1 lds
  v_mfma_f32_16x16x32_bf16 v[228:231], a[212:215], v[140:143], 0
  s_add_u32 m0, s42, 102400
  ds_read_b128 a[244:247], v120 offset:10240
  v_accvgpr_read_b32 v101, a49
  v_mfma_f32_16x16x32_bf16 v[228:231], a[208:211], v[132:135], v[228:231]
  v_accvgpr_read_b32 v102, a50
  v_accvgpr_read_b32 v103, a51
  v_mfma_f32_16x16x32_bf16 v[236:239], a[216:219], v[132:135], 0
  s_bfe_u32 s40, s78, 262164
  s_mul_i32 s40, s40, 81920
  s_add_u32 s40, s40, s84
  ds_read_b128 a[248:251], v120 offset:1024
  v_cvt_pk_bf16_f32 v44, v96, v97
  v_mfma_f32_16x16x32_bf16 v[236:239], a[220:223], v[140:143], v[236:239]
  buffer_load_dwordx4 v3, s[52:55], s40 offen offset:0 sc1 lds
  v_mfma_f32_16x16x32_bf16 v[232:235], a[220:223], v[136:139], 0
  ds_read_b128 a[252:255], v120 offset:11264
  v_cvt_pk_bf16_f32 v45, v98, v99
  v_mfma_f32_16x16x32_bf16 v[232:235], a[216:219], v[128:131], v[232:235]
  s_waitcnt lgkmcnt(4)
  v_cvt_pk_bf16_f32 v46, v100, v101
  v_cvt_pk_bf16_f32 v47, v102, v103
  v_mfma_f32_16x16x32_bf16 v[240:243], a[224:227], v[128:131], 0
  ds_read_b128 a[192:195], v120 offset:2048
  v_accvgpr_read_b32 v96, a60
  v_mfma_f32_16x16x32_bf16 v[240:243], a[228:231], v[136:139], v[240:243]
  buffer_load_dwordx4 v3, s[52:55], s40 offen offset:1024 sc1 lds
  v_mfma_f32_16x16x32_bf16 v[244:247], a[228:231], v[140:143], 0
  ds_read_b128 a[196:199], v120 offset:12288
  v_accvgpr_read_b32 v97, a61
  v_mfma_f32_16x16x32_bf16 v[244:247], a[224:227], v[132:135], v[244:247]
  v_accvgpr_read_b32 v98, a62
  v_accvgpr_read_b32 v99, a63
  v_mfma_f32_16x16x32_bf16 v[252:255], a[232:235], v[132:135], 0
  ds_read_b128 a[200:203], v120 offset:3072
  v_accvgpr_read_b32 v100, a68
  v_mfma_f32_16x16x32_bf16 v[252:255], a[236:239], v[140:143], v[252:255]
  buffer_load_dwordx4 v3, s[52:55], s40 offen offset:2048 sc1 lds
  v_mfma_f32_16x16x32_bf16 v[248:251], a[236:239], v[136:139], 0
  ds_read_b128 a[204:207], v120 offset:13312
  v_accvgpr_read_b32 v101, a69
  v_mfma_f32_16x16x32_bf16 v[248:251], a[232:235], v[128:131], v[248:251]
  s_waitcnt lgkmcnt(4)
  v_accvgpr_read_b32 v102, a70
  v_accvgpr_read_b32 v103, a71
  s_waitcnt vmcnt(9)
  v_cmp_ne_u32 vcc, 1, v117
  s_nop 1
  s_cbranch_vccnz L_ow_1
L_ow_ok_1:
  v_mfma_f32_16x16x32_bf16 v[176:179], a[240:243], v[144:147], v[176:179]
  s_bfe_u32 s41, s78, 262144
  s_mul_i32 s41, s41, 262144
  s_add_u32 s41, s41, s85
  ds_read_b128 a[208:211], v120 offset:4096
  v_cvt_pk_bf16_f32 v48, v96, v97
  v_mfma_f32_16x16x32_bf16 v[176:179], a[244:247], v[152:155], v[176:179]
  buffer_load_dwordx4 a[112:115], v112, s[32:35], s41 offen offset:0 sc1
  v_mfma_f32_16x16x32_bf16 v[180:183], a[244:247], v[156:159], v[180:183]
  ds_read_b128 a[212:215], v120 offset:14336
  v_cvt_pk_bf16_f32 v49, v98, v99
  v_mfma_f32_16x16x32_bf16 v[180:183], a[240:243], v[148:151], v[180:183]
  v_cvt_pk_bf16_f32 v50, v100, v101
  v_cvt_pk_bf16_f32 v51, v102, v103
  v_mfma_f32_16x16x32_bf16 v[188:191], a[248:251], v[148:151], v[188:191]
  ds_read_b128 a[216:219], v120 offset:5120
  v_accvgpr_read_b32 v96, a56
  v_mfma_f32_16x16x32_bf16 v[188:191], a[252:255], v[156:159], v[188:191]
  buffer_load_dwordx4 a[116:119], v112, s[32:35], s41 offen offset:1024 sc1
  v_mfma_f32_16x16x32_bf16 v[184:187], a[252:255], v[152:155], v[184:187]
  ds_read_b128 a[220:223], v120 offset:15360
  v_accvgpr_read_b32 v97, a57
  v_mfma_f32_16x16x32_bf16 v[184:187], a[248:251], v[144:147], v[184:187]
  s_waitcnt lgkmcnt(4)
  v_accvgpr_read_b32 v98, a58
  v_accvgpr_read_b32 v99, a59
  v_mfma_f32_16x16x32_bf16 v[192:195], a[192:195], v[144:147], v[192:195]
  ds_read_b128 a[224:227], v120 offset:6144
  v_accvgpr_read_b32 v100, a64
  v_mfma_f32_16x16x32_bf16 v[192:195], a[196:199], v[152:155], v[192:195]
  buffer_load_dwordx4 a[120:123], v113, s[32:35], s41 offen offset:0 sc1
  v_mfma_f32_16x16x32_bf16 v[196:199], a[196:199], v[156:159], v[196:199]
  ds_read_b128 a[228:231], v120 offset:16384
  v_accvgpr_read_b32 v101, a65
  v_mfma_f32_16x16x32_bf16 v[196:199], a[192:195], v[148:151], v[196:199]
  v_accvgpr_read_b32 v102, a66
  v_accvgpr_read_b32 v103, a67
  v_mfma_f32_16x16x32_bf16 v[204:207], a[200:203], v[148:151], v[204:207]
  ds_read_b128 a[232:235], v120 offset:7168
  v_cvt_pk_bf16_f32 v52, v96, v97
  v_mfma_f32_16x16x32_bf16 v[204:207], a[204:207], v[156:159], v[204:207]
  buffer_load_dwordx4 a[124:127], v113, s[32:35], s41 offen offset:1024 sc1
  v_mfma_f32_16x16x32_bf16 v[200:203], a[204:207], v[152:155], v[200:203]
  ds_read_b128 a[236:239], v120 offset:17408
  v_cvt_pk_bf16_f32 v53, v98, v99
  v_mfma_f32_16x16x32_bf16 v[200:203], a[200:203], v[144:147], v[200:203]
  s_waitcnt lgkmcnt(4)
  v_cvt_pk_bf16_f32 v54, v100, v101
  v_cvt_pk_bf16_f32 v55, v102, v103
  v_mfma_f32_16x16x32_bf16 v[208:211], a[208:211], v[144:147], v[208:211]
  s_bfe_u32 s41, s78, 262148
  s_mul_i32 s41, s41, 262144
  s_add_u32 s41, s41, s85
  ds_read_b128 a[240:243], v120 offset:8192
  v_accvgpr_read_b32 v96, a4
  v_mfma_f32_16x16x32_bf16 v[208:211], a[212:215], v[152:155], v[208:211]
  buffer_load_dwordx4 a[128:131], v112, s[32:35], s41 offen offset:0 sc1
  v_mfma_f32_16x16x32_bf16 v[212:215], a[212:215], v[156:159], v[212:215]
  ds_read_b128 a[244:247], v120 offset:18432
  v_accvgpr_read_b32 v97, a5
  v_mfma_f32_16x16x32_bf16 v[212:215], a[208:211], v[148:151], v[212:215]
  v_accvgpr_read_b32 v98, a6
  v_accvgpr_read_b32 v99, a7
  v_mfma_f32_16x16x32_bf16 v[220:223], a[216:219], v[148:151], v[220:223]
  ds_read_b128 a[248:251], v120 offset:9216
  v_accvgpr_read_b32 v100, a12
  v_mfma_f32_16x16x32_bf16 v[220:223], a[220:223], v[156:159], v[220:223]
  buffer_load_dwordx4 a[132:135], v112, s[32:35], s41 offen offset:1024 sc1
  v_mfma_f32_16x16x32_bf16 v[216:219], a[220:223], v[152:155], v[216:219]
  ds_read_b128 a[252:255], v120 offset:19456
  v_accvgpr_read_b32 v101, a13
  v_mfma_f32_16x16x32_bf16 v[216:219], a[216:219], v[144:147], v[216:219]
  s_waitcnt lgkmcnt(4)
  v_accvgpr_read_b32 v102, a14
  v_accvgpr_read_b32 v103, a15
  v_mfma_f32_16x16x32_bf16 v[224:227], a[224:227], v[144:147], v[224:227]
  v_cvt_pk_bf16_f32 v56, v96, v97
  v_cvt_pk_bf16_f32 v57, v98, v99
  v_mfma_f32_16x16x32_bf16 v[224:227], a[228:231], v[152:155], v[224:227]
  buffer_load_dwordx4 a[136:139], v113, s[32:35], s41 offen offset:0 sc1
  v_mfma_f32_16x16x32_bf16 v[228:231], a[228:231], v[156:159], v[228:231]
  v_cvt_pk_bf16_f32 v58, v100, v101
  v_cvt_pk_bf16_f32 v59, v102, v103
  v_mfma_f32_16x16x32_bf16 v[228:231], a[224:227], v[148:151], v[228:231]
  s_waitcnt lgkmcnt(0)
  s_barrier
  v_accvgpr_read_b32 v96, a20
  v_accvgpr_read_b32 v97, a21
  v_mfma_f32_16x16x32_bf16 v[236:239], a[232:235], v[148:151], v[236:239]
  ds_read_b128 a[192:195], v121 offset:20480
  v_accvgpr_read_b32 v98, a22
  v_mfma_f32_16x16x32_bf16 v[236:239], a[236:239], v[156:159], v[236:239]
  ds_read_b128 a[196:199], v121 offset:30720
  v_mfma_f32_16x16x32_bf16 v[232:235], a[236:239], v[152:155], v[232:235]
  ds_read_b128 a[200:203], v121 offset:21504
  v_accvgpr_read_b32 v99, a23
  v_mfma_f32_16x16x32_bf16 v[232:235], a[232:235], v[144:147], v[232:235]
  ds_read_b128 a[204:207], v121 offset:31744
  v_accvgpr_read_b32 v100, a28
  v_mfma_f32_16x16x32_bf16 v[240:243], a[240:243], v[144:147], v[240:243]
  ds_read_b128 a[208:211], v121 offset:22528
  v_accvgpr_read_b32 v101, a29
  v_mfma_f32_16x16x32_bf16 v[240:243], a[244:247], v[152:155], v[240:243]
  buffer_load_dwordx4 a[140:143], v113, s[32:35], s41 offen offset:1024 sc1
  v_mfma_f32_16x16x32_bf16 v[244:247], a[244:247], v[156:159], v[244:247]
  ds_read_b128 a[212:215], v121 offset:32768
  v_accvgpr_read_b32 v102, a30
  v_mfma_f32_16x16x32_bf16 v[244:247], a[240:243], v[148:151], v[244:247]
  v_accvgpr_read_b32 v103, a31
  v_cvt_pk_bf16_f32 v60, v96, v97
  v_mfma_f32_16x16x32_bf16 v[252:255], a[248:251], v[148:151], v[252:255]
  s_xor_b32 s3, s97, 62464
  ds_read_b128 a[216:219], v121 offset:23552
  v_cvt_pk_bf16_f32 v61, v98, v99
  v_mfma_f32_16x16x32_bf16 v[252:255], a[252:255], v[156:159], v[252:255]
  s_waitcnt vmcnt(4)
  buffer_store_dwordx4 v[40:43], v3, s[32:35], s3 offen offset:0 sc1
  v_mfma_f32_16x16x32_bf16 v[248:251], a[252:255], v[152:155], v[248:251]
  ds_read_b128 a[220:223], v121 offset:33792
  v_cvt_pk_bf16_f32 v62, v100, v101
  v_mfma_f32_16x16x32_bf16 v[248:251], a[248:251], v[144:147], v[248:251]
  s_waitcnt lgkmcnt(4)
  v_cvt_pk_bf16_f32 v63, v102, v103
  v_mfma_f32_16x16x32_bf16 v[176:179], a[192:195], a[112:115], v[176:179]
  ds_read_b128 a[224:227], v121 offset:24576
  v_accvgpr_read_b32 v96, a76
  v_mfma_f32_16x16x32_bf16 v[176:179], a[196:199], a[116:119], v[176:179]
  v_mfma_f32_16x16x32_bf16 v[180:183], a[196:199], a[124:127], v[180:183]
  ds_read_b128 a[228:231], v121 offset:34816
  v_accvgpr_read_b32 v97, a77
  v_mfma_f32_16x16x32_bf16 v[180:183], a[192:195], a[120:123], v[180:183]
  v_accvgpr_read_b32 v98, a78
  v_accvgpr_read_b32 v99, a79
  v_mfma_f32_16x16x32_bf16 v[188:191], a[200:203], a[120:123], v[188:191]
  ds_read_b128 a[232:235], v121 offset:25600
  v_cvt_pk_bf16_f32 v64, v96, v97
  v_mfma_f32_16x16x32_bf16 v[188:191], a[204:207], a[124:127], v[188:191]
  v_mfma_f32_16x16x32_bf16 v[184:187], a[204:207], a[116:119], v[184:187]
  ds_read_b128 a[236:239], v121 offset:35840
  v_cvt_pk_bf16_f32 v65, v98, v99
  v_mfma_f32_16x16x32_bf16 v[184:187], a[200:203], a[112:115], v[184:187]
  s_waitcnt lgkmcnt(4)
  v_accvgpr_read_b32 v96, a72
  v_accvgpr_read_b32 v97, a73
  v_mfma_f32_16x16x32_bf16 v[192:195], a[208:211], a[112:115], v[192:195]
  s_bfe_u32 s41, s78, 262152
  s_mul_i32 s41, s41, 262144
  s_add_u32 s41, s41, s85
  ds_read_b128 a[240:243], v121 offset:26624
  v_accvgpr_read_b32 v98, a74
  v_mfma_f32_16x16x32_bf16 v[192:195], a[212:215], a[116:119], v[192:195]
  buffer_load_dwordx4 a[144:147], v112, s[32:35], s41 offen offset:0 sc1
  v_mfma_f32_16x16x32_bf16 v[196:199], a[212:215], a[124:127], v[196:199]
  ds_read_b128 a[244:247], v121 offset:36864
  v_accvgpr_read_b32 v99, a75
  v_mfma_f32_16x16x32_bf16 v[196:199], a[208:211], a[120:123], v[196:199]
  v_cvt_pk_bf16_f32 v66, v96, v97
  v_cvt_pk_bf16_f32 v67, v98, v99
  v_mfma_f32_16x16x32_bf16 v[204:207], a[216:219], a[120:123], v[204:207]
  ds_read_b128 a[248:251], v121 offset:27648
  v_accvgpr_read_b32 v96, a36
  v_mfma_f32_16x16x32_bf16 v[204:207], a[220:223], a[124:127], v[204:207]
  buffer_load_dwordx4 a[148:151], v112, s[32:35], s41 offen offset:1024 sc1
  v_mfma_f32_16x16x32_bf16 v[200:203], a[220:223], a[116:119], v[200:203]
  ds_read_b128 a[252:255], v121 offset:37888
  v_accvgpr_read_b32 v97, a37
  v_mfma_f32_16x16x32_bf16 v[200:203], a[216:219], a[112:115], v[200:203]
  s_waitcnt lgkmcnt(4)
  v_accvgpr_read_b32 v98, a38
  v_accvgpr_read_b32 v99, a39
  v_mfma_f32_16x16x32_bf16 v[208:211], a[224:227], a[112:115], v[208:211]
  ds_read_b128 a[192:195], v121 offset:28672
  v_cvt_pk_bf16_f32 v68, v96, v97
  v_mfma_f32_16x16x32_bf16 v[208:211], a[228:231], a[116:119], v[208:211]
  buffer_load_dwordx4 a[152:155], v113, s[32:35], s41 offen offset:0 sc1
  v_mfma_f32_16x16x32_bf16 v[212:215], a[228:231], a[124:127], v[212:215]
  ds_read_b128 a[196:199], v121 offset:38912
  v_cvt_pk_bf16_f32 v69, v98, v99
  v_mfma_f32_16x16x32_bf16 v[212:215], a[224:227], a[120:123], v[212:215]
  v_and_b32 v2, 15, v1
  v_mul_u32_u24 v123, 1280, v2
  v_mfma_f32_16x16x32_bf16 v[220:223], a[232:235], a[120:123], v[220:223]
  ds_read_b128 a[200:203], v121 offset:29696
  v_lshrrev_b32 v2, 4, v1
  v_mfma_f32_16x16x32_bf16 v[220:223], a[236:239], a[124:127], v[220:223]
  buffer_load_dwordx4 a[156:159], v113, s[32:35], s41 offen offset:1024 sc1
  v_mfma_f32_16x16x32_bf16 v[216:219], a[236:239], a[116:119], v[216:219]
  ds_read_b128 a[204:207], v121 offset:39936
  v_lshl_add_u32 v123, v2, 3, v123
  v_mfma_f32_16x16x32_bf16 v[216:219], a[232:235], a[112:115], v[216:219]
  s_waitcnt lgkmcnt(4)
  v_and_b32 v2, 1, v2
  v_mad_u32_u24 v38, v2, 24, v123
  v_mfma_f32_16x16x32_bf16 v[224:227], a[240:243], a[112:115], v[224:227]
  ds_read_b128 a[208:211], v119 offset:0
  v_accvgpr_read_b32 v8, a0
  v_mfma_f32_16x16x32_bf16 v[224:227], a[244:247], a[116:119], v[224:227]
  v_mfma_f32_16x16x32_bf16 v[228:231], a[244:247], a[124:127], v[228:231]
  ds_read_b128 a[212:215], v119 offset:10240
  v_accvgpr_read_b32 v9, a1
  v_mfma_f32_16x16x32_bf16 v[228:231], a[240:243], a[120:123], v[228:231]
  v_accvgpr_read_b32 v10, a2
  v_accvgpr_read_b32 v11, a3
  v_mfma_f32_16x16x32_bf16 v[236:239], a[248:251], a[120:123], v[236:239]
  s_xor_b32 s3, s97, 25600
  ds_read_b128 a[216:219], v119 offset:1024
  v_accvgpr_read_b32 v12, a8
  v_mfma_f32_16x16x32_bf16 v[236:239], a[252:255], a[124:127], v[236:239]
  buffer_store_dwordx4 v[44:47], v3, s[32:35], s3 offen offset:0 sc1
  v_mfma_f32_16x16x32_bf16 v[232:235], a[252:255], a[116:119], v[232:235]
  ds_read_b128 a[220:223], v119 offset:11264
  v_accvgpr_read_b32 v13, a9
  v_mfma_f32_16x16x32_bf16 v[232:235], a[248:251], a[112:115], v[232:235]
  s_waitcnt lgkmcnt(4)
  v_accvgpr_read_b32 v14, a10
  v_accvgpr_read_b32 v15, a11
  v_mfma_f32_16x16x32_bf16 v[240:243], a[192:195], a[112:115], v[240:243]
  ds_read_b128 a[224:227], v119 offset:2048
  v_accvgpr_read_b32 v16, a16
  v_mfma_f32_16x16x32_bf16 v[240:243], a[196:199], a[116:119], v[240:243]
  v_mfma_f32_16x16x32_bf16 v[244:247], a[196:199], a[124:127], v[244:247]
  ds_read_b128 a[228:231], v119 offset:12288
  v_accvgpr_read_b32 v17, a17
  v_mfma_f32_16x16x32_bf16 v[244:247], a[192:195], a[120:123], v[244:247]
  v_accvgpr_read_b32 v18, a18
  v_accvgpr_read_b32 v19, a19
  v_mfma_f32_16x16x32_bf16 v[252:255], a[200:203], a[120:123], v[252:255]
  ds_read_b128 a[232:235], v119 offset:3072
  v_accvgpr_read_b32 v20, a24
  v_mfma_f32_16x16x32_bf16 v[252:255], a[204:207], a[124:127], v[252:255]
  s_waitcnt vmcnt(6)
  v_mfma_f32_16x16x32_bf16 v[248:251], a[204:207], a[116:119], v[248:251]
  ds_read_b128 a[236:239], v119 offset:13312
  v_accvgpr_read_b32 v21, a25
  v_mfma_f32_16x16x32_bf16 v[248:251], a[200:203], a[112:115], v[248:251]
  s_waitcnt lgkmcnt(4)
L_pad_post10_1:
  s_cbranch_execz L_back1
  v_accvgpr_read_b32 v22, a26
  v_accvgpr_read_b32 v23, a27
  v_mfma_f32_16x16x32_bf16 v[176:179], a[208:211], a[128:131], v[176:179]
  s_bfe_u32 s41, s78, 262156
  s_mul_i32 s41, s41, 262144
  s_add_u32 s41, s41, s85
  ds_read_b128 a[240:243], v119 offset:4096
  v_accvgpr_read_b32 v24, a32
  v_mfma_f32_16x16x32_bf16 v[176:179], a[212:215], a[132:135], v[176:179]
  buffer_load_dwordx4 a[160:163], v112, s[32:35], s41 offen offset:0 sc1
  v_mfma_f32_16x16x32_bf16 v[180:183], a[212:215], a[140:143], v[180:183]
  ds_read_b128 a[244:247], v119 offset:14336
  v_accvgpr_read_b32 v25, a33
  v_mfma_f32_16x16x32_bf16 v[180:183], a[208:211], a[136:139], v[180:183]
  v_accvgpr_read_b32 v26, a34
  v_accvgpr_read_b32 v27, a35
  v_mfma_f32_16x16x32_bf16 v[188:191], a[216:219], a[136:139], v[188:191]
  ds_read_b128 a[248:251], v119 offset:5120
  v_bfe_u32 v90, v1, 2, 2
  v_mfma_f32_16x16x32_bf16 v[188:191], a[220:223], a[140:143], v[188:191]
  buffer_load_dwordx4 a[164:167], v112, s[32:35], s41 offen offset:1024 sc1
  v_mfma_f32_16x16x32_bf16 v[184:187], a[220:223], a[132:135], v[184:187]
  ds_read_b128 a[252:255], v119 offset:15360
  v_lshrrev_b32 v91, 4, v1
  v_mfma_f32_16x16x32_bf16 v[184:187], a[216:219], a[128:131], v[184:187]
  s_waitcnt lgkmcnt(4)
  v_cmp_eq_u32 vcc, v90, v91
  v_and_b32 v90, 1, v1
  v_mfma_f32_16x16x32_bf16 v[192:195], a[224:227], a[128:131], v[192:195]
  ds_read_b128 a[192:195], v119 offset:6144
  v_lshlrev_b32 v90, 4, v90
  v_mfma_f32_16x16x32_bf16 v[192:195], a[228:231], a[132:135], v[192:195]
  buffer_load_dwordx4 a[168:171], v113, s[32:35], s41 offen offset:0 sc1
  v_mfma_f32_16x16x32_bf16 v[196:199], a[228:231], a[140:143], v[196:199]
  ds_read_b128 a[196:199], v119 offset:16384
  v_mov_b32 v91, 0x3f80
  v_mfma_f32_16x16x32_bf16 v[196:199], a[224:227], a[136:139], v[196:199]
  v_lshlrev_b32 v90, v90, v91
  v_cndmask_b32 v90, 0, v90, vcc
  v_mfma_f32_16x16x32_bf16 v[204:207], a[232:235], a[136:139], v[204:207]
  ds_read_b128 a[200:203], v119 offset:7168
  v_bfe_i32 v91, v1, 1, 1
  v_mfma_f32_16x16x32_bf16 v[204:207], a[236:239], a[140:143], v[204:207]
  buffer_load_dwordx4 a[172:175], v113, s[32:35], s41 offen offset:1024 sc1
  v_mfma_f32_16x16x32_bf16 v[200:203], a[236:239], a[132:135], v[200:203]
  ds_read_b128 a[204:207], v119 offset:17408
  v_and_b32 v91, v91, v90
  v_mfma_f32_16x16x32_bf16 v[200:203], a[232:235], a[128:131], v[200:203]
  s_waitcnt lgkmcnt(4)
  v_sub_u32 v90, v90, v91
  v_mov_b32 v88, 0
  v_mfma_f32_16x16x32_bf16 v[208:211], a[240:243], a[128:131], v[208:211]
  ds_read_b128 a[208:211], v119 offset:8192
  v_mov_b32 v89, 0
  v_mfma_f32_16x16x32_bf16 v[208:211], a[244:247], a[132:135], v[208:211]
  v_mfma_f32_16x16x32_bf16 v[212:215], a[244:247], a[140:143], v[212:215]
  ds_read_b128 a[212:215], v119 offset:18432
  v_mov_b32 v92, 0
  v_mfma_f32_16x16x32_bf16 v[212:215], a[240:243], a[136:139], v[212:215]
  v_mov_b32 v93, 0
  v_mfma_f32_16x16x32_bf16 v[220:223], a[248:251], a[136:139], v[220:223]
  s_xor_b32 s3, s97, 62464
  ds_read_b128 a[216:219], v119 offset:9216
  v_mfma_f32_16x16x32_bf16 v[220:223], a[252:255], a[140:143], v[220:223]
  buffer_store_dwordx4 v[48:51], v3, s[32:35], s3 offen offset:1024 sc1
  v_mfma_f32_16x16x32_bf16 v[216:219], a[252:255], a[132:135], v[216:219]
  ds_read_b128 a[220:223], v119 offset:19456
  v_mfma_f32_16x16x32_bf16 v[216:219], a[248:251], a[128:131], v[216:219]
  s_waitcnt lgkmcnt(4)
  v_mfma_f32_16x16x32_bf16 v[224:227], a[192:195], a[128:131], v[224:227]
  v_mfma_f32_16x16x32_bf16 v[224:227], a[196:199], a[132:135], v[224:227]
  v_mfma_f32_16x16x32_bf16 v[228:231], a[196:199], a[140:143], v[228:231]
  v_mfma_f32_16x16x32_bf16 v[228:231], a[192:195], a[136:139], v[228:231]
  s_waitcnt lgkmcnt(0)
  s_barrier
  v_mfma_f32_16x16x32_bf16 v[236:239], a[200:203], a[136:139], v[236:239]
  ds_read_b128 a[224:227], v119 offset:20480
  v_mfma_f32_16x16x32_bf16 v[236:239], a[204:207], a[140:143], v[236:239]
  ds_read_b128 a[228:231], v119 offset:30720
  v_mfma_f32_16x16x32_bf16 v[232:235], a[204:207], a[132:135], v[232:235]
  ds_read_b128 a[232:235], v119 offset:21504
  v_mfma_f32_16x16x32_bf16 v[232:235], a[200:203], a[128:131], v[232:235]
  ds_read_b128 a[236:239], v119 offset:31744
  v_mfma_f32_16x16x32_bf16 v[240:243], a[208:211], a[128:131], v[240:243]
  ds_read_b128 a[240:243], v119 offset:22528
  v_mfma_f32_16x16x32_bf16 v[240:243], a[212:215], a[132:135], v[240:243]
  buffer_load_dwordx4 v3, s[52:55], s40 offen offset:3072 sc1 lds
  v_mfma_f32_16x16x32_bf16 v[244:247], a[212:215], a[140:143], v[244:247]
  s_add_u32 m0, s42, 106496
  ds_read_b128 a[244:247], v119 offset:32768
  v_mfma_f32_16x16x32_bf16 v[244:247], a[208:211], a[136:139], v[244:247]
  v_mfma_f32_16x16x32_bf16 v[252:255], a[216:219], a[136:139], v[252:255]
  s_add_u32 s40, s40, 4096
  ds_read_b128 a[248:251], v119 offset:23552
  v_mfma_f32_16x16x32_bf16 v[252:255], a[220:223], a[140:143], v[252:255]
  s_waitcnt vmcnt(7)
  buffer_load_dwordx4 v3, s[52:55], s40 offen offset:0 sc1 lds
  v_mfma_f32_16x16x32_bf16 v[248:251], a[220:223], a[132:135], v[248:251]
  ds_read_b128 a[252:255], v119 offset:33792
  v_mfma_f32_16x16x32_bf16 v[248:251], a[216:219], a[128:131], v[248:251]
  s_waitcnt lgkmcnt(4)
  v_mfma_f32_16x16x32_bf16 v[176:179], a[224:227], a[144:147], v[176:179]
  ds_read_b128 a[192:195], v119 offset:24576
  v_mfma_f32_16x16x32_bf16 v[176:179], a[228:231], a[148:151], v[176:179]
  v_mfma_f32_16x16x32_bf16 v[180:183], a[228:231], a[156:159], v[180:183]
  s_bfe_u32 s41, s78, 262160
  s_mul_i32 s41, s41, 262144
  s_add_u32 s41, s41, s85
  ds_read_b128 a[196:199], v119 offset:34816
  v_mfma_f32_16x16x32_bf16 v[180:183], a[224:227], a[152:155], v[180:183]
  buffer_load_dwordx4 a[176:179], v112, s[32:35], s41 offen offset:0 sc1
  v_mfma_f32_16x16x32_bf16 v[188:191], a[232:235], a[152:155], v[188:191]
  ds_read_b128 a[200:203], v119 offset:25600
  v_mfma_f32_16x16x32_bf16 v[188:191], a[236:239], a[156:159], v[188:191]
  v_mfma_f32_16x16x32_bf16 v[184:187], a[236:239], a[148:151], v[184:187]
  ds_read_b128 a[204:207], v119 offset:35840
  v_mfma_f32_16x16x32_bf16 v[184:187], a[232:235], a[144:147], v[184:187]
  s_waitcnt lgkmcnt(4)
  buffer_load_dwordx4 a[180:183], v112, s[32:35], s41 offen offset:1024 sc1
  v_mfma_f32_16x16x32_bf16 v[192:195], a[240:243], a[144:147], v[192:195]
  ds_read_b128 a[208:211], v119 offset:26624
  v_mfma_f32_16x16x32_bf16 v[192:195], a[244:247], a[148:151], v[192:195]
  buffer_load_dwordx4 a[184:187], v113, s[32:35], s41 offen offset:0 sc1
  v_mfma_f32_16x16x32_bf16 v[196:199], a[244:247], a[156:159], v[196:199]
  ds_read_b128 a[212:215], v119 offset:36864
  v_mfma_f32_16x16x32_bf16 v[196:199], a[240:243], a[152:155], v[196:199]
  buffer_load_dwordx4 a[188:191], v113, s[32:35], s41 offen offset:1024 sc1
  v_mfma_f32_16x16x32_bf16 v[204:207], a[248:251], a[152:155], v[204:207]
  s_xor_b32 s3, s97, 25600
  ds_read_b128 a[216:219], v119 offset:27648
  v_mfma_f32_16x16x32_bf16 v[204:207], a[252:255], a[156:159], v[204:207]
  buffer_store_dwordx4 v[52:55], v3, s[32:35], s3 offen offset:1024 sc1
  v_mfma_f32_16x16x32_bf16 v[200:203], a[252:255], a[148:151], v[200:203]
  ds_read_b128 a[220:223], v119 offset:37888
  v_mfma_f32_16x16x32_bf16 v[200:203], a[248:251], a[144:147], v[200:203]
  s_waitcnt lgkmcnt(4)
  v_mfma_f32_16x16x32_bf16 v[208:211], a[192:195], a[144:147], v[208:211]
  ds_read_b128 a[224:227], v119 offset:28672
  v_mfma_f32_16x16x32_bf16 v[208:211], a[196:199], a[148:151], v[208:211]
  v_mfma_f32_16x16x32_bf16 v[212:215], a[196:199], a[156:159], v[212:215]
  ds_read_b128 a[228:231], v119 offset:38912
  v_mfma_f32_16x16x32_bf16 v[212:215], a[192:195], a[152:155], v[212:215]
  v_mfma_f32_16x16x32_bf16 v[220:223], a[200:203], a[152:155], v[220:223]
  ds_read_b128 a[232:235], v119 offset:29696
  v_mfma_f32_16x16x32_bf16 v[220:223], a[204:207], a[156:159], v[220:223]
  v_mfma_f32_16x16x32_bf16 v[216:219], a[204:207], a[148:151], v[216:219]
  ds_read_b128 a[236:239], v119 offset:39936
  v_mfma_f32_16x16x32_bf16 v[216:219], a[200:203], a[144:147], v[216:219]
  s_waitcnt lgkmcnt(4)
  v_mfma_f32_16x16x32_bf16 v[224:227], a[208:211], a[144:147], v[224:227]
  ds_read_b128 a[240:243], v121 offset:0
  v_mfma_f32_16x16x32_bf16 v[224:227], a[212:215], a[148:151], v[224:227]
  v_mfma_f32_16x16x32_bf16 v[228:231], a[212:215], a[156:159], v[228:231]
  ds_read_b128 a[244:247], v121 offset:10240
  v_mfma_f32_16x16x32_bf16 v[228:231], a[208:211], a[152:155], v[228:231]
  v_mfma_f32_16x16x32_bf16 v[236:239], a[216:219], a[152:155], v[236:239]
  s_xor_b32 s3, s97, 44032
  ds_read_b128 a[248:251], v121 offset:1024
  v_mfma_f32_16x16x32_bf16 v[236:239], a[220:223], a[156:159], v[236:239]
  buffer_store_dwordx4 v[56:59], v3, s[32:35], s3 offen offset:0 sc1
  v_mfma_f32_16x16x32_bf16 v[232:235], a[220:223], a[148:151], v[232:235]
  ds_read_b128 a[252:255], v121 offset:11264
  v_mfma_f32_16x16x32_bf16 v[232:235], a[216:219], a[144:147], v[232:235]
  s_waitcnt lgkmcnt(4)
  v_mfma_f32_16x16x32_bf16 v[240:243], a[224:227], a[144:147], v[240:243]
  ds_read_b128 a[192:195], v121 offset:2048
  v_mfma_f32_16x16x32_bf16 v[240:243], a[228:231], a[148:151], v[240:243]
  v_mfma_f32_16x16x32_bf16 v[244:247], a[228:231], a[156:159], v[244:247]
  ds_read_b128 a[196:199], v121 offset:12288
  v_mfma_f32_16x16x32_bf16 v[244:247], a[224:227], a[152:155], v[244:247]
  v_mfma_f32_16x16x32_bf16 v[252:255], a[232:235], a[152:155], v[252:255]
  ds_read_b128 a[200:203], v121 offset:3072
  v_mfma_f32_16x16x32_bf16 v[252:255], a[236:239], a[156:159], v[252:255]
  s_waitcnt vmcnt(9)
  v_mfma_f32_16x16x32_bf16 v[248:251], a[236:239], a[148:151], v[248:251]
  ds_read_b128 a[204:207], v121 offset:13312
  v_mfma_f32_16x16x32_bf16 v[248:251], a[232:235], a[144:147], v[248:251]
  s_waitcnt lgkmcnt(4)
  v_mfma_f32_16x16x32_bf16 v[176:179], a[240:243], a[160:163], v[176:179]
  s_xor_b32 s30, s30, 16
  ds_read_b128 a[208:211], v121 offset:4096
  v_mfma_f32_16x16x32_bf16 v[176:179], a[244:247], a[164:167], v[176:179]
  buffer_load_dword v117, v122, s[32:35], s30 offen sc1
  v_mfma_f32_16x16x32_bf16 v[180:183], a[244:247], a[172:175], v[180:183]
  s_bfe_u32 s41, s78, 262164
  s_mul_i32 s41, s41, 262144
  s_add_u32 s41, s41, s85
  ds_read_b128 a[212:215], v121 offset:14336
  v_mfma_f32_16x16x32_bf16 v[180:183], a[240:243], a[168:171], v[180:183]
  buffer_load_dwordx4 a[80:83], v112, s[32:35], s41 offen offset:0 sc1
  v_mfma_f32_16x16x32_bf16 v[188:191], a[248:251], a[168:171], v[188:191]
  ds_read_b128 a[216:219], v121 offset:5120
  v_mfma_f32_16x16x32_bf16 v[188:191], a[252:255], a[172:175], v[188:191]
  v_mfma_f32_16x16x32_bf16 v[184:187], a[252:255], a[164:167], v[184:187]
  ds_read_b128 a[220:223], v121 offset:15360
  v_mfma_f32_16x16x32_bf16 v[184:187], a[248:251], a[160:163], v[184:187]
  s_waitcnt lgkmcnt(4)
  buffer_load_dwordx4 a[84:87], v112, s[32:35], s41 offen offset:1024 sc1
  v_mfma_f32_16x16x32_bf16 v[192:195], a[192:195], a[160:163], v[192:195]
  ds_read_b128 a[224:227], v121 offset:6144
  v_mfma_f32_16x16x32_bf16 v[192:195], a[196:199], a[164:167], v[192:195]
  buffer_load_dwordx4 a[88:91], v113, s[32:35], s41 offen offset:0 sc1
  v_mfma_f32_16x16x32_bf16 v[196:199], a[196:199], a[172:175], v[196:199]
  ds_read_b128 a[228:231], v121 offset:16384
  v_mfma_f32_16x16x32_bf16 v[196:199], a[192:195], a[168:171], v[196:199]
  buffer_load_dwordx4 a[92:95], v113, s[32:35], s41 offen offset:1024 sc1
  v_mfma_f32_16x16x32_bf16 v[204:207], a[200:203], a[168:171], v[204:207]
  ds_read_b128 a[232:235], v121 offset:7168
  v_mfma_f32_16x16x32_bf16 v[204:207], a[204:207], a[172:175], v[204:207]
  v_mfma_f32_16x16x32_bf16 v[200:203], a[204:207], a[164:167], v[200:203]
  s_add_u32 m0, s42, 81920
  ds_read_b128 a[236:239], v121 offset:17408
  v_mfma_f32_16x16x32_bf16 v[200:203], a[200:203], a[160:163], v[200:203]
  s_waitcnt lgkmcnt(4)
  v_mfma_f32_16x16x32_bf16 v[208:211], a[208:211], a[160:163], v[208:211]
  s_bfe_u32 s40, s78, 262168
  s_mul_i32 s40, s40, 81920
  s_add_u32 s40, s40, s84
  ds_read_b128 a[240:243], v121 offset:8192
  v_mfma_f32_16x16x32_bf16 v[208:211], a[212:215], a[164:167], v[208:211]
  buffer_load_dwordx4 v3, s[52:55], s40 offen offset:0 sc1 lds
  v_mfma_f32_16x16x32_bf16 v[212:215], a[212:215], a[172:175], v[212:215]
  ds_read_b128 a[244:247], v121 offset:18432
  v_mfma_f32_16x16x32_bf16 v[212:215], a[208:211], a[168:171], v[212:215]
  v_mfma_f32_16x16x32_bf16 v[220:223], a[216:219], a[168:171], v[220:223]
  ds_read_b128 a[248:251], v121 offset:9216
  v_mfma_f32_16x16x32_bf16 v[220:223], a[220:223], a[172:175], v[220:223]
  buffer_load_dwordx4 v3, s[52:55], s40 offen offset:1024 sc1 lds
  v_mfma_f32_16x16x32_bf16 v[216:219], a[220:223], a[164:167], v[216:219]
  ds_read_b128 a[252:255], v121 offset:19456
  v_mfma_f32_16x16x32_bf16 v[216:219], a[216:219], a[160:163], v[216:219]
  s_waitcnt lgkmcnt(4)
  v_mfma_f32_16x16x32_bf16 v[224:227], a[224:227], a[160:163], v[224:227]
  v_mfma_f32_16x16x32_bf16 v[224:227], a[228:231], a[164:167], v[224:227]
  buffer_load_dwordx4 v3, s[52:55], s40 offen offset:2048 sc1 lds
  v_mfma_f32_16x16x32_bf16 v[228:231], a[228:231], a[172:175], v[228:231]
  v_mfma_f32_16x16x32_bf16 v[228:231], a[224:227], a[168:171], v[228:231]
  s_waitcnt vmcnt(14)
  s_waitcnt lgkmcnt(0)
  s_barrier
  v_mfma_f32_16x16x32_bf16 v[236:239], a[232:235], a[168:171], v[236:239]
  ds_read_b128 a[192:195], v119 offset:40960
  v_mfma_f32_16x16x32_bf16 v[236:239], a[236:239], a[172:175], v[236:239]
  ds_read_b128 a[196:199], v119 offset:51200
  v_mfma_f32_16x16x32_bf16 v[232:235], a[236:239], a[164:167], v[232:235]
  ds_read_b128 a[200:203], v119 offset:41984
  v_mfma_f32_16x16x32_bf16 v[232:235], a[232:235], a[160:163], v[232:235]
  ds_read_b128 a[204:207], v119 offset:52224
  v_mfma_f32_16x16x32_bf16 v[240:243], a[240:243], a[160:163], v[240:243]
  ds_read_b128 a[208:211], v119 offset:43008
  v_mfma_f32_16x16x32_bf16 v[240:243], a[244:247], a[164:167], v[240:243]
  buffer_load_dwordx4 v3, s[52:55], s40 offen offset:3072 sc1 lds
  v_mfma_f32_16x16x32_bf16 v[244:247], a[244:247], a[172:175], v[244:247]
  s_add_u32 m0, s42, 86016
  s_add_u32 s40, s40, 4096
  ds_read_b128 a[212:215], v119 offset:53248
  v_mfma_f32_16x16x32_bf16 v[244:247], a[240:243], a[168:171], v[244:247]
  buffer_load_dwordx4 v3, s[52:55], s40 offen offset:0 sc1 lds
  v_mfma_f32_16x16x32_bf16 v[252:255], a[248:251], a[168:171], v[252:255]
  s_add_u32 m0, s42, 61440
  s_bfe_u32 s40, s78, 262172
  s_mul_i32 s40, s40, 81920
  s_add_u32 s40, s40, s84
  ds_read_b128 a[216:219], v119 offset:44032
  v_mfma_f32_16x16x32_bf16 v[252:255], a[252:255], a[172:175], v[252:255]
  s_waitcnt vmcnt(12)
  buffer_load_dwordx4 v3, s[52:55], s40 offen offset:0 sc1 lds
  v_mfma_f32_16x16x32_bf16 v[248:251], a[252:255], a[164:167], v[248:251]
  ds_read_b128 a[220:223], v119 offset:54272
  v_mfma_f32_16x16x32_bf16 v[248:251], a[248:251], a[160:163], v[248:251]
  s_waitcnt lgkmcnt(4)
  s_waitcnt vmcnt(10)
  v_cmp_ne_u32 vcc, 1, v117
  s_nop 1
  s_cbranch_vccnz L_ox_1
L_ox_ok_1:
  v_mfma_f32_16x16x32_bf16 v[176:179], a[192:195], a[176:179], v[176:179]
  ds_read_b128 a[224:227], v119 offset:45056
  v_mfma_f32_16x16x32_bf16 v[176:179], a[196:199], a[180:183], v[176:179]
  buffer_load_dwordx4 v3, s[52:55], s40 offen offset:1024 sc1 lds
  v_mfma_f32_16x16x32_bf16 v[180:183], a[196:199], a[188:191], v[180:183]
  ds_read_b128 a[228:231], v119 offset:55296
  v_mfma_f32_16x16x32_bf16 v[180:183], a[192:195], a[184:187], v[180:183]
  buffer_load_dwordx4 v3, s[52:55], s40 offen offset:2048 sc1 lds
  v_mfma_f32_16x16x32_bf16 v[188:191], a[200:203], a[184:187], v[188:191]
  ds_read_b128 a[232:235], v119 offset:46080
  v_mfma_f32_16x16x32_bf16 v[188:191], a[204:207], a[188:191], v[188:191]
  buffer_load_dwordx4 v3, s[52:55], s40 offen offset:3072 sc1 lds
  v_mfma_f32_16x16x32_bf16 v[184:187], a[204:207], a[180:183], v[184:187]
  s_add_u32 m0, s42, 65536
  s_add_u32 s40, s40, 4096
  ds_read_b128 a[236:239], v119 offset:56320
  v_mfma_f32_16x16x32_bf16 v[184:187], a[200:203], a[176:179], v[184:187]
  s_waitcnt lgkmcnt(4)
  buffer_load_dwordx4 v3, s[52:55], s40 offen offset:0 sc1 lds
  v_mfma_f32_16x16x32_bf16 v[192:195], a[208:211], a[176:179], v[192:195]
  s_xor_b32 s3, s97, 44032
  ds_read_b128 a[240:243], v119 offset:47104
  v_mfma_f32_16x16x32_bf16 v[192:195], a[212:215], a[180:183], v[192:195]
  buffer_store_dwordx4 v[60:63], v3, s[32:35], s3 offen offset:1024 sc1
  v_mfma_f32_16x16x32_bf16 v[196:199], a[212:215], a[188:191], v[196:199]
  s_bfe_u32 s41, s78, 262168
  s_mul_i32 s41, s41, 262144
  s_add_u32 s41, s41, s85
  ds_read_b128 a[244:247], v119 offset:57344
  v_mfma_f32_16x16x32_bf16 v[196:199], a[208:211], a[184:187], v[196:199]
  buffer_load_dwordx4 a[96:99], v112, s[32:35], s41 offen offset:0 sc1
  v_mfma_f32_16x16x32_bf16 v[204:207], a[216:219], a[184:187], v[204:207]
  ds_read_b128 a[248:251], v119 offset:48128
  v_mfma_f32_16x16x32_bf16 v[204:207], a[220:223], a[188:191], v[204:207]
  buffer_load_dwordx4 a[100:103], v112, s[32:35], s41 offen offset:1024 sc1
  v_mfma_f32_16x16x32_bf16 v[200:203], a[220:223], a[180:183], v[200:203]
  ds_read_b128 a[252:255], v119 offset:58368
  v_mfma_f32_16x16x32_bf16 v[200:203], a[216:219], a[176:179], v[200:203]
  s_waitcnt lgkmcnt(4)
  buffer_load_dwordx4 a[104:107], v113, s[32:35], s41 offen offset:0 sc1
  v_mfma_f32_16x16x32_bf16 v[208:211], a[224:227], a[176:179], v[208:211]
  ds_read_b128 a[192:195], v119 offset:49152
  v_mfma_f32_16x16x32_bf16 v[208:211], a[228:231], a[180:183], v[208:211]
  buffer_load_dwordx4 a[108:111], v113, s[32:35], s41 offen offset:1024 sc1
  v_mfma_f32_16x16x32_bf16 v[212:215], a[228:231], a[188:191], v[212:215]
  ds_read_b128 a[196:199], v119 offset:59392
  v_mfma_f32_16x16x32_bf16 v[212:215], a[224:227], a[184:187], v[212:215]
  v_mfma_f32_16x16x32_bf16 v[220:223], a[232:235], a[184:187], v[220:223]
  ds_read_b128 a[200:203], v119 offset:50176
  v_mfma_f32_16x16x32_bf16 v[220:223], a[236:239], a[188:191], v[220:223]
  v_mfma_f32_16x16x32_bf16 v[216:219], a[236:239], a[180:183], v[216:219]
  s_bfe_u32 s41, s78, 262172
  s_mul_i32 s41, s41, 262144
  s_add_u32 s41, s41, s85
  ds_read_b128 a[204:207], v119 offset:60416
  v_mfma_f32_16x16x32_bf16 v[216:219], a[232:235], a[176:179], v[216:219]
  s_waitcnt lgkmcnt(4)
  buffer_load_dwordx4 a[112:115], v112, s[32:35], s41 offen offset:0 sc1
  v_mfma_f32_16x16x32_bf16 v[224:227], a[240:243], a[176:179], v[224:227]
  ds_read_b128 a[208:211], v120 offset:40960
  v_mfma_f32_16x16x32_bf16 v[224:227], a[244:247], a[180:183], v[224:227]
  v_mfma_f32_16x16x32_bf16 v[228:231], a[244:247], a[188:191], v[228:231]
  ds_read_b128 a[212:215], v120 offset:51200
  v_mfma_f32_16x16x32_bf16 v[228:231], a[240:243], a[184:187], v[228:231]
  buffer_load_dwordx4 a[116:119], v112, s[32:35], s41 offen offset:1024 sc1
  v_mfma_f32_16x16x32_bf16 v[236:239], a[248:251], a[184:187], v[236:239]
  ds_read_b128 a[216:219], v120 offset:41984
  v_mfma_f32_16x16x32_bf16 v[236:239], a[252:255], a[188:191], v[236:239]
  v_mfma_f32_16x16x32_bf16 v[232:235], a[252:255], a[180:183], v[232:235]
  ds_read_b128 a[220:223], v120 offset:52224
  v_mfma_f32_16x16x32_bf16 v[232:235], a[248:251], a[176:179], v[232:235]
  s_waitcnt lgkmcnt(4)
  buffer_load_dwordx4 a[120:123], v113, s[32:35], s41 offen offset:0 sc1
  v_mfma_f32_16x16x32_bf16 v[240:243], a[192:195], a[176:179], v[240:243]
  ds_read_b128 a[224:227], v120 offset:43008
  v_mfma_f32_16x16x32_bf16 v[240:243], a[196:199], a[180:183], v[240:243]
  v_mfma_f32_16x16x32_bf16 v[244:247], a[196:199], a[188:191], v[244:247]
  ds_read_b128 a[228:231], v120 offset:53248
  v_mfma_f32_16x16x32_bf16 v[244:247], a[192:195], a[184:187], v[244:247]
  buffer_load_dwordx4 a[124:127], v113, s[32:35], s41 offen offset:1024 sc1
  v_mfma_f32_16x16x32_bf16 v[252:255], a[200:203], a[184:187], v[252:255]
  s_add_u32 m0, s42, 143360
  ds_read_b128 a[232:235], v120 offset:44032
  v_mfma_f32_16x16x32_bf16 v[252:255], a[204:207], a[188:191], v[252:255]
  s_waitcnt vmcnt(19)
  v_mfma_f32_16x16x32_bf16 v[248:251], a[204:207], a[180:183], v[248:251]
  s_bfe_u32 s40, s79, 262144
  s_mul_i32 s40, s40, 81920
  s_add_u32 s40, s40, s84
  ds_read_b128 a[236:239], v120 offset:54272
  v_mfma_f32_16x16x32_bf16 v[248:251], a[200:203], a[176:179], v[248:251]
  s_waitcnt lgkmcnt(4)
  buffer_load_dwordx4 v3, s[52:55], s40 offen offset:0 sc1 lds
  v_mfma_f32_16x16x32_bf16 v[176:179], a[208:211], a[80:83], v[176:179]
  ds_read_b128 a[240:243], v120 offset:45056
  v_mfma_f32_16x16x32_bf16 v[176:179], a[212:215], a[84:87], v[176:179]
  v_mfma_f32_16x16x32_bf16 v[180:183], a[212:215], a[92:95], v[180:183]
  ds_read_b128 a[244:247], v120 offset:55296
  v_mfma_f32_16x16x32_bf16 v[180:183], a[208:211], a[88:91], v[180:183]
  v_mfma_f32_16x16x32_bf16 v[188:191], a[216:219], a[88:91], v[188:191]
  ds_read_b128 a[248:251], v120 offset:46080
  v_mfma_f32_16x16x32_bf16 v[188:191], a[220:223], a[92:95], v[188:191]
  buffer_load_dwordx4 v3, s[52:55], s40 offen offset:1024 sc1 lds
  v_mfma_f32_16x16x32_bf16 v[184:187], a[220:223], a[84:87], v[184:187]
  ds_read_b128 a[252:255], v120 offset:56320
  v_mfma_f32_16x16x32_bf16 v[184:187], a[216:219], a[80:83], v[184:187]
  s_waitcnt lgkmcnt(4)
  v_mfma_f32_16x16x32_bf16 v[192:195], a[224:227], a[80:83], v[192:195]
  ds_read_b128 a[192:195], v120 offset:47104
  v_mfma_f32_16x16x32_bf16 v[192:195], a[228:231], a[84:87], v[192:195]
  buffer_load_dwordx4 v3, s[52:55], s40 offen offset:2048 sc1 lds
  v_mfma_f32_16x16x32_bf16 v[196:199], a[228:231], a[92:95], v[196:199]
  ds_read_b128 a[196:199], v120 offset:57344
  v_mfma_f32_16x16x32_bf16 v[196:199], a[224:227], a[88:91], v[196:199]
  v_mfma_f32_16x16x32_bf16 v[204:207], a[232:235], a[88:91], v[204:207]
  ds_read_b128 a[200:203], v120 offset:48128
  v_mfma_f32_16x16x32_bf16 v[204:207], a[236:239], a[92:95], v[204:207]
  buffer_load_dwordx4 v3, s[52:55], s40 offen offset:3072 sc1 lds
  v_mfma_f32_16x16x32_bf16 v[200:203], a[236:239], a[84:87], v[200:203]
  s_add_u32 m0, s42, 147456
  ds_read_b128 a[204:207], v120 offset:58368
  v_mfma_f32_16x16x32_bf16 v[200:203], a[232:235], a[80:83], v[200:203]
  s_waitcnt lgkmcnt(4)
  v_mfma_f32_16x16x32_bf16 v[208:211], a[240:243], a[80:83], v[208:211]
  s_add_u32 s40, s40, 4096
  ds_read_b128 a[208:211], v120 offset:49152
  v_mfma_f32_16x16x32_bf16 v[208:211], a[244:247], a[84:87], v[208:211]
  buffer_load_dwordx4 v3, s[52:55], s40 offen offset:0 sc1 lds
  v_mfma_f32_16x16x32_bf16 v[212:215], a[244:247], a[92:95], v[212:215]
  s_add_u32 m0, s42, 0
  ds_read_b128 a[212:215], v120 offset:59392
  v_mfma_f32_16x16x32_bf16 v[212:215], a[240:243], a[88:91], v[212:215]
  v_mfma_f32_16x16x32_bf16 v[220:223], a[248:251], a[88:91], v[220:223]
  s_bfe_u32 s40, s79, 262148
  s_mul_i32 s40, s40, 81920
  s_add_u32 s40, s40, s84
  ds_read_b128 a[216:219], v120 offset:50176
  v_mfma_f32_16x16x32_bf16 v[220:223], a[252:255], a[92:95], v[220:223]
  buffer_load_dwordx4 v3, s[52:55], s40 offen offset:0 sc1 lds
  v_mfma_f32_16x16x32_bf16 v[216:219], a[252:255], a[84:87], v[216:219]
  ds_read_b128 a[220:223], v120 offset:60416
  v_mfma_f32_16x16x32_bf16 v[216:219], a[248:251], a[80:83], v[216:219]
  s_waitcnt lgkmcnt(4)
  v_mfma_f32_16x16x32_bf16 v[224:227], a[192:195], a[80:83], v[224:227]
  v_mfma_f32_16x16x32_bf16 v[224:227], a[196:199], a[84:87], v[224:227]
  v_mfma_f32_16x16x32_bf16 v[228:231], a[196:199], a[92:95], v[228:231]
  buffer_load_dwordx4 v3, s[52:55], s40 offen offset:1024 sc1 lds
  v_mfma_f32_16x16x32_bf16 v[228:231], a[192:195], a[88:91], v[228:231]
  s_waitcnt vmcnt(16)
  s_waitcnt lgkmcnt(0)
  s_barrier
  v_mfma_f32_16x16x32_bf16 v[236:239], a[200:203], a[88:91], v[236:239]
  ds_read_b128 a[224:227], v120 offset:20480
  v_mfma_f32_16x16x32_bf16 v[236:239], a[204:207], a[92:95], v[236:239]
  ds_read_b128 a[228:231], v120 offset:30720
  v_mfma_f32_16x16x32_bf16 v[232:235], a[204:207], a[84:87], v[232:235]
  ds_read_b128 a[232:235], v120 offset:21504
  v_mfma_f32_16x16x32_bf16 v[232:235], a[200:203], a[80:83], v[232:235]
  ds_read_b128 a[236:239], v120 offset:31744
  v_mfma_f32_16x16x32_bf16 v[240:243], a[208:211], a[80:83], v[240:243]
  ds_read_b128 a[240:243], v120 offset:22528
  v_mfma_f32_16x16x32_bf16 v[240:243], a[212:215], a[84:87], v[240:243]
  buffer_load_dwordx4 v3, s[52:55], s40 offen offset:2048 sc1 lds
  v_mfma_f32_16x16x32_bf16 v[244:247], a[212:215], a[92:95], v[244:247]
  ds_read_b128 a[244:247], v120 offset:32768
  v_mfma_f32_16x16x32_bf16 v[244:247], a[208:211], a[88:91], v[244:247]
  buffer_load_dwordx4 v3, s[52:55], s40 offen offset:3072 sc1 lds
  v_mfma_f32_16x16x32_bf16 v[252:255], a[216:219], a[88:91], v[252:255]
  s_add_u32 m0, s42, 4096
  s_add_u32 s40, s40, 4096
  ds_read_b128 a[248:251], v120 offset:23552
  v_mfma_f32_16x16x32_bf16 v[252:255], a[220:223], a[92:95], v[252:255]
  s_waitcnt vmcnt(13)
  buffer_load_dwordx4 v3, s[52:55], s40 offen offset:0 sc1 lds
  v_mfma_f32_16x16x32_bf16 v[248:251], a[220:223], a[84:87], v[248:251]
  ds_read_b128 a[252:255], v120 offset:33792
  v_mfma_f32_16x16x32_bf16 v[248:251], a[216:219], a[80:83], v[248:251]
  s_waitcnt lgkmcnt(4)
  v_mfma_f32_16x16x32_bf16 v[176:179], a[224:227], a[96:99], v[176:179]
  s_xor_b32 s3, s97, 55808
  ds_read_b128 a[192:195], v120 offset:24576
  v_mfma_f32_16x16x32_bf16 v[176:179], a[228:231], a[100:103], v[176:179]
  buffer_store_dwordx2 v[64:65], v114, s[32:35], s3 offen offset:2048 sc1
  v_mfma_f32_16x16x32_bf16 v[180:183], a[228:231], a[108:111], v[180:183]
  ds_read_b128 a[196:199], v120 offset:34816
  v_mfma_f32_16x16x32_bf16 v[180:183], a[224:227], a[104:107], v[180:183]
  v_mfma_f32_16x16x32_bf16 v[188:191], a[232:235], a[104:107], v[188:191]
  ds_read_b128 a[200:203], v120 offset:25600
  v_mfma_f32_16x16x32_bf16 v[188:191], a[236:239], a[108:111], v[188:191]
  v_mfma_f32_16x16x32_bf16 v[184:187], a[236:239], a[100:103], v[184:187]
  s_bfe_u32 s41, s79, 262144
  s_mul_i32 s41, s41, 262144
  s_add_u32 s41, s41, s85
  ds_read_b128 a[204:207], v120 offset:35840
  v_mfma_f32_16x16x32_bf16 v[184:187], a[232:235], a[96:99], v[184:187]
  s_waitcnt lgkmcnt(4)
  buffer_load_dwordx4 a[128:131], v112, s[32:35], s41 offen offset:0 sc1
  v_mfma_f32_16x16x32_bf16 v[192:195], a[240:243], a[96:99], v[192:195]
  ds_read_b128 a[208:211], v120 offset:26624
  v_mfma_f32_16x16x32_bf16 v[192:195], a[244:247], a[100:103], v[192:195]
  buffer_load_dwordx4 a[132:135], v112, s[32:35], s41 offen offset:1024 sc1
  v_mfma_f32_16x16x32_bf16 v[196:199], a[244:247], a[108:111], v[196:199]
  ds_read_b128 a[212:215], v120 offset:36864
  v_mfma_f32_16x16x32_bf16 v[196:199], a[240:243], a[104:107], v[196:199]
  buffer_load_dwordx4 a[136:139], v113, s[32:35], s41 offen offset:0 sc1
  v_mfma_f32_16x16x32_bf16 v[204:207], a[248:251], a[104:107], v[204:207]
  ds_read_b128 a[216:219], v120 offset:27648
  v_mfma_f32_16x16x32_bf16 v[204:207], a[252:255], a[108:111], v[204:207]
  buffer_load_dwordx4 a[140:143], v113, s[32:35], s41 offen offset:1024 sc1
  v_mfma_f32_16x16x32_bf16 v[200:203], a[252:255], a[100:103], v[200:203]
  s_xor_b32 s3, s97, 22016
  ds_read_b128 a[220:223], v120 offset:37888
  v_mfma_f32_16x16x32_bf16 v[200:203], a[248:251], a[96:99], v[200:203]
  s_waitcnt lgkmcnt(4)
  buffer_store_dwordx2 v[66:67], v114, s[32:35], s3 offen offset:2048 sc1
  v_mfma_f32_16x16x32_bf16 v[208:211], a[192:195], a[96:99], v[208:211]
  s_xor_b32 s3, s97, 38912
  ds_read_b128 a[224:227], v120 offset:28672
  v_mfma_f32_16x16x32_bf16 v[208:211], a[196:199], a[100:103], v[208:211]
  buffer_store_dwordx2 v[68:69], v114, s[32:35], s3 offen offset:2048 sc1
  v_mfma_f32_16x16x32_bf16 v[212:215], a[196:199], a[108:111], v[212:215]
  ds_read_b128 a[228:231], v120 offset:38912
  v_mfma_f32_16x16x32_bf16 v[212:215], a[192:195], a[104:107], v[212:215]
  v_mfma_f32_16x16x32_bf16 v[220:223], a[200:203], a[104:107], v[220:223]
  ds_read_b128 a[232:235], v120 offset:29696
  v_mfma_f32_16x16x32_bf16 v[220:223], a[204:207], a[108:111], v[220:223]
  v_mfma_f32_16x16x32_bf16 v[216:219], a[204:207], a[100:103], v[216:219]
  ds_read_b128 a[236:239], v120 offset:39936
  v_mfma_f32_16x16x32_bf16 v[216:219], a[200:203], a[96:99], v[216:219]
  s_waitcnt lgkmcnt(4)
  v_mfma_f32_16x16x32_bf16 v[224:227], a[208:211], a[96:99], v[224:227]
  s_bfe_u32 s41, s79, 262148
  s_mul_i32 s41, s41, 262144
  s_add_u32 s41, s41, s85
  ds_read_b128 a[240:243], v120 offset:0
  v_mfma_f32_16x16x32_bf16 v[224:227], a[212:215], a[100:103], v[224:227]
  buffer_load_dwordx4 a[144:147], v112, s[32:35], s41 offen offset:0 sc1
  v_mfma_f32_16x16x32_bf16 v[228:231], a[212:215], a[108:111], v[228:231]
  ds_read_b128 a[244:247], v120 offset:10240
  v_mfma_f32_16x16x32_bf16 v[228:231], a[208:211], a[104:107], v[228:231]
  v_mfma_f32_16x16x32_bf16 v[236:239], a[216:219], a[104:107], v[236:239]
  ds_read_b128 a[248:251], v120 offset:1024
  v_mfma_f32_16x16x32_bf16 v[236:239], a[220:223], a[108:111], v[236:239]
  buffer_load_dwordx4 a[148:151], v112, s[32:35], s41 offen offset:1024 sc1
  v_mfma_f32_16x16x32_bf16 v[232:235], a[220:223], a[100:103], v[232:235]
  ds_read_b128 a[252:255], v120 offset:11264
  v_mfma_f32_16x16x32_bf16 v[232:235], a[216:219], a[96:99], v[232:235]
  s_waitcnt lgkmcnt(4)
  v_mfma_f32_16x16x32_bf16 v[240:243], a[224:227], a[96:99], v[240:243]
  ds_read_b128 a[192:195], v120 offset:2048
  v_mfma_f32_16x16x32_bf16 v[240:243], a[228:231], a[100:103], v[240:243]
  v_mfma_f32_16x16x32_bf16 v[244:247], a[228:231], a[108:111], v[244:247]
  ds_read_b128 a[196:199], v120 offset:12288
  v_mfma_f32_16x16x32_bf16 v[244:247], a[224:227], a[104:107], v[244:247]
  buffer_load_dwordx4 a[152:155], v113, s[32:35], s41 offen offset:0 sc1
  v_mfma_f32_16x16x32_bf16 v[252:255], a[232:235], a[104:107], v[252:255]
  ds_read_b128 a[200:203], v120 offset:3072
  v_mfma_f32_16x16x32_bf16 v[252:255], a[236:239], a[108:111], v[252:255]
  s_waitcnt vmcnt(20)
  v_mfma_f32_16x16x32_bf16 v[248:251], a[236:239], a[100:103], v[248:251]
  ds_read_b128 a[204:207], v120 offset:13312
  v_mfma_f32_16x16x32_bf16 v[248:251], a[232:235], a[96:99], v[248:251]
  s_waitcnt lgkmcnt(4)
  buffer_load_dwordx4 a[156:159], v113, s[32:35], s41 offen offset:1024 sc1
  v_mfma_f32_16x16x32_bf16 v[176:179], a[240:243], a[112:115], v[176:179]
  s_add_u32 m0, s42, 20480
  ds_read_b128 a[208:211], v120 offset:4096
  v_mfma_f32_16x16x32_bf16 v[176:179], a[244:247], a[116:119], v[176:179]
L_pad_post11_1:
  s_cbranch_execz L_back1
  v_mfma_f32_16x16x32_bf16 v[180:183], a[244:247], a[124:127], v[180:183]
  s_bfe_u32 s40, s79, 262152
  s_mul_i32 s40, s40, 81920
  s_add_u32 s40, s40, s84
  ds_read_b128 a[212:215], v120 offset:14336
  v_mfma_f32_16x16x32_bf16 v[180:183], a[240:243], a[120:123], v[180:183]
  buffer_load_dwordx4 v3, s[52:55], s40 offen offset:0 sc1 lds
  v_mfma_f32_16x16x32_bf16 v[188:191], a[248:251], a[120:123], v[188:191]
  ds_read_b128 a[216:219], v120 offset:5120
  v_mfma_f32_16x16x32_bf16 v[188:191], a[252:255], a[124:127], v[188:191]
  v_mfma_f32_16x16x32_bf16 v[184:187], a[252:255], a[116:119], v[184:187]
  ds_read_b128 a[220:223], v120 offset:15360
  v_mfma_f32_16x16x32_bf16 v[184:187], a[248:251], a[112:115], v[184:187]
  s_waitcnt lgkmcnt(4)
  buffer_load_dwordx4 v3, s[52:55], s40 offen offset:1024 sc1 lds
  v_mfma_f32_16x16x32_bf16 v[192:195], a[192:195], a[112:115], v[192:195]
  ds_read_b128 a[224:227], v120 offset:6144
  v_mfma_f32_16x16x32_bf16 v[192:195], a[196:199], a[116:119], v[192:195]
  v_mfma_f32_16x16x32_bf16 v[196:199], a[196:199], a[124:127], v[196:199]
  ds_read_b128 a[228:231], v120 offset:16384
  v_mfma_f32_16x16x32_bf16 v[196:199], a[192:195], a[120:123], v[196:199]
  buffer_load_dwordx4 v3, s[52:55], s40 offen offset:2048 sc1 lds
  v_mfma_f32_16x16x32_bf16 v[204:207], a[200:203], a[120:123], v[204:207]
  ds_read_b128 a[232:235], v120 offset:7168
  v_mfma_f32_16x16x32_bf16 v[204:207], a[204:207], a[124:127], v[204:207]
  v_mfma_f32_16x16x32_bf16 v[200:203], a[204:207], a[116:119], v[200:203]
  ds_read_b128 a[236:239], v120 offset:17408
  v_mfma_f32_16x16x32_bf16 v[200:203], a[200:203], a[112:115], v[200:203]
  s_waitcnt lgkmcnt(4)
  v_mfma_f32_16x16x32_bf16 v[208:211], a[208:211], a[112:115], v[208:211]
  ds_read_b128 a[240:243], v120 offset:8192
  v_mfma_f32_16x16x32_bf16 v[208:211], a[212:215], a[116:119], v[208:211]
  buffer_load_dwordx4 v3, s[52:55], s40 offen offset:3072 sc1 lds
  v_mfma_f32_16x16x32_bf16 v[212:215], a[212:215], a[124:127], v[212:215]
  s_add_u32 m0, s42, 24576
  ds_read_b128 a[244:247], v120 offset:18432
  v_mfma_f32_16x16x32_bf16 v[212:215], a[208:211], a[120:123], v[212:215]
  v_mfma_f32_16x16x32_bf16 v[220:223], a[216:219], a[120:123], v[220:223]
  s_add_u32 s40, s40, 4096
  ds_read_b128 a[248:251], v120 offset:9216
  v_mfma_f32_16x16x32_bf16 v[220:223], a[220:223], a[124:127], v[220:223]
  buffer_load_dwordx4 v3, s[52:55], s40 offen offset:0 sc1 lds
  v_mfma_f32_16x16x32_bf16 v[216:219], a[220:223], a[116:119], v[216:219]
  s_add_u32 m0, s42, 122880
  ds_read_b128 a[252:255], v120 offset:19456
  v_mfma_f32_16x16x32_bf16 v[216:219], a[216:219], a[112:115], v[216:219]
  s_waitcnt lgkmcnt(4)
  s_bfe_u32 s40, s79, 262156
  s_mul_i32 s40, s40, 81920
  s_add_u32 s40, s40, s84
  v_mfma_f32_16x16x32_bf16 v[224:227], a[224:227], a[112:115], v[224:227]
  buffer_load_dwordx4 v3, s[52:55], s40 offen offset:0 sc1 lds
  v_mfma_f32_16x16x32_bf16 v[224:227], a[228:231], a[116:119], v[224:227]
  v_mfma_f32_16x16x32_bf16 v[228:231], a[228:231], a[124:127], v[228:231]
  v_mfma_f32_16x16x32_bf16 v[228:231], a[224:227], a[120:123], v[228:231]
  s_waitcnt vmcnt(17)
  s_barrier
  v_mfma_f32_16x16x32_bf16 v[236:239], a[232:235], a[120:123], v[236:239]
  ds_read_b128 a[192:195], v121 offset:20480
  v_mfma_f32_16x16x32_bf16 v[236:239], a[236:239], a[124:127], v[236:239]
  ds_read_b128 a[196:199], v121 offset:30720
  v_mfma_f32_16x16x32_bf16 v[232:235], a[236:239], a[116:119], v[232:235]
  ds_read_b128 a[200:203], v121 offset:21504
  v_mfma_f32_16x16x32_bf16 v[232:235], a[232:235], a[112:115], v[232:235]
  s_waitcnt lgkmcnt(3)
  ds_read_b128 a[204:207], v121 offset:31744
  v_mfma_f32_16x16x32_bf16 v[240:243], a[240:243], a[112:115], v[240:243]
  ds_read_b128 a[208:211], v121 offset:22528
  v_mfma_f32_16x16x32_bf16 v[240:243], a[244:247], a[116:119], v[240:243]
  buffer_load_dwordx4 v3, s[52:55], s40 offen offset:1024 sc1 lds
  v_mfma_f32_16x16x32_bf16 v[244:247], a[244:247], a[124:127], v[244:247]
  ds_read_b128 a[212:215], v121 offset:32768
  v_mfma_f32_16x16x32_bf16 v[244:247], a[240:243], a[120:123], v[244:247]
  buffer_load_dwordx4 v3, s[52:55], s40 offen offset:2048 sc1 lds
  v_mfma_f32_16x16x32_bf16 v[252:255], a[248:251], a[120:123], v[252:255]
  ds_read_b128 a[216:219], v121 offset:23552
  v_mfma_f32_16x16x32_bf16 v[252:255], a[252:255], a[124:127], v[252:255]
  s_waitcnt vmcnt(14)
  buffer_load_dwordx4 v3, s[52:55], s40 offen offset:3072 sc1 lds
  v_mfma_f32_16x16x32_bf16 v[248:251], a[252:255], a[116:119], v[248:251]
  s_add_u32 m0, s42, 126976
  s_add_u32 s40, s40, 4096
  ds_read_b128 a[220:223], v121 offset:33792
  v_mfma_f32_16x16x32_bf16 v[248:251], a[248:251], a[112:115], v[248:251]
  s_waitcnt lgkmcnt(4)
  buffer_load_dwordx4 v3, s[52:55], s40 offen offset:0 sc1 lds
  v_mfma_f32_16x16x32_bf16 v[176:179], a[192:195], a[128:131], v[176:179]
  s_xor_b32 s3, s97, 5632
  ds_read_b128 a[224:227], v121 offset:24576
  v_mfma_f32_16x16x32_bf16 v[176:179], a[196:199], a[132:135], v[176:179]
  buffer_load_dwordx2 v[136:137], v114, s[32:35], s3 offen offset:2048 sc1
  v_mfma_f32_16x16x32_bf16 v[180:183], a[196:199], a[140:143], v[180:183]
  ds_read_b128 a[228:231], v121 offset:34816
  v_mfma_f32_16x16x32_bf16 v[180:183], a[192:195], a[136:139], v[180:183]
  v_mfma_f32_16x16x32_bf16 v[188:191], a[200:203], a[136:139], v[188:191]
  s_xor_b32 s3, s97, 6144
  ds_read_b128 a[232:235], v121 offset:25600
  v_mfma_f32_16x16x32_bf16 v[188:191], a[204:207], a[140:143], v[188:191]
  buffer_load_dwordx2 v[146:147], v114, s[32:35], s3 offen offset:2048 sc1
  v_mfma_f32_16x16x32_bf16 v[184:187], a[204:207], a[132:135], v[184:187]
  s_bfe_u32 s41, s79, 262152
  s_mul_i32 s41, s41, 262144
  s_add_u32 s41, s41, s85
  ds_read_b128 a[236:239], v121 offset:35840
  v_mfma_f32_16x16x32_bf16 v[184:187], a[200:203], a[128:131], v[184:187]
  s_waitcnt lgkmcnt(4)
  buffer_load_dwordx4 a[160:163], v112, s[32:35], s41 offen offset:0 sc1
  v_mfma_f32_16x16x32_bf16 v[192:195], a[208:211], a[128:131], v[192:195]
  ds_read_b128 a[240:243], v121 offset:26624
  v_mfma_f32_16x16x32_bf16 v[192:195], a[212:215], a[132:135], v[192:195]
  buffer_load_dwordx4 a[164:167], v112, s[32:35], s41 offen offset:1024 sc1
  v_mfma_f32_16x16x32_bf16 v[196:199], a[212:215], a[140:143], v[196:199]
  ds_read_b128 a[244:247], v121 offset:36864
  v_mfma_f32_16x16x32_bf16 v[196:199], a[208:211], a[136:139], v[196:199]
  buffer_load_dwordx4 a[168:171], v113, s[32:35], s41 offen offset:0 sc1
  v_mfma_f32_16x16x32_bf16 v[204:207], a[216:219], a[136:139], v[204:207]
  ds_read_b128 a[248:251], v121 offset:27648
  v_mfma_f32_16x16x32_bf16 v[204:207], a[220:223], a[140:143], v[204:207]
  buffer_load_dwordx4 a[172:175], v113, s[32:35], s41 offen offset:1024 sc1
  v_mfma_f32_16x16x32_bf16 v[200:203], a[220:223], a[132:135], v[200:203]
  s_xor_b32 s3, s97, 6656
  ds_read_b128 a[252:255], v121 offset:37888
  v_mfma_f32_16x16x32_bf16 v[200:203], a[216:219], a[128:131], v[200:203]
  s_waitcnt lgkmcnt(4)
  buffer_load_dwordx2 v[156:157], v114, s[32:35], s3 offen offset:2048 sc1
  v_mfma_f32_16x16x32_bf16 v[208:211], a[224:227], a[128:131], v[208:211]
  s_add_u32 m0, s42, 40960
  ds_read_b128 a[192:195], v121 offset:28672
  v_mfma_f32_16x16x32_bf16 v[208:211], a[228:231], a[132:135], v[208:211]
  v_mfma_f32_16x16x32_bf16 v[212:215], a[228:231], a[140:143], v[212:215]
  s_bfe_u32 s40, s79, 262160
  s_mul_i32 s40, s40, 81920
  s_add_u32 s40, s40, s84
  ds_read_b128 a[196:199], v121 offset:38912
  v_mfma_f32_16x16x32_bf16 v[212:215], a[224:227], a[136:139], v[212:215]
  buffer_load_dwordx4 v3, s[52:55], s40 offen offset:0 sc1 lds
  v_mfma_f32_16x16x32_bf16 v[220:223], a[232:235], a[136:139], v[220:223]
  ds_read_b128 a[200:203], v121 offset:29696
  v_mfma_f32_16x16x32_bf16 v[220:223], a[236:239], a[140:143], v[220:223]
  v_mfma_f32_16x16x32_bf16 v[216:219], a[236:239], a[132:135], v[216:219]
  ds_read_b128 a[204:207], v121 offset:39936
  v_mfma_f32_16x16x32_bf16 v[216:219], a[232:235], a[128:131], v[216:219]
  s_waitcnt lgkmcnt(4)
  buffer_load_dwordx4 v3, s[52:55], s40 offen offset:1024 sc1 lds
  v_mfma_f32_16x16x32_bf16 v[224:227], a[240:243], a[128:131], v[224:227]
  ds_read_b128 a[208:211], v119 offset:0
  v_mfma_f32_16x16x32_bf16 v[224:227], a[244:247], a[132:135], v[224:227]
  v_mfma_f32_16x16x32_bf16 v[228:231], a[244:247], a[140:143], v[228:231]
  ds_read_b128 a[212:215], v119 offset:10240
  v_mfma_f32_16x16x32_bf16 v[228:231], a[240:243], a[136:139], v[228:231]
  buffer_load_dwordx4 v3, s[52:55], s40 offen offset:2048 sc1 lds
  v_mfma_f32_16x16x32_bf16 v[236:239], a[248:251], a[136:139], v[236:239]
  ds_read_b128 a[216:219], v119 offset:1024
  v_mfma_f32_16x16x32_bf16 v[236:239], a[252:255], a[140:143], v[236:239]
  v_mfma_f32_16x16x32_bf16 v[232:235], a[252:255], a[132:135], v[232:235]
  ds_read_b128 a[220:223], v119 offset:11264
  v_mfma_f32_16x16x32_bf16 v[232:235], a[248:251], a[128:131], v[232:235]
  s_waitcnt lgkmcnt(4)
  buffer_load_dwordx4 v3, s[52:55], s40 offen offset:3072 sc1 lds
  v_mfma_f32_16x16x32_bf16 v[240:243], a[192:195], a[128:131], v[240:243]
  s_add_u32 m0, s42, 45056
  ds_read_b128 a[224:227], v119 offset:2048
  v_mfma_f32_16x16x32_bf16 v[240:243], a[196:199], a[132:135], v[240:243]
  v_mfma_f32_16x16x32_bf16 v[244:247], a[196:199], a[140:143], v[244:247]
  s_add_u32 s40, s40, 4096
  ds_read_b128 a[228:231], v119 offset:12288
  v_mfma_f32_16x16x32_bf16 v[244:247], a[192:195], a[136:139], v[244:247]
  buffer_load_dwordx4 v3, s[52:55], s40 offen offset:0 sc1 lds
  v_mfma_f32_16x16x32_bf16 v[252:255], a[200:203], a[136:139], v[252:255]
  s_add_u32 m0, s42, 102400
  s_bfe_u32 s40, s79, 262164
  s_mul_i32 s40, s40, 81920
  s_add_u32 s40, s40, s84
  ds_read_b128 a[232:235], v119 offset:3072
  v_mfma_f32_16x16x32_bf16 v[252:255], a[204:207], a[140:143], v[252:255]
  s_waitcnt vmcnt(22)
  buffer_load_dwordx4 v3, s[52:55], s40 offen offset:0 sc1 lds
  v_mfma_f32_16x16x32_bf16 v[248:251], a[204:207], a[132:135], v[248:251]
  ds_read_b128 a[236:239], v119 offset:13312
  v_mfma_f32_16x16x32_bf16 v[248:251], a[200:203], a[128:131], v[248:251]
  s_waitcnt lgkmcnt(4)
  buffer_load_dwordx4 v3, s[52:55], s40 offen offset:1024 sc1 lds
  v_mfma_f32_16x16x32_bf16 v[176:179], a[208:211], a[144:147], v[176:179]
  ds_read_b128 a[240:243], v119 offset:4096
  v_mfma_f32_16x16x32_bf16 v[176:179], a[212:215], a[148:151], v[176:179]
  buffer_load_dwordx4 v3, s[52:55], s40 offen offset:2048 sc1 lds
  v_mfma_f32_16x16x32_bf16 v[180:183], a[212:215], a[156:159], v[180:183]
  ds_read_b128 a[244:247], v119 offset:14336
  v_mfma_f32_16x16x32_bf16 v[180:183], a[208:211], a[152:155], v[180:183]
  buffer_load_dwordx4 v3, s[52:55], s40 offen offset:3072 sc1 lds
  v_mfma_f32_16x16x32_bf16 v[188:191], a[216:219], a[152:155], v[188:191]
  s_add_u32 m0, s42, 106496
  s_add_u32 s40, s40, 4096
  ds_read_b128 a[248:251], v119 offset:5120
  v_mfma_f32_16x16x32_bf16 v[188:191], a[220:223], a[156:159], v[188:191]
  buffer_load_dwordx4 v3, s[52:55], s40 offen offset:0 sc1 lds
  v_mfma_f32_16x16x32_bf16 v[184:187], a[220:223], a[148:151], v[184:187]
  s_bfe_u32 s41, s79, 262156
  s_mul_i32 s41, s41, 262144
  s_add_u32 s41, s41, s85
  ds_read_b128 a[252:255], v119 offset:15360
  v_mfma_f32_16x16x32_bf16 v[184:187], a[216:219], a[144:147], v[184:187]
  s_waitcnt lgkmcnt(4)
  buffer_load_dwordx4 a[176:179], v112, s[32:35], s41 offen offset:0 sc1
  v_mfma_f32_16x16x32_bf16 v[192:195], a[224:227], a[144:147], v[192:195]
  ds_read_b128 a[192:195], v119 offset:6144
  v_mfma_f32_16x16x32_bf16 v[192:195], a[228:231], a[148:151], v[192:195]
  buffer_load_dwordx4 a[180:183], v112, s[32:35], s41 offen offset:1024 sc1
  v_mfma_f32_16x16x32_bf16 v[196:199], a[228:231], a[156:159], v[196:199]
  ds_read_b128 a[196:199], v119 offset:16384
  v_mfma_f32_16x16x32_bf16 v[196:199], a[224:227], a[152:155], v[196:199]
  buffer_load_dwordx4 a[184:187], v113, s[32:35], s41 offen offset:0 sc1
  v_mfma_f32_16x16x32_bf16 v[204:207], a[232:235], a[152:155], v[204:207]
  ds_read_b128 a[200:203], v119 offset:7168
  v_mfma_f32_16x16x32_bf16 v[204:207], a[236:239], a[156:159], v[204:207]
  buffer_load_dwordx4 a[188:191], v113, s[32:35], s41 offen offset:1024 sc1
  v_mfma_f32_16x16x32_bf16 v[200:203], a[236:239], a[148:151], v[200:203]
  s_bfe_u32 s41, s79, 262160
  s_mul_i32 s41, s41, 262144
  s_add_u32 s41, s41, s85
  ds_read_b128 a[204:207], v119 offset:17408
  v_mfma_f32_16x16x32_bf16 v[200:203], a[232:235], a[144:147], v[200:203]
  s_waitcnt lgkmcnt(4)
  buffer_load_dwordx4 a[80:83], v112, s[32:35], s41 offen offset:0 sc1
  v_mfma_f32_16x16x32_bf16 v[208:211], a[240:243], a[144:147], v[208:211]
  ds_read_b128 a[208:211], v119 offset:8192
  v_mfma_f32_16x16x32_bf16 v[208:211], a[244:247], a[148:151], v[208:211]
  buffer_load_dwordx4 a[84:87], v112, s[32:35], s41 offen offset:1024 sc1
  v_mfma_f32_16x16x32_bf16 v[212:215], a[244:247], a[156:159], v[212:215]
  ds_read_b128 a[212:215], v119 offset:18432
  v_mfma_f32_16x16x32_bf16 v[212:215], a[240:243], a[152:155], v[212:215]
  buffer_load_dwordx4 a[88:91], v113, s[32:35], s41 offen offset:0 sc1
  v_mfma_f32_16x16x32_bf16 v[220:223], a[248:251], a[152:155], v[220:223]
  ds_read_b128 a[216:219], v119 offset:9216
  v_mfma_f32_16x16x32_bf16 v[220:223], a[252:255], a[156:159], v[220:223]
  buffer_load_dwordx4 a[92:95], v113, s[32:35], s41 offen offset:1024 sc1
  v_mfma_f32_16x16x32_bf16 v[216:219], a[252:255], a[148:151], v[216:219]
  s_bfe_u32 s41, s79, 262164
  s_mul_i32 s41, s41, 262144
  s_add_u32 s41, s41, s85
  ds_read_b128 a[220:223], v119 offset:19456
  v_mfma_f32_16x16x32_bf16 v[216:219], a[248:251], a[144:147], v[216:219]
  s_waitcnt lgkmcnt(4)
  buffer_load_dwordx4 a[96:99], v112, s[32:35], s41 offen offset:0 sc1
  v_mfma_f32_16x16x32_bf16 v[224:227], a[192:195], a[144:147], v[224:227]
  v_mfma_f32_16x16x32_bf16 v[224:227], a[196:199], a[148:151], v[224:227]
  buffer_load_dwordx4 a[100:103], v112, s[32:35], s41 offen offset:1024 sc1
  v_mfma_f32_16x16x32_bf16 v[228:231], a[196:199], a[156:159], v[228:231]
  v_mfma_f32_16x16x32_bf16 v[228:231], a[192:195], a[152:155], v[228:231]
  s_waitcnt vmcnt(27)
  s_barrier
  buffer_load_dwordx4 a[104:107], v113, s[32:35], s41 offen offset:0 sc1
  v_mfma_f32_16x16x32_bf16 v[236:239], a[200:203], a[152:155], v[236:239]
  ds_read_b128 a[224:227], v119 offset:20480
  v_mfma_f32_16x16x32_bf16 v[236:239], a[204:207], a[156:159], v[236:239]
  ds_read_b128 a[228:231], v119 offset:30720
  v_mfma_f32_16x16x32_bf16 v[232:235], a[204:207], a[148:151], v[232:235]
  ds_read_b128 a[232:235], v119 offset:21504
  v_mfma_f32_16x16x32_bf16 v[232:235], a[200:203], a[144:147], v[232:235]
  s_waitcnt lgkmcnt(3)
  ds_read_b128 a[236:239], v119 offset:31744
  v_mfma_f32_16x16x32_bf16 v[240:243], a[208:211], a[144:147], v[240:243]
  ds_read_b128 a[240:243], v119 offset:22528
  v_mfma_f32_16x16x32_bf16 v[240:243], a[212:215], a[148:151], v[240:243]
  buffer_load_dwordx4 a[108:111], v113, s[32:35], s41 offen offset:1024 sc1
  v_mfma_f32_16x16x32_bf16 v[244:247], a[212:215], a[156:159], v[244:247]
  ds_read_b128 a[244:247], v119 offset:32768
  v_mfma_f32_16x16x32_bf16 v[244:247], a[208:211], a[152:155], v[244:247]
  buffer_load_dwordx2 v[28:29], v123, s[20:23], s28 offen offset:0
  v_mfma_f32_16x16x32_bf16 v[252:255], a[216:219], a[152:155], v[252:255]
  ds_read_b128 a[248:251], v119 offset:23552
  v_mfma_f32_16x16x32_bf16 v[252:255], a[220:223], a[156:159], v[252:255]
  s_waitcnt vmcnt(24)
  buffer_load_dwordx4 v[30:33], v38, s[20:23], s28 offen offset:32
  v_mfma_f32_16x16x32_bf16 v[248:251], a[220:223], a[148:151], v[248:251]
  ds_read_b128 a[252:255], v119 offset:33792
  v_mfma_f32_16x16x32_bf16 v[248:251], a[216:219], a[144:147], v[248:251]
  s_waitcnt lgkmcnt(4)
  s_waitcnt vmcnt(24)
  v_max3_u32 v96, v136, v137, v146
  v_max3_u32 v96, v96, v147, v156
  v_max_u32 v96, v96, v157
  v_cmp_eq_u32 vcc, -1, v96
  s_nop 1
  s_cbranch_vccnz L_gw_1
L_gw_ok_1:
  v_mfma_f32_16x16x32_bf16 v[176:179], a[224:227], a[160:163], v[176:179]
  ds_read_b128 a[192:195], v119 offset:24576
  v_mfma_f32_16x16x32_bf16 v[176:179], a[228:231], a[164:167], v[176:179]
  buffer_load_dwordx4 v[34:37], v38, s[20:23], s28 offen offset:96
  v_mfma_f32_16x16x32_bf16 v[180:183], a[228:231], a[172:175], v[180:183]
  s_xor_b32 s3, s97, 9216
  ds_read_b128 a[196:199], v119 offset:34816
  v_mfma_f32_16x16x32_bf16 v[180:183], a[224:227], a[168:171], v[180:183]
  buffer_load_dwordx4 v[128:131], v3, s[32:35], s3 offen offset:0 sc1
  v_mfma_f32_16x16x32_bf16 v[188:191], a[232:235], a[168:171], v[188:191]
  ds_read_b128 a[200:203], v119 offset:25600
  v_mfma_f32_16x16x32_bf16 v[188:191], a[236:239], a[172:175], v[188:191]
  buffer_load_dwordx4 v[132:135], v3, s[32:35], s3 offen offset:1024 sc1
  v_mfma_f32_16x16x32_bf16 v[184:187], a[236:239], a[164:167], v[184:187]
  ds_read_b128 a[204:207], v119 offset:35840
  v_mfma_f32_16x16x32_bf16 v[184:187], a[232:235], a[160:163], v[184:187]
  s_waitcnt lgkmcnt(4)
  v_mfma_f32_16x16x32_bf16 v[192:195], a[240:243], a[160:163], v[192:195]
  s_xor_b32 s3, s97, 11264
  ds_read_b128 a[208:211], v119 offset:26624
  v_mfma_f32_16x16x32_bf16 v[192:195], a[244:247], a[164:167], v[192:195]
  buffer_load_dwordx4 v[138:141], v3, s[32:35], s3 offen offset:0 sc1
  v_mfma_f32_16x16x32_bf16 v[196:199], a[244:247], a[172:175], v[196:199]
  ds_read_b128 a[212:215], v119 offset:36864
  v_mfma_f32_16x16x32_bf16 v[196:199], a[240:243], a[168:171], v[196:199]
  v_mfma_f32_16x16x32_bf16 v[204:207], a[248:251], a[168:171], v[204:207]
  ds_read_b128 a[216:219], v119 offset:27648
  v_mfma_f32_16x16x32_bf16 v[204:207], a[252:255], a[172:175], v[204:207]
  buffer_load_dwordx4 v[142:145], v3, s[32:35], s3 offen offset:1024 sc1
  v_mfma_f32_16x16x32_bf16 v[200:203], a[252:255], a[164:167], v[200:203]
  ds_read_b128 a[220:223], v119 offset:37888
  v_mfma_f32_16x16x32_bf16 v[200:203], a[248:251], a[160:163], v[200:203]
  s_waitcnt lgkmcnt(4)
  v_mfma_f32_16x16x32_bf16 v[208:211], a[192:195], a[160:163], v[208:211]
  s_xor_b32 s3, s97, 13312
  ds_read_b128 a[224:227], v119 offset:28672
  v_mfma_f32_16x16x32_bf16 v[208:211], a[196:199], a[164:167], v[208:211]
  buffer_load_dwordx4 v[148:151], v3, s[32:35], s3 offen offset:0 sc1
  v_mfma_f32_16x16x32_bf16 v[212:215], a[196:199], a[172:175], v[212:215]
  ds_read_b128 a[228:231], v119 offset:38912
  v_mfma_f32_16x16x32_bf16 v[212:215], a[192:195], a[168:171], v[212:215]
  v_mfma_f32_16x16x32_bf16 v[220:223], a[200:203], a[168:171], v[220:223]
  ds_read_b128 a[232:235], v119 offset:29696
  v_mfma_f32_16x16x32_bf16 v[220:223], a[204:207], a[172:175], v[220:223]
  buffer_load_dwordx4 v[152:155], v3, s[32:35], s3 offen offset:1024 sc1
  v_mfma_f32_16x16x32_bf16 v[216:219], a[204:207], a[164:167], v[216:219]
  ds_read_b128 a[236:239], v119 offset:39936
  v_mfma_f32_16x16x32_bf16 v[216:219], a[200:203], a[160:163], v[216:219]
  s_waitcnt lgkmcnt(4)
  v_mfma_f32_16x16x32_bf16 v[224:227], a[208:211], a[160:163], v[224:227]
  v_mfma_f32_16x16x32_bf16 v[224:227], a[212:215], a[164:167], v[224:227]
  v_mfma_f32_16x16x32_bf16 v[228:231], a[212:215], a[172:175], v[228:231]
  v_mfma_f32_16x16x32_bf16 v[228:231], a[208:211], a[168:171], v[228:231]
  s_waitcnt vmcnt(21)
  s_barrier
  v_mfma_f32_16x16x32_bf16 v[236:239], a[216:219], a[168:171], v[236:239]
  ds_read_b128 a[240:243], v121 offset:5120
  v_mfma_f32_16x16x32_bf16 v[236:239], a[220:223], a[172:175], v[236:239]
  ds_read_b128 a[244:247], v121 offset:15360
  v_mfma_f32_16x16x32_bf16 v[232:235], a[220:223], a[164:167], v[232:235]
  ds_read_b128 a[248:251], v119 offset:46080
  v_mfma_f32_16x16x32_bf16 v[232:235], a[216:219], a[160:163], v[232:235]
  s_waitcnt lgkmcnt(3)
  ds_read_b128 a[252:255], v119 offset:56320
  v_mfma_f32_16x16x32_bf16 v[240:243], a[224:227], a[160:163], v[240:243]
  ds_read_b128 a[192:195], v120 offset:46080
  v_mfma_f32_16x16x32_bf16 v[240:243], a[228:231], a[164:167], v[240:243]
  v_mfma_f32_16x16x32_bf16 v[244:247], a[228:231], a[172:175], v[244:247]
  ds_read_b128 a[196:199], v120 offset:56320
  v_mfma_f32_16x16x32_bf16 v[244:247], a[224:227], a[168:171], v[244:247]
  v_mfma_f32_16x16x32_bf16 v[252:255], a[232:235], a[168:171], v[252:255]
  ds_read_b128 a[200:203], v121 offset:6144
  v_mfma_f32_16x16x32_bf16 v[252:255], a[236:239], a[172:175], v[252:255]
  s_waitcnt vmcnt(9)
  v_mfma_f32_16x16x32_bf16 v[248:251], a[236:239], a[164:167], v[248:251]
  ds_read_b128 a[204:207], v121 offset:16384
  v_mfma_f32_16x16x32_bf16 v[248:251], a[232:235], a[160:163], v[248:251]
  s_waitcnt lgkmcnt(4)
  v_mfma_f32_16x16x32_bf16 v[220:223], a[240:243], a[184:187], v[220:223]
  ds_read_b128 a[208:211], v119 offset:47104
  v_mfma_f32_16x16x32_bf16 v[220:223], a[244:247], a[188:191], v[220:223]
  v_mfma_f32_16x16x32_bf16 v[216:219], a[244:247], a[180:183], v[216:219]
  ds_read_b128 a[212:215], v119 offset:57344
  v_mfma_f32_16x16x32_bf16 v[216:219], a[240:243], a[176:179], v[216:219]
  v_mfma_f32_16x16x32_bf16 v[216:219], a[248:251], a[80:83], v[216:219]
  ds_read_b128 a[216:219], v120 offset:47104
  v_mfma_f32_16x16x32_bf16 v[216:219], a[252:255], a[84:87], v[216:219]
  v_mfma_f32_16x16x32_bf16 v[220:223], a[252:255], a[92:95], v[220:223]
  ds_read_b128 a[220:223], v120 offset:57344
  v_mfma_f32_16x16x32_bf16 v[220:223], a[248:251], a[88:91], v[220:223]
  s_waitcnt lgkmcnt(4)
  v_mfma_f32_16x16x32_bf16 v[220:223], a[192:195], a[104:107], v[220:223]
  ds_read_b128 a[224:227], v121 offset:7168
  v_mfma_f32_16x16x32_bf16 v[220:223], a[196:199], a[108:111], v[220:223]
  v_mfma_f32_16x16x32_bf16 v[216:219], a[196:199], a[100:103], v[216:219]
  ds_read_b128 a[228:231], v121 offset:17408
  v_mfma_f32_16x16x32_bf16 v[216:219], a[192:195], a[96:99], v[216:219]
  v_mfma_f32_16x16x32_bf16 v[228:231], a[200:203], a[184:187], v[228:231]
  ds_read_b128 a[232:235], v119 offset:48128
  v_mfma_f32_16x16x32_bf16 v[228:231], a[204:207], a[188:191], v[228:231]
  v_mfma_f32_16x16x32_bf16 v[224:227], a[204:207], a[180:183], v[224:227]
  ds_read_b128 a[236:239], v119 offset:58368
  v_mfma_f32_16x16x32_bf16 v[224:227], a[200:203], a[176:179], v[224:227]
  s_waitcnt lgkmcnt(4)
  v_mfma_f32_16x16x32_bf16 v[224:227], a[208:211], a[80:83], v[224:227]
  ds_read_b128 a[240:243], v120 offset:48128
  v_mfma_f32_16x16x32_bf16 v[224:227], a[212:215], a[84:87], v[224:227]
  v_mfma_f32_16x16x32_bf16 v[228:231], a[212:215], a[92:95], v[228:231]
  ds_read_b128 a[244:247], v120 offset:58368
  v_mfma_f32_16x16x32_bf16 v[228:231], a[208:211], a[88:91], v[228:231]
  v_mfma_f32_16x16x32_bf16 v[228:231], a[216:219], a[104:107], v[228:231]
  ds_read_b128 a[248:251], v121 offset:8192
  v_mfma_f32_16x16x32_bf16 v[228:231], a[220:223], a[108:111], v[228:231]
  v_mfma_f32_16x16x32_bf16 v[224:227], a[220:223], a[100:103], v[224:227]
  ds_read_b128 a[252:255], v121 offset:18432
  v_mfma_f32_16x16x32_bf16 v[224:227], a[216:219], a[96:99], v[224:227]
  s_waitcnt lgkmcnt(4)
  v_mfma_f32_16x16x32_bf16 v[236:239], a[224:227], a[184:187], v[236:239]
  ds_read_b128 a[192:195], v119 offset:49152
  v_mfma_f32_16x16x32_bf16 v[236:239], a[228:231], a[188:191], v[236:239]
  v_cvt_pk_bf16_f32 v76, v220, v221
  v_cvt_pk_bf16_f32 v77, v222, v223
  v_mfma_f32_16x16x32_bf16 v[232:235], a[228:231], a[180:183], v[232:235]
  ds_read_b128 a[196:199], v119 offset:59392
  v_cvt_pk_bf16_f32 v78, v228, v229
  v_mfma_f32_16x16x32_bf16 v[232:235], a[224:227], a[176:179], v[232:235]
  v_cvt_pk_bf16_f32 v79, v230, v231
  v_mfma_f32_16x16x32_bf16 v[232:235], a[232:235], a[80:83], v[232:235]
  s_xor_b32 s3, s97, 54272
  ds_read_b128 a[200:203], v120 offset:49152
  v_mfma_f32_16x16x32_bf16 v[232:235], a[236:239], a[84:87], v[232:235]
  buffer_store_dwordx4 v[76:79], v3, s[32:35], s3 offen offset:0 sc1
  v_mfma_f32_16x16x32_bf16 v[236:239], a[236:239], a[92:95], v[236:239]
  ds_read_b128 a[204:207], v120 offset:59392
  v_cvt_pk_bf16_f32 v80, v216, v217
  v_mfma_f32_16x16x32_bf16 v[236:239], a[232:235], a[88:91], v[236:239]
  s_waitcnt lgkmcnt(4)
  v_cvt_pk_bf16_f32 v81, v218, v219
  v_cvt_pk_bf16_f32 v82, v224, v225
  v_mfma_f32_16x16x32_bf16 v[236:239], a[240:243], a[104:107], v[236:239]
  s_xor_b32 s3, s97, 16384
  ds_read_b128 a[208:211], v121 offset:9216
  v_cvt_pk_bf16_f32 v83, v226, v227
  v_mfma_f32_16x16x32_bf16 v[236:239], a[244:247], a[108:111], v[236:239]
  buffer_store_dwordx4 v[80:83], v3, s[32:35], s3 offen offset:0 sc1
  v_mfma_f32_16x16x32_bf16 v[232:235], a[244:247], a[100:103], v[232:235]
  ds_read_b128 a[212:215], v121 offset:19456
  v_mfma_f32_16x16x32_bf16 v[232:235], a[240:243], a[96:99], v[232:235]
  v_mfma_f32_16x16x32_bf16 v[244:247], a[248:251], a[184:187], v[244:247]
  ds_read_b128 a[216:219], v119 offset:50176
  v_mfma_f32_16x16x32_bf16 v[244:247], a[252:255], a[188:191], v[244:247]
  v_mfma_f32_16x16x32_bf16 v[240:243], a[252:255], a[180:183], v[240:243]
  ds_read_b128 a[220:223], v119 offset:60416
  v_mfma_f32_16x16x32_bf16 v[240:243], a[248:251], a[176:179], v[240:243]
  s_waitcnt lgkmcnt(4)
  v_mfma_f32_16x16x32_bf16 v[240:243], a[192:195], a[80:83], v[240:243]
  ds_read_b128 a[224:227], v120 offset:50176
  v_mfma_f32_16x16x32_bf16 v[240:243], a[196:199], a[84:87], v[240:243]
  v_mfma_f32_16x16x32_bf16 v[244:247], a[196:199], a[92:95], v[244:247]
  ds_read_b128 a[228:231], v120 offset:60416
  v_mfma_f32_16x16x32_bf16 v[244:247], a[192:195], a[88:91], v[244:247]
  v_mfma_f32_16x16x32_bf16 v[244:247], a[200:203], a[104:107], v[244:247]
  ds_read_b128 a[232:235], v121 offset:0
  v_mfma_f32_16x16x32_bf16 v[244:247], a[204:207], a[108:111], v[244:247]
  v_mfma_f32_16x16x32_bf16 v[240:243], a[204:207], a[100:103], v[240:243]
  ds_read_b128 a[236:239], v121 offset:10240
  v_mfma_f32_16x16x32_bf16 v[240:243], a[200:203], a[96:99], v[240:243]
  s_waitcnt lgkmcnt(4)
  v_mfma_f32_16x16x32_bf16 v[252:255], a[208:211], a[184:187], v[252:255]
  ds_read_b128 a[240:243], v119 offset:40960
  v_mfma_f32_16x16x32_bf16 v[252:255], a[212:215], a[188:191], v[252:255]
  v_cvt_pk_bf16_f32 v84, v236, v237
  v_cvt_pk_bf16_f32 v85, v238, v239
  v_mfma_f32_16x16x32_bf16 v[248:251], a[212:215], a[180:183], v[248:251]
  ds_read_b128 a[244:247], v119 offset:51200
  v_cvt_pk_bf16_f32 v86, v244, v245
  v_mfma_f32_16x16x32_bf16 v[248:251], a[208:211], a[176:179], v[248:251]
  v_cvt_pk_bf16_f32 v87, v246, v247
  v_mfma_f32_16x16x32_bf16 v[248:251], a[216:219], a[80:83], v[248:251]
  s_xor_b32 s3, s97, 54272
  ds_read_b128 a[248:251], v120 offset:40960
  v_mfma_f32_16x16x32_bf16 v[248:251], a[220:223], a[84:87], v[248:251]
  buffer_store_dwordx4 v[84:87], v3, s[32:35], s3 offen offset:1024 sc1
  v_mfma_f32_16x16x32_bf16 v[252:255], a[220:223], a[92:95], v[252:255]
  ds_read_b128 a[252:255], v120 offset:51200
  v_cvt_pk_bf16_f32 v76, v232, v233
  v_mfma_f32_16x16x32_bf16 v[252:255], a[216:219], a[88:91], v[252:255]
  s_waitcnt lgkmcnt(4)
  v_cvt_pk_bf16_f32 v77, v234, v235
  v_cvt_pk_bf16_f32 v78, v240, v241
  v_mfma_f32_16x16x32_bf16 v[252:255], a[224:227], a[104:107], v[252:255]
  s_xor_b32 s3, s97, 16384
  ds_read_b128 a[192:195], v121 offset:1024
  v_cvt_pk_bf16_f32 v79, v242, v243
  v_mfma_f32_16x16x32_bf16 v[252:255], a[228:231], a[108:111], v[252:255]
  buffer_store_dwordx4 v[76:79], v3, s[32:35], s3 offen offset:1024 sc1
  v_mfma_f32_16x16x32_bf16 v[248:251], a[228:231], a[100:103], v[248:251]
  ds_read_b128 a[196:199], v121 offset:11264
  v_mfma_f32_16x16x32_bf16 v[248:251], a[224:227], a[96:99], v[248:251]
  v_mfma_f32_16x16x32_bf16 v[180:183], a[232:235], a[184:187], v[180:183]
  ds_read_b128 a[200:203], v119 offset:41984
  v_mfma_f32_16x16x32_bf16 v[180:183], a[236:239], a[188:191], v[180:183]
  s_nop 0
  v_cvt_pk_bf16_f32 v80, v252, v253
  v_cvt_pk_bf16_f32 v81, v254, v255
  v_mfma_f32_16x16x32_bf16 v[176:179], a[236:239], a[180:183], v[176:179]
  s_xor_b32 s3, s97, 54272
  ds_read_b128 a[204:207], v119 offset:52224
  v_mfma_f32_16x16x32_bf16 v[176:179], a[232:235], a[176:179], v[176:179]
  s_waitcnt lgkmcnt(4)
  buffer_store_dwordx2 v[80:81], v114, s[32:35], s3 offen offset:2048 sc1
  v_mfma_f32_16x16x32_bf16 v[176:179], a[240:243], a[80:83], v[176:179]
  ds_read_b128 a[208:211], v120 offset:41984
  v_cvt_pk_bf16_f32 v84, v248, v249
  v_mfma_f32_16x16x32_bf16 v[176:179], a[244:247], a[84:87], v[176:179]
  v_cvt_pk_bf16_f32 v85, v250, v251
  v_mfma_f32_16x16x32_bf16 v[180:183], a[244:247], a[92:95], v[180:183]
  s_xor_b32 s3, s97, 16384
  ds_read_b128 a[212:215], v120 offset:52224
  v_mfma_f32_16x16x32_bf16 v[180:183], a[240:243], a[88:91], v[180:183]
  buffer_store_dwordx2 v[84:85], v114, s[32:35], s3 offen offset:2048 sc1
  v_mfma_f32_16x16x32_bf16 v[180:183], a[248:251], a[104:107], v[180:183]
  ds_read_b128 a[216:219], v121 offset:2048
  v_mfma_f32_16x16x32_bf16 v[180:183], a[252:255], a[108:111], v[180:183]
  v_mfma_f32_16x16x32_bf16 v[176:179], a[252:255], a[100:103], v[176:179]
  ds_read_b128 a[220:223], v121 offset:12288
  v_mfma_f32_16x16x32_bf16 v[176:179], a[248:251], a[96:99], v[176:179]
  s_waitcnt lgkmcnt(4)
  v_mfma_f32_16x16x32_bf16 v[188:191], a[192:195], a[184:187], v[188:191]
  ds_read_b128 a[224:227], v119 offset:43008
  v_mfma_f32_16x16x32_bf16 v[188:191], a[196:199], a[188:191], v[188:191]
  v_mfma_f32_16x16x32_bf16 v[184:187], a[196:199], a[180:183], v[184:187]
  ds_read_b128 a[228:231], v119 offset:53248
  v_mfma_f32_16x16x32_bf16 v[184:187], a[192:195], a[176:179], v[184:187]
  v_mfma_f32_16x16x32_bf16 v[184:187], a[200:203], a[80:83], v[184:187]
  ds_read_b128 a[232:235], v120 offset:43008
  v_mfma_f32_16x16x32_bf16 v[184:187], a[204:207], a[84:87], v[184:187]
  v_mfma_f32_16x16x32_bf16 v[188:191], a[204:207], a[92:95], v[188:191]
  ds_read_b128 a[236:239], v120 offset:53248
  v_mfma_f32_16x16x32_bf16 v[188:191], a[200:203], a[88:91], v[188:191]
  s_waitcnt lgkmcnt(4)
  v_mfma_f32_16x16x32_bf16 v[188:191], a[208:211], a[104:107], v[188:191]
  ds_read_b128 a[240:243], v121 offset:3072
  v_mfma_f32_16x16x32_bf16 v[188:191], a[212:215], a[108:111], v[188:191]
  v_mfma_f32_16x16x32_bf16 v[184:187], a[212:215], a[100:103], v[184:187]
  ds_read_b128 a[244:247], v121 offset:13312
  v_mfma_f32_16x16x32_bf16 v[184:187], a[208:211], a[96:99], v[184:187]
  v_mfma_f32_16x16x32_bf16 v[196:199], a[216:219], a[184:187], v[196:199]
  ds_read_b128 a[248:251], v119 offset:44032
  v_mfma_f32_16x16x32_bf16 v[196:199], a[220:223], a[188:191], v[196:199]
  v_cvt_pk_bf16_f32 v76, v180, v181
  v_cvt_pk_bf16_f32 v77, v182, v183
  v_mfma_f32_16x16x32_bf16 v[192:195], a[220:223], a[180:183], v[192:195]
  ds_read_b128 a[252:255], v119 offset:54272
  v_cvt_pk_bf16_f32 v78, v188, v189
  v_mfma_f32_16x16x32_bf16 v[192:195], a[216:219], a[176:179], v[192:195]
  s_waitcnt lgkmcnt(4)
  v_cvt_pk_bf16_f32 v79, v190, v191
L_pad_post12_1:
  s_cbranch_execz L_back1
  v_mfma_f32_16x16x32_bf16 v[192:195], a[224:227], a[80:83], v[192:195]
  s_xor_b32 s3, s97, 35328
  ds_read_b128 a[192:195], v120 offset:44032
  v_mfma_f32_16x16x32_bf16 v[192:195], a[228:231], a[84:87], v[192:195]
  buffer_store_dwordx4 v[76:79], v3, s[32:35], s3 offen offset:0 sc1
  v_mfma_f32_16x16x32_bf16 v[196:199], a[228:231], a[92:95], v[196:199]
  ds_read_b128 a[196:199], v120 offset:54272
  v_mfma_f32_16x16x32_bf16 v[196:199], a[224:227], a[88:91], v[196:199]
  v_mfma_f32_16x16x32_bf16 v[196:199], a[232:235], a[104:107], v[196:199]
  ds_read_b128 a[200:203], v121 offset:4096
  v_mfma_f32_16x16x32_bf16 v[196:199], a[236:239], a[108:111], v[196:199]
  v_mfma_f32_16x16x32_bf16 v[192:195], a[236:239], a[100:103], v[192:195]
  ds_read_b128 a[204:207], v121 offset:14336
  v_mfma_f32_16x16x32_bf16 v[192:195], a[232:235], a[96:99], v[192:195]
  s_waitcnt lgkmcnt(4)
  v_mfma_f32_16x16x32_bf16 v[204:207], a[240:243], a[184:187], v[204:207]
  ds_read_b128 a[208:211], v119 offset:45056
  v_mfma_f32_16x16x32_bf16 v[204:207], a[244:247], a[188:191], v[204:207]
  v_mfma_f32_16x16x32_bf16 v[200:203], a[244:247], a[180:183], v[200:203]
  ds_read_b128 a[212:215], v119 offset:55296
  v_mfma_f32_16x16x32_bf16 v[200:203], a[240:243], a[176:179], v[200:203]
  v_mfma_f32_16x16x32_bf16 v[200:203], a[248:251], a[80:83], v[200:203]
  ds_read_b128 a[216:219], v120 offset:45056
  v_mfma_f32_16x16x32_bf16 v[200:203], a[252:255], a[84:87], v[200:203]
  v_mfma_f32_16x16x32_bf16 v[204:207], a[252:255], a[92:95], v[204:207]
  ds_read_b128 a[220:223], v120 offset:55296
  v_mfma_f32_16x16x32_bf16 v[204:207], a[248:251], a[88:91], v[204:207]
  s_waitcnt lgkmcnt(4)
  v_mfma_f32_16x16x32_bf16 v[204:207], a[192:195], a[104:107], v[204:207]
  v_mfma_f32_16x16x32_bf16 v[204:207], a[196:199], a[108:111], v[204:207]
  v_mfma_f32_16x16x32_bf16 v[200:203], a[196:199], a[100:103], v[200:203]
  v_mfma_f32_16x16x32_bf16 v[200:203], a[192:195], a[96:99], v[200:203]
  v_mfma_f32_16x16x32_bf16 v[212:215], a[200:203], a[184:187], v[212:215]
  v_mfma_f32_16x16x32_bf16 v[212:215], a[204:207], a[188:191], v[212:215]
  v_cvt_pk_bf16_f32 v80, v196, v197
  v_cvt_pk_bf16_f32 v81, v198, v199
  v_mfma_f32_16x16x32_bf16 v[208:211], a[204:207], a[180:183], v[208:211]
  s_xor_b32 s3, s97, 35328
  v_cvt_pk_bf16_f32 v82, v204, v205
  v_cvt_pk_bf16_f32 v83, v206, v207
  v_mfma_f32_16x16x32_bf16 v[208:211], a[200:203], a[176:179], v[208:211]
  s_waitcnt lgkmcnt(0)
  buffer_store_dwordx4 v[80:83], v3, s[32:35], s3 offen offset:1024 sc1
  v_mfma_f32_16x16x32_bf16 v[208:211], a[208:211], a[80:83], v[208:211]
  v_mfma_f32_16x16x32_bf16 v[208:211], a[212:215], a[84:87], v[208:211]
  v_mfma_f32_16x16x32_bf16 v[212:215], a[212:215], a[92:95], v[212:215]
  v_mfma_f32_16x16x32_bf16 v[212:215], a[208:211], a[88:91], v[212:215]
  v_mfma_f32_16x16x32_bf16 v[212:215], a[216:219], a[104:107], v[212:215]
  v_mfma_f32_16x16x32_bf16 v[212:215], a[220:223], a[108:111], v[212:215]
  v_mfma_f32_16x16x32_bf16 v[208:211], a[220:223], a[100:103], v[208:211]
  v_mfma_f32_16x16x32_bf16 v[208:211], a[216:219], a[96:99], v[208:211]
  s_nop 5
  v_cvt_pk_bf16_f32 v84, v212, v213
  v_cvt_pk_bf16_f32 v85, v214, v215
  s_xor_b32 s3, s97, 35328
  buffer_store_dwordx2 v[84:85], v114, s[32:35], s3 offen offset:2048 sc1
  s_waitcnt vmcnt(9)
  v_mfma_f32_16x16x32_bf16 v[8:11], v[90:93], v[128:131], v[8:11]
  v_mfma_f32_16x16x32_bf16 v[12:15], v[88:91], v[128:131], v[12:15]
  v_mfma_f32_16x16x32_bf16 v[16:19], v[90:93], v[132:135], v[16:19]
  v_mfma_f32_16x16x32_bf16 v[20:23], v[88:91], v[132:135], v[20:23]
  v_mfma_f32_16x16x32_bf16 v[24:27], v[88:91], v[134:137], v[24:27]
  v_mfma_f32_16x16x32_bf16 v[8:11], v[90:93], v[138:141], v[8:11]
  v_mfma_f32_16x16x32_bf16 v[12:15], v[88:91], v[138:141], v[12:15]
  v_mfma_f32_16x16x32_bf16 v[16:19], v[90:93], v[142:145], v[16:19]
  v_mfma_f32_16x16x32_bf16 v[20:23], v[88:91], v[142:145], v[20:23]
  v_mfma_f32_16x16x32_bf16 v[24:27], v[88:91], v[144:147], v[24:27]
  v_mfma_f32_16x16x32_bf16 v[8:11], v[90:93], v[148:151], v[8:11]
  v_mfma_f32_16x16x32_bf16 v[12:15], v[88:91], v[148:151], v[12:15]
  v_mfma_f32_16x16x32_bf16 v[16:19], v[90:93], v[152:155], v[16:19]
  v_mfma_f32_16x16x32_bf16 v[20:23], v[88:91], v[152:155], v[20:23]
  v_mfma_f32_16x16x32_bf16 v[24:27], v[88:91], v[154:157], v[24:27]
  v_mov_b32 v100, 0xc2b17218
  v_mov_b32 v102, 0x3c853526
  v_mov_b32 v103, 0x3c853526
  s_nop 0
  v_pk_mul_f32 v[128:129], v[8:9], v[100:101] op_sel_hi:[1,0]
  v_pk_mul_f32 v[130:131], v[10:11], v[100:101] op_sel_hi:[1,0]
  v_pk_mul_f32 v[132:133], v[12:13], v[100:101] op_sel_hi:[1,0]
  v_pk_mul_f32 v[134:135], v[14:15], v[100:101] op_sel_hi:[1,0]
  v_pk_mul_f32 v[136:137], v[16:17], v[100:101] op_sel_hi:[1,0]
  v_pk_mul_f32 v[138:139], v[18:19], v[100:101] op_sel_hi:[1,0]
  v_pk_mul_f32 v[140:141], v[20:21], v[100:101] op_sel_hi:[1,0]
  v_pk_mul_f32 v[142:143], v[22:23], v[100:101] op_sel_hi:[1,0]
  v_pk_mul_f32 v[144:145], v[24:25], v[100:101] op_sel_hi:[1,0]
  v_pk_mul_f32 v[146:147], v[26:27], v[100:101] op_sel_hi:[1,0]
  v_exp_f32 v128, v128
  v_exp_f32 v129, v129
  v_exp_f32 v130, v130
  v_exp_f32 v131, v131
  v_exp_f32 v132, v132
  v_exp_f32 v133, v133
  v_exp_f32 v134, v134
  v_exp_f32 v135, v135
  v_exp_f32 v136, v136
  v_exp_f32 v137, v137
  v_exp_f32 v138, v138
  v_exp_f32 v139, v139
  v_exp_f32 v140, v140
  v_exp_f32 v141, v141
  v_exp_f32 v142, v142
  v_exp_f32 v143, v143
  v_exp_f32 v144, v144
  v_exp_f32 v145, v145
  v_exp_f32 v146, v146
  v_exp_f32 v147, v147
  v_pk_fma_f32 v[128:129], v[128:129], v[102:103], v[102:103]
  v_pk_fma_f32 v[130:131], v[130:131], v[102:103], v[102:103]
  v_pk_fma_f32 v[132:133], v[132:133], v[102:103], v[102:103]
  v_pk_fma_f32 v[134:135], v[134:135], v[102:103], v[102:103]
  v_pk_fma_f32 v[136:137], v[136:137], v[102:103], v[102:103]
  v_pk_fma_f32 v[138:139], v[138:139], v[102:103], v[102:103]
  v_pk_fma_f32 v[140:141], v[140:141], v[102:103], v[102:103]
  v_pk_fma_f32 v[142:143], v[142:143], v[102:103], v[102:103]
  v_pk_fma_f32 v[144:145], v[144:145], v[102:103], v[102:103]
  v_pk_fma_f32 v[146:147], v[146:147], v[102:103], v[102:103]
  v_rcp_f32 v128, v128
  v_rcp_f32 v129, v129
  v_rcp_f32 v130, v130
  v_rcp_f32 v131, v131
  v_rcp_f32 v132, v132
  v_rcp_f32 v133, v133
  v_rcp_f32 v134, v134
  v_rcp_f32 v135, v135
  v_rcp_f32 v136, v136
  v_rcp_f32 v137, v137
  v_rcp_f32 v138, v138
  v_rcp_f32 v139, v139
  v_rcp_f32 v140, v140
  v_rcp_f32 v141, v141
  v_rcp_f32 v142, v142
  v_rcp_f32 v143, v143
  v_rcp_f32 v144, v144
  v_rcp_f32 v145, v145
  v_rcp_f32 v146, v146
  v_rcp_f32 v147, v147
  v_pk_mul_f32 v[8:9], v[8:9], v[128:129]
  v_pk_mul_f32 v[10:11], v[10:11], v[130:131]
  v_pk_mul_f32 v[12:13], v[12:13], v[132:133]
  v_pk_mul_f32 v[14:15], v[14:15], v[134:135]
  v_pk_mul_f32 v[16:17], v[16:17], v[136:137]
  v_pk_mul_f32 v[18:19], v[18:19], v[138:139]
  v_pk_mul_f32 v[20:21], v[20:21], v[140:141]
  v_pk_mul_f32 v[22:23], v[22:23], v[142:143]
  v_pk_mul_f32 v[24:25], v[24:25], v[144:145]
  v_pk_mul_f32 v[26:27], v[26:27], v[146:147]
  v_permlane16_swap_b32 v30, v32
  v_permlane16_swap_b32 v31, v33
  v_permlane16_swap_b32 v34, v36
  v_permlane16_swap_b32 v35, v37
  v_lshlrev_b32 v48, 16, v28
  v_and_b32 v49, 0xffff0000, v28
  v_lshlrev_b32 v50, 16, v29
  v_and_b32 v51, 0xffff0000, v29
  v_lshlrev_b32 v52, 16, v30
  v_and_b32 v53, 0xffff0000, v30
  v_lshlrev_b32 v54, 16, v31
  v_and_b32 v55, 0xffff0000, v31
  v_lshlrev_b32 v56, 16, v32
  v_and_b32 v57, 0xffff0000, v32
  v_lshlrev_b32 v58, 16, v33
  v_and_b32 v59, 0xffff0000, v33
  v_lshlrev_b32 v60, 16, v34
  v_and_b32 v61, 0xffff0000, v34
  v_lshlrev_b32 v62, 16, v35
  v_and_b32 v63, 0xffff0000, v35
  v_lshlrev_b32 v64, 16, v36
  v_and_b32 v65, 0xffff0000, v36
  v_lshlrev_b32 v66, 16, v37
  v_and_b32 v67, 0xffff0000, v37
  s_xor_b32 s3, s97, 0
  buffer_load_dwordx4 v[216:219], v3, s[32:35], s3 offen offset:0 sc1
  buffer_load_dwordx4 v[220:223], v3, s[32:35], s3 offen offset:1024 sc1
  buffer_load_dwordx2 v[224:225], v114, s[32:35], s3 offen offset:2048 sc1
  s_xor_b32 s3, s97, 5120
  buffer_load_dwordx4 v[236:239], v3, s[32:35], s3 offen offset:0 sc1
  buffer_load_dwordx4 v[240:243], v3, s[32:35], s3 offen offset:1024 sc1
  buffer_load_dwordx2 v[244:245], v114, s[32:35], s3 offen offset:2048 sc1
  s_xor_b32 s3, s97, 2560
  buffer_load_dwordx4 v[226:229], v3, s[32:35], s3 offen offset:0 sc1
  buffer_load_dwordx4 v[230:233], v3, s[32:35], s3 offen offset:1024 sc1
  buffer_load_dwordx2 v[234:235], v114, s[32:35], s3 offen offset:2048 sc1
  s_mov_b32 s59, 65536
  s_waitcnt vmcnt(3)
  v_max3_u32 v96, v216, v217, v218
  v_max3_u32 v97, v219, v220, v221
  v_max3_u32 v96, v96, v222, v223
  v_max3_u32 v97, v97, v224, v225
  v_max3_u32 v96, v96, v236, v237
  v_max3_u32 v97, v97, v238, v239
  v_max3_u32 v96, v96, v240, v241
  v_max3_u32 v97, v97, v242, v243
  v_max3_u32 v96, v96, v244, v245
  v_max_u32 v96, v96, v97
  v_cmp_eq_u32 vcc, -1, v96
  s_nop 1
  s_cbranch_vccnz L_px_1
L_px_ok_1:
  v_mfma_f32_16x16x32_bf16 v[176:179], v[90:93], v[216:219], v[176:179]
  v_mfma_f32_16x16x32_bf16 v[184:187], v[88:91], v[216:219], v[184:187]
  v_mfma_f32_16x16x32_bf16 v[192:195], v[90:93], v[220:223], v[192:195]
  s_waitcnt vmcnt(0)
  v_mfma_f32_16x16x32_bf16 v[200:203], v[88:91], v[220:223], v[200:203]
  v_max3_u32 v96, v226, v227, v228
  v_mfma_f32_16x16x32_bf16 v[208:211], v[88:91], v[222:225], v[208:211]
  v_max3_u32 v97, v229, v230, v231
  v_mfma_f32_16x16x32_bf16 v[176:179], v[90:93], v[236:239], v[176:179]
  v_max3_u32 v96, v96, v232, v233
  v_mfma_f32_16x16x32_bf16 v[184:187], v[88:91], v[236:239], v[184:187]
  v_max3_u32 v97, v97, v234, v235
  v_mfma_f32_16x16x32_bf16 v[192:195], v[90:93], v[240:243], v[192:195]
  v_max_u32 v96, v96, v97
  v_mfma_f32_16x16x32_bf16 v[200:203], v[88:91], v[240:243], v[200:203]
  v_cmp_eq_u32 vcc, -1, v96
  v_mfma_f32_16x16x32_bf16 v[208:211], v[88:91], v[242:245], v[208:211]
  s_cbranch_vccnz L_py_1
L_py_ok_1:
  v_mfma_f32_16x16x32_bf16 v[176:179], v[90:93], v[226:229], v[176:179]
  v_mfma_f32_16x16x32_bf16 v[184:187], v[88:91], v[226:229], v[184:187]
  v_mfma_f32_16x16x32_bf16 v[192:195], v[90:93], v[230:233], v[192:195]
  v_mfma_f32_16x16x32_bf16 v[200:203], v[88:91], v[230:233], v[200:203]
  v_mfma_f32_16x16x32_bf16 v[208:211], v[88:91], v[232:235], v[208:211]
  s_nop 3
  v_pk_fma_f32 v[48:49], v[176:177], v[8:9], v[48:49]
  v_pk_fma_f32 v[50:51], v[178:179], v[10:11], v[50:51]
  v_pk_fma_f32 v[52:53], v[184:185], v[12:13], v[52:53]
  v_pk_fma_f32 v[54:55], v[186:187], v[14:15], v[54:55]
  v_pk_fma_f32 v[56:57], v[192:193], v[16:17], v[56:57]
  v_pk_fma_f32 v[58:59], v[194:195], v[18:19], v[58:59]
  v_pk_fma_f32 v[60:61], v[200:201], v[20:21], v[60:61]
  v_pk_fma_f32 v[62:63], v[202:203], v[22:23], v[62:63]
  v_pk_fma_f32 v[64:65], v[208:209], v[24:25], v[64:65]
  v_pk_fma_f32 v[66:67], v[210:211], v[26:27], v[66:67]
  v_cvt_pk_bf16_f32 v28, v48, v49
  v_cvt_pk_bf16_f32 v29, v50, v51
  buffer_store_dwordx2 v[28:29], v123, s[24:27], s28 offen offset:0 sc1 nt
  v_cvt_pk_bf16_f32 v30, v52, v53
  v_cvt_pk_bf16_f32 v31, v54, v55
  v_cvt_pk_bf16_f32 v32, v56, v57
  v_cvt_pk_bf16_f32 v33, v58, v59
  s_nop 0
  v_permlane16_swap_b32 v30, v32
  v_permlane16_swap_b32 v31, v33
  buffer_store_dwordx4 v[30:33], v38, s[24:27], s28 offen offset:32 sc1 nt
  v_cvt_pk_bf16_f32 v34, v60, v61
  v_cvt_pk_bf16_f32 v35, v62, v63
  v_cvt_pk_bf16_f32 v36, v64, v65
  v_cvt_pk_bf16_f32 v37, v66, v67
  s_nop 0
  v_permlane16_swap_b32 v34, v36
  v_permlane16_swap_b32 v35, v37
  buffer_store_dwordx4 v[34:37], v38, s[24:27], s28 offen offset:96 sc1 nt
  s_endpgm
L_ow_1:
  s_mov_b32 s59, 65536
L_ow2_1:
  buffer_load_dword v117, v122, s[32:35], s30 offen sc1
  s_sub_u32 s59, s59, 1
  s_waitcnt vmcnt(0)
  v_cmp_ne_u32 vcc, 1, v117
  s_cmp_eq_u32 s59, 0
  s_cbranch_scc1 L_ow2_ok_1
  s_cbranch_vccnz L_ow2_1
L_ow2_ok_1:
  s_branch L_ow_ok_1
L_ox_1:
  s_mov_b32 s59, 65536
L_ox2_1:
  buffer_load_dword v117, v122, s[32:35], s30 offen sc1
  s_sub_u32 s59, s59, 1
  s_waitcnt vmcnt(0)
  v_cmp_ne_u32 vcc, 1, v117
  s_cmp_eq_u32 s59, 0
  s_cbranch_scc1 L_ox2_ok_1
  s_cbranch_vccnz L_ox2_1
L_ox2_ok_1:
  s_branch L_ox_ok_1
L_gw_1:
  s_mov_b32 s59, 65536
L_gw2_1:
  s_xor_b32 s3, s97, 5632
  buffer_load_dwordx2 v[136:137], v114, s[32:35], s3 offen offset:2048 sc1
  s_xor_b32 s3, s97, 6144
  buffer_load_dwordx2 v[146:147], v114, s[32:35], s3 offen offset:2048 sc1
  s_xor_b32 s3, s97, 6656
  buffer_load_dwordx2 v[156:157], v114, s[32:35], s3 offen offset:2048 sc1
  s_sub_u32 s59, s59, 1
  s_waitcnt vmcnt(0)
  v_max3_u32 v96, v136, v137, v146
  v_max3_u32 v96, v96, v147, v156
  v_max_u32 v96, v96, v157
  v_cmp_eq_u32 vcc, -1, v96
  s_cmp_eq_u32 s59, 0
  s_cbranch_scc1 L_gw2_ok_1
  s_cbranch_vccnz L_gw2_1
L_gw2_ok_1:
  s_branch L_gw_ok_1
L_px_1:
  s_mov_b32 s19, 0
  s_sub_u32 s59, s59, 1
  s_waitcnt vmcnt(0)
  v_max3_u32 v96, v216, v217, v218
  v_max3_u32 v97, v219, v220, v221
  v_max3_u32 v96, v96, v222, v223
  v_max3_u32 v97, v97, v224, v225
  v_max_u32 v96, v96, v97
  v_cmp_eq_u32 vcc, -1, v96
  s_nop 1
  s_cbranch_vccz L_px1_1
  s_xor_b32 s3, s97, 0
  buffer_load_dwordx4 v[216:219], v3, s[32:35], s3 offen offset:0 sc1
  buffer_load_dwordx4 v[220:223], v3, s[32:35], s3 offen offset:1024 sc1
  buffer_load_dwordx2 v[224:225], v114, s[32:35], s3 offen offset:2048 sc1
  s_mov_b32 s19, s59
L_px1_1:
  v_max3_u32 v96, v236, v237, v238
  v_max3_u32 v97, v239, v240, v241
  v_max3_u32 v96, v96, v242, v243
  v_max3_u32 v97, v97, v244, v245
  v_max_u32 v96, v96, v97
  v_cmp_eq_u32 vcc, -1, v96
  s_nop 1
  s_cbranch_vccz L_px3_1
  s_xor_b32 s3, s97, 5120
  buffer_load_dwordx4 v[236:239], v3, s[32:35], s3 offen offset:0 sc1
  buffer_load_dwordx4 v[240:243], v3, s[32:35], s3 offen offset:1024 sc1
  buffer_load_dwordx2 v[244:245], v114, s[32:35], s3 offen offset:2048 sc1
  s_mov_b32 s19, s59
L_px3_1:
  s_cmp_eq_u32 s19, 0
  s_cbranch_scc1 L_pxe_1
  v_max3_u32 v96, v226, v227, v228
  v_max3_u32 v97, v229, v230, v231
  v_max3_u32 v96, v96, v232, v233
  v_max3_u32 v97, v97, v234, v235
  v_max_u32 v96, v96, v97
  v_cmp_eq_u32 vcc, -1, v96
  s_nop 1
  s_cbranch_vccz L_px2_1
  s_xor_b32 s3, s97, 2560
  buffer_load_dwordx4 v[226:229], v3, s[32:35], s3 offen offset:0 sc1
  buffer_load_dwordx4 v[230:233], v3, s[32:35], s3 offen offset:1024 sc1
  buffer_load_dwordx2 v[234:235], v114, s[32:35], s3 offen offset:2048 sc1
L_px2_1:
  s_branch L_px_1
L_pxe_1:
  s_waitcnt vmcnt(0)
  s_mov_b32 s59, 65536
  s_branch L_px_ok_1
L_py_1:
  s_xor_b32 s3, s97, 2560
  buffer_load_dwordx4 v[226:229], v3, s[32:35], s3 offen offset:0 sc1
  buffer_load_dwordx4 v[230:233], v3, s[32:35], s3 offen offset:1024 sc1
  buffer_load_dwordx2 v[234:235], v114, s[32:35], s3 offen offset:2048 sc1
  s_sub_u32 s59, s59, 1
  s_waitcnt vmcnt(0)
  v_max3_u32 v96, v226, v227, v228
  v_max3_u32 v97, v229, v230, v231
  v_max3_u32 v96, v96, v232, v233
  v_max3_u32 v97, v97, v234, v235
  v_max_u32 v96, v96, v97
  v_cmp_eq_u32 vcc, -1, v96
  s_cmp_eq_u32 s59, 0
  s_cbranch_scc1 L_py_ok_1
  s_cbranch_vccnz L_py_1
  s_branch L_py_ok_1
L_cw_1:
  s_mov_b32 s59, 65536
L_cw2_1:
  buffer_load_dword v117, v124, s[48:51], 0 offen offset:16 sc1
  s_sub_u32 s59, s59, 1
  s_waitcnt vmcnt(0)
  v_cmp_gt_u32 vcc, 0x100, v117
  s_cmp_eq_u32 s59, 0
  s_cbranch_scc1 L_cw2_ok_1
  s_cbranch_vccnz L_cw2_1
L_cw2_ok_1:
  s_branch L_cw_ok_1
.p2align 12
L_post0:
  v_mfma_f32_16x16x32_bf16 v[40:43], a[192:195], v[192:195], v[24:27]
  v_cmp_gt_u32 vcc, 0x100, v117
  s_nop 1
  s_cbranch_vccnz L_cw_0
L_cw_ok_0:
  v_exp_f32 v69, v69
  v_mfma_f32_16x16x32_bf16 v[40:43], a[196:199], v[208:211], v[40:43]
  ds_read_b64_tr_b16 a[232:233], v81 offset:32768
  v_cvt_pk_bf16_f32 v190, v68, v69
  v_mfma_f32_16x16x32_bf16 v[40:43], a[200:203], v[224:227], v[40:43]
L_pad_post00_0:
  s_cbranch_execz L_pad_post00_1
  v_exp_f32 v70, v70
  v_mfma_f32_16x16x32_bf16 v[40:43], a[204:207], v[240:243], v[40:43]
  ds_read_b64_tr_b16 a[234:235], v81 offset:36864
  v_mfma_f32_16x16x32_bf16 v[44:47], a[204:207], v[244:247], v[28:31]
  v_exp_f32 v71, v71
  v_mfma_f32_16x16x32_bf16 v[44:47], a[200:203], v[228:231], v[44:47]
  ds_read_b64_tr_b16 a[236:237], v81 offset:40960
  v_cvt_pk_bf16_f32 v191, v70, v71
  v_mfma_f32_16x16x32_bf16 v[44:47], a[196:199], v[212:215], v[44:47]
  s_add_u32 m0, s42, 143360
  v_mfma_f32_16x16x32_bf16 v[44:47], a[192:195], v[196:199], v[44:47]
  buffer_load_dwordx4 v3, s[52:55], s40 offen offset:0 sc1 lds
  v_mfma_f32_16x16x32_bf16 v[48:51], a[192:195], v[200:203], v[32:35]
  v_exp_f32 v40, v40
  v_mfma_f32_16x16x32_bf16 v[48:51], a[196:199], v[216:219], v[48:51]
  ds_read_b64_tr_b16 a[238:239], v81 offset:45056
  v_mfma_f32_16x16x32_bf16 v[48:51], a[200:203], v[232:235], v[48:51]
  v_exp_f32 v41, v41
  v_mfma_f32_16x16x32_bf16 v[48:51], a[204:207], v[248:251], v[48:51]
  ds_read_b128 a[208:211], v76 offset:36864
  v_cvt_pk_bf16_f32 v128, v40, v41
  v_mfma_f32_16x16x32_bf16 v[52:55], a[204:207], v[252:255], v[36:39]
  v_exp_f32 v42, v42
  v_mfma_f32_16x16x32_bf16 v[52:55], a[200:203], v[236:239], v[52:55]
  ds_read_b128 a[212:215], v77 offset:36864
  v_mfma_f32_16x16x32_bf16 v[52:55], a[196:199], v[220:223], v[52:55]
  v_exp_f32 v43, v43
  v_mfma_f32_16x16x32_bf16 v[52:55], a[192:195], v[204:207], v[52:55]
  s_waitcnt lgkmcnt(6)
  buffer_load_dwordx4 v3, s[52:55], s40 offen offset:1024 sc1 lds
  v_mfma_f32_16x16x32_bf16 a[0:3], a[224:227], v[160:163], a[0:3]
  v_exp_f32 v44, v44
  v_mfma_f32_16x16x32_bf16 a[0:3], a[228:231], v[164:167], a[0:3]
  ds_read_b128 a[216:219], v78 offset:36864
  v_cvt_pk_bf16_f32 v129, v42, v43
  v_mfma_f32_16x16x32_bf16 a[4:7], a[228:231], v[172:175], a[4:7]
  v_exp_f32 v45, v45
  v_mfma_f32_16x16x32_bf16 a[4:7], a[224:227], v[168:171], a[4:7]
  ds_read_b128 a[220:223], v79 offset:36864
  v_cvt_pk_bf16_f32 v136, v44, v45
  v_mfma_f32_16x16x32_bf16 a[8:11], a[224:227], v[176:179], a[8:11]
  v_exp_f32 v46, v46
  v_mfma_f32_16x16x32_bf16 a[8:11], a[228:231], v[180:183], a[8:11]
  buffer_load_dwordx4 v3, s[52:55], s40 offen offset:2048 sc1 lds
  v_mfma_f32_16x16x32_bf16 a[12:15], a[228:231], v[188:191], a[12:15]
  v_exp_f32 v47, v47
  v_mfma_f32_16x16x32_bf16 a[12:15], a[224:227], v[184:187], a[12:15]
  s_waitcnt lgkmcnt(4)
  buffer_load_dwordx4 v3, s[52:55], s40 offen offset:3072 sc1 lds
  v_mfma_f32_16x16x32_bf16 a[28:31], a[232:235], v[184:187], a[28:31]
  v_exp_f32 v48, v48
  v_mfma_f32_16x16x32_bf16 a[28:31], a[236:239], v[188:191], a[28:31]
  ds_read_b64_tr_b16 a[240:241], v82 offset:32768
  v_cvt_pk_bf16_f32 v137, v46, v47
  v_mfma_f32_16x16x32_bf16 a[24:27], a[236:239], v[180:183], a[24:27]
  v_exp_f32 v49, v49
  v_mfma_f32_16x16x32_bf16 a[24:27], a[232:235], v[176:179], a[24:27]
  ds_read_b64_tr_b16 a[242:243], v82 offset:36864
  v_cvt_pk_bf16_f32 v144, v48, v49
  v_mfma_f32_16x16x32_bf16 a[20:23], a[232:235], v[168:171], a[20:23]
  v_exp_f32 v50, v50
  v_mfma_f32_16x16x32_bf16 a[20:23], a[236:239], v[172:175], a[20:23]
  ds_read_b64_tr_b16 a[244:245], v82 offset:40960
  v_mfma_f32_16x16x32_bf16 a[16:19], a[236:239], v[164:167], a[16:19]
  v_exp_f32 v51, v51
  v_mfma_f32_16x16x32_bf16 a[16:19], a[232:235], v[160:163], a[16:19]
  s_add_u32 m0, s42, 147456
  ds_read_b64_tr_b16 a[246:247], v82 offset:45056
  v_cvt_pk_bf16_f32 v145, v50, v51
  s_add_u32 s40, s40, 4096
  v_exp_f32 v52, v52
  v_smfmac_f32_16x16x64_bf16 v[8:11], v[4:7], v[160:167], v116
  s_waitcnt lgkmcnt(4)
  buffer_load_dwordx4 v3, s[52:55], s40 offen offset:0 sc1 lds
  v_mfma_f32_16x16x32_bf16 v[56:59], a[208:211], v[192:195], v[24:27]
  v_exp_f32 v53, v53
  v_mfma_f32_16x16x32_bf16 v[56:59], a[212:215], v[208:211], v[56:59]
  ds_read_b64_tr_b16 a[248:249], v83 offset:32768
  v_cvt_pk_bf16_f32 v152, v52, v53
  v_mfma_f32_16x16x32_bf16 v[56:59], a[216:219], v[224:227], v[56:59]
  v_exp_f32 v54, v54
  v_mfma_f32_16x16x32_bf16 v[56:59], a[220:223], v[240:243], v[56:59]
  ds_read_b64_tr_b16 a[250:251], v83 offset:36864
  v_mfma_f32_16x16x32_bf16 v[60:63], a[220:223], v[244:247], v[28:31]
  v_exp_f32 v55, v55
  v_mfma_f32_16x16x32_bf16 v[60:63], a[216:219], v[228:231], v[60:63]
  s_add_u32 m0, s42, 0
  ds_read_b64_tr_b16 a[252:253], v83 offset:40960
  v_cvt_pk_bf16_f32 v153, v54, v55
  v_mfma_f32_16x16x32_bf16 v[60:63], a[212:215], v[212:215], v[60:63]
  s_add_u32 s40, s40, 77824
  v_mfma_f32_16x16x32_bf16 v[60:63], a[208:211], v[196:199], v[60:63]
  buffer_load_dwordx4 v3, s[52:55], s40 offen offset:0 sc1 lds
  v_mfma_f32_16x16x32_bf16 v[64:67], a[208:211], v[200:203], v[32:35]
  v_exp_f32 v56, v56
  v_mfma_f32_16x16x32_bf16 v[64:67], a[212:215], v[216:219], v[64:67]
  ds_read_b64_tr_b16 a[254:255], v83 offset:45056
  v_mfma_f32_16x16x32_bf16 v[64:67], a[216:219], v[232:235], v[64:67]
  v_exp_f32 v57, v57
  v_mfma_f32_16x16x32_bf16 v[64:67], a[220:223], v[248:251], v[64:67]
  ds_read_b128 a[192:195], v76 offset:40960
  v_cvt_pk_bf16_f32 v130, v56, v57
  v_mfma_f32_16x16x32_bf16 v[68:71], a[220:223], v[252:255], v[36:39]
  v_exp_f32 v58, v58
  v_mfma_f32_16x16x32_bf16 v[68:71], a[216:219], v[236:239], v[68:71]
  ds_read_b128 a[196:199], v77 offset:40960
  v_mfma_f32_16x16x32_bf16 v[68:71], a[212:215], v[220:223], v[68:71]
  v_exp_f32 v59, v59
  v_mfma_f32_16x16x32_bf16 v[68:71], a[208:211], v[204:207], v[68:71]
  s_waitcnt lgkmcnt(6)
  buffer_load_dwordx4 v3, s[52:55], s40 offen offset:1024 sc1 lds
  v_mfma_f32_16x16x32_bf16 a[32:35], a[240:243], v[160:163], a[32:35]
  v_exp_f32 v60, v60
  v_mfma_f32_16x16x32_bf16 a[32:35], a[244:247], v[164:167], a[32:35]
  ds_read_b128 a[200:203], v78 offset:40960
  v_cvt_pk_bf16_f32 v131, v58, v59
  v_mfma_f32_16x16x32_bf16 a[36:39], a[244:247], v[172:175], a[36:39]
  v_exp_f32 v61, v61
  v_mfma_f32_16x16x32_bf16 a[36:39], a[240:243], v[168:171], a[36:39]
  ds_read_b128 a[204:207], v79 offset:40960
  v_cvt_pk_bf16_f32 v138, v60, v61
  v_mfma_f32_16x16x32_bf16 a[40:43], a[240:243], v[176:179], a[40:43]
  v_exp_f32 v62, v62
  v_mfma_f32_16x16x32_bf16 a[40:43], a[244:247], v[180:183], a[40:43]
  buffer_load_dwordx4 v3, s[52:55], s40 offen offset:2048 sc1 lds
  v_mfma_f32_16x16x32_bf16 a[44:47], a[244:247], v[188:191], a[44:47]
  v_exp_f32 v63, v63
  v_mfma_f32_16x16x32_bf16 a[44:47], a[240:243], v[184:187], a[44:47]
  s_waitcnt lgkmcnt(4)
  buffer_load_dwordx4 v3, s[52:55], s40 offen offset:3072 sc1 lds
  v_mfma_f32_16x16x32_bf16 a[60:63], a[248:251], v[184:187], a[60:63]
  v_exp_f32 v64, v64
  v_mfma_f32_16x16x32_bf16 a[60:63], a[252:255], v[188:191], a[60:63]
  ds_read_b64_tr_b16 a[224:225], v84 offset:32768
  v_cvt_pk_bf16_f32 v139, v62, v63
  v_mfma_f32_16x16x32_bf16 a[56:59], a[252:255], v[180:183], a[56:59]
  v_exp_f32 v65, v65
  v_mfma_f32_16x16x32_bf16 a[56:59], a[248:251], v[176:179], a[56:59]
  ds_read_b64_tr_b16 a[226:227], v84 offset:36864
  v_cvt_pk_bf16_f32 v146, v64, v65
  v_mfma_f32_16x16x32_bf16 a[52:55], a[248:251], v[168:171], a[52:55]
  v_exp_f32 v66, v66
  v_mfma_f32_16x16x32_bf16 a[52:55], a[252:255], v[172:175], a[52:55]
  ds_read_b64_tr_b16 a[228:229], v84 offset:40960
  v_mfma_f32_16x16x32_bf16 a[48:51], a[252:255], v[164:167], a[48:51]
  v_exp_f32 v67, v67
  v_mfma_f32_16x16x32_bf16 a[48:51], a[248:251], v[160:163], a[48:51]
  s_add_u32 m0, s42, 4096
  ds_read_b64_tr_b16 a[230:231], v84 offset:45056
  v_cvt_pk_bf16_f32 v147, v66, v67
  s_add_u32 s40, s40, 4096
  v_exp_f32 v68, v68
  v_smfmac_f32_16x16x64_bf16 v[12:15], v[4:7], v[168:175], v116
  s_waitcnt lgkmcnt(4)
  buffer_load_dwordx4 v3, s[52:55], s40 offen offset:0 sc1 lds
  v_mfma_f32_16x16x32_bf16 v[40:43], a[192:195], v[192:195], v[24:27]
  v_exp_f32 v69, v69
  v_mfma_f32_16x16x32_bf16 v[40:43], a[196:199], v[208:211], v[40:43]
  ds_read_b64_tr_b16 a[232:233], v85 offset:32768
  v_cvt_pk_bf16_f32 v154, v68, v69
  v_mfma_f32_16x16x32_bf16 v[40:43], a[200:203], v[224:227], v[40:43]
  v_exp_f32 v70, v70
  v_mfma_f32_16x16x32_bf16 v[40:43], a[204:207], v[240:243], v[40:43]
  s_add_u32 m0, s18, 65536
  ds_read_b64_tr_b16 a[234:235], v85 offset:36864
  v_mfma_f32_16x16x32_bf16 v[44:47], a[204:207], v[244:247], v[28:31]
  v_exp_f32 v71, v71
  v_mfma_f32_16x16x32_bf16 v[44:47], a[200:203], v[228:231], v[44:47]
  s_add_u32 s17, s17, 16384
  ds_read_b64_tr_b16 a[236:237], v85 offset:40960
  v_cvt_pk_bf16_f32 v155, v70, v71
  v_mfma_f32_16x16x32_bf16 v[44:47], a[196:199], v[212:215], v[44:47]
  v_mfma_f32_16x16x32_bf16 v[44:47], a[192:195], v[196:199], v[44:47]
  buffer_load_dwordx4 v92, s[12:15], s17 offen offset:0 lds
  v_mfma_f32_16x16x32_bf16 v[48:51], a[192:195], v[200:203], v[32:35]
  v_exp_f32 v40, v40
  v_mfma_f32_16x16x32_bf16 v[48:51], a[196:199], v[216:219], v[48:51]
  ds_read_b64_tr_b16 a[238:239], v85 offset:45056
  v_mfma_f32_16x16x32_bf16 v[48:51], a[200:203], v[232:235], v[48:51]
  v_exp_f32 v41, v41
  v_mfma_f32_16x16x32_bf16 v[48:51], a[204:207], v[248:251], v[48:51]
  ds_read_b128 a[208:211], v76 offset:45056
  v_cvt_pk_bf16_f32 v132, v40, v41
  v_mfma_f32_16x16x32_bf16 v[52:55], a[204:207], v[252:255], v[36:39]
  v_exp_f32 v42, v42
  v_mfma_f32_16x16x32_bf16 v[52:55], a[200:203], v[236:239], v[52:55]
  ds_read_b128 a[212:215], v77 offset:45056
  v_mfma_f32_16x16x32_bf16 v[52:55], a[196:199], v[220:223], v[52:55]
  v_exp_f32 v43, v43
  v_mfma_f32_16x16x32_bf16 v[52:55], a[192:195], v[204:207], v[52:55]
  s_waitcnt lgkmcnt(6)
  buffer_load_dwordx4 a[128:131], v112, s[36:39], s41 offen offset:0 sc1
  v_mfma_f32_16x16x32_bf16 a[64:67], a[224:227], v[160:163], a[64:67]
  v_exp_f32 v44, v44
  v_mfma_f32_16x16x32_bf16 a[64:67], a[228:231], v[164:167], a[64:67]
  ds_read_b128 a[216:219], v78 offset:45056
  v_cvt_pk_bf16_f32 v133, v42, v43
  v_mfma_f32_16x16x32_bf16 a[68:71], a[228:231], v[172:175], a[68:71]
  v_exp_f32 v45, v45
  v_mfma_f32_16x16x32_bf16 a[68:71], a[224:227], v[168:171], a[68:71]
  ds_read_b128 a[220:223], v79 offset:45056
  v_cvt_pk_bf16_f32 v140, v44, v45
  v_mfma_f32_16x16x32_bf16 a[72:75], a[224:227], v[176:179], a[72:75]
  v_exp_f32 v46, v46
  v_mfma_f32_16x16x32_bf16 a[72:75], a[228:231], v[180:183], a[72:75]
  buffer_load_dwordx4 a[132:135], v112, s[36:39], s41 offen offset:1024 sc1
  v_mfma_f32_16x16x32_bf16 a[76:79], a[228:231], v[188:191], a[76:79]
  v_exp_f32 v47, v47
  v_mfma_f32_16x16x32_bf16 a[76:79], a[224:227], v[184:187], a[76:79]
  s_waitcnt lgkmcnt(4)
  buffer_load_dwordx4 v93, s[12:15], s17 offen offset:1024 lds
  v_mfma_f32_16x16x32_bf16 a[92:95], a[232:235], v[184:187], a[92:95]
  v_exp_f32 v48, v48
  v_mfma_f32_16x16x32_bf16 a[92:95], a[236:239], v[188:191], a[92:95]
  ds_read_b64_tr_b16 a[240:241], v86 offset:32768
  v_cvt_pk_bf16_f32 v141, v46, v47
  v_mfma_f32_16x16x32_bf16 a[88:91], a[236:239], v[180:183], a[88:91]
  v_exp_f32 v49, v49
  v_mfma_f32_16x16x32_bf16 a[88:91], a[232:235], v[176:179], a[88:91]
  ds_read_b64_tr_b16 a[242:243], v86 offset:36864
  v_cvt_pk_bf16_f32 v148, v48, v49
  v_mfma_f32_16x16x32_bf16 a[84:87], a[232:235], v[168:171], a[84:87]
  v_exp_f32 v50, v50
  v_mfma_f32_16x16x32_bf16 a[84:87], a[236:239], v[172:175], a[84:87]
  ds_read_b64_tr_b16 a[244:245], v86 offset:40960
  v_mfma_f32_16x16x32_bf16 a[80:83], a[236:239], v[164:167], a[80:83]
  v_exp_f32 v51, v51
  v_mfma_f32_16x16x32_bf16 a[80:83], a[232:235], v[160:163], a[80:83]
  ds_read_b64_tr_b16 a[246:247], v86 offset:45056
  v_cvt_pk_bf16_f32 v149, v50, v51
  v_exp_f32 v52, v52
  v_smfmac_f32_16x16x64_bf16 v[16:19], v[4:7], v[176:183], v116
  s_waitcnt lgkmcnt(4)
  buffer_load_dwordx4 a[136:139], v113, s[36:39], s41 offen offset:0 sc1
  v_mfma_f32_16x16x32_bf16 v[56:59], a[208:211], v[192:195], v[24:27]
  v_exp_f32 v53, v53
  v_mfma_f32_16x16x32_bf16 v[56:59], a[212:215], v[208:211], v[56:59]
  ds_read_b64_tr_b16 a[248:249], v87 offset:32768
  v_cvt_pk_bf16_f32 v156, v52, v53
  v_mfma_f32_16x16x32_bf16 v[56:59], a[216:219], v[224:227], v[56:59]
  v_exp_f32 v54, v54
  v_mfma_f32_16x16x32_bf16 v[56:59], a[220:223], v[240:243], v[56:59]
  ds_read_b64_tr_b16 a[250:251], v87 offset:36864
  v_mfma_f32_16x16x32_bf16 v[60:63], a[220:223], v[244:247], v[28:31]
  v_exp_f32 v55, v55
  v_mfma_f32_16x16x32_bf16 v[60:63], a[216:219], v[228:231], v[60:63]
  ds_read_b64_tr_b16 a[252:253], v87 offset:40960
  v_cvt_pk_bf16_f32 v157, v54, v55
  v_mfma_f32_16x16x32_bf16 v[60:63], a[212:215], v[212:215], v[60:63]
  s_waitcnt vmcnt(15)
  s_barrier
  v_mfma_f32_16x16x32_bf16 v[60:63], a[208:211], v[196:199], v[60:63]
  buffer_load_dwordx4 v92, s[12:15], s17 offen offset:2048 lds
  v_mfma_f32_16x16x32_bf16 v[64:67], a[208:211], v[200:203], v[32:35]
  v_exp_f32 v56, v56
  v_mfma_f32_16x16x32_bf16 v[64:67], a[212:215], v[216:219], v[64:67]
  ds_read_b64_tr_b16 a[254:255], v87 offset:45056
  v_mfma_f32_16x16x32_bf16 v[64:67], a[216:219], v[232:235], v[64:67]
  v_exp_f32 v57, v57
  v_mfma_f32_16x16x32_bf16 v[64:67], a[220:223], v[248:251], v[64:67]
  ds_read_b128 a[192:195], v76 offset:49152
  v_cvt_pk_bf16_f32 v134, v56, v57
  v_mfma_f32_16x16x32_bf16 v[68:71], a[220:223], v[252:255], v[36:39]
  v_exp_f32 v58, v58
  v_mfma_f32_16x16x32_bf16 v[68:71], a[216:219], v[236:239], v[68:71]
  ds_read_b128 a[196:199], v77 offset:49152
  v_mfma_f32_16x16x32_bf16 v[68:71], a[212:215], v[220:223], v[68:71]
  v_exp_f32 v59, v59
  v_mfma_f32_16x16x32_bf16 v[68:71], a[208:211], v[204:207], v[68:71]
  s_waitcnt lgkmcnt(6)
  buffer_load_dwordx4 a[140:143], v113, s[36:39], s41 offen offset:1024 sc1
  v_mfma_f32_16x16x32_bf16 a[96:99], a[240:243], v[160:163], a[96:99]
  v_exp_f32 v60, v60
  v_mfma_f32_16x16x32_bf16 a[96:99], a[244:247], v[164:167], a[96:99]
  ds_read_b128 a[200:203], v78 offset:49152
  v_cvt_pk_bf16_f32 v135, v58, v59
  v_mfma_f32_16x16x32_bf16 a[100:103], a[244:247], v[172:175], a[100:103]
  v_exp_f32 v61, v61
  v_mfma_f32_16x16x32_bf16 a[100:103], a[240:243], v[168:171], a[100:103]
  ds_read_b128 a[204:207], v79 offset:49152
  v_cvt_pk_bf16_f32 v142, v60, v61
  v_mfma_f32_16x16x32_bf16 a[104:107], a[240:243], v[176:179], a[104:107]
  s_add_u32 s41, s41, 262144
  v_exp_f32 v62, v62
  v_mfma_f32_16x16x32_bf16 a[104:107], a[244:247], v[180:183], a[104:107]
  buffer_load_dwordx4 a[144:147], v112, s[36:39], s41 offen offset:0 sc1
  v_mfma_f32_16x16x32_bf16 a[108:111], a[244:247], v[188:191], a[108:111]
  v_exp_f32 v63, v63
  v_mfma_f32_16x16x32_bf16 a[108:111], a[240:243], v[184:187], a[108:111]
  s_waitcnt lgkmcnt(4)
  buffer_load_dwordx4 v93, s[12:15], s17 offen offset:3072 lds
  v_mfma_f32_16x16x32_bf16 a[124:127], a[248:251], v[184:187], a[124:127]
  v_exp_f32 v64, v64
  v_mfma_f32_16x16x32_bf16 a[124:127], a[252:255], v[188:191], a[124:127]
  ds_read_b64_tr_b16 a[224:225], v80 offset:16384
  v_cvt_pk_bf16_f32 v143, v62, v63
  v_mfma_f32_16x16x32_bf16 a[120:123], a[252:255], v[180:183], a[120:123]
  v_exp_f32 v65, v65
  v_mfma_f32_16x16x32_bf16 a[120:123], a[248:251], v[176:179], a[120:123]
  ds_read_b64_tr_b16 a[226:227], v80 offset:20480
  v_cvt_pk_bf16_f32 v150, v64, v65
  v_mfma_f32_16x16x32_bf16 a[116:119], a[248:251], v[168:171], a[116:119]
  v_exp_f32 v66, v66
  v_mfma_f32_16x16x32_bf16 a[116:119], a[252:255], v[172:175], a[116:119]
  ds_read_b64_tr_b16 a[228:229], v80 offset:24576
  v_mfma_f32_16x16x32_bf16 a[112:115], a[252:255], v[164:167], a[112:115]
  v_exp_f32 v67, v67
  v_mfma_f32_16x16x32_bf16 a[112:115], a[248:251], v[160:163], a[112:115]
  ds_read_b64_tr_b16 a[230:231], v80 offset:28672
  v_cvt_pk_bf16_f32 v151, v66, v67
  v_exp_f32 v68, v68
  v_smfmac_f32_16x16x64_bf16 v[20:23], v[4:7], v[184:191], v116
  s_waitcnt lgkmcnt(4)
  buffer_load_dwordx4 a[148:151], v112, s[36:39], s41 offen offset:1024 sc1
  v_mfma_f32_16x16x32_bf16 v[40:43], a[192:195], v[192:195], v[24:27]
  v_exp_f32 v69, v69
  v_mfma_f32_16x16x32_bf16 v[40:43], a[196:199], v[208:211], v[40:43]
  ds_read_b64_tr_b16 a[232:233], v81 offset:16384
  v_cvt_pk_bf16_f32 v158, v68, v69
  v_mfma_f32_16x16x32_bf16 v[40:43], a[200:203], v[224:227], v[40:43]
  v_exp_f32 v70, v70
  v_mfma_f32_16x16x32_bf16 v[40:43], a[204:207], v[240:243], v[40:43]
  ds_read_b64_tr_b16 a[234:235], v81 offset:20480
  v_mfma_f32_16x16x32_bf16 v[44:47], a[204:207], v[244:247], v[28:31]
  v_exp_f32 v71, v71
  v_mfma_f32_16x16x32_bf16 v[44:47], a[200:203], v[228:231], v[44:47]
  ds_read_b64_tr_b16 a[236:237], v81 offset:24576
  v_cvt_pk_bf16_f32 v159, v70, v71
  v_mfma_f32_16x16x32_bf16 v[44:47], a[196:199], v[212:215], v[44:47]
  v_mfma_f32_16x16x32_bf16 v[44:47], a[192:195], v[196:199], v[44:47]
  buffer_load_dwordx4 a[152:155], v113, s[36:39], s41 offen offset:0 sc1
  v_mfma_f32_16x16x32_bf16 v[48:51], a[192:195], v[200:203], v[32:35]
  v_exp_f32 v40, v40
  v_mfma_f32_16x16x32_bf16 v[48:51], a[196:199], v[216:219], v[48:51]
  ds_read_b64_tr_b16 a[238:239], v81 offset:28672
  v_mfma_f32_16x16x32_bf16 v[48:51], a[200:203], v[232:235], v[48:51]
  v_exp_f32 v41, v41
  v_mfma_f32_16x16x32_bf16 v[48:51], a[204:207], v[248:251], v[48:51]
  ds_read_b128 a[208:211], v76 offset:53248
  v_cvt_pk_bf16_f32 v160, v40, v41
  v_mfma_f32_16x16x32_bf16 v[52:55], a[204:207], v[252:255], v[36:39]
  v_exp_f32 v42, v42
  v_mfma_f32_16x16x32_bf16 v[52:55], a[200:203], v[236:239], v[52:55]
  ds_read_b128 a[212:215], v77 offset:53248
  v_mfma_f32_16x16x32_bf16 v[52:55], a[196:199], v[220:223], v[52:55]
  v_exp_f32 v43, v43
  v_mfma_f32_16x16x32_bf16 v[52:55], a[192:195], v[204:207], v[52:55]
  s_waitcnt lgkmcnt(6)
  buffer_load_dwordx4 a[156:159], v113, s[36:39], s41 offen offset:1024 sc1
  v_mfma_f32_16x16x32_bf16 a[0:3], a[224:227], v[128:131], a[0:3]
  v_exp_f32 v44, v44
  v_mfma_f32_16x16x32_bf16 a[0:3], a[228:231], v[132:135], a[0:3]
  ds_read_b128 a[216:219], v78 offset:53248
  v_cvt_pk_bf16_f32 v161, v42, v43
  v_mfma_f32_16x16x32_bf16 a[4:7], a[228:231], v[140:143], a[4:7]
  v_exp_f32 v45, v45
  v_mfma_f32_16x16x32_bf16 a[4:7], a[224:227], v[136:139], a[4:7]
  s_add_u32 m0, s42, 20480
  ds_read_b128 a[220:223], v79 offset:53248
  v_cvt_pk_bf16_f32 v168, v44, v45
  v_mfma_f32_16x16x32_bf16 a[8:11], a[224:227], v[144:147], a[8:11]
  s_add_u32 s40, s40, 77824
  v_exp_f32 v46, v46
  v_mfma_f32_16x16x32_bf16 a[8:11], a[228:231], v[148:151], a[8:11]
  buffer_load_dwordx4 v3, s[52:55], s40 offen offset:0 sc1 lds
  v_mfma_f32_16x16x32_bf16 a[12:15], a[228:231], v[156:159], a[12:15]
  v_exp_f32 v47, v47
  v_mfma_f32_16x16x32_bf16 a[12:15], a[224:227], v[152:155], a[12:15]
  s_waitcnt lgkmcnt(4)
  buffer_load_dwordx4 v3, s[52:55], s40 offen offset:1024 sc1 lds
  v_mfma_f32_16x16x32_bf16 a[28:31], a[232:235], v[152:155], a[28:31]
  v_exp_f32 v48, v48
  v_mfma_f32_16x16x32_bf16 a[28:31], a[236:239], v[156:159], a[28:31]
  ds_read_b64_tr_b16 a[240:241], v82 offset:16384
  v_cvt_pk_bf16_f32 v169, v46, v47
  v_mfma_f32_16x16x32_bf16 a[24:27], a[236:239], v[148:151], a[24:27]
  v_exp_f32 v49, v49
  v_mfma_f32_16x16x32_bf16 a[24:27], a[232:235], v[144:147], a[24:27]
  ds_read_b64_tr_b16 a[242:243], v82 offset:20480
  v_cvt_pk_bf16_f32 v176, v48, v49
  v_mfma_f32_16x16x32_bf16 a[20:23], a[232:235], v[136:139], a[20:23]
  v_exp_f32 v50, v50
  v_mfma_f32_16x16x32_bf16 a[20:23], a[236:239], v[140:143], a[20:23]
  ds_read_b64_tr_b16 a[244:245], v82 offset:24576
  v_mfma_f32_16x16x32_bf16 a[16:19], a[236:239], v[132:135], a[16:19]
  v_exp_f32 v51, v51
  v_mfma_f32_16x16x32_bf16 a[16:19], a[232:235], v[128:131], a[16:19]
  ds_read_b64_tr_b16 a[246:247], v82 offset:28672
  v_cvt_pk_bf16_f32 v177, v50, v51
  v_exp_f32 v52, v52
  v_smfmac_f32_16x16x64_bf16 v[8:11], v[4:7], v[128:135], v116
  s_waitcnt lgkmcnt(4)
  buffer_load_dwordx4 v3, s[52:55], s40 offen offset:2048 sc1 lds
  v_mfma_f32_16x16x32_bf16 v[56:59], a[208:211], v[192:195], v[24:27]
  v_exp_f32 v53, v53
  v_mfma_f32_16x16x32_bf16 v[56:59], a[212:215], v[208:211], v[56:59]
  ds_read_b64_tr_b16 a[248:249], v83 offset:16384
  v_cvt_pk_bf16_f32 v184, v52, v53
  v_mfma_f32_16x16x32_bf16 v[56:59], a[216:219], v[224:227], v[56:59]
  v_exp_f32 v54, v54
  v_mfma_f32_16x16x32_bf16 v[56:59], a[220:223], v[240:243], v[56:59]
  ds_read_b64_tr_b16 a[250:251], v83 offset:20480
  v_mfma_f32_16x16x32_bf16 v[60:63], a[220:223], v[244:247], v[28:31]
  v_exp_f32 v55, v55
  v_mfma_f32_16x16x32_bf16 v[60:63], a[216:219], v[228:231], v[60:63]
  ds_read_b64_tr_b16 a[252:253], v83 offset:24576
  v_cvt_pk_bf16_f32 v185, v54, v55
  v_mfma_f32_16x16x32_bf16 v[60:63], a[212:215], v[212:215], v[60:63]
  v_mfma_f32_16x16x32_bf16 v[60:63], a[208:211], v[196:199], v[60:63]
  buffer_load_dwordx4 v3, s[52:55], s40 offen offset:3072 sc1 lds
  v_mfma_f32_16x16x32_bf16 v[64:67], a[208:211], v[200:203], v[32:35]
  v_exp_f32 v56, v56
  v_mfma_f32_16x16x32_bf16 v[64:67], a[212:215], v[216:219], v[64:67]
  ds_read_b64_tr_b16 a[254:255], v83 offset:28672
  v_mfma_f32_16x16x32_bf16 v[64:67], a[216:219], v[232:235], v[64:67]
  v_exp_f32 v57, v57
  v_mfma_f32_16x16x32_bf16 v[64:67], a[220:223], v[248:251], v[64:67]
  ds_read_b128 a[192:195], v76 offset:57344
  v_cvt_pk_bf16_f32 v162, v56, v57
  v_mfma_f32_16x16x32_bf16 v[68:71], a[220:223], v[252:255], v[36:39]
  v_exp_f32 v58, v58
  v_mfma_f32_16x16x32_bf16 v[68:71], a[216:219], v[236:239], v[68:71]
  s_add_u32 m0, s42, 24576
  ds_read_b128 a[196:199], v77 offset:57344
  v_mfma_f32_16x16x32_bf16 v[68:71], a[212:215], v[220:223], v[68:71]
  s_add_u32 s40, s40, 4096
  v_exp_f32 v59, v59
  v_mfma_f32_16x16x32_bf16 v[68:71], a[208:211], v[204:207], v[68:71]
  s_waitcnt lgkmcnt(6)
  buffer_load_dwordx4 v3, s[52:55], s40 offen offset:0 sc1 lds
  v_mfma_f32_16x16x32_bf16 a[32:35], a[240:243], v[128:131], a[32:35]
  v_exp_f32 v60, v60
  v_mfma_f32_16x16x32_bf16 a[32:35], a[244:247], v[132:135], a[32:35]
  ds_read_b128 a[200:203], v78 offset:57344
  v_cvt_pk_bf16_f32 v163, v58, v59
  v_mfma_f32_16x16x32_bf16 a[36:39], a[244:247], v[140:143], a[36:39]
  v_exp_f32 v61, v61
  v_mfma_f32_16x16x32_bf16 a[36:39], a[240:243], v[136:139], a[36:39]
  s_add_u32 m0, s42, 122880
  ds_read_b128 a[204:207], v79 offset:57344
  v_cvt_pk_bf16_f32 v170, v60, v61
  v_mfma_f32_16x16x32_bf16 a[40:43], a[240:243], v[144:147], a[40:43]
  s_add_u32 s40, s40, 77824
  v_exp_f32 v62, v62
  v_mfma_f32_16x16x32_bf16 a[40:43], a[244:247], v[148:151], a[40:43]
  buffer_load_dwordx4 v3, s[52:55], s40 offen offset:0 sc1 lds
  v_mfma_f32_16x16x32_bf16 a[44:47], a[244:247], v[156:159], a[44:47]
  v_exp_f32 v63, v63
  v_mfma_f32_16x16x32_bf16 a[44:47], a[240:243], v[152:155], a[44:47]
  s_waitcnt lgkmcnt(4)
  buffer_load_dwordx4 v3, s[52:55], s40 offen offset:1024 sc1 lds
  v_mfma_f32_16x16x32_bf16 a[60:63], a[248:251], v[152:155], a[60:63]
  v_exp_f32 v64, v64
  v_mfma_f32_16x16x32_bf16 a[60:63], a[252:255], v[156:159], a[60:63]
  ds_read_b64_tr_b16 a[224:225], v84 offset:16384
  v_cvt_pk_bf16_f32 v171, v62, v63
  v_mfma_f32_16x16x32_bf16 a[56:59], a[252:255], v[148:151], a[56:59]
  v_exp_f32 v65, v65
  v_mfma_f32_16x16x32_bf16 a[56:59], a[248:251], v[144:147], a[56:59]
  ds_read_b64_tr_b16 a[226:227], v84 offset:20480
  v_cvt_pk_bf16_f32 v178, v64, v65
  v_mfma_f32_16x16x32_bf16 a[52:55], a[248:251], v[136:139], a[52:55]
  v_exp_f32 v66, v66
  v_mfma_f32_16x16x32_bf16 a[52:55], a[252:255], v[140:143], a[52:55]
  ds_read_b64_tr_b16 a[228:229], v84 offset:24576
  v_mfma_f32_16x16x32_bf16 a[48:51], a[252:255], v[132:135], a[48:51]
  v_exp_f32 v67, v67
  v_mfma_f32_16x16x32_bf16 a[48:51], a[248:251], v[128:131], a[48:51]
  ds_read_b64_tr_b16 a[230:231], v84 offset:28672
  v_cvt_pk_bf16_f32 v179, v66, v67
  v_exp_f32 v68, v68
  v_smfmac_f32_16x16x64_bf16 v[12:15], v[4:7], v[136:143], v116
  s_waitcnt lgkmcnt(4)
  buffer_load_dwordx4 v3, s[52:55], s40 offen offset:2048 sc1 lds
  v_mfma_f32_16x16x32_bf16 v[40:43], a[192:195], v[192:195], v[24:27]
  v_exp_f32 v69, v69
  v_mfma_f32_16x16x32_bf16 v[40:43], a[196:199], v[208:211], v[40:43]
  ds_read_b64_tr_b16 a[232:233], v85 offset:16384
  v_cvt_pk_bf16_f32 v186, v68, v69
  v_mfma_f32_16x16x32_bf16 v[40:43], a[200:203], v[224:227], v[40:43]
  v_exp_f32 v70, v70
  v_mfma_f32_16x16x32_bf16 v[40:43], a[204:207], v[240:243], v[40:43]
  ds_read_b64_tr_b16 a[234:235], v85 offset:20480
  v_mfma_f32_16x16x32_bf16 v[44:47], a[204:207], v[244:247], v[28:31]
  v_exp_f32 v71, v71
  v_mfma_f32_16x16x32_bf16 v[44:47], a[200:203], v[228:231], v[44:47]
  ds_read_b64_tr_b16 a[236:237], v85 offset:24576
  v_cvt_pk_bf16_f32 v187, v70, v71
  v_mfma_f32_16x16x32_bf16 v[44:47], a[196:199], v[212:215], v[44:47]
  v_mfma_f32_16x16x32_bf16 v[44:47], a[192:195], v[196:199], v[44:47]
  buffer_load_dwordx4 v3, s[52:55], s40 offen offset:3072 sc1 lds
  v_mfma_f32_16x16x32_bf16 v[48:51], a[192:195], v[200:203], v[32:35]
  v_exp_f32 v40, v40
  v_mfma_f32_16x16x32_bf16 v[48:51], a[196:199], v[216:219], v[48:51]
  ds_read_b64_tr_b16 a[238:239], v85 offset:28672
  v_mfma_f32_16x16x32_bf16 v[48:51], a[200:203], v[232:235], v[48:51]
  v_exp_f32 v41, v41
  v_mfma_f32_16x16x32_bf16 v[48:51], a[204:207], v[248:251], v[48:51]
  ds_read_b128 a[208:211], v76 offset:61440
  v_cvt_pk_bf16_f32 v164, v40, v41
  v_mfma_f32_16x16x32_bf16 v[52:55], a[204:207], v[252:255], v[36:39]
  v_exp_f32 v42, v42
  v_mfma_f32_16x16x32_bf16 v[52:55], a[200:203], v[236:239], v[52:55]
  s_add_u32 m0, s42, 126976
  ds_read_b128 a[212:215], v77 offset:61440
  v_mfma_f32_16x16x32_bf16 v[52:55], a[196:199], v[220:223], v[52:55]
  s_add_u32 s40, s40, 4096
  v_exp_f32 v43, v43
  v_mfma_f32_16x16x32_bf16 v[52:55], a[192:195], v[204:207], v[52:55]
  s_waitcnt lgkmcnt(6)
  buffer_load_dwordx4 v3, s[52:55], s40 offen offset:0 sc1 lds
  v_mfma_f32_16x16x32_bf16 a[64:67], a[224:227], v[128:131], a[64:67]
  v_exp_f32 v44, v44
  v_mfma_f32_16x16x32_bf16 a[64:67], a[228:231], v[132:135], a[64:67]
  ds_read_b128 a[216:219], v78 offset:61440
  v_cvt_pk_bf16_f32 v165, v42, v43
  v_mfma_f32_16x16x32_bf16 a[68:71], a[228:231], v[140:143], a[68:71]
  v_exp_f32 v45, v45
  v_mfma_f32_16x16x32_bf16 a[68:71], a[224:227], v[136:139], a[68:71]
  ds_read_b128 a[220:223], v79 offset:61440
  v_cvt_pk_bf16_f32 v172, v44, v45
  v_mfma_f32_16x16x32_bf16 a[72:75], a[224:227], v[144:147], a[72:75]
  s_add_u32 s41, s41, 262144
  v_exp_f32 v46, v46
  v_mfma_f32_16x16x32_bf16 a[72:75], a[228:231], v[148:151], a[72:75]
  buffer_load_dwordx4 a[160:163], v112, s[36:39], s41 offen offset:0 sc1
  v_mfma_f32_16x16x32_bf16 a[76:79], a[228:231], v[156:159], a[76:79]
  v_exp_f32 v47, v47
  v_mfma_f32_16x16x32_bf16 a[76:79], a[224:227], v[152:155], a[76:79]
  s_waitcnt lgkmcnt(4)
  buffer_load_dwordx4 a[164:167], v112, s[36:39], s41 offen offset:1024 sc1
  v_mfma_f32_16x16x32_bf16 a[92:95], a[232:235], v[152:155], a[92:95]
  v_exp_f32 v48, v48
  v_mfma_f32_16x16x32_bf16 a[92:95], a[236:239], v[156:159], a[92:95]
  ds_read_b64_tr_b16 a[240:241], v86 offset:16384
  v_cvt_pk_bf16_f32 v173, v46, v47
  v_mfma_f32_16x16x32_bf16 a[88:91], a[236:239], v[148:151], a[88:91]
  v_exp_f32 v49, v49
  v_mfma_f32_16x16x32_bf16 a[88:91], a[232:235], v[144:147], a[88:91]
  ds_read_b64_tr_b16 a[242:243], v86 offset:20480
  v_cvt_pk_bf16_f32 v180, v48, v49
  v_mfma_f32_16x16x32_bf16 a[84:87], a[232:235], v[136:139], a[84:87]
  v_exp_f32 v50, v50
  v_mfma_f32_16x16x32_bf16 a[84:87], a[236:239], v[140:143], a[84:87]
  ds_read_b64_tr_b16 a[244:245], v86 offset:24576
  v_mfma_f32_16x16x32_bf16 a[80:83], a[236:239], v[132:135], a[80:83]
  v_exp_f32 v51, v51
  v_mfma_f32_16x16x32_bf16 a[80:83], a[232:235], v[128:131], a[80:83]
  ds_read_b64_tr_b16 a[246:247], v86 offset:28672
  v_cvt_pk_bf16_f32 v181, v50, v51
  v_exp_f32 v52, v52
  v_smfmac_f32_16x16x64_bf16 v[16:19], v[4:7], v[144:151], v116
  s_waitcnt lgkmcnt(4)
  buffer_load_dwordx4 a[168:171], v113, s[36:39], s41 offen offset:0 sc1
  v_mfma_f32_16x16x32_bf16 v[56:59], a[208:211], v[192:195], v[24:27]
  v_exp_f32 v53, v53
  v_mfma_f32_16x16x32_bf16 v[56:59], a[212:215], v[208:211], v[56:59]
  ds_read_b64_tr_b16 a[248:249], v87 offset:16384
  v_cvt_pk_bf16_f32 v188, v52, v53
  v_mfma_f32_16x16x32_bf16 v[56:59], a[216:219], v[224:227], v[56:59]
  v_exp_f32 v54, v54
  v_mfma_f32_16x16x32_bf16 v[56:59], a[220:223], v[240:243], v[56:59]
  ds_read_b64_tr_b16 a[250:251], v87 offset:20480
  v_mfma_f32_16x16x32_bf16 v[60:63], a[220:223], v[244:247], v[28:31]
  v_exp_f32 v55, v55
  v_mfma_f32_16x16x32_bf16 v[60:63], a[216:219], v[228:231], v[60:63]
  s_add_u32 m0, s42, 40960
  ds_read_b64_tr_b16 a[252:253], v87 offset:24576
  v_cvt_pk_bf16_f32 v189, v54, v55
  v_mfma_f32_16x16x32_bf16 v[60:63], a[212:215], v[212:215], v[60:63]
  s_waitcnt vmcnt(16)
  s_barrier
  s_add_u32 s40, s40, 77824
  v_mfma_f32_16x16x32_bf16 v[60:63], a[208:211], v[196:199], v[60:63]
  buffer_load_dwordx4 a[172:175], v113, s[36:39], s41 offen offset:1024 sc1
  buffer_load_dwordx4 v3, s[52:55], s40 offen offset:0 sc1 lds
  v_mfma_f32_16x16x32_bf16 v[64:67], a[208:211], v[200:203], v[32:35]
  v_exp_f32 v56, v56
  v_mfma_f32_16x16x32_bf16 v[64:67], a[212:215], v[216:219], v[64:67]
L_pad_post01_0:
  s_cbranch_execz L_pad_post01_1
  ds_read_b64_tr_b16 a[254:255], v87 offset:28672
  v_mfma_f32_16x16x32_bf16 v[64:67], a[216:219], v[232:235], v[64:67]
  v_exp_f32 v57, v57
  v_mfma_f32_16x16x32_bf16 v[64:67], a[220:223], v[248:251], v[64:67]
  buffer_load_dwordx4 v3, s[52:55], s40 offen offset:1024 sc1 lds
  v_mfma_f32_16x16x32_bf16 v[68:71], a[220:223], v[252:255], v[36:39]
  v_exp_f32 v58, v58
  v_mfma_f32_16x16x32_bf16 v[68:71], a[216:219], v[236:239], v[68:71]
  buffer_load_dwordx4 v3, s[52:55], s40 offen offset:2048 sc1 lds
  v_mfma_f32_16x16x32_bf16 v[68:71], a[212:215], v[220:223], v[68:71]
  v_exp_f32 v59, v59
  v_mfma_f32_16x16x32_bf16 v[68:71], a[208:211], v[204:207], v[68:71]
  s_waitcnt lgkmcnt(4)
  buffer_load_dwordx4 v3, s[52:55], s40 offen offset:3072 sc1 lds
  v_mfma_f32_16x16x32_bf16 a[96:99], a[240:243], v[128:131], a[96:99]
  s_add_u32 m0, s42, 45056
  s_add_u32 s40, s40, 4096
  v_exp_f32 v60, v60
  v_mfma_f32_16x16x32_bf16 a[96:99], a[244:247], v[132:135], a[96:99]
  buffer_load_dwordx4 v3, s[52:55], s40 offen offset:0 sc1 lds
  v_mfma_f32_16x16x32_bf16 a[100:103], a[244:247], v[140:143], a[100:103]
  s_add_u32 s41, s41, 262144
  v_exp_f32 v61, v61
  v_mfma_f32_16x16x32_bf16 a[100:103], a[240:243], v[136:139], a[100:103]
  buffer_load_dwordx4 a[176:179], v112, s[36:39], s41 offen offset:0 sc1
  v_mfma_f32_16x16x32_bf16 a[104:107], a[240:243], v[144:147], a[104:107]
  v_exp_f32 v62, v62
  v_mfma_f32_16x16x32_bf16 a[104:107], a[244:247], v[148:151], a[104:107]
  buffer_load_dwordx4 a[180:183], v112, s[36:39], s41 offen offset:1024 sc1
  v_mfma_f32_16x16x32_bf16 a[108:111], a[244:247], v[156:159], a[108:111]
  v_exp_f32 v63, v63
  v_mfma_f32_16x16x32_bf16 a[108:111], a[240:243], v[152:155], a[108:111]
  s_waitcnt lgkmcnt(0)
  buffer_load_dwordx4 a[184:187], v113, s[36:39], s41 offen offset:0 sc1
  v_cvt_pk_bf16_f32 v166, v56, v57
  v_mfma_f32_16x16x32_bf16 a[124:127], a[248:251], v[152:155], a[124:127]
  v_exp_f32 v64, v64
  v_mfma_f32_16x16x32_bf16 a[124:127], a[252:255], v[156:159], a[124:127]
  ds_read_b64_tr_b16 a[224:225], v80 offset:0
  v_cvt_pk_bf16_f32 v167, v58, v59
  v_mfma_f32_16x16x32_bf16 a[120:123], a[252:255], v[148:151], a[120:123]
  v_exp_f32 v65, v65
  v_mfma_f32_16x16x32_bf16 a[120:123], a[248:251], v[144:147], a[120:123]
  ds_read_b64_tr_b16 a[226:227], v80 offset:4096
  v_cvt_pk_bf16_f32 v174, v60, v61
  v_mfma_f32_16x16x32_bf16 a[116:119], a[248:251], v[136:139], a[116:119]
  v_exp_f32 v66, v66
  v_mfma_f32_16x16x32_bf16 a[116:119], a[252:255], v[140:143], a[116:119]
  ds_read_b64_tr_b16 a[228:229], v80 offset:8192
  v_cvt_pk_bf16_f32 v175, v62, v63
  v_mfma_f32_16x16x32_bf16 a[112:115], a[252:255], v[132:135], a[112:115]
  v_exp_f32 v67, v67
  v_mfma_f32_16x16x32_bf16 a[112:115], a[248:251], v[128:131], a[112:115]
  ds_read_b64_tr_b16 a[230:231], v80 offset:12288
  v_cvt_pk_bf16_f32 v182, v64, v65
  v_exp_f32 v68, v68
  v_smfmac_f32_16x16x64_bf16 v[20:23], v[4:7], v[152:159], v116
  buffer_load_dwordx4 a[188:191], v113, s[36:39], s41 offen offset:1024 sc1
  v_exp_f32 v69, v69
  ds_read_b64_tr_b16 a[232:233], v81 offset:0
  v_cvt_pk_bf16_f32 v183, v66, v67
  v_exp_f32 v70, v70
  ds_read_b64_tr_b16 a[234:235], v81 offset:4096
  v_cvt_pk_bf16_f32 v190, v68, v69
  v_exp_f32 v71, v71
  ds_read_b64_tr_b16 a[236:237], v81 offset:8192
  v_cvt_pk_bf16_f32 v191, v70, v71
  s_add_u32 m0, s42, 102400
  v_smfmac_f32_16x16x64_bf16 v[8:11], v[4:7], v[160:167], v116
  s_add_u32 s40, s40, 77824
  ds_read_b64_tr_b16 a[238:239], v81 offset:12288
  buffer_load_dwordx4 v3, s[52:55], s40 offen offset:0 sc1 lds
  v_smfmac_f32_16x16x64_bf16 v[12:15], v[4:7], v[168:175], v116
  buffer_load_dwordx4 v3, s[52:55], s40 offen offset:1024 sc1 lds
  buffer_load_dwordx4 v3, s[52:55], s40 offen offset:2048 sc1 lds
  v_smfmac_f32_16x16x64_bf16 v[16:19], v[4:7], v[176:183], v116
  v_smfmac_f32_16x16x64_bf16 v[20:23], v[4:7], v[184:191], v116
  s_waitcnt lgkmcnt(4)
  v_mfma_f32_16x16x32_bf16 a[0:3], a[224:227], v[160:163], a[0:3]
  buffer_load_dwordx4 v3, s[52:55], s40 offen offset:3072 sc1 lds
  v_mfma_f32_16x16x32_bf16 a[0:3], a[228:231], v[164:167], a[0:3]
  s_add_u32 m0, s42, 106496
  s_add_u32 s40, s40, 4096
  v_mfma_f32_16x16x32_bf16 a[4:7], a[228:231], v[172:175], a[4:7]
  buffer_load_dwordx4 v3, s[52:55], s40 offen offset:0 sc1 lds
  v_mfma_f32_16x16x32_bf16 a[4:7], a[224:227], v[168:171], a[4:7]
  v_mfma_f32_16x16x32_bf16 a[8:11], a[224:227], v[176:179], a[8:11]
  v_add_f32 v72, v8, v9
  v_mfma_f32_16x16x32_bf16 a[8:11], a[228:231], v[180:183], a[8:11]
  v_add_f32 v73, v12, v13
  v_mfma_f32_16x16x32_bf16 a[12:15], a[228:231], v[188:191], a[12:15]
  v_add_f32 v74, v16, v17
  v_mfma_f32_16x16x32_bf16 a[12:15], a[224:227], v[184:187], a[12:15]
  s_waitcnt lgkmcnt(0)
  v_mfma_f32_16x16x32_bf16 a[28:31], a[232:235], v[184:187], a[28:31]
  v_add_f32 v75, v20, v21
  v_mfma_f32_16x16x32_bf16 a[28:31], a[236:239], v[188:191], a[28:31]
  ds_read_b64_tr_b16 a[240:241], v82 offset:0
  v_rcp_f32 v100, v72
  v_mfma_f32_16x16x32_bf16 a[24:27], a[236:239], v[180:183], a[24:27]
  v_rcp_f32 v101, v73
  v_mfma_f32_16x16x32_bf16 a[24:27], a[232:235], v[176:179], a[24:27]
  ds_read_b64_tr_b16 a[242:243], v82 offset:4096
  v_mfma_f32_16x16x32_bf16 a[20:23], a[232:235], v[168:171], a[20:23]
  v_rcp_f32 v102, v74
  v_mfma_f32_16x16x32_bf16 a[20:23], a[236:239], v[172:175], a[20:23]
  ds_read_b64_tr_b16 a[244:245], v82 offset:8192
  v_rcp_f32 v103, v75
  v_mfma_f32_16x16x32_bf16 a[16:19], a[236:239], v[164:167], a[16:19]
  v_mfma_f32_16x16x32_bf16 a[16:19], a[232:235], v[160:163], a[16:19]
  ds_read_b64_tr_b16 a[246:247], v82 offset:12288
  ds_read_b64_tr_b16 a[248:249], v83 offset:0
  ds_read_b64_tr_b16 a[250:251], v83 offset:4096
  ds_read_b64_tr_b16 a[252:253], v83 offset:8192
  ds_read_b64_tr_b16 a[254:255], v83 offset:12288
  v_accvgpr_read_b32 v40, a0
  v_accvgpr_read_b32 v41, a1
  v_accvgpr_read_b32 v42, a2
  v_accvgpr_read_b32 v43, a3
  v_accvgpr_read_b32 v44, a16
  v_accvgpr_read_b32 v45, a17
  v_accvgpr_read_b32 v46, a18
  v_accvgpr_read_b32 v47, a19
  v_mul_f32 v40, v40, v100
  v_mul_f32 v41, v41, v100
  v_mul_f32 v42, v42, v100
  v_mul_f32 v43, v43, v100
  v_mul_f32 v44, v44, v100
  v_mul_f32 v45, v45, v100
  v_mul_f32 v46, v46, v100
  v_mul_f32 v47, v47, v100
  v_cvt_pk_bf16_f32 v128, v40, v41
  v_cvt_pk_bf16_f32 v129, v42, v43
  v_cvt_pk_bf16_f32 v130, v44, v45
  v_cvt_pk_bf16_f32 v131, v46, v47
  buffer_store_dwordx4 v[128:131], v112, s[32:35], s46 offen offset:0 sc1
  s_waitcnt lgkmcnt(4)
  v_mfma_f32_16x16x32_bf16 a[32:35], a[240:243], v[160:163], a[32:35]
  v_accvgpr_read_b32 v48, a4
  v_accvgpr_read_b32 v49, a5
  v_accvgpr_read_b32 v50, a6
  v_mfma_f32_16x16x32_bf16 v[104:107], v[4:7], v[128:131], 0
  v_accvgpr_read_b32 v51, a7
  v_mfma_f32_16x16x32_bf16 a[32:35], a[244:247], v[164:167], a[32:35]
  v_accvgpr_read_b32 v52, a20
  v_accvgpr_read_b32 v53, a21
  v_accvgpr_read_b32 v54, a22
  v_accvgpr_read_b32 v55, a23
  v_mfma_f32_16x16x32_bf16 a[36:39], a[244:247], v[172:175], a[36:39]
  v_mul_f32 v48, v48, v101
  v_mul_f32 v49, v49, v101
  v_mul_f32 v50, v50, v101
  v_mul_f32 v51, v51, v101
  v_mfma_f32_16x16x32_bf16 a[36:39], a[240:243], v[168:171], a[36:39]
  v_mul_f32 v52, v52, v101
  v_mul_f32 v53, v53, v101
  v_mul_f32 v54, v54, v101
  v_mul_f32 v55, v55, v101
  v_mfma_f32_16x16x32_bf16 a[40:43], a[240:243], v[176:179], a[40:43]
  v_cvt_pk_bf16_f32 v132, v48, v49
  v_cvt_pk_bf16_f32 v133, v50, v51
  v_cvt_pk_bf16_f32 v134, v52, v53
  v_cvt_pk_bf16_f32 v135, v54, v55
  v_mfma_f32_16x16x32_bf16 a[40:43], a[244:247], v[180:183], a[40:43]
  buffer_store_dwordx4 v[132:135], v113, s[32:35], s46 offen offset:0 sc1
  v_accvgpr_read_b32 v56, a8
  v_accvgpr_read_b32 v57, a9
  v_accvgpr_read_b32 v58, a10
  v_mfma_f32_16x16x32_bf16 v[104:107], v[4:7], v[132:135], v[104:107]
  v_mfma_f32_16x16x32_bf16 a[44:47], a[244:247], v[188:191], a[44:47]
  v_accvgpr_read_b32 v59, a11
  v_accvgpr_read_b32 v60, a24
  v_accvgpr_read_b32 v61, a25
  v_accvgpr_read_b32 v62, a26
  v_mfma_f32_16x16x32_bf16 a[44:47], a[240:243], v[184:187], a[44:47]
  s_waitcnt lgkmcnt(0)
  v_accvgpr_read_b32 v63, a27
  v_mul_f32 v56, v56, v102
  v_mul_f32 v57, v57, v102
  v_mul_f32 v58, v58, v102
  v_mfma_f32_16x16x32_bf16 a[60:63], a[248:251], v[184:187], a[60:63]
  v_mul_f32 v59, v59, v102
  v_mul_f32 v60, v60, v102
  v_mul_f32 v61, v61, v102
  v_mul_f32 v62, v62, v102
  v_mfma_f32_16x16x32_bf16 a[60:63], a[252:255], v[188:191], a[60:63]
  ds_read_b64_tr_b16 a[224:225], v84 offset:0
  v_mul_f32 v63, v63, v102
  v_cvt_pk_bf16_f32 v56, v56, v57
  v_cvt_pk_bf16_f32 v57, v58, v59
  v_cvt_pk_bf16_f32 v58, v60, v61
  v_mfma_f32_16x16x32_bf16 a[56:59], a[252:255], v[180:183], a[56:59]
  v_cvt_pk_bf16_f32 v59, v62, v63
  buffer_store_dwordx4 v[56:59], v95, s[32:35], s46 offen offset:0 sc1
  v_accvgpr_read_b32 v64, a12
  v_accvgpr_read_b32 v65, a13
  v_accvgpr_read_b32 v66, a14
  v_mfma_f32_16x16x32_bf16 a[56:59], a[248:251], v[176:179], a[56:59]
  ds_read_b64_tr_b16 a[226:227], v84 offset:4096
  v_mfma_f32_16x16x32_bf16 v[104:107], v[4:7], v[56:59], v[104:107]
  v_accvgpr_read_b32 v67, a15
  v_accvgpr_read_b32 v68, a28
  v_accvgpr_read_b32 v69, a29
  v_mfma_f32_16x16x32_bf16 a[52:55], a[248:251], v[168:171], a[52:55]
  v_accvgpr_read_b32 v70, a30
  v_accvgpr_read_b32 v71, a31
  v_mul_f32 v64, v64, v103
  v_mul_f32 v65, v65, v103
  v_mfma_f32_16x16x32_bf16 a[52:55], a[252:255], v[172:175], a[52:55]
  ds_read_b64_tr_b16 a[228:229], v84 offset:8192
  v_mul_f32 v66, v66, v103
  v_mul_f32 v67, v67, v103
  v_mul_f32 v68, v68, v103
  v_mul_f32 v69, v69, v103
  v_mfma_f32_16x16x32_bf16 a[48:51], a[252:255], v[164:167], a[48:51]
  v_mul_f32 v70, v70, v103
  v_mul_f32 v71, v71, v103
  v_cvt_pk_bf16_f32 v64, v64, v65
  v_cvt_pk_bf16_f32 v65, v66, v67
  v_mfma_f32_16x16x32_bf16 a[48:51], a[248:251], v[160:163], a[48:51]
  ds_read_b64_tr_b16 a[230:231], v84 offset:12288
  v_cvt_pk_bf16_f32 v66, v68, v69
  v_cvt_pk_bf16_f32 v67, v70, v71
  buffer_store_dwordx4 v[64:67], v115, s[32:35], s46 offen offset:0 sc1
  s_nop 0
  v_mfma_f32_16x16x32_bf16 v[104:107], v[4:7], v[64:67], v[104:107]
  ds_read_b64_tr_b16 a[232:233], v85 offset:0
  ds_read_b64_tr_b16 a[234:235], v85 offset:4096
  ds_read_b64_tr_b16 a[236:237], v85 offset:8192
  ds_read_b64_tr_b16 a[238:239], v85 offset:12288
  v_accvgpr_read_b32 v40, a32
  v_accvgpr_read_b32 v41, a33
  v_accvgpr_read_b32 v42, a34
  v_accvgpr_read_b32 v43, a35
  v_accvgpr_read_b32 v44, a48
  v_accvgpr_read_b32 v45, a49
  v_accvgpr_read_b32 v46, a50
  v_accvgpr_read_b32 v47, a51
  v_mul_f32 v40, v40, v100
  v_mul_f32 v41, v41, v100
  v_mul_f32 v42, v42, v100
  v_mul_f32 v43, v43, v100
  v_mul_f32 v44, v44, v100
  v_mul_f32 v45, v45, v100
  v_mul_f32 v46, v46, v100
  v_mul_f32 v47, v47, v100
  v_cvt_pk_bf16_f32 v136, v40, v41
  v_cvt_pk_bf16_f32 v137, v42, v43
  v_cvt_pk_bf16_f32 v138, v44, v45
  v_cvt_pk_bf16_f32 v139, v46, v47
  buffer_store_dwordx4 v[136:139], v112, s[32:35], s46 offen offset:1024 sc1
  s_waitcnt lgkmcnt(4)
  v_mfma_f32_16x16x32_bf16 a[64:67], a[224:227], v[160:163], a[64:67]
  v_accvgpr_read_b32 v48, a36
  v_accvgpr_read_b32 v49, a37
  v_accvgpr_read_b32 v50, a38
  v_mfma_f32_16x16x32_bf16 v[104:107], v[4:7], v[136:139], v[104:107]
  v_accvgpr_read_b32 v51, a39
  v_mfma_f32_16x16x32_bf16 a[64:67], a[228:231], v[164:167], a[64:67]
  v_accvgpr_read_b32 v52, a52
  v_accvgpr_read_b32 v53, a53
  v_accvgpr_read_b32 v54, a54
  v_accvgpr_read_b32 v55, a55
  v_mfma_f32_16x16x32_bf16 a[68:71], a[228:231], v[172:175], a[68:71]
  v_mul_f32 v48, v48, v101
  v_mul_f32 v49, v49, v101
  v_mul_f32 v50, v50, v101
  v_mul_f32 v51, v51, v101
  v_mfma_f32_16x16x32_bf16 a[68:71], a[224:227], v[168:171], a[68:71]
  v_mul_f32 v52, v52, v101
  v_mul_f32 v53, v53, v101
  v_mul_f32 v54, v54, v101
  v_mul_f32 v55, v55, v101
  v_mfma_f32_16x16x32_bf16 a[72:75], a[224:227], v[176:179], a[72:75]
  v_cvt_pk_bf16_f32 v140, v48, v49
  v_cvt_pk_bf16_f32 v141, v50, v51
  v_cvt_pk_bf16_f32 v142, v52, v53
  v_cvt_pk_bf16_f32 v143, v54, v55
  v_mfma_f32_16x16x32_bf16 a[72:75], a[228:231], v[180:183], a[72:75]
  buffer_store_dwordx4 v[140:143], v113, s[32:35], s46 offen offset:1024 sc1
  v_accvgpr_read_b32 v56, a40
  v_accvgpr_read_b32 v57, a41
  v_accvgpr_read_b32 v58, a42
  v_mfma_f32_16x16x32_bf16 v[104:107], v[4:7], v[140:143], v[104:107]
  v_mfma_f32_16x16x32_bf16 a[76:79], a[228:231], v[188:191], a[76:79]
  v_accvgpr_read_b32 v59, a43
  v_accvgpr_read_b32 v60, a56
  v_accvgpr_read_b32 v61, a57
  v_accvgpr_read_b32 v62, a58
  v_mfma_f32_16x16x32_bf16 a[76:79], a[224:227], v[184:187], a[76:79]
  s_waitcnt lgkmcnt(0)
  v_accvgpr_read_b32 v63, a59
  v_mul_f32 v56, v56, v102
  v_mul_f32 v57, v57, v102
  v_mul_f32 v58, v58, v102
  v_mfma_f32_16x16x32_bf16 a[92:95], a[232:235], v[184:187], a[92:95]
  v_mul_f32 v59, v59, v102
  v_mul_f32 v60, v60, v102
  v_mul_f32 v61, v61, v102
  v_mul_f32 v62, v62, v102
  v_mfma_f32_16x16x32_bf16 a[92:95], a[236:239], v[188:191], a[92:95]
  ds_read_b64_tr_b16 a[240:241], v86 offset:0
  v_mul_f32 v63, v63, v102
  v_cvt_pk_bf16_f32 v56, v56, v57
  v_cvt_pk_bf16_f32 v57, v58, v59
  v_cvt_pk_bf16_f32 v58, v60, v61
  v_mfma_f32_16x16x32_bf16 a[88:91], a[236:239], v[180:183], a[88:91]
  v_cvt_pk_bf16_f32 v59, v62, v63
  buffer_store_dwordx4 v[56:59], v95, s[32:35], s46 offen offset:1024 sc1
  v_accvgpr_read_b32 v64, a44
  v_accvgpr_read_b32 v65, a45
  v_accvgpr_read_b32 v66, a46
  v_mfma_f32_16x16x32_bf16 a[88:91], a[232:235], v[176:179], a[88:91]
  ds_read_b64_tr_b16 a[242:243], v86 offset:4096
  v_mfma_f32_16x16x32_bf16 v[104:107], v[4:7], v[56:59], v[104:107]
  v_accvgpr_read_b32 v67, a47
  v_accvgpr_read_b32 v68, a60
  v_accvgpr_read_b32 v69, a61
  v_mfma_f32_16x16x32_bf16 a[84:87], a[232:235], v[168:171], a[84:87]
  v_accvgpr_read_b32 v70, a62
  v_accvgpr_read_b32 v71, a63
  v_mul_f32 v64, v64, v103
  v_mul_f32 v65, v65, v103
  v_mfma_f32_16x16x32_bf16 a[84:87], a[236:239], v[172:175], a[84:87]
  ds_read_b64_tr_b16 a[244:245], v86 offset:8192
  v_mul_f32 v66, v66, v103
  v_mul_f32 v67, v67, v103
  v_mul_f32 v68, v68, v103
  v_mul_f32 v69, v69, v103
  v_mfma_f32_16x16x32_bf16 a[80:83], a[236:239], v[164:167], a[80:83]
  v_mul_f32 v70, v70, v103
  v_mul_f32 v71, v71, v103
  v_cvt_pk_bf16_f32 v64, v64, v65
  v_cvt_pk_bf16_f32 v65, v66, v67
  v_mfma_f32_16x16x32_bf16 a[80:83], a[232:235], v[160:163], a[80:83]
  ds_read_b64_tr_b16 a[246:247], v86 offset:12288
  v_cvt_pk_bf16_f32 v66, v68, v69
  v_cvt_pk_bf16_f32 v67, v70, v71
  buffer_store_dwordx4 v[64:67], v115, s[32:35], s46 offen offset:1024 sc1
  s_nop 0
  v_mfma_f32_16x16x32_bf16 v[104:107], v[4:7], v[64:67], v[104:107]
  ds_read_b64_tr_b16 a[248:249], v87 offset:0
  ds_read_b64_tr_b16 a[250:251], v87 offset:4096
  ds_read_b64_tr_b16 a[252:253], v87 offset:8192
  ds_read_b64_tr_b16 a[254:255], v87 offset:12288
  v_accvgpr_read_b32 v40, a64
  v_accvgpr_read_b32 v41, a65
  v_accvgpr_read_b32 v42, a66
  v_accvgpr_read_b32 v43, a67
  v_accvgpr_read_b32 v44, a80
  v_accvgpr_read_b32 v45, a81
  v_accvgpr_read_b32 v46, a82
  v_accvgpr_read_b32 v47, a83
  v_mul_f32 v40, v40, v100
  v_mul_f32 v41, v41, v100
  v_mul_f32 v42, v42, v100
  v_mul_f32 v43, v43, v100
  v_mul_f32 v44, v44, v100
  v_mul_f32 v45, v45, v100
  v_mul_f32 v46, v46, v100
  v_mul_f32 v47, v47, v100
  v_cvt_pk_bf16_f32 v144, v40, v41
  v_cvt_pk_bf16_f32 v145, v42, v43
  v_cvt_pk_bf16_f32 v146, v44, v45
  v_cvt_pk_bf16_f32 v147, v46, v47
  buffer_store_dwordx4 v[144:147], v112, s[32:35], s82 offen offset:0 sc1
  s_waitcnt lgkmcnt(4)
  v_mfma_f32_16x16x32_bf16 a[96:99], a[240:243], v[160:163], a[96:99]
  v_accvgpr_read_b32 v48, a68
  v_accvgpr_read_b32 v49, a69
  v_accvgpr_read_b32 v50, a70
  v_mfma_f32_16x16x32_bf16 v[104:107], v[4:7], v[144:147], v[104:107]
  v_accvgpr_read_b32 v51, a71
  v_mfma_f32_16x16x32_bf16 a[96:99], a[244:247], v[164:167], a[96:99]
  v_accvgpr_read_b32 v52, a84
  v_accvgpr_read_b32 v53, a85
  v_accvgpr_read_b32 v54, a86
  v_accvgpr_read_b32 v55, a87
  v_mfma_f32_16x16x32_bf16 a[100:103], a[244:247], v[172:175], a[100:103]
  v_mul_f32 v48, v48, v101
  v_mul_f32 v49, v49, v101
  v_mul_f32 v50, v50, v101
  v_mul_f32 v51, v51, v101
  v_mfma_f32_16x16x32_bf16 a[100:103], a[240:243], v[168:171], a[100:103]
  v_mul_f32 v52, v52, v101
  v_mul_f32 v53, v53, v101
  v_mul_f32 v54, v54, v101
  v_mul_f32 v55, v55, v101
  v_mfma_f32_16x16x32_bf16 a[104:107], a[240:243], v[176:179], a[104:107]
  v_cvt_pk_bf16_f32 v148, v48, v49
  v_cvt_pk_bf16_f32 v149, v50, v51
  v_cvt_pk_bf16_f32 v150, v52, v53
  v_cvt_pk_bf16_f32 v151, v54, v55
  v_mfma_f32_16x16x32_bf16 a[104:107], a[244:247], v[180:183], a[104:107]
  buffer_store_dwordx4 v[148:151], v113, s[32:35], s82 offen offset:0 sc1
  v_accvgpr_read_b32 v56, a72
  v_accvgpr_read_b32 v57, a73
  v_accvgpr_read_b32 v58, a74
  v_mfma_f32_16x16x32_bf16 a[108:111], a[244:247], v[188:191], a[108:111]
  v_mfma_f32_16x16x32_bf16 v[104:107], v[4:7], v[148:151], v[104:107]
  v_accvgpr_read_b32 v59, a75
  v_accvgpr_read_b32 v60, a88
  v_accvgpr_read_b32 v61, a89
  v_mfma_f32_16x16x32_bf16 a[108:111], a[240:243], v[184:187], a[108:111]
  s_waitcnt lgkmcnt(0)
  v_accvgpr_read_b32 v62, a90
  v_accvgpr_read_b32 v63, a91
  v_mul_f32 v56, v56, v102
  v_mul_f32 v57, v57, v102
  v_mfma_f32_16x16x32_bf16 a[124:127], a[248:251], v[184:187], a[124:127]
  v_mul_f32 v58, v58, v102
  v_mul_f32 v59, v59, v102
  v_mul_f32 v60, v60, v102
  v_mul_f32 v61, v61, v102
  v_mfma_f32_16x16x32_bf16 a[124:127], a[252:255], v[188:191], a[124:127]
  v_mul_f32 v62, v62, v102
  v_mul_f32 v63, v63, v102
  v_cvt_pk_bf16_f32 v56, v56, v57
  v_cvt_pk_bf16_f32 v57, v58, v59
  v_mfma_f32_16x16x32_bf16 a[120:123], a[252:255], v[180:183], a[120:123]
  v_cvt_pk_bf16_f32 v58, v60, v61
  v_cvt_pk_bf16_f32 v59, v62, v63
  v_accvgpr_read_b32 v64, a76
  v_accvgpr_read_b32 v65, a77
  v_mfma_f32_16x16x32_bf16 a[120:123], a[248:251], v[176:179], a[120:123]
  v_accvgpr_read_b32 v66, a78
  v_mfma_f32_16x16x32_bf16 v[104:107], v[4:7], v[56:59], v[104:107]
  v_accvgpr_read_b32 v67, a79
  v_accvgpr_read_b32 v68, a92
  v_mfma_f32_16x16x32_bf16 a[116:119], a[248:251], v[168:171], a[116:119]
  v_accvgpr_read_b32 v69, a93
  v_accvgpr_read_b32 v70, a94
  v_accvgpr_read_b32 v71, a95
  v_mul_f32 v64, v64, v103
  v_mfma_f32_16x16x32_bf16 a[116:119], a[252:255], v[172:175], a[116:119]
  v_mul_f32 v65, v65, v103
  v_mul_f32 v66, v66, v103
  v_mul_f32 v67, v67, v103
  v_mul_f32 v68, v68, v103
  v_mfma_f32_16x16x32_bf16 a[112:115], a[252:255], v[164:167], a[112:115]
  v_mul_f32 v69, v69, v103
  v_mul_f32 v70, v70, v103
  v_mul_f32 v71, v71, v103
  v_cvt_pk_bf16_f32 v64, v64, v65
  v_mfma_f32_16x16x32_bf16 a[112:115], a[248:251], v[160:163], a[112:115]
  v_cvt_pk_bf16_f32 v65, v66, v67
  v_cvt_pk_bf16_f32 v66, v68, v69
  v_cvt_pk_bf16_f32 v67, v70, v71
  s_nop 1
  v_mfma_f32_16x16x32_bf16 v[104:107], v[4:7], v[64:67], v[104:107]
  s_waitcnt vmcnt(38)
  s_waitcnt lgkmcnt(0)
  s_barrier
  ds_read_b128 a[192:195], v121 offset:20480
  ds_read_b128 a[196:199], v121 offset:30720
  ds_read_b128 a[200:203], v121 offset:21504
  ds_read_b128 a[204:207], v121 offset:31744
  ds_read_b128 a[208:211], v121 offset:22528
  ds_read_b128 a[212:215], v121 offset:32768
  ds_read_b128 a[216:219], v121 offset:23552
  ds_read_b128 a[220:223], v121 offset:33792
  s_waitcnt lgkmcnt(4)
  v_mfma_f32_16x16x32_bf16 a[0:3], a[192:195], a[128:131], 0
  ds_read_b128 a[224:227], v121 offset:24576
  v_accvgpr_read_b32 v160, a96
  v_accvgpr_read_b32 v161, a97
  v_mfma_f32_16x16x32_bf16 a[0:3], a[196:199], a[132:135], a[0:3]
  v_accvgpr_read_b32 v162, a98
  v_accvgpr_read_b32 v163, a99
  v_accvgpr_read_b32 v164, a112
  v_mfma_f32_16x16x32_bf16 a[4:7], a[196:199], a[140:143], 0
  ds_read_b128 a[228:231], v121 offset:34816
  v_accvgpr_read_b32 v165, a113
  v_accvgpr_read_b32 v166, a114
  v_mfma_f32_16x16x32_bf16 a[4:7], a[192:195], a[136:139], a[4:7]
  buffer_store_dwordx4 v[56:59], v95, s[32:35], s82 offen offset:0 sc1
  v_mfma_f32_16x16x32_bf16 a[12:15], a[200:203], a[136:139], 0
  ds_read_b128 a[232:235], v121 offset:25600
  v_accvgpr_read_b32 v167, a115
  v_mul_f32 v160, v160, v100
  v_mfma_f32_16x16x32_bf16 a[12:15], a[204:207], a[140:143], a[12:15]
  v_mul_f32 v161, v161, v100
  v_mul_f32 v162, v162, v100
  v_mul_f32 v163, v163, v100
  v_mfma_f32_16x16x32_bf16 a[8:11], a[204:207], a[132:135], 0
  ds_read_b128 a[236:239], v121 offset:35840
  v_mul_f32 v164, v164, v100
  v_mul_f32 v165, v165, v100
  v_mfma_f32_16x16x32_bf16 a[8:11], a[200:203], a[128:131], a[8:11]
  s_waitcnt lgkmcnt(4)
  buffer_store_dwordx4 v[64:67], v115, s[32:35], s82 offen offset:0 sc1
  v_mfma_f32_16x16x32_bf16 a[16:19], a[208:211], a[128:131], 0
  ds_read_b128 a[240:243], v121 offset:26624
  v_mul_f32 v166, v166, v100
  v_mul_f32 v167, v167, v100
  v_mfma_f32_16x16x32_bf16 a[16:19], a[212:215], a[132:135], a[16:19]
  v_cvt_pk_bf16_f32 v152, v160, v161
  v_cvt_pk_bf16_f32 v153, v162, v163
  v_cvt_pk_bf16_f32 v154, v164, v165
  v_mfma_f32_16x16x32_bf16 a[20:23], a[212:215], a[140:143], 0
  ds_read_b128 a[244:247], v121 offset:36864
  v_cvt_pk_bf16_f32 v155, v166, v167
  v_mfma_f32_16x16x32_bf16 a[20:23], a[208:211], a[136:139], a[20:23]
  v_mfma_f32_16x16x32_bf16 a[28:31], a[216:219], a[136:139], 0
  ds_read_b128 a[248:251], v121 offset:27648
  v_accvgpr_read_b32 v168, a100
  v_accvgpr_read_b32 v169, a101
  v_mfma_f32_16x16x32_bf16 a[28:31], a[220:223], a[140:143], a[28:31]
  v_accvgpr_read_b32 v170, a102
  v_mfma_f32_16x16x32_bf16 v[104:107], v[4:7], v[152:155], v[104:107]
  v_accvgpr_read_b32 v171, a103
  v_mfma_f32_16x16x32_bf16 a[24:27], a[220:223], a[132:135], 0
  ds_read_b128 a[252:255], v121 offset:37888
  v_accvgpr_read_b32 v172, a116
  v_accvgpr_read_b32 v173, a117
  v_mfma_f32_16x16x32_bf16 a[24:27], a[216:219], a[128:131], a[24:27]
  s_waitcnt lgkmcnt(4)
  v_mfma_f32_16x16x32_bf16 a[32:35], a[224:227], a[128:131], 0
  ds_read_b128 a[192:195], v121 offset:28672
  v_accvgpr_read_b32 v174, a118
  v_accvgpr_read_b32 v175, a119
  v_mfma_f32_16x16x32_bf16 a[32:35], a[228:231], a[132:135], a[32:35]
  v_mul_f32 v168, v168, v101
  v_mul_f32 v169, v169, v101
  v_mul_f32 v170, v170, v101
  v_mfma_f32_16x16x32_bf16 a[36:39], a[228:231], a[140:143], 0
  s_add_u32 s41, s41, 262144
  ds_read_b128 a[196:199], v121 offset:38912
  v_mul_f32 v171, v171, v101
  v_mul_f32 v172, v172, v101
  v_mfma_f32_16x16x32_bf16 a[36:39], a[224:227], a[136:139], a[36:39]
  buffer_load_dwordx4 a[80:83], v112, s[36:39], s41 offen offset:0 sc1
  v_mfma_f32_16x16x32_bf16 a[44:47], a[232:235], a[136:139], 0
  ds_read_b128 a[200:203], v121 offset:29696
  v_mul_f32 v173, v173, v101
  v_mul_f32 v174, v174, v101
  v_mfma_f32_16x16x32_bf16 a[44:47], a[236:239], a[140:143], a[44:47]
  v_mul_f32 v175, v175, v101
  v_cvt_pk_bf16_f32 v156, v168, v169
  v_cvt_pk_bf16_f32 v157, v170, v171
  v_mfma_f32_16x16x32_bf16 a[40:43], a[236:239], a[132:135], 0
  ds_read_b128 a[204:207], v121 offset:39936
  v_cvt_pk_bf16_f32 v158, v172, v173
  v_cvt_pk_bf16_f32 v159, v174, v175
  v_mfma_f32_16x16x32_bf16 a[40:43], a[232:235], a[128:131], a[40:43]
  s_waitcnt lgkmcnt(4)
  buffer_load_dwordx4 a[84:87], v112, s[36:39], s41 offen offset:1024 sc1
  v_mfma_f32_16x16x32_bf16 a[48:51], a[240:243], a[128:131], 0
  ds_read_b128 a[208:211], v119 offset:0
  v_accvgpr_read_b32 v176, a104
  v_accvgpr_read_b32 v177, a105
  v_mfma_f32_16x16x32_bf16 a[48:51], a[244:247], a[132:135], a[48:51]
  v_accvgpr_read_b32 v178, a106
  v_mfma_f32_16x16x32_bf16 v[104:107], v[4:7], v[156:159], v[104:107]
  v_accvgpr_read_b32 v179, a107
  v_mfma_f32_16x16x32_bf16 a[52:55], a[244:247], a[140:143], 0
  ds_read_b128 a[212:215], v119 offset:10240
  v_accvgpr_read_b32 v180, a120
  v_accvgpr_read_b32 v181, a121
  v_mfma_f32_16x16x32_bf16 a[52:55], a[240:243], a[136:139], a[52:55]
  buffer_load_dwordx4 a[88:91], v113, s[36:39], s41 offen offset:0 sc1
  v_mfma_f32_16x16x32_bf16 a[60:63], a[248:251], a[136:139], 0
  ds_read_b128 a[216:219], v119 offset:1024
  v_accvgpr_read_b32 v182, a122
  v_accvgpr_read_b32 v183, a123
  v_mfma_f32_16x16x32_bf16 a[60:63], a[252:255], a[140:143], a[60:63]
  v_mul_f32 v176, v176, v102
  v_mul_f32 v177, v177, v102
  v_mul_f32 v178, v178, v102
  v_mfma_f32_16x16x32_bf16 a[56:59], a[252:255], a[132:135], 0
  ds_read_b128 a[220:223], v119 offset:11264
  v_mul_f32 v179, v179, v102
  v_mul_f32 v180, v180, v102
  v_mfma_f32_16x16x32_bf16 a[56:59], a[248:251], a[128:131], a[56:59]
  s_waitcnt lgkmcnt(4)
  buffer_load_dwordx4 a[92:95], v113, s[36:39], s41 offen offset:1024 sc1
  v_mfma_f32_16x16x32_bf16 a[64:67], a[192:195], a[128:131], 0
  ds_read_b128 a[224:227], v119 offset:2048
  v_mul_f32 v181, v181, v102
  v_mul_f32 v182, v182, v102
  v_mfma_f32_16x16x32_bf16 a[64:67], a[196:199], a[132:135], a[64:67]
  v_mul_f32 v183, v183, v102
  v_cvt_pk_bf16_f32 v176, v176, v177
  v_cvt_pk_bf16_f32 v177, v178, v179
  v_mfma_f32_16x16x32_bf16 a[68:71], a[196:199], a[140:143], 0
  ds_read_b128 a[228:231], v119 offset:12288
  v_cvt_pk_bf16_f32 v178, v180, v181
  v_cvt_pk_bf16_f32 v179, v182, v183
  v_mfma_f32_16x16x32_bf16 a[68:71], a[192:195], a[136:139], a[68:71]
  buffer_store_dwordx4 v[152:155], v112, s[32:35], s82 offen offset:1024 sc1
  v_mfma_f32_16x16x32_bf16 a[76:79], a[200:203], a[136:139], 0
  ds_read_b128 a[232:235], v119 offset:3072
  v_accvgpr_read_b32 v184, a108
  v_accvgpr_read_b32 v185, a109
  v_mfma_f32_16x16x32_bf16 a[76:79], a[204:207], a[140:143], a[76:79]
  v_accvgpr_read_b32 v186, a110
L_pad_post02_0:
  s_cbranch_execz L_pad_post02_1
  v_mfma_f32_16x16x32_bf16 v[104:107], v[4:7], v[176:179], v[104:107]
  v_accvgpr_read_b32 v187, a111
  v_mfma_f32_16x16x32_bf16 a[72:75], a[204:207], a[132:135], 0
  ds_read_b128 a[236:239], v119 offset:13312
  v_accvgpr_read_b32 v188, a124
  v_accvgpr_read_b32 v189, a125
  v_mfma_f32_16x16x32_bf16 a[72:75], a[200:203], a[128:131], a[72:75]
  s_waitcnt lgkmcnt(4)
  v_mfma_f32_16x16x32_bf16 a[0:3], a[208:211], a[144:147], a[0:3]
  ds_read_b128 a[240:243], v119 offset:4096
  v_accvgpr_read_b32 v190, a126
  v_accvgpr_read_b32 v191, a127
  v_mfma_f32_16x16x32_bf16 a[0:3], a[212:215], a[148:151], a[0:3]
  v_mul_f32 v184, v184, v103
  v_mul_f32 v185, v185, v103
  v_mul_f32 v186, v186, v103
  v_mfma_f32_16x16x32_bf16 a[4:7], a[212:215], a[156:159], a[4:7]
  ds_read_b128 a[244:247], v119 offset:14336
  v_mul_f32 v187, v187, v103
  v_mul_f32 v188, v188, v103
  v_mfma_f32_16x16x32_bf16 a[4:7], a[208:211], a[152:155], a[4:7]
  v_mfma_f32_16x16x32_bf16 a[12:15], a[216:219], a[152:155], a[12:15]
  ds_read_b128 a[248:251], v119 offset:5120
  v_mul_f32 v189, v189, v103
  v_mul_f32 v190, v190, v103
  v_mfma_f32_16x16x32_bf16 a[12:15], a[220:223], a[156:159], a[12:15]
  v_mul_f32 v191, v191, v103
  v_cvt_pk_bf16_f32 v184, v184, v185
  v_cvt_pk_bf16_f32 v185, v186, v187
  v_mfma_f32_16x16x32_bf16 a[8:11], a[220:223], a[148:151], a[8:11]
  ds_read_b128 a[252:255], v119 offset:15360
  v_cvt_pk_bf16_f32 v186, v188, v189
  v_cvt_pk_bf16_f32 v187, v190, v191
  v_mfma_f32_16x16x32_bf16 a[8:11], a[216:219], a[144:147], a[8:11]
  s_waitcnt lgkmcnt(4)
  v_mfma_f32_16x16x32_bf16 a[16:19], a[224:227], a[144:147], a[16:19]
  ds_read_b128 a[192:195], v119 offset:6144
  v_mfma_f32_16x16x32_bf16 v[104:107], v[4:7], v[184:187], v[104:107]
  v_mfma_f32_16x16x32_bf16 a[16:19], a[228:231], a[148:151], a[16:19]
  v_mfma_f32_16x16x32_bf16 a[20:23], a[228:231], a[156:159], a[20:23]
  ds_read_b128 a[196:199], v119 offset:16384
  v_mfma_f32_16x16x32_bf16 a[20:23], a[224:227], a[152:155], a[20:23]
  buffer_store_dwordx4 v[156:159], v113, s[32:35], s82 offen offset:1024 sc1
  v_mfma_f32_16x16x32_bf16 a[28:31], a[232:235], a[152:155], a[28:31]
  ds_read_b128 a[200:203], v119 offset:7168
  v_mfma_f32_16x16x32_bf16 a[28:31], a[236:239], a[156:159], a[28:31]
  v_mfma_f32_16x16x32_bf16 a[24:27], a[236:239], a[148:151], a[24:27]
  ds_read_b128 a[204:207], v119 offset:17408
  v_add_f32 v96, v72, v73
  v_mfma_f32_16x16x32_bf16 a[24:27], a[232:235], a[144:147], a[24:27]
  s_waitcnt lgkmcnt(4)
  v_mfma_f32_16x16x32_bf16 a[32:35], a[240:243], a[144:147], a[32:35]
  ds_read_b128 a[208:211], v119 offset:8192
  v_add_f32 v97, v74, v75
  v_mfma_f32_16x16x32_bf16 a[32:35], a[244:247], a[148:151], a[32:35]
  v_mfma_f32_16x16x32_bf16 a[36:39], a[244:247], a[156:159], a[36:39]
  ds_read_b128 a[212:215], v119 offset:18432
  v_add_f32 v96, v96, v106
  v_mfma_f32_16x16x32_bf16 a[36:39], a[240:243], a[152:155], a[36:39]
  v_mfma_f32_16x16x32_bf16 a[44:47], a[248:251], a[152:155], a[44:47]
  ds_read_b128 a[216:219], v119 offset:9216
  v_add_f32 v96, v96, v97
  v_mfma_f32_16x16x32_bf16 a[44:47], a[252:255], a[156:159], a[44:47]
  v_mfma_f32_16x16x32_bf16 a[40:43], a[252:255], a[148:151], a[40:43]
  ds_read_b128 a[220:223], v119 offset:19456
  v_cmp_ngt_f32 vcc, 0x53800000, v96
  v_mfma_f32_16x16x32_bf16 a[40:43], a[248:251], a[144:147], a[40:43]
  s_waitcnt lgkmcnt(4)
  v_mfma_f32_16x16x32_bf16 a[48:51], a[192:195], a[144:147], a[48:51]
  v_and_b32 v97, 3, v1
  v_mfma_f32_16x16x32_bf16 a[48:51], a[196:199], a[148:151], a[48:51]
  buffer_store_dwordx4 v[176:179], v95, s[32:35], s82 offen offset:1024 sc1
  v_mfma_f32_16x16x32_bf16 a[52:55], a[196:199], a[156:159], a[52:55]
  v_mul_u32_u24 v97, 5120, v97
  v_mfma_f32_16x16x32_bf16 a[52:55], a[192:195], a[152:155], a[52:55]
  s_waitcnt vmcnt(37)
  s_waitcnt lgkmcnt(0)
  s_barrier
  v_mfma_f32_16x16x32_bf16 a[60:63], a[200:203], a[152:155], a[60:63]
  ds_read_b128 a[224:227], v119 offset:20480
  s_and_b32 s47, vcc_lo, s58
  s_cselect_b32 s59, 0, 1
  v_mov_b32 v118, s59
  v_mfma_f32_16x16x32_bf16 a[60:63], a[204:207], a[156:159], a[60:63]
  ds_read_b128 a[228:231], v119 offset:30720
  v_mfma_f32_16x16x32_bf16 a[56:59], a[204:207], a[148:151], a[56:59]
  ds_read_b128 a[232:235], v119 offset:21504
  v_lshl_add_u32 v97, s43, 2, v97
  v_mfma_f32_16x16x32_bf16 a[56:59], a[200:203], a[144:147], a[56:59]
  ds_read_b128 a[236:239], v119 offset:31744
  v_mfma_f32_16x16x32_bf16 a[64:67], a[208:211], a[144:147], a[64:67]
  ds_read_b128 a[240:243], v119 offset:22528
  v_mov_b32 v96, s47
  v_mfma_f32_16x16x32_bf16 a[64:67], a[212:215], a[148:151], a[64:67]
  v_mfma_f32_16x16x32_bf16 a[68:71], a[212:215], a[156:159], a[68:71]
  ds_read_b128 a[244:247], v119 offset:32768
  v_add_u32 v97, 122880, v97
  v_mfma_f32_16x16x32_bf16 a[68:71], a[208:211], a[152:155], a[68:71]
  v_mfma_f32_16x16x32_bf16 a[76:79], a[216:219], a[152:155], a[76:79]
  ds_read_b128 a[248:251], v119 offset:23552
  v_mov_b32 v98, s42
  v_mfma_f32_16x16x32_bf16 a[76:79], a[220:223], a[156:159], a[76:79]
  s_waitcnt vmcnt(33)
  v_mfma_f32_16x16x32_bf16 a[72:75], a[220:223], a[148:151], a[72:75]
  ds_read_b128 a[252:255], v119 offset:33792
  v_add_u32 v98, 122880, v98
  v_mfma_f32_16x16x32_bf16 a[72:75], a[216:219], a[144:147], a[72:75]
  s_waitcnt lgkmcnt(4)
  v_mfma_f32_16x16x32_bf16 a[0:3], a[224:227], a[160:163], a[0:3]
  ds_read_b128 a[192:195], v119 offset:24576
  v_mfma_f32_16x16x32_bf16 a[0:3], a[228:231], a[164:167], a[0:3]
  ds_write_b32 v97, v96 offset:20480
  v_mfma_f32_16x16x32_bf16 a[4:7], a[228:231], a[172:175], a[4:7]
  ds_read_b128 a[196:199], v119 offset:34816
  v_mfma_f32_16x16x32_bf16 a[4:7], a[224:227], a[168:171], a[4:7]
  buffer_store_dwordx4 v[184:187], v115, s[32:35], s82 offen offset:1024 sc1
  v_mfma_f32_16x16x32_bf16 a[12:15], a[232:235], a[168:171], a[12:15]
  ds_read_b128 a[200:203], v119 offset:25600
  v_mfma_f32_16x16x32_bf16 a[12:15], a[236:239], a[172:175], a[12:15]
  v_mfma_f32_16x16x32_bf16 a[8:11], a[236:239], a[164:167], a[8:11]
  ds_read_b128 a[204:207], v119 offset:35840
  v_mfma_f32_16x16x32_bf16 a[8:11], a[232:235], a[160:163], a[8:11]
  s_waitcnt lgkmcnt(5)
  v_mfma_f32_16x16x32_bf16 a[16:19], a[240:243], a[160:163], a[16:19]
  ds_read_b128 a[208:211], v119 offset:26624
  v_mfma_f32_16x16x32_bf16 a[16:19], a[244:247], a[164:167], a[16:19]
  v_mfma_f32_16x16x32_bf16 a[20:23], a[244:247], a[172:175], a[20:23]
  ds_read_b128 a[212:215], v119 offset:36864
  v_mfma_f32_16x16x32_bf16 a[20:23], a[240:243], a[168:171], a[20:23]
  v_mfma_f32_16x16x32_bf16 a[28:31], a[248:251], a[168:171], a[28:31]
  ds_read_b128 a[216:219], v119 offset:27648
  v_mfma_f32_16x16x32_bf16 a[28:31], a[252:255], a[172:175], a[28:31]
  v_mfma_f32_16x16x32_bf16 a[24:27], a[252:255], a[164:167], a[24:27]
  s_add_u32 s41, s41, 262144
  ds_read_b128 a[220:223], v119 offset:37888
  v_mfma_f32_16x16x32_bf16 a[24:27], a[248:251], a[160:163], a[24:27]
  s_waitcnt lgkmcnt(4)
  buffer_load_dwordx4 a[96:99], v112, s[36:39], s41 offen offset:0 sc1
  v_mfma_f32_16x16x32_bf16 a[32:35], a[192:195], a[160:163], a[32:35]
  ds_read_b128 a[224:227], v119 offset:28672
  v_mfma_f32_16x16x32_bf16 a[32:35], a[196:199], a[164:167], a[32:35]
  v_mfma_f32_16x16x32_bf16 a[36:39], a[196:199], a[172:175], a[36:39]
  ds_read_b128 a[228:231], v119 offset:38912
  v_mfma_f32_16x16x32_bf16 a[36:39], a[192:195], a[168:171], a[36:39]
  v_mfma_f32_16x16x32_bf16 a[44:47], a[200:203], a[168:171], a[44:47]
  ds_read_b128 a[232:235], v119 offset:29696
  v_mfma_f32_16x16x32_bf16 a[44:47], a[204:207], a[172:175], a[44:47]
  buffer_load_dwordx4 a[100:103], v112, s[36:39], s41 offen offset:1024 sc1
  v_mfma_f32_16x16x32_bf16 a[40:43], a[204:207], a[164:167], a[40:43]
  ds_read_b128 a[236:239], v119 offset:39936
  v_mfma_f32_16x16x32_bf16 a[40:43], a[200:203], a[160:163], a[40:43]
  s_waitcnt lgkmcnt(4)
  v_mfma_f32_16x16x32_bf16 a[48:51], a[208:211], a[160:163], a[48:51]
  ds_read_b128 a[240:243], v121 offset:0
  v_mfma_f32_16x16x32_bf16 a[48:51], a[212:215], a[164:167], a[48:51]
  buffer_load_dwordx4 a[104:107], v113, s[36:39], s41 offen offset:0 sc1
  v_mfma_f32_16x16x32_bf16 a[52:55], a[212:215], a[172:175], a[52:55]
  s_waitcnt vmcnt(3)
  ds_read_b128 a[244:247], v121 offset:10240
  v_mfma_f32_16x16x32_bf16 a[52:55], a[208:211], a[168:171], a[52:55]
  buffer_store_dword v118, v125, s[32:35], s96 offen offset:0 sc1
  v_mfma_f32_16x16x32_bf16 a[60:63], a[216:219], a[168:171], a[60:63]
  ds_read_b128 a[248:251], v121 offset:1024
  v_mfma_f32_16x16x32_bf16 a[60:63], a[220:223], a[172:175], a[60:63]
  buffer_load_dwordx4 a[108:111], v113, s[36:39], s41 offen offset:1024 sc1
  v_mfma_f32_16x16x32_bf16 a[56:59], a[220:223], a[164:167], a[56:59]
  s_add_u32 m0, s42, 81920
  ds_read_b128 a[252:255], v121 offset:11264
  v_mfma_f32_16x16x32_bf16 a[56:59], a[216:219], a[160:163], a[56:59]
  s_waitcnt lgkmcnt(4)
  v_mfma_f32_16x16x32_bf16 a[64:67], a[224:227], a[160:163], a[64:67]
  s_add_u32 s40, s40, 77824
  ds_read_b128 a[192:195], v121 offset:2048
  v_mfma_f32_16x16x32_bf16 a[64:67], a[228:231], a[164:167], a[64:67]
  buffer_load_dwordx4 v3, s[52:55], s40 offen offset:0 sc1 lds
  v_mfma_f32_16x16x32_bf16 a[68:71], a[228:231], a[172:175], a[68:71]
  ds_read_b128 a[196:199], v121 offset:12288
  v_mfma_f32_16x16x32_bf16 a[68:71], a[224:227], a[168:171], a[68:71]
  v_mfma_f32_16x16x32_bf16 a[76:79], a[232:235], a[168:171], a[76:79]
  ds_read_b128 a[200:203], v121 offset:3072
  v_mfma_f32_16x16x32_bf16 a[76:79], a[236:239], a[172:175], a[76:79]
  buffer_load_dwordx4 v3, s[52:55], s40 offen offset:1024 sc1 lds
  v_mfma_f32_16x16x32_bf16 a[72:75], a[236:239], a[164:167], a[72:75]
  ds_read_b128 a[204:207], v121 offset:13312
  v_mfma_f32_16x16x32_bf16 a[72:75], a[232:235], a[160:163], a[72:75]
  s_waitcnt lgkmcnt(4)
  v_mfma_f32_16x16x32_bf16 a[0:3], a[240:243], a[176:179], a[0:3]
  ds_read_b128 a[208:211], v121 offset:4096
  v_mfma_f32_16x16x32_bf16 a[0:3], a[244:247], a[180:183], a[0:3]
  v_mfma_f32_16x16x32_bf16 a[4:7], a[244:247], a[188:191], a[4:7]
  ds_read_b128 a[212:215], v121 offset:14336
  v_mfma_f32_16x16x32_bf16 a[4:7], a[240:243], a[184:187], a[4:7]
  buffer_load_dwordx4 v3, s[52:55], s40 offen offset:2048 sc1 lds
  v_mfma_f32_16x16x32_bf16 a[12:15], a[248:251], a[184:187], a[12:15]
  ds_read_b128 a[216:219], v121 offset:5120
  v_mfma_f32_16x16x32_bf16 a[12:15], a[252:255], a[188:191], a[12:15]
  v_mfma_f32_16x16x32_bf16 a[8:11], a[252:255], a[180:183], a[8:11]
  ds_read_b128 a[220:223], v121 offset:15360
  v_mfma_f32_16x16x32_bf16 a[8:11], a[248:251], a[176:179], a[8:11]
  s_waitcnt lgkmcnt(4)
  buffer_load_dwordx4 v3, s[52:55], s40 offen offset:3072 sc1 lds
  v_mfma_f32_16x16x32_bf16 a[16:19], a[192:195], a[176:179], a[16:19]
  s_add_u32 m0, s42, 86016
  ds_read_b128 a[224:227], v121 offset:6144
  v_mfma_f32_16x16x32_bf16 a[16:19], a[196:199], a[180:183], a[16:19]
  v_mfma_f32_16x16x32_bf16 a[20:23], a[196:199], a[188:191], a[20:23]
  s_add_u32 s40, s40, 4096
  ds_read_b128 a[228:231], v121 offset:16384
  v_mfma_f32_16x16x32_bf16 a[20:23], a[192:195], a[184:187], a[20:23]
  buffer_load_dwordx4 v3, s[52:55], s40 offen offset:0 sc1 lds
  v_mfma_f32_16x16x32_bf16 a[28:31], a[200:203], a[184:187], a[28:31]
  s_add_u32 m0, s42, 61440
  ds_read_b128 a[232:235], v121 offset:7168
  v_mfma_f32_16x16x32_bf16 a[28:31], a[204:207], a[188:191], a[28:31]
  v_mfma_f32_16x16x32_bf16 a[24:27], a[204:207], a[180:183], a[24:27]
  s_add_u32 s40, s40, 77824
  ds_read_b128 a[236:239], v121 offset:17408
  v_mfma_f32_16x16x32_bf16 a[24:27], a[200:203], a[176:179], a[24:27]
  s_waitcnt lgkmcnt(4)
  buffer_load_dwordx4 v3, s[52:55], s40 offen offset:0 sc1 lds
  v_mfma_f32_16x16x32_bf16 a[32:35], a[208:211], a[176:179], a[32:35]
  ds_read_b128 a[240:243], v121 offset:8192
  v_mfma_f32_16x16x32_bf16 a[32:35], a[212:215], a[180:183], a[32:35]
  v_mfma_f32_16x16x32_bf16 a[36:39], a[212:215], a[188:191], a[36:39]
  ds_read_b128 a[244:247], v121 offset:18432
  v_mfma_f32_16x16x32_bf16 a[36:39], a[208:211], a[184:187], a[36:39]
  buffer_load_dwordx4 v3, s[52:55], s40 offen offset:1024 sc1 lds
  v_mfma_f32_16x16x32_bf16 a[44:47], a[216:219], a[184:187], a[44:47]
  ds_read_b128 a[248:251], v121 offset:9216
  v_mfma_f32_16x16x32_bf16 a[44:47], a[220:223], a[188:191], a[44:47]
  v_mfma_f32_16x16x32_bf16 a[40:43], a[220:223], a[180:183], a[40:43]
  ds_read_b128 a[252:255], v121 offset:19456
  v_mfma_f32_16x16x32_bf16 a[40:43], a[216:219], a[176:179], a[40:43]
  s_waitcnt lgkmcnt(4)
  v_mfma_f32_16x16x32_bf16 a[48:51], a[224:227], a[176:179], a[48:51]
  buffer_load_dwordx4 v3, s[52:55], s40 offen offset:2048 sc1 lds
  v_mfma_f32_16x16x32_bf16 a[48:51], a[228:231], a[180:183], a[48:51]
  v_mfma_f32_16x16x32_bf16 a[52:55], a[228:231], a[188:191], a[52:55]
  v_mfma_f32_16x16x32_bf16 a[52:55], a[224:227], a[184:187], a[52:55]
  s_waitcnt lgkmcnt(0)
  s_barrier
  v_mfma_f32_16x16x32_bf16 a[60:63], a[232:235], a[184:187], a[60:63]
  ds_read_b128 a[192:195], v119 offset:40960
  v_mfma_f32_16x16x32_bf16 a[60:63], a[236:239], a[188:191], a[60:63]
  ds_read_b128 a[196:199], v119 offset:51200
  v_mfma_f32_16x16x32_bf16 a[56:59], a[236:239], a[180:183], a[56:59]
  ds_read_b128 a[200:203], v119 offset:41984
  v_mfma_f32_16x16x32_bf16 a[56:59], a[232:235], a[176:179], a[56:59]
  ds_read_b128 a[204:207], v119 offset:52224
  v_mfma_f32_16x16x32_bf16 a[64:67], a[240:243], a[176:179], a[64:67]
  ds_read_b128 a[208:211], v119 offset:43008
  v_mfma_f32_16x16x32_bf16 a[64:67], a[244:247], a[180:183], a[64:67]
  ds_read_b128 v[100:103], v98 offset:20480
  v_mfma_f32_16x16x32_bf16 a[68:71], a[244:247], a[188:191], a[68:71]
  ds_read_b128 a[212:215], v119 offset:53248
  v_mfma_f32_16x16x32_bf16 a[68:71], a[240:243], a[184:187], a[68:71]
  buffer_load_dwordx4 v3, s[52:55], s40 offen offset:3072 sc1 lds
  v_mfma_f32_16x16x32_bf16 a[76:79], a[248:251], a[184:187], a[76:79]
  s_add_u32 m0, s42, 65536
  s_add_u32 s40, s40, 4096
  ds_read_b128 a[216:219], v119 offset:44032
  v_mfma_f32_16x16x32_bf16 a[76:79], a[252:255], a[188:191], a[76:79]
  buffer_load_dwordx4 v3, s[52:55], s40 offen offset:0 sc1 lds
  v_mfma_f32_16x16x32_bf16 a[72:75], a[252:255], a[180:183], a[72:75]
  s_add_u32 s41, s41, 262144
  ds_read_b128 a[220:223], v119 offset:54272
  v_mfma_f32_16x16x32_bf16 a[72:75], a[248:251], a[176:179], a[72:75]
  s_waitcnt lgkmcnt(3)
  buffer_load_dwordx4 a[112:115], v112, s[36:39], s41 offen offset:0 sc1
  v_mfma_f32_16x16x32_bf16 a[0:3], a[192:195], a[80:83], a[0:3]
  ds_read_b128 a[224:227], v119 offset:45056
  v_or3_b32 v100, v100, v101, v102
  v_mfma_f32_16x16x32_bf16 a[0:3], a[196:199], a[84:87], a[0:3]
  v_or_b32 v100, v100, v103
  v_cmp_ne_u32 vcc, 0, v100
  v_mfma_f32_16x16x32_bf16 a[4:7], a[196:199], a[92:95], a[4:7]
  ds_read_b128 a[228:231], v119 offset:55296
  v_mfma_f32_16x16x32_bf16 a[4:7], a[192:195], a[88:91], a[4:7]
  s_cbranch_vccnz L_slow
  buffer_load_dwordx4 a[116:119], v112, s[36:39], s41 offen offset:1024 sc1
  v_mfma_f32_16x16x32_bf16 a[12:15], a[200:203], a[88:91], a[12:15]
  ds_read_b128 a[232:235], v119 offset:46080
  v_mfma_f32_16x16x32_bf16 a[12:15], a[204:207], a[92:95], a[12:15]
  buffer_load_dwordx4 a[120:123], v113, s[36:39], s41 offen offset:0 sc1
  v_mfma_f32_16x16x32_bf16 a[8:11], a[204:207], a[84:87], a[8:11]
  ds_read_b128 a[236:239], v119 offset:56320
  v_mfma_f32_16x16x32_bf16 a[8:11], a[200:203], a[80:83], a[8:11]
  s_waitcnt lgkmcnt(4)
  buffer_load_dwordx4 a[124:127], v113, s[36:39], s41 offen offset:1024 sc1
  v_mfma_f32_16x16x32_bf16 a[16:19], a[208:211], a[80:83], a[16:19]
  ds_read_b128 a[240:243], v119 offset:47104
  v_mfma_f32_16x16x32_bf16 a[16:19], a[212:215], a[84:87], a[16:19]
  v_mfma_f32_16x16x32_bf16 a[20:23], a[212:215], a[92:95], a[20:23]
  ds_read_b128 a[244:247], v119 offset:57344
  v_mfma_f32_16x16x32_bf16 a[20:23], a[208:211], a[88:91], a[20:23]
  v_mfma_f32_16x16x32_bf16 a[28:31], a[216:219], a[88:91], a[28:31]
  s_add_u32 s41, s41, 262144
  ds_read_b128 a[248:251], v119 offset:48128
  v_mfma_f32_16x16x32_bf16 a[28:31], a[220:223], a[92:95], a[28:31]
  buffer_load_dwordx4 a[128:131], v112, s[36:39], s41 offen offset:0 sc1
  v_mfma_f32_16x16x32_bf16 a[24:27], a[220:223], a[84:87], a[24:27]
  ds_read_b128 a[252:255], v119 offset:58368
  v_mfma_f32_16x16x32_bf16 a[24:27], a[216:219], a[80:83], a[24:27]
  s_waitcnt lgkmcnt(4)
  v_mfma_f32_16x16x32_bf16 a[32:35], a[224:227], a[80:83], a[32:35]
  ds_read_b128 a[192:195], v119 offset:49152
  v_mfma_f32_16x16x32_bf16 a[32:35], a[228:231], a[84:87], a[32:35]
  buffer_load_dwordx4 a[132:135], v112, s[36:39], s41 offen offset:1024 sc1
  v_mfma_f32_16x16x32_bf16 a[36:39], a[228:231], a[92:95], a[36:39]
  ds_read_b128 a[196:199], v119 offset:59392
  v_mfma_f32_16x16x32_bf16 a[36:39], a[224:227], a[88:91], a[36:39]
  v_mfma_f32_16x16x32_bf16 a[44:47], a[232:235], a[88:91], a[44:47]
  ds_read_b128 a[200:203], v119 offset:50176
  v_mfma_f32_16x16x32_bf16 a[44:47], a[236:239], a[92:95], a[44:47]
  buffer_load_dwordx4 a[136:139], v113, s[36:39], s41 offen offset:0 sc1
  v_mfma_f32_16x16x32_bf16 a[40:43], a[236:239], a[84:87], a[40:43]
  ds_read_b128 a[204:207], v119 offset:60416
  v_mfma_f32_16x16x32_bf16 a[40:43], a[232:235], a[80:83], a[40:43]
  s_waitcnt lgkmcnt(4)
  v_mfma_f32_16x16x32_bf16 a[48:51], a[240:243], a[80:83], a[48:51]
  ds_read_b128 a[208:211], v120 offset:40960
  v_mfma_f32_16x16x32_bf16 a[48:51], a[244:247], a[84:87], a[48:51]
  buffer_load_dwordx4 a[140:143], v113, s[36:39], s41 offen offset:1024 sc1
  v_mfma_f32_16x16x32_bf16 a[52:55], a[244:247], a[92:95], a[52:55]
  s_add_u32 m0, s42, 143360
  ds_read_b128 a[212:215], v120 offset:51200
  v_mfma_f32_16x16x32_bf16 a[52:55], a[240:243], a[88:91], a[52:55]
  v_mfma_f32_16x16x32_bf16 a[60:63], a[248:251], a[88:91], a[60:63]
  s_mov_b32 s40, s29
  ds_read_b128 a[216:219], v120 offset:41984
  v_mfma_f32_16x16x32_bf16 a[60:63], a[252:255], a[92:95], a[60:63]
  buffer_load_dwordx4 v3, s[52:55], s40 offen offset:0 sc1 lds
  v_mfma_f32_16x16x32_bf16 a[56:59], a[252:255], a[84:87], a[56:59]
  ds_read_b128 a[220:223], v120 offset:52224
  v_mfma_f32_16x16x32_bf16 a[56:59], a[248:251], a[80:83], a[56:59]
  s_waitcnt lgkmcnt(4)
  v_mfma_f32_16x16x32_bf16 a[64:67], a[192:195], a[80:83], a[64:67]
  ds_read_b128 a[224:227], v120 offset:43008
  v_mfma_f32_16x16x32_bf16 a[64:67], a[196:199], a[84:87], a[64:67]
  v_mfma_f32_16x16x32_bf16 a[68:71], a[196:199], a[92:95], a[68:71]
  ds_read_b128 a[228:231], v120 offset:53248
  v_mfma_f32_16x16x32_bf16 a[68:71], a[192:195], a[88:91], a[68:71]
  buffer_load_dwordx4 v3, s[52:55], s40 offen offset:1024 sc1 lds
  v_mfma_f32_16x16x32_bf16 a[76:79], a[200:203], a[88:91], a[76:79]
  ds_read_b128 a[232:235], v120 offset:44032
  v_mfma_f32_16x16x32_bf16 a[76:79], a[204:207], a[92:95], a[76:79]
  s_waitcnt vmcnt(20)
  v_mfma_f32_16x16x32_bf16 a[72:75], a[204:207], a[84:87], a[72:75]
  ds_read_b128 a[236:239], v120 offset:54272
  v_mfma_f32_16x16x32_bf16 a[72:75], a[200:203], a[80:83], a[72:75]
  s_waitcnt lgkmcnt(4)
  buffer_load_dwordx4 v3, s[52:55], s40 offen offset:2048 sc1 lds
  v_mfma_f32_16x16x32_bf16 a[0:3], a[208:211], a[96:99], a[0:3]
  ds_read_b128 a[240:243], v120 offset:45056
  v_mfma_f32_16x16x32_bf16 a[0:3], a[212:215], a[100:103], a[0:3]
  v_mfma_f32_16x16x32_bf16 a[4:7], a[212:215], a[108:111], a[4:7]
  ds_read_b128 a[244:247], v120 offset:55296
  v_mfma_f32_16x16x32_bf16 a[4:7], a[208:211], a[104:107], a[4:7]
  buffer_load_dwordx4 v3, s[52:55], s40 offen offset:3072 sc1 lds
  v_mfma_f32_16x16x32_bf16 a[12:15], a[216:219], a[104:107], a[12:15]
  s_add_u32 m0, s42, 147456
  ds_read_b128 a[248:251], v120 offset:46080
  v_mfma_f32_16x16x32_bf16 a[12:15], a[220:223], a[108:111], a[12:15]
  v_mfma_f32_16x16x32_bf16 a[8:11], a[220:223], a[100:103], a[8:11]
  s_add_u32 s40, s40, 4096
  ds_read_b128 a[252:255], v120 offset:56320
  v_mfma_f32_16x16x32_bf16 a[8:11], a[216:219], a[96:99], a[8:11]
  s_waitcnt lgkmcnt(4)
  buffer_load_dwordx4 v3, s[52:55], s40 offen offset:0 sc1 lds
  v_mfma_f32_16x16x32_bf16 a[16:19], a[224:227], a[96:99], a[16:19]
  s_add_u32 m0, s42, 0
  ds_read_b128 a[192:195], v120 offset:47104
  v_mfma_f32_16x16x32_bf16 a[16:19], a[228:231], a[100:103], a[16:19]
  v_mfma_f32_16x16x32_bf16 a[20:23], a[228:231], a[108:111], a[20:23]
  s_add_u32 s40, s40, 77824
  ds_read_b128 a[196:199], v120 offset:57344
  v_mfma_f32_16x16x32_bf16 a[20:23], a[224:227], a[104:107], a[20:23]
  buffer_load_dwordx4 v3, s[52:55], s40 offen offset:0 sc1 lds
  v_mfma_f32_16x16x32_bf16 a[28:31], a[232:235], a[104:107], a[28:31]
  ds_read_b128 a[200:203], v120 offset:48128
  v_mfma_f32_16x16x32_bf16 a[28:31], a[236:239], a[108:111], a[28:31]
  v_mfma_f32_16x16x32_bf16 a[24:27], a[236:239], a[100:103], a[24:27]
  ds_read_b128 a[204:207], v120 offset:58368
  v_mfma_f32_16x16x32_bf16 a[24:27], a[232:235], a[96:99], a[24:27]
  s_waitcnt lgkmcnt(4)
  v_mfma_f32_16x16x32_bf16 a[32:35], a[240:243], a[96:99], a[32:35]
  ds_read_b128 a[208:211], v120 offset:49152
  v_mfma_f32_16x16x32_bf16 a[32:35], a[244:247], a[100:103], a[32:35]
  buffer_load_dwordx4 v3, s[52:55], s40 offen offset:1024 sc1 lds
  v_mfma_f32_16x16x32_bf16 a[36:39], a[244:247], a[108:111], a[36:39]
  ds_read_b128 a[212:215], v120 offset:59392
  v_mfma_f32_16x16x32_bf16 a[36:39], a[240:243], a[104:107], a[36:39]
  v_mfma_f32_16x16x32_bf16 a[44:47], a[248:251], a[104:107], a[44:47]
  ds_read_b128 a[216:219], v120 offset:50176
  v_mfma_f32_16x16x32_bf16 a[44:47], a[252:255], a[108:111], a[44:47]
  buffer_load_dwordx4 v3, s[52:55], s40 offen offset:2048 sc1 lds
  v_mfma_f32_16x16x32_bf16 a[40:43], a[252:255], a[100:103], a[40:43]
  ds_read_b128 a[220:223], v120 offset:60416
  v_mfma_f32_16x16x32_bf16 a[40:43], a[248:251], a[96:99], a[40:43]
  s_waitcnt lgkmcnt(4)
  v_mfma_f32_16x16x32_bf16 a[48:51], a[192:195], a[96:99], a[48:51]
  buffer_load_dwordx4 v3, s[52:55], s40 offen offset:3072 sc1 lds
  v_mfma_f32_16x16x32_bf16 a[48:51], a[196:199], a[100:103], a[48:51]
  v_mfma_f32_16x16x32_bf16 a[52:55], a[196:199], a[108:111], a[52:55]
  v_mfma_f32_16x16x32_bf16 a[52:55], a[192:195], a[104:107], a[52:55]
  s_waitcnt vmcnt(17)
  s_waitcnt lgkmcnt(0)
  s_barrier
  v_mfma_f32_16x16x32_bf16 a[60:63], a[200:203], a[104:107], a[60:63]
  ds_read_b128 a[224:227], v120 offset:20480
  v_mfma_f32_16x16x32_bf16 a[60:63], a[204:207], a[108:111], a[60:63]
  ds_read_b128 a[228:231], v120 offset:30720
  v_mfma_f32_16x16x32_bf16 a[56:59], a[204:207], a[100:103], a[56:59]
  s_add_u32 m0, s42, 4096
  ds_read_b128 a[232:235], v120 offset:21504
  v_mfma_f32_16x16x32_bf16 a[56:59], a[200:203], a[96:99], a[56:59]
  ds_read_b128 a[236:239], v120 offset:31744
  v_mfma_f32_16x16x32_bf16 a[64:67], a[208:211], a[96:99], a[64:67]
  s_add_u32 s40, s40, 4096
  ds_read_b128 a[240:243], v120 offset:22528
  v_mfma_f32_16x16x32_bf16 a[64:67], a[212:215], a[100:103], a[64:67]
  buffer_load_dwordx4 v3, s[52:55], s40 offen offset:0 sc1 lds
  v_mfma_f32_16x16x32_bf16 a[68:71], a[212:215], a[108:111], a[68:71]
  s_add_u32 m0, s42, 20480
  s_bfe_u32 s40, s78, 262144
  s_mul_i32 s40, s40, 81920
  s_add_u32 s40, s40, s84
  ds_read_b128 a[244:247], v120 offset:32768
  v_mfma_f32_16x16x32_bf16 a[68:71], a[208:211], a[104:107], a[68:71]
  buffer_load_dwordx4 v3, s[52:55], s40 offen offset:0 sc1 lds
  v_mfma_f32_16x16x32_bf16 a[76:79], a[216:219], a[104:107], a[76:79]
  ds_read_b128 a[248:251], v120 offset:23552
  v_mfma_f32_16x16x32_bf16 a[76:79], a[220:223], a[108:111], a[76:79]
  s_waitcnt vmcnt(15)
  buffer_load_dwordx4 v3, s[52:55], s40 offen offset:1024 sc1 lds
  v_mfma_f32_16x16x32_bf16 a[72:75], a[220:223], a[100:103], a[72:75]
  ds_read_b128 a[252:255], v120 offset:33792
  v_mfma_f32_16x16x32_bf16 a[72:75], a[216:219], a[96:99], a[72:75]
  s_waitcnt lgkmcnt(4)
  v_mfma_f32_16x16x32_bf16 a[0:3], a[224:227], a[112:115], a[0:3]
  ds_read_b128 a[192:195], v120 offset:24576
  v_mfma_f32_16x16x32_bf16 a[0:3], a[228:231], a[116:119], a[0:3]
  v_mfma_f32_16x16x32_bf16 a[4:7], a[228:231], a[124:127], a[4:7]
  ds_read_b128 a[196:199], v120 offset:34816
  v_mfma_f32_16x16x32_bf16 a[4:7], a[224:227], a[120:123], a[4:7]
  buffer_load_dwordx4 v3, s[52:55], s40 offen offset:2048 sc1 lds
  v_mfma_f32_16x16x32_bf16 a[12:15], a[232:235], a[120:123], a[12:15]
  ds_read_b128 a[200:203], v120 offset:25600
  v_mfma_f32_16x16x32_bf16 a[12:15], a[236:239], a[124:127], a[12:15]
  v_mfma_f32_16x16x32_bf16 a[8:11], a[236:239], a[116:119], a[8:11]
  ds_read_b128 a[204:207], v120 offset:35840
  v_mfma_f32_16x16x32_bf16 a[8:11], a[232:235], a[112:115], a[8:11]
  s_waitcnt lgkmcnt(4)
  buffer_load_dwordx4 v3, s[52:55], s40 offen offset:3072 sc1 lds
  v_mfma_f32_16x16x32_bf16 a[16:19], a[240:243], a[112:115], a[16:19]
  s_add_u32 m0, s42, 24576
  ds_read_b128 a[208:211], v120 offset:26624
  v_mfma_f32_16x16x32_bf16 a[16:19], a[244:247], a[116:119], a[16:19]
  v_mfma_f32_16x16x32_bf16 a[20:23], a[244:247], a[124:127], a[20:23]
  s_add_u32 s40, s40, 4096
  ds_read_b128 a[212:215], v120 offset:36864
  v_mfma_f32_16x16x32_bf16 a[20:23], a[240:243], a[120:123], a[20:23]
  buffer_load_dwordx4 v3, s[52:55], s40 offen offset:0 sc1 lds
  v_mfma_f32_16x16x32_bf16 a[28:31], a[248:251], a[120:123], a[28:31]
  s_add_u32 m0, s42, 122880
  ds_read_b128 a[216:219], v120 offset:27648
  v_mfma_f32_16x16x32_bf16 a[28:31], a[252:255], a[124:127], a[28:31]
  v_mfma_f32_16x16x32_bf16 a[24:27], a[252:255], a[116:119], a[24:27]
  s_bfe_u32 s40, s78, 262148
  s_mul_i32 s40, s40, 81920
  s_add_u32 s40, s40, s84
  ds_read_b128 a[220:223], v120 offset:37888
  v_mfma_f32_16x16x32_bf16 a[24:27], a[248:251], a[112:115], a[24:27]
  s_waitcnt lgkmcnt(4)
  buffer_load_dwordx4 v3, s[52:55], s40 offen offset:0 sc1 lds
  v_mfma_f32_16x16x32_bf16 a[32:35], a[192:195], a[112:115], a[32:35]
  ds_read_b128 a[224:227], v120 offset:28672
  v_mfma_f32_16x16x32_bf16 a[32:35], a[196:199], a[116:119], a[32:35]
  v_mfma_f32_16x16x32_bf16 a[36:39], a[196:199], a[124:127], a[36:39]
  ds_read_b128 a[228:231], v120 offset:38912
  v_mfma_f32_16x16x32_bf16 a[36:39], a[192:195], a[120:123], a[36:39]
  buffer_load_dwordx4 v3, s[52:55], s40 offen offset:1024 sc1 lds
  v_mfma_f32_16x16x32_bf16 a[44:47], a[200:203], a[120:123], a[44:47]
  ds_read_b128 a[232:235], v120 offset:29696
  v_mfma_f32_16x16x32_bf16 a[44:47], a[204:207], a[124:127], a[44:47]
  v_mfma_f32_16x16x32_bf16 a[40:43], a[204:207], a[116:119], a[40:43]
  ds_read_b128 a[236:239], v120 offset:39936
  v_mfma_f32_16x16x32_bf16 a[40:43], a[200:203], a[112:115], a[40:43]
  s_waitcnt lgkmcnt(4)
  v_mfma_f32_16x16x32_bf16 a[48:51], a[208:211], a[112:115], a[48:51]
  ds_read_b128 a[240:243], v120 offset:0
  v_mfma_f32_16x16x32_bf16 a[48:51], a[212:215], a[116:119], a[48:51]
  buffer_load_dwordx4 v3, s[52:55], s40 offen offset:2048 sc1 lds
  v_mfma_f32_16x16x32_bf16 a[52:55], a[212:215], a[124:127], a[52:55]
  ds_read_b128 a[244:247], v120 offset:10240
  v_mfma_f32_16x16x32_bf16 a[52:55], a[208:211], a[120:123], a[52:55]
  v_mfma_f32_16x16x32_bf16 a[60:63], a[216:219], a[120:123], a[60:63]
  ds_read_b128 a[248:251], v120 offset:1024
  v_mfma_f32_16x16x32_bf16 a[60:63], a[220:223], a[124:127], a[60:63]
  buffer_load_dwordx4 v3, s[52:55], s40 offen offset:3072 sc1 lds
  v_mfma_f32_16x16x32_bf16 a[56:59], a[220:223], a[116:119], a[56:59]
  s_add_u32 m0, s42, 126976
  ds_read_b128 a[252:255], v120 offset:11264
  v_mfma_f32_16x16x32_bf16 a[56:59], a[216:219], a[112:115], a[56:59]
  s_waitcnt lgkmcnt(4)
  v_mfma_f32_16x16x32_bf16 a[64:67], a[224:227], a[112:115], a[64:67]
  s_add_u32 s40, s40, 4096
  ds_read_b128 a[192:195], v120 offset:2048
  v_mfma_f32_16x16x32_bf16 a[64:67], a[228:231], a[116:119], a[64:67]
  buffer_load_dwordx4 v3, s[52:55], s40 offen offset:0 sc1 lds
  v_mfma_f32_16x16x32_bf16 a[68:71], a[228:231], a[124:127], a[68:71]
  s_add_u32 m0, s42, 40960
  ds_read_b128 a[196:199], v120 offset:12288
  v_mfma_f32_16x16x32_bf16 a[68:71], a[224:227], a[120:123], a[68:71]
  v_mfma_f32_16x16x32_bf16 a[76:79], a[232:235], a[120:123], a[76:79]
  s_bfe_u32 s40, s78, 262152
  s_mul_i32 s40, s40, 81920
  s_add_u32 s40, s40, s84
  ds_read_b128 a[200:203], v120 offset:3072
  v_mfma_f32_16x16x32_bf16 a[76:79], a[236:239], a[124:127], a[76:79]
  s_waitcnt vmcnt(20)
  buffer_load_dwordx4 v3, s[52:55], s40 offen offset:0 sc1 lds
  v_mfma_f32_16x16x32_bf16 a[72:75], a[236:239], a[116:119], a[72:75]
  ds_read_b128 a[204:207], v120 offset:13312
  v_mfma_f32_16x16x32_bf16 a[72:75], a[232:235], a[112:115], a[72:75]
  s_waitcnt lgkmcnt(4)
  v_mfma_f32_16x16x32_bf16 a[0:3], a[240:243], a[128:131], a[0:3]
  ds_read_b128 a[208:211], v120 offset:4096
  v_mfma_f32_16x16x32_bf16 a[0:3], a[244:247], a[132:135], a[0:3]
  buffer_load_dwordx4 v3, s[52:55], s40 offen offset:1024 sc1 lds
  v_mfma_f32_16x16x32_bf16 a[4:7], a[244:247], a[140:143], a[4:7]
  ds_read_b128 a[212:215], v120 offset:14336
  v_mfma_f32_16x16x32_bf16 a[4:7], a[240:243], a[136:139], a[4:7]
  v_mfma_f32_16x16x32_bf16 a[12:15], a[248:251], a[136:139], a[12:15]
  ds_read_b128 a[216:219], v120 offset:5120
  v_mfma_f32_16x16x32_bf16 a[12:15], a[252:255], a[140:143], a[12:15]
  v_mfma_f32_16x16x32_bf16 a[8:11], a[252:255], a[132:135], a[8:11]
  ds_read_b128 a[220:223], v120 offset:15360
  v_mfma_f32_16x16x32_bf16 a[8:11], a[248:251], a[128:131], a[8:11]
  s_waitcnt lgkmcnt(4)
  buffer_load_dwordx4 v3, s[52:55], s40 offen offset:2048 sc1 lds
  v_mfma_f32_16x16x32_bf16 a[16:19], a[192:195], a[128:131], a[16:19]
L_pad_post00_1:
  s_cbranch_execz L_pad_post00_2
  ds_read_b128 a[224:227], v120 offset:6144
  v_mfma_f32_16x16x32_bf16 a[16:19], a[196:199], a[132:135], a[16:19]
  v_mfma_f32_16x16x32_bf16 a[20:23], a[196:199], a[140:143], a[20:23]
  ds_read_b128 a[228:231], v120 offset:16384
  v_mfma_f32_16x16x32_bf16 a[20:23], a[192:195], a[136:139], a[20:23]
  buffer_load_dwordx4 v3, s[52:55], s40 offen offset:3072 sc1 lds
  v_mfma_f32_16x16x32_bf16 a[28:31], a[200:203], a[136:139], a[28:31]
  s_add_u32 m0, s42, 45056
  ds_read_b128 a[232:235], v120 offset:7168
  v_mfma_f32_16x16x32_bf16 a[28:31], a[204:207], a[140:143], a[28:31]
  v_mfma_f32_16x16x32_bf16 a[24:27], a[204:207], a[132:135], a[24:27]
  s_add_u32 s40, s40, 4096
  ds_read_b128 a[236:239], v120 offset:17408
  v_mfma_f32_16x16x32_bf16 a[24:27], a[200:203], a[128:131], a[24:27]
  s_waitcnt lgkmcnt(4)
  buffer_load_dwordx4 v3, s[52:55], s40 offen offset:0 sc1 lds
  v_mfma_f32_16x16x32_bf16 a[32:35], a[208:211], a[128:131], a[32:35]
  s_add_u32 m0, s42, 102400
  ds_read_b128 a[240:243], v120 offset:8192
  v_mfma_f32_16x16x32_bf16 a[32:35], a[212:215], a[132:135], a[32:35]
  v_mfma_f32_16x16x32_bf16 a[36:39], a[212:215], a[140:143], a[36:39]
  s_bfe_u32 s40, s78, 262156
  s_mul_i32 s40, s40, 81920
  s_add_u32 s40, s40, s84
  ds_read_b128 a[244:247], v120 offset:18432
  v_mfma_f32_16x16x32_bf16 a[36:39], a[208:211], a[136:139], a[36:39]
  buffer_load_dwordx4 v3, s[52:55], s40 offen offset:0 sc1 lds
  v_mfma_f32_16x16x32_bf16 a[44:47], a[216:219], a[136:139], a[44:47]
  ds_read_b128 a[248:251], v120 offset:9216
  v_mfma_f32_16x16x32_bf16 a[44:47], a[220:223], a[140:143], a[44:47]
  v_mfma_f32_16x16x32_bf16 a[40:43], a[220:223], a[132:135], a[40:43]
  ds_read_b128 a[252:255], v120 offset:19456
  v_mfma_f32_16x16x32_bf16 a[40:43], a[216:219], a[128:131], a[40:43]
  s_waitcnt lgkmcnt(4)
  buffer_load_dwordx4 v3, s[52:55], s40 offen offset:1024 sc1 lds
  v_mfma_f32_16x16x32_bf16 a[48:51], a[224:227], a[128:131], a[48:51]
  v_mfma_f32_16x16x32_bf16 a[48:51], a[228:231], a[132:135], a[48:51]
  v_mfma_f32_16x16x32_bf16 a[52:55], a[228:231], a[140:143], a[52:55]
  v_mfma_f32_16x16x32_bf16 a[52:55], a[224:227], a[136:139], a[52:55]
  s_waitcnt vmcnt(17)
  s_waitcnt lgkmcnt(0)
  s_barrier
  buffer_load_dwordx4 v3, s[52:55], s40 offen offset:2048 sc1 lds
  v_mfma_f32_16x16x32_bf16 a[60:63], a[232:235], a[136:139], a[60:63]
  ds_read_b128 a[192:195], v121 offset:20480
  v_mfma_f32_16x16x32_bf16 a[60:63], a[236:239], a[140:143], a[60:63]
  ds_read_b128 a[196:199], v121 offset:30720
  v_mfma_f32_16x16x32_bf16 a[56:59], a[236:239], a[132:135], a[56:59]
  ds_read_b128 a[200:203], v121 offset:21504
  v_mfma_f32_16x16x32_bf16 a[56:59], a[232:235], a[128:131], a[56:59]
  ds_read_b128 a[204:207], v121 offset:31744
  v_mfma_f32_16x16x32_bf16 a[64:67], a[240:243], a[128:131], a[64:67]
  ds_read_b128 a[208:211], v121 offset:22528
  v_mfma_f32_16x16x32_bf16 a[64:67], a[244:247], a[132:135], a[64:67]
  buffer_load_dwordx4 v3, s[52:55], s40 offen offset:3072 sc1 lds
  v_mfma_f32_16x16x32_bf16 a[68:71], a[244:247], a[140:143], a[68:71]
  s_add_u32 m0, s42, 106496
  ds_read_b128 a[212:215], v121 offset:32768
  v_mfma_f32_16x16x32_bf16 a[68:71], a[240:243], a[136:139], a[68:71]
  v_mfma_f32_16x16x32_bf16 a[76:79], a[248:251], a[136:139], a[76:79]
  s_add_u32 s40, s40, 4096
  ds_read_b128 a[216:219], v121 offset:23552
  v_mfma_f32_16x16x32_bf16 a[76:79], a[252:255], a[140:143], a[76:79]
  buffer_load_dwordx4 v3, s[52:55], s40 offen offset:0 sc1 lds
  v_mfma_f32_16x16x32_bf16 a[72:75], a[252:255], a[132:135], a[72:75]
  ds_read_b128 a[220:223], v121 offset:33792
  v_mfma_f32_16x16x32_bf16 a[72:75], a[248:251], a[128:131], a[72:75]
  s_waitcnt lgkmcnt(4)
  v_mfma_f32_16x16x32_bf16 v[176:179], a[192:195], v[128:131], 0
  s_add_u32 m0, s42, 81920
  ds_read_b128 a[224:227], v121 offset:24576
  v_mfma_f32_16x16x32_bf16 v[176:179], a[196:199], v[136:139], v[176:179]
  buffer_load_dword v117, v122, s[32:35], s30 offen sc1
  v_mfma_f32_16x16x32_bf16 v[180:183], a[196:199], v[140:143], 0
  s_bfe_u32 s40, s78, 262160
  s_mul_i32 s40, s40, 81920
  s_add_u32 s40, s40, s84
  ds_read_b128 a[228:231], v121 offset:34816
  v_mfma_f32_16x16x32_bf16 v[180:183], a[192:195], v[132:135], v[180:183]
  buffer_load_dwordx4 v3, s[52:55], s40 offen offset:0 sc1 lds
  v_mfma_f32_16x16x32_bf16 v[188:191], a[200:203], v[132:135], 0
  ds_read_b128 a[232:235], v121 offset:25600
  v_mfma_f32_16x16x32_bf16 v[188:191], a[204:207], v[140:143], v[188:191]
  buffer_load_dwordx4 v3, s[52:55], s40 offen offset:1024 sc1 lds
  v_mfma_f32_16x16x32_bf16 v[184:187], a[204:207], v[136:139], 0
  ds_read_b128 a[236:239], v121 offset:35840
  v_mfma_f32_16x16x32_bf16 v[184:187], a[200:203], v[128:131], v[184:187]
  s_waitcnt lgkmcnt(4)
  v_mfma_f32_16x16x32_bf16 v[192:195], a[208:211], v[128:131], 0
  ds_read_b128 a[240:243], v121 offset:26624
  v_accvgpr_read_b32 v96, a44
  v_mfma_f32_16x16x32_bf16 v[192:195], a[212:215], v[136:139], v[192:195]
  buffer_load_dwordx4 v3, s[52:55], s40 offen offset:2048 sc1 lds
  v_mfma_f32_16x16x32_bf16 v[196:199], a[212:215], v[140:143], 0
  ds_read_b128 a[244:247], v121 offset:36864
  v_accvgpr_read_b32 v97, a45
  v_mfma_f32_16x16x32_bf16 v[196:199], a[208:211], v[132:135], v[196:199]
  v_accvgpr_read_b32 v98, a46
  v_accvgpr_read_b32 v99, a47
  v_mfma_f32_16x16x32_bf16 v[204:207], a[216:219], v[132:135], 0
  ds_read_b128 a[248:251], v121 offset:27648
  v_accvgpr_read_b32 v100, a52
  v_mfma_f32_16x16x32_bf16 v[204:207], a[220:223], v[140:143], v[204:207]
  v_mfma_f32_16x16x32_bf16 v[200:203], a[220:223], v[136:139], 0
  ds_read_b128 a[252:255], v121 offset:37888
  v_accvgpr_read_b32 v101, a53
  v_mfma_f32_16x16x32_bf16 v[200:203], a[216:219], v[128:131], v[200:203]
  s_waitcnt lgkmcnt(4)
  v_accvgpr_read_b32 v102, a54
  v_accvgpr_read_b32 v103, a55
  v_mfma_f32_16x16x32_bf16 v[208:211], a[224:227], v[128:131], 0
  ds_read_b128 a[192:195], v121 offset:28672
  v_cvt_pk_bf16_f32 v40, v96, v97
  v_mfma_f32_16x16x32_bf16 v[208:211], a[228:231], v[136:139], v[208:211]
  buffer_load_dwordx4 v3, s[52:55], s40 offen offset:3072 sc1 lds
  v_mfma_f32_16x16x32_bf16 v[212:215], a[228:231], v[140:143], 0
  s_add_u32 m0, s42, 86016
  ds_read_b128 a[196:199], v121 offset:38912
  v_cvt_pk_bf16_f32 v41, v98, v99
  v_mfma_f32_16x16x32_bf16 v[212:215], a[224:227], v[132:135], v[212:215]
  v_cvt_pk_bf16_f32 v42, v100, v101
  v_cvt_pk_bf16_f32 v43, v102, v103
  v_mfma_f32_16x16x32_bf16 v[220:223], a[232:235], v[132:135], 0
  s_add_u32 s40, s40, 4096
  ds_read_b128 a[200:203], v121 offset:29696
  v_accvgpr_read_b32 v96, a40
  v_mfma_f32_16x16x32_bf16 v[220:223], a[236:239], v[140:143], v[220:223]
  buffer_load_dwordx4 v3, s[52:55], s40 offen offset:0 sc1 lds
  v_mfma_f32_16x16x32_bf16 v[216:219], a[236:239], v[136:139], 0
  s_add_u32 m0, s42, 61440
  ds_read_b128 a[204:207], v121 offset:39936
  v_accvgpr_read_b32 v97, a41
  v_mfma_f32_16x16x32_bf16 v[216:219], a[232:235], v[128:131], v[216:219]
  s_waitcnt lgkmcnt(4)
  v_accvgpr_read_b32 v98, a42
  v_accvgpr_read_b32 v99, a43
  v_mfma_f32_16x16x32_bf16 v[224:227], a[240:243], v[128:131], 0
  s_bfe_u32 s40, s78, 262164
  s_mul_i32 s40, s40, 81920
  s_add_u32 s40, s40, s84
  ds_read_b128 a[208:211], v119 offset:0
  v_accvgpr_read_b32 v100, a48
  v_mfma_f32_16x16x32_bf16 v[224:227], a[244:247], v[136:139], v[224:227]
  buffer_load_dwordx4 v3, s[52:55], s40 offen offset:0 sc1 lds
  v_mfma_f32_16x16x32_bf16 v[228:231], a[244:247], v[140:143], 0
  ds_read_b128 a[212:215], v119 offset:10240
  v_accvgpr_read_b32 v101, a49
  v_mfma_f32_16x16x32_bf16 v[228:231], a[240:243], v[132:135], v[228:231]
  v_accvgpr_read_b32 v102, a50
  v_accvgpr_read_b32 v103, a51
  v_mfma_f32_16x16x32_bf16 v[236:239], a[248:251], v[132:135], 0
  ds_read_b128 a[216:219], v119 offset:1024
  v_cvt_pk_bf16_f32 v44, v96, v97
  v_mfma_f32_16x16x32_bf16 v[236:239], a[252:255], v[140:143], v[236:239]
  buffer_load_dwordx4 v3, s[52:55], s40 offen offset:1024 sc1 lds
  v_mfma_f32_16x16x32_bf16 v[232:235], a[252:255], v[136:139], 0
  ds_read_b128 a[220:223], v119 offset:11264
  v_cvt_pk_bf16_f32 v45, v98, v99
  v_mfma_f32_16x16x32_bf16 v[232:235], a[248:251], v[128:131], v[232:235]
  s_waitcnt lgkmcnt(4)
  v_cvt_pk_bf16_f32 v46, v100, v101
  v_cvt_pk_bf16_f32 v47, v102, v103
  v_mfma_f32_16x16x32_bf16 v[240:243], a[192:195], v[128:131], 0
  ds_read_b128 a[224:227], v119 offset:2048
  v_accvgpr_read_b32 v96, a60
  v_mfma_f32_16x16x32_bf16 v[240:243], a[196:199], v[136:139], v[240:243]
  buffer_load_dwordx4 v3, s[52:55], s40 offen offset:2048 sc1 lds
  v_mfma_f32_16x16x32_bf16 v[244:247], a[196:199], v[140:143], 0
  ds_read_b128 a[228:231], v119 offset:12288
  v_accvgpr_read_b32 v97, a61
  v_mfma_f32_16x16x32_bf16 v[244:247], a[192:195], v[132:135], v[244:247]
  v_accvgpr_read_b32 v98, a62
  v_accvgpr_read_b32 v99, a63
  v_mfma_f32_16x16x32_bf16 v[252:255], a[200:203], v[132:135], 0
  ds_read_b128 a[232:235], v119 offset:3072
  v_accvgpr_read_b32 v100, a68
  v_mfma_f32_16x16x32_bf16 v[252:255], a[204:207], v[140:143], v[252:255]
  buffer_load_dwordx4 v3, s[52:55], s40 offen offset:3072 sc1 lds
  v_mfma_f32_16x16x32_bf16 v[248:251], a[204:207], v[136:139], 0
  ds_read_b128 a[236:239], v119 offset:13312
  v_accvgpr_read_b32 v101, a69
  v_mfma_f32_16x16x32_bf16 v[248:251], a[200:203], v[128:131], v[248:251]
  s_waitcnt lgkmcnt(4)
  v_accvgpr_read_b32 v102, a70
  v_accvgpr_read_b32 v103, a71
  s_waitcnt vmcnt(9)
  v_cmp_ne_u32 vcc, 1, v117
  s_nop 1
  s_cbranch_vccnz L_ow_0
L_ow_ok_0:
  v_mfma_f32_16x16x32_bf16 v[176:179], a[208:211], v[144:147], v[176:179]
  s_bfe_u32 s41, s78, 262144
  s_mul_i32 s41, s41, 262144
  s_add_u32 s41, s41, s85
  ds_read_b128 a[240:243], v119 offset:4096
  v_cvt_pk_bf16_f32 v48, v96, v97
  v_mfma_f32_16x16x32_bf16 v[176:179], a[212:215], v[152:155], v[176:179]
  buffer_load_dwordx4 a[144:147], v112, s[32:35], s41 offen offset:0 sc1
  v_mfma_f32_16x16x32_bf16 v[180:183], a[212:215], v[156:159], v[180:183]
  ds_read_b128 a[244:247], v119 offset:14336
  v_cvt_pk_bf16_f32 v49, v98, v99
  v_mfma_f32_16x16x32_bf16 v[180:183], a[208:211], v[148:151], v[180:183]
  v_cvt_pk_bf16_f32 v50, v100, v101
  v_cvt_pk_bf16_f32 v51, v102, v103
  v_mfma_f32_16x16x32_bf16 v[188:191], a[216:219], v[148:151], v[188:191]
  ds_read_b128 a[248:251], v119 offset:5120
  v_accvgpr_read_b32 v96, a56
  v_mfma_f32_16x16x32_bf16 v[188:191], a[220:223], v[156:159], v[188:191]
  buffer_load_dwordx4 a[148:151], v112, s[32:35], s41 offen offset:1024 sc1
  v_mfma_f32_16x16x32_bf16 v[184:187], a[220:223], v[152:155], v[184:187]
  ds_read_b128 a[252:255], v119 offset:15360
  v_accvgpr_read_b32 v97, a57
  v_mfma_f32_16x16x32_bf16 v[184:187], a[216:219], v[144:147], v[184:187]
  s_waitcnt lgkmcnt(4)
  v_accvgpr_read_b32 v98, a58
  v_accvgpr_read_b32 v99, a59
  v_mfma_f32_16x16x32_bf16 v[192:195], a[224:227], v[144:147], v[192:195]
  ds_read_b128 a[192:195], v119 offset:6144
  v_accvgpr_read_b32 v100, a64
  v_mfma_f32_16x16x32_bf16 v[192:195], a[228:231], v[152:155], v[192:195]
  buffer_load_dwordx4 a[152:155], v113, s[32:35], s41 offen offset:0 sc1
  v_mfma_f32_16x16x32_bf16 v[196:199], a[228:231], v[156:159], v[196:199]
  ds_read_b128 a[196:199], v119 offset:16384
  v_accvgpr_read_b32 v101, a65
  v_mfma_f32_16x16x32_bf16 v[196:199], a[224:227], v[148:151], v[196:199]
  v_accvgpr_read_b32 v102, a66
  v_accvgpr_read_b32 v103, a67
  v_mfma_f32_16x16x32_bf16 v[204:207], a[232:235], v[148:151], v[204:207]
  ds_read_b128 a[200:203], v119 offset:7168
  v_cvt_pk_bf16_f32 v52, v96, v97
  v_mfma_f32_16x16x32_bf16 v[204:207], a[236:239], v[156:159], v[204:207]
  buffer_load_dwordx4 a[156:159], v113, s[32:35], s41 offen offset:1024 sc1
  v_mfma_f32_16x16x32_bf16 v[200:203], a[236:239], v[152:155], v[200:203]
  ds_read_b128 a[204:207], v119 offset:17408
  v_cvt_pk_bf16_f32 v53, v98, v99
  v_mfma_f32_16x16x32_bf16 v[200:203], a[232:235], v[144:147], v[200:203]
  s_waitcnt lgkmcnt(4)
  v_cvt_pk_bf16_f32 v54, v100, v101
  v_cvt_pk_bf16_f32 v55, v102, v103
  v_mfma_f32_16x16x32_bf16 v[208:211], a[240:243], v[144:147], v[208:211]
  s_bfe_u32 s41, s78, 262148
  s_mul_i32 s41, s41, 262144
  s_add_u32 s41, s41, s85
  ds_read_b128 a[208:211], v119 offset:8192
  v_accvgpr_read_b32 v96, a4
  v_mfma_f32_16x16x32_bf16 v[208:211], a[244:247], v[152:155], v[208:211]
  buffer_load_dwordx4 a[160:163], v112, s[32:35], s41 offen offset:0 sc1
  v_mfma_f32_16x16x32_bf16 v[212:215], a[244:247], v[156:159], v[212:215]
  ds_read_b128 a[212:215], v119 offset:18432
  v_accvgpr_read_b32 v97, a5
  v_mfma_f32_16x16x32_bf16 v[212:215], a[240:243], v[148:151], v[212:215]
  v_accvgpr_read_b32 v98, a6
  v_accvgpr_read_b32 v99, a7
  v_mfma_f32_16x16x32_bf16 v[220:223], a[248:251], v[148:151], v[220:223]
  ds_read_b128 a[216:219], v119 offset:9216
  v_accvgpr_read_b32 v100, a12
  v_mfma_f32_16x16x32_bf16 v[220:223], a[252:255], v[156:159], v[220:223]
  buffer_load_dwordx4 a[164:167], v112, s[32:35], s41 offen offset:1024 sc1
  v_mfma_f32_16x16x32_bf16 v[216:219], a[252:255], v[152:155], v[216:219]
  ds_read_b128 a[220:223], v119 offset:19456
  v_accvgpr_read_b32 v101, a13
  v_mfma_f32_16x16x32_bf16 v[216:219], a[248:251], v[144:147], v[216:219]
  s_waitcnt lgkmcnt(4)
  v_accvgpr_read_b32 v102, a14
  v_accvgpr_read_b32 v103, a15
  v_mfma_f32_16x16x32_bf16 v[224:227], a[192:195], v[144:147], v[224:227]
  v_cvt_pk_bf16_f32 v56, v96, v97
  v_cvt_pk_bf16_f32 v57, v98, v99
  v_mfma_f32_16x16x32_bf16 v[224:227], a[196:199], v[152:155], v[224:227]
  buffer_load_dwordx4 a[168:171], v113, s[32:35], s41 offen offset:0 sc1
  v_mfma_f32_16x16x32_bf16 v[228:231], a[196:199], v[156:159], v[228:231]
  v_cvt_pk_bf16_f32 v58, v100, v101
  v_cvt_pk_bf16_f32 v59, v102, v103
  v_mfma_f32_16x16x32_bf16 v[228:231], a[192:195], v[148:151], v[228:231]
  s_waitcnt lgkmcnt(0)
  s_barrier
  v_accvgpr_read_b32 v96, a20
  v_accvgpr_read_b32 v97, a21
  v_mfma_f32_16x16x32_bf16 v[236:239], a[200:203], v[148:151], v[236:239]
  ds_read_b128 a[224:227], v119 offset:20480
  v_accvgpr_read_b32 v98, a22
  v_mfma_f32_16x16x32_bf16 v[236:239], a[204:207], v[156:159], v[236:239]
  ds_read_b128 a[228:231], v119 offset:30720
  v_mfma_f32_16x16x32_bf16 v[232:235], a[204:207], v[152:155], v[232:235]
  ds_read_b128 a[232:235], v119 offset:21504
  v_accvgpr_read_b32 v99, a23
  v_mfma_f32_16x16x32_bf16 v[232:235], a[200:203], v[144:147], v[232:235]
  ds_read_b128 a[236:239], v119 offset:31744
  v_accvgpr_read_b32 v100, a28
  v_mfma_f32_16x16x32_bf16 v[240:243], a[208:211], v[144:147], v[240:243]
  ds_read_b128 a[240:243], v119 offset:22528
  v_accvgpr_read_b32 v101, a29
  v_mfma_f32_16x16x32_bf16 v[240:243], a[212:215], v[152:155], v[240:243]
  buffer_load_dwordx4 a[172:175], v113, s[32:35], s41 offen offset:1024 sc1
  v_mfma_f32_16x16x32_bf16 v[244:247], a[212:215], v[156:159], v[244:247]
  ds_read_b128 a[244:247], v119 offset:32768
  v_accvgpr_read_b32 v102, a30
  v_mfma_f32_16x16x32_bf16 v[244:247], a[208:211], v[148:151], v[244:247]
  v_accvgpr_read_b32 v103, a31
  v_cvt_pk_bf16_f32 v60, v96, v97
  v_mfma_f32_16x16x32_bf16 v[252:255], a[216:219], v[148:151], v[252:255]
  s_xor_b32 s3, s97, 62464
  ds_read_b128 a[248:251], v119 offset:23552
  v_cvt_pk_bf16_f32 v61, v98, v99
  v_mfma_f32_16x16x32_bf16 v[252:255], a[220:223], v[156:159], v[252:255]
  s_waitcnt vmcnt(4)
  buffer_store_dwordx4 v[40:43], v3, s[32:35], s3 offen offset:0 sc1
  v_mfma_f32_16x16x32_bf16 v[248:251], a[220:223], v[152:155], v[248:251]
  ds_read_b128 a[252:255], v119 offset:33792
  v_cvt_pk_bf16_f32 v62, v100, v101
  v_mfma_f32_16x16x32_bf16 v[248:251], a[216:219], v[144:147], v[248:251]
  s_waitcnt lgkmcnt(4)
  v_cvt_pk_bf16_f32 v63, v102, v103
  v_mfma_f32_16x16x32_bf16 v[176:179], a[224:227], a[144:147], v[176:179]
  ds_read_b128 a[192:195], v119 offset:24576
  v_accvgpr_read_b32 v96, a76
  v_mfma_f32_16x16x32_bf16 v[176:179], a[228:231], a[148:151], v[176:179]
  v_mfma_f32_16x16x32_bf16 v[180:183], a[228:231], a[156:159], v[180:183]
  ds_read_b128 a[196:199], v119 offset:34816
  v_accvgpr_read_b32 v97, a77
  v_mfma_f32_16x16x32_bf16 v[180:183], a[224:227], a[152:155], v[180:183]
  v_accvgpr_read_b32 v98, a78
  v_accvgpr_read_b32 v99, a79
  v_mfma_f32_16x16x32_bf16 v[188:191], a[232:235], a[152:155], v[188:191]
  ds_read_b128 a[200:203], v119 offset:25600
  v_cvt_pk_bf16_f32 v64, v96, v97
  v_mfma_f32_16x16x32_bf16 v[188:191], a[236:239], a[156:159], v[188:191]
  v_mfma_f32_16x16x32_bf16 v[184:187], a[236:239], a[148:151], v[184:187]
  ds_read_b128 a[204:207], v119 offset:35840
  v_cvt_pk_bf16_f32 v65, v98, v99
  v_mfma_f32_16x16x32_bf16 v[184:187], a[232:235], a[144:147], v[184:187]
  s_waitcnt lgkmcnt(4)
  v_accvgpr_read_b32 v96, a72
  v_accvgpr_read_b32 v97, a73
  v_mfma_f32_16x16x32_bf16 v[192:195], a[240:243], a[144:147], v[192:195]
  s_bfe_u32 s41, s78, 262152
  s_mul_i32 s41, s41, 262144
  s_add_u32 s41, s41, s85
  ds_read_b128 a[208:211], v119 offset:26624
  v_accvgpr_read_b32 v98, a74
  v_mfma_f32_16x16x32_bf16 v[192:195], a[244:247], a[148:151], v[192:195]
  buffer_load_dwordx4 a[176:179], v112, s[32:35], s41 offen offset:0 sc1
  v_mfma_f32_16x16x32_bf16 v[196:199], a[244:247], a[156:159], v[196:199]
  ds_read_b128 a[212:215], v119 offset:36864
  v_accvgpr_read_b32 v99, a75
  v_mfma_f32_16x16x32_bf16 v[196:199], a[240:243], a[152:155], v[196:199]
  v_cvt_pk_bf16_f32 v66, v96, v97
  v_cvt_pk_bf16_f32 v67, v98, v99
  v_mfma_f32_16x16x32_bf16 v[204:207], a[248:251], a[152:155], v[204:207]
  ds_read_b128 a[216:219], v119 offset:27648
  v_accvgpr_read_b32 v96, a36
  v_mfma_f32_16x16x32_bf16 v[204:207], a[252:255], a[156:159], v[204:207]
  buffer_load_dwordx4 a[180:183], v112, s[32:35], s41 offen offset:1024 sc1
  v_mfma_f32_16x16x32_bf16 v[200:203], a[252:255], a[148:151], v[200:203]
  ds_read_b128 a[220:223], v119 offset:37888
  v_accvgpr_read_b32 v97, a37
  v_mfma_f32_16x16x32_bf16 v[200:203], a[248:251], a[144:147], v[200:203]
  s_waitcnt lgkmcnt(4)
  v_accvgpr_read_b32 v98, a38
  v_accvgpr_read_b32 v99, a39
  v_mfma_f32_16x16x32_bf16 v[208:211], a[192:195], a[144:147], v[208:211]
  ds_read_b128 a[224:227], v119 offset:28672
  v_cvt_pk_bf16_f32 v68, v96, v97
  v_mfma_f32_16x16x32_bf16 v[208:211], a[196:199], a[148:151], v[208:211]
  buffer_load_dwordx4 a[184:187], v113, s[32:35], s41 offen offset:0 sc1
  v_mfma_f32_16x16x32_bf16 v[212:215], a[196:199], a[156:159], v[212:215]
  ds_read_b128 a[228:231], v119 offset:38912
  v_cvt_pk_bf16_f32 v69, v98, v99
  v_mfma_f32_16x16x32_bf16 v[212:215], a[192:195], a[152:155], v[212:215]
  v_and_b32 v2, 15, v1
  v_mul_u32_u24 v123, 1280, v2
  v_mfma_f32_16x16x32_bf16 v[220:223], a[200:203], a[152:155], v[220:223]
  ds_read_b128 a[232:235], v119 offset:29696
  v_lshrrev_b32 v2, 4, v1
  v_mfma_f32_16x16x32_bf16 v[220:223], a[204:207], a[156:159], v[220:223]
  buffer_load_dwordx4 a[188:191], v113, s[32:35], s41 offen offset:1024 sc1
  v_mfma_f32_16x16x32_bf16 v[216:219], a[204:207], a[148:151], v[216:219]
  ds_read_b128 a[236:239], v119 offset:39936
  v_lshl_add_u32 v123, v2, 3, v123
  v_mfma_f32_16x16x32_bf16 v[216:219], a[200:203], a[144:147], v[216:219]
  s_waitcnt lgkmcnt(4)
  v_and_b32 v2, 1, v2
  v_mad_u32_u24 v38, v2, 24, v123
  v_mfma_f32_16x16x32_bf16 v[224:227], a[208:211], a[144:147], v[224:227]
  ds_read_b128 a[240:243], v121 offset:0
  v_accvgpr_read_b32 v8, a0
  v_mfma_f32_16x16x32_bf16 v[224:227], a[212:215], a[148:151], v[224:227]
  v_mfma_f32_16x16x32_bf16 v[228:231], a[212:215], a[156:159], v[228:231]
  ds_read_b128 a[244:247], v121 offset:10240
  v_accvgpr_read_b32 v9, a1
  v_mfma_f32_16x16x32_bf16 v[228:231], a[208:211], a[152:155], v[228:231]
  v_accvgpr_read_b32 v10, a2
  v_accvgpr_read_b32 v11, a3
  v_mfma_f32_16x16x32_bf16 v[236:239], a[216:219], a[152:155], v[236:239]
  s_xor_b32 s3, s97, 25600
  ds_read_b128 a[248:251], v121 offset:1024
  v_accvgpr_read_b32 v12, a8
  v_mfma_f32_16x16x32_bf16 v[236:239], a[220:223], a[156:159], v[236:239]
  buffer_store_dwordx4 v[44:47], v3, s[32:35], s3 offen offset:0 sc1
  v_mfma_f32_16x16x32_bf16 v[232:235], a[220:223], a[148:151], v[232:235]
  ds_read_b128 a[252:255], v121 offset:11264
  v_accvgpr_read_b32 v13, a9
  v_mfma_f32_16x16x32_bf16 v[232:235], a[216:219], a[144:147], v[232:235]
  s_waitcnt lgkmcnt(4)
  v_accvgpr_read_b32 v14, a10
  v_accvgpr_read_b32 v15, a11
  v_mfma_f32_16x16x32_bf16 v[240:243], a[224:227], a[144:147], v[240:243]
  ds_read_b128 a[192:195], v121 offset:2048
  v_accvgpr_read_b32 v16, a16
  v_mfma_f32_16x16x32_bf16 v[240:243], a[228:231], a[148:151], v[240:243]
  v_mfma_f32_16x16x32_bf16 v[244:247], a[228:231], a[156:159], v[244:247]
  ds_read_b128 a[196:199], v121 offset:12288
  v_accvgpr_read_b32 v17, a17
  v_mfma_f32_16x16x32_bf16 v[244:247], a[224:227], a[152:155], v[244:247]
  v_accvgpr_read_b32 v18, a18
  v_accvgpr_read_b32 v19, a19
  v_mfma_f32_16x16x32_bf16 v[252:255], a[232:235], a[152:155], v[252:255]
  ds_read_b128 a[200:203], v121 offset:3072
  v_accvgpr_read_b32 v20, a24
  v_mfma_f32_16x16x32_bf16 v[252:255], a[236:239], a[156:159], v[252:255]
  s_waitcnt vmcnt(6)
  v_mfma_f32_16x16x32_bf16 v[248:251], a[236:239], a[148:151], v[248:251]
  ds_read_b128 a[204:207], v121 offset:13312
  v_accvgpr_read_b32 v21, a25
  v_mfma_f32_16x16x32_bf16 v[248:251], a[232:235], a[144:147], v[248:251]
  s_waitcnt lgkmcnt(4)
  v_accvgpr_read_b32 v22, a26
  v_accvgpr_read_b32 v23, a27
  v_mfma_f32_16x16x32_bf16 v[176:179], a[240:243], a[160:163], v[176:179]
  s_bfe_u32 s41, s78, 262156
  s_mul_i32 s41, s41, 262144
  s_add_u32 s41, s41, s85
  ds_read_b128 a[208:211], v121 offset:4096
  v_accvgpr_read_b32 v24, a32
  v_mfma_f32_16x16x32_bf16 v[176:179], a[244:247], a[164:167], v[176:179]
  buffer_load_dwordx4 a[80:83], v112, s[32:35], s41 offen offset:0 sc1
  v_mfma_f32_16x16x32_bf16 v[180:183], a[244:247], a[172:175], v[180:183]
  ds_read_b128 a[212:215], v121 offset:14336
  v_accvgpr_read_b32 v25, a33
  v_mfma_f32_16x16x32_bf16 v[180:183], a[240:243], a[168:171], v[180:183]
  v_accvgpr_read_b32 v26, a34
  v_accvgpr_read_b32 v27, a35
  v_mfma_f32_16x16x32_bf16 v[188:191], a[248:251], a[168:171], v[188:191]
  ds_read_b128 a[216:219], v121 offset:5120
  v_bfe_u32 v90, v1, 2, 2
  v_mfma_f32_16x16x32_bf16 v[188:191], a[252:255], a[172:175], v[188:191]
  buffer_load_dwordx4 a[84:87], v112, s[32:35], s41 offen offset:1024 sc1
  v_mfma_f32_16x16x32_bf16 v[184:187], a[252:255], a[164:167], v[184:187]
  ds_read_b128 a[220:223], v121 offset:15360
  v_lshrrev_b32 v91, 4, v1
  v_mfma_f32_16x16x32_bf16 v[184:187], a[248:251], a[160:163], v[184:187]
  s_waitcnt lgkmcnt(4)
  v_cmp_eq_u32 vcc, v90, v91
  v_and_b32 v90, 1, v1
  v_mfma_f32_16x16x32_bf16 v[192:195], a[192:195], a[160:163], v[192:195]
  ds_read_b128 a[224:227], v121 offset:6144
  v_lshlrev_b32 v90, 4, v90
  v_mfma_f32_16x16x32_bf16 v[192:195], a[196:199], a[164:167], v[192:195]
  buffer_load_dwordx4 a[88:91], v113, s[32:35], s41 offen offset:0 sc1
  v_mfma_f32_16x16x32_bf16 v[196:199], a[196:199], a[172:175], v[196:199]
  ds_read_b128 a[228:231], v121 offset:16384
  v_mov_b32 v91, 0x3f80
  v_mfma_f32_16x16x32_bf16 v[196:199], a[192:195], a[168:171], v[196:199]
  v_lshlrev_b32 v90, v90, v91
  v_cndmask_b32 v90, 0, v90, vcc
  v_mfma_f32_16x16x32_bf16 v[204:207], a[200:203], a[168:171], v[204:207]
  ds_read_b128 a[232:235], v121 offset:7168
  v_bfe_i32 v91, v1, 1, 1
  v_mfma_f32_16x16x32_bf16 v[204:207], a[204:207], a[172:175], v[204:207]
  buffer_load_dwordx4 a[92:95], v113, s[32:35], s41 offen offset:1024 sc1
  v_mfma_f32_16x16x32_bf16 v[200:203], a[204:207], a[164:167], v[200:203]
  ds_read_b128 a[236:239], v121 offset:17408
  v_and_b32 v91, v91, v90
  v_mfma_f32_16x16x32_bf16 v[200:203], a[200:203], a[160:163], v[200:203]
  s_waitcnt lgkmcnt(4)
  v_sub_u32 v90, v90, v91
  v_mov_b32 v88, 0
  v_mfma_f32_16x16x32_bf16 v[208:211], a[208:211], a[160:163], v[208:211]
  ds_read_b128 a[240:243], v121 offset:8192
  v_mov_b32 v89, 0
  v_mfma_f32_16x16x32_bf16 v[208:211], a[212:215], a[164:167], v[208:211]
  v_mfma_f32_16x16x32_bf16 v[212:215], a[212:215], a[172:175], v[212:215]
  ds_read_b128 a[244:247], v121 offset:18432
  v_mov_b32 v92, 0
  v_mfma_f32_16x16x32_bf16 v[212:215], a[208:211], a[168:171], v[212:215]
  v_mov_b32 v93, 0
  v_mfma_f32_16x16x32_bf16 v[220:223], a[216:219], a[168:171], v[220:223]
  s_xor_b32 s3, s97, 62464
  ds_read_b128 a[248:251], v121 offset:9216
  v_mfma_f32_16x16x32_bf16 v[220:223], a[220:223], a[172:175], v[220:223]
  buffer_store_dwordx4 v[48:51], v3, s[32:35], s3 offen offset:1024 sc1
  v_mfma_f32_16x16x32_bf16 v[216:219], a[220:223], a[164:167], v[216:219]
  ds_read_b128 a[252:255], v121 offset:19456
  v_mfma_f32_16x16x32_bf16 v[216:219], a[216:219], a[160:163], v[216:219]
  s_waitcnt lgkmcnt(4)
  v_mfma_f32_16x16x32_bf16 v[224:227], a[224:227], a[160:163], v[224:227]
  v_mfma_f32_16x16x32_bf16 v[224:227], a[228:231], a[164:167], v[224:227]
  v_mfma_f32_16x16x32_bf16 v[228:231], a[228:231], a[172:175], v[228:231]
  v_mfma_f32_16x16x32_bf16 v[228:231], a[224:227], a[168:171], v[228:231]
  s_waitcnt lgkmcnt(0)
  s_barrier
  v_mfma_f32_16x16x32_bf16 v[236:239], a[232:235], a[168:171], v[236:239]
  ds_read_b128 a[192:195], v119 offset:40960
  v_mfma_f32_16x16x32_bf16 v[236:239], a[236:239], a[172:175], v[236:239]
  ds_read_b128 a[196:199], v119 offset:51200
  v_mfma_f32_16x16x32_bf16 v[232:235], a[236:239], a[164:167], v[232:235]
  s_add_u32 m0, s42, 65536
  ds_read_b128 a[200:203], v119 offset:41984
  v_mfma_f32_16x16x32_bf16 v[232:235], a[232:235], a[160:163], v[232:235]
  ds_read_b128 a[204:207], v119 offset:52224
  v_mfma_f32_16x16x32_bf16 v[240:243], a[240:243], a[160:163], v[240:243]
  s_add_u32 s40, s40, 4096
  ds_read_b128 a[208:211], v119 offset:43008
  v_mfma_f32_16x16x32_bf16 v[240:243], a[244:247], a[164:167], v[240:243]
  buffer_load_dwordx4 v3, s[52:55], s40 offen offset:0 sc1 lds
  v_mfma_f32_16x16x32_bf16 v[244:247], a[244:247], a[172:175], v[244:247]
  ds_read_b128 a[212:215], v119 offset:53248
  v_mfma_f32_16x16x32_bf16 v[244:247], a[240:243], a[168:171], v[244:247]
  v_mfma_f32_16x16x32_bf16 v[252:255], a[248:251], a[168:171], v[252:255]
  s_bfe_u32 s41, s78, 262160
  s_mul_i32 s41, s41, 262144
  s_add_u32 s41, s41, s85
  ds_read_b128 a[216:219], v119 offset:44032
  v_mfma_f32_16x16x32_bf16 v[252:255], a[252:255], a[172:175], v[252:255]
  s_waitcnt vmcnt(7)
  buffer_load_dwordx4 a[96:99], v112, s[32:35], s41 offen offset:0 sc1
  v_mfma_f32_16x16x32_bf16 v[248:251], a[252:255], a[164:167], v[248:251]
  ds_read_b128 a[220:223], v119 offset:54272
  v_mfma_f32_16x16x32_bf16 v[248:251], a[248:251], a[160:163], v[248:251]
  s_waitcnt lgkmcnt(4)
  v_mfma_f32_16x16x32_bf16 v[176:179], a[192:195], a[176:179], v[176:179]
  ds_read_b128 a[224:227], v119 offset:45056
  v_mfma_f32_16x16x32_bf16 v[176:179], a[196:199], a[180:183], v[176:179]
  v_mfma_f32_16x16x32_bf16 v[180:183], a[196:199], a[188:191], v[180:183]
  ds_read_b128 a[228:231], v119 offset:55296
  v_mfma_f32_16x16x32_bf16 v[180:183], a[192:195], a[184:187], v[180:183]
  buffer_load_dwordx4 a[100:103], v112, s[32:35], s41 offen offset:1024 sc1
  v_mfma_f32_16x16x32_bf16 v[188:191], a[200:203], a[184:187], v[188:191]
L_pad_post01_1:
  s_cbranch_execz L_back1
  ds_read_b128 a[232:235], v119 offset:46080
  v_mfma_f32_16x16x32_bf16 v[188:191], a[204:207], a[188:191], v[188:191]
  v_mfma_f32_16x16x32_bf16 v[184:187], a[204:207], a[180:183], v[184:187]
  ds_read_b128 a[236:239], v119 offset:56320
  v_mfma_f32_16x16x32_bf16 v[184:187], a[200:203], a[176:179], v[184:187]
  s_waitcnt lgkmcnt(4)
  buffer_load_dwordx4 a[104:107], v113, s[32:35], s41 offen offset:0 sc1
  v_mfma_f32_16x16x32_bf16 v[192:195], a[208:211], a[176:179], v[192:195]
  ds_read_b128 a[240:243], v119 offset:47104
  v_mfma_f32_16x16x32_bf16 v[192:195], a[212:215], a[180:183], v[192:195]
  buffer_load_dwordx4 a[108:111], v113, s[32:35], s41 offen offset:1024 sc1
  v_mfma_f32_16x16x32_bf16 v[196:199], a[212:215], a[188:191], v[196:199]
  ds_read_b128 a[244:247], v119 offset:57344
  v_mfma_f32_16x16x32_bf16 v[196:199], a[208:211], a[184:187], v[196:199]
  v_mfma_f32_16x16x32_bf16 v[204:207], a[216:219], a[184:187], v[204:207]
  s_xor_b32 s3, s97, 25600
  ds_read_b128 a[248:251], v119 offset:48128
  v_mfma_f32_16x16x32_bf16 v[204:207], a[220:223], a[188:191], v[204:207]
  buffer_store_dwordx4 v[52:55], v3, s[32:35], s3 offen offset:1024 sc1
  v_mfma_f32_16x16x32_bf16 v[200:203], a[220:223], a[180:183], v[200:203]
  ds_read_b128 a[252:255], v119 offset:58368
  v_mfma_f32_16x16x32_bf16 v[200:203], a[216:219], a[176:179], v[200:203]
  s_waitcnt lgkmcnt(4)
  v_mfma_f32_16x16x32_bf16 v[208:211], a[224:227], a[176:179], v[208:211]
  ds_read_b128 a[192:195], v119 offset:49152
  v_mfma_f32_16x16x32_bf16 v[208:211], a[228:231], a[180:183], v[208:211]
  v_mfma_f32_16x16x32_bf16 v[212:215], a[228:231], a[188:191], v[212:215]
  ds_read_b128 a[196:199], v119 offset:59392
  v_mfma_f32_16x16x32_bf16 v[212:215], a[224:227], a[184:187], v[212:215]
  v_mfma_f32_16x16x32_bf16 v[220:223], a[232:235], a[184:187], v[220:223]
  ds_read_b128 a[200:203], v119 offset:50176
  v_mfma_f32_16x16x32_bf16 v[220:223], a[236:239], a[188:191], v[220:223]
  v_mfma_f32_16x16x32_bf16 v[216:219], a[236:239], a[180:183], v[216:219]
  ds_read_b128 a[204:207], v119 offset:60416
  v_mfma_f32_16x16x32_bf16 v[216:219], a[232:235], a[176:179], v[216:219]
  s_waitcnt lgkmcnt(4)
  v_mfma_f32_16x16x32_bf16 v[224:227], a[240:243], a[176:179], v[224:227]
  ds_read_b128 a[208:211], v120 offset:40960
  v_mfma_f32_16x16x32_bf16 v[224:227], a[244:247], a[180:183], v[224:227]
  v_mfma_f32_16x16x32_bf16 v[228:231], a[244:247], a[188:191], v[228:231]
  ds_read_b128 a[212:215], v120 offset:51200
  v_mfma_f32_16x16x32_bf16 v[228:231], a[240:243], a[184:187], v[228:231]
  v_mfma_f32_16x16x32_bf16 v[236:239], a[248:251], a[184:187], v[236:239]
  s_xor_b32 s3, s97, 44032
  ds_read_b128 a[216:219], v120 offset:41984
  v_mfma_f32_16x16x32_bf16 v[236:239], a[252:255], a[188:191], v[236:239]
  buffer_store_dwordx4 v[56:59], v3, s[32:35], s3 offen offset:0 sc1
  v_mfma_f32_16x16x32_bf16 v[232:235], a[252:255], a[180:183], v[232:235]
  ds_read_b128 a[220:223], v120 offset:52224
  v_mfma_f32_16x16x32_bf16 v[232:235], a[248:251], a[176:179], v[232:235]
  s_waitcnt lgkmcnt(4)
  v_mfma_f32_16x16x32_bf16 v[240:243], a[192:195], a[176:179], v[240:243]
  ds_read_b128 a[224:227], v120 offset:43008
  v_mfma_f32_16x16x32_bf16 v[240:243], a[196:199], a[180:183], v[240:243]
  v_mfma_f32_16x16x32_bf16 v[244:247], a[196:199], a[188:191], v[244:247]
  ds_read_b128 a[228:231], v120 offset:53248
  v_mfma_f32_16x16x32_bf16 v[244:247], a[192:195], a[184:187], v[244:247]
  v_mfma_f32_16x16x32_bf16 v[252:255], a[200:203], a[184:187], v[252:255]
  ds_read_b128 a[232:235], v120 offset:44032
  v_mfma_f32_16x16x32_bf16 v[252:255], a[204:207], a[188:191], v[252:255]
  s_waitcnt vmcnt(8)
  v_mfma_f32_16x16x32_bf16 v[248:251], a[204:207], a[180:183], v[248:251]
  ds_read_b128 a[236:239], v120 offset:54272
  v_mfma_f32_16x16x32_bf16 v[248:251], a[200:203], a[176:179], v[248:251]
  s_waitcnt lgkmcnt(4)
  v_mfma_f32_16x16x32_bf16 v[176:179], a[208:211], a[80:83], v[176:179]
  s_xor_b32 s30, s30, 16
  ds_read_b128 a[240:243], v120 offset:45056
  v_mfma_f32_16x16x32_bf16 v[176:179], a[212:215], a[84:87], v[176:179]
  buffer_load_dword v117, v122, s[32:35], s30 offen sc1
  v_mfma_f32_16x16x32_bf16 v[180:183], a[212:215], a[92:95], v[180:183]
  s_bfe_u32 s41, s78, 262164
  s_mul_i32 s41, s41, 262144
  s_add_u32 s41, s41, s85
  ds_read_b128 a[244:247], v120 offset:55296
  v_mfma_f32_16x16x32_bf16 v[180:183], a[208:211], a[88:91], v[180:183]
  buffer_load_dwordx4 a[112:115], v112, s[32:35], s41 offen offset:0 sc1
  v_mfma_f32_16x16x32_bf16 v[188:191], a[216:219], a[88:91], v[188:191]
  ds_read_b128 a[248:251], v120 offset:46080
  v_mfma_f32_16x16x32_bf16 v[188:191], a[220:223], a[92:95], v[188:191]
  v_mfma_f32_16x16x32_bf16 v[184:187], a[220:223], a[84:87], v[184:187]
  ds_read_b128 a[252:255], v120 offset:56320
  v_mfma_f32_16x16x32_bf16 v[184:187], a[216:219], a[80:83], v[184:187]
  s_waitcnt lgkmcnt(4)
  buffer_load_dwordx4 a[116:119], v112, s[32:35], s41 offen offset:1024 sc1
  v_mfma_f32_16x16x32_bf16 v[192:195], a[224:227], a[80:83], v[192:195]
  ds_read_b128 a[192:195], v120 offset:47104
  v_mfma_f32_16x16x32_bf16 v[192:195], a[228:231], a[84:87], v[192:195]
  buffer_load_dwordx4 a[120:123], v113, s[32:35], s41 offen offset:0 sc1
  v_mfma_f32_16x16x32_bf16 v[196:199], a[228:231], a[92:95], v[196:199]
  ds_read_b128 a[196:199], v120 offset:57344
  v_mfma_f32_16x16x32_bf16 v[196:199], a[224:227], a[88:91], v[196:199]
  buffer_load_dwordx4 a[124:127], v113, s[32:35], s41 offen offset:1024 sc1
  v_mfma_f32_16x16x32_bf16 v[204:207], a[232:235], a[88:91], v[204:207]
  ds_read_b128 a[200:203], v120 offset:48128
  v_mfma_f32_16x16x32_bf16 v[204:207], a[236:239], a[92:95], v[204:207]
  v_mfma_f32_16x16x32_bf16 v[200:203], a[236:239], a[84:87], v[200:203]
  s_add_u32 m0, s42, 143360
  ds_read_b128 a[204:207], v120 offset:58368
  v_mfma_f32_16x16x32_bf16 v[200:203], a[232:235], a[80:83], v[200:203]
  s_waitcnt lgkmcnt(4)
  v_mfma_f32_16x16x32_bf16 v[208:211], a[240:243], a[80:83], v[208:211]
  s_bfe_u32 s40, s78, 262168
  s_mul_i32 s40, s40, 81920
  s_add_u32 s40, s40, s84
  ds_read_b128 a[208:211], v120 offset:49152
  v_mfma_f32_16x16x32_bf16 v[208:211], a[244:247], a[84:87], v[208:211]
  buffer_load_dwordx4 v3, s[52:55], s40 offen offset:0 sc1 lds
  v_mfma_f32_16x16x32_bf16 v[212:215], a[244:247], a[92:95], v[212:215]
  ds_read_b128 a[212:215], v120 offset:59392
  v_mfma_f32_16x16x32_bf16 v[212:215], a[240:243], a[88:91], v[212:215]
  v_mfma_f32_16x16x32_bf16 v[220:223], a[248:251], a[88:91], v[220:223]
  ds_read_b128 a[216:219], v120 offset:50176
  v_mfma_f32_16x16x32_bf16 v[220:223], a[252:255], a[92:95], v[220:223]
  buffer_load_dwordx4 v3, s[52:55], s40 offen offset:1024 sc1 lds
  v_mfma_f32_16x16x32_bf16 v[216:219], a[252:255], a[84:87], v[216:219]
  ds_read_b128 a[220:223], v120 offset:60416
  v_mfma_f32_16x16x32_bf16 v[216:219], a[248:251], a[80:83], v[216:219]
  s_waitcnt lgkmcnt(4)
  v_mfma_f32_16x16x32_bf16 v[224:227], a[192:195], a[80:83], v[224:227]
  v_mfma_f32_16x16x32_bf16 v[224:227], a[196:199], a[84:87], v[224:227]
  buffer_load_dwordx4 v3, s[52:55], s40 offen offset:2048 sc1 lds
  v_mfma_f32_16x16x32_bf16 v[228:231], a[196:199], a[92:95], v[228:231]
  v_mfma_f32_16x16x32_bf16 v[228:231], a[192:195], a[88:91], v[228:231]
  s_waitcnt vmcnt(14)
  s_waitcnt lgkmcnt(0)
  s_barrier
  v_mfma_f32_16x16x32_bf16 v[236:239], a[200:203], a[88:91], v[236:239]
  ds_read_b128 a[224:227], v120 offset:20480
  v_mfma_f32_16x16x32_bf16 v[236:239], a[204:207], a[92:95], v[236:239]
  ds_read_b128 a[228:231], v120 offset:30720
  v_mfma_f32_16x16x32_bf16 v[232:235], a[204:207], a[84:87], v[232:235]
  ds_read_b128 a[232:235], v120 offset:21504
  v_mfma_f32_16x16x32_bf16 v[232:235], a[200:203], a[80:83], v[232:235]
  ds_read_b128 a[236:239], v120 offset:31744
  v_mfma_f32_16x16x32_bf16 v[240:243], a[208:211], a[80:83], v[240:243]
  ds_read_b128 a[240:243], v120 offset:22528
  v_mfma_f32_16x16x32_bf16 v[240:243], a[212:215], a[84:87], v[240:243]
  buffer_load_dwordx4 v3, s[52:55], s40 offen offset:3072 sc1 lds
  v_mfma_f32_16x16x32_bf16 v[244:247], a[212:215], a[92:95], v[244:247]
  s_add_u32 m0, s42, 147456
  s_add_u32 s40, s40, 4096
  ds_read_b128 a[244:247], v120 offset:32768
  v_mfma_f32_16x16x32_bf16 v[244:247], a[208:211], a[88:91], v[244:247]
  buffer_load_dwordx4 v3, s[52:55], s40 offen offset:0 sc1 lds
  v_mfma_f32_16x16x32_bf16 v[252:255], a[216:219], a[88:91], v[252:255]
  s_add_u32 m0, s42, 0
  s_bfe_u32 s40, s78, 262172
  s_mul_i32 s40, s40, 81920
  s_add_u32 s40, s40, s84
  ds_read_b128 a[248:251], v120 offset:23552
  v_mfma_f32_16x16x32_bf16 v[252:255], a[220:223], a[92:95], v[252:255]
  s_waitcnt vmcnt(12)
  buffer_load_dwordx4 v3, s[52:55], s40 offen offset:0 sc1 lds
  v_mfma_f32_16x16x32_bf16 v[248:251], a[220:223], a[84:87], v[248:251]
  ds_read_b128 a[252:255], v120 offset:33792
  v_mfma_f32_16x16x32_bf16 v[248:251], a[216:219], a[80:83], v[248:251]
  s_waitcnt lgkmcnt(4)
  s_waitcnt vmcnt(10)
  v_cmp_ne_u32 vcc, 1, v117
  s_nop 1
  s_cbranch_vccnz L_ox_0
L_ox_ok_0:
  v_mfma_f32_16x16x32_bf16 v[176:179], a[224:227], a[96:99], v[176:179]
  ds_read_b128 a[192:195], v120 offset:24576
  v_mfma_f32_16x16x32_bf16 v[176:179], a[228:231], a[100:103], v[176:179]
  buffer_load_dwordx4 v3, s[52:55], s40 offen offset:1024 sc1 lds
  v_mfma_f32_16x16x32_bf16 v[180:183], a[228:231], a[108:111], v[180:183]
  ds_read_b128 a[196:199], v120 offset:34816
  v_mfma_f32_16x16x32_bf16 v[180:183], a[224:227], a[104:107], v[180:183]
  buffer_load_dwordx4 v3, s[52:55], s40 offen offset:2048 sc1 lds
  v_mfma_f32_16x16x32_bf16 v[188:191], a[232:235], a[104:107], v[188:191]
  ds_read_b128 a[200:203], v120 offset:25600
  v_mfma_f32_16x16x32_bf16 v[188:191], a[236:239], a[108:111], v[188:191]
  buffer_load_dwordx4 v3, s[52:55], s40 offen offset:3072 sc1 lds
  v_mfma_f32_16x16x32_bf16 v[184:187], a[236:239], a[100:103], v[184:187]
  s_add_u32 m0, s42, 4096
  s_add_u32 s40, s40, 4096
  ds_read_b128 a[204:207], v120 offset:35840
  v_mfma_f32_16x16x32_bf16 v[184:187], a[232:235], a[96:99], v[184:187]
  s_waitcnt lgkmcnt(4)
  buffer_load_dwordx4 v3, s[52:55], s40 offen offset:0 sc1 lds
  v_mfma_f32_16x16x32_bf16 v[192:195], a[240:243], a[96:99], v[192:195]
  s_xor_b32 s3, s97, 44032
  ds_read_b128 a[208:211], v120 offset:26624
  v_mfma_f32_16x16x32_bf16 v[192:195], a[244:247], a[100:103], v[192:195]
  buffer_store_dwordx4 v[60:63], v3, s[32:35], s3 offen offset:1024 sc1
  v_mfma_f32_16x16x32_bf16 v[196:199], a[244:247], a[108:111], v[196:199]
  s_bfe_u32 s41, s78, 262168
  s_mul_i32 s41, s41, 262144
  s_add_u32 s41, s41, s85
  ds_read_b128 a[212:215], v120 offset:36864
  v_mfma_f32_16x16x32_bf16 v[196:199], a[240:243], a[104:107], v[196:199]
  buffer_load_dwordx4 a[128:131], v112, s[32:35], s41 offen offset:0 sc1
  v_mfma_f32_16x16x32_bf16 v[204:207], a[248:251], a[104:107], v[204:207]
  ds_read_b128 a[216:219], v120 offset:27648
  v_mfma_f32_16x16x32_bf16 v[204:207], a[252:255], a[108:111], v[204:207]
  buffer_load_dwordx4 a[132:135], v112, s[32:35], s41 offen offset:1024 sc1
  v_mfma_f32_16x16x32_bf16 v[200:203], a[252:255], a[100:103], v[200:203]
  ds_read_b128 a[220:223], v120 offset:37888
  v_mfma_f32_16x16x32_bf16 v[200:203], a[248:251], a[96:99], v[200:203]
  s_waitcnt lgkmcnt(4)
  buffer_load_dwordx4 a[136:139], v113, s[32:35], s41 offen offset:0 sc1
  v_mfma_f32_16x16x32_bf16 v[208:211], a[192:195], a[96:99], v[208:211]
  ds_read_b128 a[224:227], v120 offset:28672
  v_mfma_f32_16x16x32_bf16 v[208:211], a[196:199], a[100:103], v[208:211]
  buffer_load_dwordx4 a[140:143], v113, s[32:35], s41 offen offset:1024 sc1
  v_mfma_f32_16x16x32_bf16 v[212:215], a[196:199], a[108:111], v[212:215]
  ds_read_b128 a[228:231], v120 offset:38912
  v_mfma_f32_16x16x32_bf16 v[212:215], a[192:195], a[104:107], v[212:215]
  v_mfma_f32_16x16x32_bf16 v[220:223], a[200:203], a[104:107], v[220:223]
  ds_read_b128 a[232:235], v120 offset:29696
  v_mfma_f32_16x16x32_bf16 v[220:223], a[204:207], a[108:111], v[220:223]
  v_mfma_f32_16x16x32_bf16 v[216:219], a[204:207], a[100:103], v[216:219]
  s_bfe_u32 s41, s78, 262172
  s_mul_i32 s41, s41, 262144
  s_add_u32 s41, s41, s85
  ds_read_b128 a[236:239], v120 offset:39936
  v_mfma_f32_16x16x32_bf16 v[216:219], a[200:203], a[96:99], v[216:219]
  s_waitcnt lgkmcnt(4)
  buffer_load_dwordx4 a[144:147], v112, s[32:35], s41 offen offset:0 sc1
  v_mfma_f32_16x16x32_bf16 v[224:227], a[208:211], a[96:99], v[224:227]
  ds_read_b128 a[240:243], v120 offset:0
  v_mfma_f32_16x16x32_bf16 v[224:227], a[212:215], a[100:103], v[224:227]
  v_mfma_f32_16x16x32_bf16 v[228:231], a[212:215], a[108:111], v[228:231]
  ds_read_b128 a[244:247], v120 offset:10240
  v_mfma_f32_16x16x32_bf16 v[228:231], a[208:211], a[104:107], v[228:231]
  buffer_load_dwordx4 a[148:151], v112, s[32:35], s41 offen offset:1024 sc1
  v_mfma_f32_16x16x32_bf16 v[236:239], a[216:219], a[104:107], v[236:239]
  ds_read_b128 a[248:251], v120 offset:1024
  v_mfma_f32_16x16x32_bf16 v[236:239], a[220:223], a[108:111], v[236:239]
  v_mfma_f32_16x16x32_bf16 v[232:235], a[220:223], a[100:103], v[232:235]
  ds_read_b128 a[252:255], v120 offset:11264
  v_mfma_f32_16x16x32_bf16 v[232:235], a[216:219], a[96:99], v[232:235]
  s_waitcnt lgkmcnt(4)
  buffer_load_dwordx4 a[152:155], v113, s[32:35], s41 offen offset:0 sc1
  v_mfma_f32_16x16x32_bf16 v[240:243], a[224:227], a[96:99], v[240:243]
  ds_read_b128 a[192:195], v120 offset:2048
  v_mfma_f32_16x16x32_bf16 v[240:243], a[228:231], a[100:103], v[240:243]
  v_mfma_f32_16x16x32_bf16 v[244:247], a[228:231], a[108:111], v[244:247]
  ds_read_b128 a[196:199], v120 offset:12288
  v_mfma_f32_16x16x32_bf16 v[244:247], a[224:227], a[104:107], v[244:247]
  buffer_load_dwordx4 a[156:159], v113, s[32:35], s41 offen offset:1024 sc1
  v_mfma_f32_16x16x32_bf16 v[252:255], a[232:235], a[104:107], v[252:255]
  s_add_u32 m0, s42, 20480
  ds_read_b128 a[200:203], v120 offset:3072
  v_mfma_f32_16x16x32_bf16 v[252:255], a[236:239], a[108:111], v[252:255]
  s_waitcnt vmcnt(19)
  v_mfma_f32_16x16x32_bf16 v[248:251], a[236:239], a[100:103], v[248:251]
  s_bfe_u32 s40, s79, 262144
  s_mul_i32 s40, s40, 81920
  s_add_u32 s40, s40, s84
  ds_read_b128 a[204:207], v120 offset:13312
  v_mfma_f32_16x16x32_bf16 v[248:251], a[232:235], a[96:99], v[248:251]
  s_waitcnt lgkmcnt(4)
  buffer_load_dwordx4 v3, s[52:55], s40 offen offset:0 sc1 lds
  v_mfma_f32_16x16x32_bf16 v[176:179], a[240:243], a[112:115], v[176:179]
  ds_read_b128 a[208:211], v120 offset:4096
  v_mfma_f32_16x16x32_bf16 v[176:179], a[244:247], a[116:119], v[176:179]
  v_mfma_f32_16x16x32_bf16 v[180:183], a[244:247], a[124:127], v[180:183]
  ds_read_b128 a[212:215], v120 offset:14336
  v_mfma_f32_16x16x32_bf16 v[180:183], a[240:243], a[120:123], v[180:183]
  v_mfma_f32_16x16x32_bf16 v[188:191], a[248:251], a[120:123], v[188:191]
  ds_read_b128 a[216:219], v120 offset:5120
  v_mfma_f32_16x16x32_bf16 v[188:191], a[252:255], a[124:127], v[188:191]
  buffer_load_dwordx4 v3, s[52:55], s40 offen offset:1024 sc1 lds
  v_mfma_f32_16x16x32_bf16 v[184:187], a[252:255], a[116:119], v[184:187]
  ds_read_b128 a[220:223], v120 offset:15360
  v_mfma_f32_16x16x32_bf16 v[184:187], a[248:251], a[112:115], v[184:187]
  s_waitcnt lgkmcnt(4)
  v_mfma_f32_16x16x32_bf16 v[192:195], a[192:195], a[112:115], v[192:195]
  ds_read_b128 a[224:227], v120 offset:6144
  v_mfma_f32_16x16x32_bf16 v[192:195], a[196:199], a[116:119], v[192:195]
  buffer_load_dwordx4 v3, s[52:55], s40 offen offset:2048 sc1 lds
  v_mfma_f32_16x16x32_bf16 v[196:199], a[196:199], a[124:127], v[196:199]
  ds_read_b128 a[228:231], v120 offset:16384
  v_mfma_f32_16x16x32_bf16 v[196:199], a[192:195], a[120:123], v[196:199]
  v_mfma_f32_16x16x32_bf16 v[204:207], a[200:203], a[120:123], v[204:207]
  ds_read_b128 a[232:235], v120 offset:7168
  v_mfma_f32_16x16x32_bf16 v[204:207], a[204:207], a[124:127], v[204:207]
  buffer_load_dwordx4 v3, s[52:55], s40 offen offset:3072 sc1 lds
  v_mfma_f32_16x16x32_bf16 v[200:203], a[204:207], a[116:119], v[200:203]
  s_add_u32 m0, s42, 24576
  ds_read_b128 a[236:239], v120 offset:17408
  v_mfma_f32_16x16x32_bf16 v[200:203], a[200:203], a[112:115], v[200:203]
  s_waitcnt lgkmcnt(4)
  v_mfma_f32_16x16x32_bf16 v[208:211], a[208:211], a[112:115], v[208:211]
  s_add_u32 s40, s40, 4096
  ds_read_b128 a[240:243], v120 offset:8192
  v_mfma_f32_16x16x32_bf16 v[208:211], a[212:215], a[116:119], v[208:211]
  buffer_load_dwordx4 v3, s[52:55], s40 offen offset:0 sc1 lds
  v_mfma_f32_16x16x32_bf16 v[212:215], a[212:215], a[124:127], v[212:215]
  s_add_u32 m0, s42, 122880
  ds_read_b128 a[244:247], v120 offset:18432
  v_mfma_f32_16x16x32_bf16 v[212:215], a[208:211], a[120:123], v[212:215]
  v_mfma_f32_16x16x32_bf16 v[220:223], a[216:219], a[120:123], v[220:223]
  s_bfe_u32 s40, s79, 262148
  s_mul_i32 s40, s40, 81920
  s_add_u32 s40, s40, s84
  ds_read_b128 a[248:251], v120 offset:9216
  v_mfma_f32_16x16x32_bf16 v[220:223], a[220:223], a[124:127], v[220:223]
  buffer_load_dwordx4 v3, s[52:55], s40 offen offset:0 sc1 lds
  v_mfma_f32_16x16x32_bf16 v[216:219], a[220:223], a[116:119], v[216:219]
  ds_read_b128 a[252:255], v120 offset:19456
  v_mfma_f32_16x16x32_bf16 v[216:219], a[216:219], a[112:115], v[216:219]
  s_waitcnt lgkmcnt(4)
  v_mfma_f32_16x16x32_bf16 v[224:227], a[224:227], a[112:115], v[224:227]
  v_mfma_f32_16x16x32_bf16 v[224:227], a[228:231], a[116:119], v[224:227]
  v_mfma_f32_16x16x32_bf16 v[228:231], a[228:231], a[124:127], v[228:231]
  buffer_load_dwordx4 v3, s[52:55], s40 offen offset:1024 sc1 lds
  v_mfma_f32_16x16x32_bf16 v[228:231], a[224:227], a[120:123], v[228:231]
  s_waitcnt vmcnt(16)
  s_waitcnt lgkmcnt(0)
  s_barrier
  v_mfma_f32_16x16x32_bf16 v[236:239], a[232:235], a[120:123], v[236:239]
  ds_read_b128 a[192:195], v121 offset:20480
  v_mfma_f32_16x16x32_bf16 v[236:239], a[236:239], a[124:127], v[236:239]
  ds_read_b128 a[196:199], v121 offset:30720
  v_mfma_f32_16x16x32_bf16 v[232:235], a[236:239], a[116:119], v[232:235]
  ds_read_b128 a[200:203], v121 offset:21504
  v_mfma_f32_16x16x32_bf16 v[232:235], a[232:235], a[112:115], v[232:235]
  ds_read_b128 a[204:207], v121 offset:31744
  v_mfma_f32_16x16x32_bf16 v[240:243], a[240:243], a[112:115], v[240:243]
  ds_read_b128 a[208:211], v121 offset:22528
  v_mfma_f32_16x16x32_bf16 v[240:243], a[244:247], a[116:119], v[240:243]
  buffer_load_dwordx4 v3, s[52:55], s40 offen offset:2048 sc1 lds
  v_mfma_f32_16x16x32_bf16 v[244:247], a[244:247], a[124:127], v[244:247]
  ds_read_b128 a[212:215], v121 offset:32768
  v_mfma_f32_16x16x32_bf16 v[244:247], a[240:243], a[120:123], v[244:247]
  buffer_load_dwordx4 v3, s[52:55], s40 offen offset:3072 sc1 lds
  v_mfma_f32_16x16x32_bf16 v[252:255], a[248:251], a[120:123], v[252:255]
  s_add_u32 m0, s42, 126976
  s_add_u32 s40, s40, 4096
  ds_read_b128 a[216:219], v121 offset:23552
  v_mfma_f32_16x16x32_bf16 v[252:255], a[252:255], a[124:127], v[252:255]
  s_waitcnt vmcnt(13)
  buffer_load_dwordx4 v3, s[52:55], s40 offen offset:0 sc1 lds
  v_mfma_f32_16x16x32_bf16 v[248:251], a[252:255], a[116:119], v[248:251]
  ds_read_b128 a[220:223], v121 offset:33792
  v_mfma_f32_16x16x32_bf16 v[248:251], a[248:251], a[112:115], v[248:251]
  s_waitcnt lgkmcnt(4)
  v_mfma_f32_16x16x32_bf16 v[176:179], a[192:195], a[128:131], v[176:179]
  s_xor_b32 s3, s97, 55808
  ds_read_b128 a[224:227], v121 offset:24576
  v_mfma_f32_16x16x32_bf16 v[176:179], a[196:199], a[132:135], v[176:179]
  buffer_store_dwordx2 v[64:65], v114, s[32:35], s3 offen offset:2048 sc1
  v_mfma_f32_16x16x32_bf16 v[180:183], a[196:199], a[140:143], v[180:183]
  ds_read_b128 a[228:231], v121 offset:34816
  v_mfma_f32_16x16x32_bf16 v[180:183], a[192:195], a[136:139], v[180:183]
  v_mfma_f32_16x16x32_bf16 v[188:191], a[200:203], a[136:139], v[188:191]
  ds_read_b128 a[232:235], v121 offset:25600
  v_mfma_f32_16x16x32_bf16 v[188:191], a[204:207], a[140:143], v[188:191]
  v_mfma_f32_16x16x32_bf16 v[184:187], a[204:207], a[132:135], v[184:187]
  s_bfe_u32 s41, s79, 262144
  s_mul_i32 s41, s41, 262144
  s_add_u32 s41, s41, s85
  ds_read_b128 a[236:239], v121 offset:35840
  v_mfma_f32_16x16x32_bf16 v[184:187], a[200:203], a[128:131], v[184:187]
  s_waitcnt lgkmcnt(4)
  buffer_load_dwordx4 a[160:163], v112, s[32:35], s41 offen offset:0 sc1
  v_mfma_f32_16x16x32_bf16 v[192:195], a[208:211], a[128:131], v[192:195]
  ds_read_b128 a[240:243], v121 offset:26624
  v_mfma_f32_16x16x32_bf16 v[192:195], a[212:215], a[132:135], v[192:195]
  buffer_load_dwordx4 a[164:167], v112, s[32:35], s41 offen offset:1024 sc1
  v_mfma_f32_16x16x32_bf16 v[196:199], a[212:215], a[140:143], v[196:199]
  ds_read_b128 a[244:247], v121 offset:36864
  v_mfma_f32_16x16x32_bf16 v[196:199], a[208:211], a[136:139], v[196:199]
  buffer_load_dwordx4 a[168:171], v113, s[32:35], s41 offen offset:0 sc1
  v_mfma_f32_16x16x32_bf16 v[204:207], a[216:219], a[136:139], v[204:207]
  ds_read_b128 a[248:251], v121 offset:27648
  v_mfma_f32_16x16x32_bf16 v[204:207], a[220:223], a[140:143], v[204:207]
  buffer_load_dwordx4 a[172:175], v113, s[32:35], s41 offen offset:1024 sc1
  v_mfma_f32_16x16x32_bf16 v[200:203], a[220:223], a[132:135], v[200:203]
  s_xor_b32 s3, s97, 22016
  ds_read_b128 a[252:255], v121 offset:37888
  v_mfma_f32_16x16x32_bf16 v[200:203], a[216:219], a[128:131], v[200:203]
  s_waitcnt lgkmcnt(4)
  buffer_store_dwordx2 v[66:67], v114, s[32:35], s3 offen offset:2048 sc1
  v_mfma_f32_16x16x32_bf16 v[208:211], a[224:227], a[128:131], v[208:211]
  s_xor_b32 s3, s97, 38912
  ds_read_b128 a[192:195], v121 offset:28672
  v_mfma_f32_16x16x32_bf16 v[208:211], a[228:231], a[132:135], v[208:211]
  buffer_store_dwordx2 v[68:69], v114, s[32:35], s3 offen offset:2048 sc1
  v_mfma_f32_16x16x32_bf16 v[212:215], a[228:231], a[140:143], v[212:215]
  ds_read_b128 a[196:199], v121 offset:38912
  v_mfma_f32_16x16x32_bf16 v[212:215], a[224:227], a[136:139], v[212:215]
  v_mfma_f32_16x16x32_bf16 v[220:223], a[232:235], a[136:139], v[220:223]
  ds_read_b128 a[200:203], v121 offset:29696
  v_mfma_f32_16x16x32_bf16 v[220:223], a[236:239], a[140:143], v[220:223]
  v_mfma_f32_16x16x32_bf16 v[216:219], a[236:239], a[132:135], v[216:219]
  ds_read_b128 a[204:207], v121 offset:39936
  v_mfma_f32_16x16x32_bf16 v[216:219], a[232:235], a[128:131], v[216:219]
  s_waitcnt lgkmcnt(4)
  v_mfma_f32_16x16x32_bf16 v[224:227], a[240:243], a[128:131], v[224:227]
  s_bfe_u32 s41, s79, 262148
  s_mul_i32 s41, s41, 262144
  s_add_u32 s41, s41, s85
  ds_read_b128 a[208:211], v119 offset:0
  v_mfma_f32_16x16x32_bf16 v[224:227], a[244:247], a[132:135], v[224:227]
  buffer_load_dwordx4 a[176:179], v112, s[32:35], s41 offen offset:0 sc1
  v_mfma_f32_16x16x32_bf16 v[228:231], a[244:247], a[140:143], v[228:231]
  ds_read_b128 a[212:215], v119 offset:10240
  v_mfma_f32_16x16x32_bf16 v[228:231], a[240:243], a[136:139], v[228:231]
  v_mfma_f32_16x16x32_bf16 v[236:239], a[248:251], a[136:139], v[236:239]
  ds_read_b128 a[216:219], v119 offset:1024
  v_mfma_f32_16x16x32_bf16 v[236:239], a[252:255], a[140:143], v[236:239]
  buffer_load_dwordx4 a[180:183], v112, s[32:35], s41 offen offset:1024 sc1
  v_mfma_f32_16x16x32_bf16 v[232:235], a[252:255], a[132:135], v[232:235]
  ds_read_b128 a[220:223], v119 offset:11264
  v_mfma_f32_16x16x32_bf16 v[232:235], a[248:251], a[128:131], v[232:235]
  s_waitcnt lgkmcnt(4)
  v_mfma_f32_16x16x32_bf16 v[240:243], a[192:195], a[128:131], v[240:243]
  ds_read_b128 a[224:227], v119 offset:2048
  v_mfma_f32_16x16x32_bf16 v[240:243], a[196:199], a[132:135], v[240:243]
  v_mfma_f32_16x16x32_bf16 v[244:247], a[196:199], a[140:143], v[244:247]
  ds_read_b128 a[228:231], v119 offset:12288
  v_mfma_f32_16x16x32_bf16 v[244:247], a[192:195], a[136:139], v[244:247]
  buffer_load_dwordx4 a[184:187], v113, s[32:35], s41 offen offset:0 sc1
  v_mfma_f32_16x16x32_bf16 v[252:255], a[200:203], a[136:139], v[252:255]
  ds_read_b128 a[232:235], v119 offset:3072
  v_mfma_f32_16x16x32_bf16 v[252:255], a[204:207], a[140:143], v[252:255]
  s_waitcnt vmcnt(20)
  v_mfma_f32_16x16x32_bf16 v[248:251], a[204:207], a[132:135], v[248:251]
  ds_read_b128 a[236:239], v119 offset:13312
  v_mfma_f32_16x16x32_bf16 v[248:251], a[200:203], a[128:131], v[248:251]
  s_waitcnt lgkmcnt(4)
  buffer_load_dwordx4 a[188:191], v113, s[32:35], s41 offen offset:1024 sc1
  v_mfma_f32_16x16x32_bf16 v[176:179], a[208:211], a[144:147], v[176:179]
  s_add_u32 m0, s42, 40960
  ds_read_b128 a[240:243], v119 offset:4096
  v_mfma_f32_16x16x32_bf16 v[176:179], a[212:215], a[148:151], v[176:179]
  v_mfma_f32_16x16x32_bf16 v[180:183], a[212:215], a[156:159], v[180:183]
  s_bfe_u32 s40, s79, 262152
  s_mul_i32 s40, s40, 81920
  s_add_u32 s40, s40, s84
  ds_read_b128 a[244:247], v119 offset:14336
  v_mfma_f32_16x16x32_bf16 v[180:183], a[208:211], a[152:155], v[180:183]
  buffer_load_dwordx4 v3, s[52:55], s40 offen offset:0 sc1 lds
  v_mfma_f32_16x16x32_bf16 v[188:191], a[216:219], a[152:155], v[188:191]
  ds_read_b128 a[248:251], v119 offset:5120
  v_mfma_f32_16x16x32_bf16 v[188:191], a[220:223], a[156:159], v[188:191]
  v_mfma_f32_16x16x32_bf16 v[184:187], a[220:223], a[148:151], v[184:187]
  ds_read_b128 a[252:255], v119 offset:15360
  v_mfma_f32_16x16x32_bf16 v[184:187], a[216:219], a[144:147], v[184:187]
  s_waitcnt lgkmcnt(4)
  buffer_load_dwordx4 v3, s[52:55], s40 offen offset:1024 sc1 lds
  v_mfma_f32_16x16x32_bf16 v[192:195], a[224:227], a[144:147], v[192:195]
  ds_read_b128 a[192:195], v119 offset:6144
  v_mfma_f32_16x16x32_bf16 v[192:195], a[228:231], a[148:151], v[192:195]
  v_mfma_f32_16x16x32_bf16 v[196:199], a[228:231], a[156:159], v[196:199]
  ds_read_b128 a[196:199], v119 offset:16384
  v_mfma_f32_16x16x32_bf16 v[196:199], a[224:227], a[152:155], v[196:199]
  buffer_load_dwordx4 v3, s[52:55], s40 offen offset:2048 sc1 lds
  v_mfma_f32_16x16x32_bf16 v[204:207], a[232:235], a[152:155], v[204:207]
  ds_read_b128 a[200:203], v119 offset:7168
  v_mfma_f32_16x16x32_bf16 v[204:207], a[236:239], a[156:159], v[204:207]
  v_mfma_f32_16x16x32_bf16 v[200:203], a[236:239], a[148:151], v[200:203]
  ds_read_b128 a[204:207], v119 offset:17408
  v_mfma_f32_16x16x32_bf16 v[200:203], a[232:235], a[144:147], v[200:203]
  s_waitcnt lgkmcnt(4)
  v_mfma_f32_16x16x32_bf16 v[208:211], a[240:243], a[144:147], v[208:211]
  ds_read_b128 a[208:211], v119 offset:8192
  v_mfma_f32_16x16x32_bf16 v[208:211], a[244:247], a[148:151], v[208:211]
  buffer_load_dwordx4 v3, s[52:55], s40 offen offset:3072 sc1 lds
  v_mfma_f32_16x16x32_bf16 v[212:215], a[244:247], a[156:159], v[212:215]
  s_add_u32 m0, s42, 45056
  ds_read_b128 a[212:215], v119 offset:18432
  v_mfma_f32_16x16x32_bf16 v[212:215], a[240:243], a[152:155], v[212:215]
  v_mfma_f32_16x16x32_bf16 v[220:223], a[248:251], a[152:155], v[220:223]
  s_add_u32 s40, s40, 4096
  ds_read_b128 a[216:219], v119 offset:9216
  v_mfma_f32_16x16x32_bf16 v[220:223], a[252:255], a[156:159], v[220:223]
  buffer_load_dwordx4 v3, s[52:55], s40 offen offset:0 sc1 lds
  v_mfma_f32_16x16x32_bf16 v[216:219], a[252:255], a[148:151], v[216:219]
  s_add_u32 m0, s42, 102400
  ds_read_b128 a[220:223], v119 offset:19456
  v_mfma_f32_16x16x32_bf16 v[216:219], a[248:251], a[144:147], v[216:219]
  s_waitcnt lgkmcnt(4)
  s_bfe_u32 s40, s79, 262156
  s_mul_i32 s40, s40, 81920
  s_add_u32 s40, s40, s84
  v_mfma_f32_16x16x32_bf16 v[224:227], a[192:195], a[144:147], v[224:227]
  buffer_load_dwordx4 v3, s[52:55], s40 offen offset:0 sc1 lds
  v_mfma_f32_16x16x32_bf16 v[224:227], a[196:199], a[148:151], v[224:227]
  v_mfma_f32_16x16x32_bf16 v[228:231], a[196:199], a[156:159], v[228:231]
  v_mfma_f32_16x16x32_bf16 v[228:231], a[192:195], a[152:155], v[228:231]
  s_waitcnt vmcnt(17)
  s_barrier
  v_mfma_f32_16x16x32_bf16 v[236:239], a[200:203], a[152:155], v[236:239]
  ds_read_b128 a[224:227], v119 offset:20480
  v_mfma_f32_16x16x32_bf16 v[236:239], a[204:207], a[156:159], v[236:239]
  ds_read_b128 a[228:231], v119 offset:30720
  v_mfma_f32_16x16x32_bf16 v[232:235], a[204:207], a[148:151], v[232:235]
  ds_read_b128 a[232:235], v119 offset:21504
  v_mfma_f32_16x16x32_bf16 v[232:235], a[200:203], a[144:147], v[232:235]
  s_waitcnt lgkmcnt(3)
  ds_read_b128 a[236:239], v119 offset:31744
  v_mfma_f32_16x16x32_bf16 v[240:243], a[208:211], a[144:147], v[240:243]
  ds_read_b128 a[240:243], v119 offset:22528
  v_mfma_f32_16x16x32_bf16 v[240:243], a[212:215], a[148:151], v[240:243]
  buffer_load_dwordx4 v3, s[52:55], s40 offen offset:1024 sc1 lds
  v_mfma_f32_16x16x32_bf16 v[244:247], a[212:215], a[156:159], v[244:247]
  ds_read_b128 a[244:247], v119 offset:32768
  v_mfma_f32_16x16x32_bf16 v[244:247], a[208:211], a[152:155], v[244:247]
  buffer_load_dwordx4 v3, s[52:55], s40 offen offset:2048 sc1 lds
  v_mfma_f32_16x16x32_bf16 v[252:255], a[216:219], a[152:155], v[252:255]
  ds_read_b128 a[248:251], v119 offset:23552
  v_mfma_f32_16x16x32_bf16 v[252:255], a[220:223], a[156:159], v[252:255]
  s_waitcnt vmcnt(14)
  buffer_load_dwordx4 v3, s[52:55], s40 offen offset:3072 sc1 lds
  v_mfma_f32_16x16x32_bf16 v[248:251], a[220:223], a[148:151], v[248:251]
  s_add_u32 m0, s42, 106496
  s_add_u32 s40, s40, 4096
  ds_read_b128 a[252:255], v119 offset:33792
  v_mfma_f32_16x16x32_bf16 v[248:251], a[216:219], a[144:147], v[248:251]
  s_waitcnt lgkmcnt(4)
  buffer_load_dwordx4 v3, s[52:55], s40 offen offset:0 sc1 lds
  v_mfma_f32_16x16x32_bf16 v[176:179], a[224:227], a[160:163], v[176:179]
  s_xor_b32 s3, s97, 5632
  ds_read_b128 a[192:195], v119 offset:24576
  v_mfma_f32_16x16x32_bf16 v[176:179], a[228:231], a[164:167], v[176:179]
  buffer_load_dwordx2 v[136:137], v114, s[32:35], s3 offen offset:2048 sc1
  v_mfma_f32_16x16x32_bf16 v[180:183], a[228:231], a[172:175], v[180:183]
  ds_read_b128 a[196:199], v119 offset:34816
  v_mfma_f32_16x16x32_bf16 v[180:183], a[224:227], a[168:171], v[180:183]
  v_mfma_f32_16x16x32_bf16 v[188:191], a[232:235], a[168:171], v[188:191]
  s_xor_b32 s3, s97, 6144
  ds_read_b128 a[200:203], v119 offset:25600
  v_mfma_f32_16x16x32_bf16 v[188:191], a[236:239], a[172:175], v[188:191]
  buffer_load_dwordx2 v[146:147], v114, s[32:35], s3 offen offset:2048 sc1
  v_mfma_f32_16x16x32_bf16 v[184:187], a[236:239], a[164:167], v[184:187]
  s_bfe_u32 s41, s79, 262152
  s_mul_i32 s41, s41, 262144
  s_add_u32 s41, s41, s85
  ds_read_b128 a[204:207], v119 offset:35840
  v_mfma_f32_16x16x32_bf16 v[184:187], a[232:235], a[160:163], v[184:187]
  s_waitcnt lgkmcnt(4)
  buffer_load_dwordx4 a[80:83], v112, s[32:35], s41 offen offset:0 sc1
  v_mfma_f32_16x16x32_bf16 v[192:195], a[240:243], a[160:163], v[192:195]
  ds_read_b128 a[208:211], v119 offset:26624
  v_mfma_f32_16x16x32_bf16 v[192:195], a[244:247], a[164:167], v[192:195]
  buffer_load_dwordx4 a[84:87], v112, s[32:35], s41 offen offset:1024 sc1
  v_mfma_f32_16x16x32_bf16 v[196:199], a[244:247], a[172:175], v[196:199]
L_pad_post02_1:
  s_cbranch_execz L_back1
  ds_read_b128 a[212:215], v119 offset:36864
  v_mfma_f32_16x16x32_bf16 v[196:199], a[240:243], a[168:171], v[196:199]
  buffer_load_dwordx4 a[88:91], v113, s[32:35], s41 offen offset:0 sc1
  v_mfma_f32_16x16x32_bf16 v[204:207], a[248:251], a[168:171], v[204:207]
  ds_read_b128 a[216:219], v119 offset:27648
  v_mfma_f32_16x16x32_bf16 v[204:207], a[252:255], a[172:175], v[204:207]
  buffer_load_dwordx4 a[92:95], v113, s[32:35], s41 offen offset:1024 sc1
  v_mfma_f32_16x16x32_bf16 v[200:203], a[252:255], a[164:167], v[200:203]
  s_xor_b32 s3, s97, 6656
  ds_read_b128 a[220:223], v119 offset:37888
  v_mfma_f32_16x16x32_bf16 v[200:203], a[248:251], a[160:163], v[200:203]
  s_waitcnt lgkmcnt(4)
  buffer_load_dwordx2 v[156:157], v114, s[32:35], s3 offen offset:2048 sc1
  v_mfma_f32_16x16x32_bf16 v[208:211], a[192:195], a[160:163], v[208:211]
  s_add_u32 m0, s42, 81920
  ds_read_b128 a[224:227], v119 offset:28672
  v_mfma_f32_16x16x32_bf16 v[208:211], a[196:199], a[164:167], v[208:211]
  v_mfma_f32_16x16x32_bf16 v[212:215], a[196:199], a[172:175], v[212:215]
  s_bfe_u32 s40, s79, 262160
  s_mul_i32 s40, s40, 81920
  s_add_u32 s40, s40, s84
  ds_read_b128 a[228:231], v119 offset:38912
  v_mfma_f32_16x16x32_bf16 v[212:215], a[192:195], a[168:171], v[212:215]
  buffer_load_dwordx4 v3, s[52:55], s40 offen offset:0 sc1 lds
  v_mfma_f32_16x16x32_bf16 v[220:223], a[200:203], a[168:171], v[220:223]
  ds_read_b128 a[232:235], v119 offset:29696
  v_mfma_f32_16x16x32_bf16 v[220:223], a[204:207], a[172:175], v[220:223]
  v_mfma_f32_16x16x32_bf16 v[216:219], a[204:207], a[164:167], v[216:219]
  ds_read_b128 a[236:239], v119 offset:39936
  v_mfma_f32_16x16x32_bf16 v[216:219], a[200:203], a[160:163], v[216:219]
  s_waitcnt lgkmcnt(4)
  buffer_load_dwordx4 v3, s[52:55], s40 offen offset:1024 sc1 lds
  v_mfma_f32_16x16x32_bf16 v[224:227], a[208:211], a[160:163], v[224:227]
  ds_read_b128 a[240:243], v121 offset:0
  v_mfma_f32_16x16x32_bf16 v[224:227], a[212:215], a[164:167], v[224:227]
  v_mfma_f32_16x16x32_bf16 v[228:231], a[212:215], a[172:175], v[228:231]
  ds_read_b128 a[244:247], v121 offset:10240
  v_mfma_f32_16x16x32_bf16 v[228:231], a[208:211], a[168:171], v[228:231]
  buffer_load_dwordx4 v3, s[52:55], s40 offen offset:2048 sc1 lds
  v_mfma_f32_16x16x32_bf16 v[236:239], a[216:219], a[168:171], v[236:239]
  ds_read_b128 a[248:251], v121 offset:1024
  v_mfma_f32_16x16x32_bf16 v[236:239], a[220:223], a[172:175], v[236:239]
  v_mfma_f32_16x16x32_bf16 v[232:235], a[220:223], a[164:167], v[232:235]
  ds_read_b128 a[252:255], v121 offset:11264
  v_mfma_f32_16x16x32_bf16 v[232:235], a[216:219], a[160:163], v[232:235]
  s_waitcnt lgkmcnt(4)
  buffer_load_dwordx4 v3, s[52:55], s40 offen offset:3072 sc1 lds
  v_mfma_f32_16x16x32_bf16 v[240:243], a[224:227], a[160:163], v[240:243]
  s_add_u32 m0, s42, 86016
  ds_read_b128 a[192:195], v121 offset:2048
  v_mfma_f32_16x16x32_bf16 v[240:243], a[228:231], a[164:167], v[240:243]
  v_mfma_f32_16x16x32_bf16 v[244:247], a[228:231], a[172:175], v[244:247]
  s_add_u32 s40, s40, 4096
  ds_read_b128 a[196:199], v121 offset:12288
  v_mfma_f32_16x16x32_bf16 v[244:247], a[224:227], a[168:171], v[244:247]
  buffer_load_dwordx4 v3, s[52:55], s40 offen offset:0 sc1 lds
  v_mfma_f32_16x16x32_bf16 v[252:255], a[232:235], a[168:171], v[252:255]
  s_add_u32 m0, s42, 61440
  s_bfe_u32 s40, s79, 262164
  s_mul_i32 s40, s40, 81920
  s_add_u32 s40, s40, s84
  ds_read_b128 a[200:203], v121 offset:3072
  v_mfma_f32_16x16x32_bf16 v[252:255], a[236:239], a[172:175], v[252:255]
  s_waitcnt vmcnt(22)
  buffer_load_dwordx4 v3, s[52:55], s40 offen offset:0 sc1 lds
  v_mfma_f32_16x16x32_bf16 v[248:251], a[236:239], a[164:167], v[248:251]
  ds_read_b128 a[204:207], v121 offset:13312
  v_mfma_f32_16x16x32_bf16 v[248:251], a[232:235], a[160:163], v[248:251]
  s_waitcnt lgkmcnt(4)
  buffer_load_dwordx4 v3, s[52:55], s40 offen offset:1024 sc1 lds
  v_mfma_f32_16x16x32_bf16 v[176:179], a[240:243], a[176:179], v[176:179]
  ds_read_b128 a[208:211], v121 offset:4096
  v_mfma_f32_16x16x32_bf16 v[176:179], a[244:247], a[180:183], v[176:179]
  buffer_load_dwordx4 v3, s[52:55], s40 offen offset:2048 sc1 lds
  v_mfma_f32_16x16x32_bf16 v[180:183], a[244:247], a[188:191], v[180:183]
  ds_read_b128 a[212:215], v121 offset:14336
  v_mfma_f32_16x16x32_bf16 v[180:183], a[240:243], a[184:187], v[180:183]
  buffer_load_dwordx4 v3, s[52:55], s40 offen offset:3072 sc1 lds
  v_mfma_f32_16x16x32_bf16 v[188:191], a[248:251], a[184:187], v[188:191]
  s_add_u32 m0, s42, 65536
  s_add_u32 s40, s40, 4096
  ds_read_b128 a[216:219], v121 offset:5120
  v_mfma_f32_16x16x32_bf16 v[188:191], a[252:255], a[188:191], v[188:191]
  buffer_load_dwordx4 v3, s[52:55], s40 offen offset:0 sc1 lds
  v_mfma_f32_16x16x32_bf16 v[184:187], a[252:255], a[180:183], v[184:187]
  s_bfe_u32 s41, s79, 262156
  s_mul_i32 s41, s41, 262144
  s_add_u32 s41, s41, s85
  ds_read_b128 a[220:223], v121 offset:15360
  v_mfma_f32_16x16x32_bf16 v[184:187], a[248:251], a[176:179], v[184:187]
  s_waitcnt lgkmcnt(4)
  buffer_load_dwordx4 a[96:99], v112, s[32:35], s41 offen offset:0 sc1
  v_mfma_f32_16x16x32_bf16 v[192:195], a[192:195], a[176:179], v[192:195]
  ds_read_b128 a[224:227], v121 offset:6144
  v_mfma_f32_16x16x32_bf16 v[192:195], a[196:199], a[180:183], v[192:195]
  buffer_load_dwordx4 a[100:103], v112, s[32:35], s41 offen offset:1024 sc1
  v_mfma_f32_16x16x32_bf16 v[196:199], a[196:199], a[188:191], v[196:199]
  ds_read_b128 a[228:231], v121 offset:16384
  v_mfma_f32_16x16x32_bf16 v[196:199], a[192:195], a[184:187], v[196:199]
  buffer_load_dwordx4 a[104:107], v113, s[32:35], s41 offen offset:0 sc1
  v_mfma_f32_16x16x32_bf16 v[204:207], a[200:203], a[184:187], v[204:207]
  ds_read_b128 a[232:235], v121 offset:7168
  v_mfma_f32_16x16x32_bf16 v[204:207], a[204:207], a[188:191], v[204:207]
  buffer_load_dwordx4 a[108:111], v113, s[32:35], s41 offen offset:1024 sc1
  v_mfma_f32_16x16x32_bf16 v[200:203], a[204:207], a[180:183], v[200:203]
  s_bfe_u32 s41, s79, 262160
  s_mul_i32 s41, s41, 262144
  s_add_u32 s41, s41, s85
  ds_read_b128 a[236:239], v121 offset:17408
  v_mfma_f32_16x16x32_bf16 v[200:203], a[200:203], a[176:179], v[200:203]
  s_waitcnt lgkmcnt(4)
  buffer_load_dwordx4 a[112:115], v112, s[32:35], s41 offen offset:0 sc1
  v_mfma_f32_16x16x32_bf16 v[208:211], a[208:211], a[176:179], v[208:211]
  ds_read_b128 a[240:243], v121 offset:8192
  v_mfma_f32_16x16x32_bf16 v[208:211], a[212:215], a[180:183], v[208:211]
  buffer_load_dwordx4 a[116:119], v112, s[32:35], s41 offen offset:1024 sc1
  v_mfma_f32_16x16x32_bf16 v[212:215], a[212:215], a[188:191], v[212:215]
  ds_read_b128 a[244:247], v121 offset:18432
  v_mfma_f32_16x16x32_bf16 v[212:215], a[208:211], a[184:187], v[212:215]
  buffer_load_dwordx4 a[120:123], v113, s[32:35], s41 offen offset:0 sc1
  v_mfma_f32_16x16x32_bf16 v[220:223], a[216:219], a[184:187], v[220:223]
  ds_read_b128 a[248:251], v121 offset:9216
  v_mfma_f32_16x16x32_bf16 v[220:223], a[220:223], a[188:191], v[220:223]
  buffer_load_dwordx4 a[124:127], v113, s[32:35], s41 offen offset:1024 sc1
  v_mfma_f32_16x16x32_bf16 v[216:219], a[220:223], a[180:183], v[216:219]
  s_bfe_u32 s41, s79, 262164
  s_mul_i32 s41, s41, 262144
  s_add_u32 s41, s41, s85
  ds_read_b128 a[252:255], v121 offset:19456
  v_mfma_f32_16x16x32_bf16 v[216:219], a[216:219], a[176:179], v[216:219]
  s_waitcnt lgkmcnt(4)
  buffer_load_dwordx4 a[128:131], v112, s[32:35], s41 offen offset:0 sc1
  v_mfma_f32_16x16x32_bf16 v[224:227], a[224:227], a[176:179], v[224:227]
  v_mfma_f32_16x16x32_bf16 v[224:227], a[228:231], a[180:183], v[224:227]
  buffer_load_dwordx4 a[132:135], v112, s[32:35], s41 offen offset:1024 sc1
  v_mfma_f32_16x16x32_bf16 v[228:231], a[228:231], a[188:191], v[228:231]
  v_mfma_f32_16x16x32_bf16 v[228:231], a[224:227], a[184:187], v[228:231]
  s_waitcnt vmcnt(27)
  s_barrier
  buffer_load_dwordx4 a[136:139], v113, s[32:35], s41 offen offset:0 sc1
  v_mfma_f32_16x16x32_bf16 v[236:239], a[232:235], a[184:187], v[236:239]
  ds_read_b128 a[192:195], v119 offset:40960
  v_mfma_f32_16x16x32_bf16 v[236:239], a[236:239], a[188:191], v[236:239]
  ds_read_b128 a[196:199], v119 offset:51200
  v_mfma_f32_16x16x32_bf16 v[232:235], a[236:239], a[180:183], v[232:235]
  ds_read_b128 a[200:203], v119 offset:41984
  v_mfma_f32_16x16x32_bf16 v[232:235], a[232:235], a[176:179], v[232:235]
  s_waitcnt lgkmcnt(3)
  ds_read_b128 a[204:207], v119 offset:52224
  v_mfma_f32_16x16x32_bf16 v[240:243], a[240:243], a[176:179], v[240:243]
  ds_read_b128 a[208:211], v119 offset:43008
  v_mfma_f32_16x16x32_bf16 v[240:243], a[244:247], a[180:183], v[240:243]
  buffer_load_dwordx4 a[140:143], v113, s[32:35], s41 offen offset:1024 sc1
  v_mfma_f32_16x16x32_bf16 v[244:247], a[244:247], a[188:191], v[244:247]
  ds_read_b128 a[212:215], v119 offset:53248
  v_mfma_f32_16x16x32_bf16 v[244:247], a[240:243], a[184:187], v[244:247]
  buffer_load_dwordx4 v[28:31], v38, s[20:23], s28 offen offset:0
  v_mfma_f32_16x16x32_bf16 v[252:255], a[248:251], a[184:187], v[252:255]
  ds_read_b128 a[216:219], v119 offset:44032
  v_mfma_f32_16x16x32_bf16 v[252:255], a[252:255], a[188:191], v[252:255]
  s_waitcnt vmcnt(24)
  buffer_load_dwordx4 v[32:35], v38, s[20:23], s28 offen offset:64
  v_mfma_f32_16x16x32_bf16 v[248:251], a[252:255], a[180:183], v[248:251]
  ds_read_b128 a[220:223], v119 offset:54272
  v_mfma_f32_16x16x32_bf16 v[248:251], a[248:251], a[176:179], v[248:251]
  s_waitcnt lgkmcnt(4)
  s_waitcnt vmcnt(24)
  v_max3_u32 v96, v136, v137, v146
  v_max3_u32 v96, v96, v147, v156
  v_max_u32 v96, v96, v157
  v_cmp_eq_u32 vcc, -1, v96
  s_nop 1
  s_cbranch_vccnz L_gw_0
L_gw_ok_0:
  v_mfma_f32_16x16x32_bf16 v[176:179], a[192:195], a[80:83], v[176:179]
  ds_read_b128 a[224:227], v119 offset:45056
  v_mfma_f32_16x16x32_bf16 v[176:179], a[196:199], a[84:87], v[176:179]
  buffer_load_dwordx2 v[36:37], v123, s[20:23], s28 offen offset:128
  v_mfma_f32_16x16x32_bf16 v[180:183], a[196:199], a[92:95], v[180:183]
  s_xor_b32 s3, s97, 9216
  ds_read_b128 a[228:231], v119 offset:55296
  v_mfma_f32_16x16x32_bf16 v[180:183], a[192:195], a[88:91], v[180:183]
  buffer_load_dwordx4 v[128:131], v3, s[32:35], s3 offen offset:0 sc1
  v_mfma_f32_16x16x32_bf16 v[188:191], a[200:203], a[88:91], v[188:191]
  ds_read_b128 a[232:235], v119 offset:46080
  v_mfma_f32_16x16x32_bf16 v[188:191], a[204:207], a[92:95], v[188:191]
  buffer_load_dwordx4 v[132:135], v3, s[32:35], s3 offen offset:1024 sc1
  v_mfma_f32_16x16x32_bf16 v[184:187], a[204:207], a[84:87], v[184:187]
  ds_read_b128 a[236:239], v119 offset:56320
  v_mfma_f32_16x16x32_bf16 v[184:187], a[200:203], a[80:83], v[184:187]
  s_waitcnt lgkmcnt(4)
  v_mfma_f32_16x16x32_bf16 v[192:195], a[208:211], a[80:83], v[192:195]
  s_xor_b32 s3, s97, 11264
  ds_read_b128 a[240:243], v119 offset:47104
  v_mfma_f32_16x16x32_bf16 v[192:195], a[212:215], a[84:87], v[192:195]
  buffer_load_dwordx4 v[138:141], v3, s[32:35], s3 offen offset:0 sc1
  v_mfma_f32_16x16x32_bf16 v[196:199], a[212:215], a[92:95], v[196:199]
  ds_read_b128 a[244:247], v119 offset:57344
  v_mfma_f32_16x16x32_bf16 v[196:199], a[208:211], a[88:91], v[196:199]
  v_mfma_f32_16x16x32_bf16 v[204:207], a[216:219], a[88:91], v[204:207]
  ds_read_b128 a[248:251], v119 offset:48128
  v_mfma_f32_16x16x32_bf16 v[204:207], a[220:223], a[92:95], v[204:207]
  buffer_load_dwordx4 v[142:145], v3, s[32:35], s3 offen offset:1024 sc1
  v_mfma_f32_16x16x32_bf16 v[200:203], a[220:223], a[84:87], v[200:203]
  ds_read_b128 a[252:255], v119 offset:58368
  v_mfma_f32_16x16x32_bf16 v[200:203], a[216:219], a[80:83], v[200:203]
  s_waitcnt lgkmcnt(4)
  v_mfma_f32_16x16x32_bf16 v[208:211], a[224:227], a[80:83], v[208:211]
  s_xor_b32 s3, s97, 13312
  ds_read_b128 a[192:195], v119 offset:49152
  v_mfma_f32_16x16x32_bf16 v[208:211], a[228:231], a[84:87], v[208:211]
  buffer_load_dwordx4 v[148:151], v3, s[32:35], s3 offen offset:0 sc1
  v_mfma_f32_16x16x32_bf16 v[212:215], a[228:231], a[92:95], v[212:215]
  ds_read_b128 a[196:199], v119 offset:59392
  v_mfma_f32_16x16x32_bf16 v[212:215], a[224:227], a[88:91], v[212:215]
  v_mfma_f32_16x16x32_bf16 v[220:223], a[232:235], a[88:91], v[220:223]
  ds_read_b128 a[200:203], v119 offset:50176
  v_mfma_f32_16x16x32_bf16 v[220:223], a[236:239], a[92:95], v[220:223]
  buffer_load_dwordx4 v[152:155], v3, s[32:35], s3 offen offset:1024 sc1
  v_mfma_f32_16x16x32_bf16 v[216:219], a[236:239], a[84:87], v[216:219]
  ds_read_b128 a[204:207], v119 offset:60416
  v_mfma_f32_16x16x32_bf16 v[216:219], a[232:235], a[80:83], v[216:219]
  s_waitcnt lgkmcnt(4)
  v_mfma_f32_16x16x32_bf16 v[224:227], a[240:243], a[80:83], v[224:227]
  v_mfma_f32_16x16x32_bf16 v[224:227], a[244:247], a[84:87], v[224:227]
  v_mfma_f32_16x16x32_bf16 v[228:231], a[244:247], a[92:95], v[228:231]
  v_mfma_f32_16x16x32_bf16 v[228:231], a[240:243], a[88:91], v[228:231]
  s_waitcnt vmcnt(21)
  s_barrier
  v_mfma_f32_16x16x32_bf16 v[236:239], a[248:251], a[88:91], v[236:239]
  ds_read_b128 a[208:211], v120 offset:46080
  v_mfma_f32_16x16x32_bf16 v[236:239], a[252:255], a[92:95], v[236:239]
  ds_read_b128 a[212:215], v120 offset:56320
  v_mfma_f32_16x16x32_bf16 v[232:235], a[252:255], a[84:87], v[232:235]
  ds_read_b128 a[216:219], v120 offset:25600
  v_mfma_f32_16x16x32_bf16 v[232:235], a[248:251], a[80:83], v[232:235]
  s_waitcnt lgkmcnt(3)
  ds_read_b128 a[220:223], v120 offset:35840
  v_mfma_f32_16x16x32_bf16 v[240:243], a[192:195], a[80:83], v[240:243]
  ds_read_b128 a[224:227], v120 offset:5120
  v_mfma_f32_16x16x32_bf16 v[240:243], a[196:199], a[84:87], v[240:243]
  v_mfma_f32_16x16x32_bf16 v[244:247], a[196:199], a[92:95], v[244:247]
  ds_read_b128 a[228:231], v120 offset:15360
  v_mfma_f32_16x16x32_bf16 v[244:247], a[192:195], a[88:91], v[244:247]
  v_mfma_f32_16x16x32_bf16 v[252:255], a[200:203], a[88:91], v[252:255]
  ds_read_b128 a[232:235], v120 offset:47104
  v_mfma_f32_16x16x32_bf16 v[252:255], a[204:207], a[92:95], v[252:255]
  s_waitcnt vmcnt(9)
  v_mfma_f32_16x16x32_bf16 v[248:251], a[204:207], a[84:87], v[248:251]
  ds_read_b128 a[236:239], v120 offset:57344
  v_mfma_f32_16x16x32_bf16 v[248:251], a[200:203], a[80:83], v[248:251]
  s_waitcnt lgkmcnt(4)
  v_mfma_f32_16x16x32_bf16 v[220:223], a[208:211], a[104:107], v[220:223]
  ds_read_b128 a[240:243], v120 offset:26624
  v_mfma_f32_16x16x32_bf16 v[220:223], a[212:215], a[108:111], v[220:223]
  v_mfma_f32_16x16x32_bf16 v[216:219], a[212:215], a[100:103], v[216:219]
  ds_read_b128 a[244:247], v120 offset:36864
  v_mfma_f32_16x16x32_bf16 v[216:219], a[208:211], a[96:99], v[216:219]
  v_mfma_f32_16x16x32_bf16 v[216:219], a[216:219], a[112:115], v[216:219]
  ds_read_b128 a[248:251], v120 offset:6144
  v_mfma_f32_16x16x32_bf16 v[216:219], a[220:223], a[116:119], v[216:219]
  v_mfma_f32_16x16x32_bf16 v[220:223], a[220:223], a[124:127], v[220:223]
  ds_read_b128 a[252:255], v120 offset:16384
  v_mfma_f32_16x16x32_bf16 v[220:223], a[216:219], a[120:123], v[220:223]
  s_waitcnt lgkmcnt(4)
  v_mfma_f32_16x16x32_bf16 v[220:223], a[224:227], a[136:139], v[220:223]
  ds_read_b128 a[192:195], v120 offset:48128
  v_mfma_f32_16x16x32_bf16 v[220:223], a[228:231], a[140:143], v[220:223]
  v_mfma_f32_16x16x32_bf16 v[216:219], a[228:231], a[132:135], v[216:219]
  ds_read_b128 a[196:199], v120 offset:58368
  v_mfma_f32_16x16x32_bf16 v[216:219], a[224:227], a[128:131], v[216:219]
  v_mfma_f32_16x16x32_bf16 v[228:231], a[232:235], a[104:107], v[228:231]
  ds_read_b128 a[200:203], v120 offset:27648
  v_mfma_f32_16x16x32_bf16 v[228:231], a[236:239], a[108:111], v[228:231]
  v_mfma_f32_16x16x32_bf16 v[224:227], a[236:239], a[100:103], v[224:227]
  ds_read_b128 a[204:207], v120 offset:37888
  v_mfma_f32_16x16x32_bf16 v[224:227], a[232:235], a[96:99], v[224:227]
  s_waitcnt lgkmcnt(4)
  v_mfma_f32_16x16x32_bf16 v[224:227], a[240:243], a[112:115], v[224:227]
  ds_read_b128 a[208:211], v120 offset:7168
  v_mfma_f32_16x16x32_bf16 v[224:227], a[244:247], a[116:119], v[224:227]
  v_mfma_f32_16x16x32_bf16 v[228:231], a[244:247], a[124:127], v[228:231]
  ds_read_b128 a[212:215], v120 offset:17408
  v_mfma_f32_16x16x32_bf16 v[228:231], a[240:243], a[120:123], v[228:231]
  v_mfma_f32_16x16x32_bf16 v[228:231], a[248:251], a[136:139], v[228:231]
  ds_read_b128 a[216:219], v120 offset:49152
  v_mfma_f32_16x16x32_bf16 v[228:231], a[252:255], a[140:143], v[228:231]
  v_mfma_f32_16x16x32_bf16 v[224:227], a[252:255], a[132:135], v[224:227]
  ds_read_b128 a[220:223], v120 offset:59392
  v_mfma_f32_16x16x32_bf16 v[224:227], a[248:251], a[128:131], v[224:227]
  s_waitcnt lgkmcnt(4)
  v_mfma_f32_16x16x32_bf16 v[236:239], a[192:195], a[104:107], v[236:239]
  ds_read_b128 a[224:227], v120 offset:28672
  v_mfma_f32_16x16x32_bf16 v[236:239], a[196:199], a[108:111], v[236:239]
  v_cvt_pk_bf16_f32 v76, v220, v221
  v_cvt_pk_bf16_f32 v77, v222, v223
  v_mfma_f32_16x16x32_bf16 v[232:235], a[196:199], a[100:103], v[232:235]
  ds_read_b128 a[228:231], v120 offset:38912
  v_cvt_pk_bf16_f32 v78, v228, v229
  v_mfma_f32_16x16x32_bf16 v[232:235], a[192:195], a[96:99], v[232:235]
  v_cvt_pk_bf16_f32 v79, v230, v231
  v_mfma_f32_16x16x32_bf16 v[232:235], a[200:203], a[112:115], v[232:235]
  s_xor_b32 s3, s97, 54272
  ds_read_b128 a[232:235], v120 offset:8192
  v_mfma_f32_16x16x32_bf16 v[232:235], a[204:207], a[116:119], v[232:235]
  buffer_store_dwordx4 v[76:79], v3, s[32:35], s3 offen offset:0 sc1
  v_mfma_f32_16x16x32_bf16 v[236:239], a[204:207], a[124:127], v[236:239]
  ds_read_b128 a[236:239], v120 offset:18432
  v_cvt_pk_bf16_f32 v80, v216, v217
  v_mfma_f32_16x16x32_bf16 v[236:239], a[200:203], a[120:123], v[236:239]
  s_waitcnt lgkmcnt(4)
  v_cvt_pk_bf16_f32 v81, v218, v219
  v_cvt_pk_bf16_f32 v82, v224, v225
  v_mfma_f32_16x16x32_bf16 v[236:239], a[208:211], a[136:139], v[236:239]
  s_xor_b32 s3, s97, 16384
  ds_read_b128 a[240:243], v120 offset:50176
  v_cvt_pk_bf16_f32 v83, v226, v227
  v_mfma_f32_16x16x32_bf16 v[236:239], a[212:215], a[140:143], v[236:239]
  buffer_store_dwordx4 v[80:83], v3, s[32:35], s3 offen offset:0 sc1
  v_mfma_f32_16x16x32_bf16 v[232:235], a[212:215], a[132:135], v[232:235]
  ds_read_b128 a[244:247], v120 offset:60416
  v_mfma_f32_16x16x32_bf16 v[232:235], a[208:211], a[128:131], v[232:235]
  v_mfma_f32_16x16x32_bf16 v[244:247], a[216:219], a[104:107], v[244:247]
  ds_read_b128 a[248:251], v120 offset:29696
  v_mfma_f32_16x16x32_bf16 v[244:247], a[220:223], a[108:111], v[244:247]
  v_mfma_f32_16x16x32_bf16 v[240:243], a[220:223], a[100:103], v[240:243]
  ds_read_b128 a[252:255], v120 offset:39936
  v_mfma_f32_16x16x32_bf16 v[240:243], a[216:219], a[96:99], v[240:243]
  s_waitcnt lgkmcnt(4)
  v_mfma_f32_16x16x32_bf16 v[240:243], a[224:227], a[112:115], v[240:243]
  ds_read_b128 a[192:195], v120 offset:9216
  v_mfma_f32_16x16x32_bf16 v[240:243], a[228:231], a[116:119], v[240:243]
  v_mfma_f32_16x16x32_bf16 v[244:247], a[228:231], a[124:127], v[244:247]
  ds_read_b128 a[196:199], v120 offset:19456
  v_mfma_f32_16x16x32_bf16 v[244:247], a[224:227], a[120:123], v[244:247]
  v_mfma_f32_16x16x32_bf16 v[244:247], a[232:235], a[136:139], v[244:247]
  ds_read_b128 a[200:203], v120 offset:40960
  v_mfma_f32_16x16x32_bf16 v[244:247], a[236:239], a[140:143], v[244:247]
  v_mfma_f32_16x16x32_bf16 v[240:243], a[236:239], a[132:135], v[240:243]
  ds_read_b128 a[204:207], v120 offset:51200
  v_mfma_f32_16x16x32_bf16 v[240:243], a[232:235], a[128:131], v[240:243]
  s_waitcnt lgkmcnt(4)
  v_mfma_f32_16x16x32_bf16 v[252:255], a[240:243], a[104:107], v[252:255]
  ds_read_b128 a[208:211], v120 offset:20480
  v_mfma_f32_16x16x32_bf16 v[252:255], a[244:247], a[108:111], v[252:255]
  v_cvt_pk_bf16_f32 v84, v236, v237
  v_cvt_pk_bf16_f32 v85, v238, v239
  v_mfma_f32_16x16x32_bf16 v[248:251], a[244:247], a[100:103], v[248:251]
  ds_read_b128 a[212:215], v120 offset:30720
  v_cvt_pk_bf16_f32 v86, v244, v245
  v_mfma_f32_16x16x32_bf16 v[248:251], a[240:243], a[96:99], v[248:251]
  v_cvt_pk_bf16_f32 v87, v246, v247
  v_mfma_f32_16x16x32_bf16 v[248:251], a[248:251], a[112:115], v[248:251]
  s_xor_b32 s3, s97, 54272
  ds_read_b128 a[216:219], v120 offset:0
  v_mfma_f32_16x16x32_bf16 v[248:251], a[252:255], a[116:119], v[248:251]
  buffer_store_dwordx4 v[84:87], v3, s[32:35], s3 offen offset:1024 sc1
  v_mfma_f32_16x16x32_bf16 v[252:255], a[252:255], a[124:127], v[252:255]
  ds_read_b128 a[220:223], v120 offset:10240
  v_cvt_pk_bf16_f32 v76, v232, v233
  v_mfma_f32_16x16x32_bf16 v[252:255], a[248:251], a[120:123], v[252:255]
  s_waitcnt lgkmcnt(4)
  v_cvt_pk_bf16_f32 v77, v234, v235
  v_cvt_pk_bf16_f32 v78, v240, v241
  v_mfma_f32_16x16x32_bf16 v[252:255], a[192:195], a[136:139], v[252:255]
  s_xor_b32 s3, s97, 16384
  ds_read_b128 a[224:227], v120 offset:41984
  v_cvt_pk_bf16_f32 v79, v242, v243
  v_mfma_f32_16x16x32_bf16 v[252:255], a[196:199], a[140:143], v[252:255]
  buffer_store_dwordx4 v[76:79], v3, s[32:35], s3 offen offset:1024 sc1
  v_mfma_f32_16x16x32_bf16 v[248:251], a[196:199], a[132:135], v[248:251]
  ds_read_b128 a[228:231], v120 offset:52224
  v_mfma_f32_16x16x32_bf16 v[248:251], a[192:195], a[128:131], v[248:251]
  v_mfma_f32_16x16x32_bf16 v[180:183], a[200:203], a[104:107], v[180:183]
  ds_read_b128 a[232:235], v120 offset:21504
  v_mfma_f32_16x16x32_bf16 v[180:183], a[204:207], a[108:111], v[180:183]
  s_nop 0
  v_cvt_pk_bf16_f32 v80, v252, v253
  v_cvt_pk_bf16_f32 v81, v254, v255
  v_mfma_f32_16x16x32_bf16 v[176:179], a[204:207], a[100:103], v[176:179]
  s_xor_b32 s3, s97, 54272
  ds_read_b128 a[236:239], v120 offset:31744
  v_mfma_f32_16x16x32_bf16 v[176:179], a[200:203], a[96:99], v[176:179]
  s_waitcnt lgkmcnt(4)
  buffer_store_dwordx2 v[80:81], v114, s[32:35], s3 offen offset:2048 sc1
  v_mfma_f32_16x16x32_bf16 v[176:179], a[208:211], a[112:115], v[176:179]
  ds_read_b128 a[240:243], v120 offset:1024
  v_cvt_pk_bf16_f32 v84, v248, v249
  v_mfma_f32_16x16x32_bf16 v[176:179], a[212:215], a[116:119], v[176:179]
  v_cvt_pk_bf16_f32 v85, v250, v251
  v_mfma_f32_16x16x32_bf16 v[180:183], a[212:215], a[124:127], v[180:183]
  s_xor_b32 s3, s97, 16384
  ds_read_b128 a[244:247], v120 offset:11264
  v_mfma_f32_16x16x32_bf16 v[180:183], a[208:211], a[120:123], v[180:183]
  buffer_store_dwordx2 v[84:85], v114, s[32:35], s3 offen offset:2048 sc1
  v_mfma_f32_16x16x32_bf16 v[180:183], a[216:219], a[136:139], v[180:183]
  ds_read_b128 a[248:251], v120 offset:43008
  v_mfma_f32_16x16x32_bf16 v[180:183], a[220:223], a[140:143], v[180:183]
  v_mfma_f32_16x16x32_bf16 v[176:179], a[220:223], a[132:135], v[176:179]
  ds_read_b128 a[252:255], v120 offset:53248
  v_mfma_f32_16x16x32_bf16 v[176:179], a[216:219], a[128:131], v[176:179]
  s_waitcnt lgkmcnt(4)
  v_mfma_f32_16x16x32_bf16 v[188:191], a[224:227], a[104:107], v[188:191]
  ds_read_b128 a[192:195], v120 offset:22528
  v_mfma_f32_16x16x32_bf16 v[188:191], a[228:231], a[108:111], v[188:191]
  v_mfma_f32_16x16x32_bf16 v[184:187], a[228:231], a[100:103], v[184:187]
  ds_read_b128 a[196:199], v120 offset:32768
  v_mfma_f32_16x16x32_bf16 v[184:187], a[224:227], a[96:99], v[184:187]
  v_mfma_f32_16x16x32_bf16 v[184:187], a[232:235], a[112:115], v[184:187]
  ds_read_b128 a[200:203], v120 offset:2048
  v_mfma_f32_16x16x32_bf16 v[184:187], a[236:239], a[116:119], v[184:187]
  v_mfma_f32_16x16x32_bf16 v[188:191], a[236:239], a[124:127], v[188:191]
  ds_read_b128 a[204:207], v120 offset:12288
  v_mfma_f32_16x16x32_bf16 v[188:191], a[232:235], a[120:123], v[188:191]
  s_waitcnt lgkmcnt(4)
  v_mfma_f32_16x16x32_bf16 v[188:191], a[240:243], a[136:139], v[188:191]
  ds_read_b128 a[208:211], v120 offset:44032
  v_mfma_f32_16x16x32_bf16 v[188:191], a[244:247], a[140:143], v[188:191]
  v_mfma_f32_16x16x32_bf16 v[184:187], a[244:247], a[132:135], v[184:187]
  ds_read_b128 a[212:215], v120 offset:54272
  v_mfma_f32_16x16x32_bf16 v[184:187], a[240:243], a[128:131], v[184:187]
  v_mfma_f32_16x16x32_bf16 v[196:199], a[248:251], a[104:107], v[196:199]
  ds_read_b128 a[216:219], v120 offset:23552
  v_mfma_f32_16x16x32_bf16 v[196:199], a[252:255], a[108:111], v[196:199]
  v_cvt_pk_bf16_f32 v76, v180, v181
  v_cvt_pk_bf16_f32 v77, v182, v183
  v_mfma_f32_16x16x32_bf16 v[192:195], a[252:255], a[100:103], v[192:195]
  ds_read_b128 a[220:223], v120 offset:33792
  v_cvt_pk_bf16_f32 v78, v188, v189
  v_mfma_f32_16x16x32_bf16 v[192:195], a[248:251], a[96:99], v[192:195]
  s_waitcnt lgkmcnt(4)
  v_cvt_pk_bf16_f32 v79, v190, v191
  v_mfma_f32_16x16x32_bf16 v[192:195], a[192:195], a[112:115], v[192:195]
  s_xor_b32 s3, s97, 35328
  ds_read_b128 a[224:227], v120 offset:3072
  v_mfma_f32_16x16x32_bf16 v[192:195], a[196:199], a[116:119], v[192:195]
  buffer_store_dwordx4 v[76:79], v3, s[32:35], s3 offen offset:0 sc1
  v_mfma_f32_16x16x32_bf16 v[196:199], a[196:199], a[124:127], v[196:199]
  ds_read_b128 a[228:231], v120 offset:13312
  v_mfma_f32_16x16x32_bf16 v[196:199], a[192:195], a[120:123], v[196:199]
  v_mfma_f32_16x16x32_bf16 v[196:199], a[200:203], a[136:139], v[196:199]
  ds_read_b128 a[232:235], v120 offset:45056
  v_mfma_f32_16x16x32_bf16 v[196:199], a[204:207], a[140:143], v[196:199]
  v_mfma_f32_16x16x32_bf16 v[192:195], a[204:207], a[132:135], v[192:195]
  ds_read_b128 a[236:239], v120 offset:55296
  v_mfma_f32_16x16x32_bf16 v[192:195], a[200:203], a[128:131], v[192:195]
  s_waitcnt lgkmcnt(4)
  v_mfma_f32_16x16x32_bf16 v[204:207], a[208:211], a[104:107], v[204:207]
  ds_read_b128 a[240:243], v120 offset:24576
  v_mfma_f32_16x16x32_bf16 v[204:207], a[212:215], a[108:111], v[204:207]
  v_mfma_f32_16x16x32_bf16 v[200:203], a[212:215], a[100:103], v[200:203]
  ds_read_b128 a[244:247], v120 offset:34816
  v_mfma_f32_16x16x32_bf16 v[200:203], a[208:211], a[96:99], v[200:203]
  v_mfma_f32_16x16x32_bf16 v[200:203], a[216:219], a[112:115], v[200:203]
  ds_read_b128 a[248:251], v120 offset:4096
  v_mfma_f32_16x16x32_bf16 v[200:203], a[220:223], a[116:119], v[200:203]
  v_mfma_f32_16x16x32_bf16 v[204:207], a[220:223], a[124:127], v[204:207]
  ds_read_b128 a[252:255], v120 offset:14336
  v_mfma_f32_16x16x32_bf16 v[204:207], a[216:219], a[120:123], v[204:207]
  s_waitcnt lgkmcnt(4)
  v_mfma_f32_16x16x32_bf16 v[204:207], a[224:227], a[136:139], v[204:207]
  v_mfma_f32_16x16x32_bf16 v[204:207], a[228:231], a[140:143], v[204:207]
  v_mfma_f32_16x16x32_bf16 v[200:203], a[228:231], a[132:135], v[200:203]
  v_mfma_f32_16x16x32_bf16 v[200:203], a[224:227], a[128:131], v[200:203]
  v_mfma_f32_16x16x32_bf16 v[212:215], a[232:235], a[104:107], v[212:215]
  v_mfma_f32_16x16x32_bf16 v[212:215], a[236:239], a[108:111], v[212:215]
  v_cvt_pk_bf16_f32 v80, v196, v197
  v_cvt_pk_bf16_f32 v81, v198, v199
  v_mfma_f32_16x16x32_bf16 v[208:211], a[236:239], a[100:103], v[208:211]
  s_xor_b32 s3, s97, 35328
  v_cvt_pk_bf16_f32 v82, v204, v205
  v_cvt_pk_bf16_f32 v83, v206, v207
  v_mfma_f32_16x16x32_bf16 v[208:211], a[232:235], a[96:99], v[208:211]
  s_waitcnt lgkmcnt(0)
  buffer_store_dwordx4 v[80:83], v3, s[32:35], s3 offen offset:1024 sc1
  v_mfma_f32_16x16x32_bf16 v[208:211], a[240:243], a[112:115], v[208:211]
  v_mfma_f32_16x16x32_bf16 v[208:211], a[244:247], a[116:119], v[208:211]
  v_mfma_f32_16x16x32_bf16 v[212:215], a[244:247], a[124:127], v[212:215]
  v_mfma_f32_16x16x32_bf16 v[212:215], a[240:243], a[120:123], v[212:215]
  v_mfma_f32_16x16x32_bf16 v[212:215], a[248:251], a[136:139], v[212:215]
  v_mfma_f32_16x16x32_bf16 v[212:215], a[252:255], a[140:143], v[212:215]
  v_mfma_f32_16x16x32_bf16 v[208:211], a[252:255], a[132:135], v[208:211]
  v_mfma_f32_16x16x32_bf16 v[208:211], a[248:251], a[128:131], v[208:211]
  s_nop 5
  v_cvt_pk_bf16_f32 v84, v212, v213
  v_cvt_pk_bf16_f32 v85, v214, v215
  s_xor_b32 s3, s97, 35328
  buffer_store_dwordx2 v[84:85], v114, s[32:35], s3 offen offset:2048 sc1
  s_waitcnt vmcnt(9)
  v_mfma_f32_16x16x32_bf16 v[8:11], v[90:93], v[128:131], v[8:11]
  v_mfma_f32_16x16x32_bf16 v[12:15], v[88:91], v[128:131], v[12:15]
  v_mfma_f32_16x16x32_bf16 v[16:19], v[90:93], v[132:135], v[16:19]
  v_mfma_f32_16x16x32_bf16 v[20:23], v[88:91], v[132:135], v[20:23]
  v_mfma_f32_16x16x32_bf16 v[24:27], v[88:91], v[134:137], v[24:27]
  v_mfma_f32_16x16x32_bf16 v[8:11], v[90:93], v[138:141], v[8:11]
  v_mfma_f32_16x16x32_bf16 v[12:15], v[88:91], v[138:141], v[12:15]
  v_mfma_f32_16x16x32_bf16 v[16:19], v[90:93], v[142:145], v[16:19]
  v_mfma_f32_16x16x32_bf16 v[20:23], v[88:91], v[142:145], v[20:23]
  v_mfma_f32_16x16x32_bf16 v[24:27], v[88:91], v[144:147], v[24:27]
  v_mfma_f32_16x16x32_bf16 v[8:11], v[90:93], v[148:151], v[8:11]
  v_mfma_f32_16x16x32_bf16 v[12:15], v[88:91], v[148:151], v[12:15]
  v_mfma_f32_16x16x32_bf16 v[16:19], v[90:93], v[152:155], v[16:19]
  v_mfma_f32_16x16x32_bf16 v[20:23], v[88:91], v[152:155], v[20:23]
  v_mfma_f32_16x16x32_bf16 v[24:27], v[88:91], v[154:157], v[24:27]
  v_mov_b32 v100, 0xc2b17218
  v_mov_b32 v102, 0x3c853526
  v_mov_b32 v103, 0x3c853526
  s_nop 0
  v_pk_mul_f32 v[128:129], v[8:9], v[100:101] op_sel_hi:[1,0]
  v_pk_mul_f32 v[130:131], v[10:11], v[100:101] op_sel_hi:[1,0]
  v_pk_mul_f32 v[132:133], v[12:13], v[100:101] op_sel_hi:[1,0]
  v_pk_mul_f32 v[134:135], v[14:15], v[100:101] op_sel_hi:[1,0]
  v_pk_mul_f32 v[136:137], v[16:17], v[100:101] op_sel_hi:[1,0]
  v_pk_mul_f32 v[138:139], v[18:19], v[100:101] op_sel_hi:[1,0]
  v_pk_mul_f32 v[140:141], v[20:21], v[100:101] op_sel_hi:[1,0]
  v_pk_mul_f32 v[142:143], v[22:23], v[100:101] op_sel_hi:[1,0]
  v_pk_mul_f32 v[144:145], v[24:25], v[100:101] op_sel_hi:[1,0]
  v_pk_mul_f32 v[146:147], v[26:27], v[100:101] op_sel_hi:[1,0]
  v_exp_f32 v128, v128
  v_exp_f32 v129, v129
  v_exp_f32 v130, v130
  v_exp_f32 v131, v131
  v_exp_f32 v132, v132
  v_exp_f32 v133, v133
  v_exp_f32 v134, v134
  v_exp_f32 v135, v135
  v_exp_f32 v136, v136
  v_exp_f32 v137, v137
  v_exp_f32 v138, v138
  v_exp_f32 v139, v139
  v_exp_f32 v140, v140
  v_exp_f32 v141, v141
  v_exp_f32 v142, v142
  v_exp_f32 v143, v143
  v_exp_f32 v144, v144
  v_exp_f32 v145, v145
  v_exp_f32 v146, v146
  v_exp_f32 v147, v147
  v_pk_fma_f32 v[128:129], v[128:129], v[102:103], v[102:103]
  v_pk_fma_f32 v[130:131], v[130:131], v[102:103], v[102:103]
  v_pk_fma_f32 v[132:133], v[132:133], v[102:103], v[102:103]
  v_pk_fma_f32 v[134:135], v[134:135], v[102:103], v[102:103]
  v_pk_fma_f32 v[136:137], v[136:137], v[102:103], v[102:103]
  v_pk_fma_f32 v[138:139], v[138:139], v[102:103], v[102:103]
  v_pk_fma_f32 v[140:141], v[140:141], v[102:103], v[102:103]
  v_pk_fma_f32 v[142:143], v[142:143], v[102:103], v[102:103]
  v_pk_fma_f32 v[144:145], v[144:145], v[102:103], v[102:103]
  v_pk_fma_f32 v[146:147], v[146:147], v[102:103], v[102:103]
  v_rcp_f32 v128, v128
  v_rcp_f32 v129, v129
  v_rcp_f32 v130, v130
  v_rcp_f32 v131, v131
  v_rcp_f32 v132, v132
  v_rcp_f32 v133, v133
  v_rcp_f32 v134, v134
  v_rcp_f32 v135, v135
  v_rcp_f32 v136, v136
  v_rcp_f32 v137, v137
  v_rcp_f32 v138, v138
  v_rcp_f32 v139, v139
  v_rcp_f32 v140, v140
L_pad_post00_2:
  s_cbranch_execz L_back1
  v_rcp_f32 v141, v141
  v_rcp_f32 v142, v142
  v_rcp_f32 v143, v143
  v_rcp_f32 v144, v144
  v_rcp_f32 v145, v145
  v_rcp_f32 v146, v146
  v_rcp_f32 v147, v147
  v_pk_mul_f32 v[8:9], v[8:9], v[128:129]
  v_pk_mul_f32 v[10:11], v[10:11], v[130:131]
  v_pk_mul_f32 v[12:13], v[12:13], v[132:133]
  v_pk_mul_f32 v[14:15], v[14:15], v[134:135]
  v_pk_mul_f32 v[16:17], v[16:17], v[136:137]
  v_pk_mul_f32 v[18:19], v[18:19], v[138:139]
  v_pk_mul_f32 v[20:21], v[20:21], v[140:141]
  v_pk_mul_f32 v[22:23], v[22:23], v[142:143]
  v_pk_mul_f32 v[24:25], v[24:25], v[144:145]
  v_pk_mul_f32 v[26:27], v[26:27], v[146:147]
  v_permlane16_swap_b32 v28, v30
  v_permlane16_swap_b32 v29, v31
  v_permlane16_swap_b32 v32, v34
  v_permlane16_swap_b32 v33, v35
  v_lshlrev_b32 v48, 16, v28
  v_and_b32 v49, 0xffff0000, v28
  v_lshlrev_b32 v50, 16, v29
  v_and_b32 v51, 0xffff0000, v29
  v_lshlrev_b32 v52, 16, v30
  v_and_b32 v53, 0xffff0000, v30
  v_lshlrev_b32 v54, 16, v31
  v_and_b32 v55, 0xffff0000, v31
  v_lshlrev_b32 v56, 16, v32
  v_and_b32 v57, 0xffff0000, v32
  v_lshlrev_b32 v58, 16, v33
  v_and_b32 v59, 0xffff0000, v33
  v_lshlrev_b32 v60, 16, v34
  v_and_b32 v61, 0xffff0000, v34
  v_lshlrev_b32 v62, 16, v35
  v_and_b32 v63, 0xffff0000, v35
  v_lshlrev_b32 v64, 16, v36
  v_and_b32 v65, 0xffff0000, v36
  v_lshlrev_b32 v66, 16, v37
  v_and_b32 v67, 0xffff0000, v37
  s_xor_b32 s3, s97, 0
  buffer_load_dwordx4 v[216:219], v3, s[32:35], s3 offen offset:0 sc1
  buffer_load_dwordx4 v[220:223], v3, s[32:35], s3 offen offset:1024 sc1
  buffer_load_dwordx2 v[224:225], v114, s[32:35], s3 offen offset:2048 sc1
  s_xor_b32 s3, s97, 5120
  buffer_load_dwordx4 v[236:239], v3, s[32:35], s3 offen offset:0 sc1
  buffer_load_dwordx4 v[240:243], v3, s[32:35], s3 offen offset:1024 sc1
  buffer_load_dwordx2 v[244:245], v114, s[32:35], s3 offen offset:2048 sc1
  s_xor_b32 s3, s97, 2560
  buffer_load_dwordx4 v[226:229], v3, s[32:35], s3 offen offset:0 sc1
  buffer_load_dwordx4 v[230:233], v3, s[32:35], s3 offen offset:1024 sc1
  buffer_load_dwordx2 v[234:235], v114, s[32:35], s3 offen offset:2048 sc1
  s_mov_b32 s59, 65536
  s_waitcnt vmcnt(3)
  v_max3_u32 v96, v216, v217, v218
  v_max3_u32 v97, v219, v220, v221
  v_max3_u32 v96, v96, v222, v223
  v_max3_u32 v97, v97, v224, v225
  v_max3_u32 v96, v96, v236, v237
  v_max3_u32 v97, v97, v238, v239
  v_max3_u32 v96, v96, v240, v241
  v_max3_u32 v97, v97, v242, v243
  v_max3_u32 v96, v96, v244, v245
  v_max_u32 v96, v96, v97
  v_cmp_eq_u32 vcc, -1, v96
  s_nop 1
  s_cbranch_vccnz L_px_0
L_px_ok_0:
  v_mfma_f32_16x16x32_bf16 v[176:179], v[90:93], v[216:219], v[176:179]
  v_mfma_f32_16x16x32_bf16 v[184:187], v[88:91], v[216:219], v[184:187]
  v_mfma_f32_16x16x32_bf16 v[192:195], v[90:93], v[220:223], v[192:195]
  s_waitcnt vmcnt(0)
  v_mfma_f32_16x16x32_bf16 v[200:203], v[88:91], v[220:223], v[200:203]
  v_max3_u32 v96, v226, v227, v228
  v_mfma_f32_16x16x32_bf16 v[208:211], v[88:91], v[222:225], v[208:211]
  v_max3_u32 v97, v229, v230, v231
  v_mfma_f32_16x16x32_bf16 v[176:179], v[90:93], v[236:239], v[176:179]
  v_max3_u32 v96, v96, v232, v233
  v_mfma_f32_16x16x32_bf16 v[184:187], v[88:91], v[236:239], v[184:187]
  v_max3_u32 v97, v97, v234, v235
  v_mfma_f32_16x16x32_bf16 v[192:195], v[90:93], v[240:243], v[192:195]
  v_max_u32 v96, v96, v97
  v_mfma_f32_16x16x32_bf16 v[200:203], v[88:91], v[240:243], v[200:203]
  v_cmp_eq_u32 vcc, -1, v96
  v_mfma_f32_16x16x32_bf16 v[208:211], v[88:91], v[242:245], v[208:211]
  s_cbranch_vccnz L_py_0
L_py_ok_0:
  v_mfma_f32_16x16x32_bf16 v[176:179], v[90:93], v[226:229], v[176:179]
  v_mfma_f32_16x16x32_bf16 v[184:187], v[88:91], v[226:229], v[184:187]
  v_mfma_f32_16x16x32_bf16 v[192:195], v[90:93], v[230:233], v[192:195]
  v_mfma_f32_16x16x32_bf16 v[200:203], v[88:91], v[230:233], v[200:203]
  v_mfma_f32_16x16x32_bf16 v[208:211], v[88:91], v[232:235], v[208:211]
  s_nop 3
  v_pk_fma_f32 v[48:49], v[176:177], v[8:9], v[48:49]
  v_pk_fma_f32 v[50:51], v[178:179], v[10:11], v[50:51]
  v_pk_fma_f32 v[52:53], v[184:185], v[12:13], v[52:53]
  v_pk_fma_f32 v[54:55], v[186:187], v[14:15], v[54:55]
  v_pk_fma_f32 v[56:57], v[192:193], v[16:17], v[56:57]
  v_pk_fma_f32 v[58:59], v[194:195], v[18:19], v[58:59]
  v_pk_fma_f32 v[60:61], v[200:201], v[20:21], v[60:61]
  v_pk_fma_f32 v[62:63], v[202:203], v[22:23], v[62:63]
  v_pk_fma_f32 v[64:65], v[208:209], v[24:25], v[64:65]
  v_pk_fma_f32 v[66:67], v[210:211], v[26:27], v[66:67]
  v_cvt_pk_bf16_f32 v36, v64, v65
  v_cvt_pk_bf16_f32 v37, v66, v67
  buffer_store_dwordx2 v[36:37], v123, s[24:27], s28 offen offset:128 sc1 nt
  v_cvt_pk_bf16_f32 v28, v48, v49
  v_cvt_pk_bf16_f32 v29, v50, v51
  v_cvt_pk_bf16_f32 v30, v52, v53
  v_cvt_pk_bf16_f32 v31, v54, v55
  s_nop 0
  v_permlane16_swap_b32 v28, v30
  v_permlane16_swap_b32 v29, v31
  buffer_store_dwordx4 v[28:31], v38, s[24:27], s28 offen offset:0 sc1 nt
  v_cvt_pk_bf16_f32 v32, v56, v57
  v_cvt_pk_bf16_f32 v33, v58, v59
  v_cvt_pk_bf16_f32 v34, v60, v61
  v_cvt_pk_bf16_f32 v35, v62, v63
  s_nop 0
  v_permlane16_swap_b32 v32, v34
  v_permlane16_swap_b32 v33, v35
  buffer_store_dwordx4 v[32:35], v38, s[24:27], s28 offen offset:64 sc1 nt
  s_endpgm
L_ow_0:
  s_mov_b32 s59, 65536
L_ow2_0:
  buffer_load_dword v117, v122, s[32:35], s30 offen sc1
  s_sub_u32 s59, s59, 1
  s_waitcnt vmcnt(0)
  v_cmp_ne_u32 vcc, 1, v117
  s_cmp_eq_u32 s59, 0
  s_cbranch_scc1 L_ow2_ok_0
  s_cbranch_vccnz L_ow2_0
L_ow2_ok_0:
  s_branch L_ow_ok_0
L_ox_0:
  s_mov_b32 s59, 65536
L_ox2_0:
  buffer_load_dword v117, v122, s[32:35], s30 offen sc1
  s_sub_u32 s59, s59, 1
  s_waitcnt vmcnt(0)
  v_cmp_ne_u32 vcc, 1, v117
  s_cmp_eq_u32 s59, 0
  s_cbranch_scc1 L_ox2_ok_0
  s_cbranch_vccnz L_ox2_0
L_ox2_ok_0:
  s_branch L_ox_ok_0
L_gw_0:
  s_mov_b32 s59, 65536
L_gw2_0:
  s_xor_b32 s3, s97, 5632
  buffer_load_dwordx2 v[136:137], v114, s[32:35], s3 offen offset:2048 sc1
  s_xor_b32 s3, s97, 6144
  buffer_load_dwordx2 v[146:147], v114, s[32:35], s3 offen offset:2048 sc1
  s_xor_b32 s3, s97, 6656
  buffer_load_dwordx2 v[156:157], v114, s[32:35], s3 offen offset:2048 sc1
  s_sub_u32 s59, s59, 1
  s_waitcnt vmcnt(0)
  v_max3_u32 v96, v136, v137, v146
  v_max3_u32 v96, v96, v147, v156
  v_max_u32 v96, v96, v157
  v_cmp_eq_u32 vcc, -1, v96
  s_cmp_eq_u32 s59, 0
  s_cbranch_scc1 L_gw2_ok_0
  s_cbranch_vccnz L_gw2_0
L_gw2_ok_0:
  s_branch L_gw_ok_0
L_px_0:
  s_mov_b32 s19, 0
  s_sub_u32 s59, s59, 1
  s_waitcnt vmcnt(0)
  v_max3_u32 v96, v216, v217, v218
  v_max3_u32 v97, v219, v220, v221
  v_max3_u32 v96, v96, v222, v223
  v_max3_u32 v97, v97, v224, v225
  v_max_u32 v96, v96, v97
  v_cmp_eq_u32 vcc, -1, v96
  s_nop 1
  s_cbranch_vccz L_px1_0
  s_xor_b32 s3, s97, 0
  buffer_load_dwordx4 v[216:219], v3, s[32:35], s3 offen offset:0 sc1
  buffer_load_dwordx4 v[220:223], v3, s[32:35], s3 offen offset:1024 sc1
  buffer_load_dwordx2 v[224:225], v114, s[32:35], s3 offen offset:2048 sc1
  s_mov_b32 s19, s59
L_px1_0:
  v_max3_u32 v96, v236, v237, v238
  v_max3_u32 v97, v239, v240, v241
  v_max3_u32 v96, v96, v242, v243
  v_max3_u32 v97, v97, v244, v245
  v_max_u32 v96, v96, v97
  v_cmp_eq_u32 vcc, -1, v96
  s_nop 1
  s_cbranch_vccz L_px3_0
  s_xor_b32 s3, s97, 5120
  buffer_load_dwordx4 v[236:239], v3, s[32:35], s3 offen offset:0 sc1
  buffer_load_dwordx4 v[240:243], v3, s[32:35], s3 offen offset:1024 sc1
  buffer_load_dwordx2 v[244:245], v114, s[32:35], s3 offen offset:2048 sc1
  s_mov_b32 s19, s59
L_px3_0:
  s_cmp_eq_u32 s19, 0
  s_cbranch_scc1 L_pxe_0
  v_max3_u32 v96, v226, v227, v228
  v_max3_u32 v97, v229, v230, v231
  v_max3_u32 v96, v96, v232, v233
  v_max3_u32 v97, v97, v234, v235
  v_max_u32 v96, v96, v97
  v_cmp_eq_u32 vcc, -1, v96
  s_nop 1
  s_cbranch_vccz L_px2_0
  s_xor_b32 s3, s97, 2560
  buffer_load_dwordx4 v[226:229], v3, s[32:35], s3 offen offset:0 sc1
  buffer_load_dwordx4 v[230:233], v3, s[32:35], s3 offen offset:1024 sc1
  buffer_load_dwordx2 v[234:235], v114, s[32:35], s3 offen offset:2048 sc1
L_px2_0:
  s_branch L_px_0
L_pxe_0:
  s_waitcnt vmcnt(0)
  s_mov_b32 s59, 65536
  s_branch L_px_ok_0
L_py_0:
  s_xor_b32 s3, s97, 2560
  buffer_load_dwordx4 v[226:229], v3, s[32:35], s3 offen offset:0 sc1
  buffer_load_dwordx4 v[230:233], v3, s[32:35], s3 offen offset:1024 sc1
  buffer_load_dwordx2 v[234:235], v114, s[32:35], s3 offen offset:2048 sc1
  s_sub_u32 s59, s59, 1
  s_waitcnt vmcnt(0)
  v_max3_u32 v96, v226, v227, v228
  v_max3_u32 v97, v229, v230, v231
  v_max3_u32 v96, v96, v232, v233
  v_max3_u32 v97, v97, v234, v235
  v_max_u32 v96, v96, v97
  v_cmp_eq_u32 vcc, -1, v96
  s_cmp_eq_u32 s59, 0
  s_cbranch_scc1 L_py_ok_0
  s_cbranch_vccnz L_py_0
  s_branch L_py_ok_0
L_cw_0:
  s_mov_b32 s59, 65536
L_cw2_0:
  buffer_load_dword v117, v124, s[48:51], 0 offen offset:16 sc1
  s_sub_u32 s59, s59, 1
  s_waitcnt vmcnt(0)
  v_cmp_gt_u32 vcc, 0x100, v117
  s_cmp_eq_u32 s59, 0
  s_cbranch_scc1 L_cw2_ok_0
  s_cbranch_vccnz L_cw2_0
L_cw2_ok_0:
  s_branch L_cw_ok_0
L_slow:
  s_waitcnt vmcnt(0) lgkmcnt(0)
  s_barrier
  s_lshl_b32 s16, s44, 19
  s_add_u32 s16, s16, s18
  s_mov_b32 s19, 32
  v_mov_b32 v96, 0xff800000
  v_mov_b32 v97, 0xff800000
  v_mov_b32 v98, 0xff800000
  v_mov_b32 v99, 0xff800000
L_mx:
  s_add_u32 m0, s18, 0
  s_nop 0
  buffer_load_dwordx4 v88, s[8:11], s16 offen offset:0 lds
  buffer_load_dwordx4 v89, s[8:11], s16 offen offset:1024 lds
  buffer_load_dwordx4 v90, s[8:11], s16 offen offset:2048 lds
  buffer_load_dwordx4 v91, s[8:11], s16 offen offset:3072 lds
  s_waitcnt vmcnt(0)
  s_barrier
  s_add_u32 s16, s16, 16384
  ds_read_b128 a[192:195], v76 offset:0
  ds_read_b128 a[196:199], v77 offset:0
  ds_read_b128 a[200:203], v78 offset:0
  ds_read_b128 a[204:207], v79 offset:0
  s_waitcnt lgkmcnt(0)
  v_mfma_f32_16x16x32_bf16 v[40:43], a[192:195], v[192:195], 0
  v_mfma_f32_16x16x32_bf16 v[40:43], a[196:199], v[208:211], v[40:43]
  v_mfma_f32_16x16x32_bf16 v[40:43], a[200:203], v[224:227], v[40:43]
  v_mfma_f32_16x16x32_bf16 v[40:43], a[204:207], v[240:243], v[40:43]
  v_mfma_f32_16x16x32_bf16 v[44:47], a[192:195], v[196:199], 0
  v_mfma_f32_16x16x32_bf16 v[44:47], a[196:199], v[212:215], v[44:47]
  v_mfma_f32_16x16x32_bf16 v[44:47], a[200:203], v[228:231], v[44:47]
  v_mfma_f32_16x16x32_bf16 v[44:47], a[204:207], v[244:247], v[44:47]
  v_mfma_f32_16x16x32_bf16 v[48:51], a[192:195], v[200:203], 0
  v_mfma_f32_16x16x32_bf16 v[48:51], a[196:199], v[216:219], v[48:51]
  v_mfma_f32_16x16x32_bf16 v[48:51], a[200:203], v[232:235], v[48:51]
  v_mfma_f32_16x16x32_bf16 v[48:51], a[204:207], v[248:251], v[48:51]
  v_mfma_f32_16x16x32_bf16 v[52:55], a[192:195], v[204:207], 0
  v_mfma_f32_16x16x32_bf16 v[52:55], a[196:199], v[220:223], v[52:55]
  v_mfma_f32_16x16x32_bf16 v[52:55], a[200:203], v[236:239], v[52:55]
  v_mfma_f32_16x16x32_bf16 v[52:55], a[204:207], v[252:255], v[52:55]
  v_max3_f32 v96, v96, v40, v41
  v_max3_f32 v96, v96, v42, v43
  v_max3_f32 v97, v97, v44, v45
  v_max3_f32 v97, v97, v46, v47
  v_max3_f32 v98, v98, v48, v49
  v_max3_f32 v98, v98, v50, v51
  s_nop 1
  v_max3_f32 v99, v99, v52, v53
  v_max3_f32 v99, v99, v54, v55
  ds_read_b128 a[208:211], v76 offset:4096
  ds_read_b128 a[212:215], v77 offset:4096
  ds_read_b128 a[216:219], v78 offset:4096
  ds_read_b128 a[220:223], v79 offset:4096
  s_waitcnt lgkmcnt(0)
  v_mfma_f32_16x16x32_bf16 v[40:43], a[208:211], v[192:195], 0
  v_mfma_f32_16x16x32_bf16 v[40:43], a[212:215], v[208:211], v[40:43]
  v_mfma_f32_16x16x32_bf16 v[40:43], a[216:219], v[224:227], v[40:43]
  v_mfma_f32_16x16x32_bf16 v[40:43], a[220:223], v[240:243], v[40:43]
  v_mfma_f32_16x16x32_bf16 v[44:47], a[208:211], v[196:199], 0
  v_mfma_f32_16x16x32_bf16 v[44:47], a[212:215], v[212:215], v[44:47]
  v_mfma_f32_16x16x32_bf16 v[44:47], a[216:219], v[228:231], v[44:47]
  v_mfma_f32_16x16x32_bf16 v[44:47], a[220:223], v[244:247], v[44:47]
  v_mfma_f32_16x16x32_bf16 v[48:51], a[208:211], v[200:203], 0
  v_mfma_f32_16x16x32_bf16 v[48:51], a[212:215], v[216:219], v[48:51]
  v_mfma_f32_16x16x32_bf16 v[48:51], a[216:219], v[232:235], v[48:51]
  v_mfma_f32_16x16x32_bf16 v[48:51], a[220:223], v[248:251], v[48:51]
  v_mfma_f32_16x16x32_bf16 v[52:55], a[208:211], v[204:207], 0
  v_mfma_f32_16x16x32_bf16 v[52:55], a[212:215], v[220:223], v[52:55]
  v_mfma_f32_16x16x32_bf16 v[52:55], a[216:219], v[236:239], v[52:55]
  v_mfma_f32_16x16x32_bf16 v[52:55], a[220:223], v[252:255], v[52:55]
  v_max3_f32 v96, v96, v40, v41
  v_max3_f32 v96, v96, v42, v43
  v_max3_f32 v97, v97, v44, v45
  v_max3_f32 v97, v97, v46, v47
  v_max3_f32 v98, v98, v48, v49
  v_max3_f32 v98, v98, v50, v51
  s_nop 1
  v_max3_f32 v99, v99, v52, v53
  v_max3_f32 v99, v99, v54, v55
  ds_read_b128 a[192:195], v76 offset:8192
  ds_read_b128 a[196:199], v77 offset:8192
  ds_read_b128 a[200:203], v78 offset:8192
  ds_read_b128 a[204:207], v79 offset:8192
  s_waitcnt lgkmcnt(0)
  v_mfma_f32_16x16x32_bf16 v[40:43], a[192:195], v[192:195], 0
  v_mfma_f32_16x16x32_bf16 v[40:43], a[196:199], v[208:211], v[40:43]
  v_mfma_f32_16x16x32_bf16 v[40:43], a[200:203], v[224:227], v[40:43]
  v_mfma_f32_16x16x32_bf16 v[40:43], a[204:207], v[240:243], v[40:43]
  v_mfma_f32_16x16x32_bf16 v[44:47], a[192:195], v[196:199], 0
  v_mfma_f32_16x16x32_bf16 v[44:47], a[196:199], v[212:215], v[44:47]
  v_mfma_f32_16x16x32_bf16 v[44:47], a[200:203], v[228:231], v[44:47]
  v_mfma_f32_16x16x32_bf16 v[44:47], a[204:207], v[244:247], v[44:47]
  v_mfma_f32_16x16x32_bf16 v[48:51], a[192:195], v[200:203], 0
  v_mfma_f32_16x16x32_bf16 v[48:51], a[196:199], v[216:219], v[48:51]
  v_mfma_f32_16x16x32_bf16 v[48:51], a[200:203], v[232:235], v[48:51]
  v_mfma_f32_16x16x32_bf16 v[48:51], a[204:207], v[248:251], v[48:51]
  v_mfma_f32_16x16x32_bf16 v[52:55], a[192:195], v[204:207], 0
  v_mfma_f32_16x16x32_bf16 v[52:55], a[196:199], v[220:223], v[52:55]
  v_mfma_f32_16x16x32_bf16 v[52:55], a[200:203], v[236:239], v[52:55]
  v_mfma_f32_16x16x32_bf16 v[52:55], a[204:207], v[252:255], v[52:55]
  v_max3_f32 v96, v96, v40, v41
  v_max3_f32 v96, v96, v42, v43
  v_max3_f32 v97, v97, v44, v45
  v_max3_f32 v97, v97, v46, v47
  v_max3_f32 v98, v98, v48, v49
  v_max3_f32 v98, v98, v50, v51
  s_nop 1
  v_max3_f32 v99, v99, v52, v53
  v_max3_f32 v99, v99, v54, v55
  ds_read_b128 a[208:211], v76 offset:12288
  ds_read_b128 a[212:215], v77 offset:12288
  ds_read_b128 a[216:219], v78 offset:12288
  ds_read_b128 a[220:223], v79 offset:12288
  s_waitcnt lgkmcnt(0)
  v_mfma_f32_16x16x32_bf16 v[40:43], a[208:211], v[192:195], 0
  v_mfma_f32_16x16x32_bf16 v[40:43], a[212:215], v[208:211], v[40:43]
  v_mfma_f32_16x16x32_bf16 v[40:43], a[216:219], v[224:227], v[40:43]
  v_mfma_f32_16x16x32_bf16 v[40:43], a[220:223], v[240:243], v[40:43]
  v_mfma_f32_16x16x32_bf16 v[44:47], a[208:211], v[196:199], 0
  v_mfma_f32_16x16x32_bf16 v[44:47], a[212:215], v[212:215], v[44:47]
  v_mfma_f32_16x16x32_bf16 v[44:47], a[216:219], v[228:231], v[44:47]
  v_mfma_f32_16x16x32_bf16 v[44:47], a[220:223], v[244:247], v[44:47]
  v_mfma_f32_16x16x32_bf16 v[48:51], a[208:211], v[200:203], 0
  v_mfma_f32_16x16x32_bf16 v[48:51], a[212:215], v[216:219], v[48:51]
  v_mfma_f32_16x16x32_bf16 v[48:51], a[216:219], v[232:235], v[48:51]
  v_mfma_f32_16x16x32_bf16 v[48:51], a[220:223], v[248:251], v[48:51]
  v_mfma_f32_16x16x32_bf16 v[52:55], a[208:211], v[204:207], 0
  v_mfma_f32_16x16x32_bf16 v[52:55], a[212:215], v[220:223], v[52:55]
  v_mfma_f32_16x16x32_bf16 v[52:55], a[216:219], v[236:239], v[52:55]
  v_mfma_f32_16x16x32_bf16 v[52:55], a[220:223], v[252:255], v[52:55]
  v_max3_f32 v96, v96, v40, v41
  v_max3_f32 v96, v96, v42, v43
  v_max3_f32 v97, v97, v44, v45
  v_max3_f32 v97, v97, v46, v47
  v_max3_f32 v98, v98, v48, v49
  v_max3_f32 v98, v98, v50, v51
  s_nop 1
  v_max3_f32 v99, v99, v52, v53
  v_max3_f32 v99, v99, v54, v55
  s_barrier
  s_sub_u32 s19, s19, 1
  s_cmp_lg_u32 s19, 0
  s_cbranch_scc1 L_mx
  s_lshl_b32 s16, s44, 19
  s_add_u32 s16, s16, s18
  s_mov_b32 s17, s16
  s_add_u32 m0, s18, 0
  s_nop 0
  buffer_load_dwordx4 v88, s[8:11], s16 offen offset:0 lds
  buffer_load_dwordx4 v89, s[8:11], s16 offen offset:1024 lds
  buffer_load_dwordx4 v90, s[8:11], s16 offen offset:2048 lds
  buffer_load_dwordx4 v91, s[8:11], s16 offen offset:3072 lds
  s_add_u32 m0, s18, 114688
  s_nop 0
  buffer_load_dwordx4 v92, s[12:15], s17 offen offset:0 lds
  buffer_load_dwordx4 v93, s[12:15], s17 offen offset:1024 lds
  buffer_load_dwordx4 v92, s[12:15], s17 offen offset:2048 lds
  buffer_load_dwordx4 v93, s[12:15], s17 offen offset:3072 lds
  s_add_u32 m0, s18, 16384
  s_add_u32 s16, s16, 16384
  buffer_load_dwordx4 v88, s[8:11], s16 offen offset:0 lds
  buffer_load_dwordx4 v89, s[8:11], s16 offen offset:1024 lds
  buffer_load_dwordx4 v90, s[8:11], s16 offen offset:2048 lds
  buffer_load_dwordx4 v91, s[8:11], s16 offen offset:3072 lds
  v_mov_b32 v100, v96
  s_nop 1
  v_permlane32_swap_b32 v96, v100
  v_max_f32 v96, v96, v100
  v_mov_b32 v100, v96
  s_nop 1
  v_permlane16_swap_b32 v96, v100
  v_max_f32 v96, v96, v100
  v_mov_b32 v100, v97
  s_nop 1
  v_permlane32_swap_b32 v97, v100
  v_max_f32 v97, v97, v100
  v_mov_b32 v100, v97
  s_nop 1
  v_permlane16_swap_b32 v97, v100
  v_max_f32 v97, v97, v100
  v_mov_b32 v100, v98
  s_nop 1
  v_permlane32_swap_b32 v98, v100
  v_max_f32 v98, v98, v100
  v_mov_b32 v100, v98
  s_nop 1
  v_permlane16_swap_b32 v98, v100
  v_max_f32 v98, v98, v100
  v_mov_b32 v100, v99
  s_nop 1
  v_permlane32_swap_b32 v99, v100
  v_max_f32 v99, v99, v100
  v_mov_b32 v100, v99
  s_nop 1
  v_permlane16_swap_b32 v99, v100
  v_max_f32 v99, v99, v100
  v_sub_f32 v24, 0, v96
  v_sub_f32 v25, 0, v96
  v_sub_f32 v26, 0, v96
  v_sub_f32 v27, 0, v96
  v_sub_f32 v28, 0, v97
  v_sub_f32 v29, 0, v97
  v_sub_f32 v30, 0, v97
  v_sub_f32 v31, 0, v97
  v_sub_f32 v32, 0, v98
  v_sub_f32 v33, 0, v98
  v_sub_f32 v34, 0, v98
  v_sub_f32 v35, 0, v98
  v_sub_f32 v36, 0, v99
  v_sub_f32 v37, 0, v99
  v_sub_f32 v38, 0, v99
  v_sub_f32 v39, 0, v99
  v_mov_b32 v8, 0
  v_mov_b32 v9, 0
  v_mov_b32 v12, 0
  v_mov_b32 v13, 0
  v_mov_b32 v16, 0
  v_mov_b32 v17, 0
  v_mov_b32 v20, 0
  v_mov_b32 v21, 0
  v_mov_b32 v118, 0
  s_mov_b32 s58, 0
  s_mov_b32 s6, 0
  s_mov_b32 s86, 67108864
  s_mov_b32 s57, 67108864
  s_lshr_b32 s19, s44, 3
  s_and_b32 s87, s44, 3
  s_mul_i32 s42, s43, 5120
  s_lshr_b32 s99, s43, 1
  s_mul_i32 s40, s99, 40960
  s_xor_b32 s99, s43, s19
  s_and_b32 s99, s99, 1
  s_mul_i32 s99, s99, 5120
  s_add_u32 s40, s40, s99
  s_mul_i32 s99, s87, 10240
  s_add_u32 s40, s40, s99
  s_mul_i32 s99, s19, 1310720
  s_add_u32 s84, s40, s99
  s_add_u32 s84, s84, 2211840
  s_and_b32 s99, s44, 7
  s_mul_i32 s99, s99, 163840
  s_add_u32 s29, s84, s99
  s_lshr_b32 s59, s19, 1
  s_mul_i32 s59, s59, 14
  s_and_b32 s99, s19, 1
  s_mul_i32 s99, s99, 8
  s_add_u32 s59, s59, s99
  s_mul_i32 s99, s59, 81920
  s_add_u32 s40, s40, s99
  s_lshl2_add_u32 s28, s45, s43
  s_lshl_b32 s41, s28, 13
  s_lshl_b32 s99, s19, 22
  s_add_u32 s85, s41, s99
  s_add_u32 s85, s85, 12582912
  s_lshl_b32 s99, s59, 18
  s_add_u32 s41, s41, s99
  s_lshl2_add_u32 s28, s28, s98
  s_mul_i32 s28, s28, 20480
  s_and_b32 s3, s19, 1
  s_lshl1_add_u32 s99, s87, s3
  s_mul_i32 s99, s99, 160
  s_add_u32 s28, s28, s99
  s_andn2_b32 s30, s96, 15
  s_add_u32 s82, s46, 262144
  s_lshl_b32 s81, s44, 19
  s_add_u32 s81, s81, 458752
  s_waitcnt vmcnt(0)
  s_barrier
  ds_read_b128 a[192:195], v76 offset:0
  ds_read_b128 a[196:199], v77 offset:0
  ds_read_b128 a[200:203], v78 offset:0
  ds_read_b128 a[204:207], v79 offset:0
  s_waitcnt lgkmcnt(0)
  s_branch L_attn
L_end:
  s_endpgm
.section .rodata,"a"
.p2align 6
.amdhsa_kernel recurrent_scan__gqa_block_cached__glu_gated_bilinear__prompt_kernel
  .amdhsa_next_free_vgpr 512
  .amdhsa_next_free_sgpr 102
  .amdhsa_accum_offset 256
  .amdhsa_group_segment_fixed_size 0
  .amdhsa_kernarg_size 96
  .amdhsa_user_sgpr_count 2
  .amdhsa_user_sgpr_kernarg_segment_ptr 1
  .amdhsa_system_sgpr_workgroup_id_x 1
.end_amdhsa_kernel
```
